```python
import torch

def _softmax(x, axis=-1):
    return torch.softmax(x, dim=axis)
def _gelu(x):
    return torch.nn.functional.gelu(x, approximate="tanh")
def _silu(x):
    return torch.nn.functional.silu(x)
def _sigmoid(x):
    return torch.sigmoid(x)
def _layernorm(x, axis=-1, eps=1e-5):
    m = x.mean(dim=axis, keepdim=True)
    v = x.var(dim=axis, keepdim=True, unbiased=False)
    return (x - m) / torch.sqrt(v + eps)
def _scatter_add(tgt, idx, src, axis=0):
    return tgt.clone().index_add_(axis, idx, src)
def _segment_sum(src, seg, n):
    out = torch.zeros((n,) + src.shape[1:], dtype=src.dtype)
    return out.index_add_(0, seg, src)
def _pad(x, pw):
    flat = tuple(v for pair in reversed(pw) for v in pair)
    return torch.nn.functional.pad(x, flat)

kernel_name = 'standalone__fft_conv__vision'

def setup_inputs():

    _w = (lambda a: (lambda t: t.to(torch.bfloat16) if t.is_floating_point() else t)(torch.as_tensor(a)))
    H = W = 224
    C = 96
    K = 7
    return {
        "x": _w((lambda *s: torch.randn(*s, dtype=torch.bfloat16) * 0.05)(1, H, W, C)),
        "w": _w((lambda *s: torch.randn(*s, dtype=torch.bfloat16) * 0.05)(K, K, C, C)),
    }

def reference(x, w):
    B, H, W, C = x.shape
    K = w.shape[0]
    wp = _pad(w, ((0, H - K), (0, W - K), (0, 0), (0, 0)))
    Xf = (lambda x, axes=(-2,-1): torch.fft.rfft2(x.float(), dim=axes))(x, axes=(1, 2))
    Wf = (lambda x, axes=(-2,-1): torch.fft.rfft2(x.float(), dim=axes))(wp, axes=(0, 1))
    Yf = torch.einsum('bhwi,hwio->bhwo', Xf, Wf)
    y = (lambda x, s, axes=(-2,-1): torch.fft.irfft2(x, s=s, dim=axes).to(torch.bfloat16))(Yf, (H, W), axes=(1, 2))
    return y
```

```asm
; @launch kernel=k1_kernel grid=(1176,1,1) block=(64,1,1) lds=24704
; @launch kernel=k2_kernel grid=(256,1,1) block=(256,1,1) lds=163840
.amdgcn_target "amdgcn-amd-amdhsa--gfx950"
.text
.globl k1_kernel
.p2align 8
.type k1_kernel,@function
k1_kernel:
    s_load_dwordx4 s[4:7], s[0:1], 0
    s_load_dwordx2 s[8:9], s[0:1], 32
    s_getpc_b64 s[10:11]
K1_pc:
    s_cmp_ge_u32 s2, 1176
    s_cbranch_scc1 K1_end
    s_cmp_ge_u32 s2, 672
    s_cbranch_scc1 K1_w
    v_lshlrev_b32 v1, 4, v0
    s_add_u32 s10, s10, K1_bt-K1_pc
    s_addc_u32 s11, s11, 0
    global_load_dwordx4 v[20:23], v1, s[10:11]
    s_cmp_ge_u32 s2, 8
    s_cbranch_scc1 K1_nopf
    s_lshl_b32 s34, s2, 13
    v_lshlrev_b32 v2, 7, v0
    v_add_u32 v2, s34, v2
    v_min_u32 v2, K2_code_end-K1_bt-4, v2
    global_load_dword v24, v2, s[10:11]
K1_nopf:
    s_and_b32 s20, s2, 7
    s_lshr_b32 s21, s2, 3
    s_lshl_b32 s22, s21, 3
    v_add_u32 v8, 0, v0
    v_mul_u32_u24 v9, 5462, v8
    v_lshrrev_b32 v2, 16, v9
    v_mul_u32_u24 v9, 12, v2
    v_sub_u32 v8, v8, v9
    v_bfe_u32 v9, v2, 1, 2
    v_xor_b32 v8, v8, v9
    v_lshlrev_b32 v5, 4, v8
    v_add_u32 v8, 64, v0
    v_mul_u32_u24 v9, 5462, v8
    v_lshrrev_b32 v3, 16, v9
    v_mul_u32_u24 v9, 12, v3
    v_sub_u32 v8, v8, v9
    v_bfe_u32 v9, v3, 1, 2
    v_xor_b32 v8, v8, v9
    v_lshlrev_b32 v6, 4, v8
    v_add_u32 v8, 128, v0
    v_mul_u32_u24 v9, 5462, v8
    v_lshrrev_b32 v4, 16, v9
    v_mul_u32_u24 v9, 12, v4
    v_sub_u32 v8, v8, v9
    v_bfe_u32 v9, v4, 1, 2
    v_xor_b32 v8, v8, v9
    v_lshlrev_b32 v7, 4, v8
    s_mov_b32 s23, 192
    s_add_u32 s24, s22, 0
    s_mul_i32 s25, s24, 2260
    s_lshr_b32 s25, s25, 16
    s_mul_i32 s26, s25, 29
    s_sub_u32 s26, s24, s26
    s_min_u32 s25, s25, 22
    s_mul_i32 s25, s25, 10
    s_add_u32 s48, s25, 218
    s_lshl_b32 s27, s26, 3
    s_add_u32 s27, s27, s20
    s_add_u32 s28, s27, 216
    s_sub_u32 s27, s27, 8
    s_cmp_eq_u32 s26, 0
    s_cselect_b32 s27, s28, s27
    s_mul_i32 s40, s27, 43008
    s_add_u32 s24, s22, 1
    s_mul_i32 s25, s24, 2260
    s_lshr_b32 s25, s25, 16
    s_mul_i32 s26, s25, 29
    s_sub_u32 s26, s24, s26
    s_min_u32 s25, s25, 22
    s_mul_i32 s25, s25, 10
    s_add_u32 s49, s25, 218
    s_lshl_b32 s27, s26, 3
    s_add_u32 s27, s27, s20
    s_add_u32 s28, s27, 216
    s_sub_u32 s27, s27, 8
    s_cmp_eq_u32 s26, 0
    s_cselect_b32 s27, s28, s27
    s_mul_i32 s41, s27, 43008
    s_add_u32 s24, s22, 2
    s_mul_i32 s25, s24, 2260
    s_lshr_b32 s25, s25, 16
    s_mul_i32 s26, s25, 29
    s_sub_u32 s26, s24, s26
    s_min_u32 s25, s25, 22
    s_mul_i32 s25, s25, 10
    s_add_u32 s50, s25, 218
    s_lshl_b32 s27, s26, 3
    s_add_u32 s27, s27, s20
    s_add_u32 s28, s27, 216
    s_sub_u32 s27, s27, 8
    s_cmp_eq_u32 s26, 0
    s_cselect_b32 s27, s28, s27
    s_mul_i32 s42, s27, 43008
    s_add_u32 s24, s22, 3
    s_mul_i32 s25, s24, 2260
    s_lshr_b32 s25, s25, 16
    s_mul_i32 s26, s25, 29
    s_sub_u32 s26, s24, s26
    s_min_u32 s25, s25, 22
    s_mul_i32 s25, s25, 10
    s_add_u32 s51, s25, 218
    s_lshl_b32 s27, s26, 3
    s_add_u32 s27, s27, s20
    s_add_u32 s28, s27, 216
    s_sub_u32 s27, s27, 8
    s_cmp_eq_u32 s26, 0
    s_cselect_b32 s27, s28, s27
    s_mul_i32 s43, s27, 43008
    s_add_u32 s24, s22, 4
    s_mul_i32 s25, s24, 2260
    s_lshr_b32 s25, s25, 16
    s_mul_i32 s26, s25, 29
    s_sub_u32 s26, s24, s26
    s_min_u32 s25, s25, 22
    s_mul_i32 s25, s25, 10
    s_add_u32 s52, s25, 218
    s_lshl_b32 s27, s26, 3
    s_add_u32 s27, s27, s20
    s_add_u32 s28, s27, 216
    s_sub_u32 s27, s27, 8
    s_cmp_eq_u32 s26, 0
    s_cselect_b32 s27, s28, s27
    s_mul_i32 s44, s27, 43008
    s_add_u32 s24, s22, 5
    s_mul_i32 s25, s24, 2260
    s_lshr_b32 s25, s25, 16
    s_mul_i32 s26, s25, 29
    s_sub_u32 s26, s24, s26
    s_min_u32 s25, s25, 22
    s_mul_i32 s25, s25, 10
    s_add_u32 s53, s25, 218
    s_lshl_b32 s27, s26, 3
    s_add_u32 s27, s27, s20
    s_add_u32 s28, s27, 216
    s_sub_u32 s27, s27, 8
    s_cmp_eq_u32 s26, 0
    s_cselect_b32 s27, s28, s27
    s_mul_i32 s45, s27, 43008
    s_add_u32 s24, s22, 6
    s_mul_i32 s25, s24, 2260
    s_lshr_b32 s25, s25, 16
    s_mul_i32 s26, s25, 29
    s_sub_u32 s26, s24, s26
    s_min_u32 s25, s25, 22
    s_mul_i32 s25, s25, 10
    s_add_u32 s54, s25, 218
    s_lshl_b32 s27, s26, 3
    s_add_u32 s27, s27, s20
    s_add_u32 s28, s27, 216
    s_sub_u32 s27, s27, 8
    s_cmp_eq_u32 s26, 0
    s_cselect_b32 s27, s28, s27
    s_mul_i32 s46, s27, 43008
    s_add_u32 s24, s22, 7
    s_mul_i32 s25, s24, 2260
    s_lshr_b32 s25, s25, 16
    s_mul_i32 s26, s25, 29
    s_sub_u32 s26, s24, s26
    s_min_u32 s25, s25, 22
    s_mul_i32 s25, s25, 10
    s_add_u32 s55, s25, 218
    s_lshl_b32 s27, s26, 3
    s_add_u32 s27, s27, s20
    s_add_u32 s28, s27, 216
    s_sub_u32 s27, s27, 8
    s_cmp_eq_u32 s26, 0
    s_cselect_b32 s27, s28, s27
    s_mul_i32 s47, s27, 43008
    s_waitcnt lgkmcnt(0)
    s_mov_b32 s12, s4
    s_and_b32 s13, s5, 0xffff
    s_mov_b32 s14, 9633792
    s_mov_b32 s15, 0x00020000
    v_add_u32 v8, s48, v2
    v_subrev_u32 v9, 224, v8
    v_min_u32 v8, v8, v9
    v_subrev_u32 v9, 224, v8
    v_min_u32 v8, v8, v9
    s_mov_b32 m0, 0
    v_mad_u32_u24 v10, v8, s23, v5
    buffer_load_dwordx4 v10, s[12:15], s40 offen lds
    v_add_u32 v8, s48, v3
    v_subrev_u32 v9, 224, v8
    v_min_u32 v8, v8, v9
    v_subrev_u32 v9, 224, v8
    v_min_u32 v8, v8, v9
    s_mov_b32 m0, 1024
    v_mad_u32_u24 v11, v8, s23, v6
    buffer_load_dwordx4 v11, s[12:15], s40 offen lds
    v_add_u32 v8, s48, v4
    v_subrev_u32 v9, 224, v8
    v_min_u32 v8, v8, v9
    v_subrev_u32 v9, 224, v8
    v_min_u32 v8, v8, v9
    s_mov_b32 m0, 2048
    v_mad_u32_u24 v12, v8, s23, v7
    buffer_load_dwordx4 v12, s[12:15], s40 offen lds
    v_add_u32 v8, s49, v2
    v_subrev_u32 v9, 224, v8
    v_min_u32 v8, v8, v9
    v_subrev_u32 v9, 224, v8
    v_min_u32 v8, v8, v9
    s_mov_b32 m0, 3088
    v_mad_u32_u24 v10, v8, s23, v5
    buffer_load_dwordx4 v10, s[12:15], s41 offen lds
    v_add_u32 v8, s49, v3
    v_subrev_u32 v9, 224, v8
    v_min_u32 v8, v8, v9
    v_subrev_u32 v9, 224, v8
    v_min_u32 v8, v8, v9
    s_mov_b32 m0, 4112
    v_mad_u32_u24 v11, v8, s23, v6
    buffer_load_dwordx4 v11, s[12:15], s41 offen lds
    v_add_u32 v8, s49, v4
    v_subrev_u32 v9, 224, v8
    v_min_u32 v8, v8, v9
    v_subrev_u32 v9, 224, v8
    v_min_u32 v8, v8, v9
    s_mov_b32 m0, 5136
    v_mad_u32_u24 v12, v8, s23, v7
    buffer_load_dwordx4 v12, s[12:15], s41 offen lds
    v_add_u32 v8, s50, v2
    v_subrev_u32 v9, 224, v8
    v_min_u32 v8, v8, v9
    v_subrev_u32 v9, 224, v8
    v_min_u32 v8, v8, v9
    s_mov_b32 m0, 6176
    v_mad_u32_u24 v10, v8, s23, v5
    buffer_load_dwordx4 v10, s[12:15], s42 offen lds
    v_add_u32 v8, s50, v3
    v_subrev_u32 v9, 224, v8
    v_min_u32 v8, v8, v9
    v_subrev_u32 v9, 224, v8
    v_min_u32 v8, v8, v9
    s_mov_b32 m0, 7200
    v_mad_u32_u24 v11, v8, s23, v6
    buffer_load_dwordx4 v11, s[12:15], s42 offen lds
    v_add_u32 v8, s50, v4
    v_subrev_u32 v9, 224, v8
    v_min_u32 v8, v8, v9
    v_subrev_u32 v9, 224, v8
    v_min_u32 v8, v8, v9
    s_mov_b32 m0, 8224
    v_mad_u32_u24 v12, v8, s23, v7
    buffer_load_dwordx4 v12, s[12:15], s42 offen lds
    v_add_u32 v8, s51, v2
    v_subrev_u32 v9, 224, v8
    v_min_u32 v8, v8, v9
    v_subrev_u32 v9, 224, v8
    v_min_u32 v8, v8, v9
    s_mov_b32 m0, 9264
    v_mad_u32_u24 v10, v8, s23, v5
    buffer_load_dwordx4 v10, s[12:15], s43 offen lds
    v_add_u32 v8, s51, v3
    v_subrev_u32 v9, 224, v8
    v_min_u32 v8, v8, v9
    v_subrev_u32 v9, 224, v8
    v_min_u32 v8, v8, v9
    s_mov_b32 m0, 10288
    v_mad_u32_u24 v11, v8, s23, v6
    buffer_load_dwordx4 v11, s[12:15], s43 offen lds
    v_add_u32 v8, s51, v4
    v_subrev_u32 v9, 224, v8
    v_min_u32 v8, v8, v9
    v_subrev_u32 v9, 224, v8
    v_min_u32 v8, v8, v9
    s_mov_b32 m0, 11312
    v_mad_u32_u24 v12, v8, s23, v7
    buffer_load_dwordx4 v12, s[12:15], s43 offen lds
    v_add_u32 v8, s52, v2
    v_subrev_u32 v9, 224, v8
    v_min_u32 v8, v8, v9
    v_subrev_u32 v9, 224, v8
    v_min_u32 v8, v8, v9
    s_mov_b32 m0, 12352
    v_mad_u32_u24 v10, v8, s23, v5
    buffer_load_dwordx4 v10, s[12:15], s44 offen lds
    v_add_u32 v8, s52, v3
    v_subrev_u32 v9, 224, v8
    v_min_u32 v8, v8, v9
    v_subrev_u32 v9, 224, v8
    v_min_u32 v8, v8, v9
    s_mov_b32 m0, 13376
    v_mad_u32_u24 v11, v8, s23, v6
    buffer_load_dwordx4 v11, s[12:15], s44 offen lds
    v_add_u32 v8, s52, v4
    v_subrev_u32 v9, 224, v8
    v_min_u32 v8, v8, v9
    v_subrev_u32 v9, 224, v8
    v_min_u32 v8, v8, v9
    s_mov_b32 m0, 14400
    v_mad_u32_u24 v12, v8, s23, v7
    buffer_load_dwordx4 v12, s[12:15], s44 offen lds
    v_add_u32 v8, s53, v2
    v_subrev_u32 v9, 224, v8
    v_min_u32 v8, v8, v9
    v_subrev_u32 v9, 224, v8
    v_min_u32 v8, v8, v9
    s_mov_b32 m0, 15440
    v_mad_u32_u24 v10, v8, s23, v5
    buffer_load_dwordx4 v10, s[12:15], s45 offen lds
    v_add_u32 v8, s53, v3
    v_subrev_u32 v9, 224, v8
    v_min_u32 v8, v8, v9
    v_subrev_u32 v9, 224, v8
    v_min_u32 v8, v8, v9
    s_mov_b32 m0, 16464
    v_mad_u32_u24 v11, v8, s23, v6
    buffer_load_dwordx4 v11, s[12:15], s45 offen lds
    v_add_u32 v8, s53, v4
    v_subrev_u32 v9, 224, v8
    v_min_u32 v8, v8, v9
    v_subrev_u32 v9, 224, v8
    v_min_u32 v8, v8, v9
    s_mov_b32 m0, 17488
    v_mad_u32_u24 v12, v8, s23, v7
    buffer_load_dwordx4 v12, s[12:15], s45 offen lds
    v_add_u32 v8, s54, v2
    v_subrev_u32 v9, 224, v8
    v_min_u32 v8, v8, v9
    v_subrev_u32 v9, 224, v8
    v_min_u32 v8, v8, v9
    s_mov_b32 m0, 18528
    v_mad_u32_u24 v10, v8, s23, v5
    buffer_load_dwordx4 v10, s[12:15], s46 offen lds
    v_add_u32 v8, s54, v3
    v_subrev_u32 v9, 224, v8
    v_min_u32 v8, v8, v9
    v_subrev_u32 v9, 224, v8
    v_min_u32 v8, v8, v9
    s_mov_b32 m0, 19552
    v_mad_u32_u24 v11, v8, s23, v6
    buffer_load_dwordx4 v11, s[12:15], s46 offen lds
    v_add_u32 v8, s54, v4
    v_subrev_u32 v9, 224, v8
    v_min_u32 v8, v8, v9
    v_subrev_u32 v9, 224, v8
    v_min_u32 v8, v8, v9
    s_mov_b32 m0, 20576
    v_mad_u32_u24 v12, v8, s23, v7
    buffer_load_dwordx4 v12, s[12:15], s46 offen lds
    v_add_u32 v8, s55, v2
    v_subrev_u32 v9, 224, v8
    v_min_u32 v8, v8, v9
    v_subrev_u32 v9, 224, v8
    v_min_u32 v8, v8, v9
    s_mov_b32 m0, 21616
    v_mad_u32_u24 v10, v8, s23, v5
    buffer_load_dwordx4 v10, s[12:15], s47 offen lds
    v_add_u32 v8, s55, v3
    v_subrev_u32 v9, 224, v8
    v_min_u32 v8, v8, v9
    v_subrev_u32 v9, 224, v8
    v_min_u32 v8, v8, v9
    s_mov_b32 m0, 22640
    v_mad_u32_u24 v11, v8, s23, v6
    buffer_load_dwordx4 v11, s[12:15], s47 offen lds
    v_add_u32 v8, s55, v4
    v_subrev_u32 v9, 224, v8
    v_min_u32 v8, v8, v9
    v_subrev_u32 v9, 224, v8
    v_min_u32 v8, v8, v9
    s_mov_b32 m0, 23664
    v_mad_u32_u24 v12, v8, s23, v7
    buffer_load_dwordx4 v12, s[12:15], s47 offen lds
    v_lshrrev_b32 v2, 4, v0
    v_and_b32 v3, 15, v0
    v_lshrrev_b32 v4, 2, v3
    v_and_b32 v5, 3, v0
    v_and_b32 v6, 1, v2
    v_lshl_add_u32 v6, v6, 3, v4
    v_mul_u32_u24 v7, 193, v5
    v_mul_u32_u24 v8, 12, v6
    v_add_u32 v7, v7, v8
    v_lshrrev_b32 v8, 1, v4
    v_xor_b32 v9, 0, v8
    s_waitcnt vmcnt(24)
    v_add_lshl_u32 v24, v7, v9, 4
    v_xor_b32 v9, 2, v8
    v_add_u32 v9, 48, v9
    v_add_lshl_u32 v28, v7, v9, 4
    v_xor_b32 v9, 1, v8
    v_add_lshl_u32 v25, v7, v9, 4
    v_xor_b32 v9, 3, v8
    v_add_u32 v9, 48, v9
    v_add_lshl_u32 v29, v7, v9, 4
    v_xor_b32 v9, 2, v8
    v_add_lshl_u32 v26, v7, v9, 4
    v_xor_b32 v9, 0, v8
    v_add_u32 v9, 48, v9
    v_add_lshl_u32 v30, v7, v9, 4
    v_xor_b32 v9, 3, v8
    v_add_lshl_u32 v27, v7, v9, 4
    v_xor_b32 v9, 1, v8
    v_add_u32 v9, 48, v9
    v_add_lshl_u32 v31, v7, v9, 4
    v_mul_u32_u24 v7, 193, v2
    v_mul_u32_u24 v8, 12, v3
    v_add_u32 v7, v7, v8
    v_bfe_u32 v8, v3, 1, 2
    v_xor_b32 v9, 0, v8
    v_add_lshl_u32 v144, v7, v9, 4
    v_xor_b32 v9, 1, v8
    v_add_lshl_u32 v145, v7, v9, 4
    v_xor_b32 v9, 2, v8
    v_add_lshl_u32 v146, v7, v9, 4
    v_xor_b32 v9, 3, v8
    v_add_lshl_u32 v147, v7, v9, 4
    v_lshrrev_b32 v2, 5, v0
    v_bfe_u32 v3, v0, 3, 2
    v_and_b32 v4, 7, v0
    v_mul_u32_u24 v7, 193, v4
    v_mul_u32_u24 v8, 12, v2
    v_add_u32 v7, v7, v8
    v_xor_b32 v9, 0, v3
    v_add_lshl_u32 v148, v7, v9, 4
    v_xor_b32 v9, 1, v3
    v_add_lshl_u32 v149, v7, v9, 4
    v_xor_b32 v9, 2, v3
    v_add_lshl_u32 v150, v7, v9, 4
    v_xor_b32 v9, 3, v3
    v_add_lshl_u32 v151, v7, v9, 4
    v_lshlrev_b32 v7, 13, v2
    v_lshl_add_u32 v7, v3, 8, v7
    v_lshl_add_u32 v152, v4, 4, v7
    s_lshr_b32 s24, s21, 1
    s_mul_i32 s24, s24, 393216
    s_lshl_b32 s25, s20, 10
    s_add_u32 s24, s24, s25
    s_and_b32 s25, s21, 1
    s_lshl_b32 s25, s25, 7
    s_add_u32 s24, s24, s25
    s_mov_b32 s16, s8
    s_and_b32 s17, s9, 0xffff
    s_mov_b32 s18, 16515072
    s_mov_b32 s19, 0x00020000
    s_waitcnt vmcnt(12)
    ds_read_b64_tr_b16 v[32:33], v24 offset:0
    ds_read_b64_tr_b16 v[34:35], v28 offset:0
    ds_read_b64_tr_b16 v[36:37], v24 offset:8
    ds_read_b64_tr_b16 v[38:39], v28 offset:8
    ds_read_b64_tr_b16 v[40:41], v25 offset:0
    ds_read_b64_tr_b16 v[42:43], v29 offset:0
    ds_read_b64_tr_b16 v[44:45], v25 offset:8
    ds_read_b64_tr_b16 v[46:47], v29 offset:8
    ds_read_b64_tr_b16 v[48:49], v26 offset:0
    ds_read_b64_tr_b16 v[50:51], v30 offset:0
    ds_read_b64_tr_b16 v[52:53], v26 offset:8
    ds_read_b64_tr_b16 v[54:55], v30 offset:8
    ds_read_b64_tr_b16 v[56:57], v27 offset:0
    ds_read_b64_tr_b16 v[58:59], v31 offset:0
    ds_read_b64_tr_b16 v[60:61], v27 offset:8
    ds_read_b64_tr_b16 v[62:63], v31 offset:8
    s_waitcnt lgkmcnt(14)
    v_mfma_f32_16x16x32_bf16 v[64:67], v[32:35], v[20:23], 0
    s_waitcnt lgkmcnt(12)
    v_mfma_f32_16x16x32_bf16 v[68:71], v[36:39], v[20:23], 0
    s_waitcnt lgkmcnt(10)
    v_mfma_f32_16x16x32_bf16 v[72:75], v[40:43], v[20:23], 0
    s_waitcnt lgkmcnt(8)
    v_mfma_f32_16x16x32_bf16 v[76:79], v[44:47], v[20:23], 0
    s_waitcnt lgkmcnt(6)
    v_mfma_f32_16x16x32_bf16 v[80:83], v[48:51], v[20:23], 0
    s_waitcnt lgkmcnt(4)
    v_mfma_f32_16x16x32_bf16 v[84:87], v[52:55], v[20:23], 0
    s_waitcnt lgkmcnt(2)
    v_mfma_f32_16x16x32_bf16 v[88:91], v[56:59], v[20:23], 0
    s_waitcnt lgkmcnt(0)
    v_mfma_f32_16x16x32_bf16 v[92:95], v[60:63], v[20:23], 0
    v_cvt_pk_bf16_f32 v96, v64, v65
    v_cvt_pk_bf16_f32 v97, v66, v67
    v_cvt_pk_bf16_f32 v98, v68, v69
    v_cvt_pk_bf16_f32 v99, v70, v71
    ds_write_b128 v144, v[96:99] offset:0
    v_cvt_pk_bf16_f32 v100, v72, v73
    v_cvt_pk_bf16_f32 v101, v74, v75
    v_cvt_pk_bf16_f32 v102, v76, v77
    v_cvt_pk_bf16_f32 v103, v78, v79
    ds_write_b128 v145, v[100:103] offset:0
    v_cvt_pk_bf16_f32 v104, v80, v81
    v_cvt_pk_bf16_f32 v105, v82, v83
    v_cvt_pk_bf16_f32 v106, v84, v85
    v_cvt_pk_bf16_f32 v107, v86, v87
    ds_write_b128 v146, v[104:107] offset:0
    v_cvt_pk_bf16_f32 v108, v88, v89
    v_cvt_pk_bf16_f32 v109, v90, v91
    v_cvt_pk_bf16_f32 v110, v92, v93
    v_cvt_pk_bf16_f32 v111, v94, v95
    ds_write_b128 v147, v[108:111] offset:0
    ds_read_b64_tr_b16 v[32:33], v24 offset:64
    ds_read_b64_tr_b16 v[34:35], v28 offset:64
    ds_read_b64_tr_b16 v[36:37], v24 offset:72
    ds_read_b64_tr_b16 v[38:39], v28 offset:72
    ds_read_b64_tr_b16 v[40:41], v25 offset:64
    ds_read_b64_tr_b16 v[42:43], v29 offset:64
    ds_read_b64_tr_b16 v[44:45], v25 offset:72
    ds_read_b64_tr_b16 v[46:47], v29 offset:72
    ds_read_b64_tr_b16 v[48:49], v26 offset:64
    ds_read_b64_tr_b16 v[50:51], v30 offset:64
    ds_read_b64_tr_b16 v[52:53], v26 offset:72
    ds_read_b64_tr_b16 v[54:55], v30 offset:72
    ds_read_b64_tr_b16 v[56:57], v27 offset:64
    ds_read_b64_tr_b16 v[58:59], v31 offset:64
    ds_read_b64_tr_b16 v[60:61], v27 offset:72
    ds_read_b64_tr_b16 v[62:63], v31 offset:72
    s_waitcnt lgkmcnt(14)
    v_mfma_f32_16x16x32_bf16 v[64:67], v[32:35], v[20:23], 0
    s_waitcnt lgkmcnt(12)
    v_mfma_f32_16x16x32_bf16 v[68:71], v[36:39], v[20:23], 0
    s_waitcnt lgkmcnt(10)
    v_mfma_f32_16x16x32_bf16 v[72:75], v[40:43], v[20:23], 0
    s_waitcnt lgkmcnt(8)
    v_mfma_f32_16x16x32_bf16 v[76:79], v[44:47], v[20:23], 0
    s_waitcnt lgkmcnt(6)
    v_mfma_f32_16x16x32_bf16 v[80:83], v[48:51], v[20:23], 0
    s_waitcnt lgkmcnt(4)
    v_mfma_f32_16x16x32_bf16 v[84:87], v[52:55], v[20:23], 0
    s_waitcnt lgkmcnt(2)
    v_mfma_f32_16x16x32_bf16 v[88:91], v[56:59], v[20:23], 0
    s_waitcnt lgkmcnt(0)
    v_mfma_f32_16x16x32_bf16 v[92:95], v[60:63], v[20:23], 0
    v_cvt_pk_bf16_f32 v96, v64, v65
    v_cvt_pk_bf16_f32 v97, v66, v67
    v_cvt_pk_bf16_f32 v98, v68, v69
    v_cvt_pk_bf16_f32 v99, v70, v71
    ds_write_b128 v144, v[96:99] offset:64
    v_cvt_pk_bf16_f32 v100, v72, v73
    v_cvt_pk_bf16_f32 v101, v74, v75
    v_cvt_pk_bf16_f32 v102, v76, v77
    v_cvt_pk_bf16_f32 v103, v78, v79
    ds_write_b128 v145, v[100:103] offset:64
    v_cvt_pk_bf16_f32 v104, v80, v81
    v_cvt_pk_bf16_f32 v105, v82, v83
    v_cvt_pk_bf16_f32 v106, v84, v85
    v_cvt_pk_bf16_f32 v107, v86, v87
    ds_write_b128 v146, v[104:107] offset:64
    v_cvt_pk_bf16_f32 v108, v88, v89
    v_cvt_pk_bf16_f32 v109, v90, v91
    v_cvt_pk_bf16_f32 v110, v92, v93
    v_cvt_pk_bf16_f32 v111, v94, v95
    ds_write_b128 v147, v[108:111] offset:64
    ds_read_b64_tr_b16 v[32:33], v24 offset:128
    ds_read_b64_tr_b16 v[34:35], v28 offset:128
    ds_read_b64_tr_b16 v[36:37], v24 offset:136
    ds_read_b64_tr_b16 v[38:39], v28 offset:136
    ds_read_b64_tr_b16 v[40:41], v25 offset:128
    ds_read_b64_tr_b16 v[42:43], v29 offset:128
    ds_read_b64_tr_b16 v[44:45], v25 offset:136
    ds_read_b64_tr_b16 v[46:47], v29 offset:136
    ds_read_b64_tr_b16 v[48:49], v26 offset:128
    ds_read_b64_tr_b16 v[50:51], v30 offset:128
    ds_read_b64_tr_b16 v[52:53], v26 offset:136
    ds_read_b64_tr_b16 v[54:55], v30 offset:136
    ds_read_b64_tr_b16 v[56:57], v27 offset:128
    ds_read_b64_tr_b16 v[58:59], v31 offset:128
    ds_read_b64_tr_b16 v[60:61], v27 offset:136
    ds_read_b64_tr_b16 v[62:63], v31 offset:136
    s_waitcnt lgkmcnt(14)
    v_mfma_f32_16x16x32_bf16 v[64:67], v[32:35], v[20:23], 0
    s_waitcnt lgkmcnt(12)
    v_mfma_f32_16x16x32_bf16 v[68:71], v[36:39], v[20:23], 0
    s_waitcnt lgkmcnt(10)
    v_mfma_f32_16x16x32_bf16 v[72:75], v[40:43], v[20:23], 0
    s_waitcnt lgkmcnt(8)
    v_mfma_f32_16x16x32_bf16 v[76:79], v[44:47], v[20:23], 0
    s_waitcnt lgkmcnt(6)
    v_mfma_f32_16x16x32_bf16 v[80:83], v[48:51], v[20:23], 0
    s_waitcnt lgkmcnt(4)
    v_mfma_f32_16x16x32_bf16 v[84:87], v[52:55], v[20:23], 0
    s_waitcnt lgkmcnt(2)
    v_mfma_f32_16x16x32_bf16 v[88:91], v[56:59], v[20:23], 0
    s_waitcnt lgkmcnt(0)
    v_mfma_f32_16x16x32_bf16 v[92:95], v[60:63], v[20:23], 0
    v_cvt_pk_bf16_f32 v96, v64, v65
    v_cvt_pk_bf16_f32 v97, v66, v67
    v_cvt_pk_bf16_f32 v98, v68, v69
    v_cvt_pk_bf16_f32 v99, v70, v71
    ds_write_b128 v144, v[96:99] offset:128
    v_cvt_pk_bf16_f32 v100, v72, v73
    v_cvt_pk_bf16_f32 v101, v74, v75
    v_cvt_pk_bf16_f32 v102, v76, v77
    v_cvt_pk_bf16_f32 v103, v78, v79
    ds_write_b128 v145, v[100:103] offset:128
    v_cvt_pk_bf16_f32 v104, v80, v81
    v_cvt_pk_bf16_f32 v105, v82, v83
    v_cvt_pk_bf16_f32 v106, v84, v85
    v_cvt_pk_bf16_f32 v107, v86, v87
    ds_write_b128 v146, v[104:107] offset:128
    v_cvt_pk_bf16_f32 v108, v88, v89
    v_cvt_pk_bf16_f32 v109, v90, v91
    v_cvt_pk_bf16_f32 v110, v92, v93
    v_cvt_pk_bf16_f32 v111, v94, v95
    ds_write_b128 v147, v[108:111] offset:128
    s_waitcnt vmcnt(0)
    ds_read_b64_tr_b16 v[32:33], v24 offset:12352
    ds_read_b64_tr_b16 v[34:35], v28 offset:12352
    ds_read_b64_tr_b16 v[36:37], v24 offset:12360
    ds_read_b64_tr_b16 v[38:39], v28 offset:12360
    ds_read_b64_tr_b16 v[40:41], v25 offset:12352
    ds_read_b64_tr_b16 v[42:43], v29 offset:12352
    ds_read_b64_tr_b16 v[44:45], v25 offset:12360
    ds_read_b64_tr_b16 v[46:47], v29 offset:12360
    ds_read_b64_tr_b16 v[48:49], v26 offset:12352
    ds_read_b64_tr_b16 v[50:51], v30 offset:12352
    ds_read_b64_tr_b16 v[52:53], v26 offset:12360
    ds_read_b64_tr_b16 v[54:55], v30 offset:12360
    ds_read_b64_tr_b16 v[56:57], v27 offset:12352
    ds_read_b64_tr_b16 v[58:59], v31 offset:12352
    ds_read_b64_tr_b16 v[60:61], v27 offset:12360
    ds_read_b64_tr_b16 v[62:63], v31 offset:12360
    s_waitcnt lgkmcnt(14)
    v_mfma_f32_16x16x32_bf16 v[64:67], v[32:35], v[20:23], 0
    s_waitcnt lgkmcnt(12)
    v_mfma_f32_16x16x32_bf16 v[68:71], v[36:39], v[20:23], 0
    s_waitcnt lgkmcnt(10)
    v_mfma_f32_16x16x32_bf16 v[72:75], v[40:43], v[20:23], 0
    s_waitcnt lgkmcnt(8)
    v_mfma_f32_16x16x32_bf16 v[76:79], v[44:47], v[20:23], 0
    s_waitcnt lgkmcnt(6)
    v_mfma_f32_16x16x32_bf16 v[80:83], v[48:51], v[20:23], 0
    s_waitcnt lgkmcnt(4)
    v_mfma_f32_16x16x32_bf16 v[84:87], v[52:55], v[20:23], 0
    s_waitcnt lgkmcnt(2)
    v_mfma_f32_16x16x32_bf16 v[88:91], v[56:59], v[20:23], 0
    s_waitcnt lgkmcnt(0)
    v_mfma_f32_16x16x32_bf16 v[92:95], v[60:63], v[20:23], 0
    v_cvt_pk_bf16_f32 v96, v64, v65
    v_cvt_pk_bf16_f32 v97, v66, v67
    v_cvt_pk_bf16_f32 v98, v68, v69
    v_cvt_pk_bf16_f32 v99, v70, v71
    ds_write_b128 v144, v[96:99] offset:12352
    v_cvt_pk_bf16_f32 v100, v72, v73
    v_cvt_pk_bf16_f32 v101, v74, v75
    v_cvt_pk_bf16_f32 v102, v76, v77
    v_cvt_pk_bf16_f32 v103, v78, v79
    ds_write_b128 v145, v[100:103] offset:12352
    v_cvt_pk_bf16_f32 v104, v80, v81
    v_cvt_pk_bf16_f32 v105, v82, v83
    v_cvt_pk_bf16_f32 v106, v84, v85
    v_cvt_pk_bf16_f32 v107, v86, v87
    ds_write_b128 v146, v[104:107] offset:12352
    v_cvt_pk_bf16_f32 v108, v88, v89
    v_cvt_pk_bf16_f32 v109, v90, v91
    v_cvt_pk_bf16_f32 v110, v92, v93
    v_cvt_pk_bf16_f32 v111, v94, v95
    ds_write_b128 v147, v[108:111] offset:12352
    ds_read_b128 v[112:115], v148 offset:0
    ds_read_b128 v[116:119], v149 offset:384
    ds_read_b128 v[120:123], v150 offset:768
    ds_read_b128 v[124:127], v151 offset:1152
    ds_read_b128 v[128:131], v148 offset:1536
    ds_read_b128 v[132:135], v149 offset:1920
    ds_read_b128 v[136:139], v150 offset:2304
    ds_read_b128 v[140:143], v151 offset:2688
    s_add_u32 s25, s24, 0
    s_waitcnt lgkmcnt(7)
    buffer_store_dwordx4 v[112:115], v152, s[16:19], s25 offen sc1
    s_add_u32 s25, s24, 16384
    s_waitcnt lgkmcnt(6)
    buffer_store_dwordx4 v[116:119], v152, s[16:19], s25 offen sc1
    s_add_u32 s25, s24, 98304
    s_waitcnt lgkmcnt(5)
    buffer_store_dwordx4 v[120:123], v152, s[16:19], s25 offen sc1
    s_add_u32 s25, s24, 114688
    s_waitcnt lgkmcnt(4)
    buffer_store_dwordx4 v[124:127], v152, s[16:19], s25 offen sc1
    s_add_u32 s25, s24, 196608
    s_waitcnt lgkmcnt(3)
    buffer_store_dwordx4 v[128:131], v152, s[16:19], s25 offen sc1
    s_add_u32 s25, s24, 212992
    s_waitcnt lgkmcnt(2)
    buffer_store_dwordx4 v[132:135], v152, s[16:19], s25 offen sc1
    s_add_u32 s25, s24, 294912
    s_waitcnt lgkmcnt(1)
    buffer_store_dwordx4 v[136:139], v152, s[16:19], s25 offen sc1
    s_add_u32 s25, s24, 311296
    s_waitcnt lgkmcnt(0)
    buffer_store_dwordx4 v[140:143], v152, s[16:19], s25 offen sc1
    ds_read_b64_tr_b16 v[32:33], v24 offset:12416
    ds_read_b64_tr_b16 v[34:35], v28 offset:12416
    ds_read_b64_tr_b16 v[36:37], v24 offset:12424
    ds_read_b64_tr_b16 v[38:39], v28 offset:12424
    ds_read_b64_tr_b16 v[40:41], v25 offset:12416
    ds_read_b64_tr_b16 v[42:43], v29 offset:12416
    ds_read_b64_tr_b16 v[44:45], v25 offset:12424
    ds_read_b64_tr_b16 v[46:47], v29 offset:12424
    ds_read_b64_tr_b16 v[48:49], v26 offset:12416
    ds_read_b64_tr_b16 v[50:51], v30 offset:12416
    ds_read_b64_tr_b16 v[52:53], v26 offset:12424
    ds_read_b64_tr_b16 v[54:55], v30 offset:12424
    ds_read_b64_tr_b16 v[56:57], v27 offset:12416
    ds_read_b64_tr_b16 v[58:59], v31 offset:12416
    ds_read_b64_tr_b16 v[60:61], v27 offset:12424
    ds_read_b64_tr_b16 v[62:63], v31 offset:12424
    s_waitcnt lgkmcnt(14)
    v_mfma_f32_16x16x32_bf16 v[64:67], v[32:35], v[20:23], 0
    s_waitcnt lgkmcnt(12)
    v_mfma_f32_16x16x32_bf16 v[68:71], v[36:39], v[20:23], 0
    s_waitcnt lgkmcnt(10)
    v_mfma_f32_16x16x32_bf16 v[72:75], v[40:43], v[20:23], 0
    s_waitcnt lgkmcnt(8)
    v_mfma_f32_16x16x32_bf16 v[76:79], v[44:47], v[20:23], 0
    s_waitcnt lgkmcnt(6)
    v_mfma_f32_16x16x32_bf16 v[80:83], v[48:51], v[20:23], 0
    s_waitcnt lgkmcnt(4)
    v_mfma_f32_16x16x32_bf16 v[84:87], v[52:55], v[20:23], 0
    s_waitcnt lgkmcnt(2)
    v_mfma_f32_16x16x32_bf16 v[88:91], v[56:59], v[20:23], 0
    s_waitcnt lgkmcnt(0)
    v_mfma_f32_16x16x32_bf16 v[92:95], v[60:63], v[20:23], 0
    v_cvt_pk_bf16_f32 v96, v64, v65
    v_cvt_pk_bf16_f32 v97, v66, v67
    v_cvt_pk_bf16_f32 v98, v68, v69
    v_cvt_pk_bf16_f32 v99, v70, v71
    ds_write_b128 v144, v[96:99] offset:12416
    v_cvt_pk_bf16_f32 v100, v72, v73
    v_cvt_pk_bf16_f32 v101, v74, v75
    v_cvt_pk_bf16_f32 v102, v76, v77
    v_cvt_pk_bf16_f32 v103, v78, v79
    ds_write_b128 v145, v[100:103] offset:12416
    v_cvt_pk_bf16_f32 v104, v80, v81
    v_cvt_pk_bf16_f32 v105, v82, v83
    v_cvt_pk_bf16_f32 v106, v84, v85
    v_cvt_pk_bf16_f32 v107, v86, v87
    ds_write_b128 v146, v[104:107] offset:12416
    v_cvt_pk_bf16_f32 v108, v88, v89
    v_cvt_pk_bf16_f32 v109, v90, v91
    v_cvt_pk_bf16_f32 v110, v92, v93
    v_cvt_pk_bf16_f32 v111, v94, v95
    ds_write_b128 v147, v[108:111] offset:12416
    ds_read_b128 v[112:115], v148 offset:64
    ds_read_b128 v[116:119], v149 offset:448
    ds_read_b128 v[120:123], v150 offset:832
    ds_read_b128 v[124:127], v151 offset:1216
    ds_read_b128 v[128:131], v148 offset:1600
    ds_read_b128 v[132:135], v149 offset:1984
    ds_read_b128 v[136:139], v150 offset:2368
    ds_read_b128 v[140:143], v151 offset:2752
    s_add_u32 s25, s24, 32768
    s_waitcnt lgkmcnt(7)
    buffer_store_dwordx4 v[112:115], v152, s[16:19], s25 offen sc1
    s_add_u32 s25, s24, 49152
    s_waitcnt lgkmcnt(6)
    buffer_store_dwordx4 v[116:119], v152, s[16:19], s25 offen sc1
    s_add_u32 s25, s24, 131072
    s_waitcnt lgkmcnt(5)
    buffer_store_dwordx4 v[120:123], v152, s[16:19], s25 offen sc1
    s_add_u32 s25, s24, 147456
    s_waitcnt lgkmcnt(4)
    buffer_store_dwordx4 v[124:127], v152, s[16:19], s25 offen sc1
    s_add_u32 s25, s24, 229376
    s_waitcnt lgkmcnt(3)
    buffer_store_dwordx4 v[128:131], v152, s[16:19], s25 offen sc1
    s_add_u32 s25, s24, 245760
    s_waitcnt lgkmcnt(2)
    buffer_store_dwordx4 v[132:135], v152, s[16:19], s25 offen sc1
    s_add_u32 s25, s24, 327680
    s_waitcnt lgkmcnt(1)
    buffer_store_dwordx4 v[136:139], v152, s[16:19], s25 offen sc1
    s_add_u32 s25, s24, 344064
    s_waitcnt lgkmcnt(0)
    buffer_store_dwordx4 v[140:143], v152, s[16:19], s25 offen sc1
    ds_read_b64_tr_b16 v[32:33], v24 offset:12480
    ds_read_b64_tr_b16 v[34:35], v28 offset:12480
    ds_read_b64_tr_b16 v[36:37], v24 offset:12488
    ds_read_b64_tr_b16 v[38:39], v28 offset:12488
    ds_read_b64_tr_b16 v[40:41], v25 offset:12480
    ds_read_b64_tr_b16 v[42:43], v29 offset:12480
    ds_read_b64_tr_b16 v[44:45], v25 offset:12488
    ds_read_b64_tr_b16 v[46:47], v29 offset:12488
    ds_read_b64_tr_b16 v[48:49], v26 offset:12480
    ds_read_b64_tr_b16 v[50:51], v30 offset:12480
    ds_read_b64_tr_b16 v[52:53], v26 offset:12488
    ds_read_b64_tr_b16 v[54:55], v30 offset:12488
    ds_read_b64_tr_b16 v[56:57], v27 offset:12480
    ds_read_b64_tr_b16 v[58:59], v31 offset:12480
    ds_read_b64_tr_b16 v[60:61], v27 offset:12488
    ds_read_b64_tr_b16 v[62:63], v31 offset:12488
    s_waitcnt lgkmcnt(14)
    v_mfma_f32_16x16x32_bf16 v[64:67], v[32:35], v[20:23], 0
    s_waitcnt lgkmcnt(12)
    v_mfma_f32_16x16x32_bf16 v[68:71], v[36:39], v[20:23], 0
    s_waitcnt lgkmcnt(10)
    v_mfma_f32_16x16x32_bf16 v[72:75], v[40:43], v[20:23], 0
    s_waitcnt lgkmcnt(8)
    v_mfma_f32_16x16x32_bf16 v[76:79], v[44:47], v[20:23], 0
    s_waitcnt lgkmcnt(6)
    v_mfma_f32_16x16x32_bf16 v[80:83], v[48:51], v[20:23], 0
    s_waitcnt lgkmcnt(4)
    v_mfma_f32_16x16x32_bf16 v[84:87], v[52:55], v[20:23], 0
    s_waitcnt lgkmcnt(2)
    v_mfma_f32_16x16x32_bf16 v[88:91], v[56:59], v[20:23], 0
    s_waitcnt lgkmcnt(0)
    v_mfma_f32_16x16x32_bf16 v[92:95], v[60:63], v[20:23], 0
    v_cvt_pk_bf16_f32 v96, v64, v65
    v_cvt_pk_bf16_f32 v97, v66, v67
    v_cvt_pk_bf16_f32 v98, v68, v69
    v_cvt_pk_bf16_f32 v99, v70, v71
    ds_write_b128 v144, v[96:99] offset:12480
    v_cvt_pk_bf16_f32 v100, v72, v73
    v_cvt_pk_bf16_f32 v101, v74, v75
    v_cvt_pk_bf16_f32 v102, v76, v77
    v_cvt_pk_bf16_f32 v103, v78, v79
    ds_write_b128 v145, v[100:103] offset:12480
    v_cvt_pk_bf16_f32 v104, v80, v81
    v_cvt_pk_bf16_f32 v105, v82, v83
    v_cvt_pk_bf16_f32 v106, v84, v85
    v_cvt_pk_bf16_f32 v107, v86, v87
    ds_write_b128 v146, v[104:107] offset:12480
    v_cvt_pk_bf16_f32 v108, v88, v89
    v_cvt_pk_bf16_f32 v109, v90, v91
    v_cvt_pk_bf16_f32 v110, v92, v93
    v_cvt_pk_bf16_f32 v111, v94, v95
    ds_write_b128 v147, v[108:111] offset:12480
    ds_read_b128 v[112:115], v148 offset:128
    ds_read_b128 v[116:119], v149 offset:512
    ds_read_b128 v[120:123], v150 offset:896
    ds_read_b128 v[124:127], v151 offset:1280
    ds_read_b128 v[128:131], v148 offset:1664
    ds_read_b128 v[132:135], v149 offset:2048
    ds_read_b128 v[136:139], v150 offset:2432
    ds_read_b128 v[140:143], v151 offset:2816
    s_add_u32 s25, s24, 65536
    s_waitcnt lgkmcnt(7)
    buffer_store_dwordx4 v[112:115], v152, s[16:19], s25 offen sc1
    s_add_u32 s25, s24, 81920
    s_waitcnt lgkmcnt(6)
    buffer_store_dwordx4 v[116:119], v152, s[16:19], s25 offen sc1
    s_add_u32 s25, s24, 163840
    s_waitcnt lgkmcnt(5)
    buffer_store_dwordx4 v[120:123], v152, s[16:19], s25 offen sc1
    s_add_u32 s25, s24, 180224
    s_waitcnt lgkmcnt(4)
    buffer_store_dwordx4 v[124:127], v152, s[16:19], s25 offen sc1
    s_add_u32 s25, s24, 262144
    s_waitcnt lgkmcnt(3)
    buffer_store_dwordx4 v[128:131], v152, s[16:19], s25 offen sc1
    s_add_u32 s25, s24, 278528
    s_waitcnt lgkmcnt(2)
    buffer_store_dwordx4 v[132:135], v152, s[16:19], s25 offen sc1
    s_add_u32 s25, s24, 360448
    s_waitcnt lgkmcnt(1)
    buffer_store_dwordx4 v[136:139], v152, s[16:19], s25 offen sc1
    s_add_u32 s25, s24, 376832
    s_waitcnt lgkmcnt(0)
    buffer_store_dwordx4 v[140:143], v152, s[16:19], s25 offen sc1
    s_endpgm
K1_w:
    s_sub_u32 s20, s2, 672
    s_and_b32 s21, s20, 3
    s_lshr_b32 s22, s20, 2
    s_mul_i32 s23, s22, 43
    s_lshr_b32 s23, s23, 8
    s_mul_i32 s24, s23, 6
    s_sub_u32 s24, s22, s24
    s_mul_i32 s25, s23, 86
    s_lshr_b32 s25, s25, 8
    s_mul_i32 s26, s25, 3
    s_sub_u32 s26, s23, s26
    v_lshrrev_b32 v2, 1, v0
    v_mul_u32_u24 v2, 192, v2
    v_and_b32 v3, 1, v0
    v_lshl_add_u32 v2, v3, 4, v2
    s_mul_i32 s27, s25, 129024
    s_mul_i32 s28, s26, 6144
    s_add_u32 s27, s27, s28
    s_lshl_b32 s28, s24, 5
    s_add_u32 s27, s27, s28
    s_waitcnt lgkmcnt(0)
    s_mov_b32 s12, s6
    s_and_b32 s13, s7, 0xffff
    s_mov_b32 s14, 903168
    s_mov_b32 s15, 0x00020000
    s_mov_b32 m0, 0
    s_add_u32 s28, s27, 0
    buffer_load_dwordx4 v2, s[12:15], s28 offen lds
    s_mov_b32 m0, 1024
    s_add_u32 s28, s27, 18432
    buffer_load_dwordx4 v2, s[12:15], s28 offen lds
    s_mov_b32 m0, 2048
    s_add_u32 s28, s27, 36864
    buffer_load_dwordx4 v2, s[12:15], s28 offen lds
    s_mov_b32 m0, 3072
    s_add_u32 s28, s27, 55296
    buffer_load_dwordx4 v2, s[12:15], s28 offen lds
    s_mov_b32 m0, 4096
    s_add_u32 s28, s27, 73728
    buffer_load_dwordx4 v2, s[12:15], s28 offen lds
    s_mov_b32 m0, 5120
    s_add_u32 s28, s27, 92160
    buffer_load_dwordx4 v2, s[12:15], s28 offen lds
    s_mov_b32 m0, 6144
    s_add_u32 s28, s27, 110592
    buffer_load_dwordx4 v2, s[12:15], s28 offen lds
    v_lshrrev_b32 v3, 4, v0
    v_bfe_u32 v4, v0, 2, 2
    v_lshl_add_u32 v3, v3, 3, v4
    v_and_b32 v4, 3, v0
    v_lshlrev_b32 v4, 3, v4
    v_lshl_add_u32 v3, v3, 5, v4
    v_lshlrev_b32 v1, 4, v0
    s_lshl_b32 s28, s24, 2
    s_add_u32 s28, s28, s21
    s_mul_i32 s28, s28, 3
    s_add_u32 s28, s28, s26
    s_mul_i32 s28, s28, 28
    s_add_u32 s28, s28, s25
    s_lshl_b32 s28, s28, 10
    s_add_u32 s16, s8, 16515072
    s_addc_u32 s17, s9, 0
    s_and_b32 s17, s17, 0xffff
    s_mov_b32 s18, 2064384
    s_mov_b32 s19, 0x00020000
    s_waitcnt vmcnt(6)
    ds_read_b64_tr_b16 v[8:9], v3 offset:0
    ds_read_b64_tr_b16 v[10:11], v3 offset:128
    s_waitcnt vmcnt(5)
    ds_read_b64_tr_b16 v[12:13], v3 offset:1024
    ds_read_b64_tr_b16 v[14:15], v3 offset:1152
    s_waitcnt vmcnt(4)
    ds_read_b64_tr_b16 v[16:17], v3 offset:2048
    ds_read_b64_tr_b16 v[18:19], v3 offset:2176
    s_waitcnt vmcnt(3)
    ds_read_b64_tr_b16 v[20:21], v3 offset:3072
    ds_read_b64_tr_b16 v[22:23], v3 offset:3200
    s_waitcnt vmcnt(2)
    ds_read_b64_tr_b16 v[24:25], v3 offset:4096
    ds_read_b64_tr_b16 v[26:27], v3 offset:4224
    s_waitcnt vmcnt(1)
    ds_read_b64_tr_b16 v[28:29], v3 offset:5120
    ds_read_b64_tr_b16 v[30:31], v3 offset:5248
    s_waitcnt vmcnt(0)
    ds_read_b64_tr_b16 v[32:33], v3 offset:6144
    ds_read_b64_tr_b16 v[34:35], v3 offset:6272
    s_waitcnt lgkmcnt(13)
    v_lshlrev_b32 v40, 16, v8
    v_and_b32 v41, 0xffff0000, v8
    v_lshlrev_b32 v42, 16, v9
    v_and_b32 v43, 0xffff0000, v9
    s_waitcnt lgkmcnt(12)
    v_lshlrev_b32 v44, 16, v10
    v_and_b32 v45, 0xffff0000, v10
    v_lshlrev_b32 v46, 16, v11
    v_and_b32 v47, 0xffff0000, v11
    s_waitcnt lgkmcnt(11)
    v_lshlrev_b32 v48, 16, v12
    v_and_b32 v49, 0xffff0000, v12
    v_lshlrev_b32 v50, 16, v13
    v_and_b32 v51, 0xffff0000, v13
    s_waitcnt lgkmcnt(10)
    v_lshlrev_b32 v52, 16, v14
    v_and_b32 v53, 0xffff0000, v14
    v_lshlrev_b32 v54, 16, v15
    v_and_b32 v55, 0xffff0000, v15
    s_waitcnt lgkmcnt(9)
    v_lshlrev_b32 v56, 16, v16
    v_and_b32 v57, 0xffff0000, v16
    v_lshlrev_b32 v58, 16, v17
    v_and_b32 v59, 0xffff0000, v17
    s_waitcnt lgkmcnt(8)
    v_lshlrev_b32 v60, 16, v18
    v_and_b32 v61, 0xffff0000, v18
    v_lshlrev_b32 v62, 16, v19
    v_and_b32 v63, 0xffff0000, v19
    s_waitcnt lgkmcnt(7)
    v_lshlrev_b32 v64, 16, v20
    v_and_b32 v65, 0xffff0000, v20
    v_lshlrev_b32 v66, 16, v21
    v_and_b32 v67, 0xffff0000, v21
    s_waitcnt lgkmcnt(6)
    v_lshlrev_b32 v68, 16, v22
    v_and_b32 v69, 0xffff0000, v22
    v_lshlrev_b32 v70, 16, v23
    v_and_b32 v71, 0xffff0000, v23
    s_waitcnt lgkmcnt(5)
    v_lshlrev_b32 v72, 16, v24
    v_and_b32 v73, 0xffff0000, v24
    v_lshlrev_b32 v74, 16, v25
    v_and_b32 v75, 0xffff0000, v25
    s_waitcnt lgkmcnt(4)
    v_lshlrev_b32 v76, 16, v26
    v_and_b32 v77, 0xffff0000, v26
    v_lshlrev_b32 v78, 16, v27
    v_and_b32 v79, 0xffff0000, v27
    s_waitcnt lgkmcnt(3)
    v_lshlrev_b32 v80, 16, v28
    v_and_b32 v81, 0xffff0000, v28
    v_lshlrev_b32 v82, 16, v29
    v_and_b32 v83, 0xffff0000, v29
    s_waitcnt lgkmcnt(2)
    v_lshlrev_b32 v84, 16, v30
    v_and_b32 v85, 0xffff0000, v30
    v_lshlrev_b32 v86, 16, v31
    v_and_b32 v87, 0xffff0000, v31
    s_waitcnt lgkmcnt(1)
    v_lshlrev_b32 v88, 16, v32
    v_and_b32 v89, 0xffff0000, v32
    v_lshlrev_b32 v90, 16, v33
    v_and_b32 v91, 0xffff0000, v33
    s_waitcnt lgkmcnt(0)
    v_lshlrev_b32 v92, 16, v34
    v_and_b32 v93, 0xffff0000, v34
    v_lshlrev_b32 v94, 16, v35
    v_and_b32 v95, 0xffff0000, v35
    s_cmp_eq_u32 s21, 1
    s_cbranch_scc1 K1_w1
    s_cmp_eq_u32 s21, 2
    s_cbranch_scc1 K1_w2
    s_cmp_eq_u32 s21, 3
    s_cbranch_scc1 K1_w3
    v_mul_f32 v96, 0x3d373462, v40
    v_mul_f32 v97, 0x3d373462, v41
    v_mul_f32 v98, 0x3d373462, v42
    v_mul_f32 v99, 0x3d373462, v43
    v_mul_f32 v100, 0x3d373462, v44
    v_mul_f32 v101, 0x3d373462, v45
    v_mul_f32 v102, 0x3d373462, v46
    v_mul_f32 v103, 0x3d373462, v47
    v_fmac_f32 v96, 0xbeb38c1b, v48
    v_fmac_f32 v97, 0xbeb38c1b, v49
    v_fmac_f32 v98, 0xbeb38c1b, v50
    v_fmac_f32 v99, 0xbeb38c1b, v51
    v_fmac_f32 v100, 0xbeb38c1b, v52
    v_fmac_f32 v101, 0xbeb38c1b, v53
    v_fmac_f32 v102, 0xbeb38c1b, v54
    v_fmac_f32 v103, 0xbeb38c1b, v55
    v_fmac_f32 v96, 0xbf089fd8, v56
    v_fmac_f32 v97, 0xbf089fd8, v57
    v_fmac_f32 v98, 0xbf089fd8, v58
    v_fmac_f32 v99, 0xbf089fd8, v59
    v_fmac_f32 v100, 0xbf089fd8, v60
    v_fmac_f32 v101, 0xbf089fd8, v61
    v_fmac_f32 v102, 0xbf089fd8, v62
    v_fmac_f32 v103, 0xbf089fd8, v63
    v_fmac_f32 v96, 0xbec973a6, v64
    v_fmac_f32 v97, 0xbec973a6, v65
    v_fmac_f32 v98, 0xbec973a6, v66
    v_fmac_f32 v99, 0xbec973a6, v67
    v_fmac_f32 v100, 0xbec973a6, v68
    v_fmac_f32 v101, 0xbec973a6, v69
    v_fmac_f32 v102, 0xbec973a6, v70
    v_fmac_f32 v103, 0xbec973a6, v71
    v_fmac_f32 v96, 0xbc7486ea, v72
    v_fmac_f32 v97, 0xbc7486ea, v73
    v_fmac_f32 v98, 0xbc7486ea, v74
    v_fmac_f32 v99, 0xbc7486ea, v75
    v_fmac_f32 v100, 0xbc7486ea, v76
    v_fmac_f32 v101, 0xbc7486ea, v77
    v_fmac_f32 v102, 0xbc7486ea, v78
    v_fmac_f32 v103, 0xbc7486ea, v79
    v_fmac_f32 v96, 0x3ebecc09, v80
    v_fmac_f32 v97, 0x3ebecc09, v81
    v_fmac_f32 v98, 0x3ebecc09, v82
    v_fmac_f32 v99, 0x3ebecc09, v83
    v_fmac_f32 v100, 0x3ebecc09, v84
    v_fmac_f32 v101, 0x3ebecc09, v85
    v_fmac_f32 v102, 0x3ebecc09, v86
    v_fmac_f32 v103, 0x3ebecc09, v87
    v_fmac_f32 v96, 0x3f08d677, v88
    v_fmac_f32 v97, 0x3f08d677, v89
    v_fmac_f32 v98, 0x3f08d677, v90
    v_fmac_f32 v99, 0x3f08d677, v91
    v_fmac_f32 v100, 0x3f08d677, v92
    v_fmac_f32 v101, 0x3f08d677, v93
    v_fmac_f32 v102, 0x3f08d677, v94
    v_fmac_f32 v103, 0x3f08d677, v95
    v_cvt_pk_bf16_f32 v112, v96, v97
    v_cvt_pk_bf16_f32 v113, v98, v99
    v_cvt_pk_bf16_f32 v114, v100, v101
    v_cvt_pk_bf16_f32 v115, v102, v103
    s_add_u32 s29, s28, 0
    buffer_store_dwordx4 v[112:115], v1, s[16:19], s29 offen sc1
    v_mul_f32 v104, 0xbf085b9c, v40
    v_mul_f32 v105, 0xbf085b9c, v41
    v_mul_f32 v106, 0xbf085b9c, v42
    v_mul_f32 v107, 0xbf085b9c, v43
    v_mul_f32 v108, 0xbf085b9c, v44
    v_mul_f32 v109, 0xbf085b9c, v45
    v_mul_f32 v110, 0xbf085b9c, v46
    v_mul_f32 v111, 0xbf085b9c, v47
    v_fmac_f32 v104, 0xbece8ba8, v48
    v_fmac_f32 v105, 0xbece8ba8, v49
    v_fmac_f32 v106, 0xbece8ba8, v50
    v_fmac_f32 v107, 0xbece8ba8, v51
    v_fmac_f32 v108, 0xbece8ba8, v52
    v_fmac_f32 v109, 0xbece8ba8, v53
    v_fmac_f32 v110, 0xbece8ba8, v54
    v_fmac_f32 v111, 0xbece8ba8, v55
    v_fmac_f32 v104, 0xbcf46e81, v56
    v_fmac_f32 v105, 0xbcf46e81, v57
    v_fmac_f32 v106, 0xbcf46e81, v58
    v_fmac_f32 v107, 0xbcf46e81, v59
    v_fmac_f32 v108, 0xbcf46e81, v60
    v_fmac_f32 v109, 0xbcf46e81, v61
    v_fmac_f32 v110, 0xbcf46e81, v62
    v_fmac_f32 v111, 0xbcf46e81, v63
    v_fmac_f32 v104, 0x3eb93e90, v64
    v_fmac_f32 v105, 0x3eb93e90, v65
    v_fmac_f32 v106, 0x3eb93e90, v66
    v_fmac_f32 v107, 0x3eb93e90, v67
    v_fmac_f32 v108, 0x3eb93e90, v68
    v_fmac_f32 v109, 0x3eb93e90, v69
    v_fmac_f32 v110, 0x3eb93e90, v70
    v_fmac_f32 v111, 0x3eb93e90, v71
    v_fmac_f32 v104, 0x3f08c8cf, v72
    v_fmac_f32 v105, 0x3f08c8cf, v73
    v_fmac_f32 v106, 0x3f08c8cf, v74
    v_fmac_f32 v107, 0x3f08c8cf, v75
    v_fmac_f32 v108, 0x3f08c8cf, v76
    v_fmac_f32 v109, 0x3f08c8cf, v77
    v_fmac_f32 v110, 0x3f08c8cf, v78
    v_fmac_f32 v111, 0x3f08c8cf, v79
    v_fmac_f32 v104, 0x3ec4336d, v80
    v_fmac_f32 v105, 0x3ec4336d, v81
    v_fmac_f32 v106, 0x3ec4336d, v82
    v_fmac_f32 v107, 0x3ec4336d, v83
    v_fmac_f32 v108, 0x3ec4336d, v84
    v_fmac_f32 v109, 0x3ec4336d, v85
    v_fmac_f32 v110, 0x3ec4336d, v86
    v_fmac_f32 v111, 0x3ec4336d, v87
    v_cvt_pk_bf16_f32 v116, v104, v105
    v_cvt_pk_bf16_f32 v117, v106, v107
    v_cvt_pk_bf16_f32 v118, v108, v109
    v_cvt_pk_bf16_f32 v119, v110, v111
    s_add_u32 s29, s28, 7168
    buffer_store_dwordx4 v[116:119], v1, s[16:19], s29 offen sc1
    v_mul_f32 v96, 0x3f800000, v88
    v_mul_f32 v97, 0x3f800000, v89
    v_mul_f32 v98, 0x3f800000, v90
    v_mul_f32 v99, 0x3f800000, v91
    v_mul_f32 v100, 0x3f800000, v92
    v_mul_f32 v101, 0x3f800000, v93
    v_mul_f32 v102, 0x3f800000, v94
    v_mul_f32 v103, 0x3f800000, v95
    v_cvt_pk_bf16_f32 v120, v96, v97
    v_cvt_pk_bf16_f32 v121, v98, v99
    v_cvt_pk_bf16_f32 v122, v100, v101
    v_cvt_pk_bf16_f32 v123, v102, v103
    s_add_u32 s29, s28, 14336
    buffer_store_dwordx4 v[120:123], v1, s[16:19], s29 offen sc1
    v_mul_f32 v104, 0x3f800000, v40
    v_mul_f32 v105, 0x3f800000, v41
    v_mul_f32 v106, 0x3f800000, v42
    v_mul_f32 v107, 0x3f800000, v43
    v_mul_f32 v108, 0x3f800000, v44
    v_mul_f32 v109, 0x3f800000, v45
    v_mul_f32 v110, 0x3f800000, v46
    v_mul_f32 v111, 0x3f800000, v47
    v_cvt_pk_bf16_f32 v124, v104, v105
    v_cvt_pk_bf16_f32 v125, v106, v107
    v_cvt_pk_bf16_f32 v126, v108, v109
    v_cvt_pk_bf16_f32 v127, v110, v111
    s_add_u32 s29, s28, 21504
    buffer_store_dwordx4 v[124:127], v1, s[16:19], s29 offen sc1
    s_endpgm
K1_w1:
    v_mul_f32 v96, 0xbd09794c, v40
    v_mul_f32 v97, 0xbd09794c, v41
    v_mul_f32 v98, 0xbd09794c, v42
    v_mul_f32 v99, 0xbd09794c, v43
    v_mul_f32 v100, 0xbd09794c, v44
    v_mul_f32 v101, 0xbd09794c, v45
    v_mul_f32 v102, 0xbd09794c, v46
    v_mul_f32 v103, 0xbd09794c, v47
    v_fmac_f32 v96, 0x3f0223f4, v48
    v_fmac_f32 v97, 0x3f0223f4, v49
    v_fmac_f32 v98, 0x3f0223f4, v50
    v_fmac_f32 v99, 0x3f0223f4, v51
    v_fmac_f32 v100, 0x3f0223f4, v52
    v_fmac_f32 v101, 0x3f0223f4, v53
    v_fmac_f32 v102, 0x3f0223f4, v54
    v_fmac_f32 v103, 0x3f0223f4, v55
    v_fmac_f32 v96, 0x3e92a486, v56
    v_fmac_f32 v97, 0x3e92a486, v57
    v_fmac_f32 v98, 0x3e92a486, v58
    v_fmac_f32 v99, 0x3e92a486, v59
    v_fmac_f32 v100, 0x3e92a486, v60
    v_fmac_f32 v101, 0x3e92a486, v61
    v_fmac_f32 v102, 0x3e92a486, v62
    v_fmac_f32 v103, 0x3e92a486, v63
    v_fmac_f32 v96, 0xbebb5802, v64
    v_fmac_f32 v97, 0xbebb5802, v65
    v_fmac_f32 v98, 0xbebb5802, v66
    v_fmac_f32 v99, 0xbebb5802, v67
    v_fmac_f32 v100, 0xbebb5802, v68
    v_fmac_f32 v101, 0xbebb5802, v69
    v_fmac_f32 v102, 0xbebb5802, v70
    v_fmac_f32 v103, 0xbebb5802, v71
    v_fmac_f32 v96, 0xbeefd2dd, v72
    v_fmac_f32 v97, 0xbeefd2dd, v73
    v_fmac_f32 v98, 0xbeefd2dd, v74
    v_fmac_f32 v99, 0xbeefd2dd, v75
    v_fmac_f32 v100, 0xbeefd2dd, v76
    v_fmac_f32 v101, 0xbeefd2dd, v77
    v_fmac_f32 v102, 0xbeefd2dd, v78
    v_fmac_f32 v103, 0xbeefd2dd, v79
    v_fmac_f32 v96, 0x3e081ee4, v80
    v_fmac_f32 v97, 0x3e081ee4, v81
    v_fmac_f32 v98, 0x3e081ee4, v82
    v_fmac_f32 v99, 0x3e081ee4, v83
    v_fmac_f32 v100, 0x3e081ee4, v84
    v_fmac_f32 v101, 0x3e081ee4, v85
    v_fmac_f32 v102, 0x3e081ee4, v86
    v_fmac_f32 v103, 0x3e081ee4, v87
    v_fmac_f32 v96, 0x3f08d677, v88
    v_fmac_f32 v97, 0x3f08d677, v89
    v_fmac_f32 v98, 0x3f08d677, v90
    v_fmac_f32 v99, 0x3f08d677, v91
    v_fmac_f32 v100, 0x3f08d677, v92
    v_fmac_f32 v101, 0x3f08d677, v93
    v_fmac_f32 v102, 0x3f08d677, v94
    v_fmac_f32 v103, 0x3f08d677, v95
    v_cvt_pk_bf16_f32 v112, v96, v97
    v_cvt_pk_bf16_f32 v113, v98, v99
    v_cvt_pk_bf16_f32 v114, v100, v101
    v_cvt_pk_bf16_f32 v115, v102, v103
    s_add_u32 s29, s28, 0
    buffer_store_dwordx4 v[112:115], v1, s[16:19], s29 offen sc1
    v_mul_f32 v104, 0x3f089157, v40
    v_mul_f32 v105, 0x3f089157, v41
    v_mul_f32 v106, 0x3f089157, v42
    v_mul_f32 v107, 0x3f089157, v43
    v_mul_f32 v108, 0x3f089157, v44
    v_mul_f32 v109, 0x3f089157, v45
    v_mul_f32 v110, 0x3f089157, v46
    v_mul_f32 v111, 0x3f089157, v47
    v_fmac_f32 v104, 0x3e292409, v48
    v_fmac_f32 v105, 0x3e292409, v49
    v_fmac_f32 v106, 0x3e292409, v50
    v_fmac_f32 v107, 0x3e292409, v51
    v_fmac_f32 v108, 0x3e292409, v52
    v_fmac_f32 v109, 0x3e292409, v53
    v_fmac_f32 v110, 0x3e292409, v54
    v_fmac_f32 v111, 0x3e292409, v55
    v_fmac_f32 v104, 0xbee71267, v56
    v_fmac_f32 v105, 0xbee71267, v57
    v_fmac_f32 v106, 0xbee71267, v58
    v_fmac_f32 v107, 0xbee71267, v59
    v_fmac_f32 v108, 0xbee71267, v60
    v_fmac_f32 v109, 0xbee71267, v61
    v_fmac_f32 v110, 0xbee71267, v62
    v_fmac_f32 v111, 0xbee71267, v63
    v_fmac_f32 v104, 0xbec78039, v64
    v_fmac_f32 v105, 0xbec78039, v65
    v_fmac_f32 v106, 0xbec78039, v66
    v_fmac_f32 v107, 0xbec78039, v67
    v_fmac_f32 v108, 0xbec78039, v68
    v_fmac_f32 v109, 0xbec78039, v69
    v_fmac_f32 v110, 0xbec78039, v70
    v_fmac_f32 v111, 0xbec78039, v71
    v_fmac_f32 v104, 0x3e83d81c, v72
    v_fmac_f32 v105, 0x3e83d81c, v73
    v_fmac_f32 v106, 0x3e83d81c, v74
    v_fmac_f32 v107, 0x3e83d81c, v75
    v_fmac_f32 v108, 0x3e83d81c, v76
    v_fmac_f32 v109, 0x3e83d81c, v77
    v_fmac_f32 v110, 0x3e83d81c, v78
    v_fmac_f32 v111, 0x3e83d81c, v79
    v_fmac_f32 v104, 0x3f0489eb, v80
    v_fmac_f32 v105, 0x3f0489eb, v81
    v_fmac_f32 v106, 0x3f0489eb, v82
    v_fmac_f32 v107, 0x3f0489eb, v83
    v_fmac_f32 v108, 0x3f0489eb, v84
    v_fmac_f32 v109, 0x3f0489eb, v85
    v_fmac_f32 v110, 0x3f0489eb, v86
    v_fmac_f32 v111, 0x3f0489eb, v87
    v_cvt_pk_bf16_f32 v116, v104, v105
    v_cvt_pk_bf16_f32 v117, v106, v107
    v_cvt_pk_bf16_f32 v118, v108, v109
    v_cvt_pk_bf16_f32 v119, v110, v111
    s_add_u32 s29, s28, 7168
    buffer_store_dwordx4 v[116:119], v1, s[16:19], s29 offen sc1
    v_mul_f32 v96, 0x3ec1848f, v40
    v_mul_f32 v97, 0x3ec1848f, v41
    v_mul_f32 v98, 0x3ec1848f, v42
    v_mul_f32 v99, 0x3ec1848f, v43
    v_mul_f32 v100, 0x3ec1848f, v44
    v_mul_f32 v101, 0x3ec1848f, v45
    v_mul_f32 v102, 0x3ec1848f, v46
    v_mul_f32 v103, 0x3ec1848f, v47
    v_fmac_f32 v96, 0x3ec1848f, v48
    v_fmac_f32 v97, 0x3ec1848f, v49
    v_fmac_f32 v98, 0x3ec1848f, v50
    v_fmac_f32 v99, 0x3ec1848f, v51
    v_fmac_f32 v100, 0x3ec1848f, v52
    v_fmac_f32 v101, 0x3ec1848f, v53
    v_fmac_f32 v102, 0x3ec1848f, v54
    v_fmac_f32 v103, 0x3ec1848f, v55
    v_fmac_f32 v96, 0x3ec1848f, v56
    v_fmac_f32 v97, 0x3ec1848f, v57
    v_fmac_f32 v98, 0x3ec1848f, v58
    v_fmac_f32 v99, 0x3ec1848f, v59
    v_fmac_f32 v100, 0x3ec1848f, v60
    v_fmac_f32 v101, 0x3ec1848f, v61
    v_fmac_f32 v102, 0x3ec1848f, v62
    v_fmac_f32 v103, 0x3ec1848f, v63
    v_fmac_f32 v96, 0x3ec1848f, v64
    v_fmac_f32 v97, 0x3ec1848f, v65
    v_fmac_f32 v98, 0x3ec1848f, v66
    v_fmac_f32 v99, 0x3ec1848f, v67
    v_fmac_f32 v100, 0x3ec1848f, v68
    v_fmac_f32 v101, 0x3ec1848f, v69
    v_fmac_f32 v102, 0x3ec1848f, v70
    v_fmac_f32 v103, 0x3ec1848f, v71
    v_fmac_f32 v96, 0x3ec1848f, v72
    v_fmac_f32 v97, 0x3ec1848f, v73
    v_fmac_f32 v98, 0x3ec1848f, v74
    v_fmac_f32 v99, 0x3ec1848f, v75
    v_fmac_f32 v100, 0x3ec1848f, v76
    v_fmac_f32 v101, 0x3ec1848f, v77
    v_fmac_f32 v102, 0x3ec1848f, v78
    v_fmac_f32 v103, 0x3ec1848f, v79
    v_fmac_f32 v96, 0x3ec1848f, v80
    v_fmac_f32 v97, 0x3ec1848f, v81
    v_fmac_f32 v98, 0x3ec1848f, v82
    v_fmac_f32 v99, 0x3ec1848f, v83
    v_fmac_f32 v100, 0x3ec1848f, v84
    v_fmac_f32 v101, 0x3ec1848f, v85
    v_fmac_f32 v102, 0x3ec1848f, v86
    v_fmac_f32 v103, 0x3ec1848f, v87
    v_fmac_f32 v96, 0x3ec1848f, v88
    v_fmac_f32 v97, 0x3ec1848f, v89
    v_fmac_f32 v98, 0x3ec1848f, v90
    v_fmac_f32 v99, 0x3ec1848f, v91
    v_fmac_f32 v100, 0x3ec1848f, v92
    v_fmac_f32 v101, 0x3ec1848f, v93
    v_fmac_f32 v102, 0x3ec1848f, v94
    v_fmac_f32 v103, 0x3ec1848f, v95
    v_cvt_pk_bf16_f32 v120, v96, v97
    v_cvt_pk_bf16_f32 v121, v98, v99
    v_cvt_pk_bf16_f32 v122, v100, v101
    v_cvt_pk_bf16_f32 v123, v102, v103
    s_add_u32 s29, s28, 14336
    buffer_store_dwordx4 v[120:123], v1, s[16:19], s29 offen sc1
    v_mul_f32 v104, 0x3ec1848f, v40
    v_mul_f32 v105, 0x3ec1848f, v41
    v_mul_f32 v106, 0x3ec1848f, v42
    v_mul_f32 v107, 0x3ec1848f, v43
    v_mul_f32 v108, 0x3ec1848f, v44
    v_mul_f32 v109, 0x3ec1848f, v45
    v_mul_f32 v110, 0x3ec1848f, v46
    v_mul_f32 v111, 0x3ec1848f, v47
    v_fmac_f32 v104, 0xbec1848f, v48
    v_fmac_f32 v105, 0xbec1848f, v49
    v_fmac_f32 v106, 0xbec1848f, v50
    v_fmac_f32 v107, 0xbec1848f, v51
    v_fmac_f32 v108, 0xbec1848f, v52
    v_fmac_f32 v109, 0xbec1848f, v53
    v_fmac_f32 v110, 0xbec1848f, v54
    v_fmac_f32 v111, 0xbec1848f, v55
    v_fmac_f32 v104, 0x3ec1848f, v56
    v_fmac_f32 v105, 0x3ec1848f, v57
    v_fmac_f32 v106, 0x3ec1848f, v58
    v_fmac_f32 v107, 0x3ec1848f, v59
    v_fmac_f32 v108, 0x3ec1848f, v60
    v_fmac_f32 v109, 0x3ec1848f, v61
    v_fmac_f32 v110, 0x3ec1848f, v62
    v_fmac_f32 v111, 0x3ec1848f, v63
    v_fmac_f32 v104, 0xbec1848f, v64
    v_fmac_f32 v105, 0xbec1848f, v65
    v_fmac_f32 v106, 0xbec1848f, v66
    v_fmac_f32 v107, 0xbec1848f, v67
    v_fmac_f32 v108, 0xbec1848f, v68
    v_fmac_f32 v109, 0xbec1848f, v69
    v_fmac_f32 v110, 0xbec1848f, v70
    v_fmac_f32 v111, 0xbec1848f, v71
    v_fmac_f32 v104, 0x3ec1848f, v72
    v_fmac_f32 v105, 0x3ec1848f, v73
    v_fmac_f32 v106, 0x3ec1848f, v74
    v_fmac_f32 v107, 0x3ec1848f, v75
    v_fmac_f32 v108, 0x3ec1848f, v76
    v_fmac_f32 v109, 0x3ec1848f, v77
    v_fmac_f32 v110, 0x3ec1848f, v78
    v_fmac_f32 v111, 0x3ec1848f, v79
    v_fmac_f32 v104, 0xbec1848f, v80
    v_fmac_f32 v105, 0xbec1848f, v81
    v_fmac_f32 v106, 0xbec1848f, v82
    v_fmac_f32 v107, 0xbec1848f, v83
    v_fmac_f32 v108, 0xbec1848f, v84
    v_fmac_f32 v109, 0xbec1848f, v85
    v_fmac_f32 v110, 0xbec1848f, v86
    v_fmac_f32 v111, 0xbec1848f, v87
    v_fmac_f32 v104, 0x3ec1848f, v88
    v_fmac_f32 v105, 0x3ec1848f, v89
    v_fmac_f32 v106, 0x3ec1848f, v90
    v_fmac_f32 v107, 0x3ec1848f, v91
    v_fmac_f32 v108, 0x3ec1848f, v92
    v_fmac_f32 v109, 0x3ec1848f, v93
    v_fmac_f32 v110, 0x3ec1848f, v94
    v_fmac_f32 v111, 0x3ec1848f, v95
    v_cvt_pk_bf16_f32 v124, v104, v105
    v_cvt_pk_bf16_f32 v125, v106, v107
    v_cvt_pk_bf16_f32 v126, v108, v109
    v_cvt_pk_bf16_f32 v127, v110, v111
    s_add_u32 s29, s28, 21504
    buffer_store_dwordx4 v[124:127], v1, s[16:19], s29 offen sc1
    s_endpgm
K1_w2:
    v_mul_f32 v96, 0xbd09794c, v40
    v_mul_f32 v97, 0xbd09794c, v41
    v_mul_f32 v98, 0xbd09794c, v42
    v_mul_f32 v99, 0xbd09794c, v43
    v_mul_f32 v100, 0xbd09794c, v44
    v_mul_f32 v101, 0xbd09794c, v45
    v_mul_f32 v102, 0xbd09794c, v46
    v_mul_f32 v103, 0xbd09794c, v47
    v_fmac_f32 v96, 0xbf0223f4, v48
    v_fmac_f32 v97, 0xbf0223f4, v49
    v_fmac_f32 v98, 0xbf0223f4, v50
    v_fmac_f32 v99, 0xbf0223f4, v51
    v_fmac_f32 v100, 0xbf0223f4, v52
    v_fmac_f32 v101, 0xbf0223f4, v53
    v_fmac_f32 v102, 0xbf0223f4, v54
    v_fmac_f32 v103, 0xbf0223f4, v55
    v_fmac_f32 v96, 0x3e92a486, v56
    v_fmac_f32 v97, 0x3e92a486, v57
    v_fmac_f32 v98, 0x3e92a486, v58
    v_fmac_f32 v99, 0x3e92a486, v59
    v_fmac_f32 v100, 0x3e92a486, v60
    v_fmac_f32 v101, 0x3e92a486, v61
    v_fmac_f32 v102, 0x3e92a486, v62
    v_fmac_f32 v103, 0x3e92a486, v63
    v_fmac_f32 v96, 0x3ebb5802, v64
    v_fmac_f32 v97, 0x3ebb5802, v65
    v_fmac_f32 v98, 0x3ebb5802, v66
    v_fmac_f32 v99, 0x3ebb5802, v67
    v_fmac_f32 v100, 0x3ebb5802, v68
    v_fmac_f32 v101, 0x3ebb5802, v69
    v_fmac_f32 v102, 0x3ebb5802, v70
    v_fmac_f32 v103, 0x3ebb5802, v71
    v_fmac_f32 v96, 0xbeefd2dd, v72
    v_fmac_f32 v97, 0xbeefd2dd, v73
    v_fmac_f32 v98, 0xbeefd2dd, v74
    v_fmac_f32 v99, 0xbeefd2dd, v75
    v_fmac_f32 v100, 0xbeefd2dd, v76
    v_fmac_f32 v101, 0xbeefd2dd, v77
    v_fmac_f32 v102, 0xbeefd2dd, v78
    v_fmac_f32 v103, 0xbeefd2dd, v79
    v_fmac_f32 v96, 0xbe081ee4, v80
    v_fmac_f32 v97, 0xbe081ee4, v81
    v_fmac_f32 v98, 0xbe081ee4, v82
    v_fmac_f32 v99, 0xbe081ee4, v83
    v_fmac_f32 v100, 0xbe081ee4, v84
    v_fmac_f32 v101, 0xbe081ee4, v85
    v_fmac_f32 v102, 0xbe081ee4, v86
    v_fmac_f32 v103, 0xbe081ee4, v87
    v_fmac_f32 v96, 0x3f08d677, v88
    v_fmac_f32 v97, 0x3f08d677, v89
    v_fmac_f32 v98, 0x3f08d677, v90
    v_fmac_f32 v99, 0x3f08d677, v91
    v_fmac_f32 v100, 0x3f08d677, v92
    v_fmac_f32 v101, 0x3f08d677, v93
    v_fmac_f32 v102, 0x3f08d677, v94
    v_fmac_f32 v103, 0x3f08d677, v95
    v_cvt_pk_bf16_f32 v112, v96, v97
    v_cvt_pk_bf16_f32 v113, v98, v99
    v_cvt_pk_bf16_f32 v114, v100, v101
    v_cvt_pk_bf16_f32 v115, v102, v103
    s_add_u32 s29, s28, 0
    buffer_store_dwordx4 v[112:115], v1, s[16:19], s29 offen sc1
    v_mul_f32 v104, 0xbf089157, v40
    v_mul_f32 v105, 0xbf089157, v41
    v_mul_f32 v106, 0xbf089157, v42
    v_mul_f32 v107, 0xbf089157, v43
    v_mul_f32 v108, 0xbf089157, v44
    v_mul_f32 v109, 0xbf089157, v45
    v_mul_f32 v110, 0xbf089157, v46
    v_mul_f32 v111, 0xbf089157, v47
    v_fmac_f32 v104, 0x3e292409, v48
    v_fmac_f32 v105, 0x3e292409, v49
    v_fmac_f32 v106, 0x3e292409, v50
    v_fmac_f32 v107, 0x3e292409, v51
    v_fmac_f32 v108, 0x3e292409, v52
    v_fmac_f32 v109, 0x3e292409, v53
    v_fmac_f32 v110, 0x3e292409, v54
    v_fmac_f32 v111, 0x3e292409, v55
    v_fmac_f32 v104, 0x3ee71267, v56
    v_fmac_f32 v105, 0x3ee71267, v57
    v_fmac_f32 v106, 0x3ee71267, v58
    v_fmac_f32 v107, 0x3ee71267, v59
    v_fmac_f32 v108, 0x3ee71267, v60
    v_fmac_f32 v109, 0x3ee71267, v61
    v_fmac_f32 v110, 0x3ee71267, v62
    v_fmac_f32 v111, 0x3ee71267, v63
    v_fmac_f32 v104, 0xbec78039, v64
    v_fmac_f32 v105, 0xbec78039, v65
    v_fmac_f32 v106, 0xbec78039, v66
    v_fmac_f32 v107, 0xbec78039, v67
    v_fmac_f32 v108, 0xbec78039, v68
    v_fmac_f32 v109, 0xbec78039, v69
    v_fmac_f32 v110, 0xbec78039, v70
    v_fmac_f32 v111, 0xbec78039, v71
    v_fmac_f32 v104, 0xbe83d81c, v72
    v_fmac_f32 v105, 0xbe83d81c, v73
    v_fmac_f32 v106, 0xbe83d81c, v74
    v_fmac_f32 v107, 0xbe83d81c, v75
    v_fmac_f32 v108, 0xbe83d81c, v76
    v_fmac_f32 v109, 0xbe83d81c, v77
    v_fmac_f32 v110, 0xbe83d81c, v78
    v_fmac_f32 v111, 0xbe83d81c, v79
    v_fmac_f32 v104, 0x3f0489eb, v80
    v_fmac_f32 v105, 0x3f0489eb, v81
    v_fmac_f32 v106, 0x3f0489eb, v82
    v_fmac_f32 v107, 0x3f0489eb, v83
    v_fmac_f32 v108, 0x3f0489eb, v84
    v_fmac_f32 v109, 0x3f0489eb, v85
    v_fmac_f32 v110, 0x3f0489eb, v86
    v_fmac_f32 v111, 0x3f0489eb, v87
    v_cvt_pk_bf16_f32 v116, v104, v105
    v_cvt_pk_bf16_f32 v117, v106, v107
    v_cvt_pk_bf16_f32 v118, v108, v109
    v_cvt_pk_bf16_f32 v119, v110, v111
    s_add_u32 s29, s28, 7168
    buffer_store_dwordx4 v[116:119], v1, s[16:19], s29 offen sc1
    v_mul_f32 v96, 0x3f391b22, v40
    v_mul_f32 v97, 0x3f391b22, v41
    v_mul_f32 v98, 0x3f391b22, v42
    v_mul_f32 v99, 0x3f391b22, v43
    v_mul_f32 v100, 0x3f391b22, v44
    v_mul_f32 v101, 0x3f391b22, v45
    v_mul_f32 v102, 0x3f391b22, v46
    v_mul_f32 v103, 0x3f391b22, v47
    v_fmac_f32 v96, 0x3f004751, v48
    v_fmac_f32 v97, 0x3f004751, v49
    v_fmac_f32 v98, 0x3f004751, v50
    v_fmac_f32 v99, 0x3f004751, v51
    v_fmac_f32 v100, 0x3f004751, v52
    v_fmac_f32 v101, 0x3f004751, v53
    v_fmac_f32 v102, 0x3f004751, v54
    v_fmac_f32 v103, 0x3f004751, v55
    v_fmac_f32 v96, 0x3eb1cb56, v56
    v_fmac_f32 v97, 0x3eb1cb56, v57
    v_fmac_f32 v98, 0x3eb1cb56, v58
    v_fmac_f32 v99, 0x3eb1cb56, v59
    v_fmac_f32 v100, 0x3eb1cb56, v60
    v_fmac_f32 v101, 0x3eb1cb56, v61
    v_fmac_f32 v102, 0x3eb1cb56, v62
    v_fmac_f32 v103, 0x3eb1cb56, v63
    v_fmac_f32 v96, 0x3e766c52, v64
    v_fmac_f32 v97, 0x3e766c52, v65
    v_fmac_f32 v98, 0x3e766c52, v66
    v_fmac_f32 v99, 0x3e766c52, v67
    v_fmac_f32 v100, 0x3e766c52, v68
    v_fmac_f32 v101, 0x3e766c52, v69
    v_fmac_f32 v102, 0x3e766c52, v70
    v_fmac_f32 v103, 0x3e766c52, v71
    v_fmac_f32 v96, 0x3e2ac57a, v72
    v_fmac_f32 v97, 0x3e2ac57a, v73
    v_fmac_f32 v98, 0x3e2ac57a, v74
    v_fmac_f32 v99, 0x3e2ac57a, v75
    v_fmac_f32 v100, 0x3e2ac57a, v76
    v_fmac_f32 v101, 0x3e2ac57a, v77
    v_fmac_f32 v102, 0x3e2ac57a, v78
    v_fmac_f32 v103, 0x3e2ac57a, v79
    v_fmac_f32 v96, 0x3decb07c, v80
    v_fmac_f32 v97, 0x3decb07c, v81
    v_fmac_f32 v98, 0x3decb07c, v82
    v_fmac_f32 v99, 0x3decb07c, v83
    v_fmac_f32 v100, 0x3decb07c, v84
    v_fmac_f32 v101, 0x3decb07c, v85
    v_fmac_f32 v102, 0x3decb07c, v86
    v_fmac_f32 v103, 0x3decb07c, v87
    v_fmac_f32 v96, 0x3da406a2, v88
    v_fmac_f32 v97, 0x3da406a2, v89
    v_fmac_f32 v98, 0x3da406a2, v90
    v_fmac_f32 v99, 0x3da406a2, v91
    v_fmac_f32 v100, 0x3da406a2, v92
    v_fmac_f32 v101, 0x3da406a2, v93
    v_fmac_f32 v102, 0x3da406a2, v94
    v_fmac_f32 v103, 0x3da406a2, v95
    v_cvt_pk_bf16_f32 v120, v96, v97
    v_cvt_pk_bf16_f32 v121, v98, v99
    v_cvt_pk_bf16_f32 v122, v100, v101
    v_cvt_pk_bf16_f32 v123, v102, v103
    s_add_u32 s29, s28, 14336
    buffer_store_dwordx4 v[120:123], v1, s[16:19], s29 offen sc1
    v_mul_f32 v104, 0x3f391b22, v40
    v_mul_f32 v105, 0x3f391b22, v41
    v_mul_f32 v106, 0x3f391b22, v42
    v_mul_f32 v107, 0x3f391b22, v43
    v_mul_f32 v108, 0x3f391b22, v44
    v_mul_f32 v109, 0x3f391b22, v45
    v_mul_f32 v110, 0x3f391b22, v46
    v_mul_f32 v111, 0x3f391b22, v47
    v_fmac_f32 v104, 0xbf004751, v48
    v_fmac_f32 v105, 0xbf004751, v49
    v_fmac_f32 v106, 0xbf004751, v50
    v_fmac_f32 v107, 0xbf004751, v51
    v_fmac_f32 v108, 0xbf004751, v52
    v_fmac_f32 v109, 0xbf004751, v53
    v_fmac_f32 v110, 0xbf004751, v54
    v_fmac_f32 v111, 0xbf004751, v55
    v_fmac_f32 v104, 0x3eb1cb56, v56
    v_fmac_f32 v105, 0x3eb1cb56, v57
    v_fmac_f32 v106, 0x3eb1cb56, v58
    v_fmac_f32 v107, 0x3eb1cb56, v59
    v_fmac_f32 v108, 0x3eb1cb56, v60
    v_fmac_f32 v109, 0x3eb1cb56, v61
    v_fmac_f32 v110, 0x3eb1cb56, v62
    v_fmac_f32 v111, 0x3eb1cb56, v63
    v_fmac_f32 v104, 0xbe766c52, v64
    v_fmac_f32 v105, 0xbe766c52, v65
    v_fmac_f32 v106, 0xbe766c52, v66
    v_fmac_f32 v107, 0xbe766c52, v67
    v_fmac_f32 v108, 0xbe766c52, v68
    v_fmac_f32 v109, 0xbe766c52, v69
    v_fmac_f32 v110, 0xbe766c52, v70
    v_fmac_f32 v111, 0xbe766c52, v71
    v_fmac_f32 v104, 0x3e2ac57a, v72
    v_fmac_f32 v105, 0x3e2ac57a, v73
    v_fmac_f32 v106, 0x3e2ac57a, v74
    v_fmac_f32 v107, 0x3e2ac57a, v75
    v_fmac_f32 v108, 0x3e2ac57a, v76
    v_fmac_f32 v109, 0x3e2ac57a, v77
    v_fmac_f32 v110, 0x3e2ac57a, v78
    v_fmac_f32 v111, 0x3e2ac57a, v79
    v_fmac_f32 v104, 0xbdecb07c, v80
    v_fmac_f32 v105, 0xbdecb07c, v81
    v_fmac_f32 v106, 0xbdecb07c, v82
    v_fmac_f32 v107, 0xbdecb07c, v83
    v_fmac_f32 v108, 0xbdecb07c, v84
    v_fmac_f32 v109, 0xbdecb07c, v85
    v_fmac_f32 v110, 0xbdecb07c, v86
    v_fmac_f32 v111, 0xbdecb07c, v87
    v_fmac_f32 v104, 0x3da406a2, v88
    v_fmac_f32 v105, 0x3da406a2, v89
    v_fmac_f32 v106, 0x3da406a2, v90
    v_fmac_f32 v107, 0x3da406a2, v91
    v_fmac_f32 v108, 0x3da406a2, v92
    v_fmac_f32 v109, 0x3da406a2, v93
    v_fmac_f32 v110, 0x3da406a2, v94
    v_fmac_f32 v111, 0x3da406a2, v95
    v_cvt_pk_bf16_f32 v124, v104, v105
    v_cvt_pk_bf16_f32 v125, v106, v107
    v_cvt_pk_bf16_f32 v126, v108, v109
    v_cvt_pk_bf16_f32 v127, v110, v111
    s_add_u32 s29, s28, 21504
    buffer_store_dwordx4 v[124:127], v1, s[16:19], s29 offen sc1
    s_endpgm
K1_w3:
    v_mul_f32 v96, 0x3d373462, v40
    v_mul_f32 v97, 0x3d373462, v41
    v_mul_f32 v98, 0x3d373462, v42
    v_mul_f32 v99, 0x3d373462, v43
    v_mul_f32 v100, 0x3d373462, v44
    v_mul_f32 v101, 0x3d373462, v45
    v_mul_f32 v102, 0x3d373462, v46
    v_mul_f32 v103, 0x3d373462, v47
    v_fmac_f32 v96, 0x3eb38c1b, v48
    v_fmac_f32 v97, 0x3eb38c1b, v49
    v_fmac_f32 v98, 0x3eb38c1b, v50
    v_fmac_f32 v99, 0x3eb38c1b, v51
    v_fmac_f32 v100, 0x3eb38c1b, v52
    v_fmac_f32 v101, 0x3eb38c1b, v53
    v_fmac_f32 v102, 0x3eb38c1b, v54
    v_fmac_f32 v103, 0x3eb38c1b, v55
    v_fmac_f32 v96, 0xbf089fd8, v56
    v_fmac_f32 v97, 0xbf089fd8, v57
    v_fmac_f32 v98, 0xbf089fd8, v58
    v_fmac_f32 v99, 0xbf089fd8, v59
    v_fmac_f32 v100, 0xbf089fd8, v60
    v_fmac_f32 v101, 0xbf089fd8, v61
    v_fmac_f32 v102, 0xbf089fd8, v62
    v_fmac_f32 v103, 0xbf089fd8, v63
    v_fmac_f32 v96, 0x3ec973a6, v64
    v_fmac_f32 v97, 0x3ec973a6, v65
    v_fmac_f32 v98, 0x3ec973a6, v66
    v_fmac_f32 v99, 0x3ec973a6, v67
    v_fmac_f32 v100, 0x3ec973a6, v68
    v_fmac_f32 v101, 0x3ec973a6, v69
    v_fmac_f32 v102, 0x3ec973a6, v70
    v_fmac_f32 v103, 0x3ec973a6, v71
    v_fmac_f32 v96, 0xbc7486ea, v72
    v_fmac_f32 v97, 0xbc7486ea, v73
    v_fmac_f32 v98, 0xbc7486ea, v74
    v_fmac_f32 v99, 0xbc7486ea, v75
    v_fmac_f32 v100, 0xbc7486ea, v76
    v_fmac_f32 v101, 0xbc7486ea, v77
    v_fmac_f32 v102, 0xbc7486ea, v78
    v_fmac_f32 v103, 0xbc7486ea, v79
    v_fmac_f32 v96, 0xbebecc09, v80
    v_fmac_f32 v97, 0xbebecc09, v81
    v_fmac_f32 v98, 0xbebecc09, v82
    v_fmac_f32 v99, 0xbebecc09, v83
    v_fmac_f32 v100, 0xbebecc09, v84
    v_fmac_f32 v101, 0xbebecc09, v85
    v_fmac_f32 v102, 0xbebecc09, v86
    v_fmac_f32 v103, 0xbebecc09, v87
    v_fmac_f32 v96, 0x3f08d677, v88
    v_fmac_f32 v97, 0x3f08d677, v89
    v_fmac_f32 v98, 0x3f08d677, v90
    v_fmac_f32 v99, 0x3f08d677, v91
    v_fmac_f32 v100, 0x3f08d677, v92
    v_fmac_f32 v101, 0x3f08d677, v93
    v_fmac_f32 v102, 0x3f08d677, v94
    v_fmac_f32 v103, 0x3f08d677, v95
    v_cvt_pk_bf16_f32 v112, v96, v97
    v_cvt_pk_bf16_f32 v113, v98, v99
    v_cvt_pk_bf16_f32 v114, v100, v101
    v_cvt_pk_bf16_f32 v115, v102, v103
    s_add_u32 s29, s28, 0
    buffer_store_dwordx4 v[112:115], v1, s[16:19], s29 offen sc1
    v_mul_f32 v104, 0x3f085b9c, v40
    v_mul_f32 v105, 0x3f085b9c, v41
    v_mul_f32 v106, 0x3f085b9c, v42
    v_mul_f32 v107, 0x3f085b9c, v43
    v_mul_f32 v108, 0x3f085b9c, v44
    v_mul_f32 v109, 0x3f085b9c, v45
    v_mul_f32 v110, 0x3f085b9c, v46
    v_mul_f32 v111, 0x3f085b9c, v47
    v_fmac_f32 v104, 0xbece8ba8, v48
    v_fmac_f32 v105, 0xbece8ba8, v49
    v_fmac_f32 v106, 0xbece8ba8, v50
    v_fmac_f32 v107, 0xbece8ba8, v51
    v_fmac_f32 v108, 0xbece8ba8, v52
    v_fmac_f32 v109, 0xbece8ba8, v53
    v_fmac_f32 v110, 0xbece8ba8, v54
    v_fmac_f32 v111, 0xbece8ba8, v55
    v_fmac_f32 v104, 0x3cf46e81, v56
    v_fmac_f32 v105, 0x3cf46e81, v57
    v_fmac_f32 v106, 0x3cf46e81, v58
    v_fmac_f32 v107, 0x3cf46e81, v59
    v_fmac_f32 v108, 0x3cf46e81, v60
    v_fmac_f32 v109, 0x3cf46e81, v61
    v_fmac_f32 v110, 0x3cf46e81, v62
    v_fmac_f32 v111, 0x3cf46e81, v63
    v_fmac_f32 v104, 0x3eb93e90, v64
    v_fmac_f32 v105, 0x3eb93e90, v65
    v_fmac_f32 v106, 0x3eb93e90, v66
    v_fmac_f32 v107, 0x3eb93e90, v67
    v_fmac_f32 v108, 0x3eb93e90, v68
    v_fmac_f32 v109, 0x3eb93e90, v69
    v_fmac_f32 v110, 0x3eb93e90, v70
    v_fmac_f32 v111, 0x3eb93e90, v71
    v_fmac_f32 v104, 0xbf08c8cf, v72
    v_fmac_f32 v105, 0xbf08c8cf, v73
    v_fmac_f32 v106, 0xbf08c8cf, v74
    v_fmac_f32 v107, 0xbf08c8cf, v75
    v_fmac_f32 v108, 0xbf08c8cf, v76
    v_fmac_f32 v109, 0xbf08c8cf, v77
    v_fmac_f32 v110, 0xbf08c8cf, v78
    v_fmac_f32 v111, 0xbf08c8cf, v79
    v_fmac_f32 v104, 0x3ec4336d, v80
    v_fmac_f32 v105, 0x3ec4336d, v81
    v_fmac_f32 v106, 0x3ec4336d, v82
    v_fmac_f32 v107, 0x3ec4336d, v83
    v_fmac_f32 v108, 0x3ec4336d, v84
    v_fmac_f32 v109, 0x3ec4336d, v85
    v_fmac_f32 v110, 0x3ec4336d, v86
    v_fmac_f32 v111, 0x3ec4336d, v87
    v_cvt_pk_bf16_f32 v116, v104, v105
    v_cvt_pk_bf16_f32 v117, v106, v107
    v_cvt_pk_bf16_f32 v118, v108, v109
    v_cvt_pk_bf16_f32 v119, v110, v111
    s_add_u32 s29, s28, 7168
    buffer_store_dwordx4 v[116:119], v1, s[16:19], s29 offen sc1
    v_mul_f32 v96, 0x3da406a2, v40
    v_mul_f32 v97, 0x3da406a2, v41
    v_mul_f32 v98, 0x3da406a2, v42
    v_mul_f32 v99, 0x3da406a2, v43
    v_mul_f32 v100, 0x3da406a2, v44
    v_mul_f32 v101, 0x3da406a2, v45
    v_mul_f32 v102, 0x3da406a2, v46
    v_mul_f32 v103, 0x3da406a2, v47
    v_fmac_f32 v96, 0x3decb07c, v48
    v_fmac_f32 v97, 0x3decb07c, v49
    v_fmac_f32 v98, 0x3decb07c, v50
    v_fmac_f32 v99, 0x3decb07c, v51
    v_fmac_f32 v100, 0x3decb07c, v52
    v_fmac_f32 v101, 0x3decb07c, v53
    v_fmac_f32 v102, 0x3decb07c, v54
    v_fmac_f32 v103, 0x3decb07c, v55
    v_fmac_f32 v96, 0x3e2ac57a, v56
    v_fmac_f32 v97, 0x3e2ac57a, v57
    v_fmac_f32 v98, 0x3e2ac57a, v58
    v_fmac_f32 v99, 0x3e2ac57a, v59
    v_fmac_f32 v100, 0x3e2ac57a, v60
    v_fmac_f32 v101, 0x3e2ac57a, v61
    v_fmac_f32 v102, 0x3e2ac57a, v62
    v_fmac_f32 v103, 0x3e2ac57a, v63
    v_fmac_f32 v96, 0x3e766c52, v64
    v_fmac_f32 v97, 0x3e766c52, v65
    v_fmac_f32 v98, 0x3e766c52, v66
    v_fmac_f32 v99, 0x3e766c52, v67
    v_fmac_f32 v100, 0x3e766c52, v68
    v_fmac_f32 v101, 0x3e766c52, v69
    v_fmac_f32 v102, 0x3e766c52, v70
    v_fmac_f32 v103, 0x3e766c52, v71
    v_fmac_f32 v96, 0x3eb1cb56, v72
    v_fmac_f32 v97, 0x3eb1cb56, v73
    v_fmac_f32 v98, 0x3eb1cb56, v74
    v_fmac_f32 v99, 0x3eb1cb56, v75
    v_fmac_f32 v100, 0x3eb1cb56, v76
    v_fmac_f32 v101, 0x3eb1cb56, v77
    v_fmac_f32 v102, 0x3eb1cb56, v78
    v_fmac_f32 v103, 0x3eb1cb56, v79
    v_fmac_f32 v96, 0x3f004751, v80
    v_fmac_f32 v97, 0x3f004751, v81
    v_fmac_f32 v98, 0x3f004751, v82
    v_fmac_f32 v99, 0x3f004751, v83
    v_fmac_f32 v100, 0x3f004751, v84
    v_fmac_f32 v101, 0x3f004751, v85
    v_fmac_f32 v102, 0x3f004751, v86
    v_fmac_f32 v103, 0x3f004751, v87
    v_fmac_f32 v96, 0x3f391b22, v88
    v_fmac_f32 v97, 0x3f391b22, v89
    v_fmac_f32 v98, 0x3f391b22, v90
    v_fmac_f32 v99, 0x3f391b22, v91
    v_fmac_f32 v100, 0x3f391b22, v92
    v_fmac_f32 v101, 0x3f391b22, v93
    v_fmac_f32 v102, 0x3f391b22, v94
    v_fmac_f32 v103, 0x3f391b22, v95
    v_cvt_pk_bf16_f32 v120, v96, v97
    v_cvt_pk_bf16_f32 v121, v98, v99
    v_cvt_pk_bf16_f32 v122, v100, v101
    v_cvt_pk_bf16_f32 v123, v102, v103
    s_add_u32 s29, s28, 14336
    buffer_store_dwordx4 v[120:123], v1, s[16:19], s29 offen sc1
    v_mul_f32 v104, 0x3da406a2, v40
    v_mul_f32 v105, 0x3da406a2, v41
    v_mul_f32 v106, 0x3da406a2, v42
    v_mul_f32 v107, 0x3da406a2, v43
    v_mul_f32 v108, 0x3da406a2, v44
    v_mul_f32 v109, 0x3da406a2, v45
    v_mul_f32 v110, 0x3da406a2, v46
    v_mul_f32 v111, 0x3da406a2, v47
    v_fmac_f32 v104, 0xbdecb07c, v48
    v_fmac_f32 v105, 0xbdecb07c, v49
    v_fmac_f32 v106, 0xbdecb07c, v50
    v_fmac_f32 v107, 0xbdecb07c, v51
    v_fmac_f32 v108, 0xbdecb07c, v52
    v_fmac_f32 v109, 0xbdecb07c, v53
    v_fmac_f32 v110, 0xbdecb07c, v54
    v_fmac_f32 v111, 0xbdecb07c, v55
    v_fmac_f32 v104, 0x3e2ac57a, v56
    v_fmac_f32 v105, 0x3e2ac57a, v57
    v_fmac_f32 v106, 0x3e2ac57a, v58
    v_fmac_f32 v107, 0x3e2ac57a, v59
    v_fmac_f32 v108, 0x3e2ac57a, v60
    v_fmac_f32 v109, 0x3e2ac57a, v61
    v_fmac_f32 v110, 0x3e2ac57a, v62
    v_fmac_f32 v111, 0x3e2ac57a, v63
    v_fmac_f32 v104, 0xbe766c52, v64
    v_fmac_f32 v105, 0xbe766c52, v65
    v_fmac_f32 v106, 0xbe766c52, v66
    v_fmac_f32 v107, 0xbe766c52, v67
    v_fmac_f32 v108, 0xbe766c52, v68
    v_fmac_f32 v109, 0xbe766c52, v69
    v_fmac_f32 v110, 0xbe766c52, v70
    v_fmac_f32 v111, 0xbe766c52, v71
    v_fmac_f32 v104, 0x3eb1cb56, v72
    v_fmac_f32 v105, 0x3eb1cb56, v73
    v_fmac_f32 v106, 0x3eb1cb56, v74
    v_fmac_f32 v107, 0x3eb1cb56, v75
    v_fmac_f32 v108, 0x3eb1cb56, v76
    v_fmac_f32 v109, 0x3eb1cb56, v77
    v_fmac_f32 v110, 0x3eb1cb56, v78
    v_fmac_f32 v111, 0x3eb1cb56, v79
    v_fmac_f32 v104, 0xbf004751, v80
    v_fmac_f32 v105, 0xbf004751, v81
    v_fmac_f32 v106, 0xbf004751, v82
    v_fmac_f32 v107, 0xbf004751, v83
    v_fmac_f32 v108, 0xbf004751, v84
    v_fmac_f32 v109, 0xbf004751, v85
    v_fmac_f32 v110, 0xbf004751, v86
    v_fmac_f32 v111, 0xbf004751, v87
    v_fmac_f32 v104, 0x3f391b22, v88
    v_fmac_f32 v105, 0x3f391b22, v89
    v_fmac_f32 v106, 0x3f391b22, v90
    v_fmac_f32 v107, 0x3f391b22, v91
    v_fmac_f32 v108, 0x3f391b22, v92
    v_fmac_f32 v109, 0x3f391b22, v93
    v_fmac_f32 v110, 0x3f391b22, v94
    v_fmac_f32 v111, 0x3f391b22, v95
    v_cvt_pk_bf16_f32 v124, v104, v105
    v_cvt_pk_bf16_f32 v125, v106, v107
    v_cvt_pk_bf16_f32 v126, v108, v109
    v_cvt_pk_bf16_f32 v127, v110, v111
    s_add_u32 s29, s28, 21504
    buffer_store_dwordx4 v[124:127], v1, s[16:19], s29 offen sc1
    s_endpgm
K1_end:
    s_endpgm
.p2align 8
K1_bt:
    .long 0x3e3f0000, 0xbeb53dec, 0xbe92beb5, 0x3eae3d8e, 0xbcab0000, 0xbe19be18, 0x3ebf3e19, 0x3e8f3eee
    .long 0x00003ea6, 0x0000bf12, 0x0000be82, 0x0000bd94, 0xbea60000, 0x3f120000, 0x3e820000, 0x3d940000
    .long 0x3d9f0000, 0xbe91be10, 0x3ec23ea1, 0xbec73c76, 0xbe290000, 0x3ecbbdee, 0xbda83ebf, 0xbd98bec6
    .long 0xbe5b0000, 0x3e25be5b, 0x3ea83e25, 0x3ec03ea8, 0x3e5b0000, 0xbe25be5b, 0xbea83e25, 0xbec03ea8
    .long 0xbd9f0000, 0x3e91be10, 0xbec23ea1, 0x3ec73c76, 0xbe290000, 0x3ecb3dee, 0xbda8bebf, 0xbd983ec6
    .long 0x3e840000, 0xbea83e37, 0xbeb8be69, 0xbe6bbe7e, 0xbe840000, 0x3ea83e37, 0x3eb8be69, 0x3e6bbe7e
    .long 0xbe3f0000, 0x3eb53dec, 0x3e92beb5, 0xbeae3d8e, 0xbcab0000, 0xbe193e18, 0x3ebfbe19, 0x3e8fbeee
    .long 0x3ebe0000, 0x3dfa3f09, 0xbd163e34, 0xbe23bd59, 0xbebe0000, 0xbdfa3f09, 0x3d163e34, 0x3e23bd59
    .long 0x3e9f3ee0, 0xbe5cbd12, 0x3c81bec1, 0x00003e15, 0xbeb4bd49, 0xbea3bef0, 0x3e40bd8a, 0x00003df4
    .long 0x00003d94, 0x00003e82, 0x00003f12, 0x0000bea6, 0xbd940000, 0xbe820000, 0xbf120000, 0x3ea60000
    .long 0x3ea5be2d, 0xbdf13e94, 0x3c3cbefa, 0x00003e37, 0x3e5d3eb7, 0xbef2be84, 0x3e3abb6b, 0x00003d0c
    .long 0x3ea83ec0, 0x3e253ea8, 0xbe5b3e25, 0x0000be5b, 0xbea83ec0, 0xbe253ea8, 0x3e5b3e25, 0x0000be5b
    .long 0xbea5be2d, 0x3df13e94, 0xbc3cbefa, 0x00003e37, 0x3e5dbeb7, 0xbef23e84, 0x3e3a3b6b, 0x0000bd0c
    .long 0xbd59be23, 0x3e34bd16, 0x3f093dfa, 0x00003ebe, 0x3d59be23, 0xbe34bd16, 0xbf093dfa, 0x00003ebe
    .long 0xbe9f3ee0, 0x3e5cbd12, 0xbc81bec1, 0x00003e15, 0xbeb43d49, 0xbea33ef0, 0x3e403d8a, 0x0000bdf4
    .long 0xbe7ebe6b, 0xbe69beb8, 0x3e37bea8, 0x00003e84, 0x3e7ebe6b, 0x3e69beb8, 0xbe37bea8, 0x00003e84
    .long 0xb6f20000, 0x3979b952, 0x37543996, 0x3906b97b, 0xb8460000, 0x3984390f, 0x3a24b90f, 0xb82d38bb
    .long 0x00003a25, 0x00003a07, 0x0000b95a, 0x0000b82a, 0xba250000, 0xba070000, 0x395a0000, 0x382a0000
    .long 0x380b0000, 0xba213892, 0x3939ba47, 0xb96d372a, 0xb7950000, 0x3986b88c, 0x395e3a08, 0x3809ba52
    .long 0x394a0000, 0xb759394a, 0x3916b759, 0x3a593916, 0xb94a0000, 0x3759394a, 0xb916b759, 0xba593916
    .long 0xb80b0000, 0x3a213892, 0xb939ba47, 0x396d372a, 0xb7950000, 0x3986388c, 0x395eba08, 0x38093a52
    .long 0xba0e0000, 0x39dab9dd, 0x3a4239e5, 0xb6c3b9ff, 0x3a0e0000, 0xb9dab9dd, 0xba4239e5, 0x36c3b9ff
    .long 0x36f20000, 0xb979b952, 0xb7543996, 0xb906b97b, 0xb8460000, 0x3984b90f, 0x3a24390f, 0xb82db8bb
    .long 0x391b0000, 0xb96d3a0f, 0xb89d3826, 0x391037de, 0xb91b0000, 0x396d3a0f, 0x389d3826, 0xb91037de
    .long 0x3a23b994, 0xb8cb379d, 0xb830ba16, 0x0000b9fa, 0xba3f3800, 0x3a4d3884, 0xb9f83897, 0x0000b733
    .long 0x0000382a, 0x0000395a, 0x0000ba07, 0x0000ba25, 0xb82a0000, 0xb95a0000, 0x3a070000, 0x3a250000
    .long 0x38a039c5, 0xb927b851, 0xb7ac3a00, 0x000039fa, 0xb94e3a54, 0xba38ba4c, 0x39dbb3f8, 0x00003609
    .long 0x39163a59, 0xb7593916, 0x394ab759, 0x0000394a, 0xb9163a59, 0x37593916, 0xb94ab759, 0x0000394a
    .long 0xb8a039c5, 0x3927b851, 0x37ac3a00, 0x000039fa, 0xb94eba54, 0xba383a4c, 0x39db33f8, 0x0000b609
    .long 0x37de3910, 0x3826b89d, 0x3a0fb96d, 0x0000391b, 0xb7de3910, 0xb826b89d, 0xba0fb96d, 0x0000391b
    .long 0xba23b994, 0x38cb379d, 0x3830ba16, 0x0000b9fa, 0xba3fb800, 0x3a4db884, 0xb9f8b897, 0x00003733
    .long 0xb9ffb6c3, 0x39e53a42, 0xb9dd39da, 0x0000ba0e, 0x39ffb6c3, 0xb9e53a42, 0x39dd39da, 0x0000ba0e

.section .rodata,"a"
.p2align 6
.amdhsa_kernel k1_kernel
  .amdhsa_next_free_vgpr 160
  .amdhsa_next_free_sgpr 80
  .amdhsa_accum_offset 160
  .amdhsa_group_segment_fixed_size 0
  .amdhsa_kernarg_size 40
  .amdhsa_user_sgpr_count 2
  .amdhsa_user_sgpr_kernarg_segment_ptr 1
  .amdhsa_system_sgpr_workgroup_id_x 1
.end_amdhsa_kernel
.text
.globl k2_kernel
.p2align 8
.type k2_kernel,@function
k2_kernel:
    s_load_dwordx2 s[8:9], s[0:1], 32
    s_load_dwordx2 s[4:5], s[0:1], 16
    s_getpc_b64 s[10:11]
K2_pc:
    s_cmp_ge_u32 s2, 256
    s_cbranch_scc1 K2_end
    v_lshrrev_b32 v3, 6, v0
    v_lshlrev_b32 v4, 7, v0
    v_min_u32 v4, K2_code_end-K2_pc-4, v4
    v_and_b32 v0, 63, v0
    s_nop 0
    v_readfirstlane_b32 s24, v3
    s_cmp_ge_u32 s2, 8
    s_cbranch_scc1 K2_nocpf
    global_load_dword v5, v4, s[10:11]
K2_nocpf:
    s_and_b32 s25, s2, 7
    s_lshr_b32 s26, s2, 3
    s_mul_i32 s27, s26, 43
    s_lshr_b32 s27, s27, 8
    s_mul_i32 s28, s27, 6
    s_sub_u32 s28, s26, s28
    s_lshl_b32 s27, s27, 3
    s_add_u32 s27, s27, s25
    s_cmp_lt_u32 s26, 30
    s_cbranch_scc1 K2_map
    s_lshl_b32 s29, s25, 1
    s_add_u32 s29, s29, s26
    s_sub_u32 s29, s29, 30
    s_mul_i32 s27, s29, 43
    s_lshr_b32 s27, s27, 8
    s_mul_i32 s28, s27, 6
    s_sub_u32 s28, s29, s28
    s_add_u32 s27, s27, 40
K2_map:
    s_cmp_ge_u32 s27, 42
    s_cbranch_scc1 K2_end
    v_lshlrev_b32 v1, 4, v0
    v_and_b32 v3, 15, v0
    v_cmp_ne_u32 vcc, 0, v3
    v_min_u32 v3, 5, v3
    v_add_u32 v3, 2, v3
    v_lshlrev_b32 v3, 10, v3
    v_lshrrev_b32 v4, 4, v0
    v_lshl_add_u32 v3, v4, 8, v3
    v_add_u32 v2, 240, v3
    s_mov_b32 s40, 4096
    s_mov_b32 s41, 8192
    s_mov_b32 s42, 12288
    s_mov_b32 s43, 16384
    s_mov_b32 s44, 20480
    s_mov_b32 s45, 24576
    s_mov_b32 s46, 28672
    s_mov_b32 s47, 32768
    s_mov_b32 s48, 36864
    s_mov_b32 s49, 40960
    s_mov_b32 s50, 45056
    s_mov_b32 s51, 49152
    s_mov_b32 s52, 53248
    s_mov_b32 s53, 57344
    s_mov_b32 s54, 61440
    s_mov_b32 s55, 65536
    s_mov_b32 s56, 69632
    s_mov_b32 s57, 73728
    s_mov_b32 s58, 77824
    s_mov_b32 s59, 81920
    s_mov_b32 s60, 86016
    s_mov_b32 s61, 90112
    s_mov_b32 s62, 94208
    s_lshl_b32 s29, s27, 2
    s_add_u32 s29, s29, s24
    s_mul_i32 s29, s29, 98304
    s_max_u32 s30, s27, 1
    s_sub_u32 s30, s30, 1
    s_lshl_b32 s30, s30, 2
    s_add_u32 s30, s30, s24
    s_mul_i32 s30, s30, 98304
    s_lshl_b32 s31, s28, 2
    s_add_u32 s31, s31, s24
    s_mul_i32 s31, s31, 86016
    s_add_u32 s31, s31, 16515072
    s_waitcnt lgkmcnt(0)
    s_add_u32 s12, s8, s29
    s_addc_u32 s13, s9, 0
    s_and_b32 s13, s13, 0xffff
    s_mov_b32 s14, 98304
    s_mov_b32 s15, 0x00020000
    s_add_u32 s16, s8, s31
    s_addc_u32 s17, s9, 0
    s_and_b32 s17, s17, 0xffff
    s_mov_b32 s18, 86016
    s_mov_b32 s19, 0x00020000
    s_add_u32 s20, s8, s30
    s_addc_u32 s21, s9, 0
    s_and_b32 s21, s21, 0xffff
    s_mov_b32 s22, 98304
    s_mov_b32 s23, 0x00020000
    buffer_load_dwordx4 v[8:11], v1, s[12:15], s40 offen offset:3072
    buffer_load_dwordx4 a[160:163], v1, s[16:19], 0 offen offset:0
    buffer_load_dwordx4 v[12:15], v1, s[12:15], s40 offen offset:2048
    buffer_load_dwordx4 a[164:167], v1, s[16:19], 0 offen offset:1024
    buffer_load_dwordx4 v[16:19], v1, s[12:15], s40 offen offset:1024
    buffer_load_dwordx4 a[168:171], v1, s[16:19], 0 offen offset:2048
    buffer_load_dwordx4 v[20:23], v1, s[12:15], s40 offen offset:0
    buffer_load_dwordx4 a[172:175], v1, s[16:19], 0 offen offset:3072
    buffer_load_dwordx4 a[176:179], v1, s[16:19], s41 offen offset:2048
    buffer_load_dwordx4 a[180:183], v1, s[16:19], s41 offen offset:1024
    buffer_load_dwordx4 a[184:187], v1, s[16:19], s41 offen offset:0
    buffer_load_dwordx4 a[188:191], v1, s[16:19], s40 offen offset:3072
    buffer_load_dwordx4 v[24:27], v1, s[12:15], s42 offen offset:3072
    buffer_load_dwordx4 v[28:31], v2, s[20:23], 0 offen offset:0
    buffer_load_dwordx4 v[32:35], v2, s[20:23], s41 offen offset:0
    buffer_load_dwordx4 v[36:39], v1, s[12:15], s42 offen offset:2048
    s_waitcnt vmcnt(14)
    v_mfma_f32_16x16x32_bf16 a[28:31], v[8:11], a[160:163], 0
    buffer_load_dwordx4 v[40:43], v1, s[12:15], s42 offen offset:1024
    s_waitcnt vmcnt(13)
    v_mfma_f32_16x16x32_bf16 a[28:31], v[12:15], a[164:167], a[28:31]
    buffer_load_dwordx4 v[44:47], v1, s[12:15], s42 offen offset:0
    s_waitcnt vmcnt(12)
    v_mfma_f32_16x16x32_bf16 a[28:31], v[16:19], a[168:171], a[28:31]
    buffer_load_dwordx4 v[48:51], v1, s[12:15], 0 offen offset:3072
    s_waitcnt vmcnt(11)
    v_mfma_f32_16x16x32_bf16 a[28:31], v[20:23], a[172:175], a[28:31]
    buffer_load_dwordx4 v[52:55], v1, s[12:15], s41 offen offset:3072
    s_waitcnt vmcnt(11)
    v_mfma_f32_16x16x32_bf16 a[60:63], v[20:23], a[176:179], 0
    buffer_load_dwordx4 v[56:59], v1, s[12:15], 0 offen offset:2048
    s_waitcnt vmcnt(11)
    v_mfma_f32_16x16x32_bf16 a[60:63], v[16:19], a[180:183], a[60:63]
    buffer_load_dwordx4 v[60:63], v1, s[12:15], s41 offen offset:2048
    s_waitcnt vmcnt(11)
    v_mfma_f32_16x16x32_bf16 a[60:63], v[12:15], a[184:187], a[60:63]
    s_waitcnt vmcnt(10)
    v_mfma_f32_16x16x32_bf16 a[60:63], v[8:11], a[188:191], a[60:63]
    v_mov_b32_dpp v8, v8 row_shr:1 row_mask:0xf bank_mask:0xf
    s_waitcnt vmcnt(9)
    v_mfma_f32_16x16x32_bf16 a[60:63], v[24:27], a[160:163], a[60:63]
    v_mov_b32_dpp v9, v9 row_shr:1 row_mask:0xf bank_mask:0xf
    s_waitcnt vmcnt(6)
    v_mfma_f32_16x16x32_bf16 a[60:63], v[36:39], a[164:167], a[60:63]
    v_mov_b32_dpp v10, v10 row_shr:1 row_mask:0xf bank_mask:0xf
    s_waitcnt vmcnt(5)
    v_mfma_f32_16x16x32_bf16 a[60:63], v[40:43], a[168:171], a[60:63]
    buffer_load_dwordx4 v[64:67], v1, s[12:15], 0 offen offset:1024
    s_waitcnt vmcnt(5)
    v_mfma_f32_16x16x32_bf16 a[60:63], v[44:47], a[172:175], a[60:63]
    v_mov_b32_dpp v11, v11 row_shr:1 row_mask:0xf bank_mask:0xf
    v_mfma_f32_16x16x32_bf16 a[92:95], v[44:47], a[176:179], 0
    v_cndmask_b32_dpp v8, v28, v8, vcc row_shl:5 row_mask:0xf bank_mask:0xf
    v_mfma_f32_16x16x32_bf16 a[92:95], v[40:43], a[180:183], a[92:95]
    v_cndmask_b32_dpp v9, v29, v9, vcc row_shl:5 row_mask:0xf bank_mask:0xf
    v_mfma_f32_16x16x32_bf16 a[92:95], v[36:39], a[184:187], a[92:95]
    v_cndmask_b32_dpp v10, v30, v10, vcc row_shl:5 row_mask:0xf bank_mask:0xf
    v_mfma_f32_16x16x32_bf16 a[92:95], v[24:27], a[188:191], a[92:95]
    buffer_load_dwordx4 v[68:71], v1, s[12:15], s41 offen offset:1024
    v_mfma_f32_16x16x32_bf16 a[24:27], v[12:15], a[160:163], 0
    v_cndmask_b32_dpp v11, v31, v11, vcc row_shl:5 row_mask:0xf bank_mask:0xf
    v_mfma_f32_16x16x32_bf16 a[24:27], v[16:19], a[164:167], a[24:27]
    v_mov_b32_dpp v24, v24 row_shr:1 row_mask:0xf bank_mask:0xf
    v_mfma_f32_16x16x32_bf16 a[24:27], v[20:23], a[168:171], a[24:27]
    v_mov_b32_dpp v25, v25 row_shr:1 row_mask:0xf bank_mask:0xf
    s_waitcnt vmcnt(5)
    v_mfma_f32_16x16x32_bf16 a[24:27], v[48:51], a[172:175], a[24:27]
    v_mov_b32_dpp v26, v26 row_shr:1 row_mask:0xf bank_mask:0xf
    v_mfma_f32_16x16x32_bf16 a[56:59], v[48:51], a[176:179], 0
    buffer_load_dwordx4 v[72:75], v1, s[12:15], 0 offen offset:0
    v_mfma_f32_16x16x32_bf16 a[56:59], v[20:23], a[180:183], a[56:59]
    v_mov_b32_dpp v27, v27 row_shr:1 row_mask:0xf bank_mask:0xf
    v_mfma_f32_16x16x32_bf16 a[56:59], v[16:19], a[184:187], a[56:59]
    v_cndmask_b32_dpp v24, v32, v24, vcc row_shl:5 row_mask:0xf bank_mask:0xf
    v_mfma_f32_16x16x32_bf16 a[56:59], v[12:15], a[188:191], a[56:59]
    v_cndmask_b32_dpp v25, v33, v25, vcc row_shl:5 row_mask:0xf bank_mask:0xf
    v_mfma_f32_16x16x32_bf16 a[56:59], v[36:39], a[160:163], a[56:59]
    v_cndmask_b32_dpp v26, v34, v26, vcc row_shl:5 row_mask:0xf bank_mask:0xf
    v_mfma_f32_16x16x32_bf16 a[56:59], v[40:43], a[164:167], a[56:59]
    buffer_load_dwordx4 v[76:79], v1, s[12:15], s41 offen offset:0
    v_mfma_f32_16x16x32_bf16 a[56:59], v[44:47], a[168:171], a[56:59]
    v_cndmask_b32_dpp v27, v35, v27, vcc row_shl:5 row_mask:0xf bank_mask:0xf
    s_waitcnt vmcnt(6)
    v_mfma_f32_16x16x32_bf16 a[56:59], v[52:55], a[172:175], a[56:59]
    v_mov_b32_dpp v12, v12 row_shr:1 row_mask:0xf bank_mask:0xf
    v_mfma_f32_16x16x32_bf16 a[88:91], v[52:55], a[176:179], 0
    v_mov_b32_dpp v13, v13 row_shr:1 row_mask:0xf bank_mask:0xf
    v_mfma_f32_16x16x32_bf16 a[88:91], v[44:47], a[180:183], a[88:91]
    v_mov_b32_dpp v14, v14 row_shr:1 row_mask:0xf bank_mask:0xf
    v_mfma_f32_16x16x32_bf16 a[88:91], v[40:43], a[184:187], a[88:91]
    buffer_load_dwordx4 a[192:195], v1, s[16:19], s40 offen offset:0
    v_mfma_f32_16x16x32_bf16 a[88:91], v[36:39], a[188:191], a[88:91]
    v_mov_b32_dpp v15, v15 row_shr:1 row_mask:0xf bank_mask:0xf
    v_mfma_f32_16x16x32_bf16 a[20:23], v[16:19], a[160:163], 0
    v_cndmask_b32_dpp v12, v28, v12, vcc row_shl:4 row_mask:0xf bank_mask:0xf
    v_mfma_f32_16x16x32_bf16 a[20:23], v[20:23], a[164:167], a[20:23]
    v_cndmask_b32_dpp v13, v29, v13, vcc row_shl:4 row_mask:0xf bank_mask:0xf
    v_mfma_f32_16x16x32_bf16 a[20:23], v[48:51], a[168:171], a[20:23]
    v_cndmask_b32_dpp v14, v30, v14, vcc row_shl:4 row_mask:0xf bank_mask:0xf
    s_waitcnt vmcnt(6)
    v_mfma_f32_16x16x32_bf16 a[20:23], v[56:59], a[172:175], a[20:23]
    buffer_load_dwordx4 a[196:199], v1, s[16:19], s40 offen offset:1024
    v_mfma_f32_16x16x32_bf16 a[52:55], v[56:59], a[176:179], 0
    v_cndmask_b32_dpp v15, v31, v15, vcc row_shl:4 row_mask:0xf bank_mask:0xf
    v_mfma_f32_16x16x32_bf16 a[52:55], v[48:51], a[180:183], a[52:55]
    v_mov_b32_dpp v36, v36 row_shr:1 row_mask:0xf bank_mask:0xf
    v_mfma_f32_16x16x32_bf16 a[52:55], v[20:23], a[184:187], a[52:55]
    v_mov_b32_dpp v37, v37 row_shr:1 row_mask:0xf bank_mask:0xf
    v_mfma_f32_16x16x32_bf16 a[52:55], v[16:19], a[188:191], a[52:55]
    v_mov_b32_dpp v38, v38 row_shr:1 row_mask:0xf bank_mask:0xf
    v_mfma_f32_16x16x32_bf16 a[52:55], v[40:43], a[160:163], a[52:55]
    buffer_load_dwordx4 a[200:203], v1, s[16:19], s40 offen offset:2048
    v_mfma_f32_16x16x32_bf16 a[52:55], v[44:47], a[164:167], a[52:55]
    v_mov_b32_dpp v39, v39 row_shr:1 row_mask:0xf bank_mask:0xf
    v_mfma_f32_16x16x32_bf16 a[52:55], v[52:55], a[168:171], a[52:55]
    v_cndmask_b32_dpp v36, v32, v36, vcc row_shl:4 row_mask:0xf bank_mask:0xf
    s_waitcnt vmcnt(7)
    v_mfma_f32_16x16x32_bf16 a[52:55], v[60:63], a[172:175], a[52:55]
    v_cndmask_b32_dpp v37, v33, v37, vcc row_shl:4 row_mask:0xf bank_mask:0xf
    v_mfma_f32_16x16x32_bf16 a[84:87], v[60:63], a[176:179], 0
    v_cndmask_b32_dpp v38, v34, v38, vcc row_shl:4 row_mask:0xf bank_mask:0xf
    v_mfma_f32_16x16x32_bf16 a[84:87], v[52:55], a[180:183], a[84:87]
    buffer_load_dwordx4 a[204:207], v1, s[16:19], s42 offen offset:1024
    v_mfma_f32_16x16x32_bf16 a[84:87], v[44:47], a[184:187], a[84:87]
    v_cndmask_b32_dpp v39, v35, v39, vcc row_shl:4 row_mask:0xf bank_mask:0xf
    v_mfma_f32_16x16x32_bf16 a[84:87], v[40:43], a[188:191], a[84:87]
    v_mov_b32_dpp v16, v16 row_shr:1 row_mask:0xf bank_mask:0xf
    v_mfma_f32_16x16x32_bf16 a[16:19], v[20:23], a[160:163], 0
    v_mov_b32_dpp v17, v17 row_shr:1 row_mask:0xf bank_mask:0xf
    v_mfma_f32_16x16x32_bf16 a[16:19], v[48:51], a[164:167], a[16:19]
    v_mov_b32_dpp v18, v18 row_shr:1 row_mask:0xf bank_mask:0xf
    v_mfma_f32_16x16x32_bf16 a[16:19], v[56:59], a[168:171], a[16:19]
    buffer_load_dwordx4 a[208:211], v1, s[16:19], s42 offen offset:0
    s_waitcnt vmcnt(8)
    v_mfma_f32_16x16x32_bf16 a[16:19], v[64:67], a[172:175], a[16:19]
    v_mov_b32_dpp v19, v19 row_shr:1 row_mask:0xf bank_mask:0xf
    v_mfma_f32_16x16x32_bf16 a[48:51], v[64:67], a[176:179], 0
    v_cndmask_b32_dpp v16, v28, v16, vcc row_shl:3 row_mask:0xf bank_mask:0xf
    v_mfma_f32_16x16x32_bf16 a[48:51], v[56:59], a[180:183], a[48:51]
    v_cndmask_b32_dpp v17, v29, v17, vcc row_shl:3 row_mask:0xf bank_mask:0xf
    v_mfma_f32_16x16x32_bf16 a[48:51], v[48:51], a[184:187], a[48:51]
    v_cndmask_b32_dpp v18, v30, v18, vcc row_shl:3 row_mask:0xf bank_mask:0xf
    v_mfma_f32_16x16x32_bf16 a[48:51], v[20:23], a[188:191], a[48:51]
    buffer_load_dwordx4 a[212:215], v1, s[16:19], s41 offen offset:3072
    v_mfma_f32_16x16x32_bf16 a[48:51], v[44:47], a[160:163], a[48:51]
    v_cndmask_b32_dpp v19, v31, v19, vcc row_shl:3 row_mask:0xf bank_mask:0xf
    v_mfma_f32_16x16x32_bf16 a[48:51], v[52:55], a[164:167], a[48:51]
    v_mov_b32_dpp v40, v40 row_shr:1 row_mask:0xf bank_mask:0xf
    v_mfma_f32_16x16x32_bf16 a[48:51], v[60:63], a[168:171], a[48:51]
    v_mov_b32_dpp v41, v41 row_shr:1 row_mask:0xf bank_mask:0xf
    s_waitcnt vmcnt(8)
    v_mfma_f32_16x16x32_bf16 a[48:51], v[68:71], a[172:175], a[48:51]
    v_mov_b32_dpp v42, v42 row_shr:1 row_mask:0xf bank_mask:0xf
    v_mfma_f32_16x16x32_bf16 a[80:83], v[68:71], a[176:179], 0
    buffer_load_dwordx4 v[80:83], v2, s[20:23], s43 offen offset:0
    v_mfma_f32_16x16x32_bf16 a[80:83], v[60:63], a[180:183], a[80:83]
    v_mov_b32_dpp v43, v43 row_shr:1 row_mask:0xf bank_mask:0xf
    v_mfma_f32_16x16x32_bf16 a[80:83], v[52:55], a[184:187], a[80:83]
    v_cndmask_b32_dpp v40, v32, v40, vcc row_shl:3 row_mask:0xf bank_mask:0xf
    v_mfma_f32_16x16x32_bf16 a[80:83], v[44:47], a[188:191], a[80:83]
    v_cndmask_b32_dpp v41, v33, v41, vcc row_shl:3 row_mask:0xf bank_mask:0xf
    v_mfma_f32_16x16x32_bf16 a[12:15], v[48:51], a[160:163], 0
    v_cndmask_b32_dpp v42, v34, v42, vcc row_shl:3 row_mask:0xf bank_mask:0xf
    v_mfma_f32_16x16x32_bf16 a[12:15], v[56:59], a[164:167], a[12:15]
    buffer_load_dwordx4 v[84:87], v1, s[12:15], s44 offen offset:3072
    v_mfma_f32_16x16x32_bf16 a[12:15], v[64:67], a[168:171], a[12:15]
    v_cndmask_b32_dpp v43, v35, v43, vcc row_shl:3 row_mask:0xf bank_mask:0xf
    s_waitcnt vmcnt(9)
    v_mfma_f32_16x16x32_bf16 a[12:15], v[72:75], a[172:175], a[12:15]
    v_mov_b32_dpp v20, v20 row_shr:1 row_mask:0xf bank_mask:0xf
    v_mfma_f32_16x16x32_bf16 a[44:47], v[72:75], a[176:179], 0
    v_mov_b32_dpp v21, v21 row_shr:1 row_mask:0xf bank_mask:0xf
    v_mfma_f32_16x16x32_bf16 a[44:47], v[64:67], a[180:183], a[44:47]
    v_mov_b32_dpp v22, v22 row_shr:1 row_mask:0xf bank_mask:0xf
    v_mfma_f32_16x16x32_bf16 a[44:47], v[56:59], a[184:187], a[44:47]
    buffer_load_dwordx4 a[216:219], v1, s[16:19], s42 offen offset:2048
    v_mfma_f32_16x16x32_bf16 a[44:47], v[48:51], a[188:191], a[44:47]
    v_mov_b32_dpp v23, v23 row_shr:1 row_mask:0xf bank_mask:0xf
    v_mfma_f32_16x16x32_bf16 a[44:47], v[52:55], a[160:163], a[44:47]
    v_cndmask_b32_dpp v20, v28, v20, vcc row_shl:2 row_mask:0xf bank_mask:0xf
    v_mfma_f32_16x16x32_bf16 a[44:47], v[60:63], a[164:167], a[44:47]
    v_cndmask_b32_dpp v21, v29, v21, vcc row_shl:2 row_mask:0xf bank_mask:0xf
    v_mfma_f32_16x16x32_bf16 a[44:47], v[68:71], a[168:171], a[44:47]
    v_cndmask_b32_dpp v22, v30, v22, vcc row_shl:2 row_mask:0xf bank_mask:0xf
    s_waitcnt vmcnt(9)
    v_mfma_f32_16x16x32_bf16 a[44:47], v[76:79], a[172:175], a[44:47]
    buffer_load_dwordx4 v[88:91], v1, s[12:15], s44 offen offset:2048
    v_mfma_f32_16x16x32_bf16 a[76:79], v[76:79], a[176:179], 0
    v_cndmask_b32_dpp v23, v31, v23, vcc row_shl:2 row_mask:0xf bank_mask:0xf
    v_mfma_f32_16x16x32_bf16 a[76:79], v[68:71], a[180:183], a[76:79]
    v_mov_b32_dpp v44, v44 row_shr:1 row_mask:0xf bank_mask:0xf
    v_mfma_f32_16x16x32_bf16 a[76:79], v[60:63], a[184:187], a[76:79]
    v_mov_b32_dpp v45, v45 row_shr:1 row_mask:0xf bank_mask:0xf
    v_mfma_f32_16x16x32_bf16 a[76:79], v[52:55], a[188:191], a[76:79]
    v_mov_b32_dpp v46, v46 row_shr:1 row_mask:0xf bank_mask:0xf
    v_mfma_f32_16x16x32_bf16 a[8:11], v[56:59], a[160:163], 0
    buffer_load_dwordx4 a[220:223], v1, s[16:19], s42 offen offset:3072
    v_mfma_f32_16x16x32_bf16 a[8:11], v[64:67], a[164:167], a[8:11]
    v_mov_b32_dpp v47, v47 row_shr:1 row_mask:0xf bank_mask:0xf
    v_mfma_f32_16x16x32_bf16 a[8:11], v[72:75], a[168:171], a[8:11]
    v_cndmask_b32_dpp v44, v32, v44, vcc row_shl:2 row_mask:0xf bank_mask:0xf
    v_mfma_f32_16x16x32_bf16 a[8:11], v[8:11], a[172:175], a[8:11]
    v_cndmask_b32_dpp v45, v33, v45, vcc row_shl:2 row_mask:0xf bank_mask:0xf
    v_mfma_f32_16x16x32_bf16 a[40:43], v[8:11], a[176:179], 0
    v_cndmask_b32_dpp v46, v34, v46, vcc row_shl:2 row_mask:0xf bank_mask:0xf
    v_mfma_f32_16x16x32_bf16 a[40:43], v[72:75], a[180:183], a[40:43]
    buffer_load_dwordx4 v[92:95], v1, s[12:15], s44 offen offset:1024
    v_mfma_f32_16x16x32_bf16 a[40:43], v[64:67], a[184:187], a[40:43]
    v_cndmask_b32_dpp v47, v35, v47, vcc row_shl:2 row_mask:0xf bank_mask:0xf
    v_mfma_f32_16x16x32_bf16 a[40:43], v[56:59], a[188:191], a[40:43]
    v_mfma_f32_16x16x32_bf16 a[40:43], v[60:63], a[160:163], a[40:43]
    v_mfma_f32_16x16x32_bf16 a[40:43], v[68:71], a[164:167], a[40:43]
    v_mfma_f32_16x16x32_bf16 a[40:43], v[76:79], a[168:171], a[40:43]
    buffer_load_dwordx4 a[224:227], v1, s[16:19], s43 offen offset:0
    v_mfma_f32_16x16x32_bf16 a[40:43], v[24:27], a[172:175], a[40:43]
    v_mfma_f32_16x16x32_bf16 a[72:75], v[24:27], a[176:179], 0
    v_mfma_f32_16x16x32_bf16 a[72:75], v[76:79], a[180:183], a[72:75]
    v_mfma_f32_16x16x32_bf16 a[72:75], v[68:71], a[184:187], a[72:75]
    v_mfma_f32_16x16x32_bf16 a[72:75], v[60:63], a[188:191], a[72:75]
    buffer_load_dwordx4 v[96:99], v1, s[12:15], s44 offen offset:0
    v_mfma_f32_16x16x32_bf16 a[4:7], v[64:67], a[160:163], 0
    v_mfma_f32_16x16x32_bf16 a[4:7], v[72:75], a[164:167], a[4:7]
    v_mfma_f32_16x16x32_bf16 a[4:7], v[8:11], a[168:171], a[4:7]
    v_mfma_f32_16x16x32_bf16 a[4:7], v[12:15], a[172:175], a[4:7]
    v_mfma_f32_16x16x32_bf16 a[36:39], v[12:15], a[176:179], 0
    buffer_load_dwordx4 a[228:231], v1, s[16:19], s43 offen offset:1024
    v_mfma_f32_16x16x32_bf16 a[36:39], v[8:11], a[180:183], a[36:39]
    v_mfma_f32_16x16x32_bf16 a[36:39], v[72:75], a[184:187], a[36:39]
    v_mfma_f32_16x16x32_bf16 a[36:39], v[64:67], a[188:191], a[36:39]
    v_mfma_f32_16x16x32_bf16 a[36:39], v[68:71], a[160:163], a[36:39]
    v_mfma_f32_16x16x32_bf16 a[36:39], v[76:79], a[164:167], a[36:39]
    buffer_load_dwordx4 v[100:103], v1, s[12:15], s43 offen offset:3072
    v_mfma_f32_16x16x32_bf16 a[36:39], v[24:27], a[168:171], a[36:39]
    v_mfma_f32_16x16x32_bf16 a[36:39], v[36:39], a[172:175], a[36:39]
    v_mfma_f32_16x16x32_bf16 a[68:71], v[36:39], a[176:179], 0
    v_mfma_f32_16x16x32_bf16 a[68:71], v[24:27], a[180:183], a[68:71]
    v_mfma_f32_16x16x32_bf16 a[68:71], v[76:79], a[184:187], a[68:71]
    buffer_load_dwordx4 a[232:235], v1, s[16:19], s43 offen offset:2048
    v_mfma_f32_16x16x32_bf16 a[68:71], v[68:71], a[188:191], a[68:71]
    v_mfma_f32_16x16x32_bf16 a[0:3], v[72:75], a[160:163], 0
    v_mfma_f32_16x16x32_bf16 a[0:3], v[8:11], a[164:167], a[0:3]
    v_mfma_f32_16x16x32_bf16 a[0:3], v[12:15], a[168:171], a[0:3]
    v_mfma_f32_16x16x32_bf16 a[0:3], v[16:19], a[172:175], a[0:3]
    buffer_load_dwordx4 v[104:107], v1, s[12:15], s43 offen offset:2048
    v_mfma_f32_16x16x32_bf16 a[32:35], v[16:19], a[176:179], 0
    v_mfma_f32_16x16x32_bf16 a[32:35], v[12:15], a[180:183], a[32:35]
    v_mfma_f32_16x16x32_bf16 a[32:35], v[8:11], a[184:187], a[32:35]
    v_mfma_f32_16x16x32_bf16 a[32:35], v[72:75], a[188:191], a[32:35]
    v_mfma_f32_16x16x32_bf16 a[32:35], v[76:79], a[160:163], a[32:35]
    buffer_load_dwordx4 a[236:239], v1, s[16:19], s43 offen offset:3072
    v_mfma_f32_16x16x32_bf16 a[32:35], v[24:27], a[164:167], a[32:35]
    v_mfma_f32_16x16x32_bf16 a[32:35], v[36:39], a[168:171], a[32:35]
    v_mfma_f32_16x16x32_bf16 a[32:35], v[40:43], a[172:175], a[32:35]
    v_mfma_f32_16x16x32_bf16 a[64:67], v[40:43], a[176:179], 0
    v_mfma_f32_16x16x32_bf16 a[64:67], v[36:39], a[180:183], a[64:67]
    buffer_load_dwordx4 v[108:111], v1, s[12:15], s43 offen offset:1024
    v_mfma_f32_16x16x32_bf16 a[64:67], v[24:27], a[184:187], a[64:67]
    v_mfma_f32_16x16x32_bf16 a[64:67], v[76:79], a[188:191], a[64:67]
    s_waitcnt vmcnt(18)
    v_mfma_f32_16x16x32_bf16 a[28:31], v[48:51], a[192:195], a[28:31]
    v_mfma_f32_16x16x32_bf16 a[28:31], v[56:59], a[196:199], a[28:31]
    s_waitcnt vmcnt(17)
    v_mfma_f32_16x16x32_bf16 a[28:31], v[64:67], a[200:203], a[28:31]
    buffer_load_dwordx4 a[240:243], v1, s[16:19], s44 offen offset:0
    s_waitcnt vmcnt(17)
    v_mfma_f32_16x16x32_bf16 a[60:63], v[64:67], a[204:207], a[60:63]
    s_waitcnt vmcnt(16)
    v_mfma_f32_16x16x32_bf16 a[60:63], v[56:59], a[208:211], a[60:63]
    s_waitcnt vmcnt(15)
    v_mfma_f32_16x16x32_bf16 a[60:63], v[48:51], a[212:215], a[60:63]
    v_mov_b32_dpp v48, v48 row_shr:1 row_mask:0xf bank_mask:0xf
    v_mfma_f32_16x16x32_bf16 a[60:63], v[52:55], a[192:195], a[60:63]
    v_mov_b32_dpp v49, v49 row_shr:1 row_mask:0xf bank_mask:0xf
    v_mfma_f32_16x16x32_bf16 a[60:63], v[60:63], a[196:199], a[60:63]
    buffer_load_dwordx4 v[112:115], v1, s[12:15], s43 offen offset:0
    v_mfma_f32_16x16x32_bf16 a[60:63], v[68:71], a[200:203], a[60:63]
    v_mov_b32_dpp v50, v50 row_shr:1 row_mask:0xf bank_mask:0xf
    v_mfma_f32_16x16x32_bf16 a[92:95], v[68:71], a[204:207], a[92:95]
    v_mov_b32_dpp v51, v51 row_shr:1 row_mask:0xf bank_mask:0xf
    v_mfma_f32_16x16x32_bf16 a[92:95], v[60:63], a[208:211], a[92:95]
    v_cndmask_b32_dpp v48, v28, v48, vcc row_shl:1 row_mask:0xf bank_mask:0xf
    v_mfma_f32_16x16x32_bf16 a[92:95], v[52:55], a[212:215], a[92:95]
    v_cndmask_b32_dpp v49, v29, v49, vcc row_shl:1 row_mask:0xf bank_mask:0xf
    v_mfma_f32_16x16x32_bf16 a[24:27], v[56:59], a[192:195], a[24:27]
    buffer_load_dwordx4 v[116:119], v2, s[20:23], s45 offen offset:0
    v_mfma_f32_16x16x32_bf16 a[24:27], v[64:67], a[196:199], a[24:27]
    v_cndmask_b32_dpp v50, v30, v50, vcc row_shl:1 row_mask:0xf bank_mask:0xf
    v_mfma_f32_16x16x32_bf16 a[24:27], v[72:75], a[200:203], a[24:27]
    v_cndmask_b32_dpp v51, v31, v51, vcc row_shl:1 row_mask:0xf bank_mask:0xf
    v_mfma_f32_16x16x32_bf16 a[56:59], v[72:75], a[204:207], a[56:59]
    v_mov_b32_dpp v52, v52 row_shr:1 row_mask:0xf bank_mask:0xf
    v_mfma_f32_16x16x32_bf16 a[56:59], v[64:67], a[208:211], a[56:59]
    v_mov_b32_dpp v53, v53 row_shr:1 row_mask:0xf bank_mask:0xf
    v_mfma_f32_16x16x32_bf16 a[56:59], v[56:59], a[212:215], a[56:59]
    buffer_load_dwordx4 v[120:123], v1, s[12:15], s46 offen offset:3072
    v_mfma_f32_16x16x32_bf16 a[56:59], v[60:63], a[192:195], a[56:59]
    v_mov_b32_dpp v54, v54 row_shr:1 row_mask:0xf bank_mask:0xf
    v_mfma_f32_16x16x32_bf16 a[56:59], v[68:71], a[196:199], a[56:59]
    v_mov_b32_dpp v55, v55 row_shr:1 row_mask:0xf bank_mask:0xf
    v_mfma_f32_16x16x32_bf16 a[56:59], v[76:79], a[200:203], a[56:59]
    v_cndmask_b32_dpp v52, v32, v52, vcc row_shl:1 row_mask:0xf bank_mask:0xf
    v_mfma_f32_16x16x32_bf16 a[88:91], v[76:79], a[204:207], a[88:91]
    v_cndmask_b32_dpp v53, v33, v53, vcc row_shl:1 row_mask:0xf bank_mask:0xf
    v_mfma_f32_16x16x32_bf16 a[88:91], v[68:71], a[208:211], a[88:91]
    buffer_load_dwordx4 a[244:247], v1, s[16:19], s44 offen offset:1024
    v_mfma_f32_16x16x32_bf16 a[88:91], v[60:63], a[212:215], a[88:91]
    v_cndmask_b32_dpp v54, v34, v54, vcc row_shl:1 row_mask:0xf bank_mask:0xf
    v_mfma_f32_16x16x32_bf16 a[20:23], v[64:67], a[192:195], a[20:23]
    v_cndmask_b32_dpp v55, v35, v55, vcc row_shl:1 row_mask:0xf bank_mask:0xf
    v_mfma_f32_16x16x32_bf16 a[20:23], v[72:75], a[196:199], a[20:23]
    v_mov_b32_dpp v56, v56 row_shr:1 row_mask:0xf bank_mask:0xf
    v_mfma_f32_16x16x32_bf16 a[20:23], v[8:11], a[200:203], a[20:23]
    v_mov_b32_dpp v57, v57 row_shr:1 row_mask:0xf bank_mask:0xf
    v_mfma_f32_16x16x32_bf16 a[52:55], v[8:11], a[204:207], a[52:55]
    buffer_load_dwordx4 v[124:127], v1, s[12:15], s46 offen offset:2048
    v_mfma_f32_16x16x32_bf16 a[52:55], v[72:75], a[208:211], a[52:55]
    v_mov_b32_dpp v58, v58 row_shr:1 row_mask:0xf bank_mask:0xf
    v_mfma_f32_16x16x32_bf16 a[52:55], v[64:67], a[212:215], a[52:55]
    v_mov_b32_dpp v59, v59 row_shr:1 row_mask:0xf bank_mask:0xf
    v_mfma_f32_16x16x32_bf16 a[52:55], v[68:71], a[192:195], a[52:55]
    v_cndmask_b32 v56, v28, v56, vcc
    v_mfma_f32_16x16x32_bf16 a[52:55], v[76:79], a[196:199], a[52:55]
    v_cndmask_b32 v57, v29, v57, vcc
    v_mfma_f32_16x16x32_bf16 a[52:55], v[24:27], a[200:203], a[52:55]
    buffer_load_dwordx4 a[248:251], v1, s[16:19], s44 offen offset:2048
    v_mfma_f32_16x16x32_bf16 a[84:87], v[24:27], a[204:207], a[84:87]
    v_cndmask_b32 v58, v30, v58, vcc
    v_mfma_f32_16x16x32_bf16 a[84:87], v[76:79], a[208:211], a[84:87]
    v_cndmask_b32 v59, v31, v59, vcc
    v_mfma_f32_16x16x32_bf16 a[84:87], v[68:71], a[212:215], a[84:87]
    v_mov_b32_dpp v60, v60 row_shr:1 row_mask:0xf bank_mask:0xf
    v_mfma_f32_16x16x32_bf16 a[16:19], v[72:75], a[192:195], a[16:19]
    v_mov_b32_dpp v61, v61 row_shr:1 row_mask:0xf bank_mask:0xf
    v_mfma_f32_16x16x32_bf16 a[16:19], v[8:11], a[196:199], a[16:19]
    buffer_load_dwordx4 v[128:131], v1, s[12:15], s46 offen offset:1024
    v_mfma_f32_16x16x32_bf16 a[16:19], v[12:15], a[200:203], a[16:19]
    v_mov_b32_dpp v62, v62 row_shr:1 row_mask:0xf bank_mask:0xf
    v_mfma_f32_16x16x32_bf16 a[48:51], v[12:15], a[204:207], a[48:51]
    v_mov_b32_dpp v63, v63 row_shr:1 row_mask:0xf bank_mask:0xf
    v_mfma_f32_16x16x32_bf16 a[48:51], v[8:11], a[208:211], a[48:51]
    v_cndmask_b32 v60, v32, v60, vcc
    v_mfma_f32_16x16x32_bf16 a[48:51], v[72:75], a[212:215], a[48:51]
    v_cndmask_b32 v61, v33, v61, vcc
    v_mfma_f32_16x16x32_bf16 a[48:51], v[76:79], a[192:195], a[48:51]
    buffer_load_dwordx4 a[252:255], v1, s[16:19], s44 offen offset:3072
    v_mfma_f32_16x16x32_bf16 a[48:51], v[24:27], a[196:199], a[48:51]
    v_cndmask_b32 v62, v34, v62, vcc
    v_mfma_f32_16x16x32_bf16 a[48:51], v[36:39], a[200:203], a[48:51]
    v_cndmask_b32 v63, v35, v63, vcc
    v_mfma_f32_16x16x32_bf16 a[80:83], v[36:39], a[204:207], a[80:83]
    v_mfma_f32_16x16x32_bf16 a[80:83], v[24:27], a[208:211], a[80:83]
    v_mfma_f32_16x16x32_bf16 a[80:83], v[76:79], a[212:215], a[80:83]
    buffer_load_dwordx4 v[132:135], v1, s[12:15], s46 offen offset:0
    v_mfma_f32_16x16x32_bf16 a[12:15], v[8:11], a[192:195], a[12:15]
    v_mfma_f32_16x16x32_bf16 a[12:15], v[12:15], a[196:199], a[12:15]
    v_mfma_f32_16x16x32_bf16 a[12:15], v[16:19], a[200:203], a[12:15]
    v_mfma_f32_16x16x32_bf16 a[44:47], v[16:19], a[204:207], a[44:47]
    v_mfma_f32_16x16x32_bf16 a[44:47], v[12:15], a[208:211], a[44:47]
    buffer_load_dwordx4 a[160:163], v1, s[16:19], s45 offen offset:0
    v_mfma_f32_16x16x32_bf16 a[44:47], v[8:11], a[212:215], a[44:47]
    v_mfma_f32_16x16x32_bf16 a[44:47], v[24:27], a[192:195], a[44:47]
    v_mfma_f32_16x16x32_bf16 a[44:47], v[36:39], a[196:199], a[44:47]
    v_mfma_f32_16x16x32_bf16 a[44:47], v[40:43], a[200:203], a[44:47]
    v_mfma_f32_16x16x32_bf16 a[76:79], v[40:43], a[204:207], a[76:79]
    buffer_load_dwordx4 v[136:139], v1, s[12:15], s45 offen offset:3072
    v_mfma_f32_16x16x32_bf16 a[76:79], v[36:39], a[208:211], a[76:79]
    v_mfma_f32_16x16x32_bf16 a[76:79], v[24:27], a[212:215], a[76:79]
    v_mfma_f32_16x16x32_bf16 a[8:11], v[12:15], a[192:195], a[8:11]
    v_mfma_f32_16x16x32_bf16 a[8:11], v[16:19], a[196:199], a[8:11]
    v_mfma_f32_16x16x32_bf16 a[8:11], v[20:23], a[200:203], a[8:11]
    buffer_load_dwordx4 a[164:167], v1, s[16:19], s45 offen offset:1024
    v_mfma_f32_16x16x32_bf16 a[40:43], v[20:23], a[204:207], a[40:43]
    v_mfma_f32_16x16x32_bf16 a[40:43], v[16:19], a[208:211], a[40:43]
    v_mfma_f32_16x16x32_bf16 a[40:43], v[12:15], a[212:215], a[40:43]
    v_mfma_f32_16x16x32_bf16 a[40:43], v[36:39], a[192:195], a[40:43]
    v_mfma_f32_16x16x32_bf16 a[40:43], v[40:43], a[196:199], a[40:43]
    buffer_load_dwordx4 v[140:143], v1, s[12:15], s45 offen offset:2048
    v_mfma_f32_16x16x32_bf16 a[40:43], v[44:47], a[200:203], a[40:43]
    v_mfma_f32_16x16x32_bf16 a[72:75], v[44:47], a[204:207], a[72:75]
    v_mfma_f32_16x16x32_bf16 a[72:75], v[40:43], a[208:211], a[72:75]
    v_mfma_f32_16x16x32_bf16 a[72:75], v[36:39], a[212:215], a[72:75]
    v_mfma_f32_16x16x32_bf16 a[4:7], v[16:19], a[192:195], a[4:7]
    buffer_load_dwordx4 a[168:171], v1, s[16:19], s45 offen offset:2048
    v_mfma_f32_16x16x32_bf16 a[4:7], v[20:23], a[196:199], a[4:7]
    v_mfma_f32_16x16x32_bf16 a[4:7], v[48:51], a[200:203], a[4:7]
    v_mfma_f32_16x16x32_bf16 a[36:39], v[48:51], a[204:207], a[36:39]
    v_mfma_f32_16x16x32_bf16 a[36:39], v[20:23], a[208:211], a[36:39]
    v_mfma_f32_16x16x32_bf16 a[36:39], v[16:19], a[212:215], a[36:39]
    buffer_load_dwordx4 v[144:147], v1, s[12:15], s45 offen offset:1024
    v_mfma_f32_16x16x32_bf16 a[36:39], v[40:43], a[192:195], a[36:39]
    v_mfma_f32_16x16x32_bf16 a[36:39], v[44:47], a[196:199], a[36:39]
    v_mfma_f32_16x16x32_bf16 a[36:39], v[52:55], a[200:203], a[36:39]
    v_mfma_f32_16x16x32_bf16 a[68:71], v[52:55], a[204:207], a[68:71]
    v_mfma_f32_16x16x32_bf16 a[68:71], v[44:47], a[208:211], a[68:71]
    buffer_load_dwordx4 a[172:175], v1, s[16:19], s45 offen offset:3072
    v_mfma_f32_16x16x32_bf16 a[68:71], v[40:43], a[212:215], a[68:71]
    v_mfma_f32_16x16x32_bf16 a[0:3], v[20:23], a[192:195], a[0:3]
    v_mfma_f32_16x16x32_bf16 a[0:3], v[48:51], a[196:199], a[0:3]
    v_mfma_f32_16x16x32_bf16 a[0:3], v[56:59], a[200:203], a[0:3]
    v_mfma_f32_16x16x32_bf16 a[32:35], v[56:59], a[204:207], a[32:35]
    buffer_load_dwordx4 v[148:151], v1, s[12:15], s45 offen offset:0
    v_mfma_f32_16x16x32_bf16 a[32:35], v[48:51], a[208:211], a[32:35]
    v_mfma_f32_16x16x32_bf16 a[32:35], v[20:23], a[212:215], a[32:35]
    v_mfma_f32_16x16x32_bf16 a[32:35], v[44:47], a[192:195], a[32:35]
    v_mfma_f32_16x16x32_bf16 a[32:35], v[52:55], a[196:199], a[32:35]
    v_mfma_f32_16x16x32_bf16 a[32:35], v[60:63], a[200:203], a[32:35]
    buffer_load_dwordx4 v[152:155], v2, s[20:23], s47 offen offset:0
    v_mfma_f32_16x16x32_bf16 a[64:67], v[60:63], a[204:207], a[64:67]
    v_mfma_f32_16x16x32_bf16 a[64:67], v[52:55], a[208:211], a[64:67]
    v_mfma_f32_16x16x32_bf16 a[64:67], v[44:47], a[212:215], a[64:67]
    s_waitcnt vmcnt(18)
    v_mfma_f32_16x16x32_bf16 a[124:127], v[84:87], a[216:219], 0
    v_mov_b32_dpp v84, v84 row_shr:1 row_mask:0xf bank_mask:0xf
    v_mov_b32_dpp v85, v85 row_shr:1 row_mask:0xf bank_mask:0xf
    v_mfma_f32_16x16x32_bf16 a[124:127], v[88:91], a[220:223], a[124:127]
    buffer_load_dwordx4 v[156:159], v2, s[20:23], s49 offen offset:0
    v_mov_b32_dpp v86, v86 row_shr:1 row_mask:0xf bank_mask:0xf
    v_mfma_f32_16x16x32_bf16 a[124:127], v[92:95], a[224:227], a[124:127]
    v_mov_b32_dpp v87, v87 row_shr:1 row_mask:0xf bank_mask:0xf
    v_cndmask_b32_dpp v84, v80, v84, vcc row_shl:5 row_mask:0xf bank_mask:0xf
    v_mfma_f32_16x16x32_bf16 a[124:127], v[96:99], a[228:231], a[124:127]
    v_cndmask_b32_dpp v85, v81, v85, vcc row_shl:5 row_mask:0xf bank_mask:0xf
    v_cndmask_b32_dpp v86, v82, v86, vcc row_shl:5 row_mask:0xf bank_mask:0xf
    v_mfma_f32_16x16x32_bf16 a[124:127], v[100:103], a[232:235], a[124:127]
    v_cndmask_b32_dpp v87, v83, v87, vcc row_shl:5 row_mask:0xf bank_mask:0xf
    v_mfma_f32_16x16x32_bf16 a[124:127], v[104:107], a[236:239], a[124:127]
    v_mfma_f32_16x16x32_bf16 a[124:127], v[108:111], a[240:243], a[124:127]
    buffer_load_dwordx4 v[160:163], v1, s[12:15], s48 offen offset:3072
    v_mfma_f32_16x16x32_bf16 a[120:123], v[88:91], a[216:219], 0
    v_mov_b32_dpp v88, v88 row_shr:1 row_mask:0xf bank_mask:0xf
    v_mov_b32_dpp v89, v89 row_shr:1 row_mask:0xf bank_mask:0xf
    v_mfma_f32_16x16x32_bf16 a[120:123], v[92:95], a[220:223], a[120:123]
    v_mov_b32_dpp v90, v90 row_shr:1 row_mask:0xf bank_mask:0xf
    v_mov_b32_dpp v91, v91 row_shr:1 row_mask:0xf bank_mask:0xf
    v_mfma_f32_16x16x32_bf16 a[120:123], v[96:99], a[224:227], a[120:123]
    v_cndmask_b32_dpp v88, v80, v88, vcc row_shl:4 row_mask:0xf bank_mask:0xf
    v_cndmask_b32_dpp v89, v81, v89, vcc row_shl:4 row_mask:0xf bank_mask:0xf
    v_mfma_f32_16x16x32_bf16 a[120:123], v[100:103], a[228:231], a[120:123]
    v_cndmask_b32_dpp v90, v82, v90, vcc row_shl:4 row_mask:0xf bank_mask:0xf
    v_cndmask_b32_dpp v91, v83, v91, vcc row_shl:4 row_mask:0xf bank_mask:0xf
    v_mfma_f32_16x16x32_bf16 a[120:123], v[104:107], a[232:235], a[120:123]
    buffer_load_dwordx4 a[176:179], v1, s[16:19], s46 offen offset:0
    v_mfma_f32_16x16x32_bf16 a[120:123], v[108:111], a[236:239], a[120:123]
    s_waitcnt vmcnt(18)
    v_mfma_f32_16x16x32_bf16 a[120:123], v[112:115], a[240:243], a[120:123]
    v_mfma_f32_16x16x32_bf16 a[116:119], v[92:95], a[216:219], 0
    v_mov_b32_dpp v92, v92 row_shr:1 row_mask:0xf bank_mask:0xf
    v_mov_b32_dpp v93, v93 row_shr:1 row_mask:0xf bank_mask:0xf
    v_mfma_f32_16x16x32_bf16 a[116:119], v[96:99], a[220:223], a[116:119]
    v_mov_b32_dpp v94, v94 row_shr:1 row_mask:0xf bank_mask:0xf
    v_mov_b32_dpp v95, v95 row_shr:1 row_mask:0xf bank_mask:0xf
    v_mfma_f32_16x16x32_bf16 a[116:119], v[100:103], a[224:227], a[116:119]
    buffer_load_dwordx4 v[164:167], v1, s[12:15], s48 offen offset:2048
    v_cndmask_b32_dpp v92, v80, v92, vcc row_shl:3 row_mask:0xf bank_mask:0xf
    v_mfma_f32_16x16x32_bf16 a[116:119], v[104:107], a[228:231], a[116:119]
    v_cndmask_b32_dpp v93, v81, v93, vcc row_shl:3 row_mask:0xf bank_mask:0xf
    v_cndmask_b32_dpp v94, v82, v94, vcc row_shl:3 row_mask:0xf bank_mask:0xf
    v_mfma_f32_16x16x32_bf16 a[116:119], v[108:111], a[232:235], a[116:119]
    v_cndmask_b32_dpp v95, v83, v95, vcc row_shl:3 row_mask:0xf bank_mask:0xf
    v_mfma_f32_16x16x32_bf16 a[116:119], v[112:115], a[236:239], a[116:119]
    v_mfma_f32_16x16x32_bf16 a[116:119], v[84:87], a[240:243], a[116:119]
    v_mfma_f32_16x16x32_bf16 a[112:115], v[96:99], a[216:219], 0
    buffer_load_dwordx4 a[180:183], v1, s[16:19], s46 offen offset:1024
    v_mov_b32_dpp v96, v96 row_shr:1 row_mask:0xf bank_mask:0xf
    v_mfma_f32_16x16x32_bf16 a[112:115], v[100:103], a[220:223], a[112:115]
    v_mov_b32_dpp v97, v97 row_shr:1 row_mask:0xf bank_mask:0xf
    v_mov_b32_dpp v98, v98 row_shr:1 row_mask:0xf bank_mask:0xf
    v_mfma_f32_16x16x32_bf16 a[112:115], v[104:107], a[224:227], a[112:115]
    v_mov_b32_dpp v99, v99 row_shr:1 row_mask:0xf bank_mask:0xf
    v_mfma_f32_16x16x32_bf16 a[112:115], v[108:111], a[228:231], a[112:115]
    v_cndmask_b32_dpp v96, v80, v96, vcc row_shl:2 row_mask:0xf bank_mask:0xf
    v_mfma_f32_16x16x32_bf16 a[112:115], v[112:115], a[232:235], a[112:115]
    v_cndmask_b32_dpp v97, v81, v97, vcc row_shl:2 row_mask:0xf bank_mask:0xf
    v_mfma_f32_16x16x32_bf16 a[112:115], v[84:87], a[236:239], a[112:115]
    buffer_load_dwordx4 v[168:171], v1, s[12:15], s48 offen offset:1024
    v_mfma_f32_16x16x32_bf16 a[112:115], v[88:91], a[240:243], a[112:115]
    v_cndmask_b32_dpp v98, v82, v98, vcc row_shl:2 row_mask:0xf bank_mask:0xf
    v_mfma_f32_16x16x32_bf16 a[108:111], v[100:103], a[216:219], 0
    v_cndmask_b32_dpp v99, v83, v99, vcc row_shl:2 row_mask:0xf bank_mask:0xf
    v_mfma_f32_16x16x32_bf16 a[108:111], v[104:107], a[220:223], a[108:111]
    v_mov_b32_dpp v100, v100 row_shr:1 row_mask:0xf bank_mask:0xf
    v_mfma_f32_16x16x32_bf16 a[108:111], v[108:111], a[224:227], a[108:111]
    v_mov_b32_dpp v101, v101 row_shr:1 row_mask:0xf bank_mask:0xf
    v_mfma_f32_16x16x32_bf16 a[108:111], v[112:115], a[228:231], a[108:111]
    buffer_load_dwordx4 a[184:187], v1, s[16:19], s46 offen offset:2048
    v_mfma_f32_16x16x32_bf16 a[108:111], v[84:87], a[232:235], a[108:111]
    v_mov_b32_dpp v102, v102 row_shr:1 row_mask:0xf bank_mask:0xf
    v_mfma_f32_16x16x32_bf16 a[108:111], v[88:91], a[236:239], a[108:111]
    v_mov_b32_dpp v103, v103 row_shr:1 row_mask:0xf bank_mask:0xf
    v_mfma_f32_16x16x32_bf16 a[108:111], v[92:95], a[240:243], a[108:111]
    v_cndmask_b32_dpp v100, v80, v100, vcc row_shl:1 row_mask:0xf bank_mask:0xf
    v_mfma_f32_16x16x32_bf16 a[104:107], v[104:107], a[216:219], 0
    v_cndmask_b32_dpp v101, v81, v101, vcc row_shl:1 row_mask:0xf bank_mask:0xf
    v_mfma_f32_16x16x32_bf16 a[104:107], v[108:111], a[220:223], a[104:107]
    buffer_load_dwordx4 v[172:175], v1, s[12:15], s48 offen offset:0
    v_mfma_f32_16x16x32_bf16 a[104:107], v[112:115], a[224:227], a[104:107]
    v_cndmask_b32_dpp v102, v82, v102, vcc row_shl:1 row_mask:0xf bank_mask:0xf
    v_mfma_f32_16x16x32_bf16 a[104:107], v[84:87], a[228:231], a[104:107]
    v_cndmask_b32_dpp v103, v83, v103, vcc row_shl:1 row_mask:0xf bank_mask:0xf
    v_mfma_f32_16x16x32_bf16 a[104:107], v[88:91], a[232:235], a[104:107]
    v_mov_b32_dpp v104, v104 row_shr:1 row_mask:0xf bank_mask:0xf
    v_mfma_f32_16x16x32_bf16 a[104:107], v[92:95], a[236:239], a[104:107]
    v_mov_b32_dpp v105, v105 row_shr:1 row_mask:0xf bank_mask:0xf
    v_mfma_f32_16x16x32_bf16 a[104:107], v[96:99], a[240:243], a[104:107]
    buffer_load_dwordx4 a[188:191], v1, s[16:19], s46 offen offset:3072
    v_mfma_f32_16x16x32_bf16 a[100:103], v[108:111], a[216:219], 0
    v_mov_b32_dpp v106, v106 row_shr:1 row_mask:0xf bank_mask:0xf
    v_mfma_f32_16x16x32_bf16 a[100:103], v[112:115], a[220:223], a[100:103]
    v_mov_b32_dpp v107, v107 row_shr:1 row_mask:0xf bank_mask:0xf
    v_mfma_f32_16x16x32_bf16 a[100:103], v[84:87], a[224:227], a[100:103]
    v_cndmask_b32 v104, v80, v104, vcc
    v_cndmask_b32 v105, v81, v105, vcc
    v_mfma_f32_16x16x32_bf16 a[100:103], v[88:91], a[228:231], a[100:103]
    v_cndmask_b32 v106, v82, v106, vcc
    v_cndmask_b32 v107, v83, v107, vcc
    v_mfma_f32_16x16x32_bf16 a[100:103], v[92:95], a[232:235], a[100:103]
    buffer_load_dwordx4 a[192:195], v1, s[16:19], s48 offen offset:2048
    v_mfma_f32_16x16x32_bf16 a[100:103], v[96:99], a[236:239], a[100:103]
    v_mfma_f32_16x16x32_bf16 a[100:103], v[100:103], a[240:243], a[100:103]
    v_mfma_f32_16x16x32_bf16 a[96:99], v[112:115], a[216:219], 0
    v_mfma_f32_16x16x32_bf16 a[96:99], v[84:87], a[220:223], a[96:99]
    v_mfma_f32_16x16x32_bf16 a[96:99], v[88:91], a[224:227], a[96:99]
    buffer_load_dwordx4 a[196:199], v1, s[16:19], s48 offen offset:1024
    v_mfma_f32_16x16x32_bf16 a[96:99], v[92:95], a[228:231], a[96:99]
    v_mfma_f32_16x16x32_bf16 a[96:99], v[96:99], a[232:235], a[96:99]
    v_mfma_f32_16x16x32_bf16 a[96:99], v[100:103], a[236:239], a[96:99]
    v_mfma_f32_16x16x32_bf16 a[96:99], v[104:107], a[240:243], a[96:99]
    s_waitcnt vmcnt(18)
    v_mfma_f32_16x16x32_bf16 a[156:159], v[120:123], a[244:247], 0
    buffer_load_dwordx4 a[200:203], v1, s[16:19], s48 offen offset:0
    v_mov_b32_dpp v120, v120 row_shr:1 row_mask:0xf bank_mask:0xf
    v_mfma_f32_16x16x32_bf16 a[156:159], v[124:127], a[248:251], a[156:159]
    v_mov_b32_dpp v121, v121 row_shr:1 row_mask:0xf bank_mask:0xf
    v_mov_b32_dpp v122, v122 row_shr:1 row_mask:0xf bank_mask:0xf
    v_mfma_f32_16x16x32_bf16 a[156:159], v[128:131], a[252:255], a[156:159]
    v_mov_b32_dpp v123, v123 row_shr:1 row_mask:0xf bank_mask:0xf
    v_cndmask_b32_dpp v120, v116, v120, vcc row_shl:5 row_mask:0xf bank_mask:0xf
    v_mfma_f32_16x16x32_bf16 a[156:159], v[132:135], a[160:163], a[156:159]
    v_cndmask_b32_dpp v121, v117, v121, vcc row_shl:5 row_mask:0xf bank_mask:0xf
    v_cndmask_b32_dpp v122, v118, v122, vcc row_shl:5 row_mask:0xf bank_mask:0xf
    s_waitcnt vmcnt(18)
    v_mfma_f32_16x16x32_bf16 a[156:159], v[136:139], a[164:167], a[156:159]
    v_cndmask_b32_dpp v123, v119, v123, vcc row_shl:5 row_mask:0xf bank_mask:0xf
    s_waitcnt vmcnt(16)
    v_mfma_f32_16x16x32_bf16 a[156:159], v[140:143], a[168:171], a[156:159]
    buffer_load_dwordx4 a[204:207], v1, s[16:19], s47 offen offset:3072
    s_waitcnt vmcnt(15)
    v_mfma_f32_16x16x32_bf16 a[156:159], v[144:147], a[172:175], a[156:159]
    v_mfma_f32_16x16x32_bf16 a[152:155], v[124:127], a[244:247], 0
    v_mov_b32_dpp v124, v124 row_shr:1 row_mask:0xf bank_mask:0xf
    v_mov_b32_dpp v125, v125 row_shr:1 row_mask:0xf bank_mask:0xf
    v_mfma_f32_16x16x32_bf16 a[152:155], v[128:131], a[248:251], a[152:155]
    v_mov_b32_dpp v126, v126 row_shr:1 row_mask:0xf bank_mask:0xf
    v_mov_b32_dpp v127, v127 row_shr:1 row_mask:0xf bank_mask:0xf
    v_mfma_f32_16x16x32_bf16 a[152:155], v[132:135], a[252:255], a[152:155]
    v_cndmask_b32_dpp v124, v116, v124, vcc row_shl:4 row_mask:0xf bank_mask:0xf
    v_cndmask_b32_dpp v125, v117, v125, vcc row_shl:4 row_mask:0xf bank_mask:0xf
    v_mfma_f32_16x16x32_bf16 a[152:155], v[136:139], a[160:163], a[152:155]
    buffer_load_dwordx4 v[176:179], v1, s[12:15], s50 offen offset:3072
    v_cndmask_b32_dpp v126, v118, v126, vcc row_shl:4 row_mask:0xf bank_mask:0xf
    v_mfma_f32_16x16x32_bf16 a[152:155], v[140:143], a[164:167], a[152:155]
    v_cndmask_b32_dpp v127, v119, v127, vcc row_shl:4 row_mask:0xf bank_mask:0xf
    v_mfma_f32_16x16x32_bf16 a[152:155], v[144:147], a[168:171], a[152:155]
    s_waitcnt vmcnt(15)
    v_mfma_f32_16x16x32_bf16 a[152:155], v[148:151], a[172:175], a[152:155]
    v_mfma_f32_16x16x32_bf16 a[148:151], v[128:131], a[244:247], 0
    v_mov_b32_dpp v128, v128 row_shr:1 row_mask:0xf bank_mask:0xf
    v_mov_b32_dpp v129, v129 row_shr:1 row_mask:0xf bank_mask:0xf
    v_mfma_f32_16x16x32_bf16 a[148:151], v[132:135], a[248:251], a[148:151]
    buffer_load_dwordx4 v[180:183], v1, s[12:15], s50 offen offset:2048
    v_mov_b32_dpp v130, v130 row_shr:1 row_mask:0xf bank_mask:0xf
    v_mfma_f32_16x16x32_bf16 a[148:151], v[136:139], a[252:255], a[148:151]
    v_mov_b32_dpp v131, v131 row_shr:1 row_mask:0xf bank_mask:0xf
    v_cndmask_b32_dpp v128, v116, v128, vcc row_shl:3 row_mask:0xf bank_mask:0xf
    v_mfma_f32_16x16x32_bf16 a[148:151], v[140:143], a[160:163], a[148:151]
    v_cndmask_b32_dpp v129, v117, v129, vcc row_shl:3 row_mask:0xf bank_mask:0xf
    v_cndmask_b32_dpp v130, v118, v130, vcc row_shl:3 row_mask:0xf bank_mask:0xf
    v_mfma_f32_16x16x32_bf16 a[148:151], v[144:147], a[164:167], a[148:151]
    v_cndmask_b32_dpp v131, v119, v131, vcc row_shl:3 row_mask:0xf bank_mask:0xf
    v_mfma_f32_16x16x32_bf16 a[148:151], v[148:151], a[168:171], a[148:151]
    v_mfma_f32_16x16x32_bf16 a[148:151], v[120:123], a[172:175], a[148:151]
    buffer_load_dwordx4 v[184:187], v1, s[12:15], s50 offen offset:1024
    v_mfma_f32_16x16x32_bf16 a[144:147], v[132:135], a[244:247], 0
    v_mov_b32_dpp v132, v132 row_shr:1 row_mask:0xf bank_mask:0xf
    v_mov_b32_dpp v133, v133 row_shr:1 row_mask:0xf bank_mask:0xf
    v_mfma_f32_16x16x32_bf16 a[144:147], v[136:139], a[248:251], a[144:147]
    v_mov_b32_dpp v134, v134 row_shr:1 row_mask:0xf bank_mask:0xf
    v_mfma_f32_16x16x32_bf16 a[144:147], v[140:143], a[252:255], a[144:147]
    v_mov_b32_dpp v135, v135 row_shr:1 row_mask:0xf bank_mask:0xf
    v_mfma_f32_16x16x32_bf16 a[144:147], v[144:147], a[160:163], a[144:147]
    v_cndmask_b32_dpp v132, v116, v132, vcc row_shl:2 row_mask:0xf bank_mask:0xf
    v_mfma_f32_16x16x32_bf16 a[144:147], v[148:151], a[164:167], a[144:147]
    buffer_load_dwordx4 v[188:191], v1, s[12:15], s50 offen offset:0
    v_mfma_f32_16x16x32_bf16 a[144:147], v[120:123], a[168:171], a[144:147]
    v_cndmask_b32_dpp v133, v117, v133, vcc row_shl:2 row_mask:0xf bank_mask:0xf
    v_mfma_f32_16x16x32_bf16 a[144:147], v[124:127], a[172:175], a[144:147]
    v_cndmask_b32_dpp v134, v118, v134, vcc row_shl:2 row_mask:0xf bank_mask:0xf
    v_mfma_f32_16x16x32_bf16 a[140:143], v[136:139], a[244:247], 0
    v_cndmask_b32_dpp v135, v119, v135, vcc row_shl:2 row_mask:0xf bank_mask:0xf
    v_mfma_f32_16x16x32_bf16 a[140:143], v[140:143], a[248:251], a[140:143]
    v_mov_b32_dpp v136, v136 row_shr:1 row_mask:0xf bank_mask:0xf
    v_mfma_f32_16x16x32_bf16 a[140:143], v[144:147], a[252:255], a[140:143]
    buffer_load_dwordx4 v[192:195], v1, s[12:15], s47 offen offset:3072
    v_mfma_f32_16x16x32_bf16 a[140:143], v[148:151], a[160:163], a[140:143]
    v_mov_b32_dpp v137, v137 row_shr:1 row_mask:0xf bank_mask:0xf
    v_mfma_f32_16x16x32_bf16 a[140:143], v[120:123], a[164:167], a[140:143]
    v_mov_b32_dpp v138, v138 row_shr:1 row_mask:0xf bank_mask:0xf
    v_mfma_f32_16x16x32_bf16 a[140:143], v[124:127], a[168:171], a[140:143]
    v_mov_b32_dpp v139, v139 row_shr:1 row_mask:0xf bank_mask:0xf
    v_mfma_f32_16x16x32_bf16 a[140:143], v[128:131], a[172:175], a[140:143]
    v_cndmask_b32_dpp v136, v116, v136, vcc row_shl:1 row_mask:0xf bank_mask:0xf
    v_mfma_f32_16x16x32_bf16 a[136:139], v[140:143], a[244:247], 0
    buffer_load_dwordx4 v[196:199], v1, s[12:15], s49 offen offset:3072
    v_mfma_f32_16x16x32_bf16 a[136:139], v[144:147], a[248:251], a[136:139]
    v_cndmask_b32_dpp v137, v117, v137, vcc row_shl:1 row_mask:0xf bank_mask:0xf
    v_mfma_f32_16x16x32_bf16 a[136:139], v[148:151], a[252:255], a[136:139]
    v_cndmask_b32_dpp v138, v118, v138, vcc row_shl:1 row_mask:0xf bank_mask:0xf
    v_mfma_f32_16x16x32_bf16 a[136:139], v[120:123], a[160:163], a[136:139]
    v_cndmask_b32_dpp v139, v119, v139, vcc row_shl:1 row_mask:0xf bank_mask:0xf
    v_mfma_f32_16x16x32_bf16 a[136:139], v[124:127], a[164:167], a[136:139]
    v_mov_b32_dpp v140, v140 row_shr:1 row_mask:0xf bank_mask:0xf
    v_mfma_f32_16x16x32_bf16 a[136:139], v[128:131], a[168:171], a[136:139]
    buffer_load_dwordx4 v[200:203], v1, s[12:15], s47 offen offset:2048
    v_mfma_f32_16x16x32_bf16 a[136:139], v[132:135], a[172:175], a[136:139]
    v_mov_b32_dpp v141, v141 row_shr:1 row_mask:0xf bank_mask:0xf
    v_mfma_f32_16x16x32_bf16 a[132:135], v[144:147], a[244:247], 0
    v_mov_b32_dpp v142, v142 row_shr:1 row_mask:0xf bank_mask:0xf
    v_mfma_f32_16x16x32_bf16 a[132:135], v[148:151], a[248:251], a[132:135]
    v_mov_b32_dpp v143, v143 row_shr:1 row_mask:0xf bank_mask:0xf
    v_mfma_f32_16x16x32_bf16 a[132:135], v[120:123], a[252:255], a[132:135]
    v_cndmask_b32 v140, v116, v140, vcc
    v_mfma_f32_16x16x32_bf16 a[132:135], v[124:127], a[160:163], a[132:135]
    buffer_load_dwordx4 v[204:207], v1, s[12:15], s49 offen offset:2048
    v_mfma_f32_16x16x32_bf16 a[132:135], v[128:131], a[164:167], a[132:135]
    v_cndmask_b32 v141, v117, v141, vcc
    v_mfma_f32_16x16x32_bf16 a[132:135], v[132:135], a[168:171], a[132:135]
    v_cndmask_b32 v142, v118, v142, vcc
    v_mfma_f32_16x16x32_bf16 a[132:135], v[136:139], a[172:175], a[132:135]
    v_cndmask_b32 v143, v119, v143, vcc
    v_mfma_f32_16x16x32_bf16 a[128:131], v[148:151], a[244:247], 0
    v_mfma_f32_16x16x32_bf16 a[128:131], v[120:123], a[248:251], a[128:131]
    buffer_load_dwordx4 v[208:211], v1, s[12:15], s47 offen offset:1024
    v_mfma_f32_16x16x32_bf16 a[128:131], v[124:127], a[252:255], a[128:131]
    v_mfma_f32_16x16x32_bf16 a[128:131], v[128:131], a[160:163], a[128:131]
    v_mfma_f32_16x16x32_bf16 a[128:131], v[132:135], a[164:167], a[128:131]
    v_mfma_f32_16x16x32_bf16 a[128:131], v[136:139], a[168:171], a[128:131]
    v_mfma_f32_16x16x32_bf16 a[128:131], v[140:143], a[172:175], a[128:131]
    buffer_load_dwordx4 v[212:215], v1, s[12:15], s49 offen offset:1024
    s_waitcnt vmcnt(18)
    v_mfma_f32_16x16x32_bf16 a[28:31], v[160:163], a[176:179], a[28:31]
    v_mfma_f32_16x16x32_bf16 a[28:31], v[164:167], a[180:183], a[28:31]
    s_waitcnt vmcnt(16)
    v_mfma_f32_16x16x32_bf16 a[28:31], v[168:171], a[184:187], a[28:31]
    s_waitcnt vmcnt(14)
    v_mfma_f32_16x16x32_bf16 a[28:31], v[172:175], a[188:191], a[28:31]
    s_waitcnt vmcnt(13)
    v_mfma_f32_16x16x32_bf16 a[60:63], v[172:175], a[192:195], a[60:63]
    buffer_load_dwordx4 v[216:219], v1, s[12:15], s47 offen offset:0
    s_waitcnt vmcnt(13)
    v_mfma_f32_16x16x32_bf16 a[60:63], v[168:171], a[196:199], a[60:63]
    s_waitcnt vmcnt(12)
    v_mfma_f32_16x16x32_bf16 a[60:63], v[164:167], a[200:203], a[60:63]
    s_waitcnt vmcnt(11)
    v_mfma_f32_16x16x32_bf16 a[60:63], v[160:163], a[204:207], a[60:63]
    v_mov_b32_dpp v160, v160 row_shr:1 row_mask:0xf bank_mask:0xf
    s_waitcnt vmcnt(10)
    v_mfma_f32_16x16x32_bf16 a[60:63], v[176:179], a[176:179], a[60:63]
    v_mov_b32_dpp v161, v161 row_shr:1 row_mask:0xf bank_mask:0xf
    s_waitcnt vmcnt(9)
    v_mfma_f32_16x16x32_bf16 a[60:63], v[180:183], a[180:183], a[60:63]
    buffer_load_dwordx4 v[220:223], v1, s[12:15], s49 offen offset:0
    s_waitcnt vmcnt(9)
    v_mfma_f32_16x16x32_bf16 a[60:63], v[184:187], a[184:187], a[60:63]
    v_mov_b32_dpp v162, v162 row_shr:1 row_mask:0xf bank_mask:0xf
    s_waitcnt vmcnt(8)
    v_mfma_f32_16x16x32_bf16 a[60:63], v[188:191], a[188:191], a[60:63]
    v_mov_b32_dpp v163, v163 row_shr:1 row_mask:0xf bank_mask:0xf
    v_mfma_f32_16x16x32_bf16 a[92:95], v[188:191], a[192:195], a[92:95]
    v_cndmask_b32_dpp v160, v152, v160, vcc row_shl:5 row_mask:0xf bank_mask:0xf
    v_mfma_f32_16x16x32_bf16 a[92:95], v[184:187], a[196:199], a[92:95]
    v_cndmask_b32_dpp v161, v153, v161, vcc row_shl:5 row_mask:0xf bank_mask:0xf
    v_mfma_f32_16x16x32_bf16 a[92:95], v[180:183], a[200:203], a[92:95]
    buffer_load_dwordx4 a[208:211], v1, s[16:19], s47 offen offset:0
    v_mfma_f32_16x16x32_bf16 a[92:95], v[176:179], a[204:207], a[92:95]
    v_cndmask_b32_dpp v162, v154, v162, vcc row_shl:5 row_mask:0xf bank_mask:0xf
    v_mfma_f32_16x16x32_bf16 a[24:27], v[164:167], a[176:179], a[24:27]
    v_cndmask_b32_dpp v163, v155, v163, vcc row_shl:5 row_mask:0xf bank_mask:0xf
    v_mfma_f32_16x16x32_bf16 a[24:27], v[168:171], a[180:183], a[24:27]
    v_mov_b32_dpp v176, v176 row_shr:1 row_mask:0xf bank_mask:0xf
    v_mfma_f32_16x16x32_bf16 a[24:27], v[172:175], a[184:187], a[24:27]
    v_mov_b32_dpp v177, v177 row_shr:1 row_mask:0xf bank_mask:0xf
    s_waitcnt vmcnt(8)
    v_mfma_f32_16x16x32_bf16 a[24:27], v[192:195], a[188:191], a[24:27]
    buffer_load_dwordx4 a[212:215], v1, s[16:19], s47 offen offset:1024
    v_mfma_f32_16x16x32_bf16 a[56:59], v[192:195], a[192:195], a[56:59]
    v_mov_b32_dpp v178, v178 row_shr:1 row_mask:0xf bank_mask:0xf
    v_mfma_f32_16x16x32_bf16 a[56:59], v[172:175], a[196:199], a[56:59]
    v_mov_b32_dpp v179, v179 row_shr:1 row_mask:0xf bank_mask:0xf
    v_mfma_f32_16x16x32_bf16 a[56:59], v[168:171], a[200:203], a[56:59]
    v_cndmask_b32_dpp v176, v156, v176, vcc row_shl:5 row_mask:0xf bank_mask:0xf
    v_mfma_f32_16x16x32_bf16 a[56:59], v[164:167], a[204:207], a[56:59]
    v_cndmask_b32_dpp v177, v157, v177, vcc row_shl:5 row_mask:0xf bank_mask:0xf
    v_mfma_f32_16x16x32_bf16 a[56:59], v[180:183], a[176:179], a[56:59]
    buffer_load_dwordx4 a[216:219], v1, s[16:19], s47 offen offset:2048
    v_mfma_f32_16x16x32_bf16 a[56:59], v[184:187], a[180:183], a[56:59]
    v_cndmask_b32_dpp v178, v158, v178, vcc row_shl:5 row_mask:0xf bank_mask:0xf
    v_mfma_f32_16x16x32_bf16 a[56:59], v[188:191], a[184:187], a[56:59]
    v_cndmask_b32_dpp v179, v159, v179, vcc row_shl:5 row_mask:0xf bank_mask:0xf
    s_waitcnt vmcnt(9)
    v_mfma_f32_16x16x32_bf16 a[56:59], v[196:199], a[188:191], a[56:59]
    v_mov_b32_dpp v164, v164 row_shr:1 row_mask:0xf bank_mask:0xf
    v_mfma_f32_16x16x32_bf16 a[88:91], v[196:199], a[192:195], a[88:91]
    v_mov_b32_dpp v165, v165 row_shr:1 row_mask:0xf bank_mask:0xf
    v_mfma_f32_16x16x32_bf16 a[88:91], v[188:191], a[196:199], a[88:91]
    buffer_load_dwordx4 a[220:223], v1, s[16:19], s49 offen offset:1024
    v_mfma_f32_16x16x32_bf16 a[88:91], v[184:187], a[200:203], a[88:91]
    v_mov_b32_dpp v166, v166 row_shr:1 row_mask:0xf bank_mask:0xf
    v_mfma_f32_16x16x32_bf16 a[88:91], v[180:183], a[204:207], a[88:91]
    v_mov_b32_dpp v167, v167 row_shr:1 row_mask:0xf bank_mask:0xf
    v_mfma_f32_16x16x32_bf16 a[20:23], v[168:171], a[176:179], a[20:23]
    v_cndmask_b32_dpp v164, v152, v164, vcc row_shl:4 row_mask:0xf bank_mask:0xf
    v_mfma_f32_16x16x32_bf16 a[20:23], v[172:175], a[180:183], a[20:23]
    v_cndmask_b32_dpp v165, v153, v165, vcc row_shl:4 row_mask:0xf bank_mask:0xf
    v_mfma_f32_16x16x32_bf16 a[20:23], v[192:195], a[184:187], a[20:23]
    buffer_load_dwordx4 a[224:227], v1, s[16:19], s49 offen offset:0
    s_waitcnt vmcnt(10)
    v_mfma_f32_16x16x32_bf16 a[20:23], v[200:203], a[188:191], a[20:23]
    v_cndmask_b32_dpp v166, v154, v166, vcc row_shl:4 row_mask:0xf bank_mask:0xf
    v_mfma_f32_16x16x32_bf16 a[52:55], v[200:203], a[192:195], a[52:55]
    v_cndmask_b32_dpp v167, v155, v167, vcc row_shl:4 row_mask:0xf bank_mask:0xf
    v_mfma_f32_16x16x32_bf16 a[52:55], v[192:195], a[196:199], a[52:55]
    v_mov_b32_dpp v180, v180 row_shr:1 row_mask:0xf bank_mask:0xf
    v_mfma_f32_16x16x32_bf16 a[52:55], v[172:175], a[200:203], a[52:55]
    v_mov_b32_dpp v181, v181 row_shr:1 row_mask:0xf bank_mask:0xf
    v_mfma_f32_16x16x32_bf16 a[52:55], v[168:171], a[204:207], a[52:55]
    buffer_load_dwordx4 a[228:231], v1, s[16:19], s48 offen offset:3072
    v_mfma_f32_16x16x32_bf16 a[52:55], v[184:187], a[176:179], a[52:55]
    v_mov_b32_dpp v182, v182 row_shr:1 row_mask:0xf bank_mask:0xf
    v_mfma_f32_16x16x32_bf16 a[52:55], v[188:191], a[180:183], a[52:55]
    v_mov_b32_dpp v183, v183 row_shr:1 row_mask:0xf bank_mask:0xf
    v_mfma_f32_16x16x32_bf16 a[52:55], v[196:199], a[184:187], a[52:55]
    v_cndmask_b32_dpp v180, v156, v180, vcc row_shl:4 row_mask:0xf bank_mask:0xf
    s_waitcnt vmcnt(10)
    v_mfma_f32_16x16x32_bf16 a[52:55], v[204:207], a[188:191], a[52:55]
    v_cndmask_b32_dpp v181, v157, v181, vcc row_shl:4 row_mask:0xf bank_mask:0xf
    v_mfma_f32_16x16x32_bf16 a[84:87], v[204:207], a[192:195], a[84:87]
    buffer_load_dwordx4 v[224:227], v2, s[20:23], s51 offen offset:0
    v_mfma_f32_16x16x32_bf16 a[84:87], v[196:199], a[196:199], a[84:87]
    v_cndmask_b32_dpp v182, v158, v182, vcc row_shl:4 row_mask:0xf bank_mask:0xf
    v_mfma_f32_16x16x32_bf16 a[84:87], v[188:191], a[200:203], a[84:87]
    v_cndmask_b32_dpp v183, v159, v183, vcc row_shl:4 row_mask:0xf bank_mask:0xf
    v_mfma_f32_16x16x32_bf16 a[84:87], v[184:187], a[204:207], a[84:87]
    v_mov_b32_dpp v168, v168 row_shr:1 row_mask:0xf bank_mask:0xf
    v_mfma_f32_16x16x32_bf16 a[16:19], v[172:175], a[176:179], a[16:19]
    v_mov_b32_dpp v169, v169 row_shr:1 row_mask:0xf bank_mask:0xf
    v_mfma_f32_16x16x32_bf16 a[16:19], v[192:195], a[180:183], a[16:19]
    buffer_load_dwordx4 v[228:231], v1, s[12:15], s52 offen offset:3072
    v_mfma_f32_16x16x32_bf16 a[16:19], v[200:203], a[184:187], a[16:19]
    v_mov_b32_dpp v170, v170 row_shr:1 row_mask:0xf bank_mask:0xf
    s_waitcnt vmcnt(11)
    v_mfma_f32_16x16x32_bf16 a[16:19], v[208:211], a[188:191], a[16:19]
    v_mov_b32_dpp v171, v171 row_shr:1 row_mask:0xf bank_mask:0xf
    v_mfma_f32_16x16x32_bf16 a[48:51], v[208:211], a[192:195], a[48:51]
    v_cndmask_b32_dpp v168, v152, v168, vcc row_shl:3 row_mask:0xf bank_mask:0xf
    v_mfma_f32_16x16x32_bf16 a[48:51], v[200:203], a[196:199], a[48:51]
    v_cndmask_b32_dpp v169, v153, v169, vcc row_shl:3 row_mask:0xf bank_mask:0xf
    v_mfma_f32_16x16x32_bf16 a[48:51], v[192:195], a[200:203], a[48:51]
    buffer_load_dwordx4 a[232:235], v1, s[16:19], s49 offen offset:2048
    v_mfma_f32_16x16x32_bf16 a[48:51], v[172:175], a[204:207], a[48:51]
    v_cndmask_b32_dpp v170, v154, v170, vcc row_shl:3 row_mask:0xf bank_mask:0xf
    v_mfma_f32_16x16x32_bf16 a[48:51], v[188:191], a[176:179], a[48:51]
    v_cndmask_b32_dpp v171, v155, v171, vcc row_shl:3 row_mask:0xf bank_mask:0xf
    v_mfma_f32_16x16x32_bf16 a[48:51], v[196:199], a[180:183], a[48:51]
    v_mov_b32_dpp v184, v184 row_shr:1 row_mask:0xf bank_mask:0xf
    v_mfma_f32_16x16x32_bf16 a[48:51], v[204:207], a[184:187], a[48:51]
    v_mov_b32_dpp v185, v185 row_shr:1 row_mask:0xf bank_mask:0xf
    s_waitcnt vmcnt(11)
    v_mfma_f32_16x16x32_bf16 a[48:51], v[212:215], a[188:191], a[48:51]
    buffer_load_dwordx4 v[232:235], v1, s[12:15], s52 offen offset:2048
    v_mfma_f32_16x16x32_bf16 a[80:83], v[212:215], a[192:195], a[80:83]
    v_mov_b32_dpp v186, v186 row_shr:1 row_mask:0xf bank_mask:0xf
    v_mfma_f32_16x16x32_bf16 a[80:83], v[204:207], a[196:199], a[80:83]
    v_mov_b32_dpp v187, v187 row_shr:1 row_mask:0xf bank_mask:0xf
    v_mfma_f32_16x16x32_bf16 a[80:83], v[196:199], a[200:203], a[80:83]
    v_cndmask_b32_dpp v184, v156, v184, vcc row_shl:3 row_mask:0xf bank_mask:0xf
    v_mfma_f32_16x16x32_bf16 a[80:83], v[188:191], a[204:207], a[80:83]
    v_cndmask_b32_dpp v185, v157, v185, vcc row_shl:3 row_mask:0xf bank_mask:0xf
    v_mfma_f32_16x16x32_bf16 a[12:15], v[192:195], a[176:179], a[12:15]
    buffer_load_dwordx4 a[236:239], v1, s[16:19], s49 offen offset:3072
    v_mfma_f32_16x16x32_bf16 a[12:15], v[200:203], a[180:183], a[12:15]
    v_cndmask_b32_dpp v186, v158, v186, vcc row_shl:3 row_mask:0xf bank_mask:0xf
    v_mfma_f32_16x16x32_bf16 a[12:15], v[208:211], a[184:187], a[12:15]
    v_cndmask_b32_dpp v187, v159, v187, vcc row_shl:3 row_mask:0xf bank_mask:0xf
    s_waitcnt vmcnt(12)
    v_mfma_f32_16x16x32_bf16 a[12:15], v[216:219], a[188:191], a[12:15]
    v_mov_b32_dpp v172, v172 row_shr:1 row_mask:0xf bank_mask:0xf
    v_mfma_f32_16x16x32_bf16 a[44:47], v[216:219], a[192:195], a[44:47]
    v_mov_b32_dpp v173, v173 row_shr:1 row_mask:0xf bank_mask:0xf
    v_mfma_f32_16x16x32_bf16 a[44:47], v[208:211], a[196:199], a[44:47]
    buffer_load_dwordx4 v[236:239], v1, s[12:15], s52 offen offset:1024
    v_mfma_f32_16x16x32_bf16 a[44:47], v[200:203], a[200:203], a[44:47]
    v_mov_b32_dpp v174, v174 row_shr:1 row_mask:0xf bank_mask:0xf
    v_mfma_f32_16x16x32_bf16 a[44:47], v[192:195], a[204:207], a[44:47]
    v_mov_b32_dpp v175, v175 row_shr:1 row_mask:0xf bank_mask:0xf
    v_mfma_f32_16x16x32_bf16 a[44:47], v[196:199], a[176:179], a[44:47]
    v_cndmask_b32_dpp v172, v152, v172, vcc row_shl:2 row_mask:0xf bank_mask:0xf
    v_mfma_f32_16x16x32_bf16 a[44:47], v[204:207], a[180:183], a[44:47]
    v_cndmask_b32_dpp v173, v153, v173, vcc row_shl:2 row_mask:0xf bank_mask:0xf
    v_mfma_f32_16x16x32_bf16 a[44:47], v[212:215], a[184:187], a[44:47]
    buffer_load_dwordx4 a[240:243], v1, s[16:19], s50 offen offset:0
    s_waitcnt vmcnt(13)
    v_mfma_f32_16x16x32_bf16 a[44:47], v[220:223], a[188:191], a[44:47]
    v_cndmask_b32_dpp v174, v154, v174, vcc row_shl:2 row_mask:0xf bank_mask:0xf
    v_mfma_f32_16x16x32_bf16 a[76:79], v[220:223], a[192:195], a[76:79]
    v_cndmask_b32_dpp v175, v155, v175, vcc row_shl:2 row_mask:0xf bank_mask:0xf
    v_mfma_f32_16x16x32_bf16 a[76:79], v[212:215], a[196:199], a[76:79]
    v_mov_b32_dpp v188, v188 row_shr:1 row_mask:0xf bank_mask:0xf
    v_mfma_f32_16x16x32_bf16 a[76:79], v[204:207], a[200:203], a[76:79]
    v_mov_b32_dpp v189, v189 row_shr:1 row_mask:0xf bank_mask:0xf
    v_mfma_f32_16x16x32_bf16 a[76:79], v[196:199], a[204:207], a[76:79]
    buffer_load_dwordx4 v[240:243], v1, s[12:15], s52 offen offset:0
    v_mfma_f32_16x16x32_bf16 a[8:11], v[200:203], a[176:179], a[8:11]
    v_mov_b32_dpp v190, v190 row_shr:1 row_mask:0xf bank_mask:0xf
    v_mfma_f32_16x16x32_bf16 a[8:11], v[208:211], a[180:183], a[8:11]
    v_mov_b32_dpp v191, v191 row_shr:1 row_mask:0xf bank_mask:0xf
    v_mfma_f32_16x16x32_bf16 a[8:11], v[216:219], a[184:187], a[8:11]
    v_cndmask_b32_dpp v188, v156, v188, vcc row_shl:2 row_mask:0xf bank_mask:0xf
    v_mfma_f32_16x16x32_bf16 a[8:11], v[160:163], a[188:191], a[8:11]
    v_cndmask_b32_dpp v189, v157, v189, vcc row_shl:2 row_mask:0xf bank_mask:0xf
    v_mfma_f32_16x16x32_bf16 a[40:43], v[160:163], a[192:195], a[40:43]
    buffer_load_dwordx4 a[244:247], v1, s[16:19], s50 offen offset:1024
    v_mfma_f32_16x16x32_bf16 a[40:43], v[216:219], a[196:199], a[40:43]
    v_cndmask_b32_dpp v190, v158, v190, vcc row_shl:2 row_mask:0xf bank_mask:0xf
    v_mfma_f32_16x16x32_bf16 a[40:43], v[208:211], a[200:203], a[40:43]
    v_cndmask_b32_dpp v191, v159, v191, vcc row_shl:2 row_mask:0xf bank_mask:0xf
    v_mfma_f32_16x16x32_bf16 a[40:43], v[200:203], a[204:207], a[40:43]
    v_mfma_f32_16x16x32_bf16 a[40:43], v[204:207], a[176:179], a[40:43]
    v_mfma_f32_16x16x32_bf16 a[40:43], v[212:215], a[180:183], a[40:43]
    buffer_load_dwordx4 v[244:247], v1, s[12:15], s51 offen offset:3072
    v_mfma_f32_16x16x32_bf16 a[40:43], v[220:223], a[184:187], a[40:43]
    v_mfma_f32_16x16x32_bf16 a[40:43], v[176:179], a[188:191], a[40:43]
    v_mfma_f32_16x16x32_bf16 a[72:75], v[176:179], a[192:195], a[72:75]
    v_mfma_f32_16x16x32_bf16 a[72:75], v[220:223], a[196:199], a[72:75]
    v_mfma_f32_16x16x32_bf16 a[72:75], v[212:215], a[200:203], a[72:75]
    buffer_load_dwordx4 a[248:251], v1, s[16:19], s50 offen offset:2048
    v_mfma_f32_16x16x32_bf16 a[72:75], v[204:207], a[204:207], a[72:75]
    v_mfma_f32_16x16x32_bf16 a[4:7], v[208:211], a[176:179], a[4:7]
    v_mfma_f32_16x16x32_bf16 a[4:7], v[216:219], a[180:183], a[4:7]
    v_mfma_f32_16x16x32_bf16 a[4:7], v[160:163], a[184:187], a[4:7]
    v_mfma_f32_16x16x32_bf16 a[4:7], v[164:167], a[188:191], a[4:7]
    buffer_load_dwordx4 v[248:251], v1, s[12:15], s51 offen offset:2048
    v_mfma_f32_16x16x32_bf16 a[36:39], v[164:167], a[192:195], a[36:39]
    v_mfma_f32_16x16x32_bf16 a[36:39], v[160:163], a[196:199], a[36:39]
    v_mfma_f32_16x16x32_bf16 a[36:39], v[216:219], a[200:203], a[36:39]
    v_mfma_f32_16x16x32_bf16 a[36:39], v[208:211], a[204:207], a[36:39]
    v_mfma_f32_16x16x32_bf16 a[36:39], v[212:215], a[176:179], a[36:39]
    buffer_load_dwordx4 a[252:255], v1, s[16:19], s50 offen offset:3072
    v_mfma_f32_16x16x32_bf16 a[36:39], v[220:223], a[180:183], a[36:39]
    v_mfma_f32_16x16x32_bf16 a[36:39], v[176:179], a[184:187], a[36:39]
    v_mfma_f32_16x16x32_bf16 a[36:39], v[180:183], a[188:191], a[36:39]
    v_mfma_f32_16x16x32_bf16 a[68:71], v[180:183], a[192:195], a[68:71]
    v_mfma_f32_16x16x32_bf16 a[68:71], v[176:179], a[196:199], a[68:71]
    buffer_load_dwordx4 v[252:255], v1, s[12:15], s51 offen offset:1024
    v_mfma_f32_16x16x32_bf16 a[68:71], v[220:223], a[200:203], a[68:71]
    v_mfma_f32_16x16x32_bf16 a[68:71], v[212:215], a[204:207], a[68:71]
    v_mfma_f32_16x16x32_bf16 a[0:3], v[216:219], a[176:179], a[0:3]
    v_mfma_f32_16x16x32_bf16 a[0:3], v[160:163], a[180:183], a[0:3]
    v_mfma_f32_16x16x32_bf16 a[0:3], v[164:167], a[184:187], a[0:3]
    buffer_load_dwordx4 a[160:163], v1, s[16:19], s51 offen offset:0
    v_mfma_f32_16x16x32_bf16 a[0:3], v[168:171], a[188:191], a[0:3]
    v_mfma_f32_16x16x32_bf16 a[32:35], v[168:171], a[192:195], a[32:35]
    v_mfma_f32_16x16x32_bf16 a[32:35], v[164:167], a[196:199], a[32:35]
    v_mfma_f32_16x16x32_bf16 a[32:35], v[160:163], a[200:203], a[32:35]
    v_mfma_f32_16x16x32_bf16 a[32:35], v[216:219], a[204:207], a[32:35]
    buffer_load_dwordx4 v[64:67], v1, s[12:15], s51 offen offset:0
    v_mfma_f32_16x16x32_bf16 a[32:35], v[220:223], a[176:179], a[32:35]
    v_mfma_f32_16x16x32_bf16 a[32:35], v[176:179], a[180:183], a[32:35]
    v_mfma_f32_16x16x32_bf16 a[32:35], v[180:183], a[184:187], a[32:35]
    v_mfma_f32_16x16x32_bf16 a[32:35], v[184:187], a[188:191], a[32:35]
    v_mfma_f32_16x16x32_bf16 a[64:67], v[184:187], a[192:195], a[64:67]
    buffer_load_dwordx4 v[68:71], v2, s[20:23], s53 offen offset:0
    v_mfma_f32_16x16x32_bf16 a[64:67], v[180:183], a[196:199], a[64:67]
    v_mfma_f32_16x16x32_bf16 a[64:67], v[176:179], a[200:203], a[64:67]
    v_mfma_f32_16x16x32_bf16 a[64:67], v[220:223], a[204:207], a[64:67]
    s_waitcnt vmcnt(18)
    v_mfma_f32_16x16x32_bf16 a[28:31], v[192:195], a[208:211], a[28:31]
    v_mfma_f32_16x16x32_bf16 a[28:31], v[200:203], a[212:215], a[28:31]
    buffer_load_dwordx4 v[72:75], v1, s[12:15], s54 offen offset:3072
    v_mfma_f32_16x16x32_bf16 a[28:31], v[208:211], a[216:219], a[28:31]
    v_mfma_f32_16x16x32_bf16 a[60:63], v[208:211], a[220:223], a[60:63]
    v_mfma_f32_16x16x32_bf16 a[60:63], v[200:203], a[224:227], a[60:63]
    s_waitcnt vmcnt(18)
    v_mfma_f32_16x16x32_bf16 a[60:63], v[192:195], a[228:231], a[60:63]
    v_mov_b32_dpp v192, v192 row_shr:1 row_mask:0xf bank_mask:0xf
    v_mfma_f32_16x16x32_bf16 a[60:63], v[196:199], a[208:211], a[60:63]
    buffer_load_dwordx4 a[164:167], v1, s[16:19], s51 offen offset:1024
    v_mfma_f32_16x16x32_bf16 a[60:63], v[204:207], a[212:215], a[60:63]
    v_mov_b32_dpp v193, v193 row_shr:1 row_mask:0xf bank_mask:0xf
    v_mfma_f32_16x16x32_bf16 a[60:63], v[212:215], a[216:219], a[60:63]
    v_mov_b32_dpp v194, v194 row_shr:1 row_mask:0xf bank_mask:0xf
    v_mfma_f32_16x16x32_bf16 a[92:95], v[212:215], a[220:223], a[92:95]
    v_mov_b32_dpp v195, v195 row_shr:1 row_mask:0xf bank_mask:0xf
    v_mfma_f32_16x16x32_bf16 a[92:95], v[204:207], a[224:227], a[92:95]
    v_cndmask_b32_dpp v192, v152, v192, vcc row_shl:1 row_mask:0xf bank_mask:0xf
    v_mfma_f32_16x16x32_bf16 a[92:95], v[196:199], a[228:231], a[92:95]
    buffer_load_dwordx4 v[76:79], v1, s[12:15], s54 offen offset:2048
    v_mfma_f32_16x16x32_bf16 a[24:27], v[200:203], a[208:211], a[24:27]
    v_cndmask_b32_dpp v193, v153, v193, vcc row_shl:1 row_mask:0xf bank_mask:0xf
    v_mfma_f32_16x16x32_bf16 a[24:27], v[208:211], a[212:215], a[24:27]
    v_cndmask_b32_dpp v194, v154, v194, vcc row_shl:1 row_mask:0xf bank_mask:0xf
    v_mfma_f32_16x16x32_bf16 a[24:27], v[216:219], a[216:219], a[24:27]
    v_cndmask_b32_dpp v195, v155, v195, vcc row_shl:1 row_mask:0xf bank_mask:0xf
    v_mfma_f32_16x16x32_bf16 a[56:59], v[216:219], a[220:223], a[56:59]
    v_mov_b32_dpp v196, v196 row_shr:1 row_mask:0xf bank_mask:0xf
    v_mfma_f32_16x16x32_bf16 a[56:59], v[208:211], a[224:227], a[56:59]
    buffer_load_dwordx4 a[168:171], v1, s[16:19], s51 offen offset:2048
    v_mfma_f32_16x16x32_bf16 a[56:59], v[200:203], a[228:231], a[56:59]
    v_mov_b32_dpp v197, v197 row_shr:1 row_mask:0xf bank_mask:0xf
    v_mfma_f32_16x16x32_bf16 a[56:59], v[204:207], a[208:211], a[56:59]
    v_mov_b32_dpp v198, v198 row_shr:1 row_mask:0xf bank_mask:0xf
    v_mfma_f32_16x16x32_bf16 a[56:59], v[212:215], a[212:215], a[56:59]
    v_mov_b32_dpp v199, v199 row_shr:1 row_mask:0xf bank_mask:0xf
    v_mfma_f32_16x16x32_bf16 a[56:59], v[220:223], a[216:219], a[56:59]
    v_cndmask_b32_dpp v196, v156, v196, vcc row_shl:1 row_mask:0xf bank_mask:0xf
    v_mfma_f32_16x16x32_bf16 a[88:91], v[220:223], a[220:223], a[88:91]
    buffer_load_dwordx4 v[8:11], v1, s[12:15], s54 offen offset:1024
    v_mfma_f32_16x16x32_bf16 a[88:91], v[212:215], a[224:227], a[88:91]
    v_cndmask_b32_dpp v197, v157, v197, vcc row_shl:1 row_mask:0xf bank_mask:0xf
    v_mfma_f32_16x16x32_bf16 a[88:91], v[204:207], a[228:231], a[88:91]
    v_cndmask_b32_dpp v198, v158, v198, vcc row_shl:1 row_mask:0xf bank_mask:0xf
    v_mfma_f32_16x16x32_bf16 a[20:23], v[208:211], a[208:211], a[20:23]
    v_cndmask_b32_dpp v199, v159, v199, vcc row_shl:1 row_mask:0xf bank_mask:0xf
    v_mfma_f32_16x16x32_bf16 a[20:23], v[216:219], a[212:215], a[20:23]
    v_mov_b32_dpp v200, v200 row_shr:1 row_mask:0xf bank_mask:0xf
    v_mfma_f32_16x16x32_bf16 a[20:23], v[160:163], a[216:219], a[20:23]
    buffer_load_dwordx4 a[172:175], v1, s[16:19], s51 offen offset:3072
    v_mfma_f32_16x16x32_bf16 a[52:55], v[160:163], a[220:223], a[52:55]
    v_mov_b32_dpp v201, v201 row_shr:1 row_mask:0xf bank_mask:0xf
    v_mfma_f32_16x16x32_bf16 a[52:55], v[216:219], a[224:227], a[52:55]
    v_mov_b32_dpp v202, v202 row_shr:1 row_mask:0xf bank_mask:0xf
    v_mfma_f32_16x16x32_bf16 a[52:55], v[208:211], a[228:231], a[52:55]
    v_mov_b32_dpp v203, v203 row_shr:1 row_mask:0xf bank_mask:0xf
    v_mfma_f32_16x16x32_bf16 a[52:55], v[212:215], a[208:211], a[52:55]
    v_cndmask_b32 v200, v152, v200, vcc
    v_mfma_f32_16x16x32_bf16 a[52:55], v[220:223], a[212:215], a[52:55]
    buffer_load_dwordx4 v[24:27], v1, s[12:15], s54 offen offset:0
    v_mfma_f32_16x16x32_bf16 a[52:55], v[176:179], a[216:219], a[52:55]
    v_cndmask_b32 v201, v153, v201, vcc
    v_mfma_f32_16x16x32_bf16 a[84:87], v[176:179], a[220:223], a[84:87]
    v_cndmask_b32 v202, v154, v202, vcc
    v_mfma_f32_16x16x32_bf16 a[84:87], v[220:223], a[224:227], a[84:87]
    v_cndmask_b32 v203, v155, v203, vcc
    v_mfma_f32_16x16x32_bf16 a[84:87], v[212:215], a[228:231], a[84:87]
    v_mov_b32_dpp v204, v204 row_shr:1 row_mask:0xf bank_mask:0xf
    v_mfma_f32_16x16x32_bf16 a[16:19], v[216:219], a[208:211], a[16:19]
    buffer_load_dwordx4 a[176:179], v1, s[16:19], s52 offen offset:0
    v_mfma_f32_16x16x32_bf16 a[16:19], v[160:163], a[212:215], a[16:19]
    v_mov_b32_dpp v205, v205 row_shr:1 row_mask:0xf bank_mask:0xf
    v_mfma_f32_16x16x32_bf16 a[16:19], v[164:167], a[216:219], a[16:19]
    v_mov_b32_dpp v206, v206 row_shr:1 row_mask:0xf bank_mask:0xf
    v_mfma_f32_16x16x32_bf16 a[48:51], v[164:167], a[220:223], a[48:51]
    v_mov_b32_dpp v207, v207 row_shr:1 row_mask:0xf bank_mask:0xf
    v_mfma_f32_16x16x32_bf16 a[48:51], v[160:163], a[224:227], a[48:51]
    v_cndmask_b32 v204, v156, v204, vcc
    v_mfma_f32_16x16x32_bf16 a[48:51], v[216:219], a[228:231], a[48:51]
    buffer_load_dwordx4 v[12:15], v1, s[12:15], s53 offen offset:3072
    v_mfma_f32_16x16x32_bf16 a[48:51], v[220:223], a[208:211], a[48:51]
    v_cndmask_b32 v205, v157, v205, vcc
    v_mfma_f32_16x16x32_bf16 a[48:51], v[176:179], a[212:215], a[48:51]
    v_cndmask_b32 v206, v158, v206, vcc
    v_mfma_f32_16x16x32_bf16 a[48:51], v[180:183], a[216:219], a[48:51]
    v_cndmask_b32 v207, v159, v207, vcc
    v_mfma_f32_16x16x32_bf16 a[80:83], v[180:183], a[220:223], a[80:83]
    v_mfma_f32_16x16x32_bf16 a[80:83], v[176:179], a[224:227], a[80:83]
    buffer_load_dwordx4 a[180:183], v1, s[16:19], s52 offen offset:1024
    v_mfma_f32_16x16x32_bf16 a[80:83], v[220:223], a[228:231], a[80:83]
    v_mfma_f32_16x16x32_bf16 a[12:15], v[160:163], a[208:211], a[12:15]
    v_mfma_f32_16x16x32_bf16 a[12:15], v[164:167], a[212:215], a[12:15]
    v_mfma_f32_16x16x32_bf16 a[12:15], v[168:171], a[216:219], a[12:15]
    v_mfma_f32_16x16x32_bf16 a[44:47], v[168:171], a[220:223], a[44:47]
    buffer_load_dwordx4 v[36:39], v1, s[12:15], s53 offen offset:2048
    v_mfma_f32_16x16x32_bf16 a[44:47], v[164:167], a[224:227], a[44:47]
    v_mfma_f32_16x16x32_bf16 a[44:47], v[160:163], a[228:231], a[44:47]
    v_mfma_f32_16x16x32_bf16 a[44:47], v[176:179], a[208:211], a[44:47]
    v_mfma_f32_16x16x32_bf16 a[44:47], v[180:183], a[212:215], a[44:47]
    v_mfma_f32_16x16x32_bf16 a[44:47], v[184:187], a[216:219], a[44:47]
    buffer_load_dwordx4 a[184:187], v1, s[16:19], s52 offen offset:2048
    v_mfma_f32_16x16x32_bf16 a[76:79], v[184:187], a[220:223], a[76:79]
    v_mfma_f32_16x16x32_bf16 a[76:79], v[180:183], a[224:227], a[76:79]
    v_mfma_f32_16x16x32_bf16 a[76:79], v[176:179], a[228:231], a[76:79]
    v_mfma_f32_16x16x32_bf16 a[8:11], v[164:167], a[208:211], a[8:11]
    v_mfma_f32_16x16x32_bf16 a[8:11], v[168:171], a[212:215], a[8:11]
    buffer_load_dwordx4 v[16:19], v1, s[12:15], s53 offen offset:1024
    v_mfma_f32_16x16x32_bf16 a[8:11], v[172:175], a[216:219], a[8:11]
    v_mfma_f32_16x16x32_bf16 a[40:43], v[172:175], a[220:223], a[40:43]
    v_mfma_f32_16x16x32_bf16 a[40:43], v[168:171], a[224:227], a[40:43]
    v_mfma_f32_16x16x32_bf16 a[40:43], v[164:167], a[228:231], a[40:43]
    v_mfma_f32_16x16x32_bf16 a[40:43], v[180:183], a[208:211], a[40:43]
    buffer_load_dwordx4 a[188:191], v1, s[16:19], s52 offen offset:3072
    v_mfma_f32_16x16x32_bf16 a[40:43], v[184:187], a[212:215], a[40:43]
    v_mfma_f32_16x16x32_bf16 a[40:43], v[188:191], a[216:219], a[40:43]
    v_mfma_f32_16x16x32_bf16 a[72:75], v[188:191], a[220:223], a[72:75]
    v_mfma_f32_16x16x32_bf16 a[72:75], v[184:187], a[224:227], a[72:75]
    v_mfma_f32_16x16x32_bf16 a[72:75], v[180:183], a[228:231], a[72:75]
    buffer_load_dwordx4 v[40:43], v1, s[12:15], s53 offen offset:0
    v_mfma_f32_16x16x32_bf16 a[4:7], v[168:171], a[208:211], a[4:7]
    v_mfma_f32_16x16x32_bf16 a[4:7], v[172:175], a[212:215], a[4:7]
    v_mfma_f32_16x16x32_bf16 a[4:7], v[192:195], a[216:219], a[4:7]
    v_mfma_f32_16x16x32_bf16 a[36:39], v[192:195], a[220:223], a[36:39]
    v_mfma_f32_16x16x32_bf16 a[36:39], v[172:175], a[224:227], a[36:39]
    buffer_load_dwordx4 v[28:31], v2, s[20:23], s55 offen offset:0
    v_mfma_f32_16x16x32_bf16 a[36:39], v[168:171], a[228:231], a[36:39]
    v_mfma_f32_16x16x32_bf16 a[36:39], v[184:187], a[208:211], a[36:39]
    v_mfma_f32_16x16x32_bf16 a[36:39], v[188:191], a[212:215], a[36:39]
    v_mfma_f32_16x16x32_bf16 a[36:39], v[196:199], a[216:219], a[36:39]
    v_mfma_f32_16x16x32_bf16 a[68:71], v[196:199], a[220:223], a[68:71]
    buffer_load_dwordx4 v[56:59], v2, s[20:23], s57 offen offset:0
    v_mfma_f32_16x16x32_bf16 a[68:71], v[188:191], a[224:227], a[68:71]
    v_mfma_f32_16x16x32_bf16 a[68:71], v[184:187], a[228:231], a[68:71]
    v_mfma_f32_16x16x32_bf16 a[0:3], v[172:175], a[208:211], a[0:3]
    v_mfma_f32_16x16x32_bf16 a[0:3], v[192:195], a[212:215], a[0:3]
    v_mfma_f32_16x16x32_bf16 a[0:3], v[200:203], a[216:219], a[0:3]
    buffer_load_dwordx4 v[48:51], v1, s[12:15], s56 offen offset:3072
    v_mfma_f32_16x16x32_bf16 a[32:35], v[200:203], a[220:223], a[32:35]
    v_mfma_f32_16x16x32_bf16 a[32:35], v[192:195], a[224:227], a[32:35]
    v_mfma_f32_16x16x32_bf16 a[32:35], v[172:175], a[228:231], a[32:35]
    v_mfma_f32_16x16x32_bf16 a[32:35], v[188:191], a[208:211], a[32:35]
    v_mfma_f32_16x16x32_bf16 a[32:35], v[196:199], a[212:215], a[32:35]
    buffer_load_dwordx4 a[192:195], v1, s[16:19], s53 offen offset:0
    v_mfma_f32_16x16x32_bf16 a[32:35], v[204:207], a[216:219], a[32:35]
    v_mfma_f32_16x16x32_bf16 a[64:67], v[204:207], a[220:223], a[64:67]
    v_mfma_f32_16x16x32_bf16 a[64:67], v[196:199], a[224:227], a[64:67]
    v_mfma_f32_16x16x32_bf16 a[64:67], v[188:191], a[228:231], a[64:67]
    s_waitcnt vmcnt(18)
    v_mfma_f32_16x16x32_bf16 a[124:127], v[228:231], a[232:235], a[124:127]
    buffer_load_dwordx4 v[20:23], v1, s[12:15], s56 offen offset:2048
    v_mov_b32_dpp v228, v228 row_shr:1 row_mask:0xf bank_mask:0xf
    v_mfma_f32_16x16x32_bf16 a[124:127], v[232:235], a[236:239], a[124:127]
    v_mov_b32_dpp v229, v229 row_shr:1 row_mask:0xf bank_mask:0xf
    v_mov_b32_dpp v230, v230 row_shr:1 row_mask:0xf bank_mask:0xf
    v_mfma_f32_16x16x32_bf16 a[124:127], v[236:239], a[240:243], a[124:127]
    v_mov_b32_dpp v231, v231 row_shr:1 row_mask:0xf bank_mask:0xf
    v_cndmask_b32_dpp v228, v224, v228, vcc row_shl:5 row_mask:0xf bank_mask:0xf
    v_mfma_f32_16x16x32_bf16 a[124:127], v[240:243], a[244:247], a[124:127]
    v_cndmask_b32_dpp v229, v225, v229, vcc row_shl:5 row_mask:0xf bank_mask:0xf
    v_cndmask_b32_dpp v230, v226, v230, vcc row_shl:5 row_mask:0xf bank_mask:0xf
    v_mfma_f32_16x16x32_bf16 a[124:127], v[244:247], a[248:251], a[124:127]
    v_cndmask_b32_dpp v231, v227, v231, vcc row_shl:5 row_mask:0xf bank_mask:0xf
    v_mfma_f32_16x16x32_bf16 a[124:127], v[248:251], a[252:255], a[124:127]
    buffer_load_dwordx4 a[196:199], v1, s[16:19], s53 offen offset:1024
    v_mfma_f32_16x16x32_bf16 a[124:127], v[252:255], a[160:163], a[124:127]
    v_mfma_f32_16x16x32_bf16 a[120:123], v[232:235], a[232:235], a[120:123]
    v_mov_b32_dpp v232, v232 row_shr:1 row_mask:0xf bank_mask:0xf
    v_mov_b32_dpp v233, v233 row_shr:1 row_mask:0xf bank_mask:0xf
    v_mfma_f32_16x16x32_bf16 a[120:123], v[236:239], a[236:239], a[120:123]
    v_mov_b32_dpp v234, v234 row_shr:1 row_mask:0xf bank_mask:0xf
    v_mov_b32_dpp v235, v235 row_shr:1 row_mask:0xf bank_mask:0xf
    v_mfma_f32_16x16x32_bf16 a[120:123], v[240:243], a[240:243], a[120:123]
    v_cndmask_b32_dpp v232, v224, v232, vcc row_shl:4 row_mask:0xf bank_mask:0xf
    v_cndmask_b32_dpp v233, v225, v233, vcc row_shl:4 row_mask:0xf bank_mask:0xf
    v_mfma_f32_16x16x32_bf16 a[120:123], v[244:247], a[244:247], a[120:123]
    buffer_load_dwordx4 v[32:35], v1, s[12:15], s56 offen offset:1024
    v_cndmask_b32_dpp v234, v226, v234, vcc row_shl:4 row_mask:0xf bank_mask:0xf
    v_mfma_f32_16x16x32_bf16 a[120:123], v[248:251], a[248:251], a[120:123]
    v_cndmask_b32_dpp v235, v227, v235, vcc row_shl:4 row_mask:0xf bank_mask:0xf
    v_mfma_f32_16x16x32_bf16 a[120:123], v[252:255], a[252:255], a[120:123]
    v_mfma_f32_16x16x32_bf16 a[120:123], v[64:67], a[160:163], a[120:123]
    v_mfma_f32_16x16x32_bf16 a[116:119], v[236:239], a[232:235], a[116:119]
    v_mov_b32_dpp v236, v236 row_shr:1 row_mask:0xf bank_mask:0xf
    v_mov_b32_dpp v237, v237 row_shr:1 row_mask:0xf bank_mask:0xf
    v_mfma_f32_16x16x32_bf16 a[116:119], v[240:243], a[236:239], a[116:119]
    buffer_load_dwordx4 a[200:203], v1, s[16:19], s53 offen offset:2048
    v_mov_b32_dpp v238, v238 row_shr:1 row_mask:0xf bank_mask:0xf
    v_mfma_f32_16x16x32_bf16 a[116:119], v[244:247], a[240:243], a[116:119]
    v_mov_b32_dpp v239, v239 row_shr:1 row_mask:0xf bank_mask:0xf
    v_cndmask_b32_dpp v236, v224, v236, vcc row_shl:3 row_mask:0xf bank_mask:0xf
    v_mfma_f32_16x16x32_bf16 a[116:119], v[248:251], a[244:247], a[116:119]
    v_cndmask_b32_dpp v237, v225, v237, vcc row_shl:3 row_mask:0xf bank_mask:0xf
    v_cndmask_b32_dpp v238, v226, v238, vcc row_shl:3 row_mask:0xf bank_mask:0xf
    v_mfma_f32_16x16x32_bf16 a[116:119], v[252:255], a[248:251], a[116:119]
    v_cndmask_b32_dpp v239, v227, v239, vcc row_shl:3 row_mask:0xf bank_mask:0xf
    v_mfma_f32_16x16x32_bf16 a[116:119], v[64:67], a[252:255], a[116:119]
    v_mfma_f32_16x16x32_bf16 a[116:119], v[228:231], a[160:163], a[116:119]
    buffer_load_dwordx4 v[60:63], v1, s[12:15], s56 offen offset:0
    v_mfma_f32_16x16x32_bf16 a[112:115], v[240:243], a[232:235], a[112:115]
    v_mov_b32_dpp v240, v240 row_shr:1 row_mask:0xf bank_mask:0xf
    v_mov_b32_dpp v241, v241 row_shr:1 row_mask:0xf bank_mask:0xf
    v_mfma_f32_16x16x32_bf16 a[112:115], v[244:247], a[236:239], a[112:115]
    v_mov_b32_dpp v242, v242 row_shr:1 row_mask:0xf bank_mask:0xf
    v_mfma_f32_16x16x32_bf16 a[112:115], v[248:251], a[240:243], a[112:115]
    v_mov_b32_dpp v243, v243 row_shr:1 row_mask:0xf bank_mask:0xf
    v_mfma_f32_16x16x32_bf16 a[112:115], v[252:255], a[244:247], a[112:115]
    v_cndmask_b32_dpp v240, v224, v240, vcc row_shl:2 row_mask:0xf bank_mask:0xf
    v_mfma_f32_16x16x32_bf16 a[112:115], v[64:67], a[248:251], a[112:115]
    buffer_load_dwordx4 a[204:207], v1, s[16:19], s53 offen offset:3072
    v_mfma_f32_16x16x32_bf16 a[112:115], v[228:231], a[252:255], a[112:115]
    v_cndmask_b32_dpp v241, v225, v241, vcc row_shl:2 row_mask:0xf bank_mask:0xf
    v_mfma_f32_16x16x32_bf16 a[112:115], v[232:235], a[160:163], a[112:115]
    v_cndmask_b32_dpp v242, v226, v242, vcc row_shl:2 row_mask:0xf bank_mask:0xf
    v_mfma_f32_16x16x32_bf16 a[108:111], v[244:247], a[232:235], a[108:111]
    v_cndmask_b32_dpp v243, v227, v243, vcc row_shl:2 row_mask:0xf bank_mask:0xf
    v_mfma_f32_16x16x32_bf16 a[108:111], v[248:251], a[236:239], a[108:111]
    v_mov_b32_dpp v244, v244 row_shr:1 row_mask:0xf bank_mask:0xf
    v_mfma_f32_16x16x32_bf16 a[108:111], v[252:255], a[240:243], a[108:111]
    buffer_load_dwordx4 a[208:211], v1, s[16:19], s55 offen offset:2048
    v_mfma_f32_16x16x32_bf16 a[108:111], v[64:67], a[244:247], a[108:111]
    v_mov_b32_dpp v245, v245 row_shr:1 row_mask:0xf bank_mask:0xf
    v_mfma_f32_16x16x32_bf16 a[108:111], v[228:231], a[248:251], a[108:111]
    v_mov_b32_dpp v246, v246 row_shr:1 row_mask:0xf bank_mask:0xf
    v_mfma_f32_16x16x32_bf16 a[108:111], v[232:235], a[252:255], a[108:111]
    v_mov_b32_dpp v247, v247 row_shr:1 row_mask:0xf bank_mask:0xf
    v_mfma_f32_16x16x32_bf16 a[108:111], v[236:239], a[160:163], a[108:111]
    v_cndmask_b32_dpp v244, v224, v244, vcc row_shl:1 row_mask:0xf bank_mask:0xf
    v_mfma_f32_16x16x32_bf16 a[104:107], v[248:251], a[232:235], a[104:107]
    buffer_load_dwordx4 a[212:215], v1, s[16:19], s55 offen offset:1024
    v_mfma_f32_16x16x32_bf16 a[104:107], v[252:255], a[236:239], a[104:107]
    v_cndmask_b32_dpp v245, v225, v245, vcc row_shl:1 row_mask:0xf bank_mask:0xf
    v_mfma_f32_16x16x32_bf16 a[104:107], v[64:67], a[240:243], a[104:107]
    v_cndmask_b32_dpp v246, v226, v246, vcc row_shl:1 row_mask:0xf bank_mask:0xf
    v_mfma_f32_16x16x32_bf16 a[104:107], v[228:231], a[244:247], a[104:107]
    v_cndmask_b32_dpp v247, v227, v247, vcc row_shl:1 row_mask:0xf bank_mask:0xf
    v_mfma_f32_16x16x32_bf16 a[104:107], v[232:235], a[248:251], a[104:107]
    v_mov_b32_dpp v248, v248 row_shr:1 row_mask:0xf bank_mask:0xf
    v_mfma_f32_16x16x32_bf16 a[104:107], v[236:239], a[252:255], a[104:107]
    buffer_load_dwordx4 a[216:219], v1, s[16:19], s55 offen offset:0
    v_mfma_f32_16x16x32_bf16 a[104:107], v[240:243], a[160:163], a[104:107]
    v_mov_b32_dpp v249, v249 row_shr:1 row_mask:0xf bank_mask:0xf
    v_mfma_f32_16x16x32_bf16 a[100:103], v[252:255], a[232:235], a[100:103]
    v_mov_b32_dpp v250, v250 row_shr:1 row_mask:0xf bank_mask:0xf
    v_mfma_f32_16x16x32_bf16 a[100:103], v[64:67], a[236:239], a[100:103]
    v_mov_b32_dpp v251, v251 row_shr:1 row_mask:0xf bank_mask:0xf
    v_mfma_f32_16x16x32_bf16 a[100:103], v[228:231], a[240:243], a[100:103]
    v_cndmask_b32 v248, v224, v248, vcc
    v_cndmask_b32 v249, v225, v249, vcc
    v_mfma_f32_16x16x32_bf16 a[100:103], v[232:235], a[244:247], a[100:103]
    buffer_load_dwordx4 a[220:223], v1, s[16:19], s54 offen offset:3072
    v_cndmask_b32 v250, v226, v250, vcc
    v_mfma_f32_16x16x32_bf16 a[100:103], v[236:239], a[248:251], a[100:103]
    v_cndmask_b32 v251, v227, v251, vcc
    v_mfma_f32_16x16x32_bf16 a[100:103], v[240:243], a[252:255], a[100:103]
    v_mfma_f32_16x16x32_bf16 a[100:103], v[244:247], a[160:163], a[100:103]
    v_mfma_f32_16x16x32_bf16 a[96:99], v[64:67], a[232:235], a[96:99]
    v_mfma_f32_16x16x32_bf16 a[96:99], v[228:231], a[236:239], a[96:99]
    buffer_load_dwordx4 v[52:55], v1, s[12:15], s58 offen offset:3072
    v_mfma_f32_16x16x32_bf16 a[96:99], v[232:235], a[240:243], a[96:99]
    v_mfma_f32_16x16x32_bf16 a[96:99], v[236:239], a[244:247], a[96:99]
    v_mfma_f32_16x16x32_bf16 a[96:99], v[240:243], a[248:251], a[96:99]
    v_mfma_f32_16x16x32_bf16 a[96:99], v[244:247], a[252:255], a[96:99]
    v_mfma_f32_16x16x32_bf16 a[96:99], v[248:251], a[160:163], a[96:99]
    buffer_load_dwordx4 v[44:47], v1, s[12:15], s58 offen offset:2048
    s_waitcnt vmcnt(18)
    v_mfma_f32_16x16x32_bf16 a[156:159], v[72:75], a[164:167], a[156:159]
    v_mov_b32_dpp v72, v72 row_shr:1 row_mask:0xf bank_mask:0xf
    v_mov_b32_dpp v73, v73 row_shr:1 row_mask:0xf bank_mask:0xf
    v_mfma_f32_16x16x32_bf16 a[156:159], v[76:79], a[168:171], a[156:159]
    v_mov_b32_dpp v74, v74 row_shr:1 row_mask:0xf bank_mask:0xf
    v_mov_b32_dpp v75, v75 row_shr:1 row_mask:0xf bank_mask:0xf
    v_mfma_f32_16x16x32_bf16 a[156:159], v[8:11], a[172:175], a[156:159]
    v_cndmask_b32_dpp v72, v68, v72, vcc row_shl:5 row_mask:0xf bank_mask:0xf
    v_cndmask_b32_dpp v73, v69, v73, vcc row_shl:5 row_mask:0xf bank_mask:0xf
    v_mfma_f32_16x16x32_bf16 a[156:159], v[24:27], a[176:179], a[156:159]
    v_cndmask_b32_dpp v74, v70, v74, vcc row_shl:5 row_mask:0xf bank_mask:0xf
    v_cndmask_b32_dpp v75, v71, v75, vcc row_shl:5 row_mask:0xf bank_mask:0xf
    v_mfma_f32_16x16x32_bf16 a[156:159], v[12:15], a[180:183], a[156:159]
    buffer_load_dwordx4 v[108:111], v1, s[12:15], s58 offen offset:1024
    v_mfma_f32_16x16x32_bf16 a[156:159], v[36:39], a[184:187], a[156:159]
    s_waitcnt vmcnt(18)
    v_mfma_f32_16x16x32_bf16 a[156:159], v[16:19], a[188:191], a[156:159]
    v_mfma_f32_16x16x32_bf16 a[152:155], v[76:79], a[164:167], a[152:155]
    v_mov_b32_dpp v76, v76 row_shr:1 row_mask:0xf bank_mask:0xf
    v_mov_b32_dpp v77, v77 row_shr:1 row_mask:0xf bank_mask:0xf
    v_mfma_f32_16x16x32_bf16 a[152:155], v[8:11], a[168:171], a[152:155]
    v_mov_b32_dpp v78, v78 row_shr:1 row_mask:0xf bank_mask:0xf
    v_mov_b32_dpp v79, v79 row_shr:1 row_mask:0xf bank_mask:0xf
    v_mfma_f32_16x16x32_bf16 a[152:155], v[24:27], a[172:175], a[152:155]
    buffer_load_dwordx4 v[112:115], v1, s[12:15], s58 offen offset:0
    v_cndmask_b32_dpp v76, v68, v76, vcc row_shl:4 row_mask:0xf bank_mask:0xf
    v_mfma_f32_16x16x32_bf16 a[152:155], v[12:15], a[176:179], a[152:155]
    v_cndmask_b32_dpp v77, v69, v77, vcc row_shl:4 row_mask:0xf bank_mask:0xf
    v_cndmask_b32_dpp v78, v70, v78, vcc row_shl:4 row_mask:0xf bank_mask:0xf
    v_mfma_f32_16x16x32_bf16 a[152:155], v[36:39], a[180:183], a[152:155]
    v_cndmask_b32_dpp v79, v71, v79, vcc row_shl:4 row_mask:0xf bank_mask:0xf
    v_mfma_f32_16x16x32_bf16 a[152:155], v[16:19], a[184:187], a[152:155]
    s_waitcnt vmcnt(18)
    v_mfma_f32_16x16x32_bf16 a[152:155], v[40:43], a[188:191], a[152:155]
    v_mfma_f32_16x16x32_bf16 a[148:151], v[8:11], a[164:167], a[148:151]
    buffer_load_dwordx4 v[84:87], v1, s[12:15], s55 offen offset:3072
    v_mov_b32_dpp v8, v8 row_shr:1 row_mask:0xf bank_mask:0xf
    v_mfma_f32_16x16x32_bf16 a[148:151], v[24:27], a[168:171], a[148:151]
    v_mov_b32_dpp v9, v9 row_shr:1 row_mask:0xf bank_mask:0xf
    v_mov_b32_dpp v10, v10 row_shr:1 row_mask:0xf bank_mask:0xf
    v_mfma_f32_16x16x32_bf16 a[148:151], v[12:15], a[172:175], a[148:151]
    v_mov_b32_dpp v11, v11 row_shr:1 row_mask:0xf bank_mask:0xf
    v_cndmask_b32_dpp v8, v68, v8, vcc row_shl:3 row_mask:0xf bank_mask:0xf
    v_mfma_f32_16x16x32_bf16 a[148:151], v[36:39], a[176:179], a[148:151]
    v_cndmask_b32_dpp v9, v69, v9, vcc row_shl:3 row_mask:0xf bank_mask:0xf
    v_cndmask_b32_dpp v10, v70, v10, vcc row_shl:3 row_mask:0xf bank_mask:0xf
    v_mfma_f32_16x16x32_bf16 a[148:151], v[16:19], a[180:183], a[148:151]
    v_cndmask_b32_dpp v11, v71, v11, vcc row_shl:3 row_mask:0xf bank_mask:0xf
    v_mfma_f32_16x16x32_bf16 a[148:151], v[40:43], a[184:187], a[148:151]
    buffer_load_dwordx4 v[88:91], v1, s[12:15], s57 offen offset:3072
    v_mfma_f32_16x16x32_bf16 a[148:151], v[72:75], a[188:191], a[148:151]
    v_mfma_f32_16x16x32_bf16 a[144:147], v[24:27], a[164:167], a[144:147]
    v_mov_b32_dpp v24, v24 row_shr:1 row_mask:0xf bank_mask:0xf
    v_mov_b32_dpp v25, v25 row_shr:1 row_mask:0xf bank_mask:0xf
    v_mfma_f32_16x16x32_bf16 a[144:147], v[12:15], a[168:171], a[144:147]
    v_mov_b32_dpp v26, v26 row_shr:1 row_mask:0xf bank_mask:0xf
    v_mfma_f32_16x16x32_bf16 a[144:147], v[36:39], a[172:175], a[144:147]
    v_mov_b32_dpp v27, v27 row_shr:1 row_mask:0xf bank_mask:0xf
    v_mfma_f32_16x16x32_bf16 a[144:147], v[16:19], a[176:179], a[144:147]
    buffer_load_dwordx4 v[92:95], v1, s[12:15], s55 offen offset:2048
    v_mfma_f32_16x16x32_bf16 a[144:147], v[40:43], a[180:183], a[144:147]
    v_cndmask_b32_dpp v24, v68, v24, vcc row_shl:2 row_mask:0xf bank_mask:0xf
    v_mfma_f32_16x16x32_bf16 a[144:147], v[72:75], a[184:187], a[144:147]
    v_cndmask_b32_dpp v25, v69, v25, vcc row_shl:2 row_mask:0xf bank_mask:0xf
    v_mfma_f32_16x16x32_bf16 a[144:147], v[76:79], a[188:191], a[144:147]
    v_cndmask_b32_dpp v26, v70, v26, vcc row_shl:2 row_mask:0xf bank_mask:0xf
    v_mfma_f32_16x16x32_bf16 a[140:143], v[12:15], a[164:167], a[140:143]
    v_cndmask_b32_dpp v27, v71, v27, vcc row_shl:2 row_mask:0xf bank_mask:0xf
    v_mfma_f32_16x16x32_bf16 a[140:143], v[36:39], a[168:171], a[140:143]
    buffer_load_dwordx4 v[96:99], v1, s[12:15], s57 offen offset:2048
    v_mfma_f32_16x16x32_bf16 a[140:143], v[16:19], a[172:175], a[140:143]
    v_mov_b32_dpp v12, v12 row_shr:1 row_mask:0xf bank_mask:0xf
    v_mfma_f32_16x16x32_bf16 a[140:143], v[40:43], a[176:179], a[140:143]
    v_mov_b32_dpp v13, v13 row_shr:1 row_mask:0xf bank_mask:0xf
    v_mfma_f32_16x16x32_bf16 a[140:143], v[72:75], a[180:183], a[140:143]
    v_mov_b32_dpp v14, v14 row_shr:1 row_mask:0xf bank_mask:0xf
    v_mfma_f32_16x16x32_bf16 a[140:143], v[76:79], a[184:187], a[140:143]
    v_mov_b32_dpp v15, v15 row_shr:1 row_mask:0xf bank_mask:0xf
    v_mfma_f32_16x16x32_bf16 a[140:143], v[8:11], a[188:191], a[140:143]
    buffer_load_dwordx4 v[100:103], v1, s[12:15], s55 offen offset:1024
    v_mfma_f32_16x16x32_bf16 a[136:139], v[36:39], a[164:167], a[136:139]
    v_cndmask_b32_dpp v12, v68, v12, vcc row_shl:1 row_mask:0xf bank_mask:0xf
    v_mfma_f32_16x16x32_bf16 a[136:139], v[16:19], a[168:171], a[136:139]
    v_cndmask_b32_dpp v13, v69, v13, vcc row_shl:1 row_mask:0xf bank_mask:0xf
    v_mfma_f32_16x16x32_bf16 a[136:139], v[40:43], a[172:175], a[136:139]
    v_cndmask_b32_dpp v14, v70, v14, vcc row_shl:1 row_mask:0xf bank_mask:0xf
    v_mfma_f32_16x16x32_bf16 a[136:139], v[72:75], a[176:179], a[136:139]
    v_cndmask_b32_dpp v15, v71, v15, vcc row_shl:1 row_mask:0xf bank_mask:0xf
    v_mfma_f32_16x16x32_bf16 a[136:139], v[76:79], a[180:183], a[136:139]
    buffer_load_dwordx4 v[80:83], v1, s[12:15], s57 offen offset:1024
    v_mfma_f32_16x16x32_bf16 a[136:139], v[8:11], a[184:187], a[136:139]
    v_mov_b32_dpp v36, v36 row_shr:1 row_mask:0xf bank_mask:0xf
    v_mfma_f32_16x16x32_bf16 a[136:139], v[24:27], a[188:191], a[136:139]
    v_mov_b32_dpp v37, v37 row_shr:1 row_mask:0xf bank_mask:0xf
    v_mfma_f32_16x16x32_bf16 a[132:135], v[16:19], a[164:167], a[132:135]
    v_mov_b32_dpp v38, v38 row_shr:1 row_mask:0xf bank_mask:0xf
    v_mfma_f32_16x16x32_bf16 a[132:135], v[40:43], a[168:171], a[132:135]
    v_mov_b32_dpp v39, v39 row_shr:1 row_mask:0xf bank_mask:0xf
    v_mfma_f32_16x16x32_bf16 a[132:135], v[72:75], a[172:175], a[132:135]
    buffer_load_dwordx4 v[104:107], v1, s[12:15], s55 offen offset:0
    v_mfma_f32_16x16x32_bf16 a[132:135], v[76:79], a[176:179], a[132:135]
    v_cndmask_b32 v36, v68, v36, vcc
    v_mfma_f32_16x16x32_bf16 a[132:135], v[8:11], a[180:183], a[132:135]
    v_cndmask_b32 v37, v69, v37, vcc
    v_mfma_f32_16x16x32_bf16 a[132:135], v[24:27], a[184:187], a[132:135]
    v_cndmask_b32 v38, v70, v38, vcc
    v_mfma_f32_16x16x32_bf16 a[132:135], v[12:15], a[188:191], a[132:135]
    v_cndmask_b32 v39, v71, v39, vcc
    v_mfma_f32_16x16x32_bf16 a[128:131], v[40:43], a[164:167], a[128:131]
    buffer_load_dwordx4 v[144:147], v1, s[12:15], s57 offen offset:0
    v_mfma_f32_16x16x32_bf16 a[128:131], v[72:75], a[168:171], a[128:131]
    v_mfma_f32_16x16x32_bf16 a[128:131], v[76:79], a[172:175], a[128:131]
    v_mfma_f32_16x16x32_bf16 a[128:131], v[8:11], a[176:179], a[128:131]
    v_mfma_f32_16x16x32_bf16 a[128:131], v[24:27], a[180:183], a[128:131]
    v_mfma_f32_16x16x32_bf16 a[128:131], v[12:15], a[184:187], a[128:131]
    buffer_load_dwordx4 a[224:227], v1, s[16:19], s54 offen offset:0
    v_mfma_f32_16x16x32_bf16 a[128:131], v[36:39], a[188:191], a[128:131]
    s_waitcnt vmcnt(18)
    v_mfma_f32_16x16x32_bf16 a[28:31], v[48:51], a[192:195], a[28:31]
    v_mfma_f32_16x16x32_bf16 a[28:31], v[20:23], a[196:199], a[28:31]
    v_mfma_f32_16x16x32_bf16 a[28:31], v[32:35], a[200:203], a[28:31]
    s_waitcnt vmcnt(17)
    v_mfma_f32_16x16x32_bf16 a[28:31], v[60:63], a[204:207], a[28:31]
    buffer_load_dwordx4 a[228:231], v1, s[16:19], s54 offen offset:1024
    s_waitcnt vmcnt(17)
    v_mfma_f32_16x16x32_bf16 a[60:63], v[60:63], a[208:211], a[60:63]
    s_waitcnt vmcnt(16)
    v_mfma_f32_16x16x32_bf16 a[60:63], v[32:35], a[212:215], a[60:63]
    s_waitcnt vmcnt(15)
    v_mfma_f32_16x16x32_bf16 a[60:63], v[20:23], a[216:219], a[60:63]
    s_waitcnt vmcnt(14)
    v_mfma_f32_16x16x32_bf16 a[60:63], v[48:51], a[220:223], a[60:63]
    v_mov_b32_dpp v48, v48 row_shr:1 row_mask:0xf bank_mask:0xf
    s_waitcnt vmcnt(13)
    v_mfma_f32_16x16x32_bf16 a[60:63], v[52:55], a[192:195], a[60:63]
    buffer_load_dwordx4 a[232:235], v1, s[16:19], s54 offen offset:2048
    s_waitcnt vmcnt(13)
    v_mfma_f32_16x16x32_bf16 a[60:63], v[44:47], a[196:199], a[60:63]
    v_mov_b32_dpp v49, v49 row_shr:1 row_mask:0xf bank_mask:0xf
    s_waitcnt vmcnt(12)
    v_mfma_f32_16x16x32_bf16 a[60:63], v[108:111], a[200:203], a[60:63]
    v_mov_b32_dpp v50, v50 row_shr:1 row_mask:0xf bank_mask:0xf
    s_waitcnt vmcnt(11)
    v_mfma_f32_16x16x32_bf16 a[60:63], v[112:115], a[204:207], a[60:63]
    v_mov_b32_dpp v51, v51 row_shr:1 row_mask:0xf bank_mask:0xf
    v_mfma_f32_16x16x32_bf16 a[92:95], v[112:115], a[208:211], a[92:95]
    v_cndmask_b32_dpp v48, v28, v48, vcc row_shl:5 row_mask:0xf bank_mask:0xf
    v_mfma_f32_16x16x32_bf16 a[92:95], v[108:111], a[212:215], a[92:95]
    buffer_load_dwordx4 a[236:239], v1, s[16:19], s56 offen offset:1024
    v_mfma_f32_16x16x32_bf16 a[92:95], v[44:47], a[216:219], a[92:95]
    v_cndmask_b32_dpp v49, v29, v49, vcc row_shl:5 row_mask:0xf bank_mask:0xf
    v_mfma_f32_16x16x32_bf16 a[92:95], v[52:55], a[220:223], a[92:95]
    v_cndmask_b32_dpp v50, v30, v50, vcc row_shl:5 row_mask:0xf bank_mask:0xf
    v_mfma_f32_16x16x32_bf16 a[24:27], v[20:23], a[192:195], a[24:27]
    v_cndmask_b32_dpp v51, v31, v51, vcc row_shl:5 row_mask:0xf bank_mask:0xf
    v_mfma_f32_16x16x32_bf16 a[24:27], v[32:35], a[196:199], a[24:27]
    v_mov_b32_dpp v52, v52 row_shr:1 row_mask:0xf bank_mask:0xf
    v_mfma_f32_16x16x32_bf16 a[24:27], v[60:63], a[200:203], a[24:27]
    buffer_load_dwordx4 a[240:243], v1, s[16:19], s56 offen offset:0
    s_waitcnt vmcnt(12)
    v_mfma_f32_16x16x32_bf16 a[24:27], v[84:87], a[204:207], a[24:27]
    v_mov_b32_dpp v53, v53 row_shr:1 row_mask:0xf bank_mask:0xf
    v_mfma_f32_16x16x32_bf16 a[56:59], v[84:87], a[208:211], a[56:59]
    v_mov_b32_dpp v54, v54 row_shr:1 row_mask:0xf bank_mask:0xf
    v_mfma_f32_16x16x32_bf16 a[56:59], v[60:63], a[212:215], a[56:59]
    v_mov_b32_dpp v55, v55 row_shr:1 row_mask:0xf bank_mask:0xf
    v_mfma_f32_16x16x32_bf16 a[56:59], v[32:35], a[216:219], a[56:59]
    v_cndmask_b32_dpp v52, v56, v52, vcc row_shl:5 row_mask:0xf bank_mask:0xf
    v_mfma_f32_16x16x32_bf16 a[56:59], v[20:23], a[220:223], a[56:59]
    buffer_load_dwordx4 a[244:247], v1, s[16:19], s55 offen offset:3072
    v_mfma_f32_16x16x32_bf16 a[56:59], v[44:47], a[192:195], a[56:59]
    v_cndmask_b32_dpp v53, v57, v53, vcc row_shl:5 row_mask:0xf bank_mask:0xf
    v_mfma_f32_16x16x32_bf16 a[56:59], v[108:111], a[196:199], a[56:59]
    v_cndmask_b32_dpp v54, v58, v54, vcc row_shl:5 row_mask:0xf bank_mask:0xf
    v_mfma_f32_16x16x32_bf16 a[56:59], v[112:115], a[200:203], a[56:59]
    v_cndmask_b32_dpp v55, v59, v55, vcc row_shl:5 row_mask:0xf bank_mask:0xf
    s_waitcnt vmcnt(12)
    v_mfma_f32_16x16x32_bf16 a[56:59], v[88:91], a[204:207], a[56:59]
    v_mov_b32_dpp v20, v20 row_shr:1 row_mask:0xf bank_mask:0xf
    v_mfma_f32_16x16x32_bf16 a[88:91], v[88:91], a[208:211], a[88:91]
    buffer_load_dwordx4 v[148:151], v2, s[20:23], s59 offen offset:0
    v_mfma_f32_16x16x32_bf16 a[88:91], v[112:115], a[212:215], a[88:91]
    v_mov_b32_dpp v21, v21 row_shr:1 row_mask:0xf bank_mask:0xf
    v_mfma_f32_16x16x32_bf16 a[88:91], v[108:111], a[216:219], a[88:91]
    v_mov_b32_dpp v22, v22 row_shr:1 row_mask:0xf bank_mask:0xf
    v_mfma_f32_16x16x32_bf16 a[88:91], v[44:47], a[220:223], a[88:91]
    v_mov_b32_dpp v23, v23 row_shr:1 row_mask:0xf bank_mask:0xf
    v_mfma_f32_16x16x32_bf16 a[20:23], v[32:35], a[192:195], a[20:23]
    v_cndmask_b32_dpp v20, v28, v20, vcc row_shl:4 row_mask:0xf bank_mask:0xf
    v_mfma_f32_16x16x32_bf16 a[20:23], v[60:63], a[196:199], a[20:23]
    buffer_load_dwordx4 v[120:123], v1, s[12:15], s60 offen offset:3072
    v_mfma_f32_16x16x32_bf16 a[20:23], v[84:87], a[200:203], a[20:23]
    v_cndmask_b32_dpp v21, v29, v21, vcc row_shl:4 row_mask:0xf bank_mask:0xf
    s_waitcnt vmcnt(13)
    v_mfma_f32_16x16x32_bf16 a[20:23], v[92:95], a[204:207], a[20:23]
    v_cndmask_b32_dpp v22, v30, v22, vcc row_shl:4 row_mask:0xf bank_mask:0xf
    v_mfma_f32_16x16x32_bf16 a[52:55], v[92:95], a[208:211], a[52:55]
    v_cndmask_b32_dpp v23, v31, v23, vcc row_shl:4 row_mask:0xf bank_mask:0xf
    v_mfma_f32_16x16x32_bf16 a[52:55], v[84:87], a[212:215], a[52:55]
    v_mov_b32_dpp v44, v44 row_shr:1 row_mask:0xf bank_mask:0xf
    v_mfma_f32_16x16x32_bf16 a[52:55], v[60:63], a[216:219], a[52:55]
    buffer_load_dwordx4 a[248:251], v1, s[16:19], s56 offen offset:2048
    v_mfma_f32_16x16x32_bf16 a[52:55], v[32:35], a[220:223], a[52:55]
    v_mov_b32_dpp v45, v45 row_shr:1 row_mask:0xf bank_mask:0xf
    v_mfma_f32_16x16x32_bf16 a[52:55], v[108:111], a[192:195], a[52:55]
    v_mov_b32_dpp v46, v46 row_shr:1 row_mask:0xf bank_mask:0xf
    v_mfma_f32_16x16x32_bf16 a[52:55], v[112:115], a[196:199], a[52:55]
    v_mov_b32_dpp v47, v47 row_shr:1 row_mask:0xf bank_mask:0xf
    v_mfma_f32_16x16x32_bf16 a[52:55], v[88:91], a[200:203], a[52:55]
    v_cndmask_b32_dpp v44, v56, v44, vcc row_shl:4 row_mask:0xf bank_mask:0xf
    s_waitcnt vmcnt(13)
    v_mfma_f32_16x16x32_bf16 a[52:55], v[96:99], a[204:207], a[52:55]
    buffer_load_dwordx4 v[124:127], v1, s[12:15], s60 offen offset:2048
    v_mfma_f32_16x16x32_bf16 a[84:87], v[96:99], a[208:211], a[84:87]
    v_cndmask_b32_dpp v45, v57, v45, vcc row_shl:4 row_mask:0xf bank_mask:0xf
    v_mfma_f32_16x16x32_bf16 a[84:87], v[88:91], a[212:215], a[84:87]
    v_cndmask_b32_dpp v46, v58, v46, vcc row_shl:4 row_mask:0xf bank_mask:0xf
    v_mfma_f32_16x16x32_bf16 a[84:87], v[112:115], a[216:219], a[84:87]
    v_cndmask_b32_dpp v47, v59, v47, vcc row_shl:4 row_mask:0xf bank_mask:0xf
    v_mfma_f32_16x16x32_bf16 a[84:87], v[108:111], a[220:223], a[84:87]
    v_mov_b32_dpp v32, v32 row_shr:1 row_mask:0xf bank_mask:0xf
    v_mfma_f32_16x16x32_bf16 a[16:19], v[60:63], a[192:195], a[16:19]
    buffer_load_dwordx4 a[252:255], v1, s[16:19], s56 offen offset:3072
    v_mfma_f32_16x16x32_bf16 a[16:19], v[84:87], a[196:199], a[16:19]
    v_mov_b32_dpp v33, v33 row_shr:1 row_mask:0xf bank_mask:0xf
    v_mfma_f32_16x16x32_bf16 a[16:19], v[92:95], a[200:203], a[16:19]
    v_mov_b32_dpp v34, v34 row_shr:1 row_mask:0xf bank_mask:0xf
    s_waitcnt vmcnt(14)
    v_mfma_f32_16x16x32_bf16 a[16:19], v[100:103], a[204:207], a[16:19]
    v_mov_b32_dpp v35, v35 row_shr:1 row_mask:0xf bank_mask:0xf
    v_mfma_f32_16x16x32_bf16 a[48:51], v[100:103], a[208:211], a[48:51]
    v_cndmask_b32_dpp v32, v28, v32, vcc row_shl:3 row_mask:0xf bank_mask:0xf
    v_mfma_f32_16x16x32_bf16 a[48:51], v[92:95], a[212:215], a[48:51]
    buffer_load_dwordx4 v[128:131], v1, s[12:15], s60 offen offset:1024
    v_mfma_f32_16x16x32_bf16 a[48:51], v[84:87], a[216:219], a[48:51]
    v_cndmask_b32_dpp v33, v29, v33, vcc row_shl:3 row_mask:0xf bank_mask:0xf
    v_mfma_f32_16x16x32_bf16 a[48:51], v[60:63], a[220:223], a[48:51]
    v_cndmask_b32_dpp v34, v30, v34, vcc row_shl:3 row_mask:0xf bank_mask:0xf
    v_mfma_f32_16x16x32_bf16 a[48:51], v[112:115], a[192:195], a[48:51]
    v_cndmask_b32_dpp v35, v31, v35, vcc row_shl:3 row_mask:0xf bank_mask:0xf
    v_mfma_f32_16x16x32_bf16 a[48:51], v[88:91], a[196:199], a[48:51]
    v_mov_b32_dpp v108, v108 row_shr:1 row_mask:0xf bank_mask:0xf
    v_mfma_f32_16x16x32_bf16 a[48:51], v[96:99], a[200:203], a[48:51]
    buffer_load_dwordx4 a[160:163], v1, s[16:19], s57 offen offset:0
    s_waitcnt vmcnt(15)
    v_mfma_f32_16x16x32_bf16 a[48:51], v[80:83], a[204:207], a[48:51]
    v_mov_b32_dpp v109, v109 row_shr:1 row_mask:0xf bank_mask:0xf
    v_mfma_f32_16x16x32_bf16 a[80:83], v[80:83], a[208:211], a[80:83]
    v_mov_b32_dpp v110, v110 row_shr:1 row_mask:0xf bank_mask:0xf
    v_mfma_f32_16x16x32_bf16 a[80:83], v[96:99], a[212:215], a[80:83]
    v_mov_b32_dpp v111, v111 row_shr:1 row_mask:0xf bank_mask:0xf
    v_mfma_f32_16x16x32_bf16 a[80:83], v[88:91], a[216:219], a[80:83]
    v_cndmask_b32_dpp v108, v56, v108, vcc row_shl:3 row_mask:0xf bank_mask:0xf
    v_mfma_f32_16x16x32_bf16 a[80:83], v[112:115], a[220:223], a[80:83]
    buffer_load_dwordx4 v[132:135], v1, s[12:15], s60 offen offset:0
    v_mfma_f32_16x16x32_bf16 a[12:15], v[84:87], a[192:195], a[12:15]
    v_cndmask_b32_dpp v109, v57, v109, vcc row_shl:3 row_mask:0xf bank_mask:0xf
    v_mfma_f32_16x16x32_bf16 a[12:15], v[92:95], a[196:199], a[12:15]
    v_cndmask_b32_dpp v110, v58, v110, vcc row_shl:3 row_mask:0xf bank_mask:0xf
    v_mfma_f32_16x16x32_bf16 a[12:15], v[100:103], a[200:203], a[12:15]
    v_cndmask_b32_dpp v111, v59, v111, vcc row_shl:3 row_mask:0xf bank_mask:0xf
    s_waitcnt vmcnt(15)
    v_mfma_f32_16x16x32_bf16 a[12:15], v[104:107], a[204:207], a[12:15]
    v_mov_b32_dpp v60, v60 row_shr:1 row_mask:0xf bank_mask:0xf
    v_mfma_f32_16x16x32_bf16 a[44:47], v[104:107], a[208:211], a[44:47]
    buffer_load_dwordx4 a[164:167], v1, s[16:19], s57 offen offset:1024
    v_mfma_f32_16x16x32_bf16 a[44:47], v[100:103], a[212:215], a[44:47]
    v_mov_b32_dpp v61, v61 row_shr:1 row_mask:0xf bank_mask:0xf
    v_mfma_f32_16x16x32_bf16 a[44:47], v[92:95], a[216:219], a[44:47]
    v_mov_b32_dpp v62, v62 row_shr:1 row_mask:0xf bank_mask:0xf
    v_mfma_f32_16x16x32_bf16 a[44:47], v[84:87], a[220:223], a[44:47]
    v_mov_b32_dpp v63, v63 row_shr:1 row_mask:0xf bank_mask:0xf
    v_mfma_f32_16x16x32_bf16 a[44:47], v[88:91], a[192:195], a[44:47]
    v_cndmask_b32_dpp v60, v28, v60, vcc row_shl:2 row_mask:0xf bank_mask:0xf
    v_mfma_f32_16x16x32_bf16 a[44:47], v[96:99], a[196:199], a[44:47]
    buffer_load_dwordx4 v[136:139], v1, s[12:15], s59 offen offset:3072
    v_mfma_f32_16x16x32_bf16 a[44:47], v[80:83], a[200:203], a[44:47]
    v_cndmask_b32_dpp v61, v29, v61, vcc row_shl:2 row_mask:0xf bank_mask:0xf
    s_waitcnt vmcnt(16)
    v_mfma_f32_16x16x32_bf16 a[44:47], v[144:147], a[204:207], a[44:47]
    v_cndmask_b32_dpp v62, v30, v62, vcc row_shl:2 row_mask:0xf bank_mask:0xf
    v_mfma_f32_16x16x32_bf16 a[76:79], v[144:147], a[208:211], a[76:79]
    v_cndmask_b32_dpp v63, v31, v63, vcc row_shl:2 row_mask:0xf bank_mask:0xf
    v_mfma_f32_16x16x32_bf16 a[76:79], v[80:83], a[212:215], a[76:79]
    v_mov_b32_dpp v112, v112 row_shr:1 row_mask:0xf bank_mask:0xf
    v_mfma_f32_16x16x32_bf16 a[76:79], v[96:99], a[216:219], a[76:79]
    buffer_load_dwordx4 a[168:171], v1, s[16:19], s57 offen offset:2048
    v_mfma_f32_16x16x32_bf16 a[76:79], v[88:91], a[220:223], a[76:79]
    v_mov_b32_dpp v113, v113 row_shr:1 row_mask:0xf bank_mask:0xf
    v_mfma_f32_16x16x32_bf16 a[8:11], v[92:95], a[192:195], a[8:11]
    v_mov_b32_dpp v114, v114 row_shr:1 row_mask:0xf bank_mask:0xf
    v_mfma_f32_16x16x32_bf16 a[8:11], v[100:103], a[196:199], a[8:11]
    v_mov_b32_dpp v115, v115 row_shr:1 row_mask:0xf bank_mask:0xf
    v_mfma_f32_16x16x32_bf16 a[8:11], v[104:107], a[200:203], a[8:11]
    v_cndmask_b32_dpp v112, v56, v112, vcc row_shl:2 row_mask:0xf bank_mask:0xf
    v_mfma_f32_16x16x32_bf16 a[8:11], v[48:51], a[204:207], a[8:11]
    buffer_load_dwordx4 v[116:119], v1, s[12:15], s59 offen offset:2048
    v_mfma_f32_16x16x32_bf16 a[40:43], v[48:51], a[208:211], a[40:43]
    v_cndmask_b32_dpp v113, v57, v113, vcc row_shl:2 row_mask:0xf bank_mask:0xf
    v_mfma_f32_16x16x32_bf16 a[40:43], v[104:107], a[212:215], a[40:43]
    v_cndmask_b32_dpp v114, v58, v114, vcc row_shl:2 row_mask:0xf bank_mask:0xf
    v_mfma_f32_16x16x32_bf16 a[40:43], v[100:103], a[216:219], a[40:43]
    v_cndmask_b32_dpp v115, v59, v115, vcc row_shl:2 row_mask:0xf bank_mask:0xf
    v_mfma_f32_16x16x32_bf16 a[40:43], v[92:95], a[220:223], a[40:43]
    v_mfma_f32_16x16x32_bf16 a[40:43], v[96:99], a[192:195], a[40:43]
    buffer_load_dwordx4 a[172:175], v1, s[16:19], s57 offen offset:3072
    v_mfma_f32_16x16x32_bf16 a[40:43], v[80:83], a[196:199], a[40:43]
    v_mfma_f32_16x16x32_bf16 a[40:43], v[144:147], a[200:203], a[40:43]
    v_mfma_f32_16x16x32_bf16 a[40:43], v[52:55], a[204:207], a[40:43]
    v_mfma_f32_16x16x32_bf16 a[72:75], v[52:55], a[208:211], a[72:75]
    v_mfma_f32_16x16x32_bf16 a[72:75], v[144:147], a[212:215], a[72:75]
    buffer_load_dwordx4 v[140:143], v1, s[12:15], s59 offen offset:1024
    v_mfma_f32_16x16x32_bf16 a[72:75], v[80:83], a[216:219], a[72:75]
    v_mfma_f32_16x16x32_bf16 a[72:75], v[96:99], a[220:223], a[72:75]
    v_mfma_f32_16x16x32_bf16 a[4:7], v[100:103], a[192:195], a[4:7]
    v_mfma_f32_16x16x32_bf16 a[4:7], v[104:107], a[196:199], a[4:7]
    v_mfma_f32_16x16x32_bf16 a[4:7], v[48:51], a[200:203], a[4:7]
    buffer_load_dwordx4 a[176:179], v1, s[16:19], s58 offen offset:0
    v_mfma_f32_16x16x32_bf16 a[4:7], v[20:23], a[204:207], a[4:7]
    v_mfma_f32_16x16x32_bf16 a[36:39], v[20:23], a[208:211], a[36:39]
    v_mfma_f32_16x16x32_bf16 a[36:39], v[48:51], a[212:215], a[36:39]
    v_mfma_f32_16x16x32_bf16 a[36:39], v[104:107], a[216:219], a[36:39]
    v_mfma_f32_16x16x32_bf16 a[36:39], v[100:103], a[220:223], a[36:39]
    buffer_load_dwordx4 v[208:211], v1, s[12:15], s59 offen offset:0
    v_mfma_f32_16x16x32_bf16 a[36:39], v[80:83], a[192:195], a[36:39]
    v_mfma_f32_16x16x32_bf16 a[36:39], v[144:147], a[196:199], a[36:39]
    v_mfma_f32_16x16x32_bf16 a[36:39], v[52:55], a[200:203], a[36:39]
    v_mfma_f32_16x16x32_bf16 a[36:39], v[44:47], a[204:207], a[36:39]
    v_mfma_f32_16x16x32_bf16 a[68:71], v[44:47], a[208:211], a[68:71]
    buffer_load_dwordx4 v[212:215], v2, s[20:23], s61 offen offset:0
    v_mfma_f32_16x16x32_bf16 a[68:71], v[52:55], a[212:215], a[68:71]
    v_mfma_f32_16x16x32_bf16 a[68:71], v[144:147], a[216:219], a[68:71]
    v_mfma_f32_16x16x32_bf16 a[68:71], v[80:83], a[220:223], a[68:71]
    v_mfma_f32_16x16x32_bf16 a[0:3], v[104:107], a[192:195], a[0:3]
    v_mfma_f32_16x16x32_bf16 a[0:3], v[48:51], a[196:199], a[0:3]
    buffer_load_dwordx4 v[216:219], v1, s[12:15], s62 offen offset:3072
    v_mfma_f32_16x16x32_bf16 a[0:3], v[20:23], a[200:203], a[0:3]
    v_mfma_f32_16x16x32_bf16 a[0:3], v[32:35], a[204:207], a[0:3]
    v_mfma_f32_16x16x32_bf16 a[32:35], v[32:35], a[208:211], a[32:35]
    v_mfma_f32_16x16x32_bf16 a[32:35], v[20:23], a[212:215], a[32:35]
    v_mfma_f32_16x16x32_bf16 a[32:35], v[48:51], a[216:219], a[32:35]
    buffer_load_dwordx4 a[180:183], v1, s[16:19], s58 offen offset:1024
    v_mfma_f32_16x16x32_bf16 a[32:35], v[104:107], a[220:223], a[32:35]
    v_mfma_f32_16x16x32_bf16 a[32:35], v[144:147], a[192:195], a[32:35]
    v_mfma_f32_16x16x32_bf16 a[32:35], v[52:55], a[196:199], a[32:35]
    v_mfma_f32_16x16x32_bf16 a[32:35], v[44:47], a[200:203], a[32:35]
    v_mfma_f32_16x16x32_bf16 a[32:35], v[108:111], a[204:207], a[32:35]
    buffer_load_dwordx4 v[220:223], v1, s[12:15], s62 offen offset:2048
    v_mfma_f32_16x16x32_bf16 a[64:67], v[108:111], a[208:211], a[64:67]
    v_mfma_f32_16x16x32_bf16 a[64:67], v[44:47], a[212:215], a[64:67]
    v_mfma_f32_16x16x32_bf16 a[64:67], v[52:55], a[216:219], a[64:67]
    v_mfma_f32_16x16x32_bf16 a[64:67], v[144:147], a[220:223], a[64:67]
    s_waitcnt vmcnt(18)
    v_mfma_f32_16x16x32_bf16 a[28:31], v[84:87], a[224:227], a[28:31]
    buffer_load_dwordx4 a[184:187], v1, s[16:19], s58 offen offset:2048
    v_mfma_f32_16x16x32_bf16 a[28:31], v[92:95], a[228:231], a[28:31]
    v_mfma_f32_16x16x32_bf16 a[28:31], v[100:103], a[232:235], a[28:31]
    v_mfma_f32_16x16x32_bf16 a[60:63], v[100:103], a[236:239], a[60:63]
    v_mfma_f32_16x16x32_bf16 a[60:63], v[92:95], a[240:243], a[60:63]
    v_mfma_f32_16x16x32_bf16 a[60:63], v[84:87], a[244:247], a[60:63]
    buffer_load_dwordx4 v[160:163], v1, s[12:15], s62 offen offset:1024
    v_mfma_f32_16x16x32_bf16 a[60:63], v[88:91], a[224:227], a[60:63]
    v_mov_b32_dpp v84, v84 row_shr:1 row_mask:0xf bank_mask:0xf
    v_mfma_f32_16x16x32_bf16 a[60:63], v[96:99], a[228:231], a[60:63]
    v_mov_b32_dpp v85, v85 row_shr:1 row_mask:0xf bank_mask:0xf
    v_mfma_f32_16x16x32_bf16 a[60:63], v[80:83], a[232:235], a[60:63]
    v_mov_b32_dpp v86, v86 row_shr:1 row_mask:0xf bank_mask:0xf
    v_mfma_f32_16x16x32_bf16 a[92:95], v[80:83], a[236:239], a[92:95]
    v_mov_b32_dpp v87, v87 row_shr:1 row_mask:0xf bank_mask:0xf
    v_mfma_f32_16x16x32_bf16 a[92:95], v[96:99], a[240:243], a[92:95]
    buffer_load_dwordx4 a[188:191], v1, s[16:19], s58 offen offset:3072
    v_mfma_f32_16x16x32_bf16 a[92:95], v[88:91], a[244:247], a[92:95]
    v_cndmask_b32_dpp v84, v28, v84, vcc row_shl:1 row_mask:0xf bank_mask:0xf
    v_mfma_f32_16x16x32_bf16 a[24:27], v[92:95], a[224:227], a[24:27]
    v_cndmask_b32_dpp v85, v29, v85, vcc row_shl:1 row_mask:0xf bank_mask:0xf
    v_mfma_f32_16x16x32_bf16 a[24:27], v[100:103], a[228:231], a[24:27]
    v_cndmask_b32_dpp v86, v30, v86, vcc row_shl:1 row_mask:0xf bank_mask:0xf
    v_mfma_f32_16x16x32_bf16 a[24:27], v[104:107], a[232:235], a[24:27]
    v_cndmask_b32_dpp v87, v31, v87, vcc row_shl:1 row_mask:0xf bank_mask:0xf
    v_mfma_f32_16x16x32_bf16 a[56:59], v[104:107], a[236:239], a[56:59]
    buffer_load_dwordx4 v[176:179], v1, s[12:15], s62 offen offset:0
    v_mfma_f32_16x16x32_bf16 a[56:59], v[100:103], a[240:243], a[56:59]
    v_mov_b32_dpp v88, v88 row_shr:1 row_mask:0xf bank_mask:0xf
    v_mfma_f32_16x16x32_bf16 a[56:59], v[92:95], a[244:247], a[56:59]
    v_mov_b32_dpp v89, v89 row_shr:1 row_mask:0xf bank_mask:0xf
    v_mfma_f32_16x16x32_bf16 a[56:59], v[96:99], a[224:227], a[56:59]
    v_mov_b32_dpp v90, v90 row_shr:1 row_mask:0xf bank_mask:0xf
    v_mfma_f32_16x16x32_bf16 a[56:59], v[80:83], a[228:231], a[56:59]
    v_mov_b32_dpp v91, v91 row_shr:1 row_mask:0xf bank_mask:0xf
    v_mfma_f32_16x16x32_bf16 a[56:59], v[144:147], a[232:235], a[56:59]
    buffer_load_dwordx4 a[192:195], v1, s[16:19], s59 offen offset:0
    v_mfma_f32_16x16x32_bf16 a[88:91], v[144:147], a[236:239], a[88:91]
    v_cndmask_b32_dpp v88, v56, v88, vcc row_shl:1 row_mask:0xf bank_mask:0xf
    v_mfma_f32_16x16x32_bf16 a[88:91], v[80:83], a[240:243], a[88:91]
    v_cndmask_b32_dpp v89, v57, v89, vcc row_shl:1 row_mask:0xf bank_mask:0xf
    v_mfma_f32_16x16x32_bf16 a[88:91], v[96:99], a[244:247], a[88:91]
    v_cndmask_b32_dpp v90, v58, v90, vcc row_shl:1 row_mask:0xf bank_mask:0xf
    v_mfma_f32_16x16x32_bf16 a[20:23], v[100:103], a[224:227], a[20:23]
    v_cndmask_b32_dpp v91, v59, v91, vcc row_shl:1 row_mask:0xf bank_mask:0xf
    v_mfma_f32_16x16x32_bf16 a[20:23], v[104:107], a[228:231], a[20:23]
    buffer_load_dwordx4 v[164:167], v1, s[12:15], s61 offen offset:3072
    v_mfma_f32_16x16x32_bf16 a[20:23], v[48:51], a[232:235], a[20:23]
    v_mov_b32_dpp v92, v92 row_shr:1 row_mask:0xf bank_mask:0xf
    v_mfma_f32_16x16x32_bf16 a[52:55], v[48:51], a[236:239], a[52:55]
    v_mov_b32_dpp v93, v93 row_shr:1 row_mask:0xf bank_mask:0xf
    v_mfma_f32_16x16x32_bf16 a[52:55], v[104:107], a[240:243], a[52:55]
    v_mov_b32_dpp v94, v94 row_shr:1 row_mask:0xf bank_mask:0xf
    v_mfma_f32_16x16x32_bf16 a[52:55], v[100:103], a[244:247], a[52:55]
    v_mov_b32_dpp v95, v95 row_shr:1 row_mask:0xf bank_mask:0xf
    v_mfma_f32_16x16x32_bf16 a[52:55], v[80:83], a[224:227], a[52:55]
    buffer_load_dwordx4 a[196:199], v1, s[16:19], s59 offen offset:1024
    v_mfma_f32_16x16x32_bf16 a[52:55], v[144:147], a[228:231], a[52:55]
    v_cndmask_b32 v92, v28, v92, vcc
    v_mfma_f32_16x16x32_bf16 a[52:55], v[52:55], a[232:235], a[52:55]
    v_cndmask_b32 v93, v29, v93, vcc
    v_mfma_f32_16x16x32_bf16 a[84:87], v[52:55], a[236:239], a[84:87]
    v_cndmask_b32 v94, v30, v94, vcc
    v_mfma_f32_16x16x32_bf16 a[84:87], v[144:147], a[240:243], a[84:87]
    v_cndmask_b32 v95, v31, v95, vcc
    v_mfma_f32_16x16x32_bf16 a[84:87], v[80:83], a[244:247], a[84:87]
    buffer_load_dwordx4 v[180:183], v1, s[12:15], s61 offen offset:2048
    v_mfma_f32_16x16x32_bf16 a[16:19], v[104:107], a[224:227], a[16:19]
    v_mov_b32_dpp v96, v96 row_shr:1 row_mask:0xf bank_mask:0xf
    v_mfma_f32_16x16x32_bf16 a[16:19], v[48:51], a[228:231], a[16:19]
    v_mov_b32_dpp v97, v97 row_shr:1 row_mask:0xf bank_mask:0xf
    v_mfma_f32_16x16x32_bf16 a[16:19], v[20:23], a[232:235], a[16:19]
    v_mov_b32_dpp v98, v98 row_shr:1 row_mask:0xf bank_mask:0xf
    v_mfma_f32_16x16x32_bf16 a[48:51], v[20:23], a[236:239], a[48:51]
    v_mov_b32_dpp v99, v99 row_shr:1 row_mask:0xf bank_mask:0xf
    v_mfma_f32_16x16x32_bf16 a[48:51], v[48:51], a[240:243], a[48:51]
    buffer_load_dwordx4 a[200:203], v1, s[16:19], s59 offen offset:2048
    v_mfma_f32_16x16x32_bf16 a[48:51], v[104:107], a[244:247], a[48:51]
    v_cndmask_b32 v96, v56, v96, vcc
    v_mfma_f32_16x16x32_bf16 a[48:51], v[144:147], a[224:227], a[48:51]
    v_cndmask_b32 v97, v57, v97, vcc
    v_mfma_f32_16x16x32_bf16 a[48:51], v[52:55], a[228:231], a[48:51]
    v_cndmask_b32 v98, v58, v98, vcc
    v_mfma_f32_16x16x32_bf16 a[48:51], v[44:47], a[232:235], a[48:51]
    v_cndmask_b32 v99, v59, v99, vcc
    v_mfma_f32_16x16x32_bf16 a[80:83], v[44:47], a[236:239], a[80:83]
    buffer_load_dwordx4 v[168:171], v1, s[12:15], s61 offen offset:1024
    v_mfma_f32_16x16x32_bf16 a[80:83], v[52:55], a[240:243], a[80:83]
    v_mfma_f32_16x16x32_bf16 a[80:83], v[144:147], a[244:247], a[80:83]
    v_mfma_f32_16x16x32_bf16 a[12:15], v[48:51], a[224:227], a[12:15]
    v_mfma_f32_16x16x32_bf16 a[12:15], v[20:23], a[228:231], a[12:15]
    v_mfma_f32_16x16x32_bf16 a[12:15], v[32:35], a[232:235], a[12:15]
    buffer_load_dwordx4 a[204:207], v1, s[16:19], s59 offen offset:3072
    v_mfma_f32_16x16x32_bf16 a[44:47], v[32:35], a[236:239], a[44:47]
    v_mfma_f32_16x16x32_bf16 a[44:47], v[20:23], a[240:243], a[44:47]
    v_mfma_f32_16x16x32_bf16 a[44:47], v[48:51], a[244:247], a[44:47]
    v_mfma_f32_16x16x32_bf16 a[44:47], v[52:55], a[224:227], a[44:47]
    v_mfma_f32_16x16x32_bf16 a[44:47], v[44:47], a[228:231], a[44:47]
    buffer_load_dwordx4 v[184:187], v1, s[12:15], s61 offen offset:0
    v_mfma_f32_16x16x32_bf16 a[44:47], v[108:111], a[232:235], a[44:47]
    v_mfma_f32_16x16x32_bf16 a[76:79], v[108:111], a[236:239], a[76:79]
    v_mfma_f32_16x16x32_bf16 a[76:79], v[44:47], a[240:243], a[76:79]
    v_mfma_f32_16x16x32_bf16 a[76:79], v[52:55], a[244:247], a[76:79]
    v_mfma_f32_16x16x32_bf16 a[8:11], v[20:23], a[224:227], a[8:11]
    v_mfma_f32_16x16x32_bf16 a[8:11], v[32:35], a[228:231], a[8:11]
    v_mfma_f32_16x16x32_bf16 a[8:11], v[60:63], a[232:235], a[8:11]
    v_mfma_f32_16x16x32_bf16 a[40:43], v[60:63], a[236:239], a[40:43]
    v_mfma_f32_16x16x32_bf16 a[40:43], v[32:35], a[240:243], a[40:43]
    v_mfma_f32_16x16x32_bf16 a[40:43], v[20:23], a[244:247], a[40:43]
    v_mfma_f32_16x16x32_bf16 a[40:43], v[44:47], a[224:227], a[40:43]
    v_mfma_f32_16x16x32_bf16 a[40:43], v[108:111], a[228:231], a[40:43]
    v_mfma_f32_16x16x32_bf16 a[40:43], v[112:115], a[232:235], a[40:43]
    v_mfma_f32_16x16x32_bf16 a[72:75], v[112:115], a[236:239], a[72:75]
    v_mfma_f32_16x16x32_bf16 a[72:75], v[108:111], a[240:243], a[72:75]
    v_mfma_f32_16x16x32_bf16 a[72:75], v[44:47], a[244:247], a[72:75]
    v_mfma_f32_16x16x32_bf16 a[4:7], v[32:35], a[224:227], a[4:7]
    v_mfma_f32_16x16x32_bf16 a[4:7], v[60:63], a[228:231], a[4:7]
    v_mfma_f32_16x16x32_bf16 a[4:7], v[84:87], a[232:235], a[4:7]
    v_mfma_f32_16x16x32_bf16 a[36:39], v[84:87], a[236:239], a[36:39]
    v_mfma_f32_16x16x32_bf16 a[36:39], v[60:63], a[240:243], a[36:39]
    v_mfma_f32_16x16x32_bf16 a[36:39], v[32:35], a[244:247], a[36:39]
    v_mfma_f32_16x16x32_bf16 a[36:39], v[108:111], a[224:227], a[36:39]
    v_mfma_f32_16x16x32_bf16 a[36:39], v[112:115], a[228:231], a[36:39]
    v_mfma_f32_16x16x32_bf16 a[36:39], v[88:91], a[232:235], a[36:39]
    v_mfma_f32_16x16x32_bf16 a[68:71], v[88:91], a[236:239], a[68:71]
    v_mfma_f32_16x16x32_bf16 a[68:71], v[112:115], a[240:243], a[68:71]
    v_mfma_f32_16x16x32_bf16 a[68:71], v[108:111], a[244:247], a[68:71]
    v_mfma_f32_16x16x32_bf16 a[0:3], v[60:63], a[224:227], a[0:3]
    v_mfma_f32_16x16x32_bf16 a[0:3], v[84:87], a[228:231], a[0:3]
    v_mfma_f32_16x16x32_bf16 a[0:3], v[92:95], a[232:235], a[0:3]
    v_mfma_f32_16x16x32_bf16 a[32:35], v[92:95], a[236:239], a[32:35]
    v_mfma_f32_16x16x32_bf16 a[32:35], v[84:87], a[240:243], a[32:35]
    v_mfma_f32_16x16x32_bf16 a[32:35], v[60:63], a[244:247], a[32:35]
    v_mfma_f32_16x16x32_bf16 a[32:35], v[112:115], a[224:227], a[32:35]
    v_mfma_f32_16x16x32_bf16 a[32:35], v[88:91], a[228:231], a[32:35]
    v_mfma_f32_16x16x32_bf16 a[32:35], v[96:99], a[232:235], a[32:35]
    v_mfma_f32_16x16x32_bf16 a[64:67], v[96:99], a[236:239], a[64:67]
    v_mfma_f32_16x16x32_bf16 a[64:67], v[88:91], a[240:243], a[64:67]
    v_mfma_f32_16x16x32_bf16 a[64:67], v[112:115], a[244:247], a[64:67]
    s_waitcnt vmcnt(10)
    v_mfma_f32_16x16x32_bf16 a[124:127], v[120:123], a[248:251], a[124:127]
    v_mov_b32_dpp v120, v120 row_shr:1 row_mask:0xf bank_mask:0xf
    v_mov_b32_dpp v121, v121 row_shr:1 row_mask:0xf bank_mask:0xf
    v_mfma_f32_16x16x32_bf16 a[124:127], v[124:127], a[252:255], a[124:127]
    v_mov_b32_dpp v122, v122 row_shr:1 row_mask:0xf bank_mask:0xf
    v_mfma_f32_16x16x32_bf16 a[124:127], v[128:131], a[160:163], a[124:127]
    v_mov_b32_dpp v123, v123 row_shr:1 row_mask:0xf bank_mask:0xf
    v_mfma_f32_16x16x32_bf16 a[124:127], v[132:135], a[164:167], a[124:127]
    v_cndmask_b32_dpp v120, v148, v120, vcc row_shl:5 row_mask:0xf bank_mask:0xf
    v_mfma_f32_16x16x32_bf16 a[124:127], v[136:139], a[168:171], a[124:127]
    v_cndmask_b32_dpp v121, v149, v121, vcc row_shl:5 row_mask:0xf bank_mask:0xf
    v_mfma_f32_16x16x32_bf16 a[124:127], v[116:119], a[172:175], a[124:127]
    v_cndmask_b32_dpp v122, v150, v122, vcc row_shl:5 row_mask:0xf bank_mask:0xf
    v_mfma_f32_16x16x32_bf16 a[124:127], v[140:143], a[176:179], a[124:127]
    v_cndmask_b32_dpp v123, v151, v123, vcc row_shl:5 row_mask:0xf bank_mask:0xf
    v_mfma_f32_16x16x32_bf16 a[120:123], v[124:127], a[248:251], a[120:123]
    v_mov_b32_dpp v124, v124 row_shr:1 row_mask:0xf bank_mask:0xf
    v_mfma_f32_16x16x32_bf16 a[120:123], v[128:131], a[252:255], a[120:123]
    v_mov_b32_dpp v125, v125 row_shr:1 row_mask:0xf bank_mask:0xf
    v_mfma_f32_16x16x32_bf16 a[120:123], v[132:135], a[160:163], a[120:123]
    v_mov_b32_dpp v126, v126 row_shr:1 row_mask:0xf bank_mask:0xf
    v_mfma_f32_16x16x32_bf16 a[120:123], v[136:139], a[164:167], a[120:123]
    v_mov_b32_dpp v127, v127 row_shr:1 row_mask:0xf bank_mask:0xf
    v_mfma_f32_16x16x32_bf16 a[120:123], v[116:119], a[168:171], a[120:123]
    v_cndmask_b32_dpp v124, v148, v124, vcc row_shl:4 row_mask:0xf bank_mask:0xf
    v_mfma_f32_16x16x32_bf16 a[120:123], v[140:143], a[172:175], a[120:123]
    v_cndmask_b32_dpp v125, v149, v125, vcc row_shl:4 row_mask:0xf bank_mask:0xf
    v_mfma_f32_16x16x32_bf16 a[120:123], v[208:211], a[176:179], a[120:123]
    v_cndmask_b32_dpp v126, v150, v126, vcc row_shl:4 row_mask:0xf bank_mask:0xf
    v_mfma_f32_16x16x32_bf16 a[116:119], v[128:131], a[248:251], a[116:119]
    v_cndmask_b32_dpp v127, v151, v127, vcc row_shl:4 row_mask:0xf bank_mask:0xf
    v_mfma_f32_16x16x32_bf16 a[116:119], v[132:135], a[252:255], a[116:119]
    v_mov_b32_dpp v128, v128 row_shr:1 row_mask:0xf bank_mask:0xf
    v_mfma_f32_16x16x32_bf16 a[116:119], v[136:139], a[160:163], a[116:119]
    v_mov_b32_dpp v129, v129 row_shr:1 row_mask:0xf bank_mask:0xf
    v_mfma_f32_16x16x32_bf16 a[116:119], v[116:119], a[164:167], a[116:119]
    v_mov_b32_dpp v130, v130 row_shr:1 row_mask:0xf bank_mask:0xf
    v_mfma_f32_16x16x32_bf16 a[116:119], v[140:143], a[168:171], a[116:119]
    v_mov_b32_dpp v131, v131 row_shr:1 row_mask:0xf bank_mask:0xf
    v_mfma_f32_16x16x32_bf16 a[116:119], v[208:211], a[172:175], a[116:119]
    v_cndmask_b32_dpp v128, v148, v128, vcc row_shl:3 row_mask:0xf bank_mask:0xf
    v_mfma_f32_16x16x32_bf16 a[116:119], v[120:123], a[176:179], a[116:119]
    v_cndmask_b32_dpp v129, v149, v129, vcc row_shl:3 row_mask:0xf bank_mask:0xf
    v_mfma_f32_16x16x32_bf16 a[112:115], v[132:135], a[248:251], a[112:115]
    v_cndmask_b32_dpp v130, v150, v130, vcc row_shl:3 row_mask:0xf bank_mask:0xf
    v_mfma_f32_16x16x32_bf16 a[112:115], v[136:139], a[252:255], a[112:115]
    v_cndmask_b32_dpp v131, v151, v131, vcc row_shl:3 row_mask:0xf bank_mask:0xf
    v_mfma_f32_16x16x32_bf16 a[112:115], v[116:119], a[160:163], a[112:115]
    v_mov_b32_dpp v132, v132 row_shr:1 row_mask:0xf bank_mask:0xf
    v_mfma_f32_16x16x32_bf16 a[112:115], v[140:143], a[164:167], a[112:115]
    v_mov_b32_dpp v133, v133 row_shr:1 row_mask:0xf bank_mask:0xf
    v_mfma_f32_16x16x32_bf16 a[112:115], v[208:211], a[168:171], a[112:115]
    v_mov_b32_dpp v134, v134 row_shr:1 row_mask:0xf bank_mask:0xf
    v_mfma_f32_16x16x32_bf16 a[112:115], v[120:123], a[172:175], a[112:115]
    v_mov_b32_dpp v135, v135 row_shr:1 row_mask:0xf bank_mask:0xf
    v_mfma_f32_16x16x32_bf16 a[112:115], v[124:127], a[176:179], a[112:115]
    v_cndmask_b32_dpp v132, v148, v132, vcc row_shl:2 row_mask:0xf bank_mask:0xf
    v_mfma_f32_16x16x32_bf16 a[108:111], v[136:139], a[248:251], a[108:111]
    v_cndmask_b32_dpp v133, v149, v133, vcc row_shl:2 row_mask:0xf bank_mask:0xf
    v_mfma_f32_16x16x32_bf16 a[108:111], v[116:119], a[252:255], a[108:111]
    v_cndmask_b32_dpp v134, v150, v134, vcc row_shl:2 row_mask:0xf bank_mask:0xf
    v_mfma_f32_16x16x32_bf16 a[108:111], v[140:143], a[160:163], a[108:111]
    v_cndmask_b32_dpp v135, v151, v135, vcc row_shl:2 row_mask:0xf bank_mask:0xf
    v_mfma_f32_16x16x32_bf16 a[108:111], v[208:211], a[164:167], a[108:111]
    v_mov_b32_dpp v136, v136 row_shr:1 row_mask:0xf bank_mask:0xf
    v_mfma_f32_16x16x32_bf16 a[108:111], v[120:123], a[168:171], a[108:111]
    v_mov_b32_dpp v137, v137 row_shr:1 row_mask:0xf bank_mask:0xf
    v_mfma_f32_16x16x32_bf16 a[108:111], v[124:127], a[172:175], a[108:111]
    v_mov_b32_dpp v138, v138 row_shr:1 row_mask:0xf bank_mask:0xf
    v_mfma_f32_16x16x32_bf16 a[108:111], v[128:131], a[176:179], a[108:111]
    v_mov_b32_dpp v139, v139 row_shr:1 row_mask:0xf bank_mask:0xf
    v_mfma_f32_16x16x32_bf16 a[104:107], v[116:119], a[248:251], a[104:107]
    v_cndmask_b32_dpp v136, v148, v136, vcc row_shl:1 row_mask:0xf bank_mask:0xf
    v_mfma_f32_16x16x32_bf16 a[104:107], v[140:143], a[252:255], a[104:107]
    v_cndmask_b32_dpp v137, v149, v137, vcc row_shl:1 row_mask:0xf bank_mask:0xf
    v_mfma_f32_16x16x32_bf16 a[104:107], v[208:211], a[160:163], a[104:107]
    v_cndmask_b32_dpp v138, v150, v138, vcc row_shl:1 row_mask:0xf bank_mask:0xf
    v_mfma_f32_16x16x32_bf16 a[104:107], v[120:123], a[164:167], a[104:107]
    v_cndmask_b32_dpp v139, v151, v139, vcc row_shl:1 row_mask:0xf bank_mask:0xf
    v_mfma_f32_16x16x32_bf16 a[104:107], v[124:127], a[168:171], a[104:107]
    v_mov_b32_dpp v116, v116 row_shr:1 row_mask:0xf bank_mask:0xf
    v_mfma_f32_16x16x32_bf16 a[104:107], v[128:131], a[172:175], a[104:107]
    v_mov_b32_dpp v117, v117 row_shr:1 row_mask:0xf bank_mask:0xf
    v_mfma_f32_16x16x32_bf16 a[104:107], v[132:135], a[176:179], a[104:107]
    v_mov_b32_dpp v118, v118 row_shr:1 row_mask:0xf bank_mask:0xf
    v_mfma_f32_16x16x32_bf16 a[100:103], v[140:143], a[248:251], a[100:103]
    v_mov_b32_dpp v119, v119 row_shr:1 row_mask:0xf bank_mask:0xf
    v_mfma_f32_16x16x32_bf16 a[100:103], v[208:211], a[252:255], a[100:103]
    v_cndmask_b32 v116, v148, v116, vcc
    v_mfma_f32_16x16x32_bf16 a[100:103], v[120:123], a[160:163], a[100:103]
    v_cndmask_b32 v117, v149, v117, vcc
    v_mfma_f32_16x16x32_bf16 a[100:103], v[124:127], a[164:167], a[100:103]
    v_cndmask_b32 v118, v150, v118, vcc
    v_mfma_f32_16x16x32_bf16 a[100:103], v[128:131], a[168:171], a[100:103]
    v_cndmask_b32 v119, v151, v119, vcc
    v_mfma_f32_16x16x32_bf16 a[100:103], v[132:135], a[172:175], a[100:103]
    v_mfma_f32_16x16x32_bf16 a[100:103], v[136:139], a[176:179], a[100:103]
    v_mfma_f32_16x16x32_bf16 a[96:99], v[208:211], a[248:251], a[96:99]
    v_mfma_f32_16x16x32_bf16 a[96:99], v[120:123], a[252:255], a[96:99]
    v_mfma_f32_16x16x32_bf16 a[96:99], v[124:127], a[160:163], a[96:99]
    v_mfma_f32_16x16x32_bf16 a[96:99], v[128:131], a[164:167], a[96:99]
    v_mfma_f32_16x16x32_bf16 a[96:99], v[132:135], a[168:171], a[96:99]
    v_mfma_f32_16x16x32_bf16 a[96:99], v[136:139], a[172:175], a[96:99]
    v_mfma_f32_16x16x32_bf16 a[96:99], v[116:119], a[176:179], a[96:99]
    v_mfma_f32_16x16x32_bf16 a[156:159], v[216:219], a[180:183], a[156:159]
    v_mov_b32_dpp v216, v216 row_shr:1 row_mask:0xf bank_mask:0xf
    v_mov_b32_dpp v217, v217 row_shr:1 row_mask:0xf bank_mask:0xf
    v_mfma_f32_16x16x32_bf16 a[156:159], v[220:223], a[184:187], a[156:159]
    v_mov_b32_dpp v218, v218 row_shr:1 row_mask:0xf bank_mask:0xf
    s_waitcnt vmcnt(0)
    v_mfma_f32_16x16x32_bf16 a[156:159], v[160:163], a[188:191], a[156:159]
    v_mov_b32_dpp v219, v219 row_shr:1 row_mask:0xf bank_mask:0xf
    v_mfma_f32_16x16x32_bf16 a[156:159], v[176:179], a[192:195], a[156:159]
    v_cndmask_b32_dpp v216, v212, v216, vcc row_shl:5 row_mask:0xf bank_mask:0xf
    v_mfma_f32_16x16x32_bf16 a[156:159], v[164:167], a[196:199], a[156:159]
    v_cndmask_b32_dpp v217, v213, v217, vcc row_shl:5 row_mask:0xf bank_mask:0xf
    v_mfma_f32_16x16x32_bf16 a[156:159], v[180:183], a[200:203], a[156:159]
    v_cndmask_b32_dpp v218, v214, v218, vcc row_shl:5 row_mask:0xf bank_mask:0xf
    v_mfma_f32_16x16x32_bf16 a[156:159], v[168:171], a[204:207], a[156:159]
    v_cndmask_b32_dpp v219, v215, v219, vcc row_shl:5 row_mask:0xf bank_mask:0xf
    v_mfma_f32_16x16x32_bf16 a[152:155], v[220:223], a[180:183], a[152:155]
    v_mov_b32_dpp v220, v220 row_shr:1 row_mask:0xf bank_mask:0xf
    v_mfma_f32_16x16x32_bf16 a[152:155], v[160:163], a[184:187], a[152:155]
    v_mov_b32_dpp v221, v221 row_shr:1 row_mask:0xf bank_mask:0xf
    v_mfma_f32_16x16x32_bf16 a[152:155], v[176:179], a[188:191], a[152:155]
    v_mov_b32_dpp v222, v222 row_shr:1 row_mask:0xf bank_mask:0xf
    v_mfma_f32_16x16x32_bf16 a[152:155], v[164:167], a[192:195], a[152:155]
    v_mov_b32_dpp v223, v223 row_shr:1 row_mask:0xf bank_mask:0xf
    v_mfma_f32_16x16x32_bf16 a[152:155], v[180:183], a[196:199], a[152:155]
    v_cndmask_b32_dpp v220, v212, v220, vcc row_shl:4 row_mask:0xf bank_mask:0xf
    v_mfma_f32_16x16x32_bf16 a[152:155], v[168:171], a[200:203], a[152:155]
    v_cndmask_b32_dpp v221, v213, v221, vcc row_shl:4 row_mask:0xf bank_mask:0xf
    v_mfma_f32_16x16x32_bf16 a[152:155], v[184:187], a[204:207], a[152:155]
    v_cndmask_b32_dpp v222, v214, v222, vcc row_shl:4 row_mask:0xf bank_mask:0xf
    v_mfma_f32_16x16x32_bf16 a[148:151], v[160:163], a[180:183], a[148:151]
    v_cndmask_b32_dpp v223, v215, v223, vcc row_shl:4 row_mask:0xf bank_mask:0xf
    v_mfma_f32_16x16x32_bf16 a[148:151], v[176:179], a[184:187], a[148:151]
    v_mov_b32_dpp v160, v160 row_shr:1 row_mask:0xf bank_mask:0xf
    v_mfma_f32_16x16x32_bf16 a[148:151], v[164:167], a[188:191], a[148:151]
    v_mov_b32_dpp v161, v161 row_shr:1 row_mask:0xf bank_mask:0xf
    v_mfma_f32_16x16x32_bf16 a[148:151], v[180:183], a[192:195], a[148:151]
    v_mov_b32_dpp v162, v162 row_shr:1 row_mask:0xf bank_mask:0xf
    v_mfma_f32_16x16x32_bf16 a[148:151], v[168:171], a[196:199], a[148:151]
    v_mov_b32_dpp v163, v163 row_shr:1 row_mask:0xf bank_mask:0xf
    v_mfma_f32_16x16x32_bf16 a[148:151], v[184:187], a[200:203], a[148:151]
    v_cndmask_b32_dpp v160, v212, v160, vcc row_shl:3 row_mask:0xf bank_mask:0xf
    v_mfma_f32_16x16x32_bf16 a[148:151], v[216:219], a[204:207], a[148:151]
    v_cndmask_b32_dpp v161, v213, v161, vcc row_shl:3 row_mask:0xf bank_mask:0xf
    v_mfma_f32_16x16x32_bf16 a[144:147], v[176:179], a[180:183], a[144:147]
    v_cndmask_b32_dpp v162, v214, v162, vcc row_shl:3 row_mask:0xf bank_mask:0xf
    v_mfma_f32_16x16x32_bf16 a[144:147], v[164:167], a[184:187], a[144:147]
    v_cndmask_b32_dpp v163, v215, v163, vcc row_shl:3 row_mask:0xf bank_mask:0xf
    v_mfma_f32_16x16x32_bf16 a[144:147], v[180:183], a[188:191], a[144:147]
    v_mov_b32_dpp v176, v176 row_shr:1 row_mask:0xf bank_mask:0xf
    v_mfma_f32_16x16x32_bf16 a[144:147], v[168:171], a[192:195], a[144:147]
    v_mov_b32_dpp v177, v177 row_shr:1 row_mask:0xf bank_mask:0xf
    v_mfma_f32_16x16x32_bf16 a[144:147], v[184:187], a[196:199], a[144:147]
    v_mov_b32_dpp v178, v178 row_shr:1 row_mask:0xf bank_mask:0xf
    v_mfma_f32_16x16x32_bf16 a[144:147], v[216:219], a[200:203], a[144:147]
    v_mov_b32_dpp v179, v179 row_shr:1 row_mask:0xf bank_mask:0xf
    v_mfma_f32_16x16x32_bf16 a[144:147], v[220:223], a[204:207], a[144:147]
    v_cndmask_b32_dpp v176, v212, v176, vcc row_shl:2 row_mask:0xf bank_mask:0xf
    v_mfma_f32_16x16x32_bf16 a[140:143], v[164:167], a[180:183], a[140:143]
    v_cndmask_b32_dpp v177, v213, v177, vcc row_shl:2 row_mask:0xf bank_mask:0xf
    v_mfma_f32_16x16x32_bf16 a[140:143], v[180:183], a[184:187], a[140:143]
    v_cndmask_b32_dpp v178, v214, v178, vcc row_shl:2 row_mask:0xf bank_mask:0xf
    v_mfma_f32_16x16x32_bf16 a[140:143], v[168:171], a[188:191], a[140:143]
    v_cndmask_b32_dpp v179, v215, v179, vcc row_shl:2 row_mask:0xf bank_mask:0xf
    v_mfma_f32_16x16x32_bf16 a[140:143], v[184:187], a[192:195], a[140:143]
    v_mov_b32_dpp v164, v164 row_shr:1 row_mask:0xf bank_mask:0xf
    v_mfma_f32_16x16x32_bf16 a[140:143], v[216:219], a[196:199], a[140:143]
    v_mov_b32_dpp v165, v165 row_shr:1 row_mask:0xf bank_mask:0xf
    v_mfma_f32_16x16x32_bf16 a[140:143], v[220:223], a[200:203], a[140:143]
    v_mov_b32_dpp v166, v166 row_shr:1 row_mask:0xf bank_mask:0xf
    v_mfma_f32_16x16x32_bf16 a[140:143], v[160:163], a[204:207], a[140:143]
    v_mov_b32_dpp v167, v167 row_shr:1 row_mask:0xf bank_mask:0xf
    v_mfma_f32_16x16x32_bf16 a[136:139], v[180:183], a[180:183], a[136:139]
    v_cndmask_b32_dpp v164, v212, v164, vcc row_shl:1 row_mask:0xf bank_mask:0xf
    v_mfma_f32_16x16x32_bf16 a[136:139], v[168:171], a[184:187], a[136:139]
    v_cndmask_b32_dpp v165, v213, v165, vcc row_shl:1 row_mask:0xf bank_mask:0xf
    v_mfma_f32_16x16x32_bf16 a[136:139], v[184:187], a[188:191], a[136:139]
    v_cndmask_b32_dpp v166, v214, v166, vcc row_shl:1 row_mask:0xf bank_mask:0xf
    v_mfma_f32_16x16x32_bf16 a[136:139], v[216:219], a[192:195], a[136:139]
    v_cndmask_b32_dpp v167, v215, v167, vcc row_shl:1 row_mask:0xf bank_mask:0xf
    v_mfma_f32_16x16x32_bf16 a[136:139], v[220:223], a[196:199], a[136:139]
    v_mov_b32_dpp v180, v180 row_shr:1 row_mask:0xf bank_mask:0xf
    v_mfma_f32_16x16x32_bf16 a[136:139], v[160:163], a[200:203], a[136:139]
    v_mov_b32_dpp v181, v181 row_shr:1 row_mask:0xf bank_mask:0xf
    v_mfma_f32_16x16x32_bf16 a[136:139], v[176:179], a[204:207], a[136:139]
    v_mov_b32_dpp v182, v182 row_shr:1 row_mask:0xf bank_mask:0xf
    v_mfma_f32_16x16x32_bf16 a[132:135], v[168:171], a[180:183], a[132:135]
    v_mov_b32_dpp v183, v183 row_shr:1 row_mask:0xf bank_mask:0xf
    v_mfma_f32_16x16x32_bf16 a[132:135], v[184:187], a[184:187], a[132:135]
    v_cndmask_b32 v180, v212, v180, vcc
    v_mfma_f32_16x16x32_bf16 a[132:135], v[216:219], a[188:191], a[132:135]
    v_cndmask_b32 v181, v213, v181, vcc
    v_mfma_f32_16x16x32_bf16 a[132:135], v[220:223], a[192:195], a[132:135]
    v_cndmask_b32 v182, v214, v182, vcc
    v_mfma_f32_16x16x32_bf16 a[132:135], v[160:163], a[196:199], a[132:135]
    v_cndmask_b32 v183, v215, v183, vcc
    v_mfma_f32_16x16x32_bf16 a[132:135], v[176:179], a[200:203], a[132:135]
    v_mfma_f32_16x16x32_bf16 a[132:135], v[164:167], a[204:207], a[132:135]
    v_mfma_f32_16x16x32_bf16 a[128:131], v[184:187], a[180:183], a[128:131]
    v_mfma_f32_16x16x32_bf16 a[128:131], v[216:219], a[184:187], a[128:131]
    v_mfma_f32_16x16x32_bf16 a[128:131], v[220:223], a[188:191], a[128:131]
    v_mfma_f32_16x16x32_bf16 a[128:131], v[160:163], a[192:195], a[128:131]
    v_mfma_f32_16x16x32_bf16 a[128:131], v[176:179], a[196:199], a[128:131]
    v_mfma_f32_16x16x32_bf16 a[128:131], v[164:167], a[200:203], a[128:131]
    v_mfma_f32_16x16x32_bf16 a[128:131], v[180:183], a[204:207], a[128:131]
    v_lshlrev_b32 v3, 4, v0
    s_add_u32 s10, s10, K2_at-K2_pc
    s_addc_u32 s11, s11, 0
    global_load_dwordx4 v[8:11], v3, s[10:11]
    v_and_b32 v3, 15, v0
    v_lshrrev_b32 v4, 4, v0
    v_lshlrev_b32 v4, 10, v4
    v_lshl_add_u32 v4, v3, 4, v4
    s_lshr_b32 s33, s24, 1
    s_mul_i32 s33, s33, 32768
    s_and_b32 s34, s24, 1
    s_lshl_b32 s34, s34, 3
    s_add_u32 s33, s33, s34
    v_add_u32 v5, s33, v4
    s_lshl_b32 s33, s24, 2
    s_add_u32 s33, s33, 65536
    v_add_u32 v6, s33, v4
    v_accvgpr_read_b32 v16, a0
    v_accvgpr_read_b32 v17, a32
    v_accvgpr_read_b32 v18, a64
    v_accvgpr_read_b32 v19, a96
    v_accvgpr_read_b32 v20, a128
    v_cvt_pk_bf16_f32 v16, v16, v17
    v_cvt_pk_bf16_f32 v17, v18, v19
    v_cvt_pk_bf16_f32 v18, v20, 0
    ds_write_b64 v5, v[16:17] offset:0
    ds_write_b32 v6, v18 offset:0
    v_accvgpr_read_b32 v24, a1
    v_accvgpr_read_b32 v25, a33
    v_accvgpr_read_b32 v26, a65
    v_accvgpr_read_b32 v27, a97
    v_accvgpr_read_b32 v28, a129
    v_cvt_pk_bf16_f32 v24, v24, v25
    v_cvt_pk_bf16_f32 v25, v26, v27
    v_cvt_pk_bf16_f32 v26, v28, 0
    ds_write_b64 v5, v[24:25] offset:256
    ds_write_b32 v6, v26 offset:256
    v_accvgpr_read_b32 v32, a2
    v_accvgpr_read_b32 v33, a34
    v_accvgpr_read_b32 v34, a66
    v_accvgpr_read_b32 v35, a98
    v_accvgpr_read_b32 v36, a130
    v_cvt_pk_bf16_f32 v32, v32, v33
    v_cvt_pk_bf16_f32 v33, v34, v35
    v_cvt_pk_bf16_f32 v34, v36, 0
    ds_write_b64 v5, v[32:33] offset:512
    ds_write_b32 v6, v34 offset:512
    v_accvgpr_read_b32 v40, a3
    v_accvgpr_read_b32 v41, a35
    v_accvgpr_read_b32 v42, a67
    v_accvgpr_read_b32 v43, a99
    v_accvgpr_read_b32 v44, a131
    v_cvt_pk_bf16_f32 v40, v40, v41
    v_cvt_pk_bf16_f32 v41, v42, v43
    v_cvt_pk_bf16_f32 v42, v44, 0
    ds_write_b64 v5, v[40:41] offset:768
    ds_write_b32 v6, v42 offset:768
    v_accvgpr_read_b32 v48, a4
    v_accvgpr_read_b32 v49, a36
    v_accvgpr_read_b32 v50, a68
    v_accvgpr_read_b32 v51, a100
    v_accvgpr_read_b32 v52, a132
    v_cvt_pk_bf16_f32 v48, v48, v49
    v_cvt_pk_bf16_f32 v49, v50, v51
    v_cvt_pk_bf16_f32 v50, v52, 0
    ds_write_b64 v5, v[48:49] offset:4096
    ds_write_b32 v6, v50 offset:4096
    v_accvgpr_read_b32 v56, a5
    v_accvgpr_read_b32 v57, a37
    v_accvgpr_read_b32 v58, a69
    v_accvgpr_read_b32 v59, a101
    v_accvgpr_read_b32 v60, a133
    v_cvt_pk_bf16_f32 v56, v56, v57
    v_cvt_pk_bf16_f32 v57, v58, v59
    v_cvt_pk_bf16_f32 v58, v60, 0
    ds_write_b64 v5, v[56:57] offset:4352
    ds_write_b32 v6, v58 offset:4352
    v_accvgpr_read_b32 v64, a6
    v_accvgpr_read_b32 v65, a38
    v_accvgpr_read_b32 v66, a70
    v_accvgpr_read_b32 v67, a102
    v_accvgpr_read_b32 v68, a134
    v_cvt_pk_bf16_f32 v64, v64, v65
    v_cvt_pk_bf16_f32 v65, v66, v67
    v_cvt_pk_bf16_f32 v66, v68, 0
    ds_write_b64 v5, v[64:65] offset:4608
    ds_write_b32 v6, v66 offset:4608
    v_accvgpr_read_b32 v72, a7
    v_accvgpr_read_b32 v73, a39
    v_accvgpr_read_b32 v74, a71
    v_accvgpr_read_b32 v75, a103
    v_accvgpr_read_b32 v76, a135
    v_cvt_pk_bf16_f32 v72, v72, v73
    v_cvt_pk_bf16_f32 v73, v74, v75
    v_cvt_pk_bf16_f32 v74, v76, 0
    ds_write_b64 v5, v[72:73] offset:4864
    ds_write_b32 v6, v74 offset:4864
    v_accvgpr_read_b32 v16, a8
    v_accvgpr_read_b32 v17, a40
    v_accvgpr_read_b32 v18, a72
    v_accvgpr_read_b32 v19, a104
    v_accvgpr_read_b32 v20, a136
    v_cvt_pk_bf16_f32 v16, v16, v17
    v_cvt_pk_bf16_f32 v17, v18, v19
    v_cvt_pk_bf16_f32 v18, v20, 0
    ds_write_b64 v5, v[16:17] offset:8192
    ds_write_b32 v6, v18 offset:8192
    v_accvgpr_read_b32 v24, a9
    v_accvgpr_read_b32 v25, a41
    v_accvgpr_read_b32 v26, a73
    v_accvgpr_read_b32 v27, a105
    v_accvgpr_read_b32 v28, a137
    v_cvt_pk_bf16_f32 v24, v24, v25
    v_cvt_pk_bf16_f32 v25, v26, v27
    v_cvt_pk_bf16_f32 v26, v28, 0
    ds_write_b64 v5, v[24:25] offset:8448
    ds_write_b32 v6, v26 offset:8448
    v_accvgpr_read_b32 v32, a10
    v_accvgpr_read_b32 v33, a42
    v_accvgpr_read_b32 v34, a74
    v_accvgpr_read_b32 v35, a106
    v_accvgpr_read_b32 v36, a138
    v_cvt_pk_bf16_f32 v32, v32, v33
    v_cvt_pk_bf16_f32 v33, v34, v35
    v_cvt_pk_bf16_f32 v34, v36, 0
    ds_write_b64 v5, v[32:33] offset:8704
    ds_write_b32 v6, v34 offset:8704
    v_accvgpr_read_b32 v40, a11
    v_accvgpr_read_b32 v41, a43
    v_accvgpr_read_b32 v42, a75
    v_accvgpr_read_b32 v43, a107
    v_accvgpr_read_b32 v44, a139
    v_cvt_pk_bf16_f32 v40, v40, v41
    v_cvt_pk_bf16_f32 v41, v42, v43
    v_cvt_pk_bf16_f32 v42, v44, 0
    ds_write_b64 v5, v[40:41] offset:8960
    ds_write_b32 v6, v42 offset:8960
    v_accvgpr_read_b32 v48, a12
    v_accvgpr_read_b32 v49, a44
    v_accvgpr_read_b32 v50, a76
    v_accvgpr_read_b32 v51, a108
    v_accvgpr_read_b32 v52, a140
    v_cvt_pk_bf16_f32 v48, v48, v49
    v_cvt_pk_bf16_f32 v49, v50, v51
    v_cvt_pk_bf16_f32 v50, v52, 0
    ds_write_b64 v5, v[48:49] offset:12288
    ds_write_b32 v6, v50 offset:12288
    v_accvgpr_read_b32 v56, a13
    v_accvgpr_read_b32 v57, a45
    v_accvgpr_read_b32 v58, a77
    v_accvgpr_read_b32 v59, a109
    v_accvgpr_read_b32 v60, a141
    v_cvt_pk_bf16_f32 v56, v56, v57
    v_cvt_pk_bf16_f32 v57, v58, v59
    v_cvt_pk_bf16_f32 v58, v60, 0
    ds_write_b64 v5, v[56:57] offset:12544
    ds_write_b32 v6, v58 offset:12544
    v_accvgpr_read_b32 v64, a14
    v_accvgpr_read_b32 v65, a46
    v_accvgpr_read_b32 v66, a78
    v_accvgpr_read_b32 v67, a110
    v_accvgpr_read_b32 v68, a142
    v_cvt_pk_bf16_f32 v64, v64, v65
    v_cvt_pk_bf16_f32 v65, v66, v67
    v_cvt_pk_bf16_f32 v66, v68, 0
    ds_write_b64 v5, v[64:65] offset:12800
    ds_write_b32 v6, v66 offset:12800
    v_accvgpr_read_b32 v72, a15
    v_accvgpr_read_b32 v73, a47
    v_accvgpr_read_b32 v74, a79
    v_accvgpr_read_b32 v75, a111
    v_accvgpr_read_b32 v76, a143
    v_cvt_pk_bf16_f32 v72, v72, v73
    v_cvt_pk_bf16_f32 v73, v74, v75
    v_cvt_pk_bf16_f32 v74, v76, 0
    ds_write_b64 v5, v[72:73] offset:13056
    ds_write_b32 v6, v74 offset:13056
    v_accvgpr_read_b32 v16, a16
    v_accvgpr_read_b32 v17, a48
    v_accvgpr_read_b32 v18, a80
    v_accvgpr_read_b32 v19, a112
    v_accvgpr_read_b32 v20, a144
    v_cvt_pk_bf16_f32 v16, v16, v17
    v_cvt_pk_bf16_f32 v17, v18, v19
    v_cvt_pk_bf16_f32 v18, v20, 0
    ds_write_b64 v5, v[16:17] offset:16384
    ds_write_b32 v6, v18 offset:16384
    v_accvgpr_read_b32 v24, a17
    v_accvgpr_read_b32 v25, a49
    v_accvgpr_read_b32 v26, a81
    v_accvgpr_read_b32 v27, a113
    v_accvgpr_read_b32 v28, a145
    v_cvt_pk_bf16_f32 v24, v24, v25
    v_cvt_pk_bf16_f32 v25, v26, v27
    v_cvt_pk_bf16_f32 v26, v28, 0
    ds_write_b64 v5, v[24:25] offset:16640
    ds_write_b32 v6, v26 offset:16640
    v_accvgpr_read_b32 v32, a18
    v_accvgpr_read_b32 v33, a50
    v_accvgpr_read_b32 v34, a82
    v_accvgpr_read_b32 v35, a114
    v_accvgpr_read_b32 v36, a146
    v_cvt_pk_bf16_f32 v32, v32, v33
    v_cvt_pk_bf16_f32 v33, v34, v35
    v_cvt_pk_bf16_f32 v34, v36, 0
    ds_write_b64 v5, v[32:33] offset:16896
    ds_write_b32 v6, v34 offset:16896
    v_accvgpr_read_b32 v40, a19
    v_accvgpr_read_b32 v41, a51
    v_accvgpr_read_b32 v42, a83
    v_accvgpr_read_b32 v43, a115
    v_accvgpr_read_b32 v44, a147
    v_cvt_pk_bf16_f32 v40, v40, v41
    v_cvt_pk_bf16_f32 v41, v42, v43
    v_cvt_pk_bf16_f32 v42, v44, 0
    ds_write_b64 v5, v[40:41] offset:17152
    ds_write_b32 v6, v42 offset:17152
    v_accvgpr_read_b32 v48, a20
    v_accvgpr_read_b32 v49, a52
    v_accvgpr_read_b32 v50, a84
    v_accvgpr_read_b32 v51, a116
    v_accvgpr_read_b32 v52, a148
    v_cvt_pk_bf16_f32 v48, v48, v49
    v_cvt_pk_bf16_f32 v49, v50, v51
    v_cvt_pk_bf16_f32 v50, v52, 0
    ds_write_b64 v5, v[48:49] offset:20480
    ds_write_b32 v6, v50 offset:20480
    v_accvgpr_read_b32 v56, a21
    v_accvgpr_read_b32 v57, a53
    v_accvgpr_read_b32 v58, a85
    v_accvgpr_read_b32 v59, a117
    v_accvgpr_read_b32 v60, a149
    v_cvt_pk_bf16_f32 v56, v56, v57
    v_cvt_pk_bf16_f32 v57, v58, v59
    v_cvt_pk_bf16_f32 v58, v60, 0
    ds_write_b64 v5, v[56:57] offset:20736
    ds_write_b32 v6, v58 offset:20736
    v_accvgpr_read_b32 v64, a22
    v_accvgpr_read_b32 v65, a54
    v_accvgpr_read_b32 v66, a86
    v_accvgpr_read_b32 v67, a118
    v_accvgpr_read_b32 v68, a150
    v_cvt_pk_bf16_f32 v64, v64, v65
    v_cvt_pk_bf16_f32 v65, v66, v67
    v_cvt_pk_bf16_f32 v66, v68, 0
    ds_write_b64 v5, v[64:65] offset:20992
    ds_write_b32 v6, v66 offset:20992
    v_accvgpr_read_b32 v72, a23
    v_accvgpr_read_b32 v73, a55
    v_accvgpr_read_b32 v74, a87
    v_accvgpr_read_b32 v75, a119
    v_accvgpr_read_b32 v76, a151
    v_cvt_pk_bf16_f32 v72, v72, v73
    v_cvt_pk_bf16_f32 v73, v74, v75
    v_cvt_pk_bf16_f32 v74, v76, 0
    ds_write_b64 v5, v[72:73] offset:21248
    ds_write_b32 v6, v74 offset:21248
    v_accvgpr_read_b32 v16, a24
    v_accvgpr_read_b32 v17, a56
    v_accvgpr_read_b32 v18, a88
    v_accvgpr_read_b32 v19, a120
    v_accvgpr_read_b32 v20, a152
    v_cvt_pk_bf16_f32 v16, v16, v17
    v_cvt_pk_bf16_f32 v17, v18, v19
    v_cvt_pk_bf16_f32 v18, v20, 0
    ds_write_b64 v5, v[16:17] offset:24576
    ds_write_b32 v6, v18 offset:24576
    v_accvgpr_read_b32 v24, a25
    v_accvgpr_read_b32 v25, a57
    v_accvgpr_read_b32 v26, a89
    v_accvgpr_read_b32 v27, a121
    v_accvgpr_read_b32 v28, a153
    v_cvt_pk_bf16_f32 v24, v24, v25
    v_cvt_pk_bf16_f32 v25, v26, v27
    v_cvt_pk_bf16_f32 v26, v28, 0
    ds_write_b64 v5, v[24:25] offset:24832
    ds_write_b32 v6, v26 offset:24832
    v_accvgpr_read_b32 v32, a26
    v_accvgpr_read_b32 v33, a58
    v_accvgpr_read_b32 v34, a90
    v_accvgpr_read_b32 v35, a122
    v_accvgpr_read_b32 v36, a154
    v_cvt_pk_bf16_f32 v32, v32, v33
    v_cvt_pk_bf16_f32 v33, v34, v35
    v_cvt_pk_bf16_f32 v34, v36, 0
    ds_write_b64 v5, v[32:33] offset:25088
    ds_write_b32 v6, v34 offset:25088
    v_accvgpr_read_b32 v40, a27
    v_accvgpr_read_b32 v41, a59
    v_accvgpr_read_b32 v42, a91
    v_accvgpr_read_b32 v43, a123
    v_accvgpr_read_b32 v44, a155
    v_cvt_pk_bf16_f32 v40, v40, v41
    v_cvt_pk_bf16_f32 v41, v42, v43
    v_cvt_pk_bf16_f32 v42, v44, 0
    ds_write_b64 v5, v[40:41] offset:25344
    ds_write_b32 v6, v42 offset:25344
    v_accvgpr_read_b32 v48, a28
    v_accvgpr_read_b32 v49, a60
    v_accvgpr_read_b32 v50, a92
    v_accvgpr_read_b32 v51, a124
    v_accvgpr_read_b32 v52, a156
    v_cvt_pk_bf16_f32 v48, v48, v49
    v_cvt_pk_bf16_f32 v49, v50, v51
    v_cvt_pk_bf16_f32 v50, v52, 0
    ds_write_b64 v5, v[48:49] offset:28672
    ds_write_b32 v6, v50 offset:28672
    v_accvgpr_read_b32 v56, a29
    v_accvgpr_read_b32 v57, a61
    v_accvgpr_read_b32 v58, a93
    v_accvgpr_read_b32 v59, a125
    v_accvgpr_read_b32 v60, a157
    v_cvt_pk_bf16_f32 v56, v56, v57
    v_cvt_pk_bf16_f32 v57, v58, v59
    v_cvt_pk_bf16_f32 v58, v60, 0
    ds_write_b64 v5, v[56:57] offset:28928
    ds_write_b32 v6, v58 offset:28928
    v_accvgpr_read_b32 v64, a30
    v_accvgpr_read_b32 v65, a62
    v_accvgpr_read_b32 v66, a94
    v_accvgpr_read_b32 v67, a126
    v_accvgpr_read_b32 v68, a158
    v_cvt_pk_bf16_f32 v64, v64, v65
    v_cvt_pk_bf16_f32 v65, v66, v67
    v_cvt_pk_bf16_f32 v66, v68, 0
    ds_write_b64 v5, v[64:65] offset:29184
    ds_write_b32 v6, v66 offset:29184
    v_accvgpr_read_b32 v72, a31
    v_accvgpr_read_b32 v73, a63
    v_accvgpr_read_b32 v74, a95
    v_accvgpr_read_b32 v75, a127
    v_accvgpr_read_b32 v76, a159
    v_cvt_pk_bf16_f32 v72, v72, v73
    v_cvt_pk_bf16_f32 v73, v74, v75
    v_cvt_pk_bf16_f32 v74, v76, 0
    ds_write_b64 v5, v[72:73] offset:29440
    ds_write_b32 v6, v74 offset:29440
    v_lshrrev_b32 v12, 5, v0
    v_bfe_u32 v13, v0, 1, 4
    v_and_b32 v14, 1, v0
    s_mov_b32 s38, 224
    s_mov_b32 s35, 2260
    s_mov_b32 s36, 43008
    s_mov_b32 s37, 192
    s_lshl_b32 s33, s27, 4
    s_lshl_b32 s34, s24, 2
    s_add_u32 s33, s33, s34
    s_add_u32 s33, s33, 0
    v_add_u32 v82, s33, v12
    v_mul_u32_u24 v83, s35, v82
    v_lshrrev_b32 v83, 16, v83
    v_mul_u32_u24 v84, 29, v83
    v_sub_u32 v84, v82, v84
    v_mul_u32_u24 v85, 10, v83
    v_add_u32 v85, v85, v13
    v_subrev_u32 v86, 1, v84
    v_mul_u32_u24 v86, 1792, v86
    v_add_u32 v86, v86, v85
    v_mul_lo_u32 v86, v86, s37
    v_lshl_add_u32 v86, v14, 4, v86
    s_lshl_b32 s34, s28, 5
    v_add_u32 v86, s34, v86
    v_mov_b32 v87, 0x7fffffff
    v_cmp_ne_u32 s[60:61], 0, v84
    v_cmp_gt_u32 s[62:63], 10, v13
    v_cmp_gt_u32 s[64:65], s38, v85
    s_nop 3
    s_and_b64 s[60:61], s[60:61], s[62:63]
    s_and_b64 s[60:61], s[60:61], s[64:65]
    s_nop 0
    v_cndmask_b32 v80, v87, v86, s[60:61]
    s_lshl_b32 s33, s27, 4
    s_lshl_b32 s34, s24, 2
    s_add_u32 s33, s33, s34
    s_add_u32 s33, s33, 2
    v_add_u32 v82, s33, v12
    v_mul_u32_u24 v83, s35, v82
    v_lshrrev_b32 v83, 16, v83
    v_mul_u32_u24 v84, 29, v83
    v_sub_u32 v84, v82, v84
    v_mul_u32_u24 v85, 10, v83
    v_add_u32 v85, v85, v13
    v_subrev_u32 v86, 1, v84
    v_mul_u32_u24 v86, 1792, v86
    v_add_u32 v86, v86, v85
    v_mul_lo_u32 v86, v86, s37
    v_lshl_add_u32 v86, v14, 4, v86
    s_lshl_b32 s34, s28, 5
    v_add_u32 v86, s34, v86
    v_mov_b32 v87, 0x7fffffff
    v_cmp_ne_u32 s[60:61], 0, v84
    v_cmp_gt_u32 s[62:63], 10, v13
    v_cmp_gt_u32 s[64:65], s38, v85
    s_nop 3
    s_and_b64 s[60:61], s[60:61], s[62:63]
    s_and_b64 s[60:61], s[60:61], s[64:65]
    s_nop 0
    v_cndmask_b32 v81, v87, v86, s[60:61]
    s_mov_b32 s6, 9633792
    s_mov_b32 s7, 0x00020000
    s_and_b32 s5, s5, 0xffff
    v_lshrrev_b32 v3, 4, v0
    v_min_u32 v3, 2, v3
    v_lshlrev_b32 v3, 15, v3
    v_and_b32 v4, 15, v0
    v_lshl_add_u32 v3, v4, 4, v3
    s_lshl_b32 s33, s24, 10
    v_add_u32 v7, s33, v3
    s_lshl_b32 s33, s24, 14
    s_add_u32 s33, s33, 98304
    v_lshrrev_b32 v3, 4, v0
    v_lshlrev_b32 v3, 3, v3
    v_lshl_add_u32 v3, v4, 5, v3
    v_add_u32 v88, s33, v3
    v_lshlrev_b32 v3, 4, v0
    v_add_u32 v89, s33, v3
    s_waitcnt lgkmcnt(0)
    s_barrier
    ds_read_b128 v[96:99], v7 offset:0
    ds_read_b128 v[100:103], v7 offset:256
    ds_read_b128 v[104:107], v7 offset:512
    ds_read_b128 v[108:111], v7 offset:768
    s_waitcnt vmcnt(0) lgkmcnt(3)
    v_mfma_f32_16x16x32_bf16 v[112:115], v[96:99], v[8:11], 0
    s_waitcnt lgkmcnt(2)
    v_mfma_f32_16x16x32_bf16 v[116:119], v[100:103], v[8:11], 0
    s_waitcnt lgkmcnt(1)
    v_mfma_f32_16x16x32_bf16 v[120:123], v[104:107], v[8:11], 0
    s_waitcnt lgkmcnt(0)
    v_mfma_f32_16x16x32_bf16 v[124:127], v[108:111], v[8:11], 0
    s_nop 1
    v_cvt_pk_bf16_f32 v112, v112, v113
    v_cvt_pk_bf16_f32 v113, v114, v115
    ds_write_b64 v88, v[112:113] offset:0
    v_cvt_pk_bf16_f32 v116, v116, v117
    v_cvt_pk_bf16_f32 v117, v118, v119
    ds_write_b64 v88, v[116:117] offset:512
    v_cvt_pk_bf16_f32 v120, v120, v121
    v_cvt_pk_bf16_f32 v121, v122, v123
    ds_write_b64 v88, v[120:121] offset:1024
    v_cvt_pk_bf16_f32 v124, v124, v125
    v_cvt_pk_bf16_f32 v125, v126, v127
    ds_write_b64 v88, v[124:125] offset:1536
    ds_read_b128 v[160:163], v89 offset:0
    ds_read_b128 v[164:167], v89 offset:1024
    s_mov_b32 s33, 0
    s_waitcnt lgkmcnt(1)
    buffer_store_dwordx4 v[160:163], v80, s[4:7], s33 offen
    s_mov_b32 s33, 0
    s_waitcnt lgkmcnt(0)
    buffer_store_dwordx4 v[164:167], v81, s[4:7], s33 offen
    ds_read_b128 v[128:131], v7 offset:4096
    ds_read_b128 v[132:135], v7 offset:4352
    ds_read_b128 v[136:139], v7 offset:4608
    ds_read_b128 v[140:143], v7 offset:4864
    s_waitcnt lgkmcnt(3)
    v_mfma_f32_16x16x32_bf16 v[144:147], v[128:131], v[8:11], 0
    s_waitcnt lgkmcnt(2)
    v_mfma_f32_16x16x32_bf16 v[148:151], v[132:135], v[8:11], 0
    s_waitcnt lgkmcnt(1)
    v_mfma_f32_16x16x32_bf16 v[152:155], v[136:139], v[8:11], 0
    s_waitcnt lgkmcnt(0)
    v_mfma_f32_16x16x32_bf16 v[156:159], v[140:143], v[8:11], 0
    s_nop 1
    v_cvt_pk_bf16_f32 v144, v144, v145
    v_cvt_pk_bf16_f32 v145, v146, v147
    ds_write_b64 v88, v[144:145] offset:2048
    v_cvt_pk_bf16_f32 v148, v148, v149
    v_cvt_pk_bf16_f32 v149, v150, v151
    ds_write_b64 v88, v[148:149] offset:2560
    v_cvt_pk_bf16_f32 v152, v152, v153
    v_cvt_pk_bf16_f32 v153, v154, v155
    ds_write_b64 v88, v[152:153] offset:3072
    v_cvt_pk_bf16_f32 v156, v156, v157
    v_cvt_pk_bf16_f32 v157, v158, v159
    ds_write_b64 v88, v[156:157] offset:3584
    ds_read_b128 v[168:171], v89 offset:2048
    ds_read_b128 v[172:175], v89 offset:3072
    s_mov_b32 s33, 43008
    s_waitcnt lgkmcnt(1)
    buffer_store_dwordx4 v[168:171], v80, s[4:7], s33 offen
    s_mov_b32 s33, 43008
    s_waitcnt lgkmcnt(0)
    buffer_store_dwordx4 v[172:175], v81, s[4:7], s33 offen
    ds_read_b128 v[96:99], v7 offset:8192
    ds_read_b128 v[100:103], v7 offset:8448
    ds_read_b128 v[104:107], v7 offset:8704
    ds_read_b128 v[108:111], v7 offset:8960
    s_waitcnt lgkmcnt(3)
    v_mfma_f32_16x16x32_bf16 v[112:115], v[96:99], v[8:11], 0
    s_waitcnt lgkmcnt(2)
    v_mfma_f32_16x16x32_bf16 v[116:119], v[100:103], v[8:11], 0
    s_waitcnt lgkmcnt(1)
    v_mfma_f32_16x16x32_bf16 v[120:123], v[104:107], v[8:11], 0
    s_waitcnt lgkmcnt(0)
    v_mfma_f32_16x16x32_bf16 v[124:127], v[108:111], v[8:11], 0
    s_nop 1
    v_cvt_pk_bf16_f32 v112, v112, v113
    v_cvt_pk_bf16_f32 v113, v114, v115
    ds_write_b64 v88, v[112:113] offset:4096
    v_cvt_pk_bf16_f32 v116, v116, v117
    v_cvt_pk_bf16_f32 v117, v118, v119
    ds_write_b64 v88, v[116:117] offset:4608
    v_cvt_pk_bf16_f32 v120, v120, v121
    v_cvt_pk_bf16_f32 v121, v122, v123
    ds_write_b64 v88, v[120:121] offset:5120
    v_cvt_pk_bf16_f32 v124, v124, v125
    v_cvt_pk_bf16_f32 v125, v126, v127
    ds_write_b64 v88, v[124:125] offset:5632
    ds_read_b128 v[176:179], v89 offset:4096
    ds_read_b128 v[180:183], v89 offset:5120
    s_mov_b32 s33, 86016
    s_waitcnt lgkmcnt(1)
    buffer_store_dwordx4 v[176:179], v80, s[4:7], s33 offen
    s_mov_b32 s33, 86016
    s_waitcnt lgkmcnt(0)
    buffer_store_dwordx4 v[180:183], v81, s[4:7], s33 offen
    ds_read_b128 v[128:131], v7 offset:12288
    ds_read_b128 v[132:135], v7 offset:12544
    ds_read_b128 v[136:139], v7 offset:12800
    ds_read_b128 v[140:143], v7 offset:13056
    s_waitcnt lgkmcnt(3)
    v_mfma_f32_16x16x32_bf16 v[144:147], v[128:131], v[8:11], 0
    s_waitcnt lgkmcnt(2)
    v_mfma_f32_16x16x32_bf16 v[148:151], v[132:135], v[8:11], 0
    s_waitcnt lgkmcnt(1)
    v_mfma_f32_16x16x32_bf16 v[152:155], v[136:139], v[8:11], 0
    s_waitcnt lgkmcnt(0)
    v_mfma_f32_16x16x32_bf16 v[156:159], v[140:143], v[8:11], 0
    s_nop 1
    v_cvt_pk_bf16_f32 v144, v144, v145
    v_cvt_pk_bf16_f32 v145, v146, v147
    ds_write_b64 v88, v[144:145] offset:6144
    v_cvt_pk_bf16_f32 v148, v148, v149
    v_cvt_pk_bf16_f32 v149, v150, v151
    ds_write_b64 v88, v[148:149] offset:6656
    v_cvt_pk_bf16_f32 v152, v152, v153
    v_cvt_pk_bf16_f32 v153, v154, v155
    ds_write_b64 v88, v[152:153] offset:7168
    v_cvt_pk_bf16_f32 v156, v156, v157
    v_cvt_pk_bf16_f32 v157, v158, v159
    ds_write_b64 v88, v[156:157] offset:7680
    ds_read_b128 v[184:187], v89 offset:6144
    ds_read_b128 v[188:191], v89 offset:7168
    s_mov_b32 s33, 129024
    s_waitcnt lgkmcnt(1)
    buffer_store_dwordx4 v[184:187], v80, s[4:7], s33 offen
    s_mov_b32 s33, 129024
    s_waitcnt lgkmcnt(0)
    buffer_store_dwordx4 v[188:191], v81, s[4:7], s33 offen
    ds_read_b128 v[96:99], v7 offset:16384
    ds_read_b128 v[100:103], v7 offset:16640
    ds_read_b128 v[104:107], v7 offset:16896
    ds_read_b128 v[108:111], v7 offset:17152
    s_waitcnt lgkmcnt(3)
    v_mfma_f32_16x16x32_bf16 v[112:115], v[96:99], v[8:11], 0
    s_waitcnt lgkmcnt(2)
    v_mfma_f32_16x16x32_bf16 v[116:119], v[100:103], v[8:11], 0
    s_waitcnt lgkmcnt(1)
    v_mfma_f32_16x16x32_bf16 v[120:123], v[104:107], v[8:11], 0
    s_waitcnt lgkmcnt(0)
    v_mfma_f32_16x16x32_bf16 v[124:127], v[108:111], v[8:11], 0
    s_nop 1
    v_cvt_pk_bf16_f32 v112, v112, v113
    v_cvt_pk_bf16_f32 v113, v114, v115
    ds_write_b64 v88, v[112:113] offset:8192
    v_cvt_pk_bf16_f32 v116, v116, v117
    v_cvt_pk_bf16_f32 v117, v118, v119
    ds_write_b64 v88, v[116:117] offset:8704
    v_cvt_pk_bf16_f32 v120, v120, v121
    v_cvt_pk_bf16_f32 v121, v122, v123
    ds_write_b64 v88, v[120:121] offset:9216
    v_cvt_pk_bf16_f32 v124, v124, v125
    v_cvt_pk_bf16_f32 v125, v126, v127
    ds_write_b64 v88, v[124:125] offset:9728
    ds_read_b128 v[160:163], v89 offset:8192
    ds_read_b128 v[164:167], v89 offset:9216
    s_mov_b32 s33, 172032
    s_waitcnt lgkmcnt(1)
    buffer_store_dwordx4 v[160:163], v80, s[4:7], s33 offen
    s_mov_b32 s33, 172032
    s_waitcnt lgkmcnt(0)
    buffer_store_dwordx4 v[164:167], v81, s[4:7], s33 offen
    ds_read_b128 v[128:131], v7 offset:20480
    ds_read_b128 v[132:135], v7 offset:20736
    ds_read_b128 v[136:139], v7 offset:20992
    ds_read_b128 v[140:143], v7 offset:21248
    s_waitcnt lgkmcnt(3)
    v_mfma_f32_16x16x32_bf16 v[144:147], v[128:131], v[8:11], 0
    s_waitcnt lgkmcnt(2)
    v_mfma_f32_16x16x32_bf16 v[148:151], v[132:135], v[8:11], 0
    s_waitcnt lgkmcnt(1)
    v_mfma_f32_16x16x32_bf16 v[152:155], v[136:139], v[8:11], 0
    s_waitcnt lgkmcnt(0)
    v_mfma_f32_16x16x32_bf16 v[156:159], v[140:143], v[8:11], 0
    s_nop 1
    v_cvt_pk_bf16_f32 v144, v144, v145
    v_cvt_pk_bf16_f32 v145, v146, v147
    ds_write_b64 v88, v[144:145] offset:10240
    v_cvt_pk_bf16_f32 v148, v148, v149
    v_cvt_pk_bf16_f32 v149, v150, v151
    ds_write_b64 v88, v[148:149] offset:10752
    v_cvt_pk_bf16_f32 v152, v152, v153
    v_cvt_pk_bf16_f32 v153, v154, v155
    ds_write_b64 v88, v[152:153] offset:11264
    v_cvt_pk_bf16_f32 v156, v156, v157
    v_cvt_pk_bf16_f32 v157, v158, v159
    ds_write_b64 v88, v[156:157] offset:11776
    ds_read_b128 v[168:171], v89 offset:10240
    ds_read_b128 v[172:175], v89 offset:11264
    s_mov_b32 s33, 215040
    s_waitcnt lgkmcnt(1)
    buffer_store_dwordx4 v[168:171], v80, s[4:7], s33 offen
    s_mov_b32 s33, 215040
    s_waitcnt lgkmcnt(0)
    buffer_store_dwordx4 v[172:175], v81, s[4:7], s33 offen
    ds_read_b128 v[96:99], v7 offset:24576
    ds_read_b128 v[100:103], v7 offset:24832
    ds_read_b128 v[104:107], v7 offset:25088
    ds_read_b128 v[108:111], v7 offset:25344
    s_waitcnt lgkmcnt(3)
    v_mfma_f32_16x16x32_bf16 v[112:115], v[96:99], v[8:11], 0
    s_waitcnt lgkmcnt(2)
    v_mfma_f32_16x16x32_bf16 v[116:119], v[100:103], v[8:11], 0
    s_waitcnt lgkmcnt(1)
    v_mfma_f32_16x16x32_bf16 v[120:123], v[104:107], v[8:11], 0
    s_waitcnt lgkmcnt(0)
    v_mfma_f32_16x16x32_bf16 v[124:127], v[108:111], v[8:11], 0
    s_nop 1
    v_cvt_pk_bf16_f32 v112, v112, v113
    v_cvt_pk_bf16_f32 v113, v114, v115
    ds_write_b64 v88, v[112:113] offset:12288
    v_cvt_pk_bf16_f32 v116, v116, v117
    v_cvt_pk_bf16_f32 v117, v118, v119
    ds_write_b64 v88, v[116:117] offset:12800
    v_cvt_pk_bf16_f32 v120, v120, v121
    v_cvt_pk_bf16_f32 v121, v122, v123
    ds_write_b64 v88, v[120:121] offset:13312
    v_cvt_pk_bf16_f32 v124, v124, v125
    v_cvt_pk_bf16_f32 v125, v126, v127
    ds_write_b64 v88, v[124:125] offset:13824
    ds_read_b128 v[176:179], v89 offset:12288
    ds_read_b128 v[180:183], v89 offset:13312
    s_mov_b32 s33, 258048
    s_waitcnt lgkmcnt(1)
    buffer_store_dwordx4 v[176:179], v80, s[4:7], s33 offen
    s_mov_b32 s33, 258048
    s_waitcnt lgkmcnt(0)
    buffer_store_dwordx4 v[180:183], v81, s[4:7], s33 offen
    ds_read_b128 v[128:131], v7 offset:28672
    ds_read_b128 v[132:135], v7 offset:28928
    ds_read_b128 v[136:139], v7 offset:29184
    ds_read_b128 v[140:143], v7 offset:29440
    s_waitcnt lgkmcnt(3)
    v_mfma_f32_16x16x32_bf16 v[144:147], v[128:131], v[8:11], 0
    s_waitcnt lgkmcnt(2)
    v_mfma_f32_16x16x32_bf16 v[148:151], v[132:135], v[8:11], 0
    s_waitcnt lgkmcnt(1)
    v_mfma_f32_16x16x32_bf16 v[152:155], v[136:139], v[8:11], 0
    s_waitcnt lgkmcnt(0)
    v_mfma_f32_16x16x32_bf16 v[156:159], v[140:143], v[8:11], 0
    s_nop 1
    v_cvt_pk_bf16_f32 v144, v144, v145
    v_cvt_pk_bf16_f32 v145, v146, v147
    ds_write_b64 v88, v[144:145] offset:14336
    v_cvt_pk_bf16_f32 v148, v148, v149
    v_cvt_pk_bf16_f32 v149, v150, v151
    ds_write_b64 v88, v[148:149] offset:14848
    v_cvt_pk_bf16_f32 v152, v152, v153
    v_cvt_pk_bf16_f32 v153, v154, v155
    ds_write_b64 v88, v[152:153] offset:15360
    v_cvt_pk_bf16_f32 v156, v156, v157
    v_cvt_pk_bf16_f32 v157, v158, v159
    ds_write_b64 v88, v[156:157] offset:15872
    ds_read_b128 v[184:187], v89 offset:14336
    ds_read_b128 v[188:191], v89 offset:15360
    s_mov_b32 s33, 301056
    s_waitcnt lgkmcnt(1)
    buffer_store_dwordx4 v[184:187], v80, s[4:7], s33 offen
    s_mov_b32 s33, 301056
    s_waitcnt lgkmcnt(0)
    buffer_store_dwordx4 v[188:191], v81, s[4:7], s33 offen
K2_end:
    s_endpgm
.p2align 8
K2_at:
    .long 0x00003f48, 0x4045bf48, 0x00003f40, 0x3fb7bf40, 0xbf103f0c, 0x0000bf0c, 0xbf3a3e3f, 0x3fb7be3f
    .long 0xbf48bcb3, 0x00003cb3, 0xbeb9bf28, 0x3fb73f28, 0xbf08bf13, 0x00003f13, 0x3f0cbf04, 0x3fb73f04
    .long 0x3d33bf48, 0x00003f48, 0x3f223ece, 0x3fb7bece, 0x3f17bf03, 0x00003f03, 0xbe6d3f37, 0x3fb7bf37
    .long 0x3f483d86, 0x0000bd86, 0xbf40bd41, 0x3fb73d41, 0x3efe3f1b, 0x0000bf1b, 0xbe10bf3d, 0x3fb73f3d
    .long 0xbdb33f47, 0x0000bf47, 0x3f2ebea4, 0x3fb73ea4, 0xbf1e3ef6, 0x0000bef6, 0x3ef53f14, 0x3fb7bf14
    .long 0x00000000, 0x00000000, 0x00000000, 0x00000000, 0x00000000, 0x00000000, 0x00000000, 0x00000000
    .long 0x00000000, 0x00000000, 0x00000000, 0x00000000, 0x00000000, 0x00000000, 0x00000000, 0x00000000
    .long 0x00000000, 0x00000000, 0x00000000, 0x00000000, 0x00000000, 0x00000000, 0x00000000, 0x00000000
    .long 0x00003f40, 0x3dc3bf40, 0x00003f48, 0x4025bf48, 0xbf3abe3f, 0x3e0d3e3f, 0xbf10bf0c, 0x3fe53f0c
    .long 0x3eb9bf28, 0x3e4b3f28, 0x3f48bcb3, 0x3f9f3cb3, 0x3f0c3f04, 0x3e92bf04, 0xbf083f13, 0x3f5cbf13
    .long 0xbf223ece, 0x3ed3bece, 0xbd33bf48, 0x3f183f48, 0xbe6dbf37, 0x3f183f37, 0x3f173f03, 0x3ed3bf03
    .long 0x3f40bd41, 0x3f5c3d41, 0xbf483d86, 0x3e92bd86, 0xbe103f3d, 0x3f9fbf3d, 0x3efebf1b, 0x3e4b3f1b
    .long 0xbf2ebea4, 0x3fe53ea4, 0x3db33f47, 0x3e0dbf47, 0x3ef5bf14, 0x40253f14, 0xbf1ebef6, 0x3dc33ef6
    .long 0x00000000, 0x00000000, 0x00000000, 0x00000000, 0x00000000, 0x00000000, 0x00000000, 0x00000000
    .long 0x00000000, 0x00000000, 0x00000000, 0x00000000, 0x00000000, 0x00000000, 0x00000000, 0x00000000
    .long 0x00000000, 0x00000000, 0x00000000, 0x00000000, 0x00000000, 0x00000000, 0x00000000, 0x00000000
    .long 0x00000000, 0x00003fb7, 0x00003dc3, 0x00004025, 0x00000000, 0x0000bfb7, 0x0000be0d, 0x0000bfe5
    .long 0x00000000, 0x00003fb7, 0x00003e4b, 0x00003f9f, 0x00000000, 0x0000bfb7, 0x0000be92, 0x0000bf5c
    .long 0x00000000, 0x00003fb7, 0x00003ed3, 0x00003f18, 0x00000000, 0x0000bfb7, 0x0000bf18, 0x0000bed3
    .long 0x00000000, 0x00003fb7, 0x00003f5c, 0x00003e92, 0x00000000, 0x0000bfb7, 0x0000bf9f, 0x0000be4b
    .long 0x00000000, 0x00003fb7, 0x00003fe5, 0x00003e0d, 0x00004045, 0x0000bfb7, 0x0000c025, 0x0000bdc3
    .long 0x00000000, 0x00000000, 0x00000000, 0x00000000, 0x00000000, 0x00000000, 0x00000000, 0x00000000
    .long 0x00000000, 0x00000000, 0x00000000, 0x00000000, 0x00000000, 0x00000000, 0x00000000, 0x00000000
    .long 0x00000000, 0x00000000, 0x00000000, 0x00000000, 0x00000000, 0x00000000, 0x00000000, 0x00000000
    .long 0x00000000, 0x00000000, 0x00000000, 0x00000000, 0x00000000, 0x00000000, 0x00000000, 0x00000000
    .long 0x00000000, 0x00000000, 0x00000000, 0x00000000, 0x00000000, 0x00000000, 0x00000000, 0x00000000
    .long 0x00000000, 0x00000000, 0x00000000, 0x00000000, 0x00000000, 0x00000000, 0x00000000, 0x00000000
    .long 0x00000000, 0x00000000, 0x00000000, 0x00000000, 0x00000000, 0x00000000, 0x00000000, 0x00000000
    .long 0x00000000, 0x00000000, 0x00000000, 0x00000000, 0x00000000, 0x00000000, 0x00000000, 0x00000000
    .long 0x00000000, 0x00000000, 0x00000000, 0x00000000, 0x00000000, 0x00000000, 0x00000000, 0x00000000
    .long 0x00000000, 0x00000000, 0x00000000, 0x00000000, 0x00000000, 0x00000000, 0x00000000, 0x00000000
    .long 0x00000000, 0x00000000, 0x00000000, 0x00000000, 0x00000000, 0x00000000, 0x00000000, 0x00000000

K2_code_end:
.section .rodata,"a"
.p2align 6
.amdhsa_kernel k2_kernel
  .amdhsa_next_free_vgpr 512
  .amdhsa_next_free_sgpr 96
  .amdhsa_accum_offset 256
  .amdhsa_group_segment_fixed_size 0
  .amdhsa_kernarg_size 40
  .amdhsa_user_sgpr_count 2
  .amdhsa_user_sgpr_kernarg_segment_ptr 1
  .amdhsa_system_sgpr_workgroup_id_x 1
.end_amdhsa_kernel
```

```asm
; @launch kernel=k1_kernel grid=(756,1,1) block=(128,1,1) lds=24704
; @launch kernel=k2_kernel grid=(256,1,1) block=(256,1,1) lds=163840
.amdgcn_target "amdgcn-amd-amdhsa--gfx950"
.text
.globl k1_kernel
.p2align 8
.type k1_kernel,@function
k1_kernel:
    s_load_dwordx4 s[4:7], s[0:1], 0
    s_load_dwordx2 s[8:9], s[0:1], 32
    s_getpc_b64 s[10:11]
K1_pc:
    v_lshrrev_b32 v1, 6, v0
    v_and_b32 v0, 63, v0
    s_cmp_ge_u32 s2, 756
    v_readfirstlane_b32 s19, v1
    s_cbranch_scc1 K1_end
    s_cmp_ge_u32 s2, 672
    s_cbranch_scc1 K1_w
    s_and_b32 s20, s2, 7
    s_lshr_b32 s21, s2, 3
    s_lshl_b32 s22, s21, 3
    s_lshl_b32 s23, s19, 2
    s_add_u32 s22, s22, s23
    v_and_b32 v1, 3, v0
    v_add_u32 v1, s22, v1
    v_mul_u32_u24 v2, 2260, v1
    v_lshrrev_b32 v2, 16, v2
    v_mul_u32_u24 v3, 29, v2
    v_sub_u32 v3, v1, v3
    v_min_u32 v2, 22, v2
    v_lshlrev_b32 v4, 3, v3
    v_add_u32 v4, 216, v4
    v_subrev_u32 v5, 224, v4
    v_min_u32 v4, v4, v5
    v_add_u32 v4, s20, v4
    v_mul_u32_u24 v4, 43008, v4
    v_mul_u32_u24 v6, 1920, v2
    v_add_u32 v7, v4, v6
    v_cmp_eq_u32 vcc, 0, v2
    v_mov_b32 v5, 43008
    v_mov_b32 v6, 0
    v_cndmask_b32 v3, v6, v5, vcc
    s_nop 0
    v_readlane_b32 s40, v7, 0
    v_readlane_b32 s41, v7, 1
    v_readlane_b32 s42, v7, 2
    v_readlane_b32 s43, v7, 3
    v_readlane_b32 s44, v3, 0
    v_readlane_b32 s45, v3, 1
    v_readlane_b32 s46, v3, 2
    v_readlane_b32 s47, v3, 3
    v_add_u32 v8, 0, v0
    v_mul_u32_u24 v9, 5462, v8
    v_bfe_u32 v10, v9, 18, 2
    v_xor_b32 v8, v8, v10
    v_lshlrev_b32 v12, 4, v8
    v_lshrrev_b32 v9, 16, v9
    v_cmp_gt_u32 vcc, 6, v9
    s_nop 1
    v_cndmask_b32 v16, 0, 1, vcc
    v_add_u32 v8, 64, v0
    v_mul_u32_u24 v9, 5462, v8
    v_bfe_u32 v10, v9, 18, 2
    v_xor_b32 v8, v8, v10
    v_lshlrev_b32 v13, 4, v8
    v_lshrrev_b32 v9, 16, v9
    v_cmp_gt_u32 vcc, 6, v9
    s_nop 1
    v_cndmask_b32 v17, 0, 1, vcc
    v_add_u32 v8, 128, v0
    v_mul_u32_u24 v9, 5462, v8
    v_bfe_u32 v10, v9, 18, 2
    v_xor_b32 v8, v8, v10
    v_lshlrev_b32 v14, 4, v8
    v_lshrrev_b32 v9, 16, v9
    s_mul_i32 s24, s19, 12352
    s_waitcnt lgkmcnt(0)
    s_sub_u32 s12, s4, 1152
    s_subb_u32 s13, s5, 0
    s_and_b32 s13, s13, 0xffff
    s_mov_b32 s14, 9634944
    s_mov_b32 s15, 0x00020000
    s_add_u32 m0, s24, 0
    v_mad_i32_i24 v8, v16, s44, v12
    buffer_load_dwordx4 v8, s[12:15], s40 offen lds
    s_add_u32 m0, s24, 1024
    v_mad_i32_i24 v9, v17, s44, v13
    buffer_load_dwordx4 v9, s[12:15], s40 offen lds
    s_add_u32 m0, s24, 2048
    s_nop 0
    buffer_load_dwordx4 v14, s[12:15], s40 offen lds
    s_add_u32 m0, s24, 3088
    v_mad_i32_i24 v9, v16, s45, v12
    buffer_load_dwordx4 v9, s[12:15], s41 offen lds
    s_add_u32 m0, s24, 4112
    v_mad_i32_i24 v8, v17, s45, v13
    buffer_load_dwordx4 v8, s[12:15], s41 offen lds
    s_add_u32 m0, s24, 5136
    s_nop 0
    buffer_load_dwordx4 v14, s[12:15], s41 offen lds
    s_add_u32 m0, s24, 6176
    v_mad_i32_i24 v8, v16, s46, v12
    buffer_load_dwordx4 v8, s[12:15], s42 offen lds
    s_add_u32 m0, s24, 7200
    v_mad_i32_i24 v9, v17, s46, v13
    buffer_load_dwordx4 v9, s[12:15], s42 offen lds
    s_add_u32 m0, s24, 8224
    s_nop 0
    buffer_load_dwordx4 v14, s[12:15], s42 offen lds
    s_add_u32 m0, s24, 9264
    v_mad_i32_i24 v9, v16, s47, v12
    buffer_load_dwordx4 v9, s[12:15], s43 offen lds
    s_add_u32 m0, s24, 10288
    v_mad_i32_i24 v8, v17, s47, v13
    buffer_load_dwordx4 v8, s[12:15], s43 offen lds
    s_add_u32 m0, s24, 11312
    s_nop 0
    buffer_load_dwordx4 v14, s[12:15], s43 offen lds
    v_lshlrev_b32 v1, 3, v0
    s_add_u32 s10, s10, K1_bt-K1_pc
    s_addc_u32 s11, s11, 0
    global_load_dwordx2 v[20:21], v1, s[10:11]
    v_lshrrev_b32 v2, 4, v0
    v_and_b32 v3, 15, v0
    v_lshrrev_b32 v4, 2, v3
    v_and_b32 v5, 3, v0
    v_lshl_add_u32 v6, v2, 2, v4
    v_mul_u32_u24 v7, 193, v5
    v_mul_u32_u24 v8, 12, v6
    v_add_u32 v7, v7, v8
    v_mov_b32 v10, s24
    v_xor_b32 v9, 0, v2
    v_add_u32 v9, v7, v9
    v_lshl_add_u32 v24, v9, 4, v10
    v_xor_b32 v9, 1, v2
    v_add_u32 v9, v7, v9
    v_lshl_add_u32 v25, v9, 4, v10
    v_xor_b32 v9, 2, v2
    v_add_u32 v9, v7, v9
    v_lshl_add_u32 v26, v9, 4, v10
    v_xor_b32 v9, 3, v2
    v_add_u32 v9, v7, v9
    v_lshl_add_u32 v27, v9, 4, v10
    v_mul_u32_u24 v7, 193, v2
    v_mul_u32_u24 v8, 12, v3
    v_add_u32 v7, v7, v8
    v_lshrrev_b32 v8, 2, v3
    v_xor_b32 v9, 0, v8
    v_add_u32 v9, v7, v9
    v_lshl_add_u32 v12, v9, 4, v10
    v_xor_b32 v9, 1, v8
    v_add_u32 v9, v7, v9
    v_lshl_add_u32 v13, v9, 4, v10
    v_xor_b32 v9, 2, v8
    v_add_u32 v9, v7, v9
    v_lshl_add_u32 v14, v9, 4, v10
    v_xor_b32 v9, 3, v8
    v_add_u32 v9, v7, v9
    v_lshl_add_u32 v15, v9, 4, v10
    v_lshrrev_b32 v2, 5, v0
    v_bfe_u32 v3, v0, 3, 2
    v_and_b32 v4, 7, v0
    v_mul_u32_u24 v7, 193, v4
    v_mul_u32_u24 v8, 12, v2
    v_add_u32 v7, v7, v8
    s_mul_i32 s25, s19, 1536
    v_mov_b32 v10, s25
    s_lshl_b32 s25, s19, 1
    s_add_u32 s27, s25, 0
    v_xor_b32 v9, s27, v3
    v_add_u32 v9, v7, v9
    v_lshl_add_u32 v16, v9, 4, v10
    s_add_u32 s27, s25, 1
    v_xor_b32 v9, s27, v3
    v_add_u32 v9, v7, v9
    v_lshl_add_u32 v17, v9, 4, v10
    v_lshlrev_b32 v7, 13, v2
    v_lshl_add_u32 v7, v3, 8, v7
    v_lshl_add_u32 v11, v4, 4, v7
    s_lshr_b32 s26, s21, 1
    s_mul_i32 s26, s26, 393216
    s_lshl_b32 s25, s20, 10
    s_add_u32 s26, s26, s25
    s_and_b32 s25, s21, 1
    s_lshl_b32 s25, s25, 7
    s_add_u32 s26, s26, s25
    s_mul_i32 s25, s19, 196608
    s_add_u32 s26, s26, s25
    s_mov_b32 s16, s8
    s_and_b32 s17, s9, 0xffff
    s_mov_b32 s18, 16515072
    s_mov_b32 s19, 0x00020000
    s_waitcnt vmcnt(1)
    ds_read_b64_tr_b16 v[32:33], v24 offset:0
    ds_read_b64_tr_b16 v[34:35], v24 offset:8
    ds_read_b64_tr_b16 v[36:37], v25 offset:0
    ds_read_b64_tr_b16 v[38:39], v25 offset:8
    ds_read_b64_tr_b16 v[40:41], v26 offset:0
    ds_read_b64_tr_b16 v[42:43], v26 offset:8
    ds_read_b64_tr_b16 v[44:45], v27 offset:0
    ds_read_b64_tr_b16 v[46:47], v27 offset:8
    ds_read_b64_tr_b16 v[48:49], v24 offset:64
    ds_read_b64_tr_b16 v[50:51], v24 offset:72
    ds_read_b64_tr_b16 v[52:53], v25 offset:64
    ds_read_b64_tr_b16 v[54:55], v25 offset:72
    ds_read_b64_tr_b16 v[56:57], v26 offset:64
    ds_read_b64_tr_b16 v[58:59], v26 offset:72
    ds_read_b64_tr_b16 v[60:61], v27 offset:64
    ds_read_b64_tr_b16 v[62:63], v27 offset:72
    ds_read_b64_tr_b16 v[64:65], v24 offset:128
    ds_read_b64_tr_b16 v[66:67], v24 offset:136
    ds_read_b64_tr_b16 v[68:69], v25 offset:128
    ds_read_b64_tr_b16 v[70:71], v25 offset:136
    ds_read_b64_tr_b16 v[72:73], v26 offset:128
    ds_read_b64_tr_b16 v[74:75], v26 offset:136
    ds_read_b64_tr_b16 v[76:77], v27 offset:128
    ds_read_b64_tr_b16 v[78:79], v27 offset:136
    s_waitcnt vmcnt(0) lgkmcnt(15)
    v_mfma_f32_16x16x16_bf16 v[80:83], v[32:33], v[20:21], 0
    v_mfma_f32_16x16x16_bf16 v[84:87], v[34:35], v[20:21], 0
    v_mfma_f32_16x16x16_bf16 v[88:91], v[36:37], v[20:21], 0
    v_mfma_f32_16x16x16_bf16 v[92:95], v[38:39], v[20:21], 0
    v_mfma_f32_16x16x16_bf16 v[96:99], v[40:41], v[20:21], 0
    v_mfma_f32_16x16x16_bf16 v[100:103], v[42:43], v[20:21], 0
    v_mfma_f32_16x16x16_bf16 v[104:107], v[44:45], v[20:21], 0
    v_mfma_f32_16x16x16_bf16 v[108:111], v[46:47], v[20:21], 0
    v_mfma_f32_16x16x16_bf16 v[112:115], v[48:49], v[20:21], 0
    s_waitcnt lgkmcnt(14)
    v_mfma_f32_16x16x16_bf16 v[116:119], v[50:51], v[20:21], 0
    s_waitcnt lgkmcnt(13)
    v_mfma_f32_16x16x16_bf16 v[120:123], v[52:53], v[20:21], 0
    s_waitcnt lgkmcnt(12)
    v_mfma_f32_16x16x16_bf16 v[124:127], v[54:55], v[20:21], 0
    s_waitcnt lgkmcnt(11)
    v_mfma_f32_16x16x16_bf16 v[128:131], v[56:57], v[20:21], 0
    s_waitcnt lgkmcnt(10)
    v_mfma_f32_16x16x16_bf16 v[132:135], v[58:59], v[20:21], 0
    s_waitcnt lgkmcnt(9)
    v_mfma_f32_16x16x16_bf16 v[136:139], v[60:61], v[20:21], 0
    s_waitcnt lgkmcnt(8)
    v_mfma_f32_16x16x16_bf16 v[140:143], v[62:63], v[20:21], 0
    v_cvt_pk_bf16_f32 v80, v80, v81
    v_cvt_pk_bf16_f32 v81, v82, v83
    v_cvt_pk_bf16_f32 v82, v84, v85
    v_cvt_pk_bf16_f32 v83, v86, v87
    ds_write_b128 v12, v[80:83] offset:0
    v_cvt_pk_bf16_f32 v88, v88, v89
    v_cvt_pk_bf16_f32 v89, v90, v91
    v_cvt_pk_bf16_f32 v90, v92, v93
    v_cvt_pk_bf16_f32 v91, v94, v95
    ds_write_b128 v13, v[88:91] offset:0
    v_cvt_pk_bf16_f32 v96, v96, v97
    v_cvt_pk_bf16_f32 v97, v98, v99
    v_cvt_pk_bf16_f32 v98, v100, v101
    v_cvt_pk_bf16_f32 v99, v102, v103
    ds_write_b128 v14, v[96:99] offset:0
    v_cvt_pk_bf16_f32 v104, v104, v105
    v_cvt_pk_bf16_f32 v105, v106, v107
    v_cvt_pk_bf16_f32 v106, v108, v109
    v_cvt_pk_bf16_f32 v107, v110, v111
    ds_write_b128 v15, v[104:107] offset:0
    s_waitcnt lgkmcnt(0)
    s_barrier
    ds_read_b128 v[144:147], v16 offset:0
    ds_read_b128 v[148:151], v16 offset:384
    ds_read_b128 v[152:155], v17 offset:768
    ds_read_b128 v[156:159], v17 offset:1152
    v_mfma_f32_16x16x16_bf16 v[80:83], v[64:65], v[20:21], 0
    v_mfma_f32_16x16x16_bf16 v[84:87], v[66:67], v[20:21], 0
    v_mfma_f32_16x16x16_bf16 v[88:91], v[68:69], v[20:21], 0
    v_mfma_f32_16x16x16_bf16 v[92:95], v[70:71], v[20:21], 0
    v_mfma_f32_16x16x16_bf16 v[96:99], v[72:73], v[20:21], 0
    v_mfma_f32_16x16x16_bf16 v[100:103], v[74:75], v[20:21], 0
    v_mfma_f32_16x16x16_bf16 v[104:107], v[76:77], v[20:21], 0
    v_mfma_f32_16x16x16_bf16 v[108:111], v[78:79], v[20:21], 0
    s_add_u32 s25, s26, 0
    s_waitcnt lgkmcnt(3)
    buffer_store_dwordx4 v[144:147], v11, s[16:19], s25 offen sc1
    s_add_u32 s25, s26, 16384
    s_waitcnt lgkmcnt(2)
    buffer_store_dwordx4 v[148:151], v11, s[16:19], s25 offen sc1
    s_add_u32 s25, s26, 98304
    s_waitcnt lgkmcnt(1)
    buffer_store_dwordx4 v[152:155], v11, s[16:19], s25 offen sc1
    s_add_u32 s25, s26, 114688
    s_waitcnt lgkmcnt(0)
    buffer_store_dwordx4 v[156:159], v11, s[16:19], s25 offen sc1
    v_cvt_pk_bf16_f32 v112, v112, v113
    v_cvt_pk_bf16_f32 v113, v114, v115
    v_cvt_pk_bf16_f32 v114, v116, v117
    v_cvt_pk_bf16_f32 v115, v118, v119
    ds_write_b128 v12, v[112:115] offset:64
    v_cvt_pk_bf16_f32 v120, v120, v121
    v_cvt_pk_bf16_f32 v121, v122, v123
    v_cvt_pk_bf16_f32 v122, v124, v125
    v_cvt_pk_bf16_f32 v123, v126, v127
    ds_write_b128 v13, v[120:123] offset:64
    v_cvt_pk_bf16_f32 v128, v128, v129
    v_cvt_pk_bf16_f32 v129, v130, v131
    v_cvt_pk_bf16_f32 v130, v132, v133
    v_cvt_pk_bf16_f32 v131, v134, v135
    ds_write_b128 v14, v[128:131] offset:64
    v_cvt_pk_bf16_f32 v136, v136, v137
    v_cvt_pk_bf16_f32 v137, v138, v139
    v_cvt_pk_bf16_f32 v138, v140, v141
    v_cvt_pk_bf16_f32 v139, v142, v143
    ds_write_b128 v15, v[136:139] offset:64
    s_waitcnt lgkmcnt(0)
    s_barrier
    ds_read_b128 v[144:147], v16 offset:64
    ds_read_b128 v[148:151], v16 offset:448
    ds_read_b128 v[152:155], v17 offset:832
    ds_read_b128 v[156:159], v17 offset:1216
    s_add_u32 s25, s26, 32768
    s_waitcnt lgkmcnt(3)
    buffer_store_dwordx4 v[144:147], v11, s[16:19], s25 offen sc1
    s_add_u32 s25, s26, 49152
    s_waitcnt lgkmcnt(2)
    buffer_store_dwordx4 v[148:151], v11, s[16:19], s25 offen sc1
    s_add_u32 s25, s26, 131072
    s_waitcnt lgkmcnt(1)
    buffer_store_dwordx4 v[152:155], v11, s[16:19], s25 offen sc1
    s_add_u32 s25, s26, 147456
    s_waitcnt lgkmcnt(0)
    buffer_store_dwordx4 v[156:159], v11, s[16:19], s25 offen sc1
    v_cvt_pk_bf16_f32 v80, v80, v81
    v_cvt_pk_bf16_f32 v81, v82, v83
    v_cvt_pk_bf16_f32 v82, v84, v85
    v_cvt_pk_bf16_f32 v83, v86, v87
    ds_write_b128 v12, v[80:83] offset:128
    v_cvt_pk_bf16_f32 v88, v88, v89
    v_cvt_pk_bf16_f32 v89, v90, v91
    v_cvt_pk_bf16_f32 v90, v92, v93
    v_cvt_pk_bf16_f32 v91, v94, v95
    ds_write_b128 v13, v[88:91] offset:128
    v_cvt_pk_bf16_f32 v96, v96, v97
    v_cvt_pk_bf16_f32 v97, v98, v99
    v_cvt_pk_bf16_f32 v98, v100, v101
    v_cvt_pk_bf16_f32 v99, v102, v103
    ds_write_b128 v14, v[96:99] offset:128
    v_cvt_pk_bf16_f32 v104, v104, v105
    v_cvt_pk_bf16_f32 v105, v106, v107
    v_cvt_pk_bf16_f32 v106, v108, v109
    v_cvt_pk_bf16_f32 v107, v110, v111
    ds_write_b128 v15, v[104:107] offset:128
    s_waitcnt lgkmcnt(0)
    s_barrier
    ds_read_b128 v[144:147], v16 offset:128
    ds_read_b128 v[148:151], v16 offset:512
    ds_read_b128 v[152:155], v17 offset:896
    ds_read_b128 v[156:159], v17 offset:1280
    s_add_u32 s25, s26, 65536
    s_waitcnt lgkmcnt(3)
    buffer_store_dwordx4 v[144:147], v11, s[16:19], s25 offen sc1
    s_add_u32 s25, s26, 81920
    s_waitcnt lgkmcnt(2)
    buffer_store_dwordx4 v[148:151], v11, s[16:19], s25 offen sc1
    s_add_u32 s25, s26, 163840
    s_waitcnt lgkmcnt(1)
    buffer_store_dwordx4 v[152:155], v11, s[16:19], s25 offen sc1
    s_add_u32 s25, s26, 180224
    s_waitcnt lgkmcnt(0)
    buffer_store_dwordx4 v[156:159], v11, s[16:19], s25 offen sc1
    s_endpgm
K1_w:
    s_sub_u32 s20, s2, 672
    s_mov_b32 s33, s19
    s_and_b32 s25, s20, 3
    s_lshr_b32 s23, s20, 2
    s_mul_i32 s26, s23, 86
    s_lshr_b32 s26, s26, 8
    s_mul_i32 s27, s26, 3
    s_sub_u32 s27, s23, s27
    v_lshlrev_b32 v1, 4, v0
    v_add_u32 v2, 1024, v1
    s_mul_i32 s28, s26, 129024
    s_mul_i32 s29, s27, 6144
    s_add_u32 s28, s28, s29
    s_mul_i32 s29, s25, 1536
    s_add_u32 s28, s28, s29
    s_lshl_b32 s29, s19, 10
    s_add_u32 s28, s28, s29
    s_mov_b32 s30, s29
    s_waitcnt lgkmcnt(0)
    s_mov_b32 s12, s6
    s_and_b32 s13, s7, 0xffff
    s_mov_b32 s14, 903168
    s_mov_b32 s15, 0x00020000
    s_add_u32 m0, s30, 0
    s_add_u32 s29, s28, 0
    buffer_load_dwordx4 v1, s[12:15], s29 offen lds
    s_add_u32 m0, s30, 2080
    s_add_u32 s29, s28, 18432
    buffer_load_dwordx4 v1, s[12:15], s29 offen lds
    s_add_u32 m0, s30, 4160
    s_add_u32 s29, s28, 36864
    buffer_load_dwordx4 v1, s[12:15], s29 offen lds
    s_add_u32 m0, s30, 6240
    s_add_u32 s29, s28, 55296
    buffer_load_dwordx4 v1, s[12:15], s29 offen lds
    s_add_u32 m0, s30, 8320
    s_add_u32 s29, s28, 73728
    buffer_load_dwordx4 v1, s[12:15], s29 offen lds
    s_add_u32 m0, s30, 10400
    s_add_u32 s29, s28, 92160
    buffer_load_dwordx4 v1, s[12:15], s29 offen lds
    s_add_u32 m0, s30, 12480
    s_add_u32 s29, s28, 110592
    buffer_load_dwordx4 v1, s[12:15], s29 offen lds
    v_lshlrev_b32 v2, 3, v0
    s_add_u32 s10, s10, K1_gt-K1_pc
    s_addc_u32 s11, s11, 0
    global_load_dwordx2 v[20:21], v2, s[10:11]
    v_bfe_u32 v3, v0, 4, 1
    v_bfe_u32 v4, v0, 2, 2
    v_lshl_add_u32 v3, v3, 2, v4
    v_min_u32 v3, 6, v3
    v_mul_u32_u24 v3, 2080, v3
    v_and_b32 v4, 3, v0
    v_lshl_add_u32 v3, v4, 3, v3
    s_mul_i32 s29, s19, 96
    v_add_u32 v3, s29, v3
    v_lshrrev_b32 v4, 4, v0
    v_mul_u32_u24 v1, 86016, v4
    v_and_b32 v4, 15, v0
    v_lshl_add_u32 v1, v4, 4, v1
    s_mul_i32 s28, s19, 1032192
    s_mul_i32 s29, s27, 28672
    s_add_u32 s28, s28, s29
    s_lshl_b32 s29, s26, 10
    s_add_u32 s28, s28, s29
    s_lshl_b32 s29, s25, 8
    s_add_u32 s28, s28, s29
    s_add_u32 s16, s8, 16515072
    s_addc_u32 s17, s9, 0
    s_and_b32 s17, s17, 0xffff
    s_mov_b32 s18, 2064384
    s_mov_b32 s19, 0x00020000
    s_waitcnt vmcnt(0)
    s_barrier
    ds_read_b64_tr_b16 v[32:33], v3 offset:0
    ds_read_b64_tr_b16 v[34:35], v3 offset:192
    ds_read_b64_tr_b16 v[36:37], v3 offset:384
    ds_read_b64_tr_b16 v[38:39], v3 offset:576
    ds_read_b64_tr_b16 v[40:41], v3 offset:768
    ds_read_b64_tr_b16 v[42:43], v3 offset:960
    ds_read_b64_tr_b16 v[44:45], v3 offset:1152
    ds_read_b64_tr_b16 v[46:47], v3 offset:1344
    ds_read_b64_tr_b16 v[48:49], v3 offset:32
    ds_read_b64_tr_b16 v[50:51], v3 offset:224
    ds_read_b64_tr_b16 v[52:53], v3 offset:416
    ds_read_b64_tr_b16 v[54:55], v3 offset:608
    ds_read_b64_tr_b16 v[56:57], v3 offset:800
    ds_read_b64_tr_b16 v[58:59], v3 offset:992
    ds_read_b64_tr_b16 v[60:61], v3 offset:1184
    ds_read_b64_tr_b16 v[62:63], v3 offset:1376
    ds_read_b64_tr_b16 v[64:65], v3 offset:64
    ds_read_b64_tr_b16 v[66:67], v3 offset:256
    ds_read_b64_tr_b16 v[68:69], v3 offset:448
    ds_read_b64_tr_b16 v[70:71], v3 offset:640
    ds_read_b64_tr_b16 v[72:73], v3 offset:832
    ds_read_b64_tr_b16 v[74:75], v3 offset:1024
    ds_read_b64_tr_b16 v[76:77], v3 offset:1216
    ds_read_b64_tr_b16 v[78:79], v3 offset:1408
    s_waitcnt lgkmcnt(15)
    v_mfma_f32_16x16x16_bf16 v[80:83], v[20:21], v[32:33], 0
    v_mfma_f32_16x16x16_bf16 v[84:87], v[20:21], v[34:35], 0
    v_mfma_f32_16x16x16_bf16 v[88:91], v[20:21], v[36:37], 0
    v_mfma_f32_16x16x16_bf16 v[92:95], v[20:21], v[38:39], 0
    v_mfma_f32_16x16x16_bf16 v[96:99], v[20:21], v[40:41], 0
    v_mfma_f32_16x16x16_bf16 v[100:103], v[20:21], v[42:43], 0
    v_mfma_f32_16x16x16_bf16 v[104:107], v[20:21], v[44:45], 0
    v_mfma_f32_16x16x16_bf16 v[108:111], v[20:21], v[46:47], 0
    s_nop 1
    v_cvt_pk_bf16_f32 v144, v80, v84
    s_nop 0
    v_cvt_pk_bf16_f32 v145, v88, v92
    s_nop 0
    v_cvt_pk_bf16_f32 v146, v96, v100
    s_nop 0
    v_cvt_pk_bf16_f32 v147, v104, v108
    s_add_u32 s29, s28, 0
    buffer_store_dwordx4 v[144:147], v1, s[16:19], s29 offen sc1
    v_cvt_pk_bf16_f32 v148, v81, v85
    v_cvt_pk_bf16_f32 v149, v89, v93
    v_cvt_pk_bf16_f32 v150, v97, v101
    v_cvt_pk_bf16_f32 v151, v105, v109
    s_add_u32 s29, s28, 7168
    buffer_store_dwordx4 v[148:151], v1, s[16:19], s29 offen sc1
    v_cvt_pk_bf16_f32 v152, v82, v86
    v_cvt_pk_bf16_f32 v153, v90, v94
    v_cvt_pk_bf16_f32 v154, v98, v102
    v_cvt_pk_bf16_f32 v155, v106, v110
    s_add_u32 s29, s28, 14336
    buffer_store_dwordx4 v[152:155], v1, s[16:19], s29 offen sc1
    v_cvt_pk_bf16_f32 v156, v83, v87
    v_cvt_pk_bf16_f32 v157, v91, v95
    v_cvt_pk_bf16_f32 v158, v99, v103
    v_cvt_pk_bf16_f32 v159, v107, v111
    s_add_u32 s29, s28, 21504
    buffer_store_dwordx4 v[156:159], v1, s[16:19], s29 offen sc1
    v_mfma_f32_16x16x16_bf16 v[112:115], v[20:21], v[48:49], 0
    s_waitcnt lgkmcnt(14)
    v_mfma_f32_16x16x16_bf16 v[116:119], v[20:21], v[50:51], 0
    s_waitcnt lgkmcnt(13)
    v_mfma_f32_16x16x16_bf16 v[120:123], v[20:21], v[52:53], 0
    s_waitcnt lgkmcnt(12)
    v_mfma_f32_16x16x16_bf16 v[124:127], v[20:21], v[54:55], 0
    s_waitcnt lgkmcnt(11)
    v_mfma_f32_16x16x16_bf16 v[128:131], v[20:21], v[56:57], 0
    s_waitcnt lgkmcnt(10)
    v_mfma_f32_16x16x16_bf16 v[132:135], v[20:21], v[58:59], 0
    s_waitcnt lgkmcnt(9)
    v_mfma_f32_16x16x16_bf16 v[136:139], v[20:21], v[60:61], 0
    s_waitcnt lgkmcnt(8)
    v_mfma_f32_16x16x16_bf16 v[140:143], v[20:21], v[62:63], 0
    v_cvt_pk_bf16_f32 v144, v112, v116
    v_cvt_pk_bf16_f32 v145, v120, v124
    s_nop 1
    v_cvt_pk_bf16_f32 v146, v128, v132
    s_nop 2
    v_cvt_pk_bf16_f32 v147, v136, v140
    s_add_u32 s29, s28, 344064
    buffer_store_dwordx4 v[144:147], v1, s[16:19], s29 offen sc1
    v_cvt_pk_bf16_f32 v148, v113, v117
    v_cvt_pk_bf16_f32 v149, v121, v125
    v_cvt_pk_bf16_f32 v150, v129, v133
    v_cvt_pk_bf16_f32 v151, v137, v141
    s_add_u32 s29, s28, 351232
    buffer_store_dwordx4 v[148:151], v1, s[16:19], s29 offen sc1
    v_cvt_pk_bf16_f32 v152, v114, v118
    v_cvt_pk_bf16_f32 v153, v122, v126
    v_cvt_pk_bf16_f32 v154, v130, v134
    v_cvt_pk_bf16_f32 v155, v138, v142
    s_add_u32 s29, s28, 358400
    buffer_store_dwordx4 v[152:155], v1, s[16:19], s29 offen sc1
    v_cvt_pk_bf16_f32 v156, v115, v119
    v_cvt_pk_bf16_f32 v157, v123, v127
    v_cvt_pk_bf16_f32 v158, v131, v135
    v_cvt_pk_bf16_f32 v159, v139, v143
    s_add_u32 s29, s28, 365568
    buffer_store_dwordx4 v[156:159], v1, s[16:19], s29 offen sc1
    s_waitcnt lgkmcnt(7)
    v_mfma_f32_16x16x16_bf16 v[80:83], v[20:21], v[64:65], 0
    s_waitcnt lgkmcnt(6)
    v_mfma_f32_16x16x16_bf16 v[84:87], v[20:21], v[66:67], 0
    s_waitcnt lgkmcnt(5)
    v_mfma_f32_16x16x16_bf16 v[88:91], v[20:21], v[68:69], 0
    s_waitcnt lgkmcnt(4)
    v_mfma_f32_16x16x16_bf16 v[92:95], v[20:21], v[70:71], 0
    s_waitcnt lgkmcnt(3)
    v_mfma_f32_16x16x16_bf16 v[96:99], v[20:21], v[72:73], 0
    s_waitcnt lgkmcnt(2)
    v_mfma_f32_16x16x16_bf16 v[100:103], v[20:21], v[74:75], 0
    s_waitcnt lgkmcnt(1)
    v_mfma_f32_16x16x16_bf16 v[104:107], v[20:21], v[76:77], 0
    s_waitcnt lgkmcnt(0)
    v_mfma_f32_16x16x16_bf16 v[108:111], v[20:21], v[78:79], 0
    v_cvt_pk_bf16_f32 v144, v80, v84
    v_cvt_pk_bf16_f32 v145, v88, v92
    s_nop 1
    v_cvt_pk_bf16_f32 v146, v96, v100
    s_nop 2
    v_cvt_pk_bf16_f32 v147, v104, v108
    s_add_u32 s29, s28, 688128
    buffer_store_dwordx4 v[144:147], v1, s[16:19], s29 offen sc1
    v_cvt_pk_bf16_f32 v148, v81, v85
    v_cvt_pk_bf16_f32 v149, v89, v93
    v_cvt_pk_bf16_f32 v150, v97, v101
    v_cvt_pk_bf16_f32 v151, v105, v109
    s_add_u32 s29, s28, 695296
    buffer_store_dwordx4 v[148:151], v1, s[16:19], s29 offen sc1
    v_cvt_pk_bf16_f32 v152, v82, v86
    v_cvt_pk_bf16_f32 v153, v90, v94
    v_cvt_pk_bf16_f32 v154, v98, v102
    v_cvt_pk_bf16_f32 v155, v106, v110
    s_add_u32 s29, s28, 702464
    buffer_store_dwordx4 v[152:155], v1, s[16:19], s29 offen sc1
    v_cvt_pk_bf16_f32 v156, v83, v87
    v_cvt_pk_bf16_f32 v157, v91, v95
    v_cvt_pk_bf16_f32 v158, v99, v103
    v_cvt_pk_bf16_f32 v159, v107, v111
    s_add_u32 s29, s28, 709632
    buffer_store_dwordx4 v[156:159], v1, s[16:19], s29 offen sc1
    s_cmp_ge_u32 s20, 4
    s_cbranch_scc1 K1_nopf
    s_getpc_b64 s[10:11]
K1_pc2:
    s_lshl_b32 s34, s20, 1
    s_add_u32 s34, s34, s33
    s_lshl_b32 s34, s34, 13
    v_lshlrev_b32 v2, 7, v0
    v_add_u32 v2, s34, v2
    v_min_u32 v2, K2_code_end-K1_pc2-4, v2
    global_load_dword v4, v2, s[10:11]
K1_nopf:
K1_end:
    s_endpgm
.p2align 8
K1_bt:
    .long 0x3e3f0000, 0xbeb53dec, 0xbcab0000, 0xbe19be18, 0x00003ea6, 0x0000bf12, 0xbea60000, 0x3f120000
    .long 0x3d9f0000, 0xbe91be10, 0xbe290000, 0x3ecbbdee, 0xbe5b0000, 0x3e25be5b, 0x3e5b0000, 0xbe25be5b
    .long 0xbd9f0000, 0x3e91be10, 0xbe290000, 0x3ecb3dee, 0x3e840000, 0xbea83e37, 0xbe840000, 0x3ea83e37
    .long 0xbe3f0000, 0x3eb53dec, 0xbcab0000, 0xbe193e18, 0x3ebe0000, 0x3dfa3f09, 0xbebe0000, 0xbdfa3f09
    .long 0xbe92beb5, 0x3eae3d8e, 0x3ebf3e19, 0x3e8f3eee, 0x0000be82, 0x0000bd94, 0x3e820000, 0x3d940000
    .long 0x3ec23ea1, 0xbec73c76, 0xbda83ebf, 0xbd98bec6, 0x3ea83e25, 0x3ec03ea8, 0xbea83e25, 0xbec03ea8
    .long 0xbec23ea1, 0x3ec73c76, 0xbda8bebf, 0xbd983ec6, 0xbeb8be69, 0xbe6bbe7e, 0x3eb8be69, 0x3e6bbe7e
    .long 0x3e92beb5, 0xbeae3d8e, 0x3ebfbe19, 0x3e8fbeee, 0xbd163e34, 0xbe23bd59, 0x3d163e34, 0x3e23bd59
    .long 0x3e9f3ee0, 0xbe5cbd12, 0xbeb4bd49, 0xbea3bef0, 0x00003d94, 0x00003e82, 0xbd940000, 0xbe820000
    .long 0x3ea5be2d, 0xbdf13e94, 0x3e5d3eb7, 0xbef2be84, 0x3ea83ec0, 0x3e253ea8, 0xbea83ec0, 0xbe253ea8
    .long 0xbea5be2d, 0x3df13e94, 0x3e5dbeb7, 0xbef23e84, 0xbd59be23, 0x3e34bd16, 0x3d59be23, 0xbe34bd16
    .long 0xbe9f3ee0, 0x3e5cbd12, 0xbeb43d49, 0xbea33ef0, 0xbe7ebe6b, 0xbe69beb8, 0x3e7ebe6b, 0x3e69beb8
    .long 0x3c81bec1, 0x00003e15, 0x3e40bd8a, 0x00003df4, 0x00003f12, 0x0000bea6, 0xbf120000, 0x3ea60000
    .long 0x3c3cbefa, 0x00003e37, 0x3e3abb6b, 0x00003d0c, 0xbe5b3e25, 0x0000be5b, 0x3e5b3e25, 0x0000be5b
    .long 0xbc3cbefa, 0x00003e37, 0x3e3a3b6b, 0x0000bd0c, 0x3f093dfa, 0x00003ebe, 0xbf093dfa, 0x00003ebe
    .long 0xbc81bec1, 0x00003e15, 0x3e403d8a, 0x0000bdf4, 0x3e37bea8, 0x00003e84, 0xbe37bea8, 0x00003e84

K1_gt:
    .long 0xbeb43d37, 0xbec9bf09, 0xbecfbf08, 0x3eb9bcf4, 0x00000000, 0x00000000, 0x00003f80, 0x00000000
    .long 0x3f02bd09, 0xbebb3e93, 0x3e293f09, 0xbec8bee7, 0x3ec23ec2, 0x3ec23ec2, 0xbec23ec2, 0xbec23ec2
    .long 0xbf02bd09, 0x3ebb3e93, 0x3e29bf09, 0xbec83ee7, 0x3f003f39, 0x3e763eb2, 0xbf003f39, 0xbe763eb2
    .long 0x3eb43d37, 0x3ec9bf09, 0xbecf3f08, 0x3eb93cf4, 0x3ded3da4, 0x3e763e2b, 0xbded3da4, 0xbe763e2b
    .long 0x3ebfbc75, 0x00003f09, 0x3ec43f09, 0x00000000, 0x00000000, 0x00003f80, 0x00000000, 0x00000000
    .long 0x3e08bef0, 0x00003f09, 0x3f053e84, 0x00000000, 0x3ec23ec2, 0x00003ec2, 0xbec23ec2, 0x00003ec2
    .long 0xbe08bef0, 0x00003f09, 0x3f05be84, 0x00000000, 0x3ded3e2b, 0x00003da4, 0xbded3e2b, 0x00003da4
    .long 0xbebfbc75, 0x00003f09, 0x3ec4bf09, 0x00000000, 0x3f003eb2, 0x00003f39, 0xbf003eb2, 0x00003f39
    .long 0x3a683852, 0xba673ac0, 0x3a69bab7, 0x39fab85d, 0x00000000, 0x00000000, 0x00000000, 0x00000000
    .long 0x3a10b8f3, 0xba30ba37, 0x3910badd, 0x3a80b913, 0xba77ba77, 0xba77ba77, 0x3a77ba77, 0x3a77ba77
    .long 0xba10b8f3, 0x3a30ba37, 0x39103add, 0x3a803913, 0x3a8f39d9, 0x39d9b9d3, 0xba8f39d9, 0xb9d9b9d3
    .long 0xba683852, 0x3a673ac0, 0x3a693ab7, 0x39fa385d, 0xb91f3754, 0x39d9b96a, 0x391f3754, 0xb9d9b96a
    .long 0xb9d037f2, 0x0000ba26, 0x39ceba5d, 0x00000000, 0x00000000, 0x00000000, 0x00000000, 0x00000000
    .long 0x38f739b5, 0x0000ba26, 0xbaecb9a0, 0x00000000, 0xba77ba77, 0x0000ba77, 0x3a77ba77, 0x0000ba77
    .long 0xb8f739b5, 0x0000ba26, 0xbaec39a0, 0x00000000, 0xb91fb96a, 0x00003754, 0x391fb96a, 0x00003754
    .long 0x39d037f2, 0x0000ba26, 0x39ce3a5d, 0x00000000, 0x3a8fb9d3, 0x000039d9, 0xba8fb9d3, 0x000039d9

.section .rodata,"a"
.p2align 6
.amdhsa_kernel k1_kernel
  .amdhsa_next_free_vgpr 160
  .amdhsa_next_free_sgpr 96
  .amdhsa_accum_offset 160
  .amdhsa_group_segment_fixed_size 0
  .amdhsa_kernarg_size 40
  .amdhsa_user_sgpr_count 2
  .amdhsa_user_sgpr_kernarg_segment_ptr 1
  .amdhsa_system_sgpr_workgroup_id_x 1
.end_amdhsa_kernel
.text
.globl k2_kernel
.p2align 8
.type k2_kernel,@function
k2_kernel:
    s_load_dwordx2 s[8:9], s[0:1], 32
    s_load_dwordx2 s[4:5], s[0:1], 16
    s_getpc_b64 s[10:11]
K2_pc:
    s_cmp_ge_u32 s2, 256
    s_cbranch_scc1 K2_end
    v_lshrrev_b32 v3, 6, v0
    v_lshlrev_b32 v4, 7, v0
    v_min_u32 v4, K2_code_end-K2_pc-4, v4
    v_and_b32 v0, 63, v0
    s_nop 0
    v_readfirstlane_b32 s24, v3
    s_cmp_ge_u32 s2, 8
    s_cbranch_scc1 K2_nocpf
    global_load_dword v255, v4, s[10:11]
K2_nocpf:
    s_and_b32 s25, s2, 7
    s_lshr_b32 s26, s2, 3
    s_mul_i32 s27, s26, 43
    s_lshr_b32 s27, s27, 8
    s_mul_i32 s28, s27, 6
    s_sub_u32 s28, s26, s28
    s_lshl_b32 s27, s27, 3
    s_add_u32 s27, s27, s25
    s_cmp_lt_u32 s26, 30
    s_cbranch_scc1 K2_map
    s_lshl_b32 s29, s25, 1
    s_add_u32 s29, s29, s26
    s_sub_u32 s29, s29, 30
    s_mul_i32 s27, s29, 43
    s_lshr_b32 s27, s27, 8
    s_mul_i32 s28, s27, 6
    s_sub_u32 s28, s29, s28
    s_add_u32 s27, s27, 40
K2_map:
    s_cmp_ge_u32 s27, 42
    s_cbranch_scc1 K2_end
    v_lshlrev_b32 v1, 4, v0
    v_and_b32 v3, 15, v0
    v_cmp_ne_u32 vcc, 0, v3
    v_min_u32 v3, 5, v3
    v_add_u32 v3, 2, v3
    v_lshlrev_b32 v3, 10, v3
    v_lshrrev_b32 v4, 4, v0
    v_lshl_add_u32 v3, v4, 8, v3
    v_add_u32 v2, 240, v3
    s_lshl_b32 s29, s27, 2
    s_add_u32 s29, s29, s24
    s_mul_i32 s29, s29, 98304
    s_max_u32 s30, s27, 1
    s_sub_u32 s30, s30, 1
    s_lshl_b32 s30, s30, 2
    s_add_u32 s30, s30, s24
    s_mul_i32 s30, s30, 98304
    s_lshl_b32 s31, s28, 2
    s_add_u32 s31, s31, s24
    s_mul_i32 s31, s31, 86016
    s_add_u32 s31, s31, 16515072
    s_mov_b32 s32, 0
    s_mov_b32 s36, 1
    s_mov_b32 s39, 2
    s_mul_i32 s14, s32, 32768
    s_add_u32 s14, s14, s29
    s_mul_i32 s18, s32, 28672
    s_add_u32 s18, s18, s31
    s_waitcnt lgkmcnt(0)
    s_add_u32 s12, s8, s14
    s_addc_u32 s13, s9, 0
    s_and_b32 s13, s13, 0xffff
    s_mov_b32 s14, 32768
    s_mov_b32 s15, 0x00020000
    s_add_u32 s16, s8, s18
    s_addc_u32 s17, s9, 0
    s_and_b32 s17, s17, 0xffff
    s_mov_b32 s18, 28672
    s_mov_b32 s19, 0x00020000
    s_mov_b32 s25, 4096
    s_mov_b32 s26, 8192
    s_mov_b32 s64, 12288
    s_add_u32 s10, s10, K2_at-K2_pc
    s_addc_u32 s11, s11, 0
    s_lshl_b32 s33, s24, 10
    v_add_u32 v3, s33, v1
    buffer_load_dwordx4 v[72:75], v1, s[12:15], s25 offen offset:3072
    buffer_load_dwordx4 a[96:99], v1, s[16:19], 0 offen offset:0
    buffer_load_dwordx4 a[100:103], v1, s[16:19], s25 offen offset:3072
    buffer_load_dwordx4 v[76:79], v1, s[12:15], s64 offen offset:3072
    buffer_load_dwordx4 v[80:83], v1, s[12:15], s64 offen offset:2048
    buffer_load_dwordx4 a[104:107], v1, s[16:19], s26 offen offset:0
    buffer_load_dwordx4 a[108:111], v1, s[16:19], 0 offen offset:1024
    buffer_load_dwordx4 v[84:87], v1, s[12:15], s25 offen offset:2048
    buffer_load_dwordx4 v[88:91], v1, s[12:15], s64 offen offset:1024
    buffer_load_dwordx4 a[112:115], v1, s[16:19], s26 offen offset:1024
    buffer_load_dwordx4 a[116:119], v1, s[16:19], 0 offen offset:2048
    buffer_load_dwordx4 v[92:95], v1, s[12:15], s25 offen offset:1024
    s_mov_b32 s65, 16384
    s_mov_b32 s66, 20480
    s_mov_b32 s67, 24576
    s_mov_b32 s68, 28672
    s_mul_i32 s22, s32, 32768
    s_add_u32 s22, s22, s30
    s_add_u32 s20, s8, s22
    s_addc_u32 s21, s9, 0
    s_and_b32 s21, s21, 0xffff
    s_mov_b32 s22, 425984
    s_mov_b32 s23, 0x00020000
    s_mul_i32 s42, s36, 32768
    s_add_u32 s42, s42, s29
    s_add_u32 s40, s8, s42
    s_addc_u32 s41, s9, 0
    s_and_b32 s41, s41, 0xffff
    s_mov_b32 s42, 32768
    s_mov_b32 s43, 0x00020000
    s_mul_i32 s50, s36, 28672
    s_add_u32 s50, s50, s31
    s_add_u32 s48, s8, s50
    s_addc_u32 s49, s9, 0
    s_and_b32 s49, s49, 0xffff
    s_mov_b32 s50, 28672
    s_mov_b32 s51, 0x00020000
    s_mul_i32 s58, s36, 32768
    s_add_u32 s58, s58, s30
    s_add_u32 s56, s8, s58
    s_addc_u32 s57, s9, 0
    s_and_b32 s57, s57, 0xffff
    s_mov_b32 s58, 425984
    s_mov_b32 s59, 0x00020000
    s_mul_i32 s46, s39, 32768
    s_add_u32 s46, s46, s29
    s_add_u32 s44, s8, s46
    s_addc_u32 s45, s9, 0
    s_and_b32 s45, s45, 0xffff
    s_mov_b32 s46, 32768
    s_mov_b32 s47, 0x00020000
    s_mul_i32 s54, s39, 28672
    s_add_u32 s54, s54, s31
    s_add_u32 s52, s8, s54
    s_addc_u32 s53, s9, 0
    s_and_b32 s53, s53, 0xffff
    s_mov_b32 s54, 28672
    s_mov_b32 s55, 0x00020000
    s_mul_i32 s62, s39, 32768
    s_add_u32 s62, s62, s30
    s_add_u32 s60, s8, s62
    s_addc_u32 s61, s9, 0
    s_and_b32 s61, s61, 0xffff
    s_mov_b32 s62, 425984
    s_mov_b32 s63, 0x00020000
    v_and_b32 v237, 15, v0
    v_lshrrev_b32 v238, 4, v0
    v_lshlrev_b32 v239, 10, v238
    v_lshl_add_u32 v239, v237, 4, v239
    s_lshr_b32 s33, s24, 1
    s_mul_i32 s33, s33, 32768
    s_and_b32 s34, s24, 1
    s_lshl_b32 s34, s34, 3
    s_add_u32 s33, s33, s34
    v_add_u32 v244, s33, v239
    v_xor_b32 v240, s24, v238
    v_lshl_add_u32 v240, v240, 2, v239
    v_add_u32 v245, 65536, v240
    v_min_u32 v239, 2, v238
    v_lshlrev_b32 v239, 15, v239
    v_lshl_add_u32 v239, v237, 4, v239
    s_lshl_b32 s33, s24, 10
    v_add_u32 v246, s33, v239
    s_lshl_b32 s33, s24, 14
    s_add_u32 s33, s33, 98304
    v_and_b32 v237, 15, v0
    v_lshrrev_b32 v239, 1, v238
    v_lshl_add_u32 v239, v237, 1, v239
    v_bfe_u32 v240, v237, 2, 1
    v_xor_b32 v239, v239, v240
    v_and_b32 v240, 1, v238
    v_lshlrev_b32 v240, 9, v240
    v_lshl_add_u32 v239, v239, 4, v240
    v_add_u32 v247, s33, v239
    v_bfe_u32 v240, v0, 3, 1
    v_xor_b32 v240, v0, v240
    v_lshl_add_u32 v248, v240, 4, s33
    v_bfe_u32 v236, v0, 4, 1
    v_and_b32 v237, 15, v0
    v_lshrrev_b32 v238, 5, v0
    s_mov_b32 s38, 224
    s_mov_b32 s35, 2260
    s_mov_b32 s37, 192
    s_lshl_b32 s33, s27, 4
    s_lshl_b32 s34, s24, 2
    s_add_u32 s33, s33, s34
    s_add_u32 s33, s33, 0
    v_add_u32 v239, s33, v236
    v_mul_u32_u24 v240, s35, v239
    v_lshrrev_b32 v240, 16, v240
    v_mul_u32_u24 v241, 29, v240
    v_sub_u32 v241, v239, v241
    v_mul_u32_u24 v242, 10, v240
    v_add_u32 v242, v242, v237
    v_subrev_u32 v243, 1, v241
    v_mul_u32_u24 v243, 1792, v243
    v_add_u32 v243, v243, v242
    v_mul_lo_u32 v243, v243, s37
    v_lshl_add_u32 v243, v238, 4, v243
    s_lshl_b32 s34, s28, 5
    v_add_u32 v243, s34, v243
    v_cmp_ne_u32 s[70:71], 0, v241
    v_cmp_gt_u32 s[72:73], 10, v237
    v_cmp_gt_u32 s[74:75], s38, v242
    v_mov_b32 v239, 0x7fffffff
    s_nop 2
    s_and_b64 s[70:71], s[70:71], s[72:73]
    s_and_b64 s[70:71], s[70:71], s[74:75]
    s_nop 0
    v_cndmask_b32 v249, v239, v243, s[70:71]
    s_lshl_b32 s33, s27, 4
    s_lshl_b32 s34, s24, 2
    s_add_u32 s33, s33, s34
    s_add_u32 s33, s33, 2
    v_add_u32 v239, s33, v236
    v_mul_u32_u24 v240, s35, v239
    v_lshrrev_b32 v240, 16, v240
    v_mul_u32_u24 v241, 29, v240
    v_sub_u32 v241, v239, v241
    v_mul_u32_u24 v242, 10, v240
    v_add_u32 v242, v242, v237
    v_subrev_u32 v243, 1, v241
    v_mul_u32_u24 v243, 1792, v243
    v_add_u32 v243, v243, v242
    v_mul_lo_u32 v243, v243, s37
    v_lshl_add_u32 v243, v238, 4, v243
    s_lshl_b32 s34, s28, 5
    v_add_u32 v243, s34, v243
    v_cmp_ne_u32 s[70:71], 0, v241
    v_cmp_gt_u32 s[72:73], 10, v237
    v_cmp_gt_u32 s[74:75], s38, v242
    v_mov_b32 v239, 0x7fffffff
    s_nop 2
    s_and_b64 s[70:71], s[70:71], s[72:73]
    s_and_b64 s[70:71], s[70:71], s[74:75]
    s_nop 0
    v_cndmask_b32 v250, v239, v243, s[70:71]
    s_cmp_eq_u32 s27, 0
    s_cselect_b32 s33, 0, 393216
    s_sub_u32 s33, s33, 16
    v_add_u32 v239, s33, v1
    v_lshrrev_b32 v240, 4, v0
    v_lshlrev_b32 v240, 8, v240
    v_add_u32 v240, 240, v240
    v_cndmask_b32 v251, v240, v239, vcc
    s_mov_b32 s6, 9633792
    s_mov_b32 s7, 0x00020000
    s_and_b32 s5, s5, 0xffff
    s_mov_b32 s94, 0x03ff03ff
    s_mov_b32 s95, 0x03ff03ff
    buffer_load_dwordx4 v[96:99], v1, s[12:15], s25 offen offset:0
    buffer_load_dwordx4 a[120:123], v1, s[16:19], 0 offen offset:3072
    buffer_load_dwordx4 a[124:127], v1, s[16:19], s26 offen offset:2048
    buffer_load_dwordx4 v[100:103], v1, s[12:15], s64 offen offset:0
    global_load_dwordx4 v[4:7], v3, s[10:11]
    s_waitcnt vmcnt(15)
    v_mfma_f32_16x16x32_bf16 a[28:31], v[72:75], a[96:99], 0
    buffer_load_dwordx4 v[104:107], v1, s[12:15], 0 offen offset:3072
    s_waitcnt vmcnt(15)
    v_mfma_f32_16x16x32_bf16 a[60:63], v[72:75], a[100:103], 0
    s_waitcnt vmcnt(14)
    v_mfma_f32_16x16x32_bf16 a[60:63], v[76:79], a[96:99], a[60:63]
    buffer_load_dwordx4 v[108:111], v1, s[12:15], s26 offen offset:3072
    v_mfma_f32_16x16x32_bf16 a[92:95], v[76:79], a[100:103], 0
    s_waitcnt vmcnt(13)
    v_mfma_f32_16x16x32_bf16 a[92:95], v[80:83], a[104:107], a[92:95]
    s_waitcnt vmcnt(12)
    v_mfma_f32_16x16x32_bf16 a[60:63], v[80:83], a[108:111], a[60:63]
    s_waitcnt vmcnt(11)
    v_mfma_f32_16x16x32_bf16 a[60:63], v[84:87], a[104:107], a[60:63]
    v_mfma_f32_16x16x32_bf16 a[28:31], v[84:87], a[108:111], a[28:31]
    buffer_load_dwordx4 v[112:115], v2, s[20:23], 0 offen offset:0
    v_mfma_f32_16x16x32_bf16 a[24:27], v[84:87], a[96:99], 0
    v_mfma_f32_16x16x32_bf16 a[56:59], v[84:87], a[100:103], 0
    v_mfma_f32_16x16x32_bf16 a[56:59], v[80:83], a[96:99], a[56:59]
    buffer_load_dwordx4 v[116:119], v2, s[20:23], s26 offen offset:0
    v_mfma_f32_16x16x32_bf16 a[88:91], v[80:83], a[100:103], 0
    s_waitcnt vmcnt(11)
    v_mfma_f32_16x16x32_bf16 a[92:95], v[88:91], a[112:115], a[92:95]
    s_waitcnt vmcnt(10)
    v_mfma_f32_16x16x32_bf16 a[60:63], v[88:91], a[116:119], a[60:63]
    s_waitcnt vmcnt(9)
    v_mfma_f32_16x16x32_bf16 a[60:63], v[92:95], a[112:115], a[60:63]
    v_mfma_f32_16x16x32_bf16 a[28:31], v[92:95], a[116:119], a[28:31]
    buffer_load_dwordx4 v[120:123], v1, s[12:15], 0 offen offset:2048
    v_mfma_f32_16x16x32_bf16 a[24:27], v[92:95], a[108:111], a[24:27]
    v_mfma_f32_16x16x32_bf16 a[56:59], v[92:95], a[104:107], a[56:59]
    v_mfma_f32_16x16x32_bf16 a[56:59], v[88:91], a[108:111], a[56:59]
    buffer_load_dwordx4 v[124:127], v1, s[12:15], s26 offen offset:2048
    v_mfma_f32_16x16x32_bf16 a[88:91], v[88:91], a[104:107], a[88:91]
    v_mfma_f32_16x16x32_bf16 a[84:87], v[88:91], a[100:103], 0
    v_mfma_f32_16x16x32_bf16 a[52:55], v[88:91], a[96:99], 0
    v_mfma_f32_16x16x32_bf16 a[52:55], v[92:95], a[100:103], a[52:55]
    v_mfma_f32_16x16x32_bf16 a[20:23], v[92:95], a[96:99], 0
    buffer_load_dwordx4 v[128:131], v1, s[12:15], 0 offen offset:1024
    s_waitcnt vmcnt(10)
    v_mfma_f32_16x16x32_bf16 a[28:31], v[96:99], a[120:123], a[28:31]
    s_waitcnt vmcnt(9)
    v_mfma_f32_16x16x32_bf16 a[60:63], v[96:99], a[124:127], a[60:63]
    s_waitcnt vmcnt(8)
    v_mfma_f32_16x16x32_bf16 a[60:63], v[100:103], a[120:123], a[60:63]
    v_mfma_f32_16x16x32_bf16 a[92:95], v[100:103], a[124:127], a[92:95]
    v_mfma_f32_16x16x32_bf16 a[88:91], v[100:103], a[112:115], a[88:91]
    buffer_load_dwordx4 v[132:135], v1, s[12:15], s26 offen offset:1024
    v_mfma_f32_16x16x32_bf16 a[56:59], v[100:103], a[116:119], a[56:59]
    v_mfma_f32_16x16x32_bf16 a[56:59], v[96:99], a[112:115], a[56:59]
    v_mfma_f32_16x16x32_bf16 a[24:27], v[96:99], a[116:119], a[24:27]
    v_mfma_f32_16x16x32_bf16 a[20:23], v[96:99], a[108:111], a[20:23]
    v_mfma_f32_16x16x32_bf16 a[52:55], v[96:99], a[104:107], a[52:55]
    buffer_load_dwordx4 v[136:139], v1, s[12:15], 0 offen offset:0
    v_mfma_f32_16x16x32_bf16 a[52:55], v[100:103], a[108:111], a[52:55]
    v_mfma_f32_16x16x32_bf16 a[84:87], v[100:103], a[104:107], a[84:87]
    v_mfma_f32_16x16x32_bf16 a[80:83], v[100:103], a[100:103], 0
    v_mfma_f32_16x16x32_bf16 a[48:51], v[100:103], a[96:99], 0
    v_mfma_f32_16x16x32_bf16 a[48:51], v[96:99], a[100:103], a[48:51]
    buffer_load_dwordx4 v[140:143], v1, s[12:15], s26 offen offset:0
    v_mfma_f32_16x16x32_bf16 a[16:19], v[96:99], a[96:99], 0
    s_waitcnt vmcnt(9)
    v_mfma_f32_16x16x32_bf16 a[24:27], v[104:107], a[120:123], a[24:27]
    v_mfma_f32_16x16x32_bf16 a[56:59], v[104:107], a[124:127], a[56:59]
    s_waitcnt vmcnt(8)
    v_mfma_f32_16x16x32_bf16 a[56:59], v[108:111], a[120:123], a[56:59]
    v_mfma_f32_16x16x32_bf16 a[88:91], v[108:111], a[124:127], a[88:91]
    buffer_load_dwordx4 a[128:131], v1, s[16:19], s25 offen offset:0
    v_mfma_f32_16x16x32_bf16 a[84:87], v[108:111], a[112:115], a[84:87]
    v_mfma_f32_16x16x32_bf16 a[52:55], v[108:111], a[116:119], a[52:55]
    v_mfma_f32_16x16x32_bf16 a[52:55], v[104:107], a[112:115], a[52:55]
    v_mfma_f32_16x16x32_bf16 a[20:23], v[104:107], a[116:119], a[20:23]
    v_mfma_f32_16x16x32_bf16 a[16:19], v[104:107], a[108:111], a[16:19]
    buffer_load_dwordx4 a[132:135], v1, s[16:19], s25 offen offset:1024
    v_mfma_f32_16x16x32_bf16 a[48:51], v[104:107], a[104:107], a[48:51]
    v_mfma_f32_16x16x32_bf16 a[48:51], v[108:111], a[108:111], a[48:51]
    v_mfma_f32_16x16x32_bf16 a[80:83], v[108:111], a[104:107], a[80:83]
    v_mfma_f32_16x16x32_bf16 a[76:79], v[108:111], a[100:103], 0
    v_mfma_f32_16x16x32_bf16 a[44:47], v[108:111], a[96:99], 0
    buffer_load_dwordx4 a[136:139], v1, s[16:19], s25 offen offset:2048
    v_mfma_f32_16x16x32_bf16 a[44:47], v[104:107], a[100:103], a[44:47]
    v_mfma_f32_16x16x32_bf16 a[12:15], v[104:107], a[96:99], 0
    s_waitcnt vmcnt(8)
    v_mfma_f32_16x16x32_bf16 a[20:23], v[120:123], a[120:123], a[20:23]
    v_mfma_f32_16x16x32_bf16 a[52:55], v[120:123], a[124:127], a[52:55]
    s_waitcnt vmcnt(7)
    v_mfma_f32_16x16x32_bf16 a[52:55], v[124:127], a[120:123], a[52:55]
    buffer_load_dwordx4 a[140:143], v1, s[16:19], s64 offen offset:1024
    v_mfma_f32_16x16x32_bf16 a[84:87], v[124:127], a[124:127], a[84:87]
    v_mfma_f32_16x16x32_bf16 a[80:83], v[124:127], a[112:115], a[80:83]
    v_mfma_f32_16x16x32_bf16 a[48:51], v[124:127], a[116:119], a[48:51]
    v_mfma_f32_16x16x32_bf16 a[48:51], v[120:123], a[112:115], a[48:51]
    v_mfma_f32_16x16x32_bf16 a[16:19], v[120:123], a[116:119], a[16:19]
    buffer_load_dwordx4 a[144:147], v1, s[16:19], s64 offen offset:0
    v_mfma_f32_16x16x32_bf16 a[12:15], v[120:123], a[108:111], a[12:15]
    v_mfma_f32_16x16x32_bf16 a[44:47], v[120:123], a[104:107], a[44:47]
    v_mfma_f32_16x16x32_bf16 a[44:47], v[124:127], a[108:111], a[44:47]
    v_mfma_f32_16x16x32_bf16 a[76:79], v[124:127], a[104:107], a[76:79]
    v_mov_b32_dpp v72, v72 row_shr:1 row_mask:0xf bank_mask:0xf
    v_mov_b32_dpp v73, v73 row_shr:1 row_mask:0xf bank_mask:0xf
    v_mfma_f32_16x16x32_bf16 a[72:75], v[124:127], a[100:103], 0
    buffer_load_dwordx4 a[148:151], v1, s[16:19], s26 offen offset:3072
    v_mov_b32_dpp v74, v74 row_shr:1 row_mask:0xf bank_mask:0xf
    v_mfma_f32_16x16x32_bf16 a[40:43], v[124:127], a[96:99], 0
    v_mov_b32_dpp v75, v75 row_shr:1 row_mask:0xf bank_mask:0xf
    v_cndmask_b32_dpp v72, v112, v72, vcc row_shl:5 row_mask:0xf bank_mask:0xf
    v_mfma_f32_16x16x32_bf16 a[40:43], v[120:123], a[100:103], a[40:43]
    v_cndmask_b32_dpp v73, v113, v73, vcc row_shl:5 row_mask:0xf bank_mask:0xf
    v_cndmask_b32_dpp v74, v114, v74, vcc row_shl:5 row_mask:0xf bank_mask:0xf
    v_mfma_f32_16x16x32_bf16 a[8:11], v[120:123], a[96:99], 0
    v_cndmask_b32_dpp v75, v115, v75, vcc row_shl:5 row_mask:0xf bank_mask:0xf
    s_waitcnt vmcnt(9)
    v_mfma_f32_16x16x32_bf16 a[16:19], v[128:131], a[120:123], a[16:19]
    v_mov_b32_dpp v76, v76 row_shr:1 row_mask:0xf bank_mask:0xf
    v_mov_b32_dpp v77, v77 row_shr:1 row_mask:0xf bank_mask:0xf
    v_mfma_f32_16x16x32_bf16 a[48:51], v[128:131], a[124:127], a[48:51]
    buffer_load_dwordx4 v[144:147], v2, s[20:23], s65 offen offset:0
    s_waitcnt vmcnt(9)
    v_mfma_f32_16x16x32_bf16 a[48:51], v[132:135], a[120:123], a[48:51]
    v_mov_b32_dpp v78, v78 row_shr:1 row_mask:0xf bank_mask:0xf
    v_mov_b32_dpp v79, v79 row_shr:1 row_mask:0xf bank_mask:0xf
    v_mfma_f32_16x16x32_bf16 a[80:83], v[132:135], a[124:127], a[80:83]
    v_cndmask_b32_dpp v76, v116, v76, vcc row_shl:5 row_mask:0xf bank_mask:0xf
    v_cndmask_b32_dpp v77, v117, v77, vcc row_shl:5 row_mask:0xf bank_mask:0xf
    v_mfma_f32_16x16x32_bf16 a[76:79], v[132:135], a[112:115], a[76:79]
    v_cndmask_b32_dpp v78, v118, v78, vcc row_shl:5 row_mask:0xf bank_mask:0xf
    v_cndmask_b32_dpp v79, v119, v79, vcc row_shl:5 row_mask:0xf bank_mask:0xf
    v_mfma_f32_16x16x32_bf16 a[44:47], v[132:135], a[116:119], a[44:47]
    v_mov_b32_dpp v80, v80 row_shr:1 row_mask:0xf bank_mask:0xf
    v_mfma_f32_16x16x32_bf16 a[44:47], v[128:131], a[112:115], a[44:47]
    buffer_load_dwordx4 v[148:151], v1, s[12:15], s66 offen offset:3072
    v_mfma_f32_16x16x32_bf16 a[12:15], v[128:131], a[116:119], a[12:15]
    v_mov_b32_dpp v81, v81 row_shr:1 row_mask:0xf bank_mask:0xf
    v_mfma_f32_16x16x32_bf16 a[8:11], v[128:131], a[108:111], a[8:11]
    v_mov_b32_dpp v82, v82 row_shr:1 row_mask:0xf bank_mask:0xf
    v_mfma_f32_16x16x32_bf16 a[40:43], v[128:131], a[104:107], a[40:43]
    v_mov_b32_dpp v83, v83 row_shr:1 row_mask:0xf bank_mask:0xf
    v_mfma_f32_16x16x32_bf16 a[40:43], v[132:135], a[108:111], a[40:43]
    v_cndmask_b32_dpp v80, v116, v80, vcc row_shl:4 row_mask:0xf bank_mask:0xf
    v_mfma_f32_16x16x32_bf16 a[72:75], v[132:135], a[104:107], a[72:75]
    buffer_load_dwordx4 a[152:155], v1, s[16:19], s64 offen offset:2048
    v_mfma_f32_16x16x32_bf16 a[68:71], v[132:135], a[100:103], 0
    v_cndmask_b32_dpp v81, v117, v81, vcc row_shl:4 row_mask:0xf bank_mask:0xf
    v_mfma_f32_16x16x32_bf16 a[36:39], v[132:135], a[96:99], 0
    v_cndmask_b32_dpp v82, v118, v82, vcc row_shl:4 row_mask:0xf bank_mask:0xf
    v_mfma_f32_16x16x32_bf16 a[36:39], v[128:131], a[100:103], a[36:39]
    v_cndmask_b32_dpp v83, v119, v83, vcc row_shl:4 row_mask:0xf bank_mask:0xf
    v_mfma_f32_16x16x32_bf16 a[4:7], v[128:131], a[96:99], 0
    s_waitcnt vmcnt(10)
    v_mfma_f32_16x16x32_bf16 a[12:15], v[136:139], a[120:123], a[12:15]
    buffer_load_dwordx4 v[152:155], v1, s[12:15], s66 offen offset:2048
    v_mfma_f32_16x16x32_bf16 a[44:47], v[136:139], a[124:127], a[44:47]
    s_waitcnt vmcnt(10)
    v_mfma_f32_16x16x32_bf16 a[44:47], v[140:143], a[120:123], a[44:47]
    v_mov_b32_dpp v84, v84 row_shr:1 row_mask:0xf bank_mask:0xf
    v_mfma_f32_16x16x32_bf16 a[76:79], v[140:143], a[124:127], a[76:79]
    v_mov_b32_dpp v85, v85 row_shr:1 row_mask:0xf bank_mask:0xf
    v_mfma_f32_16x16x32_bf16 a[72:75], v[140:143], a[112:115], a[72:75]
    v_mov_b32_dpp v86, v86 row_shr:1 row_mask:0xf bank_mask:0xf
    v_mfma_f32_16x16x32_bf16 a[40:43], v[140:143], a[116:119], a[40:43]
    buffer_load_dwordx4 a[156:159], v1, s[16:19], s64 offen offset:3072
    v_mfma_f32_16x16x32_bf16 a[40:43], v[136:139], a[112:115], a[40:43]
    v_mov_b32_dpp v87, v87 row_shr:1 row_mask:0xf bank_mask:0xf
    v_mfma_f32_16x16x32_bf16 a[8:11], v[136:139], a[116:119], a[8:11]
    v_cndmask_b32_dpp v84, v112, v84, vcc row_shl:4 row_mask:0xf bank_mask:0xf
    v_mfma_f32_16x16x32_bf16 a[4:7], v[136:139], a[108:111], a[4:7]
    v_cndmask_b32_dpp v85, v113, v85, vcc row_shl:4 row_mask:0xf bank_mask:0xf
    v_mfma_f32_16x16x32_bf16 a[36:39], v[136:139], a[104:107], a[36:39]
    v_cndmask_b32_dpp v86, v114, v86, vcc row_shl:4 row_mask:0xf bank_mask:0xf
    v_mfma_f32_16x16x32_bf16 a[36:39], v[140:143], a[108:111], a[36:39]
    buffer_load_dwordx4 v[156:159], v1, s[12:15], s66 offen offset:1024
    v_mfma_f32_16x16x32_bf16 a[68:71], v[140:143], a[104:107], a[68:71]
    v_cndmask_b32_dpp v87, v115, v87, vcc row_shl:4 row_mask:0xf bank_mask:0xf
    v_mfma_f32_16x16x32_bf16 a[64:67], v[140:143], a[100:103], 0
    v_mov_b32_dpp v88, v88 row_shr:1 row_mask:0xf bank_mask:0xf
    v_mfma_f32_16x16x32_bf16 a[32:35], v[140:143], a[96:99], 0
    v_mov_b32_dpp v89, v89 row_shr:1 row_mask:0xf bank_mask:0xf
    v_mfma_f32_16x16x32_bf16 a[32:35], v[136:139], a[100:103], a[32:35]
    v_mov_b32_dpp v90, v90 row_shr:1 row_mask:0xf bank_mask:0xf
    v_mfma_f32_16x16x32_bf16 a[0:3], v[136:139], a[96:99], 0
    buffer_load_dwordx4 a[160:163], v1, s[16:19], s65 offen offset:0
    v_mfma_f32_16x16x32_bf16 a[8:11], v[72:75], a[120:123], a[8:11]
    v_mov_b32_dpp v91, v91 row_shr:1 row_mask:0xf bank_mask:0xf
    v_mfma_f32_16x16x32_bf16 a[40:43], v[72:75], a[124:127], a[40:43]
    v_cndmask_b32_dpp v88, v116, v88, vcc row_shl:3 row_mask:0xf bank_mask:0xf
    v_mfma_f32_16x16x32_bf16 a[40:43], v[76:79], a[120:123], a[40:43]
    v_cndmask_b32_dpp v89, v117, v89, vcc row_shl:3 row_mask:0xf bank_mask:0xf
    v_mfma_f32_16x16x32_bf16 a[72:75], v[76:79], a[124:127], a[72:75]
    v_cndmask_b32_dpp v90, v118, v90, vcc row_shl:3 row_mask:0xf bank_mask:0xf
    v_mfma_f32_16x16x32_bf16 a[68:71], v[76:79], a[112:115], a[68:71]
    buffer_load_dwordx4 v[160:163], v1, s[12:15], s66 offen offset:0
    v_mfma_f32_16x16x32_bf16 a[36:39], v[76:79], a[116:119], a[36:39]
    v_cndmask_b32_dpp v91, v119, v91, vcc row_shl:3 row_mask:0xf bank_mask:0xf
    v_mfma_f32_16x16x32_bf16 a[36:39], v[72:75], a[112:115], a[36:39]
    v_mov_b32_dpp v92, v92 row_shr:1 row_mask:0xf bank_mask:0xf
    v_mfma_f32_16x16x32_bf16 a[4:7], v[72:75], a[116:119], a[4:7]
    v_mov_b32_dpp v93, v93 row_shr:1 row_mask:0xf bank_mask:0xf
    v_mfma_f32_16x16x32_bf16 a[0:3], v[72:75], a[108:111], a[0:3]
    v_mov_b32_dpp v94, v94 row_shr:1 row_mask:0xf bank_mask:0xf
    v_mfma_f32_16x16x32_bf16 a[32:35], v[72:75], a[104:107], a[32:35]
    buffer_load_dwordx4 a[164:167], v1, s[16:19], s65 offen offset:1024
    v_mfma_f32_16x16x32_bf16 a[32:35], v[76:79], a[108:111], a[32:35]
    v_mov_b32_dpp v95, v95 row_shr:1 row_mask:0xf bank_mask:0xf
    v_mfma_f32_16x16x32_bf16 a[64:67], v[76:79], a[104:107], a[64:67]
    v_cndmask_b32_dpp v92, v112, v92, vcc row_shl:3 row_mask:0xf bank_mask:0xf
    v_mfma_f32_16x16x32_bf16 a[68:71], v[80:83], a[124:127], a[68:71]
    v_cndmask_b32_dpp v93, v113, v93, vcc row_shl:3 row_mask:0xf bank_mask:0xf
    v_mfma_f32_16x16x32_bf16 a[36:39], v[80:83], a[120:123], a[36:39]
    v_cndmask_b32_dpp v94, v114, v94, vcc row_shl:3 row_mask:0xf bank_mask:0xf
    v_mfma_f32_16x16x32_bf16 a[36:39], v[84:87], a[124:127], a[36:39]
    buffer_load_dwordx4 v[164:167], v1, s[12:15], s65 offen offset:3072
    v_mfma_f32_16x16x32_bf16 a[4:7], v[84:87], a[120:123], a[4:7]
    v_cndmask_b32_dpp v95, v115, v95, vcc row_shl:3 row_mask:0xf bank_mask:0xf
    v_mfma_f32_16x16x32_bf16 a[0:3], v[84:87], a[116:119], a[0:3]
    v_mov_b32_dpp v96, v96 row_shr:1 row_mask:0xf bank_mask:0xf
    v_mfma_f32_16x16x32_bf16 a[32:35], v[84:87], a[112:115], a[32:35]
    v_mov_b32_dpp v97, v97 row_shr:1 row_mask:0xf bank_mask:0xf
    v_mfma_f32_16x16x32_bf16 a[32:35], v[80:83], a[116:119], a[32:35]
    v_mov_b32_dpp v98, v98 row_shr:1 row_mask:0xf bank_mask:0xf
    v_mfma_f32_16x16x32_bf16 a[64:67], v[80:83], a[112:115], a[64:67]
    buffer_load_dwordx4 a[168:171], v1, s[16:19], s65 offen offset:2048
    v_mfma_f32_16x16x32_bf16 a[64:67], v[88:91], a[124:127], a[64:67]
    v_mov_b32_dpp v99, v99 row_shr:1 row_mask:0xf bank_mask:0xf
    v_mfma_f32_16x16x32_bf16 a[32:35], v[88:91], a[120:123], a[32:35]
    v_cndmask_b32_dpp v96, v112, v96, vcc row_shl:2 row_mask:0xf bank_mask:0xf
    v_mfma_f32_16x16x32_bf16 a[32:35], v[92:95], a[124:127], a[32:35]
    v_cndmask_b32_dpp v97, v113, v97, vcc row_shl:2 row_mask:0xf bank_mask:0xf
    v_mfma_f32_16x16x32_bf16 a[0:3], v[92:95], a[120:123], a[0:3]
    s_waitcnt vmcnt(16)
    v_mfma_f32_16x16x32_bf16 a[28:31], v[104:107], a[128:131], a[28:31]
    buffer_load_dwordx4 v[168:171], v1, s[12:15], s65 offen offset:2048
    s_waitcnt vmcnt(16)
    v_mfma_f32_16x16x32_bf16 a[28:31], v[120:123], a[132:135], a[28:31]
    s_waitcnt vmcnt(15)
    v_mfma_f32_16x16x32_bf16 a[28:31], v[128:131], a[136:139], a[28:31]
    s_waitcnt vmcnt(14)
    v_mfma_f32_16x16x32_bf16 a[60:63], v[128:131], a[140:143], a[60:63]
    s_waitcnt vmcnt(13)
    v_mfma_f32_16x16x32_bf16 a[60:63], v[120:123], a[144:147], a[60:63]
    s_waitcnt vmcnt(12)
    v_mfma_f32_16x16x32_bf16 a[60:63], v[104:107], a[148:151], a[60:63]
    buffer_load_dwordx4 a[172:175], v1, s[16:19], s65 offen offset:3072
    v_mfma_f32_16x16x32_bf16 a[60:63], v[108:111], a[128:131], a[60:63]
    v_cndmask_b32_dpp v98, v114, v98, vcc row_shl:2 row_mask:0xf bank_mask:0xf
    v_mfma_f32_16x16x32_bf16 a[60:63], v[124:127], a[132:135], a[60:63]
    v_cndmask_b32_dpp v99, v115, v99, vcc row_shl:2 row_mask:0xf bank_mask:0xf
    v_mfma_f32_16x16x32_bf16 a[60:63], v[132:135], a[136:139], a[60:63]
    v_mov_b32_dpp v100, v100 row_shr:1 row_mask:0xf bank_mask:0xf
    v_mfma_f32_16x16x32_bf16 a[92:95], v[132:135], a[140:143], a[92:95]
    v_mov_b32_dpp v101, v101 row_shr:1 row_mask:0xf bank_mask:0xf
    v_mfma_f32_16x16x32_bf16 a[92:95], v[124:127], a[144:147], a[92:95]
    buffer_load_dwordx4 v[172:175], v1, s[12:15], s65 offen offset:1024
    v_mfma_f32_16x16x32_bf16 a[92:95], v[108:111], a[148:151], a[92:95]
    v_mov_b32_dpp v102, v102 row_shr:1 row_mask:0xf bank_mask:0xf
    v_mfma_f32_16x16x32_bf16 a[24:27], v[120:123], a[128:131], a[24:27]
    v_mov_b32_dpp v103, v103 row_shr:1 row_mask:0xf bank_mask:0xf
    v_mfma_f32_16x16x32_bf16 a[24:27], v[128:131], a[132:135], a[24:27]
    v_cndmask_b32_dpp v100, v116, v100, vcc row_shl:2 row_mask:0xf bank_mask:0xf
    v_mfma_f32_16x16x32_bf16 a[24:27], v[136:139], a[136:139], a[24:27]
    v_cndmask_b32_dpp v101, v117, v101, vcc row_shl:2 row_mask:0xf bank_mask:0xf
    v_mfma_f32_16x16x32_bf16 a[56:59], v[136:139], a[140:143], a[56:59]
    buffer_load_dwordx4 a[176:179], v1, s[16:19], s66 offen offset:0
    v_mfma_f32_16x16x32_bf16 a[56:59], v[128:131], a[144:147], a[56:59]
    v_cndmask_b32_dpp v102, v118, v102, vcc row_shl:2 row_mask:0xf bank_mask:0xf
    v_mfma_f32_16x16x32_bf16 a[56:59], v[120:123], a[148:151], a[56:59]
    v_cndmask_b32_dpp v103, v119, v103, vcc row_shl:2 row_mask:0xf bank_mask:0xf
    v_mfma_f32_16x16x32_bf16 a[56:59], v[124:127], a[128:131], a[56:59]
    v_mov_b32_dpp v104, v104 row_shr:1 row_mask:0xf bank_mask:0xf
    v_mfma_f32_16x16x32_bf16 a[56:59], v[132:135], a[132:135], a[56:59]
    v_mov_b32_dpp v105, v105 row_shr:1 row_mask:0xf bank_mask:0xf
    v_mfma_f32_16x16x32_bf16 a[56:59], v[140:143], a[136:139], a[56:59]
    buffer_load_dwordx4 v[176:179], v1, s[12:15], s65 offen offset:0
    v_mfma_f32_16x16x32_bf16 a[88:91], v[140:143], a[140:143], a[88:91]
    v_mov_b32_dpp v106, v106 row_shr:1 row_mask:0xf bank_mask:0xf
    v_mfma_f32_16x16x32_bf16 a[88:91], v[132:135], a[144:147], a[88:91]
    v_mov_b32_dpp v107, v107 row_shr:1 row_mask:0xf bank_mask:0xf
    v_mfma_f32_16x16x32_bf16 a[88:91], v[124:127], a[148:151], a[88:91]
    v_cndmask_b32_dpp v104, v112, v104, vcc row_shl:1 row_mask:0xf bank_mask:0xf
    v_mfma_f32_16x16x32_bf16 a[20:23], v[128:131], a[128:131], a[20:23]
    v_cndmask_b32_dpp v105, v113, v105, vcc row_shl:1 row_mask:0xf bank_mask:0xf
    v_mfma_f32_16x16x32_bf16 a[20:23], v[136:139], a[132:135], a[20:23]
    buffer_load_dwordx4 v[180:183], v2, s[20:23], s67 offen offset:0
    v_mfma_f32_16x16x32_bf16 a[20:23], v[72:75], a[136:139], a[20:23]
    v_cndmask_b32_dpp v106, v114, v106, vcc row_shl:1 row_mask:0xf bank_mask:0xf
    v_mfma_f32_16x16x32_bf16 a[52:55], v[72:75], a[140:143], a[52:55]
    v_cndmask_b32_dpp v107, v115, v107, vcc row_shl:1 row_mask:0xf bank_mask:0xf
    v_mfma_f32_16x16x32_bf16 a[52:55], v[136:139], a[144:147], a[52:55]
    v_mov_b32_dpp v108, v108 row_shr:1 row_mask:0xf bank_mask:0xf
    v_mfma_f32_16x16x32_bf16 a[52:55], v[128:131], a[148:151], a[52:55]
    v_mov_b32_dpp v109, v109 row_shr:1 row_mask:0xf bank_mask:0xf
    v_mfma_f32_16x16x32_bf16 a[52:55], v[132:135], a[128:131], a[52:55]
    buffer_load_dwordx4 v[184:187], v1, s[12:15], s68 offen offset:3072
    v_mfma_f32_16x16x32_bf16 a[52:55], v[140:143], a[132:135], a[52:55]
    v_mov_b32_dpp v110, v110 row_shr:1 row_mask:0xf bank_mask:0xf
    v_mfma_f32_16x16x32_bf16 a[52:55], v[76:79], a[136:139], a[52:55]
    v_mov_b32_dpp v111, v111 row_shr:1 row_mask:0xf bank_mask:0xf
    v_mfma_f32_16x16x32_bf16 a[84:87], v[76:79], a[140:143], a[84:87]
    v_cndmask_b32_dpp v108, v116, v108, vcc row_shl:1 row_mask:0xf bank_mask:0xf
    v_mfma_f32_16x16x32_bf16 a[84:87], v[140:143], a[144:147], a[84:87]
    v_cndmask_b32_dpp v109, v117, v109, vcc row_shl:1 row_mask:0xf bank_mask:0xf
    v_mfma_f32_16x16x32_bf16 a[84:87], v[132:135], a[148:151], a[84:87]
    buffer_load_dwordx4 a[180:183], v1, s[16:19], s66 offen offset:1024
    v_mfma_f32_16x16x32_bf16 a[16:19], v[136:139], a[128:131], a[16:19]
    v_cndmask_b32_dpp v110, v118, v110, vcc row_shl:1 row_mask:0xf bank_mask:0xf
    v_mfma_f32_16x16x32_bf16 a[16:19], v[72:75], a[132:135], a[16:19]
    v_cndmask_b32_dpp v111, v119, v111, vcc row_shl:1 row_mask:0xf bank_mask:0xf
    v_mfma_f32_16x16x32_bf16 a[16:19], v[84:87], a[136:139], a[16:19]
    v_mov_b32_dpp v120, v120 row_shr:1 row_mask:0xf bank_mask:0xf
    v_mfma_f32_16x16x32_bf16 a[48:51], v[84:87], a[140:143], a[48:51]
    v_mov_b32_dpp v121, v121 row_shr:1 row_mask:0xf bank_mask:0xf
    v_mfma_f32_16x16x32_bf16 a[48:51], v[72:75], a[144:147], a[48:51]
    buffer_load_dwordx4 v[188:191], v1, s[12:15], s68 offen offset:2048
    v_mfma_f32_16x16x32_bf16 a[48:51], v[136:139], a[148:151], a[48:51]
    v_mov_b32_dpp v122, v122 row_shr:1 row_mask:0xf bank_mask:0xf
    v_mfma_f32_16x16x32_bf16 a[48:51], v[140:143], a[128:131], a[48:51]
    v_mov_b32_dpp v123, v123 row_shr:1 row_mask:0xf bank_mask:0xf
    v_mfma_f32_16x16x32_bf16 a[48:51], v[76:79], a[132:135], a[48:51]
    v_cndmask_b32 v120, v112, v120, vcc
    v_mfma_f32_16x16x32_bf16 a[48:51], v[80:83], a[136:139], a[48:51]
    v_cndmask_b32 v121, v113, v121, vcc
    v_mfma_f32_16x16x32_bf16 a[80:83], v[80:83], a[140:143], a[80:83]
    buffer_load_dwordx4 a[184:187], v1, s[16:19], s66 offen offset:2048
    v_mfma_f32_16x16x32_bf16 a[80:83], v[76:79], a[144:147], a[80:83]
    v_cndmask_b32 v122, v114, v122, vcc
    v_mfma_f32_16x16x32_bf16 a[80:83], v[140:143], a[148:151], a[80:83]
    v_cndmask_b32 v123, v115, v123, vcc
    v_mfma_f32_16x16x32_bf16 a[12:15], v[72:75], a[128:131], a[12:15]
    v_mov_b32_dpp v124, v124 row_shr:1 row_mask:0xf bank_mask:0xf
    v_mfma_f32_16x16x32_bf16 a[12:15], v[84:87], a[132:135], a[12:15]
    v_mov_b32_dpp v125, v125 row_shr:1 row_mask:0xf bank_mask:0xf
    v_mfma_f32_16x16x32_bf16 a[12:15], v[92:95], a[136:139], a[12:15]
    buffer_load_dwordx4 v[192:195], v1, s[12:15], s68 offen offset:1024
    v_mfma_f32_16x16x32_bf16 a[44:47], v[92:95], a[140:143], a[44:47]
    v_mov_b32_dpp v126, v126 row_shr:1 row_mask:0xf bank_mask:0xf
    v_mfma_f32_16x16x32_bf16 a[44:47], v[84:87], a[144:147], a[44:47]
    v_mov_b32_dpp v127, v127 row_shr:1 row_mask:0xf bank_mask:0xf
    v_mfma_f32_16x16x32_bf16 a[44:47], v[72:75], a[148:151], a[44:47]
    v_cndmask_b32 v124, v116, v124, vcc
    v_mfma_f32_16x16x32_bf16 a[44:47], v[76:79], a[128:131], a[44:47]
    v_cndmask_b32 v125, v117, v125, vcc
    v_mfma_f32_16x16x32_bf16 a[44:47], v[80:83], a[132:135], a[44:47]
    buffer_load_dwordx4 a[188:191], v1, s[16:19], s66 offen offset:3072
    v_mfma_f32_16x16x32_bf16 a[44:47], v[88:91], a[136:139], a[44:47]
    v_cndmask_b32 v126, v118, v126, vcc
    v_mfma_f32_16x16x32_bf16 a[76:79], v[88:91], a[140:143], a[76:79]
    v_cndmask_b32 v127, v119, v127, vcc
    v_mfma_f32_16x16x32_bf16 a[76:79], v[80:83], a[144:147], a[76:79]
    v_mfma_f32_16x16x32_bf16 a[76:79], v[76:79], a[148:151], a[76:79]
    v_mfma_f32_16x16x32_bf16 a[8:11], v[84:87], a[128:131], a[8:11]
    buffer_load_dwordx4 v[196:199], v1, s[12:15], s68 offen offset:0
    v_mfma_f32_16x16x32_bf16 a[8:11], v[92:95], a[132:135], a[8:11]
    v_mfma_f32_16x16x32_bf16 a[8:11], v[96:99], a[136:139], a[8:11]
    v_mfma_f32_16x16x32_bf16 a[40:43], v[96:99], a[140:143], a[40:43]
    v_mfma_f32_16x16x32_bf16 a[40:43], v[92:95], a[144:147], a[40:43]
    v_mfma_f32_16x16x32_bf16 a[40:43], v[84:87], a[148:151], a[40:43]
    buffer_load_dwordx4 a[192:195], v1, s[16:19], s67 offen offset:0
    v_mfma_f32_16x16x32_bf16 a[40:43], v[80:83], a[128:131], a[40:43]
    v_mfma_f32_16x16x32_bf16 a[40:43], v[88:91], a[132:135], a[40:43]
    v_mfma_f32_16x16x32_bf16 a[40:43], v[100:103], a[136:139], a[40:43]
    v_mfma_f32_16x16x32_bf16 a[72:75], v[100:103], a[140:143], a[72:75]
    v_mfma_f32_16x16x32_bf16 a[72:75], v[88:91], a[144:147], a[72:75]
    buffer_load_dwordx4 v[200:203], v1, s[12:15], s67 offen offset:3072
    v_mfma_f32_16x16x32_bf16 a[72:75], v[80:83], a[148:151], a[72:75]
    v_mfma_f32_16x16x32_bf16 a[4:7], v[92:95], a[128:131], a[4:7]
    v_mfma_f32_16x16x32_bf16 a[4:7], v[96:99], a[132:135], a[4:7]
    v_mfma_f32_16x16x32_bf16 a[4:7], v[104:107], a[136:139], a[4:7]
    v_mfma_f32_16x16x32_bf16 a[36:39], v[104:107], a[140:143], a[36:39]
    buffer_load_dwordx4 a[196:199], v1, s[16:19], s67 offen offset:1024
    v_mfma_f32_16x16x32_bf16 a[36:39], v[96:99], a[144:147], a[36:39]
    v_mfma_f32_16x16x32_bf16 a[36:39], v[92:95], a[148:151], a[36:39]
    v_mfma_f32_16x16x32_bf16 a[36:39], v[88:91], a[128:131], a[36:39]
    v_mfma_f32_16x16x32_bf16 a[36:39], v[100:103], a[132:135], a[36:39]
    v_mfma_f32_16x16x32_bf16 a[36:39], v[108:111], a[136:139], a[36:39]
    buffer_load_dwordx4 v[204:207], v1, s[12:15], s67 offen offset:2048
    v_mfma_f32_16x16x32_bf16 a[68:71], v[108:111], a[140:143], a[68:71]
    v_mfma_f32_16x16x32_bf16 a[68:71], v[100:103], a[144:147], a[68:71]
    v_mfma_f32_16x16x32_bf16 a[68:71], v[88:91], a[148:151], a[68:71]
    v_mfma_f32_16x16x32_bf16 a[0:3], v[96:99], a[128:131], a[0:3]
    v_mfma_f32_16x16x32_bf16 a[0:3], v[104:107], a[132:135], a[0:3]
    buffer_load_dwordx4 a[200:203], v1, s[16:19], s67 offen offset:2048
    v_mfma_f32_16x16x32_bf16 a[0:3], v[120:123], a[136:139], a[0:3]
    v_mfma_f32_16x16x32_bf16 a[32:35], v[120:123], a[140:143], a[32:35]
    v_mfma_f32_16x16x32_bf16 a[32:35], v[104:107], a[144:147], a[32:35]
    v_mfma_f32_16x16x32_bf16 a[32:35], v[96:99], a[148:151], a[32:35]
    v_mfma_f32_16x16x32_bf16 a[32:35], v[100:103], a[128:131], a[32:35]
    buffer_load_dwordx4 v[208:211], v1, s[12:15], s67 offen offset:1024
    v_mfma_f32_16x16x32_bf16 a[32:35], v[108:111], a[132:135], a[32:35]
    v_mfma_f32_16x16x32_bf16 a[32:35], v[124:127], a[136:139], a[32:35]
    v_mfma_f32_16x16x32_bf16 a[64:67], v[124:127], a[140:143], a[64:67]
    v_mfma_f32_16x16x32_bf16 a[64:67], v[108:111], a[144:147], a[64:67]
    v_mfma_f32_16x16x32_bf16 a[64:67], v[100:103], a[148:151], a[64:67]
    buffer_load_dwordx4 a[204:207], v1, s[16:19], s67 offen offset:3072
    s_waitcnt vmcnt(18)
    v_mfma_f32_16x16x32_bf16 v[36:39], v[148:151], a[152:155], 0
    v_mov_b32_dpp v148, v148 row_shr:1 row_mask:0xf bank_mask:0xf
    v_mov_b32_dpp v149, v149 row_shr:1 row_mask:0xf bank_mask:0xf
    v_mfma_f32_16x16x32_bf16 v[36:39], v[152:155], a[156:159], v[36:39]
    v_mov_b32_dpp v150, v150 row_shr:1 row_mask:0xf bank_mask:0xf
    v_mov_b32_dpp v151, v151 row_shr:1 row_mask:0xf bank_mask:0xf
    v_mfma_f32_16x16x32_bf16 v[36:39], v[156:159], a[160:163], v[36:39]
    v_cndmask_b32_dpp v148, v144, v148, vcc row_shl:5 row_mask:0xf bank_mask:0xf
    v_cndmask_b32_dpp v149, v145, v149, vcc row_shl:5 row_mask:0xf bank_mask:0xf
    v_mfma_f32_16x16x32_bf16 v[36:39], v[160:163], a[164:167], v[36:39]
    v_cndmask_b32_dpp v150, v146, v150, vcc row_shl:5 row_mask:0xf bank_mask:0xf
    v_cndmask_b32_dpp v151, v147, v151, vcc row_shl:5 row_mask:0xf bank_mask:0xf
    v_mfma_f32_16x16x32_bf16 v[36:39], v[164:167], a[168:171], v[36:39]
    buffer_load_dwordx4 v[212:215], v1, s[12:15], s67 offen offset:0
    v_mfma_f32_16x16x32_bf16 v[36:39], v[168:171], a[172:175], v[36:39]
    s_waitcnt vmcnt(17)
    v_mfma_f32_16x16x32_bf16 v[36:39], v[172:175], a[176:179], v[36:39]
    v_mfma_f32_16x16x32_bf16 v[32:35], v[152:155], a[152:155], 0
    v_mov_b32_dpp v152, v152 row_shr:1 row_mask:0xf bank_mask:0xf
    v_mov_b32_dpp v153, v153 row_shr:1 row_mask:0xf bank_mask:0xf
    v_mfma_f32_16x16x32_bf16 v[32:35], v[156:159], a[156:159], v[32:35]
    v_mov_b32_dpp v154, v154 row_shr:1 row_mask:0xf bank_mask:0xf
    v_mov_b32_dpp v155, v155 row_shr:1 row_mask:0xf bank_mask:0xf
    v_mfma_f32_16x16x32_bf16 v[32:35], v[160:163], a[160:163], v[32:35]
    buffer_load_dwordx4 v[216:219], v2, s[56:59], 0 offen offset:0
    v_cndmask_b32_dpp v152, v144, v152, vcc row_shl:4 row_mask:0xf bank_mask:0xf
    v_mfma_f32_16x16x32_bf16 v[32:35], v[164:167], a[164:167], v[32:35]
    v_cndmask_b32_dpp v153, v145, v153, vcc row_shl:4 row_mask:0xf bank_mask:0xf
    v_cndmask_b32_dpp v154, v146, v154, vcc row_shl:4 row_mask:0xf bank_mask:0xf
    v_mfma_f32_16x16x32_bf16 v[32:35], v[168:171], a[168:171], v[32:35]
    v_cndmask_b32_dpp v155, v147, v155, vcc row_shl:4 row_mask:0xf bank_mask:0xf
    v_mfma_f32_16x16x32_bf16 v[32:35], v[172:175], a[172:175], v[32:35]
    s_waitcnt vmcnt(17)
    v_mfma_f32_16x16x32_bf16 v[32:35], v[176:179], a[176:179], v[32:35]
    v_mfma_f32_16x16x32_bf16 v[28:31], v[156:159], a[152:155], 0
    buffer_load_dwordx4 v[220:223], v2, s[56:59], s26 offen offset:0
    v_mov_b32_dpp v156, v156 row_shr:1 row_mask:0xf bank_mask:0xf
    v_mfma_f32_16x16x32_bf16 v[28:31], v[160:163], a[156:159], v[28:31]
    v_mov_b32_dpp v157, v157 row_shr:1 row_mask:0xf bank_mask:0xf
    v_mov_b32_dpp v158, v158 row_shr:1 row_mask:0xf bank_mask:0xf
    v_mfma_f32_16x16x32_bf16 v[28:31], v[164:167], a[160:163], v[28:31]
    v_mov_b32_dpp v159, v159 row_shr:1 row_mask:0xf bank_mask:0xf
    v_cndmask_b32_dpp v156, v144, v156, vcc row_shl:3 row_mask:0xf bank_mask:0xf
    v_mfma_f32_16x16x32_bf16 v[28:31], v[168:171], a[164:167], v[28:31]
    v_cndmask_b32_dpp v157, v145, v157, vcc row_shl:3 row_mask:0xf bank_mask:0xf
    v_cndmask_b32_dpp v158, v146, v158, vcc row_shl:3 row_mask:0xf bank_mask:0xf
    v_mfma_f32_16x16x32_bf16 v[28:31], v[172:175], a[168:171], v[28:31]
    v_cndmask_b32_dpp v159, v147, v159, vcc row_shl:3 row_mask:0xf bank_mask:0xf
    v_mfma_f32_16x16x32_bf16 v[28:31], v[176:179], a[172:175], v[28:31]
    buffer_load_dwordx4 v[224:227], v1, s[40:43], s25 offen offset:3072
    v_mfma_f32_16x16x32_bf16 v[28:31], v[148:151], a[176:179], v[28:31]
    v_mfma_f32_16x16x32_bf16 v[24:27], v[160:163], a[152:155], 0
    v_mov_b32_dpp v160, v160 row_shr:1 row_mask:0xf bank_mask:0xf
    v_mov_b32_dpp v161, v161 row_shr:1 row_mask:0xf bank_mask:0xf
    v_mfma_f32_16x16x32_bf16 v[24:27], v[164:167], a[156:159], v[24:27]
    v_mov_b32_dpp v162, v162 row_shr:1 row_mask:0xf bank_mask:0xf
    v_mfma_f32_16x16x32_bf16 v[24:27], v[168:171], a[160:163], v[24:27]
    v_mov_b32_dpp v163, v163 row_shr:1 row_mask:0xf bank_mask:0xf
    v_mfma_f32_16x16x32_bf16 v[24:27], v[172:175], a[164:167], v[24:27]
    buffer_load_dwordx4 a[208:211], v1, s[48:51], 0 offen offset:0
    v_mfma_f32_16x16x32_bf16 v[24:27], v[176:179], a[168:171], v[24:27]
    v_cndmask_b32_dpp v160, v144, v160, vcc row_shl:2 row_mask:0xf bank_mask:0xf
    v_mfma_f32_16x16x32_bf16 v[24:27], v[148:151], a[172:175], v[24:27]
    v_cndmask_b32_dpp v161, v145, v161, vcc row_shl:2 row_mask:0xf bank_mask:0xf
    v_mfma_f32_16x16x32_bf16 v[24:27], v[152:155], a[176:179], v[24:27]
    v_cndmask_b32_dpp v162, v146, v162, vcc row_shl:2 row_mask:0xf bank_mask:0xf
    v_mfma_f32_16x16x32_bf16 v[20:23], v[164:167], a[152:155], 0
    v_cndmask_b32_dpp v163, v147, v163, vcc row_shl:2 row_mask:0xf bank_mask:0xf
    v_mfma_f32_16x16x32_bf16 v[20:23], v[168:171], a[156:159], v[20:23]
    buffer_load_dwordx4 v[228:231], v1, s[40:43], s25 offen offset:2048
    v_mfma_f32_16x16x32_bf16 v[20:23], v[172:175], a[160:163], v[20:23]
    v_mov_b32_dpp v164, v164 row_shr:1 row_mask:0xf bank_mask:0xf
    v_mov_b32_dpp v165, v165 row_shr:1 row_mask:0xf bank_mask:0xf
    v_mfma_f32_16x16x32_bf16 v[20:23], v[176:179], a[164:167], v[20:23]
    v_mov_b32_dpp v166, v166 row_shr:1 row_mask:0xf bank_mask:0xf
    v_mov_b32_dpp v167, v167 row_shr:1 row_mask:0xf bank_mask:0xf
    v_mfma_f32_16x16x32_bf16 v[20:23], v[148:151], a[168:171], v[20:23]
    v_cndmask_b32_dpp v164, v144, v164, vcc row_shl:1 row_mask:0xf bank_mask:0xf
    v_cndmask_b32_dpp v165, v145, v165, vcc row_shl:1 row_mask:0xf bank_mask:0xf
    v_mfma_f32_16x16x32_bf16 v[20:23], v[152:155], a[172:175], v[20:23]
    v_cndmask_b32_dpp v166, v146, v166, vcc row_shl:1 row_mask:0xf bank_mask:0xf
    v_cndmask_b32_dpp v167, v147, v167, vcc row_shl:1 row_mask:0xf bank_mask:0xf
    v_mfma_f32_16x16x32_bf16 v[20:23], v[156:159], a[176:179], v[20:23]
    buffer_load_dwordx4 a[212:215], v1, s[48:51], 0 offen offset:1024
    v_mfma_f32_16x16x32_bf16 v[16:19], v[168:171], a[152:155], 0
    v_mov_b32_dpp v168, v168 row_shr:1 row_mask:0xf bank_mask:0xf
    v_mfma_f32_16x16x32_bf16 v[16:19], v[172:175], a[156:159], v[16:19]
    v_mov_b32_dpp v169, v169 row_shr:1 row_mask:0xf bank_mask:0xf
    v_mfma_f32_16x16x32_bf16 v[16:19], v[176:179], a[160:163], v[16:19]
    v_mov_b32_dpp v170, v170 row_shr:1 row_mask:0xf bank_mask:0xf
    v_mov_b32_dpp v171, v171 row_shr:1 row_mask:0xf bank_mask:0xf
    v_mfma_f32_16x16x32_bf16 v[16:19], v[148:151], a[164:167], v[16:19]
    v_cndmask_b32 v168, v144, v168, vcc
    v_cndmask_b32 v169, v145, v169, vcc
    v_mfma_f32_16x16x32_bf16 v[16:19], v[152:155], a[168:171], v[16:19]
    buffer_load_dwordx4 v[232:235], v1, s[40:43], s25 offen offset:1024
    v_cndmask_b32 v170, v146, v170, vcc
    v_mfma_f32_16x16x32_bf16 v[16:19], v[156:159], a[172:175], v[16:19]
    v_cndmask_b32 v171, v147, v171, vcc
    v_mfma_f32_16x16x32_bf16 v[16:19], v[160:163], a[176:179], v[16:19]
    v_mfma_f32_16x16x32_bf16 v[12:15], v[172:175], a[152:155], 0
    v_mfma_f32_16x16x32_bf16 v[12:15], v[176:179], a[156:159], v[12:15]
    v_mfma_f32_16x16x32_bf16 v[12:15], v[148:151], a[160:163], v[12:15]
    buffer_load_dwordx4 a[216:219], v1, s[48:51], 0 offen offset:2048
    v_mfma_f32_16x16x32_bf16 v[12:15], v[152:155], a[164:167], v[12:15]
    v_mfma_f32_16x16x32_bf16 v[12:15], v[156:159], a[168:171], v[12:15]
    v_mfma_f32_16x16x32_bf16 v[12:15], v[160:163], a[172:175], v[12:15]
    v_mfma_f32_16x16x32_bf16 v[12:15], v[164:167], a[176:179], v[12:15]
    v_mfma_f32_16x16x32_bf16 v[8:11], v[176:179], a[152:155], 0
    buffer_load_dwordx4 v[236:239], v1, s[40:43], s25 offen offset:0
    v_mfma_f32_16x16x32_bf16 v[8:11], v[148:151], a[156:159], v[8:11]
    v_mfma_f32_16x16x32_bf16 v[8:11], v[152:155], a[160:163], v[8:11]
    v_mfma_f32_16x16x32_bf16 v[8:11], v[156:159], a[164:167], v[8:11]
    v_mfma_f32_16x16x32_bf16 v[8:11], v[160:163], a[168:171], v[8:11]
    v_mfma_f32_16x16x32_bf16 v[8:11], v[164:167], a[172:175], v[8:11]
    buffer_load_dwordx4 a[220:223], v1, s[48:51], 0 offen offset:3072
    v_mfma_f32_16x16x32_bf16 v[8:11], v[168:171], a[176:179], v[8:11]
    s_waitcnt vmcnt(18)
    v_mfma_f32_16x16x32_bf16 v[68:71], v[184:187], a[180:183], 0
    v_mov_b32_dpp v184, v184 row_shr:1 row_mask:0xf bank_mask:0xf
    v_mov_b32_dpp v185, v185 row_shr:1 row_mask:0xf bank_mask:0xf
    v_mfma_f32_16x16x32_bf16 v[68:71], v[188:191], a[184:187], v[68:71]
    v_mov_b32_dpp v186, v186 row_shr:1 row_mask:0xf bank_mask:0xf
    v_mov_b32_dpp v187, v187 row_shr:1 row_mask:0xf bank_mask:0xf
    v_mfma_f32_16x16x32_bf16 v[68:71], v[192:195], a[188:191], v[68:71]
    v_cndmask_b32_dpp v184, v180, v184, vcc row_shl:5 row_mask:0xf bank_mask:0xf
    s_waitcnt vmcnt(17)
    v_mfma_f32_16x16x32_bf16 v[68:71], v[196:199], a[192:195], v[68:71]
    buffer_load_dwordx4 a[224:227], v1, s[48:51], s26 offen offset:2048
    s_waitcnt vmcnt(16)
    v_mfma_f32_16x16x32_bf16 v[68:71], v[200:203], a[196:199], v[68:71]
    v_cndmask_b32_dpp v185, v181, v185, vcc row_shl:5 row_mask:0xf bank_mask:0xf
    s_waitcnt vmcnt(14)
    v_mfma_f32_16x16x32_bf16 v[68:71], v[204:207], a[200:203], v[68:71]
    v_cndmask_b32_dpp v186, v182, v186, vcc row_shl:5 row_mask:0xf bank_mask:0xf
    s_waitcnt vmcnt(12)
    v_mfma_f32_16x16x32_bf16 v[68:71], v[208:211], a[204:207], v[68:71]
    v_cndmask_b32_dpp v187, v183, v187, vcc row_shl:5 row_mask:0xf bank_mask:0xf
    v_mfma_f32_16x16x32_bf16 v[64:67], v[188:191], a[180:183], 0
    v_mov_b32_dpp v188, v188 row_shr:1 row_mask:0xf bank_mask:0xf
    v_mov_b32_dpp v189, v189 row_shr:1 row_mask:0xf bank_mask:0xf
    v_mfma_f32_16x16x32_bf16 v[64:67], v[192:195], a[184:187], v[64:67]
    buffer_load_dwordx4 a[228:231], v1, s[48:51], s26 offen offset:1024
    v_mov_b32_dpp v190, v190 row_shr:1 row_mask:0xf bank_mask:0xf
    v_mfma_f32_16x16x32_bf16 v[64:67], v[196:199], a[188:191], v[64:67]
    v_mov_b32_dpp v191, v191 row_shr:1 row_mask:0xf bank_mask:0xf
    v_cndmask_b32_dpp v188, v180, v188, vcc row_shl:4 row_mask:0xf bank_mask:0xf
    v_mfma_f32_16x16x32_bf16 v[64:67], v[200:203], a[192:195], v[64:67]
    v_cndmask_b32_dpp v189, v181, v189, vcc row_shl:4 row_mask:0xf bank_mask:0xf
    v_cndmask_b32_dpp v190, v182, v190, vcc row_shl:4 row_mask:0xf bank_mask:0xf
    v_mfma_f32_16x16x32_bf16 v[64:67], v[204:207], a[196:199], v[64:67]
    v_cndmask_b32_dpp v191, v183, v191, vcc row_shl:4 row_mask:0xf bank_mask:0xf
    v_mfma_f32_16x16x32_bf16 v[64:67], v[208:211], a[200:203], v[64:67]
    s_waitcnt vmcnt(12)
    v_mfma_f32_16x16x32_bf16 v[64:67], v[212:215], a[204:207], v[64:67]
    buffer_load_dwordx4 a[232:235], v1, s[48:51], s26 offen offset:0
    v_mfma_f32_16x16x32_bf16 v[60:63], v[192:195], a[180:183], 0
    v_mov_b32_dpp v192, v192 row_shr:1 row_mask:0xf bank_mask:0xf
    v_mov_b32_dpp v193, v193 row_shr:1 row_mask:0xf bank_mask:0xf
    v_mfma_f32_16x16x32_bf16 v[60:63], v[196:199], a[184:187], v[60:63]
    v_mov_b32_dpp v194, v194 row_shr:1 row_mask:0xf bank_mask:0xf
    v_mov_b32_dpp v195, v195 row_shr:1 row_mask:0xf bank_mask:0xf
    v_mfma_f32_16x16x32_bf16 v[60:63], v[200:203], a[188:191], v[60:63]
    v_cndmask_b32_dpp v192, v180, v192, vcc row_shl:3 row_mask:0xf bank_mask:0xf
    v_cndmask_b32_dpp v193, v181, v193, vcc row_shl:3 row_mask:0xf bank_mask:0xf
    v_mfma_f32_16x16x32_bf16 v[60:63], v[204:207], a[192:195], v[60:63]
    v_cndmask_b32_dpp v194, v182, v194, vcc row_shl:3 row_mask:0xf bank_mask:0xf
    v_cndmask_b32_dpp v195, v183, v195, vcc row_shl:3 row_mask:0xf bank_mask:0xf
    v_mfma_f32_16x16x32_bf16 v[60:63], v[208:211], a[196:199], v[60:63]
    buffer_load_dwordx4 a[236:239], v1, s[48:51], s25 offen offset:3072
    v_mfma_f32_16x16x32_bf16 v[60:63], v[212:215], a[200:203], v[60:63]
    v_mfma_f32_16x16x32_bf16 v[60:63], v[184:187], a[204:207], v[60:63]
    v_mfma_f32_16x16x32_bf16 v[56:59], v[196:199], a[180:183], 0
    v_mov_b32_dpp v196, v196 row_shr:1 row_mask:0xf bank_mask:0xf
    v_mov_b32_dpp v197, v197 row_shr:1 row_mask:0xf bank_mask:0xf
    v_mfma_f32_16x16x32_bf16 v[56:59], v[200:203], a[184:187], v[56:59]
    v_mov_b32_dpp v198, v198 row_shr:1 row_mask:0xf bank_mask:0xf
    v_mov_b32_dpp v199, v199 row_shr:1 row_mask:0xf bank_mask:0xf
    v_mfma_f32_16x16x32_bf16 v[56:59], v[204:207], a[188:191], v[56:59]
    buffer_load_dwordx4 v[240:243], v1, s[40:43], s64 offen offset:3072
    v_cndmask_b32_dpp v196, v180, v196, vcc row_shl:2 row_mask:0xf bank_mask:0xf
    v_mfma_f32_16x16x32_bf16 v[56:59], v[208:211], a[192:195], v[56:59]
    v_cndmask_b32_dpp v197, v181, v197, vcc row_shl:2 row_mask:0xf bank_mask:0xf
    v_mfma_f32_16x16x32_bf16 v[56:59], v[212:215], a[196:199], v[56:59]
    buffer_load_dwordx4 v[252:255], v1, s[40:43], s64 offen offset:2048
    v_mfma_f32_16x16x32_bf16 v[56:59], v[184:187], a[200:203], v[56:59]
    buffer_load_dwordx4 v[128:131], v1, s[40:43], s64 offen offset:1024
    v_mfma_f32_16x16x32_bf16 v[56:59], v[188:191], a[204:207], v[56:59]
    buffer_load_dwordx4 v[132:135], v1, s[40:43], s64 offen offset:0
    v_mfma_f32_16x16x32_bf16 v[52:55], v[200:203], a[180:183], 0
    v_cndmask_b32_dpp v198, v182, v198, vcc row_shl:2 row_mask:0xf bank_mask:0xf
    v_mfma_f32_16x16x32_bf16 v[52:55], v[204:207], a[184:187], v[52:55]
    v_cndmask_b32_dpp v199, v183, v199, vcc row_shl:2 row_mask:0xf bank_mask:0xf
    v_mfma_f32_16x16x32_bf16 v[52:55], v[208:211], a[188:191], v[52:55]
    v_mov_b32_dpp v200, v200 row_shr:1 row_mask:0xf bank_mask:0xf
    v_mfma_f32_16x16x32_bf16 v[52:55], v[212:215], a[192:195], v[52:55]
    v_mov_b32_dpp v201, v201 row_shr:1 row_mask:0xf bank_mask:0xf
    v_mfma_f32_16x16x32_bf16 v[52:55], v[184:187], a[196:199], v[52:55]
    buffer_load_dwordx4 v[136:139], v1, s[40:43], 0 offen offset:3072
    v_mfma_f32_16x16x32_bf16 v[52:55], v[188:191], a[200:203], v[52:55]
    v_mov_b32_dpp v202, v202 row_shr:1 row_mask:0xf bank_mask:0xf
    v_mfma_f32_16x16x32_bf16 v[52:55], v[192:195], a[204:207], v[52:55]
    v_mov_b32_dpp v203, v203 row_shr:1 row_mask:0xf bank_mask:0xf
    v_mfma_f32_16x16x32_bf16 v[48:51], v[204:207], a[180:183], 0
    v_cndmask_b32_dpp v200, v180, v200, vcc row_shl:1 row_mask:0xf bank_mask:0xf
    v_mfma_f32_16x16x32_bf16 v[48:51], v[208:211], a[184:187], v[48:51]
    v_cndmask_b32_dpp v201, v181, v201, vcc row_shl:1 row_mask:0xf bank_mask:0xf
    v_mfma_f32_16x16x32_bf16 v[48:51], v[212:215], a[188:191], v[48:51]
    buffer_load_dwordx4 v[140:143], v1, s[40:43], s26 offen offset:3072
    v_mfma_f32_16x16x32_bf16 v[48:51], v[184:187], a[192:195], v[48:51]
    v_cndmask_b32_dpp v202, v182, v202, vcc row_shl:1 row_mask:0xf bank_mask:0xf
    v_mfma_f32_16x16x32_bf16 v[48:51], v[188:191], a[196:199], v[48:51]
    v_cndmask_b32_dpp v203, v183, v203, vcc row_shl:1 row_mask:0xf bank_mask:0xf
    v_mfma_f32_16x16x32_bf16 v[48:51], v[192:195], a[200:203], v[48:51]
    v_mov_b32_dpp v204, v204 row_shr:1 row_mask:0xf bank_mask:0xf
    v_mfma_f32_16x16x32_bf16 v[48:51], v[196:199], a[204:207], v[48:51]
    v_mov_b32_dpp v205, v205 row_shr:1 row_mask:0xf bank_mask:0xf
    v_mfma_f32_16x16x32_bf16 v[44:47], v[208:211], a[180:183], 0
    buffer_load_dwordx4 v[72:75], v1, s[40:43], 0 offen offset:2048
    v_mfma_f32_16x16x32_bf16 v[44:47], v[212:215], a[184:187], v[44:47]
    v_mov_b32_dpp v206, v206 row_shr:1 row_mask:0xf bank_mask:0xf
    v_mfma_f32_16x16x32_bf16 v[44:47], v[184:187], a[188:191], v[44:47]
    v_mov_b32_dpp v207, v207 row_shr:1 row_mask:0xf bank_mask:0xf
    v_mfma_f32_16x16x32_bf16 v[44:47], v[188:191], a[192:195], v[44:47]
    v_cndmask_b32 v204, v180, v204, vcc
    v_mfma_f32_16x16x32_bf16 v[44:47], v[192:195], a[196:199], v[44:47]
    v_cndmask_b32 v205, v181, v205, vcc
    v_mfma_f32_16x16x32_bf16 v[44:47], v[196:199], a[200:203], v[44:47]
    buffer_load_dwordx4 v[76:79], v1, s[40:43], s26 offen offset:2048
    v_mfma_f32_16x16x32_bf16 v[44:47], v[200:203], a[204:207], v[44:47]
    v_cndmask_b32 v206, v182, v206, vcc
    v_mfma_f32_16x16x32_bf16 v[40:43], v[212:215], a[180:183], 0
    v_cndmask_b32 v207, v183, v207, vcc
    v_mfma_f32_16x16x32_bf16 v[40:43], v[184:187], a[184:187], v[40:43]
    v_mfma_f32_16x16x32_bf16 v[40:43], v[188:191], a[188:191], v[40:43]
    v_mfma_f32_16x16x32_bf16 v[40:43], v[192:195], a[192:195], v[40:43]
    buffer_load_dwordx4 v[84:87], v1, s[40:43], 0 offen offset:1024
    v_mfma_f32_16x16x32_bf16 v[40:43], v[196:199], a[196:199], v[40:43]
    v_mfma_f32_16x16x32_bf16 v[40:43], v[200:203], a[200:203], v[40:43]
    v_mfma_f32_16x16x32_bf16 v[40:43], v[204:207], a[204:207], v[40:43]
    s_waitcnt vmcnt(19)
    v_mfma_f32_16x16x32_bf16 a[28:31], v[224:227], a[208:211], a[28:31]
    s_waitcnt vmcnt(17)
    v_mfma_f32_16x16x32_bf16 a[28:31], v[228:231], a[212:215], a[28:31]
    buffer_load_dwordx4 v[80:83], v1, s[40:43], s26 offen offset:1024
    s_waitcnt vmcnt(16)
    v_mfma_f32_16x16x32_bf16 a[28:31], v[232:235], a[216:219], a[28:31]
    s_waitcnt vmcnt(14)
    v_mfma_f32_16x16x32_bf16 a[28:31], v[236:239], a[220:223], a[28:31]
    s_waitcnt vmcnt(13)
    v_mfma_f32_16x16x32_bf16 a[60:63], v[236:239], a[224:227], a[60:63]
    s_waitcnt vmcnt(12)
    v_mfma_f32_16x16x32_bf16 a[60:63], v[232:235], a[228:231], a[60:63]
    s_waitcnt vmcnt(11)
    v_mfma_f32_16x16x32_bf16 a[60:63], v[228:231], a[232:235], a[60:63]
    buffer_load_dwordx4 v[92:95], v1, s[40:43], 0 offen offset:0
    s_waitcnt vmcnt(11)
    v_mfma_f32_16x16x32_bf16 a[60:63], v[224:227], a[236:239], a[60:63]
    s_waitcnt vmcnt(10)
    v_mfma_f32_16x16x32_bf16 a[60:63], v[240:243], a[208:211], a[60:63]
    s_waitcnt vmcnt(9)
    v_mfma_f32_16x16x32_bf16 a[60:63], v[252:255], a[212:215], a[60:63]
    s_waitcnt vmcnt(8)
    v_mfma_f32_16x16x32_bf16 a[60:63], v[128:131], a[216:219], a[60:63]
    s_waitcnt vmcnt(7)
    v_mfma_f32_16x16x32_bf16 a[60:63], v[132:135], a[220:223], a[60:63]
    buffer_load_dwordx4 v[88:91], v1, s[40:43], s26 offen offset:0
    v_mfma_f32_16x16x32_bf16 a[92:95], v[132:135], a[224:227], a[92:95]
    v_mov_b32_dpp v224, v224 row_shr:1 row_mask:0xf bank_mask:0xf
    v_mfma_f32_16x16x32_bf16 a[92:95], v[128:131], a[228:231], a[92:95]
    v_mov_b32_dpp v225, v225 row_shr:1 row_mask:0xf bank_mask:0xf
    v_mfma_f32_16x16x32_bf16 a[92:95], v[252:255], a[232:235], a[92:95]
    v_mov_b32_dpp v226, v226 row_shr:1 row_mask:0xf bank_mask:0xf
    v_mfma_f32_16x16x32_bf16 a[92:95], v[240:243], a[236:239], a[92:95]
    v_mov_b32_dpp v227, v227 row_shr:1 row_mask:0xf bank_mask:0xf
    v_mfma_f32_16x16x32_bf16 a[24:27], v[228:231], a[208:211], a[24:27]
    buffer_load_dwordx4 a[240:243], v1, s[48:51], s25 offen offset:0
    v_mfma_f32_16x16x32_bf16 a[24:27], v[232:235], a[212:215], a[24:27]
    v_cndmask_b32_dpp v224, v216, v224, vcc row_shl:5 row_mask:0xf bank_mask:0xf
    v_mfma_f32_16x16x32_bf16 a[24:27], v[236:239], a[216:219], a[24:27]
    s_waitcnt vmcnt(8)
    v_mfma_f32_16x16x32_bf16 a[24:27], v[136:139], a[220:223], a[24:27]
    v_cndmask_b32_dpp v225, v217, v225, vcc row_shl:5 row_mask:0xf bank_mask:0xf
    v_mfma_f32_16x16x32_bf16 a[56:59], v[136:139], a[224:227], a[56:59]
    v_cndmask_b32_dpp v226, v218, v226, vcc row_shl:5 row_mask:0xf bank_mask:0xf
    v_mfma_f32_16x16x32_bf16 a[56:59], v[236:239], a[228:231], a[56:59]
    buffer_load_dwordx4 a[244:247], v1, s[48:51], s25 offen offset:1024
    v_mfma_f32_16x16x32_bf16 a[56:59], v[232:235], a[232:235], a[56:59]
    v_cndmask_b32_dpp v227, v219, v227, vcc row_shl:5 row_mask:0xf bank_mask:0xf
    v_mfma_f32_16x16x32_bf16 a[56:59], v[228:231], a[236:239], a[56:59]
    v_mov_b32_dpp v240, v240 row_shr:1 row_mask:0xf bank_mask:0xf
    v_mfma_f32_16x16x32_bf16 a[56:59], v[252:255], a[208:211], a[56:59]
    v_mov_b32_dpp v241, v241 row_shr:1 row_mask:0xf bank_mask:0xf
    v_mfma_f32_16x16x32_bf16 a[56:59], v[128:131], a[212:215], a[56:59]
    v_mov_b32_dpp v242, v242 row_shr:1 row_mask:0xf bank_mask:0xf
    v_mfma_f32_16x16x32_bf16 a[56:59], v[132:135], a[216:219], a[56:59]
    buffer_load_dwordx4 a[248:251], v1, s[48:51], s25 offen offset:2048
    s_waitcnt vmcnt(9)
    v_mfma_f32_16x16x32_bf16 a[56:59], v[140:143], a[220:223], a[56:59]
    v_mov_b32_dpp v243, v243 row_shr:1 row_mask:0xf bank_mask:0xf
    v_mfma_f32_16x16x32_bf16 a[88:91], v[140:143], a[224:227], a[88:91]
    v_cndmask_b32_dpp v240, v220, v240, vcc row_shl:5 row_mask:0xf bank_mask:0xf
    v_mfma_f32_16x16x32_bf16 a[88:91], v[132:135], a[228:231], a[88:91]
    v_cndmask_b32_dpp v241, v221, v241, vcc row_shl:5 row_mask:0xf bank_mask:0xf
    v_mfma_f32_16x16x32_bf16 a[88:91], v[128:131], a[232:235], a[88:91]
    v_cndmask_b32_dpp v242, v222, v242, vcc row_shl:5 row_mask:0xf bank_mask:0xf
    v_mfma_f32_16x16x32_bf16 a[88:91], v[252:255], a[236:239], a[88:91]
    buffer_load_dwordx4 a[252:255], v1, s[48:51], s64 offen offset:1024
    v_mfma_f32_16x16x32_bf16 a[20:23], v[232:235], a[208:211], a[20:23]
    v_cndmask_b32_dpp v243, v223, v243, vcc row_shl:5 row_mask:0xf bank_mask:0xf
    v_mfma_f32_16x16x32_bf16 a[20:23], v[236:239], a[212:215], a[20:23]
    v_mov_b32_dpp v228, v228 row_shr:1 row_mask:0xf bank_mask:0xf
    v_mfma_f32_16x16x32_bf16 a[20:23], v[136:139], a[216:219], a[20:23]
    s_waitcnt vmcnt(9)
    v_mfma_f32_16x16x32_bf16 a[20:23], v[72:75], a[220:223], a[20:23]
    v_mov_b32_dpp v229, v229 row_shr:1 row_mask:0xf bank_mask:0xf
    v_mfma_f32_16x16x32_bf16 a[52:55], v[72:75], a[224:227], a[52:55]
    buffer_load_dwordx4 a[100:103], v1, s[48:51], s64 offen offset:0
    v_mfma_f32_16x16x32_bf16 a[52:55], v[136:139], a[228:231], a[52:55]
    v_mov_b32_dpp v230, v230 row_shr:1 row_mask:0xf bank_mask:0xf
    v_mfma_f32_16x16x32_bf16 a[52:55], v[236:239], a[232:235], a[52:55]
    v_mov_b32_dpp v231, v231 row_shr:1 row_mask:0xf bank_mask:0xf
    v_mfma_f32_16x16x32_bf16 a[52:55], v[232:235], a[236:239], a[52:55]
    v_cndmask_b32_dpp v228, v216, v228, vcc row_shl:4 row_mask:0xf bank_mask:0xf
    v_mfma_f32_16x16x32_bf16 a[52:55], v[128:131], a[208:211], a[52:55]
    v_cndmask_b32_dpp v229, v217, v229, vcc row_shl:4 row_mask:0xf bank_mask:0xf
    v_mfma_f32_16x16x32_bf16 a[52:55], v[132:135], a[212:215], a[52:55]
    buffer_load_dwordx4 a[96:99], v1, s[48:51], s26 offen offset:3072
    v_mfma_f32_16x16x32_bf16 a[52:55], v[140:143], a[216:219], a[52:55]
    s_waitcnt vmcnt(10)
    v_mfma_f32_16x16x32_bf16 a[52:55], v[76:79], a[220:223], a[52:55]
    v_cndmask_b32_dpp v230, v218, v230, vcc row_shl:4 row_mask:0xf bank_mask:0xf
    v_mfma_f32_16x16x32_bf16 a[84:87], v[76:79], a[224:227], a[84:87]
    v_cndmask_b32_dpp v231, v219, v231, vcc row_shl:4 row_mask:0xf bank_mask:0xf
    v_mfma_f32_16x16x32_bf16 a[84:87], v[140:143], a[228:231], a[84:87]
    v_mov_b32_dpp v252, v252 row_shr:1 row_mask:0xf bank_mask:0xf
    v_mfma_f32_16x16x32_bf16 a[84:87], v[132:135], a[232:235], a[84:87]
    buffer_load_dwordx4 v[112:115], v2, s[56:59], s65 offen offset:0
    v_mfma_f32_16x16x32_bf16 a[84:87], v[128:131], a[236:239], a[84:87]
    v_mov_b32_dpp v253, v253 row_shr:1 row_mask:0xf bank_mask:0xf
    v_mfma_f32_16x16x32_bf16 a[16:19], v[236:239], a[208:211], a[16:19]
    v_mov_b32_dpp v254, v254 row_shr:1 row_mask:0xf bank_mask:0xf
    v_mfma_f32_16x16x32_bf16 a[16:19], v[136:139], a[212:215], a[16:19]
    v_mov_b32_dpp v255, v255 row_shr:1 row_mask:0xf bank_mask:0xf
    v_mfma_f32_16x16x32_bf16 a[16:19], v[72:75], a[216:219], a[16:19]
    s_waitcnt vmcnt(10)
    v_mfma_f32_16x16x32_bf16 a[16:19], v[84:87], a[220:223], a[16:19]
    buffer_load_dwordx4 v[120:123], v1, s[40:43], s66 offen offset:3072
    v_mfma_f32_16x16x32_bf16 a[48:51], v[84:87], a[224:227], a[48:51]
    v_cndmask_b32_dpp v252, v220, v252, vcc row_shl:4 row_mask:0xf bank_mask:0xf
    v_mfma_f32_16x16x32_bf16 a[48:51], v[72:75], a[228:231], a[48:51]
    v_cndmask_b32_dpp v253, v221, v253, vcc row_shl:4 row_mask:0xf bank_mask:0xf
    v_mfma_f32_16x16x32_bf16 a[48:51], v[136:139], a[232:235], a[48:51]
    v_cndmask_b32_dpp v254, v222, v254, vcc row_shl:4 row_mask:0xf bank_mask:0xf
    v_mfma_f32_16x16x32_bf16 a[48:51], v[236:239], a[236:239], a[48:51]
    v_cndmask_b32_dpp v255, v223, v255, vcc row_shl:4 row_mask:0xf bank_mask:0xf
    v_mfma_f32_16x16x32_bf16 a[48:51], v[132:135], a[208:211], a[48:51]
    buffer_load_dwordx4 a[108:111], v1, s[48:51], s64 offen offset:2048
    v_mfma_f32_16x16x32_bf16 a[48:51], v[140:143], a[212:215], a[48:51]
    v_mov_b32_dpp v232, v232 row_shr:1 row_mask:0xf bank_mask:0xf
    v_mfma_f32_16x16x32_bf16 a[48:51], v[76:79], a[216:219], a[48:51]
    s_waitcnt vmcnt(11)
    v_mfma_f32_16x16x32_bf16 a[48:51], v[80:83], a[220:223], a[48:51]
    v_mov_b32_dpp v233, v233 row_shr:1 row_mask:0xf bank_mask:0xf
    v_mfma_f32_16x16x32_bf16 a[80:83], v[80:83], a[224:227], a[80:83]
    v_mov_b32_dpp v234, v234 row_shr:1 row_mask:0xf bank_mask:0xf
    v_mfma_f32_16x16x32_bf16 a[80:83], v[76:79], a[228:231], a[80:83]
    buffer_load_dwordx4 v[104:107], v1, s[40:43], s66 offen offset:2048
    v_mfma_f32_16x16x32_bf16 a[80:83], v[140:143], a[232:235], a[80:83]
    v_mov_b32_dpp v235, v235 row_shr:1 row_mask:0xf bank_mask:0xf
    v_mfma_f32_16x16x32_bf16 a[80:83], v[132:135], a[236:239], a[80:83]
    v_cndmask_b32_dpp v232, v216, v232, vcc row_shl:3 row_mask:0xf bank_mask:0xf
    v_mfma_f32_16x16x32_bf16 a[12:15], v[136:139], a[208:211], a[12:15]
    v_cndmask_b32_dpp v233, v217, v233, vcc row_shl:3 row_mask:0xf bank_mask:0xf
    v_mfma_f32_16x16x32_bf16 a[12:15], v[72:75], a[212:215], a[12:15]
    v_cndmask_b32_dpp v234, v218, v234, vcc row_shl:3 row_mask:0xf bank_mask:0xf
    v_mfma_f32_16x16x32_bf16 a[12:15], v[84:87], a[216:219], a[12:15]
    buffer_load_dwordx4 a[104:107], v1, s[48:51], s64 offen offset:3072
    s_waitcnt vmcnt(12)
    v_mfma_f32_16x16x32_bf16 a[12:15], v[92:95], a[220:223], a[12:15]
    v_cndmask_b32_dpp v235, v219, v235, vcc row_shl:3 row_mask:0xf bank_mask:0xf
    v_mfma_f32_16x16x32_bf16 a[44:47], v[92:95], a[224:227], a[44:47]
    v_mov_b32_dpp v128, v128 row_shr:1 row_mask:0xf bank_mask:0xf
    v_mfma_f32_16x16x32_bf16 a[44:47], v[84:87], a[228:231], a[44:47]
    v_mov_b32_dpp v129, v129 row_shr:1 row_mask:0xf bank_mask:0xf
    v_mfma_f32_16x16x32_bf16 a[44:47], v[72:75], a[232:235], a[44:47]
    v_mov_b32_dpp v130, v130 row_shr:1 row_mask:0xf bank_mask:0xf
    v_mfma_f32_16x16x32_bf16 a[44:47], v[136:139], a[236:239], a[44:47]
    buffer_load_dwordx4 v[96:99], v1, s[40:43], s66 offen offset:1024
    v_mfma_f32_16x16x32_bf16 a[44:47], v[140:143], a[208:211], a[44:47]
    v_mov_b32_dpp v131, v131 row_shr:1 row_mask:0xf bank_mask:0xf
    v_mfma_f32_16x16x32_bf16 a[44:47], v[76:79], a[212:215], a[44:47]
    v_cndmask_b32_dpp v128, v220, v128, vcc row_shl:3 row_mask:0xf bank_mask:0xf
    v_mfma_f32_16x16x32_bf16 a[44:47], v[80:83], a[216:219], a[44:47]
    s_waitcnt vmcnt(12)
    v_mfma_f32_16x16x32_bf16 a[44:47], v[88:91], a[220:223], a[44:47]
    v_cndmask_b32_dpp v129, v221, v129, vcc row_shl:3 row_mask:0xf bank_mask:0xf
    v_mfma_f32_16x16x32_bf16 a[76:79], v[88:91], a[224:227], a[76:79]
    buffer_load_dwordx4 a[116:119], v1, s[48:51], s65 offen offset:0
    v_mfma_f32_16x16x32_bf16 a[76:79], v[80:83], a[228:231], a[76:79]
    v_cndmask_b32_dpp v130, v222, v130, vcc row_shl:3 row_mask:0xf bank_mask:0xf
    v_mfma_f32_16x16x32_bf16 a[76:79], v[76:79], a[232:235], a[76:79]
    v_cndmask_b32_dpp v131, v223, v131, vcc row_shl:3 row_mask:0xf bank_mask:0xf
    v_mfma_f32_16x16x32_bf16 a[76:79], v[140:143], a[236:239], a[76:79]
    v_mov_b32_dpp v236, v236 row_shr:1 row_mask:0xf bank_mask:0xf
    v_mfma_f32_16x16x32_bf16 a[8:11], v[72:75], a[208:211], a[8:11]
    v_mov_b32_dpp v237, v237 row_shr:1 row_mask:0xf bank_mask:0xf
    v_mfma_f32_16x16x32_bf16 a[8:11], v[84:87], a[212:215], a[8:11]
    buffer_load_dwordx4 v[116:119], v1, s[40:43], s66 offen offset:0
    v_mfma_f32_16x16x32_bf16 a[8:11], v[92:95], a[216:219], a[8:11]
    v_mov_b32_dpp v238, v238 row_shr:1 row_mask:0xf bank_mask:0xf
    v_mfma_f32_16x16x32_bf16 a[8:11], v[224:227], a[220:223], a[8:11]
    v_mov_b32_dpp v239, v239 row_shr:1 row_mask:0xf bank_mask:0xf
    v_mfma_f32_16x16x32_bf16 a[40:43], v[224:227], a[224:227], a[40:43]
    v_cndmask_b32_dpp v236, v216, v236, vcc row_shl:2 row_mask:0xf bank_mask:0xf
    v_mfma_f32_16x16x32_bf16 a[40:43], v[92:95], a[228:231], a[40:43]
    v_cndmask_b32_dpp v237, v217, v237, vcc row_shl:2 row_mask:0xf bank_mask:0xf
    v_mfma_f32_16x16x32_bf16 a[40:43], v[84:87], a[232:235], a[40:43]
    buffer_load_dwordx4 a[112:115], v1, s[48:51], s65 offen offset:1024
    v_mfma_f32_16x16x32_bf16 a[40:43], v[72:75], a[236:239], a[40:43]
    v_cndmask_b32_dpp v238, v218, v238, vcc row_shl:2 row_mask:0xf bank_mask:0xf
    v_mfma_f32_16x16x32_bf16 a[40:43], v[76:79], a[208:211], a[40:43]
    v_cndmask_b32_dpp v239, v219, v239, vcc row_shl:2 row_mask:0xf bank_mask:0xf
    v_mfma_f32_16x16x32_bf16 a[40:43], v[80:83], a[212:215], a[40:43]
    v_mov_b32_dpp v132, v132 row_shr:1 row_mask:0xf bank_mask:0xf
    v_mfma_f32_16x16x32_bf16 a[40:43], v[88:91], a[216:219], a[40:43]
    v_mov_b32_dpp v133, v133 row_shr:1 row_mask:0xf bank_mask:0xf
    v_mfma_f32_16x16x32_bf16 a[40:43], v[240:243], a[220:223], a[40:43]
    buffer_load_dwordx4 v[124:127], v1, s[40:43], s65 offen offset:3072
    v_mfma_f32_16x16x32_bf16 a[72:75], v[240:243], a[224:227], a[72:75]
    v_mov_b32_dpp v134, v134 row_shr:1 row_mask:0xf bank_mask:0xf
    v_mfma_f32_16x16x32_bf16 a[72:75], v[88:91], a[228:231], a[72:75]
    v_mov_b32_dpp v135, v135 row_shr:1 row_mask:0xf bank_mask:0xf
    v_mfma_f32_16x16x32_bf16 a[72:75], v[80:83], a[232:235], a[72:75]
    v_cndmask_b32_dpp v132, v220, v132, vcc row_shl:2 row_mask:0xf bank_mask:0xf
    v_mfma_f32_16x16x32_bf16 a[72:75], v[76:79], a[236:239], a[72:75]
    v_cndmask_b32_dpp v133, v221, v133, vcc row_shl:2 row_mask:0xf bank_mask:0xf
    v_mfma_f32_16x16x32_bf16 a[4:7], v[84:87], a[208:211], a[4:7]
    buffer_load_dwordx4 a[124:127], v1, s[48:51], s65 offen offset:2048
    v_mfma_f32_16x16x32_bf16 a[4:7], v[92:95], a[212:215], a[4:7]
    v_cndmask_b32_dpp v134, v222, v134, vcc row_shl:2 row_mask:0xf bank_mask:0xf
    v_mfma_f32_16x16x32_bf16 a[4:7], v[224:227], a[216:219], a[4:7]
    v_cndmask_b32_dpp v135, v223, v135, vcc row_shl:2 row_mask:0xf bank_mask:0xf
    v_mfma_f32_16x16x32_bf16 a[4:7], v[228:231], a[220:223], a[4:7]
    v_mfma_f32_16x16x32_bf16 a[36:39], v[228:231], a[224:227], a[36:39]
    v_mfma_f32_16x16x32_bf16 a[36:39], v[224:227], a[228:231], a[36:39]
    buffer_load_dwordx4 v[108:111], v1, s[40:43], s65 offen offset:2048
    v_mfma_f32_16x16x32_bf16 a[36:39], v[92:95], a[232:235], a[36:39]
    v_mfma_f32_16x16x32_bf16 a[36:39], v[84:87], a[236:239], a[36:39]
    v_mfma_f32_16x16x32_bf16 a[36:39], v[80:83], a[208:211], a[36:39]
    v_mfma_f32_16x16x32_bf16 a[36:39], v[88:91], a[212:215], a[36:39]
    v_mfma_f32_16x16x32_bf16 a[36:39], v[240:243], a[216:219], a[36:39]
    buffer_load_dwordx4 a[120:123], v1, s[48:51], s65 offen offset:3072
    v_mfma_f32_16x16x32_bf16 a[36:39], v[252:255], a[220:223], a[36:39]
    v_mfma_f32_16x16x32_bf16 a[68:71], v[252:255], a[224:227], a[68:71]
    v_mfma_f32_16x16x32_bf16 a[68:71], v[240:243], a[228:231], a[68:71]
    v_mfma_f32_16x16x32_bf16 a[68:71], v[88:91], a[232:235], a[68:71]
    v_mfma_f32_16x16x32_bf16 a[68:71], v[80:83], a[236:239], a[68:71]
    buffer_load_dwordx4 v[100:103], v1, s[40:43], s65 offen offset:1024
    v_mfma_f32_16x16x32_bf16 a[0:3], v[92:95], a[208:211], a[0:3]
    v_mfma_f32_16x16x32_bf16 a[0:3], v[224:227], a[212:215], a[0:3]
    v_mfma_f32_16x16x32_bf16 a[0:3], v[228:231], a[216:219], a[0:3]
    v_mfma_f32_16x16x32_bf16 a[0:3], v[232:235], a[220:223], a[0:3]
    v_mfma_f32_16x16x32_bf16 a[32:35], v[232:235], a[224:227], a[32:35]
    buffer_load_dwordx4 a[128:131], v1, s[48:51], s66 offen offset:0
    v_mfma_f32_16x16x32_bf16 a[32:35], v[228:231], a[228:231], a[32:35]
    v_mfma_f32_16x16x32_bf16 a[32:35], v[224:227], a[232:235], a[32:35]
    v_mfma_f32_16x16x32_bf16 a[32:35], v[92:95], a[236:239], a[32:35]
    v_mfma_f32_16x16x32_bf16 a[32:35], v[88:91], a[208:211], a[32:35]
    v_mfma_f32_16x16x32_bf16 a[32:35], v[240:243], a[212:215], a[32:35]
    buffer_load_dwordx4 v[172:175], v1, s[40:43], s65 offen offset:0
    v_mfma_f32_16x16x32_bf16 a[32:35], v[252:255], a[216:219], a[32:35]
    v_mfma_f32_16x16x32_bf16 a[32:35], v[128:131], a[220:223], a[32:35]
    v_mfma_f32_16x16x32_bf16 a[64:67], v[128:131], a[224:227], a[64:67]
    v_mfma_f32_16x16x32_bf16 a[64:67], v[252:255], a[228:231], a[64:67]
    v_mfma_f32_16x16x32_bf16 a[64:67], v[240:243], a[232:235], a[64:67]
    buffer_load_dwordx4 v[176:179], v2, s[56:59], s67 offen offset:0
    v_mfma_f32_16x16x32_bf16 a[64:67], v[88:91], a[236:239], a[64:67]
    s_waitcnt vmcnt(18)
    v_mfma_f32_16x16x32_bf16 a[28:31], v[136:139], a[240:243], a[28:31]
    v_mfma_f32_16x16x32_bf16 a[28:31], v[72:75], a[244:247], a[28:31]
    v_mfma_f32_16x16x32_bf16 a[28:31], v[84:87], a[248:251], a[28:31]
    v_mfma_f32_16x16x32_bf16 a[60:63], v[84:87], a[252:255], a[60:63]
    buffer_load_dwordx4 v[148:151], v1, s[40:43], s68 offen offset:3072
    v_mfma_f32_16x16x32_bf16 a[60:63], v[72:75], a[100:103], a[60:63]
    s_waitcnt vmcnt(18)
    v_mfma_f32_16x16x32_bf16 a[60:63], v[136:139], a[96:99], a[60:63]
    v_mov_b32_dpp v136, v136 row_shr:1 row_mask:0xf bank_mask:0xf
    v_mfma_f32_16x16x32_bf16 a[60:63], v[140:143], a[240:243], a[60:63]
    v_mov_b32_dpp v137, v137 row_shr:1 row_mask:0xf bank_mask:0xf
    v_mfma_f32_16x16x32_bf16 a[60:63], v[76:79], a[244:247], a[60:63]
    v_mov_b32_dpp v138, v138 row_shr:1 row_mask:0xf bank_mask:0xf
    v_mfma_f32_16x16x32_bf16 a[60:63], v[80:83], a[248:251], a[60:63]
    buffer_load_dwordx4 a[132:135], v1, s[48:51], s66 offen offset:1024
    v_mfma_f32_16x16x32_bf16 a[92:95], v[80:83], a[252:255], a[92:95]
    v_mov_b32_dpp v139, v139 row_shr:1 row_mask:0xf bank_mask:0xf
    v_mfma_f32_16x16x32_bf16 a[92:95], v[76:79], a[100:103], a[92:95]
    v_cndmask_b32_dpp v136, v216, v136, vcc row_shl:1 row_mask:0xf bank_mask:0xf
    v_mfma_f32_16x16x32_bf16 a[92:95], v[140:143], a[96:99], a[92:95]
    v_cndmask_b32_dpp v137, v217, v137, vcc row_shl:1 row_mask:0xf bank_mask:0xf
    v_mfma_f32_16x16x32_bf16 a[24:27], v[72:75], a[240:243], a[24:27]
    v_cndmask_b32_dpp v138, v218, v138, vcc row_shl:1 row_mask:0xf bank_mask:0xf
    v_mfma_f32_16x16x32_bf16 a[24:27], v[84:87], a[244:247], a[24:27]
    buffer_load_dwordx4 v[152:155], v1, s[40:43], s68 offen offset:2048
    v_mfma_f32_16x16x32_bf16 a[24:27], v[92:95], a[248:251], a[24:27]
    v_cndmask_b32_dpp v139, v219, v139, vcc row_shl:1 row_mask:0xf bank_mask:0xf
    v_mfma_f32_16x16x32_bf16 a[56:59], v[92:95], a[252:255], a[56:59]
    v_mov_b32_dpp v140, v140 row_shr:1 row_mask:0xf bank_mask:0xf
    v_mfma_f32_16x16x32_bf16 a[56:59], v[84:87], a[100:103], a[56:59]
    v_mov_b32_dpp v141, v141 row_shr:1 row_mask:0xf bank_mask:0xf
    v_mfma_f32_16x16x32_bf16 a[56:59], v[72:75], a[96:99], a[56:59]
    v_mov_b32_dpp v142, v142 row_shr:1 row_mask:0xf bank_mask:0xf
    v_mfma_f32_16x16x32_bf16 a[56:59], v[76:79], a[240:243], a[56:59]
    buffer_load_dwordx4 a[136:139], v1, s[48:51], s66 offen offset:2048
    v_mfma_f32_16x16x32_bf16 a[56:59], v[80:83], a[244:247], a[56:59]
    v_mov_b32_dpp v143, v143 row_shr:1 row_mask:0xf bank_mask:0xf
    v_mfma_f32_16x16x32_bf16 a[56:59], v[88:91], a[248:251], a[56:59]
    v_cndmask_b32_dpp v140, v220, v140, vcc row_shl:1 row_mask:0xf bank_mask:0xf
    v_mfma_f32_16x16x32_bf16 a[88:91], v[88:91], a[252:255], a[88:91]
    v_cndmask_b32_dpp v141, v221, v141, vcc row_shl:1 row_mask:0xf bank_mask:0xf
    v_mfma_f32_16x16x32_bf16 a[88:91], v[80:83], a[100:103], a[88:91]
    v_cndmask_b32_dpp v142, v222, v142, vcc row_shl:1 row_mask:0xf bank_mask:0xf
    v_mfma_f32_16x16x32_bf16 a[88:91], v[76:79], a[96:99], a[88:91]
    buffer_load_dwordx4 v[156:159], v1, s[40:43], s68 offen offset:1024
    v_mfma_f32_16x16x32_bf16 a[20:23], v[84:87], a[240:243], a[20:23]
    v_cndmask_b32_dpp v143, v223, v143, vcc row_shl:1 row_mask:0xf bank_mask:0xf
    v_mfma_f32_16x16x32_bf16 a[20:23], v[92:95], a[244:247], a[20:23]
    v_mov_b32_dpp v72, v72 row_shr:1 row_mask:0xf bank_mask:0xf
    v_mfma_f32_16x16x32_bf16 a[20:23], v[224:227], a[248:251], a[20:23]
    v_mov_b32_dpp v73, v73 row_shr:1 row_mask:0xf bank_mask:0xf
    v_mfma_f32_16x16x32_bf16 a[52:55], v[224:227], a[252:255], a[52:55]
    v_mov_b32_dpp v74, v74 row_shr:1 row_mask:0xf bank_mask:0xf
    v_mfma_f32_16x16x32_bf16 a[52:55], v[92:95], a[100:103], a[52:55]
    buffer_load_dwordx4 a[140:143], v1, s[48:51], s66 offen offset:3072
    v_mfma_f32_16x16x32_bf16 a[52:55], v[84:87], a[96:99], a[52:55]
    v_mov_b32_dpp v75, v75 row_shr:1 row_mask:0xf bank_mask:0xf
    v_mfma_f32_16x16x32_bf16 a[52:55], v[80:83], a[240:243], a[52:55]
    v_cndmask_b32 v72, v216, v72, vcc
    v_mfma_f32_16x16x32_bf16 a[52:55], v[88:91], a[244:247], a[52:55]
    v_cndmask_b32 v73, v217, v73, vcc
    v_mfma_f32_16x16x32_bf16 a[52:55], v[240:243], a[248:251], a[52:55]
    v_cndmask_b32 v74, v218, v74, vcc
    v_mfma_f32_16x16x32_bf16 a[84:87], v[240:243], a[252:255], a[84:87]
    buffer_load_dwordx4 v[160:163], v1, s[40:43], s68 offen offset:0
    v_mfma_f32_16x16x32_bf16 a[84:87], v[88:91], a[100:103], a[84:87]
    v_cndmask_b32 v75, v219, v75, vcc
    v_mfma_f32_16x16x32_bf16 a[84:87], v[80:83], a[96:99], a[84:87]
    v_mov_b32_dpp v76, v76 row_shr:1 row_mask:0xf bank_mask:0xf
    v_mfma_f32_16x16x32_bf16 a[16:19], v[92:95], a[240:243], a[16:19]
    v_mov_b32_dpp v77, v77 row_shr:1 row_mask:0xf bank_mask:0xf
    v_mfma_f32_16x16x32_bf16 a[16:19], v[224:227], a[244:247], a[16:19]
    v_mov_b32_dpp v78, v78 row_shr:1 row_mask:0xf bank_mask:0xf
    v_mfma_f32_16x16x32_bf16 a[16:19], v[228:231], a[248:251], a[16:19]
    buffer_load_dwordx4 a[144:147], v1, s[48:51], s67 offen offset:0
    v_mfma_f32_16x16x32_bf16 a[48:51], v[228:231], a[252:255], a[48:51]
    v_mov_b32_dpp v79, v79 row_shr:1 row_mask:0xf bank_mask:0xf
    v_mfma_f32_16x16x32_bf16 a[48:51], v[224:227], a[100:103], a[48:51]
    v_cndmask_b32 v76, v220, v76, vcc
    v_mfma_f32_16x16x32_bf16 a[48:51], v[92:95], a[96:99], a[48:51]
    v_cndmask_b32 v77, v221, v77, vcc
    v_mfma_f32_16x16x32_bf16 a[48:51], v[88:91], a[240:243], a[48:51]
    v_cndmask_b32 v78, v222, v78, vcc
    v_mfma_f32_16x16x32_bf16 a[48:51], v[240:243], a[244:247], a[48:51]
    buffer_load_dwordx4 v[164:167], v1, s[40:43], s67 offen offset:3072
    v_mfma_f32_16x16x32_bf16 a[48:51], v[252:255], a[248:251], a[48:51]
    v_cndmask_b32 v79, v223, v79, vcc
    v_mfma_f32_16x16x32_bf16 a[80:83], v[252:255], a[252:255], a[80:83]
    v_mfma_f32_16x16x32_bf16 a[80:83], v[240:243], a[100:103], a[80:83]
    v_mfma_f32_16x16x32_bf16 a[80:83], v[88:91], a[96:99], a[80:83]
    v_mfma_f32_16x16x32_bf16 a[12:15], v[224:227], a[240:243], a[12:15]
    buffer_load_dwordx4 a[148:151], v1, s[48:51], s67 offen offset:1024
    v_mfma_f32_16x16x32_bf16 a[12:15], v[228:231], a[244:247], a[12:15]
    v_mfma_f32_16x16x32_bf16 a[12:15], v[232:235], a[248:251], a[12:15]
    v_mfma_f32_16x16x32_bf16 a[44:47], v[232:235], a[252:255], a[44:47]
    v_mfma_f32_16x16x32_bf16 a[44:47], v[228:231], a[100:103], a[44:47]
    v_mfma_f32_16x16x32_bf16 a[44:47], v[224:227], a[96:99], a[44:47]
    buffer_load_dwordx4 v[144:147], v1, s[40:43], s67 offen offset:2048
    v_mfma_f32_16x16x32_bf16 a[44:47], v[240:243], a[240:243], a[44:47]
    v_mfma_f32_16x16x32_bf16 a[44:47], v[252:255], a[244:247], a[44:47]
    v_mfma_f32_16x16x32_bf16 a[44:47], v[128:131], a[248:251], a[44:47]
    v_mfma_f32_16x16x32_bf16 a[76:79], v[128:131], a[252:255], a[76:79]
    v_mfma_f32_16x16x32_bf16 a[76:79], v[252:255], a[100:103], a[76:79]
    buffer_load_dwordx4 a[152:155], v1, s[48:51], s67 offen offset:2048
    v_mfma_f32_16x16x32_bf16 a[76:79], v[240:243], a[96:99], a[76:79]
    v_mfma_f32_16x16x32_bf16 a[8:11], v[228:231], a[240:243], a[8:11]
    v_mfma_f32_16x16x32_bf16 a[8:11], v[232:235], a[244:247], a[8:11]
    v_mfma_f32_16x16x32_bf16 a[8:11], v[236:239], a[248:251], a[8:11]
    v_mfma_f32_16x16x32_bf16 a[40:43], v[236:239], a[252:255], a[40:43]
    buffer_load_dwordx4 v[168:171], v1, s[40:43], s67 offen offset:1024
    v_mfma_f32_16x16x32_bf16 a[40:43], v[232:235], a[100:103], a[40:43]
    v_mfma_f32_16x16x32_bf16 a[40:43], v[228:231], a[96:99], a[40:43]
    v_mfma_f32_16x16x32_bf16 a[40:43], v[252:255], a[240:243], a[40:43]
    v_mfma_f32_16x16x32_bf16 a[40:43], v[128:131], a[244:247], a[40:43]
    v_mfma_f32_16x16x32_bf16 a[40:43], v[132:135], a[248:251], a[40:43]
    buffer_load_dwordx4 a[156:159], v1, s[48:51], s67 offen offset:3072
    v_mfma_f32_16x16x32_bf16 a[72:75], v[132:135], a[252:255], a[72:75]
    v_mfma_f32_16x16x32_bf16 a[72:75], v[128:131], a[100:103], a[72:75]
    v_mfma_f32_16x16x32_bf16 a[72:75], v[252:255], a[96:99], a[72:75]
    v_mfma_f32_16x16x32_bf16 a[4:7], v[232:235], a[240:243], a[4:7]
    v_mfma_f32_16x16x32_bf16 a[4:7], v[236:239], a[244:247], a[4:7]
    buffer_load_dwordx4 v[208:211], v1, s[40:43], s67 offen offset:0
    v_mfma_f32_16x16x32_bf16 a[4:7], v[136:139], a[248:251], a[4:7]
    v_mfma_f32_16x16x32_bf16 a[36:39], v[136:139], a[252:255], a[36:39]
    v_mfma_f32_16x16x32_bf16 a[36:39], v[236:239], a[100:103], a[36:39]
    v_mfma_f32_16x16x32_bf16 a[36:39], v[232:235], a[96:99], a[36:39]
    v_mfma_f32_16x16x32_bf16 a[36:39], v[128:131], a[240:243], a[36:39]
    buffer_load_dwordx4 v[212:215], v2, s[60:63], 0 offen offset:0
    v_mfma_f32_16x16x32_bf16 a[36:39], v[132:135], a[244:247], a[36:39]
    v_mfma_f32_16x16x32_bf16 a[36:39], v[140:143], a[248:251], a[36:39]
    v_mfma_f32_16x16x32_bf16 a[68:71], v[140:143], a[252:255], a[68:71]
    v_mfma_f32_16x16x32_bf16 a[68:71], v[132:135], a[100:103], a[68:71]
    v_mfma_f32_16x16x32_bf16 a[68:71], v[128:131], a[96:99], a[68:71]
    buffer_load_dwordx4 v[184:187], v2, s[60:63], s26 offen offset:0
    v_mfma_f32_16x16x32_bf16 a[0:3], v[236:239], a[240:243], a[0:3]
    v_mfma_f32_16x16x32_bf16 a[0:3], v[136:139], a[244:247], a[0:3]
    v_mfma_f32_16x16x32_bf16 a[0:3], v[72:75], a[248:251], a[0:3]
    v_mfma_f32_16x16x32_bf16 a[32:35], v[72:75], a[252:255], a[32:35]
    v_mfma_f32_16x16x32_bf16 a[32:35], v[136:139], a[100:103], a[32:35]
    buffer_load_dwordx4 v[188:191], v1, s[44:47], s25 offen offset:3072
    v_mfma_f32_16x16x32_bf16 a[32:35], v[236:239], a[96:99], a[32:35]
    v_mfma_f32_16x16x32_bf16 a[32:35], v[132:135], a[240:243], a[32:35]
    v_mfma_f32_16x16x32_bf16 a[32:35], v[140:143], a[244:247], a[32:35]
    v_mfma_f32_16x16x32_bf16 a[32:35], v[76:79], a[248:251], a[32:35]
    v_mfma_f32_16x16x32_bf16 a[64:67], v[76:79], a[252:255], a[64:67]
    buffer_load_dwordx4 a[160:163], v1, s[52:55], 0 offen offset:0
    v_mfma_f32_16x16x32_bf16 a[64:67], v[140:143], a[100:103], a[64:67]
    v_mfma_f32_16x16x32_bf16 a[64:67], v[132:135], a[96:99], a[64:67]
    s_waitcnt vmcnt(18)
    v_mfma_f32_16x16x32_bf16 v[36:39], v[120:123], a[108:111], v[36:39]
    v_mov_b32_dpp v120, v120 row_shr:1 row_mask:0xf bank_mask:0xf
    v_mov_b32_dpp v121, v121 row_shr:1 row_mask:0xf bank_mask:0xf
    v_mfma_f32_16x16x32_bf16 v[36:39], v[104:107], a[104:107], v[36:39]
    v_mov_b32_dpp v122, v122 row_shr:1 row_mask:0xf bank_mask:0xf
    v_mov_b32_dpp v123, v123 row_shr:1 row_mask:0xf bank_mask:0xf
    v_mfma_f32_16x16x32_bf16 v[36:39], v[96:99], a[116:119], v[36:39]
    buffer_load_dwordx4 v[192:195], v1, s[44:47], s25 offen offset:2048
    v_cndmask_b32_dpp v120, v112, v120, vcc row_shl:5 row_mask:0xf bank_mask:0xf
    v_mfma_f32_16x16x32_bf16 v[36:39], v[116:119], a[112:115], v[36:39]
    v_cndmask_b32_dpp v121, v113, v121, vcc row_shl:5 row_mask:0xf bank_mask:0xf
    v_cndmask_b32_dpp v122, v114, v122, vcc row_shl:5 row_mask:0xf bank_mask:0xf
    v_mfma_f32_16x16x32_bf16 v[36:39], v[124:127], a[124:127], v[36:39]
    v_cndmask_b32_dpp v123, v115, v123, vcc row_shl:5 row_mask:0xf bank_mask:0xf
    v_mfma_f32_16x16x32_bf16 v[36:39], v[108:111], a[120:123], v[36:39]
    v_mfma_f32_16x16x32_bf16 v[36:39], v[100:103], a[128:131], v[36:39]
    v_mfma_f32_16x16x32_bf16 v[32:35], v[104:107], a[108:111], v[32:35]
    buffer_load_dwordx4 a[164:167], v1, s[52:55], 0 offen offset:1024
    v_mov_b32_dpp v104, v104 row_shr:1 row_mask:0xf bank_mask:0xf
    v_mfma_f32_16x16x32_bf16 v[32:35], v[96:99], a[104:107], v[32:35]
    v_mov_b32_dpp v105, v105 row_shr:1 row_mask:0xf bank_mask:0xf
    v_mov_b32_dpp v106, v106 row_shr:1 row_mask:0xf bank_mask:0xf
    v_mfma_f32_16x16x32_bf16 v[32:35], v[116:119], a[116:119], v[32:35]
    v_mov_b32_dpp v107, v107 row_shr:1 row_mask:0xf bank_mask:0xf
    v_cndmask_b32_dpp v104, v112, v104, vcc row_shl:4 row_mask:0xf bank_mask:0xf
    v_mfma_f32_16x16x32_bf16 v[32:35], v[124:127], a[112:115], v[32:35]
    v_cndmask_b32_dpp v105, v113, v105, vcc row_shl:4 row_mask:0xf bank_mask:0xf
    v_cndmask_b32_dpp v106, v114, v106, vcc row_shl:4 row_mask:0xf bank_mask:0xf
    v_mfma_f32_16x16x32_bf16 v[32:35], v[108:111], a[124:127], v[32:35]
    v_cndmask_b32_dpp v107, v115, v107, vcc row_shl:4 row_mask:0xf bank_mask:0xf
    v_mfma_f32_16x16x32_bf16 v[32:35], v[100:103], a[120:123], v[32:35]
    buffer_load_dwordx4 v[196:199], v1, s[44:47], s25 offen offset:1024
    v_mfma_f32_16x16x32_bf16 v[32:35], v[172:175], a[128:131], v[32:35]
    v_mfma_f32_16x16x32_bf16 v[28:31], v[96:99], a[108:111], v[28:31]
    v_mov_b32_dpp v96, v96 row_shr:1 row_mask:0xf bank_mask:0xf
    v_mov_b32_dpp v97, v97 row_shr:1 row_mask:0xf bank_mask:0xf
    v_mfma_f32_16x16x32_bf16 v[28:31], v[116:119], a[104:107], v[28:31]
    v_mov_b32_dpp v98, v98 row_shr:1 row_mask:0xf bank_mask:0xf
    v_mov_b32_dpp v99, v99 row_shr:1 row_mask:0xf bank_mask:0xf
    v_mfma_f32_16x16x32_bf16 v[28:31], v[124:127], a[116:119], v[28:31]
    v_cndmask_b32_dpp v96, v112, v96, vcc row_shl:3 row_mask:0xf bank_mask:0xf
    v_cndmask_b32_dpp v97, v113, v97, vcc row_shl:3 row_mask:0xf bank_mask:0xf
    v_mfma_f32_16x16x32_bf16 v[28:31], v[108:111], a[112:115], v[28:31]
    buffer_load_dwordx4 a[168:171], v1, s[52:55], 0 offen offset:2048
    v_mfma_f32_16x16x32_bf16 v[28:31], v[100:103], a[124:127], v[28:31]
    v_cndmask_b32_dpp v98, v114, v98, vcc row_shl:3 row_mask:0xf bank_mask:0xf
    v_mfma_f32_16x16x32_bf16 v[28:31], v[172:175], a[120:123], v[28:31]
    v_cndmask_b32_dpp v99, v115, v99, vcc row_shl:3 row_mask:0xf bank_mask:0xf
    v_mfma_f32_16x16x32_bf16 v[28:31], v[120:123], a[128:131], v[28:31]
    v_mfma_f32_16x16x32_bf16 v[24:27], v[116:119], a[108:111], v[24:27]
    v_mov_b32_dpp v116, v116 row_shr:1 row_mask:0xf bank_mask:0xf
    v_mov_b32_dpp v117, v117 row_shr:1 row_mask:0xf bank_mask:0xf
    v_mfma_f32_16x16x32_bf16 v[24:27], v[124:127], a[104:107], v[24:27]
    buffer_load_dwordx4 v[200:203], v1, s[44:47], s25 offen offset:0
    v_mfma_f32_16x16x32_bf16 v[24:27], v[108:111], a[116:119], v[24:27]
    v_mov_b32_dpp v118, v118 row_shr:1 row_mask:0xf bank_mask:0xf
    v_mfma_f32_16x16x32_bf16 v[24:27], v[100:103], a[112:115], v[24:27]
    v_mov_b32_dpp v119, v119 row_shr:1 row_mask:0xf bank_mask:0xf
    v_mfma_f32_16x16x32_bf16 v[24:27], v[172:175], a[124:127], v[24:27]
    v_cndmask_b32_dpp v116, v112, v116, vcc row_shl:2 row_mask:0xf bank_mask:0xf
    v_mfma_f32_16x16x32_bf16 v[24:27], v[120:123], a[120:123], v[24:27]
    v_cndmask_b32_dpp v117, v113, v117, vcc row_shl:2 row_mask:0xf bank_mask:0xf
    v_mfma_f32_16x16x32_bf16 v[24:27], v[104:107], a[128:131], v[24:27]
    buffer_load_dwordx4 a[172:175], v1, s[52:55], 0 offen offset:3072
    v_mfma_f32_16x16x32_bf16 v[20:23], v[124:127], a[108:111], v[20:23]
    v_cndmask_b32_dpp v118, v114, v118, vcc row_shl:2 row_mask:0xf bank_mask:0xf
    v_mfma_f32_16x16x32_bf16 v[20:23], v[108:111], a[104:107], v[20:23]
    v_cndmask_b32_dpp v119, v115, v119, vcc row_shl:2 row_mask:0xf bank_mask:0xf
    v_mfma_f32_16x16x32_bf16 v[20:23], v[100:103], a[116:119], v[20:23]
    v_mov_b32_dpp v124, v124 row_shr:1 row_mask:0xf bank_mask:0xf
    v_mov_b32_dpp v125, v125 row_shr:1 row_mask:0xf bank_mask:0xf
    v_mfma_f32_16x16x32_bf16 v[20:23], v[172:175], a[112:115], v[20:23]
    v_mov_b32_dpp v126, v126 row_shr:1 row_mask:0xf bank_mask:0xf
    v_mfma_f32_16x16x32_bf16 v[20:23], v[120:123], a[124:127], v[20:23]
    buffer_load_dwordx4 a[176:179], v1, s[52:55], s26 offen offset:2048
    v_mfma_f32_16x16x32_bf16 v[20:23], v[104:107], a[120:123], v[20:23]
    v_mov_b32_dpp v127, v127 row_shr:1 row_mask:0xf bank_mask:0xf
    v_mfma_f32_16x16x32_bf16 v[20:23], v[96:99], a[128:131], v[20:23]
    v_cndmask_b32_dpp v124, v112, v124, vcc row_shl:1 row_mask:0xf bank_mask:0xf
    v_mfma_f32_16x16x32_bf16 v[16:19], v[108:111], a[108:111], v[16:19]
    v_cndmask_b32_dpp v125, v113, v125, vcc row_shl:1 row_mask:0xf bank_mask:0xf
    v_mfma_f32_16x16x32_bf16 v[16:19], v[100:103], a[104:107], v[16:19]
    v_cndmask_b32_dpp v126, v114, v126, vcc row_shl:1 row_mask:0xf bank_mask:0xf
    v_mfma_f32_16x16x32_bf16 v[16:19], v[172:175], a[116:119], v[16:19]
    buffer_load_dwordx4 a[180:183], v1, s[52:55], s26 offen offset:1024
    v_cndmask_b32_dpp v127, v115, v127, vcc row_shl:1 row_mask:0xf bank_mask:0xf
    v_mfma_f32_16x16x32_bf16 v[16:19], v[120:123], a[112:115], v[16:19]
    v_mov_b32_dpp v108, v108 row_shr:1 row_mask:0xf bank_mask:0xf
    v_mov_b32_dpp v109, v109 row_shr:1 row_mask:0xf bank_mask:0xf
    v_mfma_f32_16x16x32_bf16 v[16:19], v[104:107], a[124:127], v[16:19]
    v_mov_b32_dpp v110, v110 row_shr:1 row_mask:0xf bank_mask:0xf
    v_mfma_f32_16x16x32_bf16 v[16:19], v[96:99], a[120:123], v[16:19]
    v_mov_b32_dpp v111, v111 row_shr:1 row_mask:0xf bank_mask:0xf
    v_mfma_f32_16x16x32_bf16 v[16:19], v[116:119], a[128:131], v[16:19]
    v_cndmask_b32 v108, v112, v108, vcc
    v_mfma_f32_16x16x32_bf16 v[12:15], v[100:103], a[108:111], v[12:15]
    buffer_load_dwordx4 a[184:187], v1, s[52:55], s26 offen offset:0
    v_mfma_f32_16x16x32_bf16 v[12:15], v[172:175], a[104:107], v[12:15]
    v_cndmask_b32 v109, v113, v109, vcc
    v_mfma_f32_16x16x32_bf16 v[12:15], v[120:123], a[116:119], v[12:15]
    v_cndmask_b32 v110, v114, v110, vcc
    v_cndmask_b32 v111, v115, v111, vcc
    v_mfma_f32_16x16x32_bf16 v[12:15], v[104:107], a[112:115], v[12:15]
    v_mfma_f32_16x16x32_bf16 v[12:15], v[96:99], a[124:127], v[12:15]
    v_mfma_f32_16x16x32_bf16 v[12:15], v[116:119], a[120:123], v[12:15]
    buffer_load_dwordx4 a[188:191], v1, s[52:55], s25 offen offset:3072
    v_mfma_f32_16x16x32_bf16 v[12:15], v[124:127], a[128:131], v[12:15]
    v_mfma_f32_16x16x32_bf16 v[8:11], v[172:175], a[108:111], v[8:11]
    v_mfma_f32_16x16x32_bf16 v[8:11], v[120:123], a[104:107], v[8:11]
    v_mfma_f32_16x16x32_bf16 v[8:11], v[104:107], a[116:119], v[8:11]
    v_mfma_f32_16x16x32_bf16 v[8:11], v[96:99], a[112:115], v[8:11]
    buffer_load_dwordx4 v[180:183], v1, s[44:47], s64 offen offset:3072
    v_mfma_f32_16x16x32_bf16 v[8:11], v[116:119], a[124:127], v[8:11]
    v_mfma_f32_16x16x32_bf16 v[8:11], v[124:127], a[120:123], v[8:11]
    v_mfma_f32_16x16x32_bf16 v[8:11], v[108:111], a[128:131], v[8:11]
    s_waitcnt vmcnt(18)
    v_mfma_f32_16x16x32_bf16 v[68:71], v[148:151], a[132:135], v[68:71]
    v_mov_b32_dpp v148, v148 row_shr:1 row_mask:0xf bank_mask:0xf
    v_mov_b32_dpp v149, v149 row_shr:1 row_mask:0xf bank_mask:0xf
    v_mfma_f32_16x16x32_bf16 v[68:71], v[152:155], a[136:139], v[68:71]
    buffer_load_dwordx4 v[204:207], v1, s[44:47], s64 offen offset:2048
    v_mov_b32_dpp v150, v150 row_shr:1 row_mask:0xf bank_mask:0xf
    v_mfma_f32_16x16x32_bf16 v[68:71], v[156:159], a[140:143], v[68:71]
    v_mov_b32_dpp v151, v151 row_shr:1 row_mask:0xf bank_mask:0xf
    v_cndmask_b32_dpp v148, v176, v148, vcc row_shl:5 row_mask:0xf bank_mask:0xf
    v_mfma_f32_16x16x32_bf16 v[68:71], v[160:163], a[144:147], v[68:71]
    v_cndmask_b32_dpp v149, v177, v149, vcc row_shl:5 row_mask:0xf bank_mask:0xf
    v_cndmask_b32_dpp v150, v178, v150, vcc row_shl:5 row_mask:0xf bank_mask:0xf
    v_mfma_f32_16x16x32_bf16 v[68:71], v[164:167], a[148:151], v[68:71]
    v_cndmask_b32_dpp v151, v179, v151, vcc row_shl:5 row_mask:0xf bank_mask:0xf
    v_mfma_f32_16x16x32_bf16 v[68:71], v[144:147], a[152:155], v[68:71]
    s_waitcnt vmcnt(17)
    v_mfma_f32_16x16x32_bf16 v[68:71], v[168:171], a[156:159], v[68:71]
    buffer_load_dwordx4 v[84:87], v1, s[44:47], s64 offen offset:1024
    v_mfma_f32_16x16x32_bf16 v[64:67], v[152:155], a[132:135], v[64:67]
    v_mov_b32_dpp v152, v152 row_shr:1 row_mask:0xf bank_mask:0xf
    v_mov_b32_dpp v153, v153 row_shr:1 row_mask:0xf bank_mask:0xf
    v_mfma_f32_16x16x32_bf16 v[64:67], v[156:159], a[136:139], v[64:67]
    v_mov_b32_dpp v154, v154 row_shr:1 row_mask:0xf bank_mask:0xf
    v_mov_b32_dpp v155, v155 row_shr:1 row_mask:0xf bank_mask:0xf
    v_mfma_f32_16x16x32_bf16 v[64:67], v[160:163], a[140:143], v[64:67]
    v_cndmask_b32_dpp v152, v176, v152, vcc row_shl:4 row_mask:0xf bank_mask:0xf
    v_cndmask_b32_dpp v153, v177, v153, vcc row_shl:4 row_mask:0xf bank_mask:0xf
    v_mfma_f32_16x16x32_bf16 v[64:67], v[164:167], a[144:147], v[64:67]
    v_cndmask_b32_dpp v154, v178, v154, vcc row_shl:4 row_mask:0xf bank_mask:0xf
    v_cndmask_b32_dpp v155, v179, v155, vcc row_shl:4 row_mask:0xf bank_mask:0xf
    v_mfma_f32_16x16x32_bf16 v[64:67], v[144:147], a[148:151], v[64:67]
    buffer_load_dwordx4 v[80:83], v1, s[44:47], s64 offen offset:0
    v_mfma_f32_16x16x32_bf16 v[64:67], v[168:171], a[152:155], v[64:67]
    s_waitcnt vmcnt(18)
    v_mfma_f32_16x16x32_bf16 v[64:67], v[208:211], a[156:159], v[64:67]
    v_mfma_f32_16x16x32_bf16 v[60:63], v[156:159], a[132:135], v[60:63]
    v_mov_b32_dpp v156, v156 row_shr:1 row_mask:0xf bank_mask:0xf
    v_mov_b32_dpp v157, v157 row_shr:1 row_mask:0xf bank_mask:0xf
    v_mfma_f32_16x16x32_bf16 v[60:63], v[160:163], a[136:139], v[60:63]
    v_mov_b32_dpp v158, v158 row_shr:1 row_mask:0xf bank_mask:0xf
    v_mov_b32_dpp v159, v159 row_shr:1 row_mask:0xf bank_mask:0xf
    v_mfma_f32_16x16x32_bf16 v[60:63], v[164:167], a[140:143], v[60:63]
    buffer_load_dwordx4 v[92:95], v1, s[44:47], 0 offen offset:3072
    v_cndmask_b32_dpp v156, v176, v156, vcc row_shl:3 row_mask:0xf bank_mask:0xf
    v_mfma_f32_16x16x32_bf16 v[60:63], v[144:147], a[144:147], v[60:63]
    v_cndmask_b32_dpp v157, v177, v157, vcc row_shl:3 row_mask:0xf bank_mask:0xf
    v_cndmask_b32_dpp v158, v178, v158, vcc row_shl:3 row_mask:0xf bank_mask:0xf
    v_mfma_f32_16x16x32_bf16 v[60:63], v[168:171], a[148:151], v[60:63]
    v_cndmask_b32_dpp v159, v179, v159, vcc row_shl:3 row_mask:0xf bank_mask:0xf
    v_mfma_f32_16x16x32_bf16 v[60:63], v[208:211], a[152:155], v[60:63]
    v_mfma_f32_16x16x32_bf16 v[60:63], v[148:151], a[156:159], v[60:63]
    v_mfma_f32_16x16x32_bf16 v[56:59], v[160:163], a[132:135], v[56:59]
    buffer_load_dwordx4 v[88:91], v1, s[44:47], s26 offen offset:3072
    v_mov_b32_dpp v160, v160 row_shr:1 row_mask:0xf bank_mask:0xf
    v_mfma_f32_16x16x32_bf16 v[56:59], v[164:167], a[136:139], v[56:59]
    v_mov_b32_dpp v161, v161 row_shr:1 row_mask:0xf bank_mask:0xf
    v_mov_b32_dpp v162, v162 row_shr:1 row_mask:0xf bank_mask:0xf
    v_mfma_f32_16x16x32_bf16 v[56:59], v[144:147], a[140:143], v[56:59]
    v_mov_b32_dpp v163, v163 row_shr:1 row_mask:0xf bank_mask:0xf
    v_mfma_f32_16x16x32_bf16 v[56:59], v[168:171], a[144:147], v[56:59]
    v_cndmask_b32_dpp v160, v176, v160, vcc row_shl:2 row_mask:0xf bank_mask:0xf
    v_mfma_f32_16x16x32_bf16 v[56:59], v[208:211], a[148:151], v[56:59]
    v_cndmask_b32_dpp v161, v177, v161, vcc row_shl:2 row_mask:0xf bank_mask:0xf
    v_mfma_f32_16x16x32_bf16 v[56:59], v[148:151], a[152:155], v[56:59]
    buffer_load_dwordx4 v[224:227], v1, s[44:47], 0 offen offset:2048
    v_mfma_f32_16x16x32_bf16 v[56:59], v[152:155], a[156:159], v[56:59]
    v_cndmask_b32_dpp v162, v178, v162, vcc row_shl:2 row_mask:0xf bank_mask:0xf
    v_mfma_f32_16x16x32_bf16 v[52:55], v[164:167], a[132:135], v[52:55]
    v_cndmask_b32_dpp v163, v179, v163, vcc row_shl:2 row_mask:0xf bank_mask:0xf
    v_mfma_f32_16x16x32_bf16 v[52:55], v[144:147], a[136:139], v[52:55]
    v_mov_b32_dpp v164, v164 row_shr:1 row_mask:0xf bank_mask:0xf
    v_mfma_f32_16x16x32_bf16 v[52:55], v[168:171], a[140:143], v[52:55]
    v_mov_b32_dpp v165, v165 row_shr:1 row_mask:0xf bank_mask:0xf
    v_mfma_f32_16x16x32_bf16 v[52:55], v[208:211], a[144:147], v[52:55]
    buffer_load_dwordx4 v[228:231], v1, s[44:47], s26 offen offset:2048
    v_mfma_f32_16x16x32_bf16 v[52:55], v[148:151], a[148:151], v[52:55]
    v_mov_b32_dpp v166, v166 row_shr:1 row_mask:0xf bank_mask:0xf
    v_mfma_f32_16x16x32_bf16 v[52:55], v[152:155], a[152:155], v[52:55]
    v_mov_b32_dpp v167, v167 row_shr:1 row_mask:0xf bank_mask:0xf
    v_mfma_f32_16x16x32_bf16 v[52:55], v[156:159], a[156:159], v[52:55]
    v_cndmask_b32_dpp v164, v176, v164, vcc row_shl:1 row_mask:0xf bank_mask:0xf
    v_mfma_f32_16x16x32_bf16 v[48:51], v[144:147], a[132:135], v[48:51]
    v_cndmask_b32_dpp v165, v177, v165, vcc row_shl:1 row_mask:0xf bank_mask:0xf
    v_mfma_f32_16x16x32_bf16 v[48:51], v[168:171], a[136:139], v[48:51]
    buffer_load_dwordx4 v[128:131], v1, s[44:47], 0 offen offset:1024
    v_mfma_f32_16x16x32_bf16 v[48:51], v[208:211], a[140:143], v[48:51]
    v_cndmask_b32_dpp v166, v178, v166, vcc row_shl:1 row_mask:0xf bank_mask:0xf
    v_mfma_f32_16x16x32_bf16 v[48:51], v[148:151], a[144:147], v[48:51]
    v_cndmask_b32_dpp v167, v179, v167, vcc row_shl:1 row_mask:0xf bank_mask:0xf
    v_mfma_f32_16x16x32_bf16 v[48:51], v[152:155], a[148:151], v[48:51]
    v_mov_b32_dpp v144, v144 row_shr:1 row_mask:0xf bank_mask:0xf
    v_mfma_f32_16x16x32_bf16 v[48:51], v[156:159], a[152:155], v[48:51]
    v_mov_b32_dpp v145, v145 row_shr:1 row_mask:0xf bank_mask:0xf
    v_mfma_f32_16x16x32_bf16 v[48:51], v[160:163], a[156:159], v[48:51]
    buffer_load_dwordx4 v[216:219], v1, s[44:47], s26 offen offset:1024
    v_mfma_f32_16x16x32_bf16 v[44:47], v[168:171], a[132:135], v[44:47]
    v_mov_b32_dpp v146, v146 row_shr:1 row_mask:0xf bank_mask:0xf
    v_mfma_f32_16x16x32_bf16 v[44:47], v[208:211], a[136:139], v[44:47]
    v_mov_b32_dpp v147, v147 row_shr:1 row_mask:0xf bank_mask:0xf
    v_mfma_f32_16x16x32_bf16 v[44:47], v[148:151], a[140:143], v[44:47]
    v_cndmask_b32 v144, v176, v144, vcc
    v_mfma_f32_16x16x32_bf16 v[44:47], v[152:155], a[144:147], v[44:47]
    v_cndmask_b32 v145, v177, v145, vcc
    v_mfma_f32_16x16x32_bf16 v[44:47], v[156:159], a[148:151], v[44:47]
    buffer_load_dwordx4 v[72:75], v1, s[44:47], 0 offen offset:0
    v_mfma_f32_16x16x32_bf16 v[44:47], v[160:163], a[152:155], v[44:47]
    v_cndmask_b32 v146, v178, v146, vcc
    v_mfma_f32_16x16x32_bf16 v[44:47], v[164:167], a[156:159], v[44:47]
    v_cndmask_b32 v147, v179, v147, vcc
    v_mfma_f32_16x16x32_bf16 v[40:43], v[208:211], a[132:135], v[40:43]
    v_mfma_f32_16x16x32_bf16 v[40:43], v[148:151], a[136:139], v[40:43]
    v_mfma_f32_16x16x32_bf16 v[40:43], v[152:155], a[140:143], v[40:43]
    buffer_load_dwordx4 v[136:139], v1, s[44:47], s26 offen offset:0
    v_mfma_f32_16x16x32_bf16 v[40:43], v[156:159], a[144:147], v[40:43]
    v_mfma_f32_16x16x32_bf16 v[40:43], v[160:163], a[148:151], v[40:43]
    v_mfma_f32_16x16x32_bf16 v[40:43], v[164:167], a[152:155], v[40:43]
    v_mfma_f32_16x16x32_bf16 v[40:43], v[144:147], a[156:159], v[40:43]
    s_waitcnt vmcnt(18)
    v_mfma_f32_16x16x32_bf16 a[28:31], v[188:191], a[160:163], a[28:31]
    buffer_load_dwordx4 a[192:195], v1, s[52:55], s25 offen offset:0
    v_mfma_f32_16x16x32_bf16 a[28:31], v[192:195], a[164:167], a[28:31]
    v_mfma_f32_16x16x32_bf16 a[28:31], v[196:199], a[168:171], a[28:31]
    s_waitcnt vmcnt(17)
    v_mfma_f32_16x16x32_bf16 a[28:31], v[200:203], a[172:175], a[28:31]
    s_waitcnt vmcnt(16)
    v_mfma_f32_16x16x32_bf16 a[60:63], v[200:203], a[176:179], a[60:63]
    s_waitcnt vmcnt(15)
    v_mfma_f32_16x16x32_bf16 a[60:63], v[196:199], a[180:183], a[60:63]
    buffer_load_dwordx4 a[196:199], v1, s[52:55], s25 offen offset:1024
    s_waitcnt vmcnt(15)
    v_mfma_f32_16x16x32_bf16 a[60:63], v[192:195], a[184:187], a[60:63]
    s_waitcnt vmcnt(14)
    v_mfma_f32_16x16x32_bf16 a[60:63], v[188:191], a[188:191], a[60:63]
    s_waitcnt vmcnt(13)
    v_mfma_f32_16x16x32_bf16 a[60:63], v[180:183], a[160:163], a[60:63]
    s_waitcnt vmcnt(12)
    v_mfma_f32_16x16x32_bf16 a[60:63], v[204:207], a[164:167], a[60:63]
    s_waitcnt vmcnt(11)
    v_mfma_f32_16x16x32_bf16 a[60:63], v[84:87], a[168:171], a[60:63]
    buffer_load_dwordx4 a[200:203], v1, s[52:55], s25 offen offset:2048
    s_waitcnt vmcnt(11)
    v_mfma_f32_16x16x32_bf16 a[60:63], v[80:83], a[172:175], a[60:63]
    v_mov_b32_dpp v188, v188 row_shr:1 row_mask:0xf bank_mask:0xf
    v_mfma_f32_16x16x32_bf16 a[92:95], v[80:83], a[176:179], a[92:95]
    v_mov_b32_dpp v189, v189 row_shr:1 row_mask:0xf bank_mask:0xf
    v_mfma_f32_16x16x32_bf16 a[92:95], v[84:87], a[180:183], a[92:95]
    v_mov_b32_dpp v190, v190 row_shr:1 row_mask:0xf bank_mask:0xf
    v_mfma_f32_16x16x32_bf16 a[92:95], v[204:207], a[184:187], a[92:95]
    v_mov_b32_dpp v191, v191 row_shr:1 row_mask:0xf bank_mask:0xf
    v_mfma_f32_16x16x32_bf16 a[92:95], v[180:183], a[188:191], a[92:95]
    buffer_load_dwordx4 a[204:207], v1, s[52:55], s64 offen offset:1024
    v_mfma_f32_16x16x32_bf16 a[24:27], v[192:195], a[160:163], a[24:27]
    v_cndmask_b32_dpp v188, v212, v188, vcc row_shl:5 row_mask:0xf bank_mask:0xf
    v_mfma_f32_16x16x32_bf16 a[24:27], v[196:199], a[164:167], a[24:27]
    v_cndmask_b32_dpp v189, v213, v189, vcc row_shl:5 row_mask:0xf bank_mask:0xf
    v_mfma_f32_16x16x32_bf16 a[24:27], v[200:203], a[168:171], a[24:27]
    s_waitcnt vmcnt(11)
    v_mfma_f32_16x16x32_bf16 a[24:27], v[92:95], a[172:175], a[24:27]
    v_cndmask_b32_dpp v190, v214, v190, vcc row_shl:5 row_mask:0xf bank_mask:0xf
    v_mfma_f32_16x16x32_bf16 a[56:59], v[92:95], a[176:179], a[56:59]
    buffer_load_dwordx4 a[208:211], v1, s[52:55], s64 offen offset:0
    v_mfma_f32_16x16x32_bf16 a[56:59], v[200:203], a[180:183], a[56:59]
    v_cndmask_b32_dpp v191, v215, v191, vcc row_shl:5 row_mask:0xf bank_mask:0xf
    v_mfma_f32_16x16x32_bf16 a[56:59], v[196:199], a[184:187], a[56:59]
    v_mov_b32_dpp v180, v180 row_shr:1 row_mask:0xf bank_mask:0xf
    v_mfma_f32_16x16x32_bf16 a[56:59], v[192:195], a[188:191], a[56:59]
    v_mov_b32_dpp v181, v181 row_shr:1 row_mask:0xf bank_mask:0xf
    v_mfma_f32_16x16x32_bf16 a[56:59], v[204:207], a[160:163], a[56:59]
    v_mov_b32_dpp v182, v182 row_shr:1 row_mask:0xf bank_mask:0xf
    v_mfma_f32_16x16x32_bf16 a[56:59], v[84:87], a[164:167], a[56:59]
    buffer_load_dwordx4 a[212:215], v1, s[52:55], s26 offen offset:3072
    v_mfma_f32_16x16x32_bf16 a[56:59], v[80:83], a[168:171], a[56:59]
    s_waitcnt vmcnt(12)
    v_mfma_f32_16x16x32_bf16 a[56:59], v[88:91], a[172:175], a[56:59]
    v_mov_b32_dpp v183, v183 row_shr:1 row_mask:0xf bank_mask:0xf
    v_mfma_f32_16x16x32_bf16 a[88:91], v[88:91], a[176:179], a[88:91]
    v_cndmask_b32_dpp v180, v184, v180, vcc row_shl:5 row_mask:0xf bank_mask:0xf
    v_mfma_f32_16x16x32_bf16 a[88:91], v[80:83], a[180:183], a[88:91]
    v_cndmask_b32_dpp v181, v185, v181, vcc row_shl:5 row_mask:0xf bank_mask:0xf
    v_mfma_f32_16x16x32_bf16 a[88:91], v[84:87], a[184:187], a[88:91]
    buffer_load_dwordx4 v[220:223], v1, s[44:47], s66 offen offset:3072
    v_mfma_f32_16x16x32_bf16 a[88:91], v[204:207], a[188:191], a[88:91]
    v_cndmask_b32_dpp v182, v186, v182, vcc row_shl:5 row_mask:0xf bank_mask:0xf
    v_mfma_f32_16x16x32_bf16 a[20:23], v[196:199], a[160:163], a[20:23]
    v_cndmask_b32_dpp v183, v187, v183, vcc row_shl:5 row_mask:0xf bank_mask:0xf
    v_mfma_f32_16x16x32_bf16 a[20:23], v[200:203], a[164:167], a[20:23]
    v_mov_b32_dpp v192, v192 row_shr:1 row_mask:0xf bank_mask:0xf
    v_mfma_f32_16x16x32_bf16 a[20:23], v[92:95], a[168:171], a[20:23]
    s_waitcnt vmcnt(12)
    v_mfma_f32_16x16x32_bf16 a[20:23], v[224:227], a[172:175], a[20:23]
    buffer_load_dwordx4 a[216:219], v1, s[52:55], s64 offen offset:2048
    v_mfma_f32_16x16x32_bf16 a[52:55], v[224:227], a[176:179], a[52:55]
    v_mov_b32_dpp v193, v193 row_shr:1 row_mask:0xf bank_mask:0xf
    v_mfma_f32_16x16x32_bf16 a[52:55], v[92:95], a[180:183], a[52:55]
    v_mov_b32_dpp v194, v194 row_shr:1 row_mask:0xf bank_mask:0xf
    v_mfma_f32_16x16x32_bf16 a[52:55], v[200:203], a[184:187], a[52:55]
    v_mov_b32_dpp v195, v195 row_shr:1 row_mask:0xf bank_mask:0xf
    v_mfma_f32_16x16x32_bf16 a[52:55], v[196:199], a[188:191], a[52:55]
    v_cndmask_b32_dpp v192, v212, v192, vcc row_shl:4 row_mask:0xf bank_mask:0xf
    v_mfma_f32_16x16x32_bf16 a[52:55], v[84:87], a[160:163], a[52:55]
    buffer_load_dwordx4 v[76:79], v1, s[44:47], s66 offen offset:2048
    v_mfma_f32_16x16x32_bf16 a[52:55], v[80:83], a[164:167], a[52:55]
    v_cndmask_b32_dpp v193, v213, v193, vcc row_shl:4 row_mask:0xf bank_mask:0xf
    v_mfma_f32_16x16x32_bf16 a[52:55], v[88:91], a[168:171], a[52:55]
    s_waitcnt vmcnt(13)
    v_mfma_f32_16x16x32_bf16 a[52:55], v[228:231], a[172:175], a[52:55]
    v_cndmask_b32_dpp v194, v214, v194, vcc row_shl:4 row_mask:0xf bank_mask:0xf
    v_mfma_f32_16x16x32_bf16 a[84:87], v[228:231], a[176:179], a[84:87]
    v_cndmask_b32_dpp v195, v215, v195, vcc row_shl:4 row_mask:0xf bank_mask:0xf
    v_mfma_f32_16x16x32_bf16 a[84:87], v[88:91], a[180:183], a[84:87]
    buffer_load_dwordx4 a[220:223], v1, s[52:55], s64 offen offset:3072
    v_mfma_f32_16x16x32_bf16 a[84:87], v[80:83], a[184:187], a[84:87]
    v_mov_b32_dpp v204, v204 row_shr:1 row_mask:0xf bank_mask:0xf
    v_mfma_f32_16x16x32_bf16 a[84:87], v[84:87], a[188:191], a[84:87]
    v_mov_b32_dpp v205, v205 row_shr:1 row_mask:0xf bank_mask:0xf
    v_mfma_f32_16x16x32_bf16 a[16:19], v[200:203], a[160:163], a[16:19]
    v_mov_b32_dpp v206, v206 row_shr:1 row_mask:0xf bank_mask:0xf
    v_mfma_f32_16x16x32_bf16 a[16:19], v[92:95], a[164:167], a[16:19]
    v_mov_b32_dpp v207, v207 row_shr:1 row_mask:0xf bank_mask:0xf
    v_mfma_f32_16x16x32_bf16 a[16:19], v[224:227], a[168:171], a[16:19]
    buffer_load_dwordx4 v[140:143], v1, s[44:47], s66 offen offset:1024
    s_waitcnt vmcnt(14)
    v_mfma_f32_16x16x32_bf16 a[16:19], v[128:131], a[172:175], a[16:19]
    v_cndmask_b32_dpp v204, v184, v204, vcc row_shl:4 row_mask:0xf bank_mask:0xf
    v_mfma_f32_16x16x32_bf16 a[48:51], v[128:131], a[176:179], a[48:51]
    v_cndmask_b32_dpp v205, v185, v205, vcc row_shl:4 row_mask:0xf bank_mask:0xf
    v_mfma_f32_16x16x32_bf16 a[48:51], v[224:227], a[180:183], a[48:51]
    v_cndmask_b32_dpp v206, v186, v206, vcc row_shl:4 row_mask:0xf bank_mask:0xf
    v_mfma_f32_16x16x32_bf16 a[48:51], v[92:95], a[184:187], a[48:51]
    v_cndmask_b32_dpp v207, v187, v207, vcc row_shl:4 row_mask:0xf bank_mask:0xf
    v_mfma_f32_16x16x32_bf16 a[48:51], v[200:203], a[188:191], a[48:51]
    buffer_load_dwordx4 a[224:227], v1, s[52:55], s65 offen offset:0
    v_mfma_f32_16x16x32_bf16 a[48:51], v[80:83], a[160:163], a[48:51]
    v_mov_b32_dpp v196, v196 row_shr:1 row_mask:0xf bank_mask:0xf
    v_mfma_f32_16x16x32_bf16 a[48:51], v[88:91], a[164:167], a[48:51]
    v_mov_b32_dpp v197, v197 row_shr:1 row_mask:0xf bank_mask:0xf
    v_mfma_f32_16x16x32_bf16 a[48:51], v[228:231], a[168:171], a[48:51]
    s_waitcnt vmcnt(14)
    v_mfma_f32_16x16x32_bf16 a[48:51], v[216:219], a[172:175], a[48:51]
    v_mov_b32_dpp v198, v198 row_shr:1 row_mask:0xf bank_mask:0xf
    v_mfma_f32_16x16x32_bf16 a[80:83], v[216:219], a[176:179], a[80:83]
    buffer_load_dwordx4 v[132:135], v1, s[44:47], s66 offen offset:0
    v_mfma_f32_16x16x32_bf16 a[80:83], v[228:231], a[180:183], a[80:83]
    v_mov_b32_dpp v199, v199 row_shr:1 row_mask:0xf bank_mask:0xf
    v_mfma_f32_16x16x32_bf16 a[80:83], v[88:91], a[184:187], a[80:83]
    v_cndmask_b32_dpp v196, v212, v196, vcc row_shl:3 row_mask:0xf bank_mask:0xf
    v_mfma_f32_16x16x32_bf16 a[80:83], v[80:83], a[188:191], a[80:83]
    v_cndmask_b32_dpp v197, v213, v197, vcc row_shl:3 row_mask:0xf bank_mask:0xf
    v_mfma_f32_16x16x32_bf16 a[12:15], v[92:95], a[160:163], a[12:15]
    v_cndmask_b32_dpp v198, v214, v198, vcc row_shl:3 row_mask:0xf bank_mask:0xf
    v_mfma_f32_16x16x32_bf16 a[12:15], v[224:227], a[164:167], a[12:15]
    buffer_load_dwordx4 a[228:231], v1, s[52:55], s65 offen offset:1024
    v_mfma_f32_16x16x32_bf16 a[12:15], v[128:131], a[168:171], a[12:15]
    s_waitcnt vmcnt(15)
    v_mfma_f32_16x16x32_bf16 a[12:15], v[72:75], a[172:175], a[12:15]
    v_cndmask_b32_dpp v199, v215, v199, vcc row_shl:3 row_mask:0xf bank_mask:0xf
    v_mov_b32_dpp v84, v84 row_shr:1 row_mask:0xf bank_mask:0xf
    v_mfma_f32_16x16x32_bf16 a[44:47], v[72:75], a[176:179], a[44:47]
    v_mov_b32_dpp v85, v85 row_shr:1 row_mask:0xf bank_mask:0xf
    v_mov_b32_dpp v86, v86 row_shr:1 row_mask:0xf bank_mask:0xf
    v_mfma_f32_16x16x32_bf16 a[44:47], v[128:131], a[180:183], a[44:47]
    v_mov_b32_dpp v87, v87 row_shr:1 row_mask:0xf bank_mask:0xf
    v_cndmask_b32_dpp v84, v184, v84, vcc row_shl:3 row_mask:0xf bank_mask:0xf
    v_mfma_f32_16x16x32_bf16 a[44:47], v[224:227], a[184:187], a[44:47]
    buffer_load_dwordx4 v[100:103], v1, s[44:47], s65 offen offset:3072
    v_cndmask_b32_dpp v85, v185, v85, vcc row_shl:3 row_mask:0xf bank_mask:0xf
    v_mfma_f32_16x16x32_bf16 a[44:47], v[92:95], a[188:191], a[44:47]
    v_cndmask_b32_dpp v86, v186, v86, vcc row_shl:3 row_mask:0xf bank_mask:0xf
    v_cndmask_b32_dpp v87, v187, v87, vcc row_shl:3 row_mask:0xf bank_mask:0xf
    v_mfma_f32_16x16x32_bf16 a[44:47], v[88:91], a[160:163], a[44:47]
    v_mov_b32_dpp v200, v200 row_shr:1 row_mask:0xf bank_mask:0xf
    v_mov_b32_dpp v201, v201 row_shr:1 row_mask:0xf bank_mask:0xf
    v_mfma_f32_16x16x32_bf16 a[44:47], v[228:231], a[164:167], a[44:47]
    v_mov_b32_dpp v202, v202 row_shr:1 row_mask:0xf bank_mask:0xf
    v_mov_b32_dpp v203, v203 row_shr:1 row_mask:0xf bank_mask:0xf
    v_mfma_f32_16x16x32_bf16 a[44:47], v[216:219], a[168:171], a[44:47]
    v_cndmask_b32_dpp v200, v212, v200, vcc row_shl:2 row_mask:0xf bank_mask:0xf
    s_waitcnt vmcnt(15)
    v_mfma_f32_16x16x32_bf16 a[44:47], v[136:139], a[172:175], a[44:47]
    buffer_load_dwordx4 a[232:235], v1, s[52:55], s65 offen offset:2048
    v_cndmask_b32_dpp v201, v213, v201, vcc row_shl:2 row_mask:0xf bank_mask:0xf
    v_mfma_f32_16x16x32_bf16 a[76:79], v[136:139], a[176:179], a[76:79]
    v_cndmask_b32_dpp v202, v214, v202, vcc row_shl:2 row_mask:0xf bank_mask:0xf
    v_cndmask_b32_dpp v203, v215, v203, vcc row_shl:2 row_mask:0xf bank_mask:0xf
    v_mfma_f32_16x16x32_bf16 a[76:79], v[216:219], a[180:183], a[76:79]
    v_mov_b32_dpp v80, v80 row_shr:1 row_mask:0xf bank_mask:0xf
    v_mov_b32_dpp v81, v81 row_shr:1 row_mask:0xf bank_mask:0xf
    v_mfma_f32_16x16x32_bf16 a[76:79], v[228:231], a[184:187], a[76:79]
    v_mov_b32_dpp v82, v82 row_shr:1 row_mask:0xf bank_mask:0xf
    v_mov_b32_dpp v83, v83 row_shr:1 row_mask:0xf bank_mask:0xf
    v_mfma_f32_16x16x32_bf16 a[76:79], v[88:91], a[188:191], a[76:79]
    v_cndmask_b32_dpp v80, v184, v80, vcc row_shl:2 row_mask:0xf bank_mask:0xf
    v_cndmask_b32_dpp v81, v185, v81, vcc row_shl:2 row_mask:0xf bank_mask:0xf
    v_mfma_f32_16x16x32_bf16 a[8:11], v[224:227], a[160:163], a[8:11]
    buffer_load_dwordx4 a[236:239], v251, s[60:63], s66 offen offset:3072
    v_cndmask_b32_dpp v82, v186, v82, vcc row_shl:2 row_mask:0xf bank_mask:0xf
    v_mfma_f32_16x16x32_bf16 a[8:11], v[128:131], a[164:167], a[8:11]
    v_cndmask_b32_dpp v83, v187, v83, vcc row_shl:2 row_mask:0xf bank_mask:0xf
    v_mfma_f32_16x16x32_bf16 a[8:11], v[72:75], a[168:171], a[8:11]
    v_mfma_f32_16x16x32_bf16 a[8:11], v[188:191], a[172:175], a[8:11]
    v_mfma_f32_16x16x32_bf16 a[40:43], v[188:191], a[176:179], a[40:43]
    v_mfma_f32_16x16x32_bf16 a[40:43], v[72:75], a[180:183], a[40:43]
    buffer_load_dwordx4 v[172:175], v1, s[44:47], s65 offen offset:2048
    v_mfma_f32_16x16x32_bf16 a[40:43], v[128:131], a[184:187], a[40:43]
    v_mfma_f32_16x16x32_bf16 a[40:43], v[224:227], a[188:191], a[40:43]
    v_mfma_f32_16x16x32_bf16 a[40:43], v[228:231], a[160:163], a[40:43]
    v_mfma_f32_16x16x32_bf16 a[40:43], v[216:219], a[164:167], a[40:43]
    v_mfma_f32_16x16x32_bf16 a[40:43], v[136:139], a[168:171], a[40:43]
    buffer_load_dwordx4 a[240:243], v1, s[52:55], s65 offen offset:3072
    v_mfma_f32_16x16x32_bf16 a[40:43], v[180:183], a[172:175], a[40:43]
    v_mfma_f32_16x16x32_bf16 a[72:75], v[180:183], a[176:179], a[72:75]
    v_mfma_f32_16x16x32_bf16 a[72:75], v[136:139], a[180:183], a[72:75]
    v_mfma_f32_16x16x32_bf16 a[72:75], v[216:219], a[184:187], a[72:75]
    v_mfma_f32_16x16x32_bf16 a[72:75], v[228:231], a[188:191], a[72:75]
    buffer_load_dwordx4 a[244:247], v251, s[60:63], s68 offen offset:3072
    v_mfma_f32_16x16x32_bf16 a[4:7], v[128:131], a[160:163], a[4:7]
    v_mfma_f32_16x16x32_bf16 a[4:7], v[72:75], a[164:167], a[4:7]
    v_mfma_f32_16x16x32_bf16 a[4:7], v[188:191], a[168:171], a[4:7]
    v_mfma_f32_16x16x32_bf16 a[4:7], v[192:195], a[172:175], a[4:7]
    v_mfma_f32_16x16x32_bf16 a[36:39], v[192:195], a[176:179], a[36:39]
    buffer_load_dwordx4 v[120:123], v1, s[44:47], s65 offen offset:1024
    v_mfma_f32_16x16x32_bf16 a[36:39], v[188:191], a[180:183], a[36:39]
    v_mfma_f32_16x16x32_bf16 a[36:39], v[72:75], a[184:187], a[36:39]
    v_mfma_f32_16x16x32_bf16 a[36:39], v[128:131], a[188:191], a[36:39]
    v_mfma_f32_16x16x32_bf16 a[36:39], v[216:219], a[160:163], a[36:39]
    v_mfma_f32_16x16x32_bf16 a[36:39], v[136:139], a[164:167], a[36:39]
    buffer_load_dwordx4 a[248:251], v1, s[52:55], s66 offen offset:0
    v_mfma_f32_16x16x32_bf16 a[36:39], v[180:183], a[168:171], a[36:39]
    v_mfma_f32_16x16x32_bf16 a[36:39], v[204:207], a[172:175], a[36:39]
    v_mfma_f32_16x16x32_bf16 a[68:71], v[204:207], a[176:179], a[68:71]
    v_mfma_f32_16x16x32_bf16 a[68:71], v[180:183], a[180:183], a[68:71]
    v_mfma_f32_16x16x32_bf16 a[68:71], v[136:139], a[184:187], a[68:71]
    buffer_load_dwordx4 v[104:107], v1, s[44:47], s67 offen offset:1024
    v_mfma_f32_16x16x32_bf16 a[68:71], v[216:219], a[188:191], a[68:71]
    v_mfma_f32_16x16x32_bf16 a[0:3], v[72:75], a[160:163], a[0:3]
    v_mfma_f32_16x16x32_bf16 a[0:3], v[188:191], a[164:167], a[0:3]
    v_mfma_f32_16x16x32_bf16 a[0:3], v[192:195], a[168:171], a[0:3]
    v_mfma_f32_16x16x32_bf16 a[0:3], v[196:199], a[172:175], a[0:3]
    buffer_load_dwordx4 a[252:255], v1, s[52:55], s67 offen offset:3072
    v_mfma_f32_16x16x32_bf16 a[32:35], v[196:199], a[176:179], a[32:35]
    v_mfma_f32_16x16x32_bf16 a[32:35], v[192:195], a[180:183], a[32:35]
    v_mfma_f32_16x16x32_bf16 a[32:35], v[188:191], a[184:187], a[32:35]
    v_mfma_f32_16x16x32_bf16 a[32:35], v[72:75], a[188:191], a[32:35]
    v_mfma_f32_16x16x32_bf16 a[32:35], v[136:139], a[160:163], a[32:35]
    buffer_load_dwordx4 v[96:99], v1, s[44:47], s67 offen offset:2048
    v_mfma_f32_16x16x32_bf16 a[32:35], v[180:183], a[164:167], a[32:35]
    v_mfma_f32_16x16x32_bf16 a[32:35], v[204:207], a[168:171], a[32:35]
    v_mfma_f32_16x16x32_bf16 a[32:35], v[84:87], a[172:175], a[32:35]
    v_mfma_f32_16x16x32_bf16 a[64:67], v[84:87], a[176:179], a[64:67]
    v_mfma_f32_16x16x32_bf16 a[64:67], v[204:207], a[180:183], a[64:67]
    buffer_load_dwordx4 a[100:103], v1, s[52:55], s67 offen offset:2048
    v_mfma_f32_16x16x32_bf16 a[64:67], v[180:183], a[184:187], a[64:67]
    v_mfma_f32_16x16x32_bf16 a[64:67], v[136:139], a[188:191], a[64:67]
    s_waitcnt vmcnt(18)
    v_mfma_f32_16x16x32_bf16 a[28:31], v[92:95], a[192:195], a[28:31]
    v_mfma_f32_16x16x32_bf16 a[28:31], v[224:227], a[196:199], a[28:31]
    v_mfma_f32_16x16x32_bf16 a[28:31], v[128:131], a[200:203], a[28:31]
    buffer_load_dwordx4 v[116:119], v1, s[44:47], s67 offen offset:3072
    v_mfma_f32_16x16x32_bf16 a[60:63], v[128:131], a[204:207], a[60:63]
    v_mfma_f32_16x16x32_bf16 a[60:63], v[224:227], a[208:211], a[60:63]
    v_mfma_f32_16x16x32_bf16 a[60:63], v[92:95], a[212:215], a[60:63]
    v_mov_b32_dpp v92, v92 row_shr:1 row_mask:0xf bank_mask:0xf
    v_mov_b32_dpp v93, v93 row_shr:1 row_mask:0xf bank_mask:0xf
    v_mfma_f32_16x16x32_bf16 a[60:63], v[88:91], a[192:195], a[60:63]
    v_mov_b32_dpp v94, v94 row_shr:1 row_mask:0xf bank_mask:0xf
    v_mov_b32_dpp v95, v95 row_shr:1 row_mask:0xf bank_mask:0xf
    v_mfma_f32_16x16x32_bf16 a[60:63], v[228:231], a[196:199], a[60:63]
    buffer_load_dwordx4 a[96:99], v1, s[52:55], s67 offen offset:1024
    v_cndmask_b32_dpp v92, v212, v92, vcc row_shl:1 row_mask:0xf bank_mask:0xf
    v_mfma_f32_16x16x32_bf16 a[60:63], v[216:219], a[200:203], a[60:63]
    v_cndmask_b32_dpp v93, v213, v93, vcc row_shl:1 row_mask:0xf bank_mask:0xf
    v_cndmask_b32_dpp v94, v214, v94, vcc row_shl:1 row_mask:0xf bank_mask:0xf
    v_mfma_f32_16x16x32_bf16 a[92:95], v[216:219], a[204:207], a[92:95]
    v_cndmask_b32_dpp v95, v215, v95, vcc row_shl:1 row_mask:0xf bank_mask:0xf
    v_mfma_f32_16x16x32_bf16 a[92:95], v[228:231], a[208:211], a[92:95]
    v_mfma_f32_16x16x32_bf16 a[92:95], v[88:91], a[212:215], a[92:95]
    v_mov_b32_dpp v88, v88 row_shr:1 row_mask:0xf bank_mask:0xf
    v_mov_b32_dpp v89, v89 row_shr:1 row_mask:0xf bank_mask:0xf
    v_mfma_f32_16x16x32_bf16 a[24:27], v[224:227], a[192:195], a[24:27]
    buffer_load_dwordx4 v[124:127], v1, s[44:47], s68 offen offset:0
    v_mov_b32_dpp v90, v90 row_shr:1 row_mask:0xf bank_mask:0xf
    v_mfma_f32_16x16x32_bf16 a[24:27], v[128:131], a[196:199], a[24:27]
    v_mov_b32_dpp v91, v91 row_shr:1 row_mask:0xf bank_mask:0xf
    v_cndmask_b32_dpp v88, v184, v88, vcc row_shl:1 row_mask:0xf bank_mask:0xf
    v_mfma_f32_16x16x32_bf16 a[24:27], v[72:75], a[200:203], a[24:27]
    v_cndmask_b32_dpp v89, v185, v89, vcc row_shl:1 row_mask:0xf bank_mask:0xf
    v_cndmask_b32_dpp v90, v186, v90, vcc row_shl:1 row_mask:0xf bank_mask:0xf
    v_mfma_f32_16x16x32_bf16 a[56:59], v[72:75], a[204:207], a[56:59]
    v_cndmask_b32_dpp v91, v187, v91, vcc row_shl:1 row_mask:0xf bank_mask:0xf
    v_mfma_f32_16x16x32_bf16 a[56:59], v[128:131], a[208:211], a[56:59]
    v_accvgpr_read_b32 v232, a28
    v_accvgpr_read_b32 v233, a60
    v_mfma_f32_16x16x32_bf16 a[56:59], v[224:227], a[212:215], a[56:59]
    buffer_load_dwordx4 a[108:111], v1, s[52:55], s67 offen offset:0
    v_mov_b32_dpp v224, v224 row_shr:1 row_mask:0xf bank_mask:0xf
    v_mfma_f32_16x16x32_bf16 a[56:59], v[228:231], a[192:195], a[56:59]
    v_mov_b32_dpp v225, v225 row_shr:1 row_mask:0xf bank_mask:0xf
    v_mov_b32_dpp v226, v226 row_shr:1 row_mask:0xf bank_mask:0xf
    v_mfma_f32_16x16x32_bf16 a[56:59], v[216:219], a[196:199], a[56:59]
    v_mov_b32_dpp v227, v227 row_shr:1 row_mask:0xf bank_mask:0xf
    v_cndmask_b32 v224, v212, v224, vcc
    v_mfma_f32_16x16x32_bf16 a[56:59], v[136:139], a[200:203], a[56:59]
    v_cndmask_b32 v225, v213, v225, vcc
    v_cndmask_b32 v226, v214, v226, vcc
    v_mfma_f32_16x16x32_bf16 a[88:91], v[136:139], a[204:207], a[88:91]
    v_cndmask_b32 v227, v215, v227, vcc
    v_accvgpr_read_b32 v234, a92
    v_mfma_f32_16x16x32_bf16 a[88:91], v[216:219], a[208:211], a[88:91]
    buffer_load_dwordx4 v[112:115], v1, s[44:47], s68 offen offset:1024
    v_accvgpr_read_b32 v236, a29
    v_mfma_f32_16x16x32_bf16 a[88:91], v[228:231], a[212:215], a[88:91]
    v_mov_b32_dpp v228, v228 row_shr:1 row_mask:0xf bank_mask:0xf
    v_mov_b32_dpp v229, v229 row_shr:1 row_mask:0xf bank_mask:0xf
    v_mfma_f32_16x16x32_bf16 a[20:23], v[128:131], a[192:195], a[20:23]
    v_mov_b32_dpp v230, v230 row_shr:1 row_mask:0xf bank_mask:0xf
    v_mov_b32_dpp v231, v231 row_shr:1 row_mask:0xf bank_mask:0xf
    v_mfma_f32_16x16x32_bf16 a[20:23], v[72:75], a[196:199], a[20:23]
    v_cndmask_b32 v228, v184, v228, vcc
    v_cndmask_b32 v229, v185, v229, vcc
    v_mfma_f32_16x16x32_bf16 a[20:23], v[188:191], a[200:203], a[20:23]
    v_cndmask_b32 v230, v186, v230, vcc
    v_cndmask_b32 v231, v187, v231, vcc
    v_mfma_f32_16x16x32_bf16 a[52:55], v[188:191], a[204:207], a[52:55]
    buffer_load_dwordx4 a[104:107], v1, s[52:55], s66 offen offset:3072
    v_accvgpr_read_b32 v237, a61
    v_mfma_f32_16x16x32_bf16 a[52:55], v[72:75], a[208:211], a[52:55]
    v_accvgpr_read_b32 v238, a93
    v_cvt_pk_bf16_f32 v232, v232, v233
    v_mfma_f32_16x16x32_bf16 a[52:55], v[128:131], a[212:215], a[52:55]
    v_cvt_pk_bf16_f32 v233, v234, 0
    v_accvgpr_read_b32 v240, a30
    v_mfma_f32_16x16x32_bf16 a[52:55], v[216:219], a[192:195], a[52:55]
    v_accvgpr_read_b32 v241, a62
    v_accvgpr_read_b32 v242, a94
    v_mfma_f32_16x16x32_bf16 a[52:55], v[136:139], a[196:199], a[52:55]
    ds_write_b64 v244, v[232:233] offset:28672
    v_cvt_pk_bf16_f32 v236, v236, v237
    v_mfma_f32_16x16x32_bf16 a[52:55], v[180:183], a[200:203], a[52:55]
    buffer_load_dwordx4 v[108:111], v1, s[44:47], s68 offen offset:2048
    v_cvt_pk_bf16_f32 v237, v238, 0
    v_mfma_f32_16x16x32_bf16 a[84:87], v[180:183], a[204:207], a[84:87]
    v_accvgpr_read_b32 v252, a31
    v_accvgpr_read_b32 v253, a63
    v_mfma_f32_16x16x32_bf16 a[84:87], v[136:139], a[208:211], a[84:87]
    v_accvgpr_read_b32 v254, a95
    ds_write_b64 v244, v[236:237] offset:28928
    v_mfma_f32_16x16x32_bf16 a[84:87], v[216:219], a[212:215], a[84:87]
    v_cvt_pk_bf16_f32 v240, v240, v241
    v_cvt_pk_bf16_f32 v241, v242, 0
    v_mfma_f32_16x16x32_bf16 a[16:19], v[72:75], a[192:195], a[16:19]
    v_cvt_pk_bf16_f32 v252, v252, v253
    v_cvt_pk_bf16_f32 v253, v254, 0
    v_mfma_f32_16x16x32_bf16 a[16:19], v[188:191], a[196:199], a[16:19]
    buffer_load_dwordx4 a[116:119], v1, s[52:55], s66 offen offset:2048
    ds_write_b64 v244, v[240:241] offset:29184
    v_mfma_f32_16x16x32_bf16 a[16:19], v[192:195], a[200:203], a[16:19]
    ds_write_b64 v244, v[252:253] offset:29440
    v_accvgpr_read_b32 v232, a24
    v_mfma_f32_16x16x32_bf16 a[48:51], v[192:195], a[204:207], a[48:51]
    v_accvgpr_read_b32 v233, a56
    v_accvgpr_read_b32 v234, a88
    v_mfma_f32_16x16x32_bf16 a[48:51], v[188:191], a[208:211], a[48:51]
    v_accvgpr_read_b32 v236, a25
    v_accvgpr_read_b32 v237, a57
    v_mfma_f32_16x16x32_bf16 a[48:51], v[72:75], a[212:215], a[48:51]
    v_accvgpr_read_b32 v238, a89
    v_cvt_pk_bf16_f32 v232, v232, v233
    v_mfma_f32_16x16x32_bf16 a[48:51], v[136:139], a[192:195], a[48:51]
    buffer_load_dwordx4 v[168:171], v1, s[44:47], s68 offen offset:3072
    v_cvt_pk_bf16_f32 v233, v234, 0
    v_mfma_f32_16x16x32_bf16 a[48:51], v[180:183], a[196:199], a[48:51]
    v_accvgpr_read_b32 v240, a26
    v_accvgpr_read_b32 v241, a58
    v_mfma_f32_16x16x32_bf16 a[48:51], v[204:207], a[200:203], a[48:51]
    v_accvgpr_read_b32 v242, a90
    ds_write_b64 v244, v[232:233] offset:24576
    v_mfma_f32_16x16x32_bf16 a[80:83], v[204:207], a[204:207], a[80:83]
    v_cvt_pk_bf16_f32 v236, v236, v237
    v_cvt_pk_bf16_f32 v237, v238, 0
    v_mfma_f32_16x16x32_bf16 a[80:83], v[180:183], a[208:211], a[80:83]
    v_accvgpr_read_b32 v252, a27
    v_accvgpr_read_b32 v253, a59
    v_mfma_f32_16x16x32_bf16 a[80:83], v[136:139], a[212:215], a[80:83]
    buffer_load_dwordx4 a[112:115], v1, s[52:55], s66 offen offset:1024
    v_accvgpr_read_b32 v254, a91
    v_mfma_f32_16x16x32_bf16 a[12:15], v[188:191], a[192:195], a[12:15]
    ds_write_b64 v244, v[236:237] offset:24832
    v_cvt_pk_bf16_f32 v240, v240, v241
    v_mfma_f32_16x16x32_bf16 a[12:15], v[192:195], a[196:199], a[12:15]
    v_cvt_pk_bf16_f32 v241, v242, 0
    v_cvt_pk_bf16_f32 v252, v252, v253
    v_mfma_f32_16x16x32_bf16 a[12:15], v[196:199], a[200:203], a[12:15]
    v_cvt_pk_bf16_f32 v253, v254, 0
    ds_write_b64 v244, v[240:241] offset:25088
    v_mfma_f32_16x16x32_bf16 a[44:47], v[196:199], a[204:207], a[44:47]
    ds_write_b64 v244, v[252:253] offset:25344
    v_accvgpr_read_b32 v232, a20
    v_mfma_f32_16x16x32_bf16 a[44:47], v[192:195], a[208:211], a[44:47]
    buffer_load_dwordx4 a[124:127], v251, s[60:63], s66 offen offset:2048
    v_accvgpr_read_b32 v233, a52
    v_mfma_f32_16x16x32_bf16 a[44:47], v[188:191], a[212:215], a[44:47]
    v_accvgpr_read_b32 v234, a84
    v_accvgpr_read_b32 v236, a21
    v_mfma_f32_16x16x32_bf16 a[44:47], v[180:183], a[192:195], a[44:47]
    v_accvgpr_read_b32 v237, a53
    v_accvgpr_read_b32 v238, a85
    v_mfma_f32_16x16x32_bf16 a[44:47], v[204:207], a[196:199], a[44:47]
    v_cvt_pk_bf16_f32 v232, v232, v233
    v_cvt_pk_bf16_f32 v233, v234, 0
    v_mfma_f32_16x16x32_bf16 a[44:47], v[84:87], a[200:203], a[44:47]
    v_accvgpr_read_b32 v240, a22
    v_accvgpr_read_b32 v241, a54
    v_mfma_f32_16x16x32_bf16 a[76:79], v[84:87], a[204:207], a[76:79]
    buffer_load_dwordx4 a[120:123], v251, s[60:63], s68 offen offset:2048
    v_accvgpr_read_b32 v242, a86
    v_mfma_f32_16x16x32_bf16 a[76:79], v[204:207], a[208:211], a[76:79]
    ds_write_b64 v244, v[232:233] offset:20480
    v_cvt_pk_bf16_f32 v236, v236, v237
    v_mfma_f32_16x16x32_bf16 a[76:79], v[180:183], a[212:215], a[76:79]
    v_cvt_pk_bf16_f32 v237, v238, 0
    v_accvgpr_read_b32 v252, a23
    v_mfma_f32_16x16x32_bf16 a[8:11], v[192:195], a[192:195], a[8:11]
    v_accvgpr_read_b32 v253, a55
    v_accvgpr_read_b32 v254, a87
    v_mfma_f32_16x16x32_bf16 a[8:11], v[196:199], a[196:199], a[8:11]
    ds_write_b64 v244, v[236:237] offset:20736
    v_cvt_pk_bf16_f32 v240, v240, v241
    v_mfma_f32_16x16x32_bf16 a[8:11], v[200:203], a[200:203], a[8:11]
    buffer_load_dwordx4 v[208:211], v1, s[44:47], s65 offen offset:0
    v_cvt_pk_bf16_f32 v241, v242, 0
    v_mfma_f32_16x16x32_bf16 a[40:43], v[200:203], a[204:207], a[40:43]
    v_cvt_pk_bf16_f32 v252, v252, v253
    v_cvt_pk_bf16_f32 v253, v254, 0
    v_mfma_f32_16x16x32_bf16 a[40:43], v[196:199], a[208:211], a[40:43]
    ds_write_b64 v244, v[240:241] offset:20992
    ds_write_b64 v244, v[252:253] offset:21248
    v_mfma_f32_16x16x32_bf16 a[40:43], v[192:195], a[212:215], a[40:43]
    v_accvgpr_read_b32 v232, a16
    v_accvgpr_read_b32 v233, a48
    v_mfma_f32_16x16x32_bf16 a[40:43], v[204:207], a[192:195], a[40:43]
    v_accvgpr_read_b32 v234, a80
    v_accvgpr_read_b32 v236, a17
    v_mfma_f32_16x16x32_bf16 a[40:43], v[84:87], a[196:199], a[40:43]
    buffer_load_dwordx4 v[148:151], v1, s[44:47], s67 offen offset:0
    v_accvgpr_read_b32 v237, a49
    v_mfma_f32_16x16x32_bf16 a[40:43], v[80:83], a[200:203], a[40:43]
    v_accvgpr_read_b32 v238, a81
    v_cvt_pk_bf16_f32 v232, v232, v233
    v_mfma_f32_16x16x32_bf16 a[72:75], v[80:83], a[204:207], a[72:75]
    v_cvt_pk_bf16_f32 v233, v234, 0
    v_accvgpr_read_b32 v240, a18
    v_mfma_f32_16x16x32_bf16 a[72:75], v[84:87], a[208:211], a[72:75]
    v_accvgpr_read_b32 v241, a50
    v_accvgpr_read_b32 v242, a82
    v_mfma_f32_16x16x32_bf16 a[72:75], v[204:207], a[212:215], a[72:75]
    ds_write_b64 v244, v[232:233] offset:16384
    v_cvt_pk_bf16_f32 v236, v236, v237
    v_mfma_f32_16x16x32_bf16 a[4:7], v[196:199], a[192:195], a[4:7]
    buffer_load_dwordx4 a[128:131], v251, s[60:63], s66 offen offset:1024
    v_cvt_pk_bf16_f32 v237, v238, 0
    v_mfma_f32_16x16x32_bf16 a[4:7], v[200:203], a[196:199], a[4:7]
    v_accvgpr_read_b32 v252, a19
    v_accvgpr_read_b32 v253, a51
    v_mfma_f32_16x16x32_bf16 a[4:7], v[92:95], a[200:203], a[4:7]
    v_accvgpr_read_b32 v254, a83
    ds_write_b64 v244, v[236:237] offset:16640
    v_mfma_f32_16x16x32_bf16 a[36:39], v[92:95], a[204:207], a[36:39]
    v_cvt_pk_bf16_f32 v240, v240, v241
    v_cvt_pk_bf16_f32 v241, v242, 0
    v_mfma_f32_16x16x32_bf16 a[36:39], v[200:203], a[208:211], a[36:39]
    v_cvt_pk_bf16_f32 v252, v252, v253
    v_cvt_pk_bf16_f32 v253, v254, 0
    v_mfma_f32_16x16x32_bf16 a[36:39], v[196:199], a[212:215], a[36:39]
    buffer_load_dwordx4 a[132:135], v251, s[60:63], s68 offen offset:1024
    ds_write_b64 v244, v[240:241] offset:16896
    v_mfma_f32_16x16x32_bf16 a[36:39], v[84:87], a[192:195], a[36:39]
    ds_write_b64 v244, v[252:253] offset:17152
    v_accvgpr_read_b32 v232, a12
    v_mfma_f32_16x16x32_bf16 a[36:39], v[80:83], a[196:199], a[36:39]
    v_accvgpr_read_b32 v233, a44
    v_accvgpr_read_b32 v234, a76
    v_mfma_f32_16x16x32_bf16 a[36:39], v[88:91], a[200:203], a[36:39]
    v_accvgpr_read_b32 v236, a13
    v_accvgpr_read_b32 v237, a45
    v_mfma_f32_16x16x32_bf16 a[68:71], v[88:91], a[204:207], a[68:71]
    v_accvgpr_read_b32 v238, a77
    v_cvt_pk_bf16_f32 v232, v232, v233
    v_mfma_f32_16x16x32_bf16 a[68:71], v[80:83], a[208:211], a[68:71]
    buffer_load_dwordx4 a[136:139], v251, s[60:63], s66 offen offset:0
    v_cvt_pk_bf16_f32 v233, v234, 0
    v_mfma_f32_16x16x32_bf16 a[68:71], v[84:87], a[212:215], a[68:71]
    v_accvgpr_read_b32 v240, a14
    v_accvgpr_read_b32 v241, a46
    v_mfma_f32_16x16x32_bf16 a[0:3], v[200:203], a[192:195], a[0:3]
    v_accvgpr_read_b32 v242, a78
    ds_write_b64 v244, v[232:233] offset:12288
    v_mfma_f32_16x16x32_bf16 a[0:3], v[92:95], a[196:199], a[0:3]
    v_cvt_pk_bf16_f32 v236, v236, v237
    v_cvt_pk_bf16_f32 v237, v238, 0
    v_mfma_f32_16x16x32_bf16 a[0:3], v[224:227], a[200:203], a[0:3]
    v_accvgpr_read_b32 v252, a15
    v_accvgpr_read_b32 v253, a47
    v_mfma_f32_16x16x32_bf16 a[32:35], v[224:227], a[204:207], a[32:35]
    buffer_load_dwordx4 a[140:143], v251, s[60:63], s68 offen offset:0
    v_accvgpr_read_b32 v254, a79
    v_mfma_f32_16x16x32_bf16 a[32:35], v[92:95], a[208:211], a[32:35]
    ds_write_b64 v244, v[236:237] offset:12544
    v_cvt_pk_bf16_f32 v240, v240, v241
    v_mfma_f32_16x16x32_bf16 a[32:35], v[200:203], a[212:215], a[32:35]
    v_cvt_pk_bf16_f32 v241, v242, 0
    v_cvt_pk_bf16_f32 v252, v252, v253
    v_mfma_f32_16x16x32_bf16 a[32:35], v[80:83], a[192:195], a[32:35]
    v_cvt_pk_bf16_f32 v253, v254, 0
    ds_write_b64 v244, v[240:241] offset:12800
    v_mfma_f32_16x16x32_bf16 a[32:35], v[88:91], a[196:199], a[32:35]
    ds_write_b64 v244, v[252:253] offset:13056
    v_accvgpr_read_b32 v232, a8
    v_mfma_f32_16x16x32_bf16 a[32:35], v[228:231], a[200:203], a[32:35]
    buffer_load_dwordx4 a[144:147], v251, s[60:63], s65 offen offset:3072
    v_accvgpr_read_b32 v233, a40
    v_mfma_f32_16x16x32_bf16 a[64:67], v[228:231], a[204:207], a[64:67]
    v_accvgpr_read_b32 v234, a72
    v_accvgpr_read_b32 v236, a9
    v_mfma_f32_16x16x32_bf16 a[64:67], v[88:91], a[208:211], a[64:67]
    v_accvgpr_read_b32 v237, a41
    v_accvgpr_read_b32 v238, a73
    v_mfma_f32_16x16x32_bf16 a[64:67], v[80:83], a[212:215], a[64:67]
    v_cvt_pk_bf16_f32 v232, v232, v233
    v_cvt_pk_bf16_f32 v233, v234, 0
    v_accvgpr_read_b32 v240, a10
    v_mfma_f32_16x16x32_bf16 v[36:39], v[220:223], a[216:219], v[36:39]
    v_accvgpr_read_b32 v241, a42
    v_accvgpr_read_b32 v242, a74
    s_waitcnt vmcnt(18)
    v_mfma_f32_16x16x32_bf16 v[36:39], v[76:79], a[220:223], v[36:39]
    buffer_load_dwordx4 a[148:151], v251, s[60:63], s67 offen offset:3072
    ds_write_b64 v244, v[232:233] offset:8192
    v_cvt_pk_bf16_f32 v236, v236, v237
    v_mfma_f32_16x16x32_bf16 v[36:39], v[140:143], a[224:227], v[36:39]
    v_cvt_pk_bf16_f32 v237, v238, 0
    v_accvgpr_read_b32 v252, a11
    v_accvgpr_read_b32 v253, a43
    v_mfma_f32_16x16x32_bf16 v[36:39], v[132:135], a[228:231], v[36:39]
    v_accvgpr_read_b32 v254, a75
    ds_write_b64 v244, v[236:237] offset:8448
    v_cvt_pk_bf16_f32 v240, v240, v241
    v_mfma_f32_16x16x32_bf16 v[36:39], v[100:103], a[232:235], v[36:39]
    v_cvt_pk_bf16_f32 v241, v242, 0
    v_cvt_pk_bf16_f32 v252, v252, v253
    v_cvt_pk_bf16_f32 v253, v254, 0
    v_mfma_f32_16x16x32_bf16 v[36:39], v[172:175], a[240:243], v[36:39]
    ds_write_b64 v244, v[240:241] offset:8704
    ds_write_b64 v244, v[252:253] offset:8960
    v_accvgpr_read_b32 v232, a4
    v_mfma_f32_16x16x32_bf16 v[36:39], v[120:123], a[248:251], v[36:39]
    buffer_load_dwordx4 a[152:155], v251, s[60:63], s65 offen offset:2048
    v_accvgpr_read_b32 v233, a36
    v_accvgpr_read_b32 v234, a68
    v_mfma_f32_16x16x32_bf16 v[68:71], v[104:107], a[252:255], v[68:71]
    v_accvgpr_read_b32 v236, a5
    v_accvgpr_read_b32 v237, a37
    v_accvgpr_read_b32 v238, a69
    v_mfma_f32_16x16x32_bf16 v[68:71], v[96:99], a[100:103], v[68:71]
    v_cvt_pk_bf16_f32 v232, v232, v233
    v_cvt_pk_bf16_f32 v233, v234, 0
    s_waitcnt vmcnt(18)
    v_mfma_f32_16x16x32_bf16 v[68:71], v[116:119], a[96:99], v[68:71]
    v_accvgpr_read_b32 v240, a6
    v_accvgpr_read_b32 v241, a38
    s_waitcnt vmcnt(17)
    v_mfma_f32_16x16x32_bf16 v[68:71], v[124:127], a[108:111], v[68:71]
    v_accvgpr_read_b32 v242, a70
    ds_write_b64 v244, v[232:233] offset:4096
    s_waitcnt vmcnt(15)
    v_mfma_f32_16x16x32_bf16 v[68:71], v[112:115], a[104:107], v[68:71]
    buffer_load_dwordx4 a[156:159], v251, s[60:63], s67 offen offset:2048
    v_cvt_pk_bf16_f32 v236, v236, v237
    s_waitcnt vmcnt(14)
    v_mfma_f32_16x16x32_bf16 v[68:71], v[108:111], a[116:119], v[68:71]
    v_cvt_pk_bf16_f32 v237, v238, 0
    v_accvgpr_read_b32 v252, a7
    s_waitcnt vmcnt(12)
    v_mfma_f32_16x16x32_bf16 v[68:71], v[168:171], a[112:115], v[68:71]
    v_accvgpr_read_b32 v253, a39
    v_accvgpr_read_b32 v254, a71
    ds_write_b64 v244, v[236:237] offset:4352
    v_mfma_f32_16x16x32_bf16 v[32:35], v[76:79], a[216:219], v[32:35]
    v_cvt_pk_bf16_f32 v240, v240, v241
    v_cvt_pk_bf16_f32 v241, v242, 0
    v_cvt_pk_bf16_f32 v252, v252, v253
    v_mfma_f32_16x16x32_bf16 v[32:35], v[140:143], a[220:223], v[32:35]
    v_cvt_pk_bf16_f32 v253, v254, 0
    ds_write_b64 v244, v[240:241] offset:4608
    ds_write_b64 v244, v[252:253] offset:4864
    v_mfma_f32_16x16x32_bf16 v[32:35], v[132:135], a[224:227], v[32:35]
    v_cvt_pk_bf16_f32 v72, v36, v68
    v_cvt_pk_bf16_f32 v73, v37, v69
    v_cvt_pk_bf16_f32 v74, v38, v70
    v_mfma_f32_16x16x32_bf16 v[32:35], v[100:103], a[228:231], v[32:35]
    v_cvt_pk_bf16_f32 v75, v39, v71
    ds_write_b32 v245, v72 offset:28672
    ds_write_b32 v245, v73 offset:28928
    v_mfma_f32_16x16x32_bf16 v[32:35], v[172:175], a[232:235], v[32:35]
    ds_write_b32 v245, v74 offset:29184
    ds_write_b32 v245, v75 offset:29440
    v_accvgpr_read_b32 v232, a0
    v_mfma_f32_16x16x32_bf16 v[32:35], v[120:123], a[240:243], v[32:35]
    v_accvgpr_read_b32 v233, a32
    v_accvgpr_read_b32 v234, a64
    s_waitcnt vmcnt(9)
    v_mfma_f32_16x16x32_bf16 v[32:35], v[208:211], a[248:251], v[32:35]
    v_accvgpr_read_b32 v236, a1
    v_accvgpr_read_b32 v237, a33
    s_waitcnt vmcnt(8)
    v_mfma_f32_16x16x32_bf16 v[64:67], v[148:151], a[252:255], v[64:67]
    v_accvgpr_read_b32 v238, a65
    v_cvt_pk_bf16_f32 v232, v232, v233
    v_cvt_pk_bf16_f32 v233, v234, 0
    v_mfma_f32_16x16x32_bf16 v[64:67], v[104:107], a[100:103], v[64:67]
    s_waitcnt lgkmcnt(0)
    s_barrier
    ds_read_b128 v[84:87], v246 offset:28672
    ds_read_b128 v[88:91], v246 offset:28928
    v_mfma_f32_16x16x32_bf16 v[64:67], v[96:99], a[96:99], v[64:67]
    ds_read_b128 v[92:95], v246 offset:29184
    ds_read_b128 v[128:131], v246 offset:29440
    v_accvgpr_read_b32 v240, a2
    v_mfma_f32_16x16x32_bf16 v[64:67], v[116:119], a[108:111], v[64:67]
    v_accvgpr_read_b32 v241, a34
    v_accvgpr_read_b32 v242, a66
    ds_write_b64 v244, v[232:233] offset:0
    v_mfma_f32_16x16x32_bf16 v[64:67], v[124:127], a[104:107], v[64:67]
    v_cvt_pk_bf16_f32 v236, v236, v237
    v_cvt_pk_bf16_f32 v237, v238, 0
    v_accvgpr_read_b32 v252, a3
    v_mfma_f32_16x16x32_bf16 v[64:67], v[112:115], a[116:119], v[64:67]
    v_accvgpr_read_b32 v253, a35
    v_accvgpr_read_b32 v254, a67
    ds_write_b64 v244, v[236:237] offset:256
    v_mfma_f32_16x16x32_bf16 v[64:67], v[108:111], a[112:115], v[64:67]
    v_cvt_pk_bf16_f32 v240, v240, v241
    v_cvt_pk_bf16_f32 v241, v242, 0
    v_cvt_pk_bf16_f32 v252, v252, v253
    v_mfma_f32_16x16x32_bf16 v[28:31], v[140:143], a[216:219], v[28:31]
    v_cvt_pk_bf16_f32 v253, v254, 0
    ds_write_b64 v244, v[240:241] offset:512
    ds_write_b64 v244, v[252:253] offset:768
    v_mfma_f32_16x16x32_bf16 v[28:31], v[132:135], a[220:223], v[28:31]
    v_mfma_f32_16x16x32_bf16 v[28:31], v[100:103], a[224:227], v[28:31]
    v_cvt_pk_bf16_f32 v80, v32, v64
    v_cvt_pk_bf16_f32 v81, v33, v65
    v_cvt_pk_bf16_f32 v82, v34, v66
    v_mfma_f32_16x16x32_bf16 v[28:31], v[172:175], a[228:231], v[28:31]
    v_cvt_pk_bf16_f32 v83, v35, v67
    ds_write_b32 v245, v80 offset:24576
    ds_write_b32 v245, v81 offset:24832
    v_mfma_f32_16x16x32_bf16 v[28:31], v[120:123], a[232:235], v[28:31]
    ds_write_b32 v245, v82 offset:25088
    ds_write_b32 v245, v83 offset:25344
    s_waitcnt lgkmcnt(11)
    v_mfma_f32_16x16x32_bf16 v[160:163], v[84:87], v[4:7], 0
    v_mfma_f32_16x16x32_bf16 v[28:31], v[208:211], a[240:243], v[28:31]
    s_waitcnt lgkmcnt(10)
    v_mfma_f32_16x16x32_bf16 v[164:167], v[88:91], v[4:7], 0
    s_waitcnt lgkmcnt(9)
    v_mfma_f32_16x16x32_bf16 v[176:179], v[92:95], v[4:7], 0
    s_waitcnt lgkmcnt(8)
    v_mfma_f32_16x16x32_bf16 v[180:183], v[128:131], v[4:7], 0
    v_mfma_f32_16x16x32_bf16 v[28:31], a[236:239], a[248:251], v[28:31]
    v_mfma_f32_16x16x32_bf16 v[60:63], a[244:247], a[252:255], v[60:63]
    v_mfma_f32_16x16x32_bf16 v[60:63], v[148:151], a[100:103], v[60:63]
    s_waitcnt lgkmcnt(0)
    s_barrier
    ds_read_b128 v[136:139], v246 offset:24576
    ds_read_b128 v[144:147], v246 offset:24832
    v_mfma_f32_16x16x32_bf16 v[60:63], v[104:107], a[96:99], v[60:63]
    ds_read_b128 v[152:155], v246 offset:25088
    ds_read_b128 v[156:159], v246 offset:25344
    v_cvt_pk_bf16_f32 v160, v160, v161
    v_mfma_f32_16x16x32_bf16 v[60:63], v[96:99], a[108:111], v[60:63]
    v_cvt_pk_bf16_f32 v161, v162, v163
    v_cvt_pk_bf16_f32 v176, v176, v177
    v_cvt_pk_bf16_f32 v177, v178, v179
    v_mfma_f32_16x16x32_bf16 v[60:63], v[116:119], a[104:107], v[60:63]
    v_cvt_pk_bf16_f32 v162, v164, v165
    v_cvt_pk_bf16_f32 v163, v166, v167
    v_cvt_pk_bf16_f32 v178, v180, v181
    v_mfma_f32_16x16x32_bf16 v[60:63], v[124:127], a[116:119], v[60:63]
    v_cvt_pk_bf16_f32 v179, v182, v183
    v_permlane16_swap_b32 v160, v162
    v_permlane16_swap_b32 v161, v163
    v_mfma_f32_16x16x32_bf16 v[60:63], v[112:115], a[112:115], v[60:63]
    v_permlane16_swap_b32 v176, v178
    v_permlane16_swap_b32 v177, v179
    s_mov_b32 s33, 301056
    s_mov_b64 exec, s[94:95]
    buffer_store_dwordx4 v[160:163], v249, s[4:7], s33 offen
    buffer_store_dwordx4 v[176:179], v250, s[4:7], s33 offen
    s_mov_b64 exec, -1
    v_mfma_f32_16x16x32_bf16 v[24:27], v[132:135], a[216:219], v[24:27]
    v_mfma_f32_16x16x32_bf16 v[24:27], v[100:103], a[220:223], v[24:27]
    v_mfma_f32_16x16x32_bf16 v[24:27], v[172:175], a[224:227], v[24:27]
    v_cvt_pk_bf16_f32 v72, v28, v60
    v_cvt_pk_bf16_f32 v73, v29, v61
    v_cvt_pk_bf16_f32 v74, v30, v62
    v_mfma_f32_16x16x32_bf16 v[24:27], v[120:123], a[228:231], v[24:27]
    v_cvt_pk_bf16_f32 v75, v31, v63
    ds_write_b32 v245, v72 offset:20480
    ds_write_b32 v245, v73 offset:20736
    v_mfma_f32_16x16x32_bf16 v[24:27], v[208:211], a[232:235], v[24:27]
    ds_write_b32 v245, v74 offset:20992
    ds_write_b32 v245, v75 offset:21248
    s_waitcnt lgkmcnt(7)
    v_mfma_f32_16x16x32_bf16 v[184:187], v[136:139], v[4:7], 0
    v_mfma_f32_16x16x32_bf16 v[24:27], a[236:239], a[240:243], v[24:27]
    s_waitcnt lgkmcnt(6)
    v_mfma_f32_16x16x32_bf16 v[188:191], v[144:147], v[4:7], 0
    s_waitcnt lgkmcnt(5)
    v_mfma_f32_16x16x32_bf16 v[192:195], v[152:155], v[4:7], 0
    s_waitcnt lgkmcnt(4)
    v_mfma_f32_16x16x32_bf16 v[196:199], v[156:159], v[4:7], 0
    v_mfma_f32_16x16x32_bf16 v[24:27], a[124:127], a[248:251], v[24:27]
    v_mfma_f32_16x16x32_bf16 v[56:59], a[120:123], a[252:255], v[56:59]
    v_mfma_f32_16x16x32_bf16 v[56:59], a[244:247], a[100:103], v[56:59]
    s_waitcnt lgkmcnt(0)
    s_barrier
    ds_read_b128 v[84:87], v246 offset:20480
    ds_read_b128 v[88:91], v246 offset:20736
    v_mfma_f32_16x16x32_bf16 v[56:59], v[148:151], a[96:99], v[56:59]
    ds_read_b128 v[92:95], v246 offset:20992
    ds_read_b128 v[128:131], v246 offset:21248
    v_cvt_pk_bf16_f32 v184, v184, v185
    v_mfma_f32_16x16x32_bf16 v[56:59], v[104:107], a[108:111], v[56:59]
    v_cvt_pk_bf16_f32 v185, v186, v187
    v_cvt_pk_bf16_f32 v192, v192, v193
    v_cvt_pk_bf16_f32 v193, v194, v195
    v_mfma_f32_16x16x32_bf16 v[56:59], v[96:99], a[104:107], v[56:59]
    v_cvt_pk_bf16_f32 v186, v188, v189
    v_cvt_pk_bf16_f32 v187, v190, v191
    v_cvt_pk_bf16_f32 v194, v196, v197
    v_mfma_f32_16x16x32_bf16 v[56:59], v[116:119], a[116:119], v[56:59]
    v_cvt_pk_bf16_f32 v195, v198, v199
    v_permlane16_swap_b32 v184, v186
    v_permlane16_swap_b32 v185, v187
    v_mfma_f32_16x16x32_bf16 v[56:59], v[124:127], a[112:115], v[56:59]
    v_permlane16_swap_b32 v192, v194
    v_permlane16_swap_b32 v193, v195
    s_mov_b32 s33, 258048
    s_mov_b64 exec, s[94:95]
    buffer_store_dwordx4 v[184:187], v249, s[4:7], s33 offen
    buffer_store_dwordx4 v[192:195], v250, s[4:7], s33 offen
    s_mov_b64 exec, -1
    v_mfma_f32_16x16x32_bf16 v[20:23], v[100:103], a[216:219], v[20:23]
    v_mfma_f32_16x16x32_bf16 v[20:23], v[172:175], a[220:223], v[20:23]
    v_mfma_f32_16x16x32_bf16 v[20:23], v[120:123], a[224:227], v[20:23]
    v_cvt_pk_bf16_f32 v80, v24, v56
    v_cvt_pk_bf16_f32 v81, v25, v57
    v_cvt_pk_bf16_f32 v82, v26, v58
    v_mfma_f32_16x16x32_bf16 v[20:23], v[208:211], a[228:231], v[20:23]
    v_cvt_pk_bf16_f32 v83, v27, v59
    ds_write_b32 v245, v80 offset:16384
    ds_write_b32 v245, v81 offset:16640
    v_mfma_f32_16x16x32_bf16 v[20:23], a[236:239], a[232:235], v[20:23]
    ds_write_b32 v245, v82 offset:16896
    ds_write_b32 v245, v83 offset:17152
    s_waitcnt lgkmcnt(7)
    v_mfma_f32_16x16x32_bf16 v[160:163], v[84:87], v[4:7], 0
    v_mfma_f32_16x16x32_bf16 v[20:23], a[124:127], a[240:243], v[20:23]
    s_waitcnt lgkmcnt(6)
    v_mfma_f32_16x16x32_bf16 v[164:167], v[88:91], v[4:7], 0
    s_waitcnt lgkmcnt(5)
    v_mfma_f32_16x16x32_bf16 v[176:179], v[92:95], v[4:7], 0
    s_waitcnt vmcnt(11)
    v_mfma_f32_16x16x32_bf16 v[20:23], a[128:131], a[248:251], v[20:23]
    s_waitcnt lgkmcnt(4)
    v_mfma_f32_16x16x32_bf16 v[180:183], v[128:131], v[4:7], 0
    s_waitcnt vmcnt(10)
    v_mfma_f32_16x16x32_bf16 v[52:55], a[132:135], a[252:255], v[52:55]
    v_mfma_f32_16x16x32_bf16 v[52:55], a[120:123], a[100:103], v[52:55]
    s_waitcnt lgkmcnt(0)
    s_barrier
    ds_read_b128 v[136:139], v246 offset:16384
    ds_read_b128 v[144:147], v246 offset:16640
    v_mfma_f32_16x16x32_bf16 v[52:55], a[244:247], a[96:99], v[52:55]
    ds_read_b128 v[152:155], v246 offset:16896
    ds_read_b128 v[156:159], v246 offset:17152
    v_cvt_pk_bf16_f32 v160, v160, v161
    v_mfma_f32_16x16x32_bf16 v[52:55], v[148:151], a[108:111], v[52:55]
    v_cvt_pk_bf16_f32 v161, v162, v163
    v_cvt_pk_bf16_f32 v176, v176, v177
    v_cvt_pk_bf16_f32 v177, v178, v179
    v_mfma_f32_16x16x32_bf16 v[52:55], v[104:107], a[104:107], v[52:55]
    v_cvt_pk_bf16_f32 v162, v164, v165
    v_cvt_pk_bf16_f32 v163, v166, v167
    v_cvt_pk_bf16_f32 v178, v180, v181
    v_mfma_f32_16x16x32_bf16 v[52:55], v[96:99], a[116:119], v[52:55]
    v_cvt_pk_bf16_f32 v179, v182, v183
    v_permlane16_swap_b32 v160, v162
    v_permlane16_swap_b32 v161, v163
    v_mfma_f32_16x16x32_bf16 v[52:55], v[116:119], a[112:115], v[52:55]
    v_permlane16_swap_b32 v176, v178
    v_permlane16_swap_b32 v177, v179
    s_mov_b32 s33, 215040
    s_mov_b64 exec, s[94:95]
    buffer_store_dwordx4 v[160:163], v249, s[4:7], s33 offen
    buffer_store_dwordx4 v[176:179], v250, s[4:7], s33 offen
    s_mov_b64 exec, -1
    v_mfma_f32_16x16x32_bf16 v[16:19], v[172:175], a[216:219], v[16:19]
    v_mfma_f32_16x16x32_bf16 v[16:19], v[120:123], a[220:223], v[16:19]
    v_mfma_f32_16x16x32_bf16 v[16:19], v[208:211], a[224:227], v[16:19]
    v_cvt_pk_bf16_f32 v72, v20, v52
    v_cvt_pk_bf16_f32 v73, v21, v53
    v_cvt_pk_bf16_f32 v74, v22, v54
    v_mfma_f32_16x16x32_bf16 v[16:19], a[236:239], a[228:231], v[16:19]
    v_cvt_pk_bf16_f32 v75, v23, v55
    ds_write_b32 v245, v72 offset:12288
    ds_write_b32 v245, v73 offset:12544
    v_mfma_f32_16x16x32_bf16 v[16:19], a[124:127], a[232:235], v[16:19]
    ds_write_b32 v245, v74 offset:12800
    ds_write_b32 v245, v75 offset:13056
    s_waitcnt lgkmcnt(7)
    v_mfma_f32_16x16x32_bf16 v[184:187], v[136:139], v[4:7], 0
    v_mfma_f32_16x16x32_bf16 v[16:19], a[128:131], a[240:243], v[16:19]
    s_waitcnt lgkmcnt(6)
    v_mfma_f32_16x16x32_bf16 v[188:191], v[144:147], v[4:7], 0
    s_waitcnt lgkmcnt(5)
    v_mfma_f32_16x16x32_bf16 v[192:195], v[152:155], v[4:7], 0
    s_waitcnt vmcnt(11)
    v_mfma_f32_16x16x32_bf16 v[16:19], a[136:139], a[248:251], v[16:19]
    s_waitcnt lgkmcnt(4)
    v_mfma_f32_16x16x32_bf16 v[196:199], v[156:159], v[4:7], 0
    s_waitcnt vmcnt(10)
    v_mfma_f32_16x16x32_bf16 v[48:51], a[140:143], a[252:255], v[48:51]
    v_mfma_f32_16x16x32_bf16 v[48:51], a[132:135], a[100:103], v[48:51]
    s_waitcnt lgkmcnt(0)
    s_barrier
    ds_read_b128 v[84:87], v246 offset:12288
    ds_read_b128 v[88:91], v246 offset:12544
    v_mfma_f32_16x16x32_bf16 v[48:51], a[120:123], a[96:99], v[48:51]
    ds_read_b128 v[92:95], v246 offset:12800
    ds_read_b128 v[128:131], v246 offset:13056
    v_cvt_pk_bf16_f32 v184, v184, v185
    v_mfma_f32_16x16x32_bf16 v[48:51], a[244:247], a[108:111], v[48:51]
    v_cvt_pk_bf16_f32 v185, v186, v187
    v_cvt_pk_bf16_f32 v192, v192, v193
    v_cvt_pk_bf16_f32 v193, v194, v195
    v_mfma_f32_16x16x32_bf16 v[48:51], v[148:151], a[104:107], v[48:51]
    v_cvt_pk_bf16_f32 v186, v188, v189
    v_cvt_pk_bf16_f32 v187, v190, v191
    v_cvt_pk_bf16_f32 v194, v196, v197
    v_mfma_f32_16x16x32_bf16 v[48:51], v[104:107], a[116:119], v[48:51]
    v_cvt_pk_bf16_f32 v195, v198, v199
    v_permlane16_swap_b32 v184, v186
    v_permlane16_swap_b32 v185, v187
    v_mfma_f32_16x16x32_bf16 v[48:51], v[96:99], a[112:115], v[48:51]
    v_permlane16_swap_b32 v192, v194
    v_permlane16_swap_b32 v193, v195
    s_mov_b32 s33, 172032
    s_mov_b64 exec, s[94:95]
    buffer_store_dwordx4 v[184:187], v249, s[4:7], s33 offen
    buffer_store_dwordx4 v[192:195], v250, s[4:7], s33 offen
    s_mov_b64 exec, -1
    v_mfma_f32_16x16x32_bf16 v[12:15], v[120:123], a[216:219], v[12:15]
    v_mfma_f32_16x16x32_bf16 v[12:15], v[208:211], a[220:223], v[12:15]
    v_mfma_f32_16x16x32_bf16 v[12:15], a[236:239], a[224:227], v[12:15]
    v_cvt_pk_bf16_f32 v80, v16, v48
    v_cvt_pk_bf16_f32 v81, v17, v49
    v_cvt_pk_bf16_f32 v82, v18, v50
    v_mfma_f32_16x16x32_bf16 v[12:15], a[124:127], a[228:231], v[12:15]
    v_cvt_pk_bf16_f32 v83, v19, v51
    ds_write_b32 v245, v80 offset:8192
    ds_write_b32 v245, v81 offset:8448
    v_mfma_f32_16x16x32_bf16 v[12:15], a[128:131], a[232:235], v[12:15]
    ds_write_b32 v245, v82 offset:8704
    ds_write_b32 v245, v83 offset:8960
    s_waitcnt lgkmcnt(7)
    v_mfma_f32_16x16x32_bf16 v[160:163], v[84:87], v[4:7], 0
    v_mfma_f32_16x16x32_bf16 v[12:15], a[136:139], a[240:243], v[12:15]
    s_waitcnt lgkmcnt(6)
    v_mfma_f32_16x16x32_bf16 v[164:167], v[88:91], v[4:7], 0
    s_waitcnt lgkmcnt(5)
    v_mfma_f32_16x16x32_bf16 v[176:179], v[92:95], v[4:7], 0
    s_waitcnt vmcnt(11)
    v_mfma_f32_16x16x32_bf16 v[12:15], a[144:147], a[248:251], v[12:15]
    s_waitcnt lgkmcnt(4)
    v_mfma_f32_16x16x32_bf16 v[180:183], v[128:131], v[4:7], 0
    s_waitcnt vmcnt(10)
    v_mfma_f32_16x16x32_bf16 v[44:47], a[148:151], a[252:255], v[44:47]
    v_mfma_f32_16x16x32_bf16 v[44:47], a[140:143], a[100:103], v[44:47]
    s_waitcnt lgkmcnt(0)
    s_barrier
    ds_read_b128 v[136:139], v246 offset:8192
    ds_read_b128 v[144:147], v246 offset:8448
    v_mfma_f32_16x16x32_bf16 v[44:47], a[132:135], a[96:99], v[44:47]
    ds_read_b128 v[152:155], v246 offset:8704
    ds_read_b128 v[156:159], v246 offset:8960
    v_cvt_pk_bf16_f32 v160, v160, v161
    v_mfma_f32_16x16x32_bf16 v[44:47], a[120:123], a[108:111], v[44:47]
    v_cvt_pk_bf16_f32 v161, v162, v163
    v_cvt_pk_bf16_f32 v176, v176, v177
    v_cvt_pk_bf16_f32 v177, v178, v179
    v_mfma_f32_16x16x32_bf16 v[44:47], a[244:247], a[104:107], v[44:47]
    v_cvt_pk_bf16_f32 v162, v164, v165
    v_cvt_pk_bf16_f32 v163, v166, v167
    v_cvt_pk_bf16_f32 v178, v180, v181
    v_mfma_f32_16x16x32_bf16 v[44:47], v[148:151], a[116:119], v[44:47]
    v_cvt_pk_bf16_f32 v179, v182, v183
    v_permlane16_swap_b32 v160, v162
    v_permlane16_swap_b32 v161, v163
    v_mfma_f32_16x16x32_bf16 v[44:47], v[104:107], a[112:115], v[44:47]
    v_permlane16_swap_b32 v176, v178
    v_permlane16_swap_b32 v177, v179
    s_mov_b32 s33, 129024
    s_mov_b64 exec, s[94:95]
    buffer_store_dwordx4 v[160:163], v249, s[4:7], s33 offen
    buffer_store_dwordx4 v[176:179], v250, s[4:7], s33 offen
    s_mov_b64 exec, -1
    v_mfma_f32_16x16x32_bf16 v[8:11], v[208:211], a[216:219], v[8:11]
    v_mfma_f32_16x16x32_bf16 v[8:11], a[236:239], a[220:223], v[8:11]
    v_mfma_f32_16x16x32_bf16 v[8:11], a[124:127], a[224:227], v[8:11]
    v_cvt_pk_bf16_f32 v72, v12, v44
    v_cvt_pk_bf16_f32 v73, v13, v45
    v_cvt_pk_bf16_f32 v74, v14, v46
    v_mfma_f32_16x16x32_bf16 v[8:11], a[128:131], a[228:231], v[8:11]
    v_cvt_pk_bf16_f32 v75, v15, v47
    ds_write_b32 v245, v72 offset:4096
    ds_write_b32 v245, v73 offset:4352
    v_mfma_f32_16x16x32_bf16 v[8:11], a[136:139], a[232:235], v[8:11]
    ds_write_b32 v245, v74 offset:4608
    ds_write_b32 v245, v75 offset:4864
    s_waitcnt lgkmcnt(7)
    v_mfma_f32_16x16x32_bf16 v[184:187], v[136:139], v[4:7], 0
    v_mfma_f32_16x16x32_bf16 v[8:11], a[144:147], a[240:243], v[8:11]
    s_waitcnt lgkmcnt(6)
    v_mfma_f32_16x16x32_bf16 v[188:191], v[144:147], v[4:7], 0
    s_waitcnt lgkmcnt(5)
    v_mfma_f32_16x16x32_bf16 v[192:195], v[152:155], v[4:7], 0
    s_waitcnt vmcnt(10)
    v_mfma_f32_16x16x32_bf16 v[8:11], a[152:155], a[248:251], v[8:11]
    s_waitcnt lgkmcnt(4)
    v_mfma_f32_16x16x32_bf16 v[196:199], v[156:159], v[4:7], 0
    v_mfma_f32_16x16x32_bf16 v[40:43], a[156:159], a[252:255], v[40:43]
    v_mfma_f32_16x16x32_bf16 v[40:43], a[148:151], a[100:103], v[40:43]
    s_waitcnt lgkmcnt(0)
    s_barrier
    ds_read_b128 v[84:87], v246 offset:4096
    ds_read_b128 v[88:91], v246 offset:4352
    v_mfma_f32_16x16x32_bf16 v[40:43], a[140:143], a[96:99], v[40:43]
    ds_read_b128 v[92:95], v246 offset:4608
    ds_read_b128 v[128:131], v246 offset:4864
    v_cvt_pk_bf16_f32 v184, v184, v185
    v_mfma_f32_16x16x32_bf16 v[40:43], a[132:135], a[108:111], v[40:43]
    v_cvt_pk_bf16_f32 v185, v186, v187
    v_cvt_pk_bf16_f32 v192, v192, v193
    v_cvt_pk_bf16_f32 v193, v194, v195
    v_mfma_f32_16x16x32_bf16 v[40:43], a[120:123], a[104:107], v[40:43]
    v_cvt_pk_bf16_f32 v186, v188, v189
    v_cvt_pk_bf16_f32 v187, v190, v191
    v_cvt_pk_bf16_f32 v194, v196, v197
    v_mfma_f32_16x16x32_bf16 v[40:43], a[244:247], a[116:119], v[40:43]
    v_cvt_pk_bf16_f32 v195, v198, v199
    v_permlane16_swap_b32 v184, v186
    v_permlane16_swap_b32 v185, v187
    v_mfma_f32_16x16x32_bf16 v[40:43], v[148:151], a[112:115], v[40:43]
    s_nop 7
    v_cvt_pk_bf16_f32 v80, v8, v40
    v_cvt_pk_bf16_f32 v81, v9, v41
    v_cvt_pk_bf16_f32 v82, v10, v42
    v_cvt_pk_bf16_f32 v83, v11, v43
    ds_write_b32 v245, v80 offset:0
    ds_write_b32 v245, v81 offset:256
    ds_write_b32 v245, v82 offset:512
    ds_write_b32 v245, v83 offset:768
    s_waitcnt lgkmcnt(0)
    s_barrier
    ds_read_b128 v[12:15], v246 offset:0
    ds_read_b128 v[16:19], v246 offset:256
    ds_read_b128 v[20:23], v246 offset:512
    ds_read_b128 v[24:27], v246 offset:768
    v_permlane16_swap_b32 v192, v194
    v_permlane16_swap_b32 v193, v195
    s_mov_b32 s33, 86016
    s_mov_b64 exec, s[94:95]
    buffer_store_dwordx4 v[184:187], v249, s[4:7], s33 offen
    buffer_store_dwordx4 v[192:195], v250, s[4:7], s33 offen
    s_mov_b64 exec, -1
    v_mfma_f32_16x16x32_bf16 v[160:163], v[84:87], v[4:7], 0
    v_mfma_f32_16x16x32_bf16 v[164:167], v[88:91], v[4:7], 0
    v_mfma_f32_16x16x32_bf16 v[176:179], v[92:95], v[4:7], 0
    v_mfma_f32_16x16x32_bf16 v[180:183], v[128:131], v[4:7], 0
    s_nop 4
    v_cvt_pk_bf16_f32 v160, v160, v161
    v_cvt_pk_bf16_f32 v161, v162, v163
    v_cvt_pk_bf16_f32 v176, v176, v177
    v_cvt_pk_bf16_f32 v177, v178, v179
    v_cvt_pk_bf16_f32 v162, v164, v165
    v_cvt_pk_bf16_f32 v163, v166, v167
    v_cvt_pk_bf16_f32 v178, v180, v181
    v_cvt_pk_bf16_f32 v179, v182, v183
    v_permlane16_swap_b32 v160, v162
    v_permlane16_swap_b32 v161, v163
    v_permlane16_swap_b32 v176, v178
    v_permlane16_swap_b32 v177, v179
    s_mov_b32 s33, 43008
    s_mov_b64 exec, s[94:95]
    buffer_store_dwordx4 v[160:163], v249, s[4:7], s33 offen
    buffer_store_dwordx4 v[176:179], v250, s[4:7], s33 offen
    s_mov_b64 exec, -1
    s_waitcnt lgkmcnt(3)
    v_mfma_f32_16x16x32_bf16 v[100:103], v[12:15], v[4:7], 0
    s_waitcnt lgkmcnt(2)
    v_mfma_f32_16x16x32_bf16 v[104:107], v[16:19], v[4:7], 0
    s_waitcnt lgkmcnt(1)
    v_mfma_f32_16x16x32_bf16 v[108:111], v[20:23], v[4:7], 0
    s_waitcnt lgkmcnt(0)
    v_mfma_f32_16x16x32_bf16 v[112:115], v[24:27], v[4:7], 0
    s_nop 1
    v_cvt_pk_bf16_f32 v100, v100, v101
    v_cvt_pk_bf16_f32 v101, v102, v103
    s_nop 1
    v_cvt_pk_bf16_f32 v108, v108, v109
    v_cvt_pk_bf16_f32 v109, v110, v111
    v_cvt_pk_bf16_f32 v102, v104, v105
    v_cvt_pk_bf16_f32 v103, v106, v107
    v_cvt_pk_bf16_f32 v110, v112, v113
    v_cvt_pk_bf16_f32 v111, v114, v115
    v_permlane16_swap_b32 v100, v102
    v_permlane16_swap_b32 v101, v103
    v_permlane16_swap_b32 v108, v110
    v_permlane16_swap_b32 v109, v111
    s_mov_b32 s33, 0
    s_mov_b64 exec, s[94:95]
    buffer_store_dwordx4 v[100:103], v249, s[4:7], s33 offen
    buffer_store_dwordx4 v[108:111], v250, s[4:7], s33 offen
    s_mov_b64 exec, -1
K2_end:
    s_endpgm
.p2align 8
K2_at:
    .long 0x00003f48, 0x0000bf48, 0x00003f40, 0x0000bf40, 0xbf103f0c, 0x0000bf0c, 0xbf3a3e3f, 0x0000be3f
    .long 0xbf48bcb3, 0x00003cb3, 0xbeb9bf28, 0x00003f28, 0xbf08bf13, 0x00003f13, 0x3f0cbf04, 0x00003f04
    .long 0x3d33bf48, 0x00003f48, 0x3f223ece, 0x0000bece, 0x3f17bf03, 0x00003f03, 0xbe6d3f37, 0x0000bf37
    .long 0x3f483d86, 0x0000bd86, 0xbf40bd41, 0x00003d41, 0x3efe3f1b, 0x0000bf1b, 0xbe10bf3d, 0x00003f3d
    .long 0xbdb33f47, 0x0000bf47, 0x3f2ebea4, 0x00003ea4, 0xbf1e3ef6, 0x0000bef6, 0x3ef53f14, 0x0000bf14
    .long 0x00000000, 0x00000000, 0x00000000, 0x00000000, 0x00000000, 0x00000000, 0x00000000, 0x00000000
    .long 0x00000000, 0x00000000, 0x00000000, 0x00000000, 0x00000000, 0x00000000, 0x00000000, 0x00000000
    .long 0x00000000, 0x00000000, 0x00000000, 0x00000000, 0x00000000, 0x00000000, 0x00000000, 0x00000000
    .long 0x00003f40, 0x0000bf40, 0x00003f48, 0x0000bf48, 0xbf3abe3f, 0x00003e3f, 0xbf10bf0c, 0x00003f0c
    .long 0x3eb9bf28, 0x00003f28, 0x3f48bcb3, 0x00003cb3, 0x3f0c3f04, 0x0000bf04, 0xbf083f13, 0x0000bf13
    .long 0xbf223ece, 0x0000bece, 0xbd33bf48, 0x00003f48, 0xbe6dbf37, 0x00003f37, 0x3f173f03, 0x0000bf03
    .long 0x3f40bd41, 0x00003d41, 0xbf483d86, 0x0000bd86, 0xbe103f3d, 0x0000bf3d, 0x3efebf1b, 0x00003f1b
    .long 0xbf2ebea4, 0x00003ea4, 0x3db33f47, 0x0000bf47, 0x3ef5bf14, 0x00003f14, 0xbf1ebef6, 0x00003ef6
    .long 0x00000000, 0x00000000, 0x00000000, 0x00000000, 0x00000000, 0x00000000, 0x00000000, 0x00000000
    .long 0x00000000, 0x00000000, 0x00000000, 0x00000000, 0x00000000, 0x00000000, 0x00000000, 0x00000000
    .long 0x00000000, 0x00000000, 0x00000000, 0x00000000, 0x00000000, 0x00000000, 0x00000000, 0x00000000
    .long 0x00004045, 0x3fb73fb7, 0x3dc33dc3, 0x40254025, 0x00000000, 0xbfb73fb7, 0xbe0d3e0d, 0xbfe53fe5
    .long 0x00000000, 0x3fb73fb7, 0x3e4b3e4b, 0x3f9f3f9f, 0x00000000, 0xbfb73fb7, 0xbe923e92, 0xbf5c3f5c
    .long 0x00000000, 0x3fb73fb7, 0x3ed33ed3, 0x3f183f18, 0x00000000, 0xbfb73fb7, 0xbf183f18, 0xbed33ed3
    .long 0x00000000, 0x3fb73fb7, 0x3f5c3f5c, 0x3e923e92, 0x00000000, 0xbfb73fb7, 0xbf9f3f9f, 0xbe4b3e4b
    .long 0x00000000, 0x3fb73fb7, 0x3fe53fe5, 0x3e0d3e0d, 0x40450000, 0xbfb73fb7, 0xc0254025, 0xbdc33dc3
    .long 0x00000000, 0x00000000, 0x00000000, 0x00000000, 0x00000000, 0x00000000, 0x00000000, 0x00000000
    .long 0x00000000, 0x00000000, 0x00000000, 0x00000000, 0x00000000, 0x00000000, 0x00000000, 0x00000000
    .long 0x00000000, 0x00000000, 0x00000000, 0x00000000, 0x00000000, 0x00000000, 0x00000000, 0x00000000
    .long 0x00000000, 0x00000000, 0x00000000, 0x00000000, 0x00000000, 0x00000000, 0x00000000, 0x00000000
    .long 0x00000000, 0x00000000, 0x00000000, 0x00000000, 0x00000000, 0x00000000, 0x00000000, 0x00000000
    .long 0x00000000, 0x00000000, 0x00000000, 0x00000000, 0x00000000, 0x00000000, 0x00000000, 0x00000000
    .long 0x00000000, 0x00000000, 0x00000000, 0x00000000, 0x00000000, 0x00000000, 0x00000000, 0x00000000
    .long 0x00000000, 0x00000000, 0x00000000, 0x00000000, 0x00000000, 0x00000000, 0x00000000, 0x00000000
    .long 0x00000000, 0x00000000, 0x00000000, 0x00000000, 0x00000000, 0x00000000, 0x00000000, 0x00000000
    .long 0x00000000, 0x00000000, 0x00000000, 0x00000000, 0x00000000, 0x00000000, 0x00000000, 0x00000000
    .long 0x00000000, 0x00000000, 0x00000000, 0x00000000, 0x00000000, 0x00000000, 0x00000000, 0x00000000
    .long 0x00003f48, 0x0000bf48, 0x00003f40, 0x0000bf40, 0xbf103f0c, 0x0000bf0c, 0xbf3a3e3f, 0x0000be3f
    .long 0xbf48bcb3, 0x00003cb3, 0xbeb9bf28, 0x00003f28, 0xbf08bf13, 0x00003f13, 0x3f0cbf04, 0x00003f04
    .long 0x3d33bf48, 0x00003f48, 0x3f223ece, 0x0000bece, 0x3f17bf03, 0x00003f03, 0xbe6d3f37, 0x0000bf37
    .long 0x3f483d86, 0x0000bd86, 0xbf40bd41, 0x00003d41, 0x3efe3f1b, 0x0000bf1b, 0xbe10bf3d, 0x00003f3d
    .long 0xbdb33f47, 0x0000bf47, 0x3f2ebea4, 0x00003ea4, 0xbf1e3ef6, 0x0000bef6, 0x3ef53f14, 0x0000bf14
    .long 0x00000000, 0x00000000, 0x00000000, 0x00000000, 0x00000000, 0x00000000, 0x00000000, 0x00000000
    .long 0x00000000, 0x00000000, 0x00000000, 0x00000000, 0x00000000, 0x00000000, 0x00000000, 0x00000000
    .long 0x00000000, 0x00000000, 0x00000000, 0x00000000, 0x00000000, 0x00000000, 0x00000000, 0x00000000
    .long 0x00003f40, 0x0000bf40, 0x00003f48, 0x0000bf48, 0xbf3abe3f, 0x00003e3f, 0xbf10bf0c, 0x00003f0c
    .long 0x3eb9bf28, 0x00003f28, 0x3f48bcb3, 0x00003cb3, 0x3f0c3f04, 0x0000bf04, 0xbf083f13, 0x0000bf13
    .long 0xbf223ece, 0x0000bece, 0xbd33bf48, 0x00003f48, 0xbe6dbf37, 0x00003f37, 0x3f173f03, 0x0000bf03
    .long 0x3f40bd41, 0x00003d41, 0xbf483d86, 0x0000bd86, 0xbe103f3d, 0x0000bf3d, 0x3efebf1b, 0x00003f1b
    .long 0xbf2ebea4, 0x00003ea4, 0x3db33f47, 0x0000bf47, 0x3ef5bf14, 0x00003f14, 0xbf1ebef6, 0x00003ef6
    .long 0x00000000, 0x00000000, 0x00000000, 0x00000000, 0x00000000, 0x00000000, 0x00000000, 0x00000000
    .long 0x00000000, 0x00000000, 0x00000000, 0x00000000, 0x00000000, 0x00000000, 0x00000000, 0x00000000
    .long 0x00000000, 0x00000000, 0x00000000, 0x00000000, 0x00000000, 0x00000000, 0x00000000, 0x00000000
    .long 0x3fb73fb7, 0x00004045, 0x40254025, 0x3dc33dc3, 0xbfb73fb7, 0x00000000, 0xbfe53fe5, 0xbe0d3e0d
    .long 0x3fb73fb7, 0x00000000, 0x3f9f3f9f, 0x3e4b3e4b, 0xbfb73fb7, 0x00000000, 0xbf5c3f5c, 0xbe923e92
    .long 0x3fb73fb7, 0x00000000, 0x3f183f18, 0x3ed33ed3, 0xbfb73fb7, 0x00000000, 0xbed33ed3, 0xbf183f18
    .long 0x3fb73fb7, 0x00000000, 0x3e923e92, 0x3f5c3f5c, 0xbfb73fb7, 0x00000000, 0xbe4b3e4b, 0xbf9f3f9f
    .long 0x3fb73fb7, 0x00000000, 0x3e0d3e0d, 0x3fe53fe5, 0xbfb73fb7, 0x40450000, 0xbdc33dc3, 0xc0254025
    .long 0x00000000, 0x00000000, 0x00000000, 0x00000000, 0x00000000, 0x00000000, 0x00000000, 0x00000000
    .long 0x00000000, 0x00000000, 0x00000000, 0x00000000, 0x00000000, 0x00000000, 0x00000000, 0x00000000
    .long 0x00000000, 0x00000000, 0x00000000, 0x00000000, 0x00000000, 0x00000000, 0x00000000, 0x00000000
    .long 0x00000000, 0x00000000, 0x00000000, 0x00000000, 0x00000000, 0x00000000, 0x00000000, 0x00000000
    .long 0x00000000, 0x00000000, 0x00000000, 0x00000000, 0x00000000, 0x00000000, 0x00000000, 0x00000000
    .long 0x00000000, 0x00000000, 0x00000000, 0x00000000, 0x00000000, 0x00000000, 0x00000000, 0x00000000
    .long 0x00000000, 0x00000000, 0x00000000, 0x00000000, 0x00000000, 0x00000000, 0x00000000, 0x00000000
    .long 0x00000000, 0x00000000, 0x00000000, 0x00000000, 0x00000000, 0x00000000, 0x00000000, 0x00000000
    .long 0x00000000, 0x00000000, 0x00000000, 0x00000000, 0x00000000, 0x00000000, 0x00000000, 0x00000000
    .long 0x00000000, 0x00000000, 0x00000000, 0x00000000, 0x00000000, 0x00000000, 0x00000000, 0x00000000
    .long 0x00000000, 0x00000000, 0x00000000, 0x00000000, 0x00000000, 0x00000000, 0x00000000, 0x00000000
    .long 0x00003f48, 0x0000bf48, 0x00003f40, 0x0000bf40, 0xbf103f0c, 0x0000bf0c, 0xbf3a3e3f, 0x0000be3f
    .long 0xbf48bcb3, 0x00003cb3, 0xbeb9bf28, 0x00003f28, 0xbf08bf13, 0x00003f13, 0x3f0cbf04, 0x00003f04
    .long 0x3d33bf48, 0x00003f48, 0x3f223ece, 0x0000bece, 0x3f17bf03, 0x00003f03, 0xbe6d3f37, 0x0000bf37
    .long 0x3f483d86, 0x0000bd86, 0xbf40bd41, 0x00003d41, 0x3efe3f1b, 0x0000bf1b, 0xbe10bf3d, 0x00003f3d
    .long 0xbdb33f47, 0x0000bf47, 0x3f2ebea4, 0x00003ea4, 0xbf1e3ef6, 0x0000bef6, 0x3ef53f14, 0x0000bf14
    .long 0x00000000, 0x00000000, 0x00000000, 0x00000000, 0x00000000, 0x00000000, 0x00000000, 0x00000000
    .long 0x00000000, 0x00000000, 0x00000000, 0x00000000, 0x00000000, 0x00000000, 0x00000000, 0x00000000
    .long 0x00000000, 0x00000000, 0x00000000, 0x00000000, 0x00000000, 0x00000000, 0x00000000, 0x00000000
    .long 0x00003f40, 0x0000bf40, 0x00003f48, 0x0000bf48, 0xbf3abe3f, 0x00003e3f, 0xbf10bf0c, 0x00003f0c
    .long 0x3eb9bf28, 0x00003f28, 0x3f48bcb3, 0x00003cb3, 0x3f0c3f04, 0x0000bf04, 0xbf083f13, 0x0000bf13
    .long 0xbf223ece, 0x0000bece, 0xbd33bf48, 0x00003f48, 0xbe6dbf37, 0x00003f37, 0x3f173f03, 0x0000bf03
    .long 0x3f40bd41, 0x00003d41, 0xbf483d86, 0x0000bd86, 0xbe103f3d, 0x0000bf3d, 0x3efebf1b, 0x00003f1b
    .long 0xbf2ebea4, 0x00003ea4, 0x3db33f47, 0x0000bf47, 0x3ef5bf14, 0x00003f14, 0xbf1ebef6, 0x00003ef6
    .long 0x00000000, 0x00000000, 0x00000000, 0x00000000, 0x00000000, 0x00000000, 0x00000000, 0x00000000
    .long 0x00000000, 0x00000000, 0x00000000, 0x00000000, 0x00000000, 0x00000000, 0x00000000, 0x00000000
    .long 0x00000000, 0x00000000, 0x00000000, 0x00000000, 0x00000000, 0x00000000, 0x00000000, 0x00000000
    .long 0x3dc33dc3, 0x40254025, 0x00004045, 0x3fb73fb7, 0xbe0d3e0d, 0xbfe53fe5, 0x00000000, 0xbfb73fb7
    .long 0x3e4b3e4b, 0x3f9f3f9f, 0x00000000, 0x3fb73fb7, 0xbe923e92, 0xbf5c3f5c, 0x00000000, 0xbfb73fb7
    .long 0x3ed33ed3, 0x3f183f18, 0x00000000, 0x3fb73fb7, 0xbf183f18, 0xbed33ed3, 0x00000000, 0xbfb73fb7
    .long 0x3f5c3f5c, 0x3e923e92, 0x00000000, 0x3fb73fb7, 0xbf9f3f9f, 0xbe4b3e4b, 0x00000000, 0xbfb73fb7
    .long 0x3fe53fe5, 0x3e0d3e0d, 0x00000000, 0x3fb73fb7, 0xc0254025, 0xbdc33dc3, 0x40450000, 0xbfb73fb7
    .long 0x00000000, 0x00000000, 0x00000000, 0x00000000, 0x00000000, 0x00000000, 0x00000000, 0x00000000
    .long 0x00000000, 0x00000000, 0x00000000, 0x00000000, 0x00000000, 0x00000000, 0x00000000, 0x00000000
    .long 0x00000000, 0x00000000, 0x00000000, 0x00000000, 0x00000000, 0x00000000, 0x00000000, 0x00000000
    .long 0x00000000, 0x00000000, 0x00000000, 0x00000000, 0x00000000, 0x00000000, 0x00000000, 0x00000000
    .long 0x00000000, 0x00000000, 0x00000000, 0x00000000, 0x00000000, 0x00000000, 0x00000000, 0x00000000
    .long 0x00000000, 0x00000000, 0x00000000, 0x00000000, 0x00000000, 0x00000000, 0x00000000, 0x00000000
    .long 0x00000000, 0x00000000, 0x00000000, 0x00000000, 0x00000000, 0x00000000, 0x00000000, 0x00000000
    .long 0x00000000, 0x00000000, 0x00000000, 0x00000000, 0x00000000, 0x00000000, 0x00000000, 0x00000000
    .long 0x00000000, 0x00000000, 0x00000000, 0x00000000, 0x00000000, 0x00000000, 0x00000000, 0x00000000
    .long 0x00000000, 0x00000000, 0x00000000, 0x00000000, 0x00000000, 0x00000000, 0x00000000, 0x00000000
    .long 0x00000000, 0x00000000, 0x00000000, 0x00000000, 0x00000000, 0x00000000, 0x00000000, 0x00000000
    .long 0x00003f48, 0x0000bf48, 0x00003f40, 0x0000bf40, 0xbf103f0c, 0x0000bf0c, 0xbf3a3e3f, 0x0000be3f
    .long 0xbf48bcb3, 0x00003cb3, 0xbeb9bf28, 0x00003f28, 0xbf08bf13, 0x00003f13, 0x3f0cbf04, 0x00003f04
    .long 0x3d33bf48, 0x00003f48, 0x3f223ece, 0x0000bece, 0x3f17bf03, 0x00003f03, 0xbe6d3f37, 0x0000bf37
    .long 0x3f483d86, 0x0000bd86, 0xbf40bd41, 0x00003d41, 0x3efe3f1b, 0x0000bf1b, 0xbe10bf3d, 0x00003f3d
    .long 0xbdb33f47, 0x0000bf47, 0x3f2ebea4, 0x00003ea4, 0xbf1e3ef6, 0x0000bef6, 0x3ef53f14, 0x0000bf14
    .long 0x00000000, 0x00000000, 0x00000000, 0x00000000, 0x00000000, 0x00000000, 0x00000000, 0x00000000
    .long 0x00000000, 0x00000000, 0x00000000, 0x00000000, 0x00000000, 0x00000000, 0x00000000, 0x00000000
    .long 0x00000000, 0x00000000, 0x00000000, 0x00000000, 0x00000000, 0x00000000, 0x00000000, 0x00000000
    .long 0x00003f40, 0x0000bf40, 0x00003f48, 0x0000bf48, 0xbf3abe3f, 0x00003e3f, 0xbf10bf0c, 0x00003f0c
    .long 0x3eb9bf28, 0x00003f28, 0x3f48bcb3, 0x00003cb3, 0x3f0c3f04, 0x0000bf04, 0xbf083f13, 0x0000bf13
    .long 0xbf223ece, 0x0000bece, 0xbd33bf48, 0x00003f48, 0xbe6dbf37, 0x00003f37, 0x3f173f03, 0x0000bf03
    .long 0x3f40bd41, 0x00003d41, 0xbf483d86, 0x0000bd86, 0xbe103f3d, 0x0000bf3d, 0x3efebf1b, 0x00003f1b
    .long 0xbf2ebea4, 0x00003ea4, 0x3db33f47, 0x0000bf47, 0x3ef5bf14, 0x00003f14, 0xbf1ebef6, 0x00003ef6
    .long 0x00000000, 0x00000000, 0x00000000, 0x00000000, 0x00000000, 0x00000000, 0x00000000, 0x00000000
    .long 0x00000000, 0x00000000, 0x00000000, 0x00000000, 0x00000000, 0x00000000, 0x00000000, 0x00000000
    .long 0x00000000, 0x00000000, 0x00000000, 0x00000000, 0x00000000, 0x00000000, 0x00000000, 0x00000000
    .long 0x40254025, 0x3dc33dc3, 0x3fb73fb7, 0x00004045, 0xbfe53fe5, 0xbe0d3e0d, 0xbfb73fb7, 0x00000000
    .long 0x3f9f3f9f, 0x3e4b3e4b, 0x3fb73fb7, 0x00000000, 0xbf5c3f5c, 0xbe923e92, 0xbfb73fb7, 0x00000000
    .long 0x3f183f18, 0x3ed33ed3, 0x3fb73fb7, 0x00000000, 0xbed33ed3, 0xbf183f18, 0xbfb73fb7, 0x00000000
    .long 0x3e923e92, 0x3f5c3f5c, 0x3fb73fb7, 0x00000000, 0xbe4b3e4b, 0xbf9f3f9f, 0xbfb73fb7, 0x00000000
    .long 0x3e0d3e0d, 0x3fe53fe5, 0x3fb73fb7, 0x00000000, 0xbdc33dc3, 0xc0254025, 0xbfb73fb7, 0x40450000
    .long 0x00000000, 0x00000000, 0x00000000, 0x00000000, 0x00000000, 0x00000000, 0x00000000, 0x00000000
    .long 0x00000000, 0x00000000, 0x00000000, 0x00000000, 0x00000000, 0x00000000, 0x00000000, 0x00000000
    .long 0x00000000, 0x00000000, 0x00000000, 0x00000000, 0x00000000, 0x00000000, 0x00000000, 0x00000000
    .long 0x00000000, 0x00000000, 0x00000000, 0x00000000, 0x00000000, 0x00000000, 0x00000000, 0x00000000
    .long 0x00000000, 0x00000000, 0x00000000, 0x00000000, 0x00000000, 0x00000000, 0x00000000, 0x00000000
    .long 0x00000000, 0x00000000, 0x00000000, 0x00000000, 0x00000000, 0x00000000, 0x00000000, 0x00000000
    .long 0x00000000, 0x00000000, 0x00000000, 0x00000000, 0x00000000, 0x00000000, 0x00000000, 0x00000000
    .long 0x00000000, 0x00000000, 0x00000000, 0x00000000, 0x00000000, 0x00000000, 0x00000000, 0x00000000
    .long 0x00000000, 0x00000000, 0x00000000, 0x00000000, 0x00000000, 0x00000000, 0x00000000, 0x00000000
    .long 0x00000000, 0x00000000, 0x00000000, 0x00000000, 0x00000000, 0x00000000, 0x00000000, 0x00000000
    .long 0x00000000, 0x00000000, 0x00000000, 0x00000000, 0x00000000, 0x00000000, 0x00000000, 0x00000000

K2_code_end:
.section .rodata,"a"
.p2align 6
.amdhsa_kernel k2_kernel
  .amdhsa_next_free_vgpr 512
  .amdhsa_next_free_sgpr 102
  .amdhsa_accum_offset 256
  .amdhsa_group_segment_fixed_size 0
  .amdhsa_kernarg_size 40
  .amdhsa_user_sgpr_count 2
  .amdhsa_user_sgpr_kernarg_segment_ptr 1
  .amdhsa_system_sgpr_workgroup_id_x 1
.end_amdhsa_kernel
```

```asm
; @launch grid=(256,1,1) block=(256,1,1) lds=163840
.amdgcn_target "amdgcn-amd-amdhsa--gfx950"
.text
.globl standalone__fft_conv__vision_kernel
.p2align 8
.type standalone__fft_conv__vision_kernel,@function
standalone__fft_conv__vision_kernel:
    s_load_dwordx4 s[84:87], s[0:1], 0
    s_load_dwordx4 s[4:7], s[0:1], 16
    s_load_dwordx2 s[8:9], s[0:1], 32
    s_getpc_b64 s[10:11]
FU_pc:
    s_cmp_ge_u32 s2, 256
    s_cbranch_scc1 K2_end
    v_lshrrev_b32 v3, 6, v0
    v_and_b32 v0, 63, v0
    s_nop 0
    v_readfirstlane_b32 s24, v3
    s_and_b32 s20, s2, 7
    s_lshr_b32 s21, s2, 3
    s_lshl_b32 s21, s21, 2
    s_add_u32 s21, s21, s24
    s_lshr_b32 s83, s2, 3
    s_lshl_b32 s83, s83, 1
    s_add_u32 s83, s83, s24
    s_cmp_lt_u32 s24, 2
    s_cselect_b32 s83, s83, 64
    s_add_u32 s22, s83, 128
    s_min_u32 s22, s22, 167
    s_mov_b32 s80, 0
    s_cmp_lt_u32 s24, 2
    s_cbranch_scc1 FA_noas
    s_lshr_b32 s57, s2, 3
    s_lshl_b32 s58, s57, 1
    s_add_u32 s58, s58, s24
    s_sub_u32 s58, s58, 2
    s_cmp_ge_u32 s58, 61
    s_cbranch_scc1 FA_noas
    s_mov_b32 s80, 1
    s_add_u32 s22, s58, 128
    s_mov_b32 s81, -41664
    s_cmp_lt_u32 s58, 40
    s_cbranch_scc1 FA_noas
    s_sub_u32 s22, s21, 2
    s_mov_b32 s81, -54016
FA_noas:
    v_and_b32 v1, 3, v0
    v_bfe_u32 v5, v0, 2, 1
    s_sub_u32 s23, s22, s21
    v_mul_u32_u24 v5, s23, v5
    v_add_u32 v5, s21, v5
    v_lshl_add_u32 v1, v5, 2, v1
    v_mul_u32_u24 v2, 2260, v1
    v_lshrrev_b32 v2, 16, v2
    v_mul_u32_u24 v3, 29, v2
    v_sub_u32 v3, v1, v3
    v_min_u32 v2, 22, v2
    v_lshlrev_b32 v4, 3, v3
    v_add_u32 v4, 216, v4
    v_subrev_u32 v5, 224, v4
    v_min_u32 v4, v4, v5
    v_add_u32 v4, s20, v4
    v_mul_u32_u24 v4, 43008, v4
    v_mul_u32_u24 v6, 1920, v2
    v_add_u32 v7, v4, v6
    v_cmp_eq_u32 vcc, 0, v2
    v_mov_b32 v5, 43008
    v_mov_b32 v6, 0
    v_cndmask_b32 v3, v6, v5, vcc
    s_nop 0
    v_readlane_b32 s40, v7, 0
    v_readlane_b32 s41, v7, 1
    v_readlane_b32 s42, v7, 2
    v_readlane_b32 s43, v7, 3
    v_readlane_b32 s44, v7, 4
    v_readlane_b32 s45, v7, 5
    v_readlane_b32 s46, v7, 6
    v_readlane_b32 s47, v7, 7
    v_readlane_b32 s48, v3, 0
    v_readlane_b32 s49, v3, 1
    v_readlane_b32 s50, v3, 2
    v_readlane_b32 s51, v3, 3
    v_readlane_b32 s52, v3, 4
    v_readlane_b32 s53, v3, 5
    v_readlane_b32 s54, v3, 6
    v_readlane_b32 s55, v3, 7
    v_add_u32 v8, 0, v0
    v_mul_u32_u24 v9, 5462, v8
    v_bfe_u32 v10, v9, 18, 2
    v_xor_b32 v8, v8, v10
    v_lshlrev_b32 v12, 4, v8
    v_lshrrev_b32 v9, 16, v9
    v_cmp_gt_u32 vcc, 6, v9
    s_nop 1
    v_cndmask_b32 v16, 0, 1, vcc
    v_add_u32 v8, 64, v0
    v_mul_u32_u24 v9, 5462, v8
    v_bfe_u32 v10, v9, 18, 2
    v_xor_b32 v8, v8, v10
    v_lshlrev_b32 v13, 4, v8
    v_lshrrev_b32 v9, 16, v9
    v_cmp_gt_u32 vcc, 6, v9
    s_nop 1
    v_cndmask_b32 v17, 0, 1, vcc
    v_add_u32 v8, 128, v0
    v_mul_u32_u24 v9, 5462, v8
    v_bfe_u32 v10, v9, 18, 2
    v_xor_b32 v8, v8, v10
    v_lshlrev_b32 v14, 4, v8
    s_mul_i32 s56, s24, 27008
    s_waitcnt lgkmcnt(0)
    s_mov_b64 s[76:77], s[6:7]
    s_sub_u32 s12, s84, 1152
    s_subb_u32 s13, s85, 0
    s_and_b32 s13, s13, 0xffff
    s_mov_b32 s14, 9634944
    s_mov_b32 s15, 0x00020000
    s_or_b32 s57, s2, s24
    s_cmp_lg_u32 s57, 0
    s_cbranch_scc1 FA_nononce
    s_memrealtime s[58:59]
    s_waitcnt lgkmcnt(0)
    s_or_b32 s58, s58, 1
    v_mov_b32 v8, 0
    v_mov_b32 v9, s58
    s_mov_b64 exec, 1
    global_store_dword v8, v9, s[76:77] sc1
    s_mov_b64 exec, -1
FA_nononce:
    s_cmp_lt_u32 s83, 40
    s_cbranch_scc1 FA_xx
    s_cmp_lt_u32 s83, 61
    s_cbranch_scc1 FA_xw
    s_add_u32 m0, s56, 0
    v_mad_i32_i24 v8, v16, s48, v12
    buffer_load_dwordx4 v8, s[12:15], s40 offen lds
    s_add_u32 m0, s56, 1024
    v_mad_i32_i24 v9, v17, s48, v13
    buffer_load_dwordx4 v9, s[12:15], s40 offen lds
    s_add_u32 m0, s56, 2048
    s_nop 0
    buffer_load_dwordx4 v14, s[12:15], s40 offen lds
    s_add_u32 m0, s56, 3088
    v_mad_i32_i24 v9, v16, s49, v12
    buffer_load_dwordx4 v9, s[12:15], s41 offen lds
    s_add_u32 m0, s56, 4112
    v_mad_i32_i24 v8, v17, s49, v13
    buffer_load_dwordx4 v8, s[12:15], s41 offen lds
    s_add_u32 m0, s56, 5136
    s_nop 0
    buffer_load_dwordx4 v14, s[12:15], s41 offen lds
    s_add_u32 m0, s56, 6176
    v_mad_i32_i24 v8, v16, s50, v12
    buffer_load_dwordx4 v8, s[12:15], s42 offen lds
    s_add_u32 m0, s56, 7200
    v_mad_i32_i24 v9, v17, s50, v13
    buffer_load_dwordx4 v9, s[12:15], s42 offen lds
    s_add_u32 m0, s56, 8224
    s_nop 0
    buffer_load_dwordx4 v14, s[12:15], s42 offen lds
    s_add_u32 m0, s56, 9264
    v_mad_i32_i24 v9, v16, s51, v12
    buffer_load_dwordx4 v9, s[12:15], s43 offen lds
    s_add_u32 m0, s56, 10288
    v_mad_i32_i24 v8, v17, s51, v13
    buffer_load_dwordx4 v8, s[12:15], s43 offen lds
    s_add_u32 m0, s56, 11312
    s_nop 0
    buffer_load_dwordx4 v14, s[12:15], s43 offen lds
    v_mov_b32 v30, 0
    global_load_dword v31, v30, s[76:77] sc1
    v_lshlrev_b32 v1, 3, v0
    s_add_u32 s58, s10, FU_bt-FU_pc
    s_addc_u32 s59, s11, 0
    global_load_dwordx2 v[20:21], v1, s[58:59]
    v_lshrrev_b32 v2, 4, v0
    v_and_b32 v3, 15, v0
    v_lshrrev_b32 v4, 2, v3
    v_and_b32 v5, 3, v0
    v_lshl_add_u32 v6, v2, 2, v4
    v_mul_u32_u24 v7, 193, v5
    v_mul_u32_u24 v8, 12, v6
    v_add_u32 v7, v7, v8
    v_mov_b32 v10, s56
    v_xor_b32 v9, 0, v2
    v_add_u32 v9, v7, v9
    v_lshl_add_u32 v24, v9, 4, v10
    v_xor_b32 v9, 1, v2
    v_add_u32 v9, v7, v9
    v_lshl_add_u32 v25, v9, 4, v10
    v_xor_b32 v9, 2, v2
    v_add_u32 v9, v7, v9
    v_lshl_add_u32 v26, v9, 4, v10
    v_xor_b32 v9, 3, v2
    v_add_u32 v9, v7, v9
    v_lshl_add_u32 v27, v9, 4, v10
    v_mul_u32_u24 v7, 193, v2
    v_mul_u32_u24 v8, 12, v3
    v_add_u32 v7, v7, v8
    v_lshrrev_b32 v8, 2, v3
    v_xor_b32 v9, 0, v8
    v_add_u32 v9, v7, v9
    v_lshl_add_u32 v244, v9, 4, v10
    v_xor_b32 v9, 1, v8
    v_add_u32 v9, v7, v9
    v_lshl_add_u32 v245, v9, 4, v10
    v_xor_b32 v9, 2, v8
    v_add_u32 v9, v7, v9
    v_lshl_add_u32 v246, v9, 4, v10
    v_xor_b32 v9, 3, v8
    v_add_u32 v9, v7, v9
    v_lshl_add_u32 v247, v9, 4, v10
    v_lshrrev_b32 v2, 4, v0
    v_bfe_u32 v3, v0, 2, 2
    v_and_b32 v4, 3, v0
    v_mul_u32_u24 v7, 193, v4
    v_mul_u32_u24 v8, 12, v2
    v_add_u32 v7, v7, v8
    v_xor_b32 v9, 0, v3
    v_add_u32 v9, v7, v9
    v_lshl_add_u32 v16, v9, 4, v10
    v_xor_b32 v9, 1, v3
    v_add_u32 v9, v7, v9
    v_lshl_add_u32 v17, v9, 4, v10
    v_xor_b32 v9, 2, v3
    v_add_u32 v9, v7, v9
    v_lshl_add_u32 v18, v9, 4, v10
    v_xor_b32 v9, 3, v3
    v_add_u32 v9, v7, v9
    v_lshl_add_u32 v19, v9, 4, v10
    v_lshlrev_b32 v7, 13, v2
    v_lshl_add_u32 v7, v3, 6, v7
    v_lshl_add_u32 v11, v4, 4, v7
    s_lshr_b32 s62, s21, 2
    s_lshl_b32 s78, s62, 7
    s_mul_i32 s60, s62, 393216
    s_lshl_b32 s62, s20, 2
    s_and_b32 s57, s21, 3
    s_add_u32 s62, s62, s57
    s_lshl_b32 s62, s62, 2
    s_add_u32 s78, s78, s62
    s_add_u32 s78, s78, 18579456
    s_lshl_b32 s62, s20, 10
    s_add_u32 s60, s60, s62
    s_and_b32 s62, s21, 3
    s_lshl_b32 s62, s62, 8
    s_add_u32 s60, s60, s62
    s_lshr_b32 s62, s22, 2
    s_lshl_b32 s79, s62, 7
    s_mul_i32 s61, s62, 393216
    s_lshl_b32 s62, s20, 2
    s_and_b32 s57, s22, 3
    s_add_u32 s62, s62, s57
    s_lshl_b32 s62, s62, 2
    s_add_u32 s79, s79, s62
    s_add_u32 s79, s79, 18579456
    s_lshl_b32 s62, s20, 10
    s_add_u32 s61, s61, s62
    s_and_b32 s62, s22, 3
    s_lshl_b32 s62, s62, 8
    s_add_u32 s61, s61, s62
    s_mov_b32 s16, s8
    s_and_b32 s17, s9, 0xffff
    s_mov_b32 s18, 16515072
    s_mov_b32 s19, 0x00020000
    s_waitcnt vmcnt(2)
    ds_read_b64_tr_b16 v[32:33], v24 offset:0
    ds_read_b64_tr_b16 v[34:35], v24 offset:8
    ds_read_b64_tr_b16 v[36:37], v25 offset:0
    ds_read_b64_tr_b16 v[38:39], v25 offset:8
    ds_read_b64_tr_b16 v[40:41], v26 offset:0
    ds_read_b64_tr_b16 v[42:43], v26 offset:8
    ds_read_b64_tr_b16 v[44:45], v27 offset:0
    ds_read_b64_tr_b16 v[46:47], v27 offset:8
    ds_read_b64_tr_b16 v[48:49], v24 offset:64
    ds_read_b64_tr_b16 v[50:51], v24 offset:72
    ds_read_b64_tr_b16 v[52:53], v25 offset:64
    ds_read_b64_tr_b16 v[54:55], v25 offset:72
    ds_read_b64_tr_b16 v[56:57], v26 offset:64
    ds_read_b64_tr_b16 v[58:59], v26 offset:72
    ds_read_b64_tr_b16 v[60:61], v27 offset:64
    ds_read_b64_tr_b16 v[62:63], v27 offset:72
    ds_read_b64_tr_b16 v[64:65], v24 offset:128
    ds_read_b64_tr_b16 v[66:67], v24 offset:136
    ds_read_b64_tr_b16 v[68:69], v25 offset:128
    ds_read_b64_tr_b16 v[70:71], v25 offset:136
    ds_read_b64_tr_b16 v[72:73], v26 offset:128
    ds_read_b64_tr_b16 v[74:75], v26 offset:136
    ds_read_b64_tr_b16 v[76:77], v27 offset:128
    ds_read_b64_tr_b16 v[78:79], v27 offset:136
    s_waitcnt vmcnt(0) lgkmcnt(15)
    v_mfma_f32_16x16x16_bf16 v[80:83], v[32:33], v[20:21], 0
    v_mfma_f32_16x16x16_bf16 v[84:87], v[34:35], v[20:21], 0
    v_mfma_f32_16x16x16_bf16 v[88:91], v[36:37], v[20:21], 0
    v_mfma_f32_16x16x16_bf16 v[92:95], v[38:39], v[20:21], 0
    v_mfma_f32_16x16x16_bf16 v[96:99], v[40:41], v[20:21], 0
    v_mfma_f32_16x16x16_bf16 v[100:103], v[42:43], v[20:21], 0
    v_mfma_f32_16x16x16_bf16 v[104:107], v[44:45], v[20:21], 0
    v_mfma_f32_16x16x16_bf16 v[108:111], v[46:47], v[20:21], 0
    v_mfma_f32_16x16x16_bf16 v[112:115], v[48:49], v[20:21], 0
    s_waitcnt lgkmcnt(14)
    v_mfma_f32_16x16x16_bf16 v[116:119], v[50:51], v[20:21], 0
    s_waitcnt lgkmcnt(13)
    v_mfma_f32_16x16x16_bf16 v[120:123], v[52:53], v[20:21], 0
    s_waitcnt lgkmcnt(12)
    v_mfma_f32_16x16x16_bf16 v[124:127], v[54:55], v[20:21], 0
    s_waitcnt lgkmcnt(11)
    v_mfma_f32_16x16x16_bf16 v[128:131], v[56:57], v[20:21], 0
    s_waitcnt lgkmcnt(10)
    v_mfma_f32_16x16x16_bf16 v[132:135], v[58:59], v[20:21], 0
    s_waitcnt lgkmcnt(9)
    v_mfma_f32_16x16x16_bf16 v[136:139], v[60:61], v[20:21], 0
    s_waitcnt lgkmcnt(8)
    v_mfma_f32_16x16x16_bf16 v[140:143], v[62:63], v[20:21], 0
    v_cvt_pk_bf16_f32 v80, v80, v81
    v_cvt_pk_bf16_f32 v81, v82, v83
    v_cvt_pk_bf16_f32 v82, v84, v85
    v_cvt_pk_bf16_f32 v83, v86, v87
    ds_write_b128 v244, v[80:83] offset:0
    v_cvt_pk_bf16_f32 v88, v88, v89
    v_cvt_pk_bf16_f32 v89, v90, v91
    v_cvt_pk_bf16_f32 v90, v92, v93
    v_cvt_pk_bf16_f32 v91, v94, v95
    ds_write_b128 v245, v[88:91] offset:0
    v_cvt_pk_bf16_f32 v96, v96, v97
    v_cvt_pk_bf16_f32 v97, v98, v99
    v_cvt_pk_bf16_f32 v98, v100, v101
    v_cvt_pk_bf16_f32 v99, v102, v103
    ds_write_b128 v246, v[96:99] offset:0
    v_cvt_pk_bf16_f32 v104, v104, v105
    v_cvt_pk_bf16_f32 v105, v106, v107
    v_cvt_pk_bf16_f32 v106, v108, v109
    v_cvt_pk_bf16_f32 v107, v110, v111
    ds_write_b128 v247, v[104:107] offset:0
    ds_read_b128 v[144:147], v16 offset:0
    ds_read_b128 v[148:151], v17 offset:768
    ds_read_b128 v[152:155], v18 offset:1536
    ds_read_b128 v[156:159], v19 offset:2304
    s_add_u32 s62, s60, 0
    s_waitcnt lgkmcnt(3)
    buffer_store_dwordx4 v[144:147], v11, s[16:19], s62 offen sc1
    s_add_u32 s62, s60, 98304
    s_waitcnt lgkmcnt(2)
    buffer_store_dwordx4 v[148:151], v11, s[16:19], s62 offen sc1
    s_add_u32 s62, s60, 196608
    s_waitcnt lgkmcnt(1)
    buffer_store_dwordx4 v[152:155], v11, s[16:19], s62 offen sc1
    s_add_u32 s62, s60, 294912
    s_waitcnt lgkmcnt(0)
    buffer_store_dwordx4 v[156:159], v11, s[16:19], s62 offen sc1
    v_mfma_f32_16x16x16_bf16 v[80:83], v[64:65], v[20:21], 0
    v_mfma_f32_16x16x16_bf16 v[84:87], v[66:67], v[20:21], 0
    v_mfma_f32_16x16x16_bf16 v[88:91], v[68:69], v[20:21], 0
    v_mfma_f32_16x16x16_bf16 v[92:95], v[70:71], v[20:21], 0
    v_mfma_f32_16x16x16_bf16 v[96:99], v[72:73], v[20:21], 0
    v_mfma_f32_16x16x16_bf16 v[100:103], v[74:75], v[20:21], 0
    v_mfma_f32_16x16x16_bf16 v[104:107], v[76:77], v[20:21], 0
    v_mfma_f32_16x16x16_bf16 v[108:111], v[78:79], v[20:21], 0
    v_cvt_pk_bf16_f32 v112, v112, v113
    v_cvt_pk_bf16_f32 v113, v114, v115
    v_cvt_pk_bf16_f32 v114, v116, v117
    v_cvt_pk_bf16_f32 v115, v118, v119
    ds_write_b128 v244, v[112:115] offset:64
    v_cvt_pk_bf16_f32 v120, v120, v121
    v_cvt_pk_bf16_f32 v121, v122, v123
    v_cvt_pk_bf16_f32 v122, v124, v125
    v_cvt_pk_bf16_f32 v123, v126, v127
    ds_write_b128 v245, v[120:123] offset:64
    v_cvt_pk_bf16_f32 v128, v128, v129
    v_cvt_pk_bf16_f32 v129, v130, v131
    v_cvt_pk_bf16_f32 v130, v132, v133
    v_cvt_pk_bf16_f32 v131, v134, v135
    ds_write_b128 v246, v[128:131] offset:64
    v_cvt_pk_bf16_f32 v136, v136, v137
    v_cvt_pk_bf16_f32 v137, v138, v139
    v_cvt_pk_bf16_f32 v138, v140, v141
    v_cvt_pk_bf16_f32 v139, v142, v143
    ds_write_b128 v247, v[136:139] offset:64
    v_cvt_pk_bf16_f32 v80, v80, v81
    v_cvt_pk_bf16_f32 v81, v82, v83
    v_cvt_pk_bf16_f32 v82, v84, v85
    v_cvt_pk_bf16_f32 v83, v86, v87
    ds_write_b128 v244, v[80:83] offset:128
    v_cvt_pk_bf16_f32 v88, v88, v89
    v_cvt_pk_bf16_f32 v89, v90, v91
    v_cvt_pk_bf16_f32 v90, v92, v93
    v_cvt_pk_bf16_f32 v91, v94, v95
    ds_write_b128 v245, v[88:91] offset:128
    v_cvt_pk_bf16_f32 v96, v96, v97
    v_cvt_pk_bf16_f32 v97, v98, v99
    v_cvt_pk_bf16_f32 v98, v100, v101
    v_cvt_pk_bf16_f32 v99, v102, v103
    ds_write_b128 v246, v[96:99] offset:128
    v_cvt_pk_bf16_f32 v104, v104, v105
    v_cvt_pk_bf16_f32 v105, v106, v107
    v_cvt_pk_bf16_f32 v106, v108, v109
    v_cvt_pk_bf16_f32 v107, v110, v111
    ds_write_b128 v247, v[104:107] offset:128
    ds_read_b128 v[208:211], v16 offset:64
    ds_read_b128 v[212:215], v17 offset:832
    ds_read_b128 v[216:219], v18 offset:1600
    ds_read_b128 v[220:223], v19 offset:2368
    s_add_u32 s62, s60, 32768
    s_waitcnt lgkmcnt(3)
    buffer_store_dwordx4 v[208:211], v11, s[16:19], s62 offen sc1
    s_add_u32 s62, s60, 131072
    s_waitcnt lgkmcnt(2)
    buffer_store_dwordx4 v[212:215], v11, s[16:19], s62 offen sc1
    s_add_u32 s62, s60, 229376
    s_waitcnt lgkmcnt(1)
    buffer_store_dwordx4 v[216:219], v11, s[16:19], s62 offen sc1
    s_add_u32 s62, s60, 327680
    s_waitcnt lgkmcnt(0)
    buffer_store_dwordx4 v[220:223], v11, s[16:19], s62 offen sc1
    s_nop 0
    v_readfirstlane_b32 s82, v31
    s_mov_b32 s57, 0
FA_na:
    s_cmp_lg_u32 s82, 0
    s_cbranch_scc1 FA_noka
    s_add_u32 s57, s57, 1
    s_cmp_ge_u32 s57, 400000
    s_cbranch_scc1 FA_noka
    s_sleep 4
    v_mov_b32 v30, 0
    global_load_dword v31, v30, s[76:77] sc1
    s_waitcnt vmcnt(0)
    v_readfirstlane_b32 s82, v31
    s_branch FA_na
FA_noka:
    s_waitcnt vmcnt(4)
    v_mov_b32 v1, s78
    v_mov_b32 v2, s82
    s_mov_b64 exec, 1
    global_atomic_swap v1, v2, s[8:9] sc1
    s_mov_b64 exec, -1
    s_barrier
    s_nop 0
    s_cmp_eq_u32 s80, 0
    s_cbranch_scc1 FA_noassist
    v_add_u32 v200, s81, v16
    v_add_u32 v201, s81, v17
    v_add_u32 v202, s81, v18
    v_add_u32 v203, s81, v19
    ds_read_b128 v[160:163], v200 offset:64
    ds_read_b128 v[164:167], v201 offset:832
    ds_read_b128 v[168:171], v202 offset:1600
    ds_read_b128 v[172:175], v203 offset:2368
    s_add_u32 s62, s61, 32768
    s_waitcnt lgkmcnt(3)
    buffer_store_dwordx4 v[160:163], v11, s[16:19], s62 offen sc1
    s_add_u32 s62, s61, 131072
    s_waitcnt lgkmcnt(2)
    buffer_store_dwordx4 v[164:167], v11, s[16:19], s62 offen sc1
    s_add_u32 s62, s61, 229376
    s_waitcnt lgkmcnt(1)
    buffer_store_dwordx4 v[168:171], v11, s[16:19], s62 offen sc1
    s_add_u32 s62, s61, 327680
    s_waitcnt lgkmcnt(0)
    buffer_store_dwordx4 v[172:175], v11, s[16:19], s62 offen sc1
    s_mov_b32 s81, s79
    s_mov_b32 s79, 0
    s_mov_b32 s61, 0x40000000
    s_branch FU_pb
FA_noassist:
    s_mov_b32 s81, 0
    s_mov_b32 s79, 0
    s_mov_b32 s61, 0x40000000
    s_branch FU_pb
FA_xx:
    s_add_u32 m0, s56, 0
    v_mad_i32_i24 v8, v16, s48, v12
    buffer_load_dwordx4 v8, s[12:15], s40 offen lds
    s_add_u32 m0, s56, 1024
    v_mad_i32_i24 v9, v17, s48, v13
    buffer_load_dwordx4 v9, s[12:15], s40 offen lds
    s_add_u32 m0, s56, 2048
    s_nop 0
    buffer_load_dwordx4 v14, s[12:15], s40 offen lds
    s_add_u32 m0, s56, 3088
    v_mad_i32_i24 v9, v16, s49, v12
    buffer_load_dwordx4 v9, s[12:15], s41 offen lds
    s_add_u32 m0, s56, 4112
    v_mad_i32_i24 v8, v17, s49, v13
    buffer_load_dwordx4 v8, s[12:15], s41 offen lds
    s_add_u32 m0, s56, 5136
    s_nop 0
    buffer_load_dwordx4 v14, s[12:15], s41 offen lds
    s_add_u32 m0, s56, 6176
    v_mad_i32_i24 v8, v16, s50, v12
    buffer_load_dwordx4 v8, s[12:15], s42 offen lds
    s_add_u32 m0, s56, 7200
    v_mad_i32_i24 v9, v17, s50, v13
    buffer_load_dwordx4 v9, s[12:15], s42 offen lds
    s_add_u32 m0, s56, 8224
    s_nop 0
    buffer_load_dwordx4 v14, s[12:15], s42 offen lds
    s_add_u32 m0, s56, 9264
    v_mad_i32_i24 v9, v16, s51, v12
    buffer_load_dwordx4 v9, s[12:15], s43 offen lds
    s_add_u32 m0, s56, 10288
    v_mad_i32_i24 v8, v17, s51, v13
    buffer_load_dwordx4 v8, s[12:15], s43 offen lds
    s_add_u32 m0, s56, 11312
    s_nop 0
    buffer_load_dwordx4 v14, s[12:15], s43 offen lds
    v_mov_b32 v30, 0
    global_load_dword v31, v30, s[76:77] sc1
    s_add_u32 m0, s56, 12352
    v_mad_i32_i24 v8, v16, s52, v12
    buffer_load_dwordx4 v8, s[12:15], s44 offen lds
    s_add_u32 m0, s56, 13376
    v_mad_i32_i24 v9, v17, s52, v13
    buffer_load_dwordx4 v9, s[12:15], s44 offen lds
    s_add_u32 m0, s56, 14400
    s_nop 0
    buffer_load_dwordx4 v14, s[12:15], s44 offen lds
    s_add_u32 m0, s56, 15440
    v_mad_i32_i24 v9, v16, s53, v12
    buffer_load_dwordx4 v9, s[12:15], s45 offen lds
    s_add_u32 m0, s56, 16464
    v_mad_i32_i24 v8, v17, s53, v13
    buffer_load_dwordx4 v8, s[12:15], s45 offen lds
    s_add_u32 m0, s56, 17488
    s_nop 0
    buffer_load_dwordx4 v14, s[12:15], s45 offen lds
    s_add_u32 m0, s56, 18528
    v_mad_i32_i24 v8, v16, s54, v12
    buffer_load_dwordx4 v8, s[12:15], s46 offen lds
    s_add_u32 m0, s56, 19552
    v_mad_i32_i24 v9, v17, s54, v13
    buffer_load_dwordx4 v9, s[12:15], s46 offen lds
    s_add_u32 m0, s56, 20576
    s_nop 0
    buffer_load_dwordx4 v14, s[12:15], s46 offen lds
    s_add_u32 m0, s56, 21616
    v_mad_i32_i24 v9, v16, s55, v12
    buffer_load_dwordx4 v9, s[12:15], s47 offen lds
    s_add_u32 m0, s56, 22640
    v_mad_i32_i24 v8, v17, s55, v13
    buffer_load_dwordx4 v8, s[12:15], s47 offen lds
    s_add_u32 m0, s56, 23664
    s_nop 0
    buffer_load_dwordx4 v14, s[12:15], s47 offen lds
    v_lshlrev_b32 v1, 3, v0
    s_add_u32 s58, s10, FU_bt-FU_pc
    s_addc_u32 s59, s11, 0
    global_load_dwordx2 v[20:21], v1, s[58:59]
    v_lshrrev_b32 v2, 4, v0
    v_and_b32 v3, 15, v0
    v_lshrrev_b32 v4, 2, v3
    v_and_b32 v5, 3, v0
    v_lshl_add_u32 v6, v2, 2, v4
    v_mul_u32_u24 v7, 193, v5
    v_mul_u32_u24 v8, 12, v6
    v_add_u32 v7, v7, v8
    v_mov_b32 v10, s56
    v_xor_b32 v9, 0, v2
    v_add_u32 v9, v7, v9
    v_lshl_add_u32 v24, v9, 4, v10
    v_xor_b32 v9, 1, v2
    v_add_u32 v9, v7, v9
    v_lshl_add_u32 v25, v9, 4, v10
    v_xor_b32 v9, 2, v2
    v_add_u32 v9, v7, v9
    v_lshl_add_u32 v26, v9, 4, v10
    v_xor_b32 v9, 3, v2
    v_add_u32 v9, v7, v9
    v_lshl_add_u32 v27, v9, 4, v10
    v_mul_u32_u24 v7, 193, v2
    v_mul_u32_u24 v8, 12, v3
    v_add_u32 v7, v7, v8
    v_lshrrev_b32 v8, 2, v3
    v_xor_b32 v9, 0, v8
    v_add_u32 v9, v7, v9
    v_lshl_add_u32 v244, v9, 4, v10
    v_xor_b32 v9, 1, v8
    v_add_u32 v9, v7, v9
    v_lshl_add_u32 v245, v9, 4, v10
    v_xor_b32 v9, 2, v8
    v_add_u32 v9, v7, v9
    v_lshl_add_u32 v246, v9, 4, v10
    v_xor_b32 v9, 3, v8
    v_add_u32 v9, v7, v9
    v_lshl_add_u32 v247, v9, 4, v10
    v_lshrrev_b32 v2, 4, v0
    v_bfe_u32 v3, v0, 2, 2
    v_and_b32 v4, 3, v0
    v_mul_u32_u24 v7, 193, v4
    v_mul_u32_u24 v8, 12, v2
    v_add_u32 v7, v7, v8
    v_xor_b32 v9, 0, v3
    v_add_u32 v9, v7, v9
    v_lshl_add_u32 v16, v9, 4, v10
    v_xor_b32 v9, 1, v3
    v_add_u32 v9, v7, v9
    v_lshl_add_u32 v17, v9, 4, v10
    v_xor_b32 v9, 2, v3
    v_add_u32 v9, v7, v9
    v_lshl_add_u32 v18, v9, 4, v10
    v_xor_b32 v9, 3, v3
    v_add_u32 v9, v7, v9
    v_lshl_add_u32 v19, v9, 4, v10
    v_lshlrev_b32 v7, 13, v2
    v_lshl_add_u32 v7, v3, 6, v7
    v_lshl_add_u32 v11, v4, 4, v7
    s_lshr_b32 s62, s21, 2
    s_lshl_b32 s78, s62, 7
    s_mul_i32 s60, s62, 393216
    s_lshl_b32 s62, s20, 2
    s_and_b32 s57, s21, 3
    s_add_u32 s62, s62, s57
    s_lshl_b32 s62, s62, 2
    s_add_u32 s78, s78, s62
    s_add_u32 s78, s78, 18579456
    s_lshl_b32 s62, s20, 10
    s_add_u32 s60, s60, s62
    s_and_b32 s62, s21, 3
    s_lshl_b32 s62, s62, 8
    s_add_u32 s60, s60, s62
    s_lshr_b32 s62, s22, 2
    s_lshl_b32 s79, s62, 7
    s_mul_i32 s61, s62, 393216
    s_lshl_b32 s62, s20, 2
    s_and_b32 s57, s22, 3
    s_add_u32 s62, s62, s57
    s_lshl_b32 s62, s62, 2
    s_add_u32 s79, s79, s62
    s_add_u32 s79, s79, 18579456
    s_lshl_b32 s62, s20, 10
    s_add_u32 s61, s61, s62
    s_and_b32 s62, s22, 3
    s_lshl_b32 s62, s62, 8
    s_add_u32 s61, s61, s62
    s_mov_b32 s16, s8
    s_and_b32 s17, s9, 0xffff
    s_mov_b32 s18, 16515072
    s_mov_b32 s19, 0x00020000
    s_waitcnt vmcnt(14)
    ds_read_b64_tr_b16 v[32:33], v24 offset:0
    ds_read_b64_tr_b16 v[34:35], v24 offset:8
    ds_read_b64_tr_b16 v[36:37], v25 offset:0
    ds_read_b64_tr_b16 v[38:39], v25 offset:8
    ds_read_b64_tr_b16 v[40:41], v26 offset:0
    ds_read_b64_tr_b16 v[42:43], v26 offset:8
    ds_read_b64_tr_b16 v[44:45], v27 offset:0
    ds_read_b64_tr_b16 v[46:47], v27 offset:8
    ds_read_b64_tr_b16 v[48:49], v24 offset:64
    ds_read_b64_tr_b16 v[50:51], v24 offset:72
    ds_read_b64_tr_b16 v[52:53], v25 offset:64
    ds_read_b64_tr_b16 v[54:55], v25 offset:72
    ds_read_b64_tr_b16 v[56:57], v26 offset:64
    ds_read_b64_tr_b16 v[58:59], v26 offset:72
    ds_read_b64_tr_b16 v[60:61], v27 offset:64
    ds_read_b64_tr_b16 v[62:63], v27 offset:72
    ds_read_b64_tr_b16 v[64:65], v24 offset:128
    ds_read_b64_tr_b16 v[66:67], v24 offset:136
    ds_read_b64_tr_b16 v[68:69], v25 offset:128
    ds_read_b64_tr_b16 v[70:71], v25 offset:136
    ds_read_b64_tr_b16 v[72:73], v26 offset:128
    ds_read_b64_tr_b16 v[74:75], v26 offset:136
    ds_read_b64_tr_b16 v[76:77], v27 offset:128
    ds_read_b64_tr_b16 v[78:79], v27 offset:136
    s_waitcnt vmcnt(0) lgkmcnt(15)
    v_mfma_f32_16x16x16_bf16 v[80:83], v[32:33], v[20:21], 0
    v_mfma_f32_16x16x16_bf16 v[84:87], v[34:35], v[20:21], 0
    v_mfma_f32_16x16x16_bf16 v[88:91], v[36:37], v[20:21], 0
    v_mfma_f32_16x16x16_bf16 v[92:95], v[38:39], v[20:21], 0
    v_mfma_f32_16x16x16_bf16 v[96:99], v[40:41], v[20:21], 0
    v_mfma_f32_16x16x16_bf16 v[100:103], v[42:43], v[20:21], 0
    v_mfma_f32_16x16x16_bf16 v[104:107], v[44:45], v[20:21], 0
    v_mfma_f32_16x16x16_bf16 v[108:111], v[46:47], v[20:21], 0
    v_mfma_f32_16x16x16_bf16 v[112:115], v[48:49], v[20:21], 0
    s_waitcnt lgkmcnt(14)
    v_mfma_f32_16x16x16_bf16 v[116:119], v[50:51], v[20:21], 0
    s_waitcnt lgkmcnt(13)
    v_mfma_f32_16x16x16_bf16 v[120:123], v[52:53], v[20:21], 0
    s_waitcnt lgkmcnt(12)
    v_mfma_f32_16x16x16_bf16 v[124:127], v[54:55], v[20:21], 0
    s_waitcnt lgkmcnt(11)
    v_mfma_f32_16x16x16_bf16 v[128:131], v[56:57], v[20:21], 0
    s_waitcnt lgkmcnt(10)
    v_mfma_f32_16x16x16_bf16 v[132:135], v[58:59], v[20:21], 0
    s_waitcnt lgkmcnt(9)
    v_mfma_f32_16x16x16_bf16 v[136:139], v[60:61], v[20:21], 0
    s_waitcnt lgkmcnt(8)
    v_mfma_f32_16x16x16_bf16 v[140:143], v[62:63], v[20:21], 0
    v_cvt_pk_bf16_f32 v80, v80, v81
    v_cvt_pk_bf16_f32 v81, v82, v83
    v_cvt_pk_bf16_f32 v82, v84, v85
    v_cvt_pk_bf16_f32 v83, v86, v87
    ds_write_b128 v244, v[80:83] offset:0
    v_cvt_pk_bf16_f32 v88, v88, v89
    v_cvt_pk_bf16_f32 v89, v90, v91
    v_cvt_pk_bf16_f32 v90, v92, v93
    v_cvt_pk_bf16_f32 v91, v94, v95
    ds_write_b128 v245, v[88:91] offset:0
    v_cvt_pk_bf16_f32 v96, v96, v97
    v_cvt_pk_bf16_f32 v97, v98, v99
    v_cvt_pk_bf16_f32 v98, v100, v101
    v_cvt_pk_bf16_f32 v99, v102, v103
    ds_write_b128 v246, v[96:99] offset:0
    v_cvt_pk_bf16_f32 v104, v104, v105
    v_cvt_pk_bf16_f32 v105, v106, v107
    v_cvt_pk_bf16_f32 v106, v108, v109
    v_cvt_pk_bf16_f32 v107, v110, v111
    ds_write_b128 v247, v[104:107] offset:0
    ds_read_b128 v[144:147], v16 offset:0
    ds_read_b128 v[148:151], v17 offset:768
    ds_read_b128 v[152:155], v18 offset:1536
    ds_read_b128 v[156:159], v19 offset:2304
    s_add_u32 s62, s60, 0
    s_waitcnt lgkmcnt(3)
    buffer_store_dwordx4 v[144:147], v11, s[16:19], s62 offen sc1
    s_add_u32 s62, s60, 98304
    s_waitcnt lgkmcnt(2)
    buffer_store_dwordx4 v[148:151], v11, s[16:19], s62 offen sc1
    s_add_u32 s62, s60, 196608
    s_waitcnt lgkmcnt(1)
    buffer_store_dwordx4 v[152:155], v11, s[16:19], s62 offen sc1
    s_add_u32 s62, s60, 294912
    s_waitcnt lgkmcnt(0)
    buffer_store_dwordx4 v[156:159], v11, s[16:19], s62 offen sc1
    ds_read_b64_tr_b16 v[160:161], v24 offset:12352
    ds_read_b64_tr_b16 v[162:163], v24 offset:12360
    ds_read_b64_tr_b16 v[164:165], v25 offset:12352
    ds_read_b64_tr_b16 v[166:167], v25 offset:12360
    ds_read_b64_tr_b16 v[168:169], v26 offset:12352
    ds_read_b64_tr_b16 v[170:171], v26 offset:12360
    ds_read_b64_tr_b16 v[172:173], v27 offset:12352
    ds_read_b64_tr_b16 v[174:175], v27 offset:12360
    ds_read_b64_tr_b16 v[176:177], v24 offset:12416
    ds_read_b64_tr_b16 v[178:179], v24 offset:12424
    ds_read_b64_tr_b16 v[180:181], v25 offset:12416
    ds_read_b64_tr_b16 v[182:183], v25 offset:12424
    ds_read_b64_tr_b16 v[184:185], v26 offset:12416
    ds_read_b64_tr_b16 v[186:187], v26 offset:12424
    ds_read_b64_tr_b16 v[188:189], v27 offset:12416
    ds_read_b64_tr_b16 v[190:191], v27 offset:12424
    ds_read_b64_tr_b16 v[192:193], v24 offset:12480
    ds_read_b64_tr_b16 v[194:195], v24 offset:12488
    ds_read_b64_tr_b16 v[196:197], v25 offset:12480
    ds_read_b64_tr_b16 v[198:199], v25 offset:12488
    ds_read_b64_tr_b16 v[200:201], v26 offset:12480
    ds_read_b64_tr_b16 v[202:203], v26 offset:12488
    ds_read_b64_tr_b16 v[204:205], v27 offset:12480
    ds_read_b64_tr_b16 v[206:207], v27 offset:12488
    s_waitcnt lgkmcnt(15)
    v_mfma_f32_16x16x16_bf16 v[80:83], v[160:161], v[20:21], 0
    v_mfma_f32_16x16x16_bf16 v[84:87], v[162:163], v[20:21], 0
    v_mfma_f32_16x16x16_bf16 v[88:91], v[164:165], v[20:21], 0
    v_mfma_f32_16x16x16_bf16 v[92:95], v[166:167], v[20:21], 0
    v_mfma_f32_16x16x16_bf16 v[96:99], v[168:169], v[20:21], 0
    v_mfma_f32_16x16x16_bf16 v[100:103], v[170:171], v[20:21], 0
    v_mfma_f32_16x16x16_bf16 v[104:107], v[172:173], v[20:21], 0
    v_mfma_f32_16x16x16_bf16 v[108:111], v[174:175], v[20:21], 0
    v_cvt_pk_bf16_f32 v112, v112, v113
    v_cvt_pk_bf16_f32 v113, v114, v115
    v_cvt_pk_bf16_f32 v114, v116, v117
    v_cvt_pk_bf16_f32 v115, v118, v119
    ds_write_b128 v244, v[112:115] offset:64
    v_cvt_pk_bf16_f32 v120, v120, v121
    v_cvt_pk_bf16_f32 v121, v122, v123
    v_cvt_pk_bf16_f32 v122, v124, v125
    v_cvt_pk_bf16_f32 v123, v126, v127
    ds_write_b128 v245, v[120:123] offset:64
    v_cvt_pk_bf16_f32 v128, v128, v129
    v_cvt_pk_bf16_f32 v129, v130, v131
    v_cvt_pk_bf16_f32 v130, v132, v133
    v_cvt_pk_bf16_f32 v131, v134, v135
    ds_write_b128 v246, v[128:131] offset:64
    v_cvt_pk_bf16_f32 v136, v136, v137
    v_cvt_pk_bf16_f32 v137, v138, v139
    v_cvt_pk_bf16_f32 v138, v140, v141
    v_cvt_pk_bf16_f32 v139, v142, v143
    ds_write_b128 v247, v[136:139] offset:64
    v_cvt_pk_bf16_f32 v80, v80, v81
    v_cvt_pk_bf16_f32 v81, v82, v83
    v_cvt_pk_bf16_f32 v82, v84, v85
    v_cvt_pk_bf16_f32 v83, v86, v87
    ds_write_b128 v244, v[80:83] offset:12352
    v_cvt_pk_bf16_f32 v88, v88, v89
    v_cvt_pk_bf16_f32 v89, v90, v91
    v_cvt_pk_bf16_f32 v90, v92, v93
    v_cvt_pk_bf16_f32 v91, v94, v95
    ds_write_b128 v245, v[88:91] offset:12352
    v_cvt_pk_bf16_f32 v96, v96, v97
    v_cvt_pk_bf16_f32 v97, v98, v99
    v_cvt_pk_bf16_f32 v98, v100, v101
    v_cvt_pk_bf16_f32 v99, v102, v103
    ds_write_b128 v246, v[96:99] offset:12352
    v_cvt_pk_bf16_f32 v104, v104, v105
    v_cvt_pk_bf16_f32 v105, v106, v107
    v_cvt_pk_bf16_f32 v106, v108, v109
    v_cvt_pk_bf16_f32 v107, v110, v111
    ds_write_b128 v247, v[104:107] offset:12352
    ds_read_b128 v[208:211], v16 offset:12352
    ds_read_b128 v[212:215], v17 offset:13120
    ds_read_b128 v[216:219], v18 offset:13888
    ds_read_b128 v[220:223], v19 offset:14656
    s_add_u32 s62, s61, 0
    s_waitcnt lgkmcnt(3)
    buffer_store_dwordx4 v[208:211], v11, s[16:19], s62 offen sc1
    s_add_u32 s62, s61, 98304
    s_waitcnt lgkmcnt(2)
    buffer_store_dwordx4 v[212:215], v11, s[16:19], s62 offen sc1
    s_add_u32 s62, s61, 196608
    s_waitcnt lgkmcnt(1)
    buffer_store_dwordx4 v[216:219], v11, s[16:19], s62 offen sc1
    s_add_u32 s62, s61, 294912
    s_waitcnt lgkmcnt(0)
    buffer_store_dwordx4 v[220:223], v11, s[16:19], s62 offen sc1
    v_mfma_f32_16x16x16_bf16 v[112:115], v[176:177], v[20:21], 0
    v_mfma_f32_16x16x16_bf16 v[116:119], v[178:179], v[20:21], 0
    v_mfma_f32_16x16x16_bf16 v[120:123], v[180:181], v[20:21], 0
    v_mfma_f32_16x16x16_bf16 v[124:127], v[182:183], v[20:21], 0
    v_mfma_f32_16x16x16_bf16 v[128:131], v[184:185], v[20:21], 0
    v_mfma_f32_16x16x16_bf16 v[132:135], v[186:187], v[20:21], 0
    v_mfma_f32_16x16x16_bf16 v[136:139], v[188:189], v[20:21], 0
    v_mfma_f32_16x16x16_bf16 v[140:143], v[190:191], v[20:21], 0
    v_mfma_f32_16x16x16_bf16 v[80:83], v[64:65], v[20:21], 0
    v_mfma_f32_16x16x16_bf16 v[84:87], v[66:67], v[20:21], 0
    v_mfma_f32_16x16x16_bf16 v[88:91], v[68:69], v[20:21], 0
    v_mfma_f32_16x16x16_bf16 v[92:95], v[70:71], v[20:21], 0
    v_mfma_f32_16x16x16_bf16 v[96:99], v[72:73], v[20:21], 0
    v_mfma_f32_16x16x16_bf16 v[100:103], v[74:75], v[20:21], 0
    v_mfma_f32_16x16x16_bf16 v[104:107], v[76:77], v[20:21], 0
    v_mfma_f32_16x16x16_bf16 v[108:111], v[78:79], v[20:21], 0
    v_cvt_pk_bf16_f32 v112, v112, v113
    v_cvt_pk_bf16_f32 v113, v114, v115
    v_cvt_pk_bf16_f32 v114, v116, v117
    v_cvt_pk_bf16_f32 v115, v118, v119
    ds_write_b128 v244, v[112:115] offset:12416
    v_cvt_pk_bf16_f32 v120, v120, v121
    v_cvt_pk_bf16_f32 v121, v122, v123
    v_cvt_pk_bf16_f32 v122, v124, v125
    v_cvt_pk_bf16_f32 v123, v126, v127
    ds_write_b128 v245, v[120:123] offset:12416
    v_cvt_pk_bf16_f32 v128, v128, v129
    v_cvt_pk_bf16_f32 v129, v130, v131
    v_cvt_pk_bf16_f32 v130, v132, v133
    v_cvt_pk_bf16_f32 v131, v134, v135
    ds_write_b128 v246, v[128:131] offset:12416
    v_cvt_pk_bf16_f32 v136, v136, v137
    v_cvt_pk_bf16_f32 v137, v138, v139
    v_cvt_pk_bf16_f32 v138, v140, v141
    v_cvt_pk_bf16_f32 v139, v142, v143
    ds_write_b128 v247, v[136:139] offset:12416
    s_waitcnt lgkmcnt(0)
    s_barrier
    ds_read_b128 v[144:147], v16 offset:64
    ds_read_b128 v[148:151], v17 offset:832
    ds_read_b128 v[152:155], v18 offset:1600
    ds_read_b128 v[156:159], v19 offset:2368
    s_add_u32 s62, s60, 32768
    s_waitcnt lgkmcnt(3)
    buffer_store_dwordx4 v[144:147], v11, s[16:19], s62 offen sc1
    s_add_u32 s62, s60, 131072
    s_waitcnt lgkmcnt(2)
    buffer_store_dwordx4 v[148:151], v11, s[16:19], s62 offen sc1
    s_add_u32 s62, s60, 229376
    s_waitcnt lgkmcnt(1)
    buffer_store_dwordx4 v[152:155], v11, s[16:19], s62 offen sc1
    s_add_u32 s62, s60, 327680
    s_waitcnt lgkmcnt(0)
    buffer_store_dwordx4 v[156:159], v11, s[16:19], s62 offen sc1
    s_nop 0
    v_readfirstlane_b32 s82, v31
    s_mov_b32 s57, 0
FA_nb:
    s_cmp_lg_u32 s82, 0
    s_cbranch_scc1 FA_nokb
    s_add_u32 s57, s57, 1
    s_cmp_ge_u32 s57, 400000
    s_cbranch_scc1 FA_nokb
    s_sleep 4
    v_mov_b32 v30, 0
    global_load_dword v31, v30, s[76:77] sc1
    s_waitcnt vmcnt(0)
    v_readfirstlane_b32 s82, v31
    s_branch FA_nb
FA_nokb:
    s_waitcnt vmcnt(8)
    v_mov_b32 v1, s78
    v_mov_b32 v2, s82
    s_mov_b64 exec, 1
    global_atomic_swap v1, v2, s[8:9] sc1
    s_mov_b64 exec, -1
    v_cvt_pk_bf16_f32 v80, v80, v81
    v_cvt_pk_bf16_f32 v81, v82, v83
    v_cvt_pk_bf16_f32 v82, v84, v85
    v_cvt_pk_bf16_f32 v83, v86, v87
    ds_write_b128 v244, v[80:83] offset:128
    v_cvt_pk_bf16_f32 v88, v88, v89
    v_cvt_pk_bf16_f32 v89, v90, v91
    v_cvt_pk_bf16_f32 v90, v92, v93
    v_cvt_pk_bf16_f32 v91, v94, v95
    ds_write_b128 v245, v[88:91] offset:128
    v_cvt_pk_bf16_f32 v96, v96, v97
    v_cvt_pk_bf16_f32 v97, v98, v99
    v_cvt_pk_bf16_f32 v98, v100, v101
    v_cvt_pk_bf16_f32 v99, v102, v103
    ds_write_b128 v246, v[96:99] offset:128
    v_cvt_pk_bf16_f32 v104, v104, v105
    v_cvt_pk_bf16_f32 v105, v106, v107
    v_cvt_pk_bf16_f32 v106, v108, v109
    v_cvt_pk_bf16_f32 v107, v110, v111
    ds_write_b128 v247, v[104:107] offset:128
    v_mfma_f32_16x16x16_bf16 v[112:115], v[192:193], v[20:21], 0
    v_mfma_f32_16x16x16_bf16 v[116:119], v[194:195], v[20:21], 0
    v_mfma_f32_16x16x16_bf16 v[120:123], v[196:197], v[20:21], 0
    v_mfma_f32_16x16x16_bf16 v[124:127], v[198:199], v[20:21], 0
    v_mfma_f32_16x16x16_bf16 v[128:131], v[200:201], v[20:21], 0
    v_mfma_f32_16x16x16_bf16 v[132:135], v[202:203], v[20:21], 0
    v_mfma_f32_16x16x16_bf16 v[136:139], v[204:205], v[20:21], 0
    v_mfma_f32_16x16x16_bf16 v[140:143], v[206:207], v[20:21], 0
    s_nop 0
    v_cvt_pk_bf16_f32 v112, v112, v113
    v_cvt_pk_bf16_f32 v113, v114, v115
    v_cvt_pk_bf16_f32 v114, v116, v117
    v_cvt_pk_bf16_f32 v115, v118, v119
    ds_write_b128 v244, v[112:115] offset:12480
    v_cvt_pk_bf16_f32 v120, v120, v121
    v_cvt_pk_bf16_f32 v121, v122, v123
    v_cvt_pk_bf16_f32 v122, v124, v125
    v_cvt_pk_bf16_f32 v123, v126, v127
    ds_write_b128 v245, v[120:123] offset:12480
    v_cvt_pk_bf16_f32 v128, v128, v129
    v_cvt_pk_bf16_f32 v129, v130, v131
    v_cvt_pk_bf16_f32 v130, v132, v133
    v_cvt_pk_bf16_f32 v131, v134, v135
    ds_write_b128 v246, v[128:131] offset:12480
    v_cvt_pk_bf16_f32 v136, v136, v137
    v_cvt_pk_bf16_f32 v137, v138, v139
    v_cvt_pk_bf16_f32 v138, v140, v141
    v_cvt_pk_bf16_f32 v139, v142, v143
    ds_write_b128 v247, v[136:139] offset:12480
    s_waitcnt vmcnt(5)
    v_mov_b32 v1, s79
    v_mov_b32 v2, s82
    s_mov_b64 exec, 1
    global_atomic_swap v1, v2, s[8:9] sc1
    s_mov_b64 exec, -1
    s_mov_b32 s80, 2
    s_mov_b32 s81, 0
    s_branch FU_pb
FA_xw:
    s_mul_i32 s63, s20, 21
    s_add_u32 s63, s63, s83
    s_sub_u32 s63, s63, 40
    s_and_b32 s64, s63, 1
    s_lshr_b32 s63, s63, 1
    s_and_b32 s65, s63, 3
    s_lshr_b32 s63, s63, 2
    s_mul_i32 s66, s63, 86
    s_lshr_b32 s66, s66, 8
    s_mul_i32 s67, s66, 3
    s_sub_u32 s67, s63, s67
    v_lshlrev_b32 v22, 4, v0
    v_add_u32 v23, 1024, v22
    s_mul_i32 s68, s66, 129024
    s_mul_i32 s69, s67, 6144
    s_add_u32 s68, s68, s69
    s_mul_i32 s69, s65, 1536
    s_add_u32 s68, s68, s69
    s_mov_b32 s72, s86
    s_and_b32 s73, s87, 0xffff
    s_mov_b32 s74, 903168
    s_mov_b32 s75, 0x00020000
    s_add_u32 m0, s56, 12352
    s_add_u32 s69, s68, 0
    buffer_load_dwordx4 v22, s[72:75], s69 offen lds
    s_add_u32 m0, s56, 13376
    s_add_u32 s69, s68, 0
    buffer_load_dwordx4 v23, s[72:75], s69 offen lds
    s_add_u32 m0, s56, 14432
    s_add_u32 s69, s68, 18432
    buffer_load_dwordx4 v22, s[72:75], s69 offen lds
    s_add_u32 m0, s56, 15456
    s_add_u32 s69, s68, 18432
    buffer_load_dwordx4 v23, s[72:75], s69 offen lds
    s_add_u32 m0, s56, 16512
    s_add_u32 s69, s68, 36864
    buffer_load_dwordx4 v22, s[72:75], s69 offen lds
    s_add_u32 m0, s56, 17536
    s_add_u32 s69, s68, 36864
    buffer_load_dwordx4 v23, s[72:75], s69 offen lds
    s_add_u32 m0, s56, 18592
    s_add_u32 s69, s68, 55296
    buffer_load_dwordx4 v22, s[72:75], s69 offen lds
    s_add_u32 m0, s56, 19616
    s_add_u32 s69, s68, 55296
    buffer_load_dwordx4 v23, s[72:75], s69 offen lds
    s_add_u32 m0, s56, 20672
    s_add_u32 s69, s68, 73728
    buffer_load_dwordx4 v22, s[72:75], s69 offen lds
    s_add_u32 m0, s56, 21696
    s_add_u32 s69, s68, 73728
    buffer_load_dwordx4 v23, s[72:75], s69 offen lds
    s_add_u32 m0, s56, 22752
    s_add_u32 s69, s68, 92160
    buffer_load_dwordx4 v22, s[72:75], s69 offen lds
    s_add_u32 m0, s56, 23776
    s_add_u32 s69, s68, 92160
    buffer_load_dwordx4 v23, s[72:75], s69 offen lds
    s_add_u32 m0, s56, 24832
    s_add_u32 s69, s68, 110592
    buffer_load_dwordx4 v22, s[72:75], s69 offen lds
    s_add_u32 m0, s56, 25856
    s_add_u32 s69, s68, 110592
    buffer_load_dwordx4 v23, s[72:75], s69 offen lds
    v_lshlrev_b32 v2, 3, v0
    s_add_u32 s58, s10, FU_gt-FU_pc
    s_addc_u32 s59, s11, 0
    global_load_dwordx2 v[22:23], v2, s[58:59]
    s_add_u32 m0, s56, 0
    v_mad_i32_i24 v8, v16, s48, v12
    buffer_load_dwordx4 v8, s[12:15], s40 offen lds
    s_add_u32 m0, s56, 1024
    v_mad_i32_i24 v9, v17, s48, v13
    buffer_load_dwordx4 v9, s[12:15], s40 offen lds
    s_add_u32 m0, s56, 2048
    s_nop 0
    buffer_load_dwordx4 v14, s[12:15], s40 offen lds
    s_add_u32 m0, s56, 3088
    v_mad_i32_i24 v9, v16, s49, v12
    buffer_load_dwordx4 v9, s[12:15], s41 offen lds
    s_add_u32 m0, s56, 4112
    v_mad_i32_i24 v8, v17, s49, v13
    buffer_load_dwordx4 v8, s[12:15], s41 offen lds
    s_add_u32 m0, s56, 5136
    s_nop 0
    buffer_load_dwordx4 v14, s[12:15], s41 offen lds
    s_add_u32 m0, s56, 6176
    v_mad_i32_i24 v8, v16, s50, v12
    buffer_load_dwordx4 v8, s[12:15], s42 offen lds
    s_add_u32 m0, s56, 7200
    v_mad_i32_i24 v9, v17, s50, v13
    buffer_load_dwordx4 v9, s[12:15], s42 offen lds
    s_add_u32 m0, s56, 8224
    s_nop 0
    buffer_load_dwordx4 v14, s[12:15], s42 offen lds
    s_add_u32 m0, s56, 9264
    v_mad_i32_i24 v9, v16, s51, v12
    buffer_load_dwordx4 v9, s[12:15], s43 offen lds
    s_add_u32 m0, s56, 10288
    v_mad_i32_i24 v8, v17, s51, v13
    buffer_load_dwordx4 v8, s[12:15], s43 offen lds
    s_add_u32 m0, s56, 11312
    s_nop 0
    buffer_load_dwordx4 v14, s[12:15], s43 offen lds
    v_mov_b32 v30, 0
    global_load_dword v31, v30, s[76:77] sc1
    v_lshlrev_b32 v1, 3, v0
    s_add_u32 s58, s10, FU_bt-FU_pc
    s_addc_u32 s59, s11, 0
    global_load_dwordx2 v[20:21], v1, s[58:59]
    v_lshrrev_b32 v2, 4, v0
    v_and_b32 v3, 15, v0
    v_lshrrev_b32 v4, 2, v3
    v_and_b32 v5, 3, v0
    v_lshl_add_u32 v6, v2, 2, v4
    v_mul_u32_u24 v7, 193, v5
    v_mul_u32_u24 v8, 12, v6
    v_add_u32 v7, v7, v8
    v_mov_b32 v10, s56
    v_xor_b32 v9, 0, v2
    v_add_u32 v9, v7, v9
    v_lshl_add_u32 v24, v9, 4, v10
    v_xor_b32 v9, 1, v2
    v_add_u32 v9, v7, v9
    v_lshl_add_u32 v25, v9, 4, v10
    v_xor_b32 v9, 2, v2
    v_add_u32 v9, v7, v9
    v_lshl_add_u32 v26, v9, 4, v10
    v_xor_b32 v9, 3, v2
    v_add_u32 v9, v7, v9
    v_lshl_add_u32 v27, v9, 4, v10
    v_mul_u32_u24 v7, 193, v2
    v_mul_u32_u24 v8, 12, v3
    v_add_u32 v7, v7, v8
    v_lshrrev_b32 v8, 2, v3
    v_xor_b32 v9, 0, v8
    v_add_u32 v9, v7, v9
    v_lshl_add_u32 v244, v9, 4, v10
    v_xor_b32 v9, 1, v8
    v_add_u32 v9, v7, v9
    v_lshl_add_u32 v245, v9, 4, v10
    v_xor_b32 v9, 2, v8
    v_add_u32 v9, v7, v9
    v_lshl_add_u32 v246, v9, 4, v10
    v_xor_b32 v9, 3, v8
    v_add_u32 v9, v7, v9
    v_lshl_add_u32 v247, v9, 4, v10
    v_lshrrev_b32 v2, 4, v0
    v_bfe_u32 v3, v0, 2, 2
    v_and_b32 v4, 3, v0
    v_mul_u32_u24 v7, 193, v4
    v_mul_u32_u24 v8, 12, v2
    v_add_u32 v7, v7, v8
    v_xor_b32 v9, 0, v3
    v_add_u32 v9, v7, v9
    v_lshl_add_u32 v16, v9, 4, v10
    v_xor_b32 v9, 1, v3
    v_add_u32 v9, v7, v9
    v_lshl_add_u32 v17, v9, 4, v10
    v_xor_b32 v9, 2, v3
    v_add_u32 v9, v7, v9
    v_lshl_add_u32 v18, v9, 4, v10
    v_xor_b32 v9, 3, v3
    v_add_u32 v9, v7, v9
    v_lshl_add_u32 v19, v9, 4, v10
    v_lshlrev_b32 v7, 13, v2
    v_lshl_add_u32 v7, v3, 6, v7
    v_lshl_add_u32 v11, v4, 4, v7
    s_lshr_b32 s62, s21, 2
    s_lshl_b32 s78, s62, 7
    s_mul_i32 s60, s62, 393216
    s_lshl_b32 s62, s20, 2
    s_and_b32 s57, s21, 3
    s_add_u32 s62, s62, s57
    s_lshl_b32 s62, s62, 2
    s_add_u32 s78, s78, s62
    s_add_u32 s78, s78, 18579456
    s_lshl_b32 s62, s20, 10
    s_add_u32 s60, s60, s62
    s_and_b32 s62, s21, 3
    s_lshl_b32 s62, s62, 8
    s_add_u32 s60, s60, s62
    s_lshr_b32 s62, s22, 2
    s_lshl_b32 s79, s62, 7
    s_mul_i32 s61, s62, 393216
    s_lshl_b32 s62, s20, 2
    s_and_b32 s57, s22, 3
    s_add_u32 s62, s62, s57
    s_lshl_b32 s62, s62, 2
    s_add_u32 s79, s79, s62
    s_add_u32 s79, s79, 18579456
    s_lshl_b32 s62, s20, 10
    s_add_u32 s61, s61, s62
    s_and_b32 s62, s22, 3
    s_lshl_b32 s62, s62, 8
    s_add_u32 s61, s61, s62
    s_mov_b32 s16, s8
    s_and_b32 s17, s9, 0xffff
    s_mov_b32 s18, 16515072
    s_mov_b32 s19, 0x00020000
    v_bfe_u32 v3, v0, 4, 1
    v_bfe_u32 v4, v0, 2, 2
    v_lshl_add_u32 v3, v3, 2, v4
    v_min_u32 v3, 6, v3
    v_mul_u32_u24 v3, 2080, v3
    v_and_b32 v4, 3, v0
    v_lshl_add_u32 v3, v4, 3, v3
    s_mul_i32 s69, s64, 96
    s_add_u32 s69, s69, s56
    v_add_u32 v240, s69, v3
    v_lshrrev_b32 v4, 4, v0
    v_mul_u32_u24 v241, 86016, v4
    v_and_b32 v4, 15, v0
    v_lshl_add_u32 v241, v4, 4, v241
    s_mul_i32 s68, s64, 1032192
    s_mul_i32 s69, s67, 28672
    s_add_u32 s68, s68, s69
    s_lshl_b32 s69, s66, 10
    s_add_u32 s68, s68, s69
    s_lshl_b32 s69, s65, 8
    s_add_u32 s68, s68, s69
    s_add_u32 s72, s8, 16515072
    s_addc_u32 s73, s9, 0
    s_and_b32 s73, s73, 0xffff
    s_mov_b32 s74, 2064384
    s_waitcnt vmcnt(15)
    ds_read_b64_tr_b16 v[160:161], v240 offset:12352
    ds_read_b64_tr_b16 v[162:163], v240 offset:12544
    ds_read_b64_tr_b16 v[164:165], v240 offset:12736
    ds_read_b64_tr_b16 v[166:167], v240 offset:12928
    ds_read_b64_tr_b16 v[168:169], v240 offset:13120
    ds_read_b64_tr_b16 v[170:171], v240 offset:13312
    ds_read_b64_tr_b16 v[172:173], v240 offset:13504
    ds_read_b64_tr_b16 v[174:175], v240 offset:13696
    ds_read_b64_tr_b16 v[176:177], v240 offset:12384
    ds_read_b64_tr_b16 v[178:179], v240 offset:12576
    ds_read_b64_tr_b16 v[180:181], v240 offset:12768
    ds_read_b64_tr_b16 v[182:183], v240 offset:12960
    ds_read_b64_tr_b16 v[184:185], v240 offset:13152
    ds_read_b64_tr_b16 v[186:187], v240 offset:13344
    ds_read_b64_tr_b16 v[188:189], v240 offset:13536
    ds_read_b64_tr_b16 v[190:191], v240 offset:13728
    ds_read_b64_tr_b16 v[192:193], v240 offset:12416
    ds_read_b64_tr_b16 v[194:195], v240 offset:12608
    ds_read_b64_tr_b16 v[196:197], v240 offset:12800
    ds_read_b64_tr_b16 v[198:199], v240 offset:12992
    ds_read_b64_tr_b16 v[200:201], v240 offset:13184
    ds_read_b64_tr_b16 v[202:203], v240 offset:13376
    ds_read_b64_tr_b16 v[204:205], v240 offset:13568
    ds_read_b64_tr_b16 v[206:207], v240 offset:13760
    s_waitcnt vmcnt(14) lgkmcnt(15)
    v_mfma_f32_16x16x16_bf16 v[80:83], v[22:23], v[160:161], 0
    v_mfma_f32_16x16x16_bf16 v[84:87], v[22:23], v[162:163], 0
    v_mfma_f32_16x16x16_bf16 v[88:91], v[22:23], v[164:165], 0
    v_mfma_f32_16x16x16_bf16 v[92:95], v[22:23], v[166:167], 0
    v_mfma_f32_16x16x16_bf16 v[96:99], v[22:23], v[168:169], 0
    v_mfma_f32_16x16x16_bf16 v[100:103], v[22:23], v[170:171], 0
    v_mfma_f32_16x16x16_bf16 v[104:107], v[22:23], v[172:173], 0
    v_mfma_f32_16x16x16_bf16 v[108:111], v[22:23], v[174:175], 0
    s_nop 1
    v_cvt_pk_bf16_f32 v224, v80, v84
    s_nop 0
    v_cvt_pk_bf16_f32 v225, v88, v92
    s_nop 0
    v_cvt_pk_bf16_f32 v226, v96, v100
    s_nop 0
    v_cvt_pk_bf16_f32 v227, v104, v108
    s_add_u32 s69, s68, 0
    buffer_store_dwordx4 v[224:227], v241, s[72:75], s69 offen sc1
    v_cvt_pk_bf16_f32 v228, v81, v85
    v_cvt_pk_bf16_f32 v229, v89, v93
    v_cvt_pk_bf16_f32 v230, v97, v101
    v_cvt_pk_bf16_f32 v231, v105, v109
    s_add_u32 s69, s68, 7168
    buffer_store_dwordx4 v[228:231], v241, s[72:75], s69 offen sc1
    v_cvt_pk_bf16_f32 v232, v82, v86
    v_cvt_pk_bf16_f32 v233, v90, v94
    v_cvt_pk_bf16_f32 v234, v98, v102
    v_cvt_pk_bf16_f32 v235, v106, v110
    s_add_u32 s69, s68, 14336
    buffer_store_dwordx4 v[232:235], v241, s[72:75], s69 offen sc1
    v_cvt_pk_bf16_f32 v236, v83, v87
    v_cvt_pk_bf16_f32 v237, v91, v95
    v_cvt_pk_bf16_f32 v238, v99, v103
    v_cvt_pk_bf16_f32 v239, v107, v111
    s_add_u32 s69, s68, 21504
    buffer_store_dwordx4 v[236:239], v241, s[72:75], s69 offen sc1
    v_mfma_f32_16x16x16_bf16 v[112:115], v[22:23], v[176:177], 0
    s_waitcnt lgkmcnt(14)
    v_mfma_f32_16x16x16_bf16 v[116:119], v[22:23], v[178:179], 0
    s_waitcnt lgkmcnt(13)
    v_mfma_f32_16x16x16_bf16 v[120:123], v[22:23], v[180:181], 0
    s_waitcnt lgkmcnt(12)
    v_mfma_f32_16x16x16_bf16 v[124:127], v[22:23], v[182:183], 0
    s_waitcnt lgkmcnt(11)
    v_mfma_f32_16x16x16_bf16 v[128:131], v[22:23], v[184:185], 0
    s_waitcnt lgkmcnt(10)
    v_mfma_f32_16x16x16_bf16 v[132:135], v[22:23], v[186:187], 0
    s_waitcnt lgkmcnt(9)
    v_mfma_f32_16x16x16_bf16 v[136:139], v[22:23], v[188:189], 0
    s_waitcnt lgkmcnt(8)
    v_mfma_f32_16x16x16_bf16 v[140:143], v[22:23], v[190:191], 0
    v_cvt_pk_bf16_f32 v224, v112, v116
    v_cvt_pk_bf16_f32 v225, v120, v124
    s_nop 1
    v_cvt_pk_bf16_f32 v226, v128, v132
    s_nop 2
    v_cvt_pk_bf16_f32 v227, v136, v140
    s_add_u32 s69, s68, 344064
    buffer_store_dwordx4 v[224:227], v241, s[72:75], s69 offen sc1
    v_cvt_pk_bf16_f32 v228, v113, v117
    v_cvt_pk_bf16_f32 v229, v121, v125
    v_cvt_pk_bf16_f32 v230, v129, v133
    v_cvt_pk_bf16_f32 v231, v137, v141
    s_add_u32 s69, s68, 351232
    buffer_store_dwordx4 v[228:231], v241, s[72:75], s69 offen sc1
    v_cvt_pk_bf16_f32 v232, v114, v118
    v_cvt_pk_bf16_f32 v233, v122, v126
    v_cvt_pk_bf16_f32 v234, v130, v134
    v_cvt_pk_bf16_f32 v235, v138, v142
    s_add_u32 s69, s68, 358400
    buffer_store_dwordx4 v[232:235], v241, s[72:75], s69 offen sc1
    v_cvt_pk_bf16_f32 v236, v115, v119
    v_cvt_pk_bf16_f32 v237, v123, v127
    v_cvt_pk_bf16_f32 v238, v131, v135
    v_cvt_pk_bf16_f32 v239, v139, v143
    s_add_u32 s69, s68, 365568
    buffer_store_dwordx4 v[236:239], v241, s[72:75], s69 offen sc1
    s_waitcnt lgkmcnt(7)
    v_mfma_f32_16x16x16_bf16 v[80:83], v[22:23], v[192:193], 0
    s_waitcnt lgkmcnt(6)
    v_mfma_f32_16x16x16_bf16 v[84:87], v[22:23], v[194:195], 0
    s_waitcnt lgkmcnt(5)
    v_mfma_f32_16x16x16_bf16 v[88:91], v[22:23], v[196:197], 0
    s_waitcnt lgkmcnt(4)
    v_mfma_f32_16x16x16_bf16 v[92:95], v[22:23], v[198:199], 0
    s_waitcnt lgkmcnt(3)
    v_mfma_f32_16x16x16_bf16 v[96:99], v[22:23], v[200:201], 0
    s_waitcnt lgkmcnt(2)
    v_mfma_f32_16x16x16_bf16 v[100:103], v[22:23], v[202:203], 0
    s_waitcnt lgkmcnt(1)
    v_mfma_f32_16x16x16_bf16 v[104:107], v[22:23], v[204:205], 0
    s_waitcnt lgkmcnt(0)
    v_mfma_f32_16x16x16_bf16 v[108:111], v[22:23], v[206:207], 0
    v_cvt_pk_bf16_f32 v224, v80, v84
    v_cvt_pk_bf16_f32 v225, v88, v92
    s_nop 1
    v_cvt_pk_bf16_f32 v226, v96, v100
    s_nop 2
    v_cvt_pk_bf16_f32 v227, v104, v108
    s_add_u32 s69, s68, 688128
    buffer_store_dwordx4 v[224:227], v241, s[72:75], s69 offen sc1
    v_cvt_pk_bf16_f32 v228, v81, v85
    v_cvt_pk_bf16_f32 v229, v89, v93
    v_cvt_pk_bf16_f32 v230, v97, v101
    v_cvt_pk_bf16_f32 v231, v105, v109
    s_add_u32 s69, s68, 695296
    buffer_store_dwordx4 v[228:231], v241, s[72:75], s69 offen sc1
    v_cvt_pk_bf16_f32 v232, v82, v86
    v_cvt_pk_bf16_f32 v233, v90, v94
    v_cvt_pk_bf16_f32 v234, v98, v102
    v_cvt_pk_bf16_f32 v235, v106, v110
    s_add_u32 s69, s68, 702464
    buffer_store_dwordx4 v[232:235], v241, s[72:75], s69 offen sc1
    v_cvt_pk_bf16_f32 v236, v83, v87
    v_cvt_pk_bf16_f32 v237, v91, v95
    v_cvt_pk_bf16_f32 v238, v99, v103
    v_cvt_pk_bf16_f32 v239, v107, v111
    s_add_u32 s69, s68, 709632
    buffer_store_dwordx4 v[236:239], v241, s[72:75], s69 offen sc1
    s_waitcnt vmcnt(14)
    ds_read_b64_tr_b16 v[32:33], v24 offset:0
    ds_read_b64_tr_b16 v[34:35], v24 offset:8
    ds_read_b64_tr_b16 v[36:37], v25 offset:0
    ds_read_b64_tr_b16 v[38:39], v25 offset:8
    ds_read_b64_tr_b16 v[40:41], v26 offset:0
    ds_read_b64_tr_b16 v[42:43], v26 offset:8
    ds_read_b64_tr_b16 v[44:45], v27 offset:0
    ds_read_b64_tr_b16 v[46:47], v27 offset:8
    ds_read_b64_tr_b16 v[48:49], v24 offset:64
    ds_read_b64_tr_b16 v[50:51], v24 offset:72
    ds_read_b64_tr_b16 v[52:53], v25 offset:64
    ds_read_b64_tr_b16 v[54:55], v25 offset:72
    ds_read_b64_tr_b16 v[56:57], v26 offset:64
    ds_read_b64_tr_b16 v[58:59], v26 offset:72
    ds_read_b64_tr_b16 v[60:61], v27 offset:64
    ds_read_b64_tr_b16 v[62:63], v27 offset:72
    ds_read_b64_tr_b16 v[64:65], v24 offset:128
    ds_read_b64_tr_b16 v[66:67], v24 offset:136
    ds_read_b64_tr_b16 v[68:69], v25 offset:128
    ds_read_b64_tr_b16 v[70:71], v25 offset:136
    ds_read_b64_tr_b16 v[72:73], v26 offset:128
    ds_read_b64_tr_b16 v[74:75], v26 offset:136
    ds_read_b64_tr_b16 v[76:77], v27 offset:128
    ds_read_b64_tr_b16 v[78:79], v27 offset:136
    s_waitcnt vmcnt(12) lgkmcnt(15)
    v_mfma_f32_16x16x16_bf16 v[80:83], v[32:33], v[20:21], 0
    v_mfma_f32_16x16x16_bf16 v[84:87], v[34:35], v[20:21], 0
    v_mfma_f32_16x16x16_bf16 v[88:91], v[36:37], v[20:21], 0
    v_mfma_f32_16x16x16_bf16 v[92:95], v[38:39], v[20:21], 0
    v_mfma_f32_16x16x16_bf16 v[96:99], v[40:41], v[20:21], 0
    v_mfma_f32_16x16x16_bf16 v[100:103], v[42:43], v[20:21], 0
    v_mfma_f32_16x16x16_bf16 v[104:107], v[44:45], v[20:21], 0
    v_mfma_f32_16x16x16_bf16 v[108:111], v[46:47], v[20:21], 0
    v_mfma_f32_16x16x16_bf16 v[112:115], v[48:49], v[20:21], 0
    s_waitcnt lgkmcnt(14)
    v_mfma_f32_16x16x16_bf16 v[116:119], v[50:51], v[20:21], 0
    s_waitcnt lgkmcnt(13)
    v_mfma_f32_16x16x16_bf16 v[120:123], v[52:53], v[20:21], 0
    s_waitcnt lgkmcnt(12)
    v_mfma_f32_16x16x16_bf16 v[124:127], v[54:55], v[20:21], 0
    s_waitcnt lgkmcnt(11)
    v_mfma_f32_16x16x16_bf16 v[128:131], v[56:57], v[20:21], 0
    s_waitcnt lgkmcnt(10)
    v_mfma_f32_16x16x16_bf16 v[132:135], v[58:59], v[20:21], 0
    s_waitcnt lgkmcnt(9)
    v_mfma_f32_16x16x16_bf16 v[136:139], v[60:61], v[20:21], 0
    s_waitcnt lgkmcnt(8)
    v_mfma_f32_16x16x16_bf16 v[140:143], v[62:63], v[20:21], 0
    v_cvt_pk_bf16_f32 v80, v80, v81
    v_cvt_pk_bf16_f32 v81, v82, v83
    v_cvt_pk_bf16_f32 v82, v84, v85
    v_cvt_pk_bf16_f32 v83, v86, v87
    ds_write_b128 v244, v[80:83] offset:0
    v_cvt_pk_bf16_f32 v88, v88, v89
    v_cvt_pk_bf16_f32 v89, v90, v91
    v_cvt_pk_bf16_f32 v90, v92, v93
    v_cvt_pk_bf16_f32 v91, v94, v95
    ds_write_b128 v245, v[88:91] offset:0
    v_cvt_pk_bf16_f32 v96, v96, v97
    v_cvt_pk_bf16_f32 v97, v98, v99
    v_cvt_pk_bf16_f32 v98, v100, v101
    v_cvt_pk_bf16_f32 v99, v102, v103
    ds_write_b128 v246, v[96:99] offset:0
    v_cvt_pk_bf16_f32 v104, v104, v105
    v_cvt_pk_bf16_f32 v105, v106, v107
    v_cvt_pk_bf16_f32 v106, v108, v109
    v_cvt_pk_bf16_f32 v107, v110, v111
    ds_write_b128 v247, v[104:107] offset:0
    ds_read_b128 v[144:147], v16 offset:0
    ds_read_b128 v[148:151], v17 offset:768
    ds_read_b128 v[152:155], v18 offset:1536
    ds_read_b128 v[156:159], v19 offset:2304
    s_add_u32 s62, s60, 0
    s_waitcnt lgkmcnt(3)
    buffer_store_dwordx4 v[144:147], v11, s[16:19], s62 offen sc1
    s_add_u32 s62, s60, 98304
    s_waitcnt lgkmcnt(2)
    buffer_store_dwordx4 v[148:151], v11, s[16:19], s62 offen sc1
    s_add_u32 s62, s60, 196608
    s_waitcnt lgkmcnt(1)
    buffer_store_dwordx4 v[152:155], v11, s[16:19], s62 offen sc1
    s_add_u32 s62, s60, 294912
    s_waitcnt lgkmcnt(0)
    buffer_store_dwordx4 v[156:159], v11, s[16:19], s62 offen sc1
    v_mfma_f32_16x16x16_bf16 v[80:83], v[64:65], v[20:21], 0
    v_mfma_f32_16x16x16_bf16 v[84:87], v[66:67], v[20:21], 0
    v_mfma_f32_16x16x16_bf16 v[88:91], v[68:69], v[20:21], 0
    v_mfma_f32_16x16x16_bf16 v[92:95], v[70:71], v[20:21], 0
    v_mfma_f32_16x16x16_bf16 v[96:99], v[72:73], v[20:21], 0
    v_mfma_f32_16x16x16_bf16 v[100:103], v[74:75], v[20:21], 0
    v_mfma_f32_16x16x16_bf16 v[104:107], v[76:77], v[20:21], 0
    v_mfma_f32_16x16x16_bf16 v[108:111], v[78:79], v[20:21], 0
    v_cvt_pk_bf16_f32 v112, v112, v113
    v_cvt_pk_bf16_f32 v113, v114, v115
    v_cvt_pk_bf16_f32 v114, v116, v117
    v_cvt_pk_bf16_f32 v115, v118, v119
    ds_write_b128 v244, v[112:115] offset:64
    v_cvt_pk_bf16_f32 v120, v120, v121
    v_cvt_pk_bf16_f32 v121, v122, v123
    v_cvt_pk_bf16_f32 v122, v124, v125
    v_cvt_pk_bf16_f32 v123, v126, v127
    ds_write_b128 v245, v[120:123] offset:64
    v_cvt_pk_bf16_f32 v128, v128, v129
    v_cvt_pk_bf16_f32 v129, v130, v131
    v_cvt_pk_bf16_f32 v130, v132, v133
    v_cvt_pk_bf16_f32 v131, v134, v135
    ds_write_b128 v246, v[128:131] offset:64
    v_cvt_pk_bf16_f32 v136, v136, v137
    v_cvt_pk_bf16_f32 v137, v138, v139
    v_cvt_pk_bf16_f32 v138, v140, v141
    v_cvt_pk_bf16_f32 v139, v142, v143
    ds_write_b128 v247, v[136:139] offset:64
    s_waitcnt lgkmcnt(0)
    s_barrier
    v_cvt_pk_bf16_f32 v80, v80, v81
    v_cvt_pk_bf16_f32 v81, v82, v83
    v_cvt_pk_bf16_f32 v82, v84, v85
    v_cvt_pk_bf16_f32 v83, v86, v87
    ds_write_b128 v244, v[80:83] offset:128
    v_cvt_pk_bf16_f32 v88, v88, v89
    v_cvt_pk_bf16_f32 v89, v90, v91
    v_cvt_pk_bf16_f32 v90, v92, v93
    v_cvt_pk_bf16_f32 v91, v94, v95
    ds_write_b128 v245, v[88:91] offset:128
    v_cvt_pk_bf16_f32 v96, v96, v97
    v_cvt_pk_bf16_f32 v97, v98, v99
    v_cvt_pk_bf16_f32 v98, v100, v101
    v_cvt_pk_bf16_f32 v99, v102, v103
    ds_write_b128 v246, v[96:99] offset:128
    v_cvt_pk_bf16_f32 v104, v104, v105
    v_cvt_pk_bf16_f32 v105, v106, v107
    v_cvt_pk_bf16_f32 v106, v108, v109
    v_cvt_pk_bf16_f32 v107, v110, v111
    ds_write_b128 v247, v[104:107] offset:128
    s_nop 0
    v_readfirstlane_b32 s82, v31
    s_mov_b32 s57, 0
FA_nc:
    s_cmp_lg_u32 s82, 0
    s_cbranch_scc1 FA_nokc
    s_add_u32 s57, s57, 1
    s_cmp_ge_u32 s57, 400000
    s_cbranch_scc1 FA_nokc
    s_sleep 4
    v_mov_b32 v30, 0
    global_load_dword v31, v30, s[76:77] sc1
    s_waitcnt vmcnt(0)
    v_readfirstlane_b32 s82, v31
    s_branch FA_nc
FA_nokc:
    s_waitcnt vmcnt(4)
    s_lshl_b32 s79, s66, 2
    s_add_u32 s79, s79, s65
    s_lshl_b32 s79, s79, 1
    s_add_u32 s79, s79, s64
    s_lshl_b32 s79, s79, 2
    s_lshl_b32 s69, s67, 8
    s_add_u32 s79, s79, s69
    s_add_u32 s79, s79, 18591744
    v_lshlrev_b32 v1, 10, v0
    v_add_u32 v1, s79, v1
    v_mov_b32 v2, s82
    s_mov_b64 exec, 0xff
    global_atomic_swap v1, v2, s[8:9] sc1
    s_mov_b64 exec, -1
    s_waitcnt vmcnt(1)
    v_mov_b32 v1, s78
    v_mov_b32 v2, s82
    s_mov_b64 exec, 1
    global_atomic_swap v1, v2, s[8:9] sc1
    s_mov_b64 exec, -1
    s_mov_b32 s79, 0
    s_mov_b32 s61, 0x40000000
    s_mov_b32 s80, 3
    s_mov_b32 s81, 0
    s_branch FU_pb
FU_pb:
    s_waitcnt lgkmcnt(0)
    s_mov_b32 s88, s60
    s_mov_b32 s89, s61
    s_mov_b32 s84, s8
    s_and_b32 s85, s9, 0xffff
    s_mov_b32 s86, 16515072
    s_mov_b32 s87, 0x00020000
    s_cmp_ge_u32 s2, 8
    s_cbranch_scc1 K2_nocpf
    s_lshl_b32 s33, s24, 13
    v_lshlrev_b32 v4, 7, v0
    v_add_u32 v4, s33, v4
    v_min_u32 v4, K2_code_end-FU_pc-4, v4
    global_load_dword v72, v4, s[10:11]
K2_nocpf:
    s_and_b32 s25, s2, 7
    s_lshr_b32 s26, s2, 3
    s_mul_i32 s27, s26, 43
    s_lshr_b32 s27, s27, 8
    s_mul_i32 s28, s27, 6
    s_sub_u32 s28, s26, s28
    s_lshl_b32 s27, s27, 3
    s_add_u32 s27, s27, s25
    s_cmp_lt_u32 s26, 30
    s_cbranch_scc1 K2_map
    s_lshl_b32 s29, s25, 1
    s_add_u32 s29, s29, s26
    s_sub_u32 s29, s29, 30
    s_mul_i32 s27, s29, 43
    s_lshr_b32 s27, s27, 8
    s_mul_i32 s28, s27, 6
    s_sub_u32 s28, s29, s28
    s_add_u32 s27, s27, 40
K2_map:
    s_cmp_ge_u32 s27, 42
    s_cbranch_scc1 FU_idle
    v_lshlrev_b32 v1, 4, v0
    v_and_b32 v3, 15, v0
    v_cmp_ne_u32 vcc, 0, v3
    v_lshrrev_b32 v4, 4, v0
    v_lshlrev_b32 v4, 6, v4
    v_lshrrev_b32 v5, 2, v3
    v_lshl_add_u32 v5, v5, 8, v4
    v_and_b32 v6, 3, v0
    v_lshl_add_u32 v247, v6, 4, v5
    v_min_u32 v3, 5, v3
    v_add_u32 v3, 2, v3
    v_lshlrev_b32 v3, 10, v3
    v_add_u32 v3, v3, v4
    v_add_u32 v2, 816, v3
    s_lshl_b32 s29, s27, 2
    s_add_u32 s29, s29, s24
    s_mul_i32 s29, s29, 98304
    s_max_u32 s30, s27, 1
    s_sub_u32 s30, s30, 1
    s_lshl_b32 s30, s30, 2
    s_add_u32 s30, s30, s24
    s_mul_i32 s30, s30, 98304
    s_lshl_b32 s31, s28, 2
    s_add_u32 s31, s31, s24
    s_mul_i32 s31, s31, 86016
    s_add_u32 s31, s31, 16515072
    s_mov_b32 s32, 0
    s_mov_b32 s36, 1
    s_mov_b32 s39, 2
    s_mul_i32 s14, s32, 32768
    s_add_u32 s14, s14, s29
    s_mul_i32 s18, s32, 28672
    s_add_u32 s18, s18, s31
    s_add_u32 s12, s8, s14
    s_addc_u32 s13, s9, 0
    s_and_b32 s13, s13, 0xffff
    s_mov_b32 s14, 32768
    s_mov_b32 s15, 0x00020000
    s_add_u32 s16, s8, s18
    s_addc_u32 s17, s9, 0
    s_and_b32 s17, s17, 0xffff
    s_mov_b32 s18, 28672
    s_mov_b32 s19, 0x00020000
    s_mov_b32 s25, 4096
    s_mov_b32 s26, 8192
    s_mov_b32 s64, 12288
    s_add_u32 s10, s10, K2_at-FU_pc
    s_addc_u32 s11, s11, 0
    s_lshl_b32 s33, s24, 10
    v_add_u32 v3, s33, v1
    global_load_dwordx4 v[4:7], v3, s[10:11]
    s_mov_b32 s65, 16384
    s_mov_b32 s66, 20480
    s_mov_b32 s67, 24576
    s_mov_b32 s68, 28672
    s_mul_i32 s22, s32, 32768
    s_add_u32 s22, s22, s30
    s_add_u32 s20, s8, s22
    s_addc_u32 s21, s9, 0
    s_and_b32 s21, s21, 0xffff
    s_mov_b32 s22, 425984
    s_mov_b32 s23, 0x00020000
    s_mul_i32 s42, s36, 32768
    s_add_u32 s42, s42, s29
    s_add_u32 s40, s8, s42
    s_addc_u32 s41, s9, 0
    s_and_b32 s41, s41, 0xffff
    s_mov_b32 s42, 32768
    s_mov_b32 s43, 0x00020000
    s_mul_i32 s50, s36, 28672
    s_add_u32 s50, s50, s31
    s_add_u32 s48, s8, s50
    s_addc_u32 s49, s9, 0
    s_and_b32 s49, s49, 0xffff
    s_mov_b32 s50, 28672
    s_mov_b32 s51, 0x00020000
    s_mul_i32 s58, s36, 32768
    s_add_u32 s58, s58, s30
    s_add_u32 s56, s8, s58
    s_addc_u32 s57, s9, 0
    s_and_b32 s57, s57, 0xffff
    s_mov_b32 s58, 425984
    s_mov_b32 s59, 0x00020000
    s_mul_i32 s46, s39, 32768
    s_add_u32 s46, s46, s29
    s_add_u32 s44, s8, s46
    s_addc_u32 s45, s9, 0
    s_and_b32 s45, s45, 0xffff
    s_mov_b32 s46, 32768
    s_mov_b32 s47, 0x00020000
    s_mul_i32 s54, s39, 28672
    s_add_u32 s54, s54, s31
    s_add_u32 s52, s8, s54
    s_addc_u32 s53, s9, 0
    s_and_b32 s53, s53, 0xffff
    s_mov_b32 s54, 28672
    s_mov_b32 s55, 0x00020000
    s_mul_i32 s62, s39, 32768
    s_add_u32 s62, s62, s30
    s_add_u32 s60, s8, s62
    s_addc_u32 s61, s9, 0
    s_and_b32 s61, s61, 0xffff
    s_mov_b32 s62, 425984
    s_mov_b32 s63, 0x00020000
    v_and_b32 v237, 15, v0
    v_lshrrev_b32 v238, 4, v0
    v_lshlrev_b32 v239, 10, v238
    v_lshl_add_u32 v239, v237, 4, v239
    s_lshr_b32 s33, s24, 1
    s_mul_i32 s33, s33, 32768
    s_and_b32 s34, s24, 1
    s_lshl_b32 s34, s34, 3
    s_add_u32 s33, s33, s34
    v_add_u32 v244, s33, v239
    v_xor_b32 v240, s24, v238
    v_lshl_add_u32 v240, v240, 2, v239
    v_add_u32 v245, 65536, v240
    v_min_u32 v239, 2, v238
    v_lshlrev_b32 v239, 15, v239
    v_lshl_add_u32 v239, v237, 4, v239
    s_lshl_b32 s33, s24, 10
    v_add_u32 v246, s33, v239
    s_lshl_b32 s33, s24, 14
    s_add_u32 s33, s33, 98304
    v_and_b32 v237, 15, v0
    v_lshrrev_b32 v239, 1, v238
    v_lshl_add_u32 v239, v237, 1, v239
    v_bfe_u32 v240, v237, 2, 1
    v_xor_b32 v239, v239, v240
    v_and_b32 v240, 1, v238
    v_lshlrev_b32 v240, 9, v240
    v_lshl_add_u32 v239, v239, 4, v240
    v_add_u32 v240, s33, v239
    v_bfe_u32 v240, v0, 3, 1
    v_xor_b32 v240, v0, v240
    v_lshl_add_u32 v241, v240, 4, s33
    v_bfe_u32 v236, v0, 4, 1
    v_and_b32 v237, 15, v0
    v_lshrrev_b32 v238, 5, v0
    s_mov_b32 s38, 224
    s_mov_b32 s35, 2260
    s_mov_b32 s37, 192
    s_lshl_b32 s33, s27, 4
    s_lshl_b32 s34, s24, 2
    s_add_u32 s33, s33, s34
    s_add_u32 s33, s33, 0
    v_add_u32 v239, s33, v236
    v_mul_u32_u24 v240, s35, v239
    v_lshrrev_b32 v240, 16, v240
    v_mul_u32_u24 v241, 29, v240
    v_sub_u32 v241, v239, v241
    v_mul_u32_u24 v242, 10, v240
    v_add_u32 v242, v242, v237
    v_subrev_u32 v243, 1, v241
    v_mul_u32_u24 v243, 1792, v243
    v_add_u32 v243, v243, v242
    v_mul_lo_u32 v243, v243, s37
    v_lshl_add_u32 v243, v238, 4, v243
    s_lshl_b32 s34, s28, 5
    v_add_u32 v243, s34, v243
    v_cmp_ne_u32 s[70:71], 0, v241
    v_cmp_gt_u32 s[72:73], 10, v237
    v_cmp_gt_u32 s[74:75], s38, v242
    v_mov_b32 v239, 0x7fffffff
    s_nop 2
    s_and_b64 s[70:71], s[70:71], s[72:73]
    s_and_b64 s[70:71], s[70:71], s[74:75]
    s_nop 0
    v_cndmask_b32 v249, v239, v243, s[70:71]
    s_lshl_b32 s33, s27, 4
    s_lshl_b32 s34, s24, 2
    s_add_u32 s33, s33, s34
    s_add_u32 s33, s33, 2
    v_add_u32 v239, s33, v236
    v_mul_u32_u24 v240, s35, v239
    v_lshrrev_b32 v240, 16, v240
    v_mul_u32_u24 v241, 29, v240
    v_sub_u32 v241, v239, v241
    v_mul_u32_u24 v242, 10, v240
    v_add_u32 v242, v242, v237
    v_subrev_u32 v243, 1, v241
    v_mul_u32_u24 v243, 1792, v243
    v_add_u32 v243, v243, v242
    v_mul_lo_u32 v243, v243, s37
    v_lshl_add_u32 v243, v238, 4, v243
    s_lshl_b32 s34, s28, 5
    v_add_u32 v243, s34, v243
    v_cmp_ne_u32 s[70:71], 0, v241
    v_cmp_gt_u32 s[72:73], 10, v237
    v_cmp_gt_u32 s[74:75], s38, v242
    v_mov_b32 v239, 0x7fffffff
    s_nop 2
    s_and_b64 s[70:71], s[70:71], s[72:73]
    s_and_b64 s[70:71], s[70:71], s[74:75]
    s_nop 0
    v_cndmask_b32 v250, v239, v243, s[70:71]
    s_cmp_eq_u32 s27, 0
    s_cselect_b32 s33, 0, 393216
    v_and_b32 v239, 15, v0
    v_add_u32 v239, -1, v239
    v_lshrrev_b32 v240, 2, v239
    v_lshlrev_b32 v240, 8, v240
    v_and_b32 v239, 3, v239
    v_lshl_add_u32 v239, v239, 4, v240
    v_lshrrev_b32 v240, 4, v0
    v_lshlrev_b32 v240, 6, v240
    v_add3_u32 v239, v239, v240, s33
    v_add_u32 v240, 816, v240
    v_cndmask_b32 v251, v240, v239, vcc
    s_mov_b32 s6, 9633792
    s_mov_b32 s7, 0x00020000
    s_and_b32 s5, s5, 0xffff
    s_mov_b32 s94, 0x03ff03ff
    s_mov_b32 s95, 0x03ff03ff
    s_lshl_b32 s33, s27, 7
    s_max_u32 s34, s27, 1
    s_sub_u32 s34, s34, 1
    s_lshl_b32 s34, s34, 7
    v_mov_b32 v252, s33
    v_mov_b32 v253, s34
    v_cmp_gt_u32 s[72:73], 32, v0
    s_nop 1
    v_cndmask_b32 v252, v253, v252, s[72:73]
    v_and_b32 v253, 31, v0
    v_lshl_add_u32 v252, v253, 2, v252
    v_add_u32 v252, 18579456, v252
    v_add_u32 v253, 6144, v252
    v_add_u32 v254, 20480, v252
    v_min_u32 v255, 55, v0
    v_lshlrev_b32 v255, 2, v255
    s_and_b32 s33, s2, 7
    s_lshl_b32 s33, s33, 10
    s_add_u32 s33, s33, 18591744
    v_add_u32 v255, s33, v255
    s_mov_b32 s33, 0
    s_waitcnt vmcnt(0)
    s_cmp_lg_u32 s24, 3
    s_cbranch_scc1 FU_sig
    global_load_dword v3, v252, s[8:9] sc1
    global_load_dword v8, v255, s[8:9] sc1
    s_waitcnt vmcnt(0)
    v_cmp_ne_u32 s[72:73], s82, v3
    v_cmp_ne_u32 s[74:75], s82, v8
    s_nop 4
    s_or_b64 s[72:73], s[72:73], s[74:75]
    s_cmp_lg_u64 s[72:73], 0
    s_cbranch_scc1 FU_poll0_again
FU_poll0_ok:
FU_sig:
    s_cmp_eq_u32 s80, 3
    s_cselect_b32 s80, 0, s78
    s_cmp_eq_u32 s80, 0
    s_cbranch_scc1 FU_nosig0_80
    s_add_u32 s33, s80, 6144
    v_mov_b32 v12, s33
    v_mov_b32 v13, s82
    s_mov_b64 exec, 1
    global_atomic_swap v12, v13, s[8:9] sc1
    s_mov_b64 exec, -1
FU_nosig0_80:
    s_cmp_eq_u32 s81, 0
    s_cbranch_scc1 FU_nosig0_81
    s_add_u32 s33, s81, 6144
    v_mov_b32 v12, s33
    v_mov_b32 v13, s82
    s_mov_b64 exec, 1
    global_atomic_swap v12, v13, s[8:9] sc1
    s_mov_b64 exec, -1
FU_nosig0_81:
    s_barrier
    buffer_load_dwordx4 v[72:75], v247, s[12:15], s25 offen offset:3072 sc1
    buffer_load_dwordx4 a[96:99], v1, s[16:19], 0 offen offset:0 sc1
    buffer_load_dwordx4 a[100:103], v1, s[16:19], s25 offen offset:3072 sc1
    buffer_load_dwordx4 v[76:79], v247, s[12:15], s64 offen offset:3072 sc1
    buffer_load_dwordx4 v[80:83], v247, s[12:15], s64 offen offset:2048 sc1
    buffer_load_dwordx4 a[104:107], v1, s[16:19], s26 offen offset:0 sc1
    buffer_load_dwordx4 a[108:111], v1, s[16:19], 0 offen offset:1024 sc1
    buffer_load_dwordx4 v[84:87], v247, s[12:15], s25 offen offset:2048 sc1
    buffer_load_dwordx4 v[88:91], v247, s[12:15], s64 offen offset:1024 sc1
    buffer_load_dwordx4 a[112:115], v1, s[16:19], s26 offen offset:1024 sc1
    buffer_load_dwordx4 a[116:119], v1, s[16:19], 0 offen offset:2048 sc1
    buffer_load_dwordx4 v[92:95], v247, s[12:15], s25 offen offset:1024 sc1
    buffer_load_dwordx4 v[96:99], v247, s[12:15], s25 offen offset:0 sc1
    buffer_load_dwordx4 a[120:123], v1, s[16:19], 0 offen offset:3072 sc1
    buffer_load_dwordx4 a[124:127], v1, s[16:19], s26 offen offset:2048 sc1
    buffer_load_dwordx4 v[100:103], v247, s[12:15], s64 offen offset:0 sc1
    s_waitcnt vmcnt(14)
    v_mfma_f32_16x16x32_bf16 a[28:31], v[72:75], a[96:99], 0
    buffer_load_dwordx4 v[104:107], v247, s[12:15], 0 offen offset:3072 sc1
    s_waitcnt vmcnt(14)
    v_mfma_f32_16x16x32_bf16 a[60:63], v[72:75], a[100:103], 0
    s_waitcnt vmcnt(13)
    v_mfma_f32_16x16x32_bf16 a[60:63], v[76:79], a[96:99], a[60:63]
    buffer_load_dwordx4 v[108:111], v247, s[12:15], s26 offen offset:3072 sc1
    v_mfma_f32_16x16x32_bf16 a[92:95], v[76:79], a[100:103], 0
    s_waitcnt vmcnt(12)
    v_mfma_f32_16x16x32_bf16 a[92:95], v[80:83], a[104:107], a[92:95]
    s_waitcnt vmcnt(11)
    v_mfma_f32_16x16x32_bf16 a[60:63], v[80:83], a[108:111], a[60:63]
    s_waitcnt vmcnt(10)
    v_mfma_f32_16x16x32_bf16 a[60:63], v[84:87], a[104:107], a[60:63]
    v_mfma_f32_16x16x32_bf16 a[28:31], v[84:87], a[108:111], a[28:31]
    buffer_load_dwordx4 v[112:115], v2, s[20:23], 0 offen offset:0 sc1
    v_mfma_f32_16x16x32_bf16 a[24:27], v[84:87], a[96:99], 0
    v_mfma_f32_16x16x32_bf16 a[56:59], v[84:87], a[100:103], 0
    v_mfma_f32_16x16x32_bf16 a[56:59], v[80:83], a[96:99], a[56:59]
    buffer_load_dwordx4 v[116:119], v2, s[20:23], s26 offen offset:0 sc1
    v_mfma_f32_16x16x32_bf16 a[88:91], v[80:83], a[100:103], 0
    s_waitcnt vmcnt(10)
    v_mfma_f32_16x16x32_bf16 a[92:95], v[88:91], a[112:115], a[92:95]
    s_waitcnt vmcnt(9)
    v_mfma_f32_16x16x32_bf16 a[60:63], v[88:91], a[116:119], a[60:63]
    s_waitcnt vmcnt(8)
    v_mfma_f32_16x16x32_bf16 a[60:63], v[92:95], a[112:115], a[60:63]
    v_mfma_f32_16x16x32_bf16 a[28:31], v[92:95], a[116:119], a[28:31]
    buffer_load_dwordx4 v[120:123], v247, s[12:15], 0 offen offset:2048 sc1
    v_mfma_f32_16x16x32_bf16 a[24:27], v[92:95], a[108:111], a[24:27]
    v_mfma_f32_16x16x32_bf16 a[56:59], v[92:95], a[104:107], a[56:59]
    v_mfma_f32_16x16x32_bf16 a[56:59], v[88:91], a[108:111], a[56:59]
    buffer_load_dwordx4 v[124:127], v247, s[12:15], s26 offen offset:2048 sc1
    v_mfma_f32_16x16x32_bf16 a[88:91], v[88:91], a[104:107], a[88:91]
    v_mfma_f32_16x16x32_bf16 a[84:87], v[88:91], a[100:103], 0
    v_mfma_f32_16x16x32_bf16 a[52:55], v[88:91], a[96:99], 0
    v_mfma_f32_16x16x32_bf16 a[52:55], v[92:95], a[100:103], a[52:55]
    v_mfma_f32_16x16x32_bf16 a[20:23], v[92:95], a[96:99], 0
    buffer_load_dwordx4 v[128:131], v247, s[12:15], 0 offen offset:1024 sc1
    s_waitcnt vmcnt(9)
    v_mfma_f32_16x16x32_bf16 a[28:31], v[96:99], a[120:123], a[28:31]
    s_waitcnt vmcnt(8)
    v_mfma_f32_16x16x32_bf16 a[60:63], v[96:99], a[124:127], a[60:63]
    s_waitcnt vmcnt(7)
    v_mfma_f32_16x16x32_bf16 a[60:63], v[100:103], a[120:123], a[60:63]
    v_mfma_f32_16x16x32_bf16 a[92:95], v[100:103], a[124:127], a[92:95]
    v_mfma_f32_16x16x32_bf16 a[88:91], v[100:103], a[112:115], a[88:91]
    buffer_load_dwordx4 v[132:135], v247, s[12:15], s26 offen offset:1024 sc1
    v_mfma_f32_16x16x32_bf16 a[56:59], v[100:103], a[116:119], a[56:59]
    v_mfma_f32_16x16x32_bf16 a[56:59], v[96:99], a[112:115], a[56:59]
    v_mfma_f32_16x16x32_bf16 a[24:27], v[96:99], a[116:119], a[24:27]
    v_mfma_f32_16x16x32_bf16 a[20:23], v[96:99], a[108:111], a[20:23]
    v_mfma_f32_16x16x32_bf16 a[52:55], v[96:99], a[104:107], a[52:55]
    buffer_load_dwordx4 v[136:139], v247, s[12:15], 0 offen offset:0 sc1
    v_mfma_f32_16x16x32_bf16 a[52:55], v[100:103], a[108:111], a[52:55]
    v_mfma_f32_16x16x32_bf16 a[84:87], v[100:103], a[104:107], a[84:87]
    v_mfma_f32_16x16x32_bf16 a[80:83], v[100:103], a[100:103], 0
    v_mfma_f32_16x16x32_bf16 a[48:51], v[100:103], a[96:99], 0
    v_mfma_f32_16x16x32_bf16 a[48:51], v[96:99], a[100:103], a[48:51]
    buffer_load_dwordx4 v[140:143], v247, s[12:15], s26 offen offset:0 sc1
    v_mfma_f32_16x16x32_bf16 a[16:19], v[96:99], a[96:99], 0
    s_waitcnt vmcnt(9)
    v_mfma_f32_16x16x32_bf16 a[24:27], v[104:107], a[120:123], a[24:27]
    v_mfma_f32_16x16x32_bf16 a[56:59], v[104:107], a[124:127], a[56:59]
    s_waitcnt vmcnt(8)
    v_mfma_f32_16x16x32_bf16 a[56:59], v[108:111], a[120:123], a[56:59]
    v_mfma_f32_16x16x32_bf16 a[88:91], v[108:111], a[124:127], a[88:91]
    buffer_load_dwordx4 a[128:131], v1, s[16:19], s25 offen offset:0 sc1
    v_mfma_f32_16x16x32_bf16 a[84:87], v[108:111], a[112:115], a[84:87]
    v_mfma_f32_16x16x32_bf16 a[52:55], v[108:111], a[116:119], a[52:55]
    v_mfma_f32_16x16x32_bf16 a[52:55], v[104:107], a[112:115], a[52:55]
    v_mfma_f32_16x16x32_bf16 a[20:23], v[104:107], a[116:119], a[20:23]
    v_mfma_f32_16x16x32_bf16 a[16:19], v[104:107], a[108:111], a[16:19]
    buffer_load_dwordx4 a[132:135], v1, s[16:19], s25 offen offset:1024 sc1
    v_mfma_f32_16x16x32_bf16 a[48:51], v[104:107], a[104:107], a[48:51]
    v_mfma_f32_16x16x32_bf16 a[48:51], v[108:111], a[108:111], a[48:51]
    v_mfma_f32_16x16x32_bf16 a[80:83], v[108:111], a[104:107], a[80:83]
    v_mfma_f32_16x16x32_bf16 a[76:79], v[108:111], a[100:103], 0
    v_mfma_f32_16x16x32_bf16 a[44:47], v[108:111], a[96:99], 0
    buffer_load_dwordx4 a[136:139], v1, s[16:19], s25 offen offset:2048 sc1
    v_mfma_f32_16x16x32_bf16 a[44:47], v[104:107], a[100:103], a[44:47]
    v_mfma_f32_16x16x32_bf16 a[12:15], v[104:107], a[96:99], 0
    s_waitcnt vmcnt(8)
    v_mfma_f32_16x16x32_bf16 a[20:23], v[120:123], a[120:123], a[20:23]
    v_mfma_f32_16x16x32_bf16 a[52:55], v[120:123], a[124:127], a[52:55]
    s_waitcnt vmcnt(7)
    v_mfma_f32_16x16x32_bf16 a[52:55], v[124:127], a[120:123], a[52:55]
    buffer_load_dwordx4 a[140:143], v1, s[16:19], s64 offen offset:1024 sc1
    v_mfma_f32_16x16x32_bf16 a[84:87], v[124:127], a[124:127], a[84:87]
    v_mfma_f32_16x16x32_bf16 a[80:83], v[124:127], a[112:115], a[80:83]
    v_mfma_f32_16x16x32_bf16 a[48:51], v[124:127], a[116:119], a[48:51]
    v_mfma_f32_16x16x32_bf16 a[48:51], v[120:123], a[112:115], a[48:51]
    v_mfma_f32_16x16x32_bf16 a[16:19], v[120:123], a[116:119], a[16:19]
    buffer_load_dwordx4 a[144:147], v1, s[16:19], s64 offen offset:0 sc1
    v_mfma_f32_16x16x32_bf16 a[12:15], v[120:123], a[108:111], a[12:15]
    v_mfma_f32_16x16x32_bf16 a[44:47], v[120:123], a[104:107], a[44:47]
    v_mfma_f32_16x16x32_bf16 a[44:47], v[124:127], a[108:111], a[44:47]
    v_mfma_f32_16x16x32_bf16 a[76:79], v[124:127], a[104:107], a[76:79]
    v_mov_b32_dpp v72, v72 row_shr:1 row_mask:0xf bank_mask:0xf
    v_mov_b32_dpp v73, v73 row_shr:1 row_mask:0xf bank_mask:0xf
    v_mfma_f32_16x16x32_bf16 a[72:75], v[124:127], a[100:103], 0
    buffer_load_dwordx4 a[148:151], v1, s[16:19], s26 offen offset:3072 sc1
    v_mov_b32_dpp v74, v74 row_shr:1 row_mask:0xf bank_mask:0xf
    v_mfma_f32_16x16x32_bf16 a[40:43], v[124:127], a[96:99], 0
    v_mov_b32_dpp v75, v75 row_shr:1 row_mask:0xf bank_mask:0xf
    v_cndmask_b32_dpp v72, v112, v72, vcc row_shl:5 row_mask:0xf bank_mask:0xf
    v_mfma_f32_16x16x32_bf16 a[40:43], v[120:123], a[100:103], a[40:43]
    v_cndmask_b32_dpp v73, v113, v73, vcc row_shl:5 row_mask:0xf bank_mask:0xf
    v_cndmask_b32_dpp v74, v114, v74, vcc row_shl:5 row_mask:0xf bank_mask:0xf
    v_mfma_f32_16x16x32_bf16 a[8:11], v[120:123], a[96:99], 0
    v_cndmask_b32_dpp v75, v115, v75, vcc row_shl:5 row_mask:0xf bank_mask:0xf
    s_waitcnt vmcnt(9)
    v_mfma_f32_16x16x32_bf16 a[16:19], v[128:131], a[120:123], a[16:19]
    v_mov_b32_dpp v76, v76 row_shr:1 row_mask:0xf bank_mask:0xf
    v_mov_b32_dpp v77, v77 row_shr:1 row_mask:0xf bank_mask:0xf
    v_mfma_f32_16x16x32_bf16 a[48:51], v[128:131], a[124:127], a[48:51]
    buffer_load_dwordx4 v[144:147], v2, s[20:23], s65 offen offset:0 sc1
    s_waitcnt vmcnt(9)
    v_mfma_f32_16x16x32_bf16 a[48:51], v[132:135], a[120:123], a[48:51]
    v_mov_b32_dpp v78, v78 row_shr:1 row_mask:0xf bank_mask:0xf
    v_mov_b32_dpp v79, v79 row_shr:1 row_mask:0xf bank_mask:0xf
    v_mfma_f32_16x16x32_bf16 a[80:83], v[132:135], a[124:127], a[80:83]
    v_cndmask_b32_dpp v76, v116, v76, vcc row_shl:5 row_mask:0xf bank_mask:0xf
    v_cndmask_b32_dpp v77, v117, v77, vcc row_shl:5 row_mask:0xf bank_mask:0xf
    v_mfma_f32_16x16x32_bf16 a[76:79], v[132:135], a[112:115], a[76:79]
    v_cndmask_b32_dpp v78, v118, v78, vcc row_shl:5 row_mask:0xf bank_mask:0xf
    v_cndmask_b32_dpp v79, v119, v79, vcc row_shl:5 row_mask:0xf bank_mask:0xf
    v_mfma_f32_16x16x32_bf16 a[44:47], v[132:135], a[116:119], a[44:47]
    v_mov_b32_dpp v80, v80 row_shr:1 row_mask:0xf bank_mask:0xf
    v_mfma_f32_16x16x32_bf16 a[44:47], v[128:131], a[112:115], a[44:47]
    buffer_load_dwordx4 v[148:151], v247, s[12:15], s66 offen offset:3072 sc1
    v_mfma_f32_16x16x32_bf16 a[12:15], v[128:131], a[116:119], a[12:15]
    v_mov_b32_dpp v81, v81 row_shr:1 row_mask:0xf bank_mask:0xf
    v_mfma_f32_16x16x32_bf16 a[8:11], v[128:131], a[108:111], a[8:11]
    v_mov_b32_dpp v82, v82 row_shr:1 row_mask:0xf bank_mask:0xf
    v_mfma_f32_16x16x32_bf16 a[40:43], v[128:131], a[104:107], a[40:43]
    v_mov_b32_dpp v83, v83 row_shr:1 row_mask:0xf bank_mask:0xf
    v_mfma_f32_16x16x32_bf16 a[40:43], v[132:135], a[108:111], a[40:43]
    v_cndmask_b32_dpp v80, v116, v80, vcc row_shl:4 row_mask:0xf bank_mask:0xf
    v_mfma_f32_16x16x32_bf16 a[72:75], v[132:135], a[104:107], a[72:75]
    buffer_load_dwordx4 a[152:155], v1, s[16:19], s64 offen offset:2048 sc1
    v_mfma_f32_16x16x32_bf16 a[68:71], v[132:135], a[100:103], 0
    v_cndmask_b32_dpp v81, v117, v81, vcc row_shl:4 row_mask:0xf bank_mask:0xf
    v_mfma_f32_16x16x32_bf16 a[36:39], v[132:135], a[96:99], 0
    v_cndmask_b32_dpp v82, v118, v82, vcc row_shl:4 row_mask:0xf bank_mask:0xf
    v_mfma_f32_16x16x32_bf16 a[36:39], v[128:131], a[100:103], a[36:39]
    v_cndmask_b32_dpp v83, v119, v83, vcc row_shl:4 row_mask:0xf bank_mask:0xf
    v_mfma_f32_16x16x32_bf16 a[4:7], v[128:131], a[96:99], 0
    s_waitcnt vmcnt(10)
    v_mfma_f32_16x16x32_bf16 a[12:15], v[136:139], a[120:123], a[12:15]
    buffer_load_dwordx4 v[152:155], v247, s[12:15], s66 offen offset:2048 sc1
    v_mfma_f32_16x16x32_bf16 a[44:47], v[136:139], a[124:127], a[44:47]
    s_waitcnt vmcnt(10)
    v_mfma_f32_16x16x32_bf16 a[44:47], v[140:143], a[120:123], a[44:47]
    v_mov_b32_dpp v84, v84 row_shr:1 row_mask:0xf bank_mask:0xf
    v_mfma_f32_16x16x32_bf16 a[76:79], v[140:143], a[124:127], a[76:79]
    v_mov_b32_dpp v85, v85 row_shr:1 row_mask:0xf bank_mask:0xf
    v_mfma_f32_16x16x32_bf16 a[72:75], v[140:143], a[112:115], a[72:75]
    v_mov_b32_dpp v86, v86 row_shr:1 row_mask:0xf bank_mask:0xf
    v_mfma_f32_16x16x32_bf16 a[40:43], v[140:143], a[116:119], a[40:43]
    buffer_load_dwordx4 a[156:159], v1, s[16:19], s64 offen offset:3072 sc1
    v_mfma_f32_16x16x32_bf16 a[40:43], v[136:139], a[112:115], a[40:43]
    v_mov_b32_dpp v87, v87 row_shr:1 row_mask:0xf bank_mask:0xf
    v_mfma_f32_16x16x32_bf16 a[8:11], v[136:139], a[116:119], a[8:11]
    v_cndmask_b32_dpp v84, v112, v84, vcc row_shl:4 row_mask:0xf bank_mask:0xf
    v_mfma_f32_16x16x32_bf16 a[4:7], v[136:139], a[108:111], a[4:7]
    v_cndmask_b32_dpp v85, v113, v85, vcc row_shl:4 row_mask:0xf bank_mask:0xf
    v_mfma_f32_16x16x32_bf16 a[36:39], v[136:139], a[104:107], a[36:39]
    v_cndmask_b32_dpp v86, v114, v86, vcc row_shl:4 row_mask:0xf bank_mask:0xf
    v_mfma_f32_16x16x32_bf16 a[36:39], v[140:143], a[108:111], a[36:39]
    buffer_load_dwordx4 v[156:159], v247, s[12:15], s66 offen offset:1024 sc1
    v_mfma_f32_16x16x32_bf16 a[68:71], v[140:143], a[104:107], a[68:71]
    v_cndmask_b32_dpp v87, v115, v87, vcc row_shl:4 row_mask:0xf bank_mask:0xf
    v_mfma_f32_16x16x32_bf16 a[64:67], v[140:143], a[100:103], 0
    v_mov_b32_dpp v88, v88 row_shr:1 row_mask:0xf bank_mask:0xf
    v_mfma_f32_16x16x32_bf16 a[32:35], v[140:143], a[96:99], 0
    v_mov_b32_dpp v89, v89 row_shr:1 row_mask:0xf bank_mask:0xf
    v_mfma_f32_16x16x32_bf16 a[32:35], v[136:139], a[100:103], a[32:35]
    v_mov_b32_dpp v90, v90 row_shr:1 row_mask:0xf bank_mask:0xf
    v_mfma_f32_16x16x32_bf16 a[0:3], v[136:139], a[96:99], 0
    buffer_load_dwordx4 a[160:163], v1, s[16:19], s65 offen offset:0 sc1
    v_mfma_f32_16x16x32_bf16 a[8:11], v[72:75], a[120:123], a[8:11]
    v_mov_b32_dpp v91, v91 row_shr:1 row_mask:0xf bank_mask:0xf
    v_mfma_f32_16x16x32_bf16 a[40:43], v[72:75], a[124:127], a[40:43]
    v_cndmask_b32_dpp v88, v116, v88, vcc row_shl:3 row_mask:0xf bank_mask:0xf
    v_mfma_f32_16x16x32_bf16 a[40:43], v[76:79], a[120:123], a[40:43]
    v_cndmask_b32_dpp v89, v117, v89, vcc row_shl:3 row_mask:0xf bank_mask:0xf
    v_mfma_f32_16x16x32_bf16 a[72:75], v[76:79], a[124:127], a[72:75]
    v_cndmask_b32_dpp v90, v118, v90, vcc row_shl:3 row_mask:0xf bank_mask:0xf
    v_mfma_f32_16x16x32_bf16 a[68:71], v[76:79], a[112:115], a[68:71]
    buffer_load_dwordx4 v[160:163], v247, s[12:15], s66 offen offset:0 sc1
    v_mfma_f32_16x16x32_bf16 a[36:39], v[76:79], a[116:119], a[36:39]
    v_cndmask_b32_dpp v91, v119, v91, vcc row_shl:3 row_mask:0xf bank_mask:0xf
    ds_read_b128 v[40:43], v16 offset:128
    v_mfma_f32_16x16x32_bf16 a[36:39], v[72:75], a[112:115], a[36:39]
    v_mov_b32_dpp v92, v92 row_shr:1 row_mask:0xf bank_mask:0xf
    v_mfma_f32_16x16x32_bf16 a[4:7], v[72:75], a[116:119], a[4:7]
    v_mov_b32_dpp v93, v93 row_shr:1 row_mask:0xf bank_mask:0xf
    v_mfma_f32_16x16x32_bf16 a[0:3], v[72:75], a[108:111], a[0:3]
    v_mov_b32_dpp v94, v94 row_shr:1 row_mask:0xf bank_mask:0xf
    v_mfma_f32_16x16x32_bf16 a[32:35], v[72:75], a[104:107], a[32:35]
    buffer_load_dwordx4 a[164:167], v1, s[16:19], s65 offen offset:1024 sc1
    ds_read_b128 v[44:47], v17 offset:896
    v_mfma_f32_16x16x32_bf16 a[32:35], v[76:79], a[108:111], a[32:35]
    v_mov_b32_dpp v95, v95 row_shr:1 row_mask:0xf bank_mask:0xf
    v_mfma_f32_16x16x32_bf16 a[64:67], v[76:79], a[104:107], a[64:67]
    v_cndmask_b32_dpp v92, v112, v92, vcc row_shl:3 row_mask:0xf bank_mask:0xf
    v_mfma_f32_16x16x32_bf16 a[68:71], v[80:83], a[124:127], a[68:71]
    v_cndmask_b32_dpp v93, v113, v93, vcc row_shl:3 row_mask:0xf bank_mask:0xf
    v_mfma_f32_16x16x32_bf16 a[36:39], v[80:83], a[120:123], a[36:39]
    v_cndmask_b32_dpp v94, v114, v94, vcc row_shl:3 row_mask:0xf bank_mask:0xf
    ds_read_b128 v[48:51], v18 offset:1664
    v_mfma_f32_16x16x32_bf16 a[36:39], v[84:87], a[124:127], a[36:39]
    buffer_load_dwordx4 v[164:167], v247, s[12:15], s65 offen offset:3072 sc1
    v_mfma_f32_16x16x32_bf16 a[4:7], v[84:87], a[120:123], a[4:7]
    v_cndmask_b32_dpp v95, v115, v95, vcc row_shl:3 row_mask:0xf bank_mask:0xf
    s_add_u32 s33, s88, 65536
    s_waitcnt lgkmcnt(2)
    buffer_store_dwordx4 v[40:43], v11, s[84:87], s33 offen sc1
    v_mfma_f32_16x16x32_bf16 a[0:3], v[84:87], a[116:119], a[0:3]
    v_mov_b32_dpp v96, v96 row_shr:1 row_mask:0xf bank_mask:0xf
    v_mfma_f32_16x16x32_bf16 a[32:35], v[84:87], a[112:115], a[32:35]
    v_mov_b32_dpp v97, v97 row_shr:1 row_mask:0xf bank_mask:0xf
    ds_read_b128 v[52:55], v19 offset:2432
    v_mfma_f32_16x16x32_bf16 a[32:35], v[80:83], a[116:119], a[32:35]
    v_mov_b32_dpp v98, v98 row_shr:1 row_mask:0xf bank_mask:0xf
    v_mfma_f32_16x16x32_bf16 a[64:67], v[80:83], a[112:115], a[64:67]
    buffer_load_dwordx4 a[168:171], v1, s[16:19], s65 offen offset:2048 sc1
    s_add_u32 s33, s88, 163840
    s_waitcnt lgkmcnt(2)
    buffer_store_dwordx4 v[44:47], v11, s[84:87], s33 offen sc1
    v_mfma_f32_16x16x32_bf16 a[64:67], v[88:91], a[124:127], a[64:67]
    v_mov_b32_dpp v99, v99 row_shr:1 row_mask:0xf bank_mask:0xf
    v_mfma_f32_16x16x32_bf16 a[32:35], v[88:91], a[120:123], a[32:35]
    v_cndmask_b32_dpp v96, v112, v96, vcc row_shl:2 row_mask:0xf bank_mask:0xf
    ds_read_b128 v[40:43], v16 offset:12480
    v_mfma_f32_16x16x32_bf16 a[32:35], v[92:95], a[124:127], a[32:35]
    v_cndmask_b32_dpp v97, v113, v97, vcc row_shl:2 row_mask:0xf bank_mask:0xf
    v_mfma_f32_16x16x32_bf16 a[0:3], v[92:95], a[120:123], a[0:3]
    s_add_u32 s33, s88, 262144
    s_waitcnt lgkmcnt(2)
    buffer_store_dwordx4 v[48:51], v11, s[84:87], s33 offen sc1
    s_waitcnt vmcnt(19)
    v_mfma_f32_16x16x32_bf16 a[28:31], v[104:107], a[128:131], a[28:31]
    buffer_load_dwordx4 v[168:171], v247, s[12:15], s65 offen offset:2048 sc1
    s_waitcnt vmcnt(19)
    v_mfma_f32_16x16x32_bf16 a[28:31], v[120:123], a[132:135], a[28:31]
    ds_read_b128 v[44:47], v17 offset:13248
    s_waitcnt vmcnt(18)
    v_mfma_f32_16x16x32_bf16 a[28:31], v[128:131], a[136:139], a[28:31]
    s_waitcnt vmcnt(17)
    v_mfma_f32_16x16x32_bf16 a[60:63], v[128:131], a[140:143], a[60:63]
    s_add_u32 s33, s88, 360448
    s_waitcnt lgkmcnt(2)
    buffer_store_dwordx4 v[52:55], v11, s[84:87], s33 offen sc1
    s_waitcnt vmcnt(17)
    v_mfma_f32_16x16x32_bf16 a[60:63], v[120:123], a[144:147], a[60:63]
    s_waitcnt vmcnt(16)
    v_mfma_f32_16x16x32_bf16 a[60:63], v[104:107], a[148:151], a[60:63]
    buffer_load_dwordx4 a[172:175], v1, s[16:19], s65 offen offset:3072 sc1
    ds_read_b128 v[48:51], v18 offset:14016
    v_mfma_f32_16x16x32_bf16 a[60:63], v[108:111], a[128:131], a[60:63]
    v_cndmask_b32_dpp v98, v114, v98, vcc row_shl:2 row_mask:0xf bank_mask:0xf
    v_mfma_f32_16x16x32_bf16 a[60:63], v[124:127], a[132:135], a[60:63]
    v_cndmask_b32_dpp v99, v115, v99, vcc row_shl:2 row_mask:0xf bank_mask:0xf
    s_add_u32 s33, s89, 65536
    s_waitcnt lgkmcnt(2)
    buffer_store_dwordx4 v[40:43], v11, s[84:87], s33 offen sc1
    v_mfma_f32_16x16x32_bf16 a[60:63], v[132:135], a[136:139], a[60:63]
    v_mov_b32_dpp v100, v100 row_shr:1 row_mask:0xf bank_mask:0xf
    v_mfma_f32_16x16x32_bf16 a[92:95], v[132:135], a[140:143], a[92:95]
    v_mov_b32_dpp v101, v101 row_shr:1 row_mask:0xf bank_mask:0xf
    ds_read_b128 v[52:55], v19 offset:14784
    v_mfma_f32_16x16x32_bf16 a[92:95], v[124:127], a[144:147], a[92:95]
    buffer_load_dwordx4 v[172:175], v247, s[12:15], s65 offen offset:1024 sc1
    v_mfma_f32_16x16x32_bf16 a[92:95], v[108:111], a[148:151], a[92:95]
    v_mov_b32_dpp v102, v102 row_shr:1 row_mask:0xf bank_mask:0xf
    s_add_u32 s33, s89, 163840
    s_waitcnt lgkmcnt(2)
    buffer_store_dwordx4 v[44:47], v11, s[84:87], s33 offen sc1
    v_mfma_f32_16x16x32_bf16 a[24:27], v[120:123], a[128:131], a[24:27]
    v_mov_b32_dpp v103, v103 row_shr:1 row_mask:0xf bank_mask:0xf
    v_mfma_f32_16x16x32_bf16 a[24:27], v[128:131], a[132:135], a[24:27]
    v_cndmask_b32_dpp v100, v116, v100, vcc row_shl:2 row_mask:0xf bank_mask:0xf
    v_mfma_f32_16x16x32_bf16 a[24:27], v[136:139], a[136:139], a[24:27]
    v_cndmask_b32_dpp v101, v117, v101, vcc row_shl:2 row_mask:0xf bank_mask:0xf
    v_mfma_f32_16x16x32_bf16 a[56:59], v[136:139], a[140:143], a[56:59]
    buffer_load_dwordx4 a[176:179], v1, s[16:19], s66 offen offset:0 sc1
    s_add_u32 s33, s89, 262144
    s_waitcnt lgkmcnt(1)
    buffer_store_dwordx4 v[48:51], v11, s[84:87], s33 offen sc1
    v_mfma_f32_16x16x32_bf16 a[56:59], v[128:131], a[144:147], a[56:59]
    v_cndmask_b32_dpp v102, v118, v102, vcc row_shl:2 row_mask:0xf bank_mask:0xf
    v_mfma_f32_16x16x32_bf16 a[56:59], v[120:123], a[148:151], a[56:59]
    v_cndmask_b32_dpp v103, v119, v103, vcc row_shl:2 row_mask:0xf bank_mask:0xf
    v_mfma_f32_16x16x32_bf16 a[56:59], v[124:127], a[128:131], a[56:59]
    v_mov_b32_dpp v104, v104 row_shr:1 row_mask:0xf bank_mask:0xf
    v_mfma_f32_16x16x32_bf16 a[56:59], v[132:135], a[132:135], a[56:59]
    v_mov_b32_dpp v105, v105 row_shr:1 row_mask:0xf bank_mask:0xf
    s_add_u32 s33, s89, 360448
    s_waitcnt lgkmcnt(0)
    buffer_store_dwordx4 v[52:55], v11, s[84:87], s33 offen sc1
    v_mfma_f32_16x16x32_bf16 a[56:59], v[140:143], a[136:139], a[56:59]
    buffer_load_dwordx4 v[176:179], v247, s[12:15], s65 offen offset:0 sc1
    v_mfma_f32_16x16x32_bf16 a[88:91], v[140:143], a[140:143], a[88:91]
    v_mov_b32_dpp v106, v106 row_shr:1 row_mask:0xf bank_mask:0xf
    v_mfma_f32_16x16x32_bf16 a[88:91], v[132:135], a[144:147], a[88:91]
    v_mov_b32_dpp v107, v107 row_shr:1 row_mask:0xf bank_mask:0xf
    v_mfma_f32_16x16x32_bf16 a[88:91], v[124:127], a[148:151], a[88:91]
    v_cndmask_b32_dpp v104, v112, v104, vcc row_shl:1 row_mask:0xf bank_mask:0xf
    v_mfma_f32_16x16x32_bf16 a[20:23], v[128:131], a[128:131], a[20:23]
    v_cndmask_b32_dpp v105, v113, v105, vcc row_shl:1 row_mask:0xf bank_mask:0xf
    global_load_dword v3, v253, s[8:9] sc1
    global_load_dword v253, v255, s[8:9] offset:256 sc1
    v_mfma_f32_16x16x32_bf16 a[20:23], v[136:139], a[132:135], a[20:23]
    buffer_load_dwordx4 v[180:183], v2, s[20:23], s67 offen offset:0 sc1
    v_mfma_f32_16x16x32_bf16 a[20:23], v[72:75], a[136:139], a[20:23]
    v_cndmask_b32_dpp v106, v114, v106, vcc row_shl:1 row_mask:0xf bank_mask:0xf
    v_mfma_f32_16x16x32_bf16 a[52:55], v[72:75], a[140:143], a[52:55]
    v_cndmask_b32_dpp v107, v115, v107, vcc row_shl:1 row_mask:0xf bank_mask:0xf
    v_mfma_f32_16x16x32_bf16 a[52:55], v[136:139], a[144:147], a[52:55]
    v_mov_b32_dpp v108, v108 row_shr:1 row_mask:0xf bank_mask:0xf
    v_mfma_f32_16x16x32_bf16 a[52:55], v[128:131], a[148:151], a[52:55]
    v_mov_b32_dpp v109, v109 row_shr:1 row_mask:0xf bank_mask:0xf
    v_mfma_f32_16x16x32_bf16 a[52:55], v[132:135], a[128:131], a[52:55]
    buffer_load_dwordx4 v[184:187], v247, s[12:15], s68 offen offset:3072 sc1
    v_mfma_f32_16x16x32_bf16 a[52:55], v[140:143], a[132:135], a[52:55]
    v_mov_b32_dpp v110, v110 row_shr:1 row_mask:0xf bank_mask:0xf
    v_mfma_f32_16x16x32_bf16 a[52:55], v[76:79], a[136:139], a[52:55]
    v_mov_b32_dpp v111, v111 row_shr:1 row_mask:0xf bank_mask:0xf
    v_mfma_f32_16x16x32_bf16 a[84:87], v[76:79], a[140:143], a[84:87]
    v_cndmask_b32_dpp v108, v116, v108, vcc row_shl:1 row_mask:0xf bank_mask:0xf
    v_mfma_f32_16x16x32_bf16 a[84:87], v[140:143], a[144:147], a[84:87]
    v_cndmask_b32_dpp v109, v117, v109, vcc row_shl:1 row_mask:0xf bank_mask:0xf
    v_mfma_f32_16x16x32_bf16 a[84:87], v[132:135], a[148:151], a[84:87]
    buffer_load_dwordx4 a[180:183], v1, s[16:19], s66 offen offset:1024 sc1
    v_mfma_f32_16x16x32_bf16 a[16:19], v[136:139], a[128:131], a[16:19]
    v_cndmask_b32_dpp v110, v118, v110, vcc row_shl:1 row_mask:0xf bank_mask:0xf
    v_mfma_f32_16x16x32_bf16 a[16:19], v[72:75], a[132:135], a[16:19]
    v_cndmask_b32_dpp v111, v119, v111, vcc row_shl:1 row_mask:0xf bank_mask:0xf
    v_mfma_f32_16x16x32_bf16 a[16:19], v[84:87], a[136:139], a[16:19]
    v_mov_b32_dpp v120, v120 row_shr:1 row_mask:0xf bank_mask:0xf
    v_mfma_f32_16x16x32_bf16 a[48:51], v[84:87], a[140:143], a[48:51]
    v_mov_b32_dpp v121, v121 row_shr:1 row_mask:0xf bank_mask:0xf
    v_mfma_f32_16x16x32_bf16 a[48:51], v[72:75], a[144:147], a[48:51]
    buffer_load_dwordx4 v[188:191], v247, s[12:15], s68 offen offset:2048 sc1
    v_mfma_f32_16x16x32_bf16 a[48:51], v[136:139], a[148:151], a[48:51]
    v_mov_b32_dpp v122, v122 row_shr:1 row_mask:0xf bank_mask:0xf
    v_mfma_f32_16x16x32_bf16 a[48:51], v[140:143], a[128:131], a[48:51]
    v_mov_b32_dpp v123, v123 row_shr:1 row_mask:0xf bank_mask:0xf
    v_mfma_f32_16x16x32_bf16 a[48:51], v[76:79], a[132:135], a[48:51]
    v_cndmask_b32 v120, v112, v120, vcc
    v_mfma_f32_16x16x32_bf16 a[48:51], v[80:83], a[136:139], a[48:51]
    v_cndmask_b32 v121, v113, v121, vcc
    v_mfma_f32_16x16x32_bf16 a[80:83], v[80:83], a[140:143], a[80:83]
    buffer_load_dwordx4 a[184:187], v1, s[16:19], s66 offen offset:2048 sc1
    v_mfma_f32_16x16x32_bf16 a[80:83], v[76:79], a[144:147], a[80:83]
    v_cndmask_b32 v122, v114, v122, vcc
    v_mfma_f32_16x16x32_bf16 a[80:83], v[140:143], a[148:151], a[80:83]
    v_cndmask_b32 v123, v115, v123, vcc
    v_mfma_f32_16x16x32_bf16 a[12:15], v[72:75], a[128:131], a[12:15]
    v_mov_b32_dpp v124, v124 row_shr:1 row_mask:0xf bank_mask:0xf
    v_mfma_f32_16x16x32_bf16 a[12:15], v[84:87], a[132:135], a[12:15]
    v_mov_b32_dpp v125, v125 row_shr:1 row_mask:0xf bank_mask:0xf
    v_mfma_f32_16x16x32_bf16 a[12:15], v[92:95], a[136:139], a[12:15]
    buffer_load_dwordx4 v[192:195], v247, s[12:15], s68 offen offset:1024 sc1
    v_mfma_f32_16x16x32_bf16 a[44:47], v[92:95], a[140:143], a[44:47]
    v_mov_b32_dpp v126, v126 row_shr:1 row_mask:0xf bank_mask:0xf
    v_mfma_f32_16x16x32_bf16 a[44:47], v[84:87], a[144:147], a[44:47]
    v_mov_b32_dpp v127, v127 row_shr:1 row_mask:0xf bank_mask:0xf
    v_mfma_f32_16x16x32_bf16 a[44:47], v[72:75], a[148:151], a[44:47]
    v_cndmask_b32 v124, v116, v124, vcc
    v_mfma_f32_16x16x32_bf16 a[44:47], v[76:79], a[128:131], a[44:47]
    v_cndmask_b32 v125, v117, v125, vcc
    v_mfma_f32_16x16x32_bf16 a[44:47], v[80:83], a[132:135], a[44:47]
    buffer_load_dwordx4 a[188:191], v1, s[16:19], s66 offen offset:3072 sc1
    v_mfma_f32_16x16x32_bf16 a[44:47], v[88:91], a[136:139], a[44:47]
    v_cndmask_b32 v126, v118, v126, vcc
    v_mfma_f32_16x16x32_bf16 a[76:79], v[88:91], a[140:143], a[76:79]
    v_cndmask_b32 v127, v119, v127, vcc
    v_mfma_f32_16x16x32_bf16 a[76:79], v[80:83], a[144:147], a[76:79]
    v_mfma_f32_16x16x32_bf16 a[76:79], v[76:79], a[148:151], a[76:79]
    v_mfma_f32_16x16x32_bf16 a[8:11], v[84:87], a[128:131], a[8:11]
    buffer_load_dwordx4 v[196:199], v247, s[12:15], s68 offen offset:0 sc1
    v_mfma_f32_16x16x32_bf16 a[8:11], v[92:95], a[132:135], a[8:11]
    v_mfma_f32_16x16x32_bf16 a[8:11], v[96:99], a[136:139], a[8:11]
    v_mfma_f32_16x16x32_bf16 a[40:43], v[96:99], a[140:143], a[40:43]
    v_mfma_f32_16x16x32_bf16 a[40:43], v[92:95], a[144:147], a[40:43]
    v_mfma_f32_16x16x32_bf16 a[40:43], v[84:87], a[148:151], a[40:43]
    buffer_load_dwordx4 a[192:195], v1, s[16:19], s67 offen offset:0 sc1
    v_mfma_f32_16x16x32_bf16 a[40:43], v[80:83], a[128:131], a[40:43]
    v_mfma_f32_16x16x32_bf16 a[40:43], v[88:91], a[132:135], a[40:43]
    v_mfma_f32_16x16x32_bf16 a[40:43], v[100:103], a[136:139], a[40:43]
    v_mfma_f32_16x16x32_bf16 a[72:75], v[100:103], a[140:143], a[72:75]
    v_mfma_f32_16x16x32_bf16 a[72:75], v[88:91], a[144:147], a[72:75]
    buffer_load_dwordx4 v[200:203], v247, s[12:15], s67 offen offset:3072 sc1
    v_mfma_f32_16x16x32_bf16 a[72:75], v[80:83], a[148:151], a[72:75]
    v_mfma_f32_16x16x32_bf16 a[4:7], v[92:95], a[128:131], a[4:7]
    v_mfma_f32_16x16x32_bf16 a[4:7], v[96:99], a[132:135], a[4:7]
    v_mfma_f32_16x16x32_bf16 a[4:7], v[104:107], a[136:139], a[4:7]
    v_mfma_f32_16x16x32_bf16 a[36:39], v[104:107], a[140:143], a[36:39]
    buffer_load_dwordx4 a[196:199], v1, s[16:19], s67 offen offset:1024 sc1
    v_mfma_f32_16x16x32_bf16 a[36:39], v[96:99], a[144:147], a[36:39]
    v_mfma_f32_16x16x32_bf16 a[36:39], v[92:95], a[148:151], a[36:39]
    v_mfma_f32_16x16x32_bf16 a[36:39], v[88:91], a[128:131], a[36:39]
    v_mfma_f32_16x16x32_bf16 a[36:39], v[100:103], a[132:135], a[36:39]
    v_mfma_f32_16x16x32_bf16 a[36:39], v[108:111], a[136:139], a[36:39]
    buffer_load_dwordx4 v[204:207], v247, s[12:15], s67 offen offset:2048 sc1
    v_mfma_f32_16x16x32_bf16 a[68:71], v[108:111], a[140:143], a[68:71]
    v_mfma_f32_16x16x32_bf16 a[68:71], v[100:103], a[144:147], a[68:71]
    v_mfma_f32_16x16x32_bf16 a[68:71], v[88:91], a[148:151], a[68:71]
    v_mfma_f32_16x16x32_bf16 a[0:3], v[96:99], a[128:131], a[0:3]
    v_mfma_f32_16x16x32_bf16 a[0:3], v[104:107], a[132:135], a[0:3]
    buffer_load_dwordx4 a[200:203], v1, s[16:19], s67 offen offset:2048 sc1
    v_mfma_f32_16x16x32_bf16 a[0:3], v[120:123], a[136:139], a[0:3]
    v_mfma_f32_16x16x32_bf16 a[32:35], v[120:123], a[140:143], a[32:35]
    v_mfma_f32_16x16x32_bf16 a[32:35], v[104:107], a[144:147], a[32:35]
    v_mfma_f32_16x16x32_bf16 a[32:35], v[96:99], a[148:151], a[32:35]
    v_mfma_f32_16x16x32_bf16 a[32:35], v[100:103], a[128:131], a[32:35]
    buffer_load_dwordx4 v[208:211], v247, s[12:15], s67 offen offset:1024 sc1
    v_mfma_f32_16x16x32_bf16 a[32:35], v[108:111], a[132:135], a[32:35]
    v_mfma_f32_16x16x32_bf16 a[32:35], v[124:127], a[136:139], a[32:35]
    v_mfma_f32_16x16x32_bf16 a[64:67], v[124:127], a[140:143], a[64:67]
    v_mfma_f32_16x16x32_bf16 a[64:67], v[108:111], a[144:147], a[64:67]
    v_mfma_f32_16x16x32_bf16 a[64:67], v[100:103], a[148:151], a[64:67]
    buffer_load_dwordx4 a[204:207], v1, s[16:19], s67 offen offset:3072 sc1
    s_waitcnt vmcnt(31)
    v_mfma_f32_16x16x32_bf16 v[36:39], v[148:151], a[152:155], 0
    v_mov_b32_dpp v148, v148 row_shr:1 row_mask:0xf bank_mask:0xf
    v_mov_b32_dpp v149, v149 row_shr:1 row_mask:0xf bank_mask:0xf
    v_mfma_f32_16x16x32_bf16 v[36:39], v[152:155], a[156:159], v[36:39]
    v_mov_b32_dpp v150, v150 row_shr:1 row_mask:0xf bank_mask:0xf
    v_mov_b32_dpp v151, v151 row_shr:1 row_mask:0xf bank_mask:0xf
    v_mfma_f32_16x16x32_bf16 v[36:39], v[156:159], a[160:163], v[36:39]
    v_cndmask_b32_dpp v148, v144, v148, vcc row_shl:5 row_mask:0xf bank_mask:0xf
    v_cndmask_b32_dpp v149, v145, v149, vcc row_shl:5 row_mask:0xf bank_mask:0xf
    v_mfma_f32_16x16x32_bf16 v[36:39], v[160:163], a[164:167], v[36:39]
    v_cndmask_b32_dpp v150, v146, v150, vcc row_shl:5 row_mask:0xf bank_mask:0xf
    v_cndmask_b32_dpp v151, v147, v151, vcc row_shl:5 row_mask:0xf bank_mask:0xf
    s_waitcnt vmcnt(18)
    s_cmp_eq_u32 s78, 0
    s_cbranch_scc1 FU_nosig1_78
    s_add_u32 s33, s78, 20480
    v_mov_b32 v12, s33
    v_mov_b32 v13, s82
    s_mov_b64 exec, 1
    global_atomic_swap v12, v13, s[8:9] sc1
    s_mov_b64 exec, -1
FU_nosig1_78:
    s_cmp_eq_u32 s79, 0
    s_cbranch_scc1 FU_nosig1_79
    s_add_u32 s33, s79, 20480
    v_mov_b32 v12, s33
    v_mov_b32 v13, s82
    s_mov_b64 exec, 1
    global_atomic_swap v12, v13, s[8:9] sc1
    s_mov_b64 exec, -1
FU_nosig1_79:
    v_mfma_f32_16x16x32_bf16 v[36:39], v[164:167], a[168:171], v[36:39]
    buffer_load_dwordx4 v[212:215], v247, s[12:15], s67 offen offset:0 sc1
    v_mfma_f32_16x16x32_bf16 v[36:39], v[168:171], a[172:175], v[36:39]
    v_mfma_f32_16x16x32_bf16 v[36:39], v[172:175], a[176:179], v[36:39]
    v_mfma_f32_16x16x32_bf16 v[32:35], v[152:155], a[152:155], 0
    v_mov_b32_dpp v152, v152 row_shr:1 row_mask:0xf bank_mask:0xf
    v_mov_b32_dpp v153, v153 row_shr:1 row_mask:0xf bank_mask:0xf
    v_mfma_f32_16x16x32_bf16 v[32:35], v[156:159], a[156:159], v[32:35]
    s_waitcnt vmcnt(16)
    v_cmp_ne_u32 s[72:73], s82, v3
    v_cmp_ne_u32 s[74:75], s82, v253
    s_nop 4
    s_or_b64 s[72:73], s[72:73], s[74:75]
    s_cmp_lg_u64 s[72:73], 0
    s_cbranch_scc1 FU_poll1_again
FU_poll1_ok:
    s_barrier
    v_mov_b32_dpp v154, v154 row_shr:1 row_mask:0xf bank_mask:0xf
    v_mov_b32_dpp v155, v155 row_shr:1 row_mask:0xf bank_mask:0xf
    v_mfma_f32_16x16x32_bf16 v[32:35], v[160:163], a[160:163], v[32:35]
    buffer_load_dwordx4 v[216:219], v2, s[56:59], 0 offen offset:0 sc1
    v_cndmask_b32_dpp v152, v144, v152, vcc row_shl:4 row_mask:0xf bank_mask:0xf
    v_mfma_f32_16x16x32_bf16 v[32:35], v[164:167], a[164:167], v[32:35]
    v_cndmask_b32_dpp v153, v145, v153, vcc row_shl:4 row_mask:0xf bank_mask:0xf
    v_cndmask_b32_dpp v154, v146, v154, vcc row_shl:4 row_mask:0xf bank_mask:0xf
    v_mfma_f32_16x16x32_bf16 v[32:35], v[168:171], a[168:171], v[32:35]
    v_cndmask_b32_dpp v155, v147, v155, vcc row_shl:4 row_mask:0xf bank_mask:0xf
    v_mfma_f32_16x16x32_bf16 v[32:35], v[172:175], a[172:175], v[32:35]
    v_mfma_f32_16x16x32_bf16 v[32:35], v[176:179], a[176:179], v[32:35]
    v_mfma_f32_16x16x32_bf16 v[28:31], v[156:159], a[152:155], 0
    buffer_load_dwordx4 v[220:223], v2, s[56:59], s26 offen offset:0 sc1
    v_mov_b32_dpp v156, v156 row_shr:1 row_mask:0xf bank_mask:0xf
    v_mfma_f32_16x16x32_bf16 v[28:31], v[160:163], a[156:159], v[28:31]
    v_mov_b32_dpp v157, v157 row_shr:1 row_mask:0xf bank_mask:0xf
    v_mov_b32_dpp v158, v158 row_shr:1 row_mask:0xf bank_mask:0xf
    v_mfma_f32_16x16x32_bf16 v[28:31], v[164:167], a[160:163], v[28:31]
    v_mov_b32_dpp v159, v159 row_shr:1 row_mask:0xf bank_mask:0xf
    v_cndmask_b32_dpp v156, v144, v156, vcc row_shl:3 row_mask:0xf bank_mask:0xf
    v_mfma_f32_16x16x32_bf16 v[28:31], v[168:171], a[164:167], v[28:31]
    v_cndmask_b32_dpp v157, v145, v157, vcc row_shl:3 row_mask:0xf bank_mask:0xf
    v_cndmask_b32_dpp v158, v146, v158, vcc row_shl:3 row_mask:0xf bank_mask:0xf
    v_mfma_f32_16x16x32_bf16 v[28:31], v[172:175], a[168:171], v[28:31]
    v_cndmask_b32_dpp v159, v147, v159, vcc row_shl:3 row_mask:0xf bank_mask:0xf
    v_mfma_f32_16x16x32_bf16 v[28:31], v[176:179], a[172:175], v[28:31]
    buffer_load_dwordx4 v[224:227], v247, s[40:43], s25 offen offset:3072 sc1
    v_mfma_f32_16x16x32_bf16 v[28:31], v[148:151], a[176:179], v[28:31]
    v_mfma_f32_16x16x32_bf16 v[24:27], v[160:163], a[152:155], 0
    v_mov_b32_dpp v160, v160 row_shr:1 row_mask:0xf bank_mask:0xf
    v_mov_b32_dpp v161, v161 row_shr:1 row_mask:0xf bank_mask:0xf
    v_mfma_f32_16x16x32_bf16 v[24:27], v[164:167], a[156:159], v[24:27]
    v_mov_b32_dpp v162, v162 row_shr:1 row_mask:0xf bank_mask:0xf
    v_mfma_f32_16x16x32_bf16 v[24:27], v[168:171], a[160:163], v[24:27]
    v_mov_b32_dpp v163, v163 row_shr:1 row_mask:0xf bank_mask:0xf
    v_mfma_f32_16x16x32_bf16 v[24:27], v[172:175], a[164:167], v[24:27]
    buffer_load_dwordx4 a[208:211], v1, s[48:51], 0 offen offset:0 sc1
    v_mfma_f32_16x16x32_bf16 v[24:27], v[176:179], a[168:171], v[24:27]
    v_cndmask_b32_dpp v160, v144, v160, vcc row_shl:2 row_mask:0xf bank_mask:0xf
    v_mfma_f32_16x16x32_bf16 v[24:27], v[148:151], a[172:175], v[24:27]
    v_cndmask_b32_dpp v161, v145, v161, vcc row_shl:2 row_mask:0xf bank_mask:0xf
    v_mfma_f32_16x16x32_bf16 v[24:27], v[152:155], a[176:179], v[24:27]
    v_cndmask_b32_dpp v162, v146, v162, vcc row_shl:2 row_mask:0xf bank_mask:0xf
    v_mfma_f32_16x16x32_bf16 v[20:23], v[164:167], a[152:155], 0
    v_cndmask_b32_dpp v163, v147, v163, vcc row_shl:2 row_mask:0xf bank_mask:0xf
    v_mfma_f32_16x16x32_bf16 v[20:23], v[168:171], a[156:159], v[20:23]
    buffer_load_dwordx4 v[228:231], v247, s[40:43], s25 offen offset:2048 sc1
    v_mfma_f32_16x16x32_bf16 v[20:23], v[172:175], a[160:163], v[20:23]
    v_mov_b32_dpp v164, v164 row_shr:1 row_mask:0xf bank_mask:0xf
    v_mov_b32_dpp v165, v165 row_shr:1 row_mask:0xf bank_mask:0xf
    v_mfma_f32_16x16x32_bf16 v[20:23], v[176:179], a[164:167], v[20:23]
    v_mov_b32_dpp v166, v166 row_shr:1 row_mask:0xf bank_mask:0xf
    v_mov_b32_dpp v167, v167 row_shr:1 row_mask:0xf bank_mask:0xf
    v_mfma_f32_16x16x32_bf16 v[20:23], v[148:151], a[168:171], v[20:23]
    v_cndmask_b32_dpp v164, v144, v164, vcc row_shl:1 row_mask:0xf bank_mask:0xf
    v_cndmask_b32_dpp v165, v145, v165, vcc row_shl:1 row_mask:0xf bank_mask:0xf
    v_mfma_f32_16x16x32_bf16 v[20:23], v[152:155], a[172:175], v[20:23]
    v_cndmask_b32_dpp v166, v146, v166, vcc row_shl:1 row_mask:0xf bank_mask:0xf
    v_cndmask_b32_dpp v167, v147, v167, vcc row_shl:1 row_mask:0xf bank_mask:0xf
    v_mfma_f32_16x16x32_bf16 v[20:23], v[156:159], a[176:179], v[20:23]
    buffer_load_dwordx4 a[212:215], v1, s[48:51], 0 offen offset:1024 sc1
    v_mfma_f32_16x16x32_bf16 v[16:19], v[168:171], a[152:155], 0
    v_mov_b32_dpp v168, v168 row_shr:1 row_mask:0xf bank_mask:0xf
    v_mfma_f32_16x16x32_bf16 v[16:19], v[172:175], a[156:159], v[16:19]
    v_mov_b32_dpp v169, v169 row_shr:1 row_mask:0xf bank_mask:0xf
    v_mfma_f32_16x16x32_bf16 v[16:19], v[176:179], a[160:163], v[16:19]
    v_mov_b32_dpp v170, v170 row_shr:1 row_mask:0xf bank_mask:0xf
    v_mov_b32_dpp v171, v171 row_shr:1 row_mask:0xf bank_mask:0xf
    v_mfma_f32_16x16x32_bf16 v[16:19], v[148:151], a[164:167], v[16:19]
    v_cndmask_b32 v168, v144, v168, vcc
    v_cndmask_b32 v169, v145, v169, vcc
    v_mfma_f32_16x16x32_bf16 v[16:19], v[152:155], a[168:171], v[16:19]
    buffer_load_dwordx4 v[232:235], v247, s[40:43], s25 offen offset:1024 sc1
    v_cndmask_b32 v170, v146, v170, vcc
    v_mfma_f32_16x16x32_bf16 v[16:19], v[156:159], a[172:175], v[16:19]
    v_cndmask_b32 v171, v147, v171, vcc
    v_mfma_f32_16x16x32_bf16 v[16:19], v[160:163], a[176:179], v[16:19]
    v_mfma_f32_16x16x32_bf16 v[12:15], v[172:175], a[152:155], 0
    v_mfma_f32_16x16x32_bf16 v[12:15], v[176:179], a[156:159], v[12:15]
    v_mfma_f32_16x16x32_bf16 v[12:15], v[148:151], a[160:163], v[12:15]
    buffer_load_dwordx4 a[216:219], v1, s[48:51], 0 offen offset:2048 sc1
    v_mfma_f32_16x16x32_bf16 v[12:15], v[152:155], a[164:167], v[12:15]
    v_mfma_f32_16x16x32_bf16 v[12:15], v[156:159], a[168:171], v[12:15]
    v_mfma_f32_16x16x32_bf16 v[12:15], v[160:163], a[172:175], v[12:15]
    v_mfma_f32_16x16x32_bf16 v[12:15], v[164:167], a[176:179], v[12:15]
    v_mfma_f32_16x16x32_bf16 v[8:11], v[176:179], a[152:155], 0
    buffer_load_dwordx4 v[236:239], v247, s[40:43], s25 offen offset:0 sc1
    v_mfma_f32_16x16x32_bf16 v[8:11], v[148:151], a[156:159], v[8:11]
    v_mfma_f32_16x16x32_bf16 v[8:11], v[152:155], a[160:163], v[8:11]
    v_mfma_f32_16x16x32_bf16 v[8:11], v[156:159], a[164:167], v[8:11]
    v_mfma_f32_16x16x32_bf16 v[8:11], v[160:163], a[168:171], v[8:11]
    v_mfma_f32_16x16x32_bf16 v[8:11], v[164:167], a[172:175], v[8:11]
    buffer_load_dwordx4 a[220:223], v1, s[48:51], 0 offen offset:3072 sc1
    v_mfma_f32_16x16x32_bf16 v[8:11], v[168:171], a[176:179], v[8:11]
    s_waitcnt vmcnt(18)
    v_mfma_f32_16x16x32_bf16 v[68:71], v[184:187], a[180:183], 0
    v_mov_b32_dpp v184, v184 row_shr:1 row_mask:0xf bank_mask:0xf
    v_mov_b32_dpp v185, v185 row_shr:1 row_mask:0xf bank_mask:0xf
    v_mfma_f32_16x16x32_bf16 v[68:71], v[188:191], a[184:187], v[68:71]
    v_mov_b32_dpp v186, v186 row_shr:1 row_mask:0xf bank_mask:0xf
    v_mov_b32_dpp v187, v187 row_shr:1 row_mask:0xf bank_mask:0xf
    v_mfma_f32_16x16x32_bf16 v[68:71], v[192:195], a[188:191], v[68:71]
    v_cndmask_b32_dpp v184, v180, v184, vcc row_shl:5 row_mask:0xf bank_mask:0xf
    s_waitcnt vmcnt(17)
    v_mfma_f32_16x16x32_bf16 v[68:71], v[196:199], a[192:195], v[68:71]
    buffer_load_dwordx4 a[224:227], v1, s[48:51], s26 offen offset:2048 sc1
    s_waitcnt vmcnt(16)
    v_mfma_f32_16x16x32_bf16 v[68:71], v[200:203], a[196:199], v[68:71]
    v_cndmask_b32_dpp v185, v181, v185, vcc row_shl:5 row_mask:0xf bank_mask:0xf
    s_waitcnt vmcnt(14)
    v_mfma_f32_16x16x32_bf16 v[68:71], v[204:207], a[200:203], v[68:71]
    v_cndmask_b32_dpp v186, v182, v186, vcc row_shl:5 row_mask:0xf bank_mask:0xf
    s_waitcnt vmcnt(12)
    v_mfma_f32_16x16x32_bf16 v[68:71], v[208:211], a[204:207], v[68:71]
    v_cndmask_b32_dpp v187, v183, v187, vcc row_shl:5 row_mask:0xf bank_mask:0xf
    v_mfma_f32_16x16x32_bf16 v[64:67], v[188:191], a[180:183], 0
    v_mov_b32_dpp v188, v188 row_shr:1 row_mask:0xf bank_mask:0xf
    v_mov_b32_dpp v189, v189 row_shr:1 row_mask:0xf bank_mask:0xf
    v_mfma_f32_16x16x32_bf16 v[64:67], v[192:195], a[184:187], v[64:67]
    buffer_load_dwordx4 a[228:231], v1, s[48:51], s26 offen offset:1024 sc1
    v_mov_b32_dpp v190, v190 row_shr:1 row_mask:0xf bank_mask:0xf
    v_mfma_f32_16x16x32_bf16 v[64:67], v[196:199], a[188:191], v[64:67]
    v_mov_b32_dpp v191, v191 row_shr:1 row_mask:0xf bank_mask:0xf
    v_cndmask_b32_dpp v188, v180, v188, vcc row_shl:4 row_mask:0xf bank_mask:0xf
    v_mfma_f32_16x16x32_bf16 v[64:67], v[200:203], a[192:195], v[64:67]
    v_cndmask_b32_dpp v189, v181, v189, vcc row_shl:4 row_mask:0xf bank_mask:0xf
    v_cndmask_b32_dpp v190, v182, v190, vcc row_shl:4 row_mask:0xf bank_mask:0xf
    v_mfma_f32_16x16x32_bf16 v[64:67], v[204:207], a[196:199], v[64:67]
    v_cndmask_b32_dpp v191, v183, v191, vcc row_shl:4 row_mask:0xf bank_mask:0xf
    v_mfma_f32_16x16x32_bf16 v[64:67], v[208:211], a[200:203], v[64:67]
    s_waitcnt vmcnt(12)
    v_mfma_f32_16x16x32_bf16 v[64:67], v[212:215], a[204:207], v[64:67]
    buffer_load_dwordx4 a[232:235], v1, s[48:51], s26 offen offset:0 sc1
    v_mfma_f32_16x16x32_bf16 v[60:63], v[192:195], a[180:183], 0
    v_mov_b32_dpp v192, v192 row_shr:1 row_mask:0xf bank_mask:0xf
    v_mov_b32_dpp v193, v193 row_shr:1 row_mask:0xf bank_mask:0xf
    v_mfma_f32_16x16x32_bf16 v[60:63], v[196:199], a[184:187], v[60:63]
    v_mov_b32_dpp v194, v194 row_shr:1 row_mask:0xf bank_mask:0xf
    v_mov_b32_dpp v195, v195 row_shr:1 row_mask:0xf bank_mask:0xf
    v_mfma_f32_16x16x32_bf16 v[60:63], v[200:203], a[188:191], v[60:63]
    v_cndmask_b32_dpp v192, v180, v192, vcc row_shl:3 row_mask:0xf bank_mask:0xf
    v_cndmask_b32_dpp v193, v181, v193, vcc row_shl:3 row_mask:0xf bank_mask:0xf
    v_mfma_f32_16x16x32_bf16 v[60:63], v[204:207], a[192:195], v[60:63]
    v_cndmask_b32_dpp v194, v182, v194, vcc row_shl:3 row_mask:0xf bank_mask:0xf
    v_cndmask_b32_dpp v195, v183, v195, vcc row_shl:3 row_mask:0xf bank_mask:0xf
    v_mfma_f32_16x16x32_bf16 v[60:63], v[208:211], a[196:199], v[60:63]
    buffer_load_dwordx4 a[236:239], v1, s[48:51], s25 offen offset:3072 sc1
    v_mfma_f32_16x16x32_bf16 v[60:63], v[212:215], a[200:203], v[60:63]
    v_mfma_f32_16x16x32_bf16 v[60:63], v[184:187], a[204:207], v[60:63]
    v_mfma_f32_16x16x32_bf16 v[56:59], v[196:199], a[180:183], 0
    v_mov_b32_dpp v196, v196 row_shr:1 row_mask:0xf bank_mask:0xf
    v_mov_b32_dpp v197, v197 row_shr:1 row_mask:0xf bank_mask:0xf
    v_mfma_f32_16x16x32_bf16 v[56:59], v[200:203], a[184:187], v[56:59]
    v_mov_b32_dpp v198, v198 row_shr:1 row_mask:0xf bank_mask:0xf
    v_mov_b32_dpp v199, v199 row_shr:1 row_mask:0xf bank_mask:0xf
    v_mfma_f32_16x16x32_bf16 v[56:59], v[204:207], a[188:191], v[56:59]
    buffer_load_dwordx4 v[240:243], v247, s[40:43], s64 offen offset:3072 sc1
    v_cndmask_b32_dpp v196, v180, v196, vcc row_shl:2 row_mask:0xf bank_mask:0xf
    v_mfma_f32_16x16x32_bf16 v[56:59], v[208:211], a[192:195], v[56:59]
    v_cndmask_b32_dpp v197, v181, v197, vcc row_shl:2 row_mask:0xf bank_mask:0xf
    v_mfma_f32_16x16x32_bf16 v[56:59], v[212:215], a[196:199], v[56:59]
    buffer_load_dwordx4 v[128:131], v247, s[40:43], s64 offen offset:2048 sc1
    v_mfma_f32_16x16x32_bf16 v[56:59], v[184:187], a[200:203], v[56:59]
    buffer_load_dwordx4 v[132:135], v247, s[40:43], s64 offen offset:1024 sc1
    v_mfma_f32_16x16x32_bf16 v[56:59], v[188:191], a[204:207], v[56:59]
    buffer_load_dwordx4 v[136:139], v247, s[40:43], s64 offen offset:0 sc1
    v_mfma_f32_16x16x32_bf16 v[52:55], v[200:203], a[180:183], 0
    v_cndmask_b32_dpp v198, v182, v198, vcc row_shl:2 row_mask:0xf bank_mask:0xf
    v_mfma_f32_16x16x32_bf16 v[52:55], v[204:207], a[184:187], v[52:55]
    v_cndmask_b32_dpp v199, v183, v199, vcc row_shl:2 row_mask:0xf bank_mask:0xf
    v_mfma_f32_16x16x32_bf16 v[52:55], v[208:211], a[188:191], v[52:55]
    v_mov_b32_dpp v200, v200 row_shr:1 row_mask:0xf bank_mask:0xf
    v_mfma_f32_16x16x32_bf16 v[52:55], v[212:215], a[192:195], v[52:55]
    v_mov_b32_dpp v201, v201 row_shr:1 row_mask:0xf bank_mask:0xf
    v_mfma_f32_16x16x32_bf16 v[52:55], v[184:187], a[196:199], v[52:55]
    buffer_load_dwordx4 v[140:143], v247, s[40:43], 0 offen offset:3072 sc1
    v_mfma_f32_16x16x32_bf16 v[52:55], v[188:191], a[200:203], v[52:55]
    v_mov_b32_dpp v202, v202 row_shr:1 row_mask:0xf bank_mask:0xf
    v_mfma_f32_16x16x32_bf16 v[52:55], v[192:195], a[204:207], v[52:55]
    v_mov_b32_dpp v203, v203 row_shr:1 row_mask:0xf bank_mask:0xf
    v_mfma_f32_16x16x32_bf16 v[48:51], v[204:207], a[180:183], 0
    v_cndmask_b32_dpp v200, v180, v200, vcc row_shl:1 row_mask:0xf bank_mask:0xf
    v_mfma_f32_16x16x32_bf16 v[48:51], v[208:211], a[184:187], v[48:51]
    v_cndmask_b32_dpp v201, v181, v201, vcc row_shl:1 row_mask:0xf bank_mask:0xf
    v_mfma_f32_16x16x32_bf16 v[48:51], v[212:215], a[188:191], v[48:51]
    buffer_load_dwordx4 v[72:75], v247, s[40:43], s26 offen offset:3072 sc1
    v_mfma_f32_16x16x32_bf16 v[48:51], v[184:187], a[192:195], v[48:51]
    v_cndmask_b32_dpp v202, v182, v202, vcc row_shl:1 row_mask:0xf bank_mask:0xf
    v_mfma_f32_16x16x32_bf16 v[48:51], v[188:191], a[196:199], v[48:51]
    v_cndmask_b32_dpp v203, v183, v203, vcc row_shl:1 row_mask:0xf bank_mask:0xf
    v_mfma_f32_16x16x32_bf16 v[48:51], v[192:195], a[200:203], v[48:51]
    v_mov_b32_dpp v204, v204 row_shr:1 row_mask:0xf bank_mask:0xf
    v_mfma_f32_16x16x32_bf16 v[48:51], v[196:199], a[204:207], v[48:51]
    v_mov_b32_dpp v205, v205 row_shr:1 row_mask:0xf bank_mask:0xf
    v_mfma_f32_16x16x32_bf16 v[44:47], v[208:211], a[180:183], 0
    buffer_load_dwordx4 v[76:79], v247, s[40:43], 0 offen offset:2048 sc1
    v_mfma_f32_16x16x32_bf16 v[44:47], v[212:215], a[184:187], v[44:47]
    v_mov_b32_dpp v206, v206 row_shr:1 row_mask:0xf bank_mask:0xf
    v_mfma_f32_16x16x32_bf16 v[44:47], v[184:187], a[188:191], v[44:47]
    v_mov_b32_dpp v207, v207 row_shr:1 row_mask:0xf bank_mask:0xf
    v_mfma_f32_16x16x32_bf16 v[44:47], v[188:191], a[192:195], v[44:47]
    v_cndmask_b32 v204, v180, v204, vcc
    v_mfma_f32_16x16x32_bf16 v[44:47], v[192:195], a[196:199], v[44:47]
    v_cndmask_b32 v205, v181, v205, vcc
    v_mfma_f32_16x16x32_bf16 v[44:47], v[196:199], a[200:203], v[44:47]
    buffer_load_dwordx4 v[84:87], v247, s[40:43], s26 offen offset:2048 sc1
    v_mfma_f32_16x16x32_bf16 v[44:47], v[200:203], a[204:207], v[44:47]
    v_cndmask_b32 v206, v182, v206, vcc
    v_mfma_f32_16x16x32_bf16 v[40:43], v[212:215], a[180:183], 0
    v_cndmask_b32 v207, v183, v207, vcc
    v_mfma_f32_16x16x32_bf16 v[40:43], v[184:187], a[184:187], v[40:43]
    v_mfma_f32_16x16x32_bf16 v[40:43], v[188:191], a[188:191], v[40:43]
    v_mfma_f32_16x16x32_bf16 v[40:43], v[192:195], a[192:195], v[40:43]
    buffer_load_dwordx4 v[80:83], v247, s[40:43], 0 offen offset:1024 sc1
    v_mfma_f32_16x16x32_bf16 v[40:43], v[196:199], a[196:199], v[40:43]
    v_mfma_f32_16x16x32_bf16 v[40:43], v[200:203], a[200:203], v[40:43]
    v_mfma_f32_16x16x32_bf16 v[40:43], v[204:207], a[204:207], v[40:43]
    s_waitcnt vmcnt(19)
    v_mfma_f32_16x16x32_bf16 a[28:31], v[224:227], a[208:211], a[28:31]
    s_waitcnt vmcnt(17)
    v_mfma_f32_16x16x32_bf16 a[28:31], v[228:231], a[212:215], a[28:31]
    buffer_load_dwordx4 v[92:95], v247, s[40:43], s26 offen offset:1024 sc1
    s_waitcnt vmcnt(16)
    v_mfma_f32_16x16x32_bf16 a[28:31], v[232:235], a[216:219], a[28:31]
    s_waitcnt vmcnt(14)
    v_mfma_f32_16x16x32_bf16 a[28:31], v[236:239], a[220:223], a[28:31]
    s_waitcnt vmcnt(13)
    v_mfma_f32_16x16x32_bf16 a[60:63], v[236:239], a[224:227], a[60:63]
    s_waitcnt vmcnt(12)
    v_mfma_f32_16x16x32_bf16 a[60:63], v[232:235], a[228:231], a[60:63]
    s_waitcnt vmcnt(11)
    v_mfma_f32_16x16x32_bf16 a[60:63], v[228:231], a[232:235], a[60:63]
    buffer_load_dwordx4 v[88:91], v247, s[40:43], 0 offen offset:0 sc1
    s_waitcnt vmcnt(11)
    v_mfma_f32_16x16x32_bf16 a[60:63], v[224:227], a[236:239], a[60:63]
    s_waitcnt vmcnt(10)
    v_mfma_f32_16x16x32_bf16 a[60:63], v[240:243], a[208:211], a[60:63]
    s_waitcnt vmcnt(9)
    v_mfma_f32_16x16x32_bf16 a[60:63], v[128:131], a[212:215], a[60:63]
    s_waitcnt vmcnt(8)
    v_mfma_f32_16x16x32_bf16 a[60:63], v[132:135], a[216:219], a[60:63]
    s_waitcnt vmcnt(7)
    v_mfma_f32_16x16x32_bf16 a[60:63], v[136:139], a[220:223], a[60:63]
    buffer_load_dwordx4 v[112:115], v247, s[40:43], s26 offen offset:0 sc1
    v_mfma_f32_16x16x32_bf16 a[92:95], v[136:139], a[224:227], a[92:95]
    v_mov_b32_dpp v224, v224 row_shr:1 row_mask:0xf bank_mask:0xf
    v_mfma_f32_16x16x32_bf16 a[92:95], v[132:135], a[228:231], a[92:95]
    v_mov_b32_dpp v225, v225 row_shr:1 row_mask:0xf bank_mask:0xf
    v_mfma_f32_16x16x32_bf16 a[92:95], v[128:131], a[232:235], a[92:95]
    v_mov_b32_dpp v226, v226 row_shr:1 row_mask:0xf bank_mask:0xf
    v_mfma_f32_16x16x32_bf16 a[92:95], v[240:243], a[236:239], a[92:95]
    v_mov_b32_dpp v227, v227 row_shr:1 row_mask:0xf bank_mask:0xf
    v_mfma_f32_16x16x32_bf16 a[24:27], v[228:231], a[208:211], a[24:27]
    buffer_load_dwordx4 a[240:243], v1, s[48:51], s25 offen offset:0 sc1
    v_mfma_f32_16x16x32_bf16 a[24:27], v[232:235], a[212:215], a[24:27]
    v_cndmask_b32_dpp v224, v216, v224, vcc row_shl:5 row_mask:0xf bank_mask:0xf
    v_mfma_f32_16x16x32_bf16 a[24:27], v[236:239], a[216:219], a[24:27]
    s_waitcnt vmcnt(8)
    v_mfma_f32_16x16x32_bf16 a[24:27], v[140:143], a[220:223], a[24:27]
    v_cndmask_b32_dpp v225, v217, v225, vcc row_shl:5 row_mask:0xf bank_mask:0xf
    v_mfma_f32_16x16x32_bf16 a[56:59], v[140:143], a[224:227], a[56:59]
    v_cndmask_b32_dpp v226, v218, v226, vcc row_shl:5 row_mask:0xf bank_mask:0xf
    v_mfma_f32_16x16x32_bf16 a[56:59], v[236:239], a[228:231], a[56:59]
    buffer_load_dwordx4 a[244:247], v1, s[48:51], s25 offen offset:1024 sc1
    v_mfma_f32_16x16x32_bf16 a[56:59], v[232:235], a[232:235], a[56:59]
    v_cndmask_b32_dpp v227, v219, v227, vcc row_shl:5 row_mask:0xf bank_mask:0xf
    v_mfma_f32_16x16x32_bf16 a[56:59], v[228:231], a[236:239], a[56:59]
    v_mov_b32_dpp v240, v240 row_shr:1 row_mask:0xf bank_mask:0xf
    v_mfma_f32_16x16x32_bf16 a[56:59], v[128:131], a[208:211], a[56:59]
    v_mov_b32_dpp v241, v241 row_shr:1 row_mask:0xf bank_mask:0xf
    v_mfma_f32_16x16x32_bf16 a[56:59], v[132:135], a[212:215], a[56:59]
    v_mov_b32_dpp v242, v242 row_shr:1 row_mask:0xf bank_mask:0xf
    v_mfma_f32_16x16x32_bf16 a[56:59], v[136:139], a[216:219], a[56:59]
    buffer_load_dwordx4 a[248:251], v1, s[48:51], s25 offen offset:2048 sc1
    s_waitcnt vmcnt(9)
    v_mfma_f32_16x16x32_bf16 a[56:59], v[72:75], a[220:223], a[56:59]
    v_mov_b32_dpp v243, v243 row_shr:1 row_mask:0xf bank_mask:0xf
    v_mfma_f32_16x16x32_bf16 a[88:91], v[72:75], a[224:227], a[88:91]
    v_cndmask_b32_dpp v240, v220, v240, vcc row_shl:5 row_mask:0xf bank_mask:0xf
    v_mfma_f32_16x16x32_bf16 a[88:91], v[136:139], a[228:231], a[88:91]
    v_cndmask_b32_dpp v241, v221, v241, vcc row_shl:5 row_mask:0xf bank_mask:0xf
    v_mfma_f32_16x16x32_bf16 a[88:91], v[132:135], a[232:235], a[88:91]
    v_cndmask_b32_dpp v242, v222, v242, vcc row_shl:5 row_mask:0xf bank_mask:0xf
    v_mfma_f32_16x16x32_bf16 a[88:91], v[128:131], a[236:239], a[88:91]
    buffer_load_dwordx4 a[252:255], v1, s[48:51], s64 offen offset:1024 sc1
    v_mfma_f32_16x16x32_bf16 a[20:23], v[232:235], a[208:211], a[20:23]
    v_cndmask_b32_dpp v243, v223, v243, vcc row_shl:5 row_mask:0xf bank_mask:0xf
    v_mfma_f32_16x16x32_bf16 a[20:23], v[236:239], a[212:215], a[20:23]
    v_mov_b32_dpp v228, v228 row_shr:1 row_mask:0xf bank_mask:0xf
    v_mfma_f32_16x16x32_bf16 a[20:23], v[140:143], a[216:219], a[20:23]
    s_waitcnt vmcnt(9)
    v_mfma_f32_16x16x32_bf16 a[20:23], v[76:79], a[220:223], a[20:23]
    v_mov_b32_dpp v229, v229 row_shr:1 row_mask:0xf bank_mask:0xf
    v_mfma_f32_16x16x32_bf16 a[52:55], v[76:79], a[224:227], a[52:55]
    buffer_load_dwordx4 a[100:103], v1, s[48:51], s64 offen offset:0 sc1
    v_mfma_f32_16x16x32_bf16 a[52:55], v[140:143], a[228:231], a[52:55]
    v_mov_b32_dpp v230, v230 row_shr:1 row_mask:0xf bank_mask:0xf
    v_mfma_f32_16x16x32_bf16 a[52:55], v[236:239], a[232:235], a[52:55]
    v_mov_b32_dpp v231, v231 row_shr:1 row_mask:0xf bank_mask:0xf
    v_mfma_f32_16x16x32_bf16 a[52:55], v[232:235], a[236:239], a[52:55]
    v_cndmask_b32_dpp v228, v216, v228, vcc row_shl:4 row_mask:0xf bank_mask:0xf
    v_mfma_f32_16x16x32_bf16 a[52:55], v[132:135], a[208:211], a[52:55]
    v_cndmask_b32_dpp v229, v217, v229, vcc row_shl:4 row_mask:0xf bank_mask:0xf
    v_mfma_f32_16x16x32_bf16 a[52:55], v[136:139], a[212:215], a[52:55]
    buffer_load_dwordx4 a[96:99], v1, s[48:51], s26 offen offset:3072 sc1
    v_mfma_f32_16x16x32_bf16 a[52:55], v[72:75], a[216:219], a[52:55]
    s_waitcnt vmcnt(10)
    v_mfma_f32_16x16x32_bf16 a[52:55], v[84:87], a[220:223], a[52:55]
    v_cndmask_b32_dpp v230, v218, v230, vcc row_shl:4 row_mask:0xf bank_mask:0xf
    v_mfma_f32_16x16x32_bf16 a[84:87], v[84:87], a[224:227], a[84:87]
    v_cndmask_b32_dpp v231, v219, v231, vcc row_shl:4 row_mask:0xf bank_mask:0xf
    v_mfma_f32_16x16x32_bf16 a[84:87], v[72:75], a[228:231], a[84:87]
    v_mov_b32_dpp v128, v128 row_shr:1 row_mask:0xf bank_mask:0xf
    v_mfma_f32_16x16x32_bf16 a[84:87], v[136:139], a[232:235], a[84:87]
    buffer_load_dwordx4 v[120:123], v2, s[56:59], s65 offen offset:0 sc1
    v_mfma_f32_16x16x32_bf16 a[84:87], v[132:135], a[236:239], a[84:87]
    v_mov_b32_dpp v129, v129 row_shr:1 row_mask:0xf bank_mask:0xf
    v_mfma_f32_16x16x32_bf16 a[16:19], v[236:239], a[208:211], a[16:19]
    v_mov_b32_dpp v130, v130 row_shr:1 row_mask:0xf bank_mask:0xf
    v_mfma_f32_16x16x32_bf16 a[16:19], v[140:143], a[212:215], a[16:19]
    v_mov_b32_dpp v131, v131 row_shr:1 row_mask:0xf bank_mask:0xf
    v_mfma_f32_16x16x32_bf16 a[16:19], v[76:79], a[216:219], a[16:19]
    s_waitcnt vmcnt(10)
    v_mfma_f32_16x16x32_bf16 a[16:19], v[80:83], a[220:223], a[16:19]
    buffer_load_dwordx4 v[104:107], v247, s[40:43], s66 offen offset:3072 sc1
    v_mfma_f32_16x16x32_bf16 a[48:51], v[80:83], a[224:227], a[48:51]
    v_cndmask_b32_dpp v128, v220, v128, vcc row_shl:4 row_mask:0xf bank_mask:0xf
    v_mfma_f32_16x16x32_bf16 a[48:51], v[76:79], a[228:231], a[48:51]
    v_cndmask_b32_dpp v129, v221, v129, vcc row_shl:4 row_mask:0xf bank_mask:0xf
    v_mfma_f32_16x16x32_bf16 a[48:51], v[140:143], a[232:235], a[48:51]
    v_cndmask_b32_dpp v130, v222, v130, vcc row_shl:4 row_mask:0xf bank_mask:0xf
    v_mfma_f32_16x16x32_bf16 a[48:51], v[236:239], a[236:239], a[48:51]
    v_cndmask_b32_dpp v131, v223, v131, vcc row_shl:4 row_mask:0xf bank_mask:0xf
    v_mfma_f32_16x16x32_bf16 a[48:51], v[136:139], a[208:211], a[48:51]
    buffer_load_dwordx4 a[108:111], v1, s[48:51], s64 offen offset:2048 sc1
    v_mfma_f32_16x16x32_bf16 a[48:51], v[72:75], a[212:215], a[48:51]
    v_mov_b32_dpp v232, v232 row_shr:1 row_mask:0xf bank_mask:0xf
    v_mfma_f32_16x16x32_bf16 a[48:51], v[84:87], a[216:219], a[48:51]
    s_waitcnt vmcnt(11)
    v_mfma_f32_16x16x32_bf16 a[48:51], v[92:95], a[220:223], a[48:51]
    v_mov_b32_dpp v233, v233 row_shr:1 row_mask:0xf bank_mask:0xf
    v_mfma_f32_16x16x32_bf16 a[80:83], v[92:95], a[224:227], a[80:83]
    v_mov_b32_dpp v234, v234 row_shr:1 row_mask:0xf bank_mask:0xf
    v_mfma_f32_16x16x32_bf16 a[80:83], v[84:87], a[228:231], a[80:83]
    buffer_load_dwordx4 v[96:99], v247, s[40:43], s66 offen offset:2048 sc1
    v_mfma_f32_16x16x32_bf16 a[80:83], v[72:75], a[232:235], a[80:83]
    v_mov_b32_dpp v235, v235 row_shr:1 row_mask:0xf bank_mask:0xf
    v_mfma_f32_16x16x32_bf16 a[80:83], v[136:139], a[236:239], a[80:83]
    v_cndmask_b32_dpp v232, v216, v232, vcc row_shl:3 row_mask:0xf bank_mask:0xf
    v_mfma_f32_16x16x32_bf16 a[12:15], v[140:143], a[208:211], a[12:15]
    v_cndmask_b32_dpp v233, v217, v233, vcc row_shl:3 row_mask:0xf bank_mask:0xf
    v_mfma_f32_16x16x32_bf16 a[12:15], v[76:79], a[212:215], a[12:15]
    v_cndmask_b32_dpp v234, v218, v234, vcc row_shl:3 row_mask:0xf bank_mask:0xf
    v_mfma_f32_16x16x32_bf16 a[12:15], v[80:83], a[216:219], a[12:15]
    buffer_load_dwordx4 a[104:107], v1, s[48:51], s64 offen offset:3072 sc1
    s_waitcnt vmcnt(12)
    v_mfma_f32_16x16x32_bf16 a[12:15], v[88:91], a[220:223], a[12:15]
    v_cndmask_b32_dpp v235, v219, v235, vcc row_shl:3 row_mask:0xf bank_mask:0xf
    v_mfma_f32_16x16x32_bf16 a[44:47], v[88:91], a[224:227], a[44:47]
    v_mov_b32_dpp v132, v132 row_shr:1 row_mask:0xf bank_mask:0xf
    v_mfma_f32_16x16x32_bf16 a[44:47], v[80:83], a[228:231], a[44:47]
    v_mov_b32_dpp v133, v133 row_shr:1 row_mask:0xf bank_mask:0xf
    v_mfma_f32_16x16x32_bf16 a[44:47], v[76:79], a[232:235], a[44:47]
    v_mov_b32_dpp v134, v134 row_shr:1 row_mask:0xf bank_mask:0xf
    v_mfma_f32_16x16x32_bf16 a[44:47], v[140:143], a[236:239], a[44:47]
    buffer_load_dwordx4 v[116:119], v247, s[40:43], s66 offen offset:1024 sc1
    v_mfma_f32_16x16x32_bf16 a[44:47], v[72:75], a[208:211], a[44:47]
    v_mov_b32_dpp v135, v135 row_shr:1 row_mask:0xf bank_mask:0xf
    v_mfma_f32_16x16x32_bf16 a[44:47], v[84:87], a[212:215], a[44:47]
    v_cndmask_b32_dpp v132, v220, v132, vcc row_shl:3 row_mask:0xf bank_mask:0xf
    v_mfma_f32_16x16x32_bf16 a[44:47], v[92:95], a[216:219], a[44:47]
    s_waitcnt vmcnt(12)
    v_mfma_f32_16x16x32_bf16 a[44:47], v[112:115], a[220:223], a[44:47]
    v_cndmask_b32_dpp v133, v221, v133, vcc row_shl:3 row_mask:0xf bank_mask:0xf
    v_mfma_f32_16x16x32_bf16 a[76:79], v[112:115], a[224:227], a[76:79]
    buffer_load_dwordx4 a[116:119], v1, s[48:51], s65 offen offset:0 sc1
    v_mfma_f32_16x16x32_bf16 a[76:79], v[92:95], a[228:231], a[76:79]
    v_cndmask_b32_dpp v134, v222, v134, vcc row_shl:3 row_mask:0xf bank_mask:0xf
    v_mfma_f32_16x16x32_bf16 a[76:79], v[84:87], a[232:235], a[76:79]
    v_cndmask_b32_dpp v135, v223, v135, vcc row_shl:3 row_mask:0xf bank_mask:0xf
    v_mfma_f32_16x16x32_bf16 a[76:79], v[72:75], a[236:239], a[76:79]
    v_mov_b32_dpp v236, v236 row_shr:1 row_mask:0xf bank_mask:0xf
    v_mfma_f32_16x16x32_bf16 a[8:11], v[76:79], a[208:211], a[8:11]
    v_mov_b32_dpp v237, v237 row_shr:1 row_mask:0xf bank_mask:0xf
    v_mfma_f32_16x16x32_bf16 a[8:11], v[80:83], a[212:215], a[8:11]
    buffer_load_dwordx4 v[124:127], v247, s[40:43], s66 offen offset:0 sc1
    v_mfma_f32_16x16x32_bf16 a[8:11], v[88:91], a[216:219], a[8:11]
    v_mov_b32_dpp v238, v238 row_shr:1 row_mask:0xf bank_mask:0xf
    v_mfma_f32_16x16x32_bf16 a[8:11], v[224:227], a[220:223], a[8:11]
    v_mov_b32_dpp v239, v239 row_shr:1 row_mask:0xf bank_mask:0xf
    v_mfma_f32_16x16x32_bf16 a[40:43], v[224:227], a[224:227], a[40:43]
    v_cndmask_b32_dpp v236, v216, v236, vcc row_shl:2 row_mask:0xf bank_mask:0xf
    v_mfma_f32_16x16x32_bf16 a[40:43], v[88:91], a[228:231], a[40:43]
    v_cndmask_b32_dpp v237, v217, v237, vcc row_shl:2 row_mask:0xf bank_mask:0xf
    v_mfma_f32_16x16x32_bf16 a[40:43], v[80:83], a[232:235], a[40:43]
    buffer_load_dwordx4 a[112:115], v1, s[48:51], s65 offen offset:1024 sc1
    v_mfma_f32_16x16x32_bf16 a[40:43], v[76:79], a[236:239], a[40:43]
    v_cndmask_b32_dpp v238, v218, v238, vcc row_shl:2 row_mask:0xf bank_mask:0xf
    v_mfma_f32_16x16x32_bf16 a[40:43], v[84:87], a[208:211], a[40:43]
    v_cndmask_b32_dpp v239, v219, v239, vcc row_shl:2 row_mask:0xf bank_mask:0xf
    v_mfma_f32_16x16x32_bf16 a[40:43], v[92:95], a[212:215], a[40:43]
    v_mov_b32_dpp v136, v136 row_shr:1 row_mask:0xf bank_mask:0xf
    v_mfma_f32_16x16x32_bf16 a[40:43], v[112:115], a[216:219], a[40:43]
    v_mov_b32_dpp v137, v137 row_shr:1 row_mask:0xf bank_mask:0xf
    v_mfma_f32_16x16x32_bf16 a[40:43], v[240:243], a[220:223], a[40:43]
    buffer_load_dwordx4 v[108:111], v247, s[40:43], s65 offen offset:3072 sc1
    v_mfma_f32_16x16x32_bf16 a[72:75], v[240:243], a[224:227], a[72:75]
    v_mov_b32_dpp v138, v138 row_shr:1 row_mask:0xf bank_mask:0xf
    v_mfma_f32_16x16x32_bf16 a[72:75], v[112:115], a[228:231], a[72:75]
    v_mov_b32_dpp v139, v139 row_shr:1 row_mask:0xf bank_mask:0xf
    v_mfma_f32_16x16x32_bf16 a[72:75], v[92:95], a[232:235], a[72:75]
    v_cndmask_b32_dpp v136, v220, v136, vcc row_shl:2 row_mask:0xf bank_mask:0xf
    v_mfma_f32_16x16x32_bf16 a[72:75], v[84:87], a[236:239], a[72:75]
    v_cndmask_b32_dpp v137, v221, v137, vcc row_shl:2 row_mask:0xf bank_mask:0xf
    v_mfma_f32_16x16x32_bf16 a[4:7], v[80:83], a[208:211], a[4:7]
    buffer_load_dwordx4 a[124:127], v1, s[48:51], s65 offen offset:2048 sc1
    v_mfma_f32_16x16x32_bf16 a[4:7], v[88:91], a[212:215], a[4:7]
    v_cndmask_b32_dpp v138, v222, v138, vcc row_shl:2 row_mask:0xf bank_mask:0xf
    v_mfma_f32_16x16x32_bf16 a[4:7], v[224:227], a[216:219], a[4:7]
    v_cndmask_b32_dpp v139, v223, v139, vcc row_shl:2 row_mask:0xf bank_mask:0xf
    v_mfma_f32_16x16x32_bf16 a[4:7], v[228:231], a[220:223], a[4:7]
    v_mfma_f32_16x16x32_bf16 a[36:39], v[228:231], a[224:227], a[36:39]
    v_mfma_f32_16x16x32_bf16 a[36:39], v[224:227], a[228:231], a[36:39]
    buffer_load_dwordx4 v[100:103], v247, s[40:43], s65 offen offset:2048 sc1
    v_mfma_f32_16x16x32_bf16 a[36:39], v[88:91], a[232:235], a[36:39]
    v_mfma_f32_16x16x32_bf16 a[36:39], v[80:83], a[236:239], a[36:39]
    v_mfma_f32_16x16x32_bf16 a[36:39], v[92:95], a[208:211], a[36:39]
    v_mfma_f32_16x16x32_bf16 a[36:39], v[112:115], a[212:215], a[36:39]
    v_mfma_f32_16x16x32_bf16 a[36:39], v[240:243], a[216:219], a[36:39]
    buffer_load_dwordx4 a[120:123], v1, s[48:51], s65 offen offset:3072 sc1
    v_mfma_f32_16x16x32_bf16 a[36:39], v[128:131], a[220:223], a[36:39]
    v_mfma_f32_16x16x32_bf16 a[68:71], v[128:131], a[224:227], a[68:71]
    v_mfma_f32_16x16x32_bf16 a[68:71], v[240:243], a[228:231], a[68:71]
    v_mfma_f32_16x16x32_bf16 a[68:71], v[112:115], a[232:235], a[68:71]
    v_mfma_f32_16x16x32_bf16 a[68:71], v[92:95], a[236:239], a[68:71]
    buffer_load_dwordx4 v[172:175], v247, s[40:43], s65 offen offset:1024 sc1
    v_mfma_f32_16x16x32_bf16 a[0:3], v[88:91], a[208:211], a[0:3]
    v_mfma_f32_16x16x32_bf16 a[0:3], v[224:227], a[212:215], a[0:3]
    v_mfma_f32_16x16x32_bf16 a[0:3], v[228:231], a[216:219], a[0:3]
    v_mfma_f32_16x16x32_bf16 a[0:3], v[232:235], a[220:223], a[0:3]
    v_mfma_f32_16x16x32_bf16 a[32:35], v[232:235], a[224:227], a[32:35]
    buffer_load_dwordx4 a[128:131], v1, s[48:51], s66 offen offset:0 sc1
    v_mfma_f32_16x16x32_bf16 a[32:35], v[228:231], a[228:231], a[32:35]
    v_mfma_f32_16x16x32_bf16 a[32:35], v[224:227], a[232:235], a[32:35]
    v_mfma_f32_16x16x32_bf16 a[32:35], v[88:91], a[236:239], a[32:35]
    v_mfma_f32_16x16x32_bf16 a[32:35], v[112:115], a[208:211], a[32:35]
    v_mfma_f32_16x16x32_bf16 a[32:35], v[240:243], a[212:215], a[32:35]
    buffer_load_dwordx4 v[176:179], v247, s[40:43], s65 offen offset:0 sc1
    v_mfma_f32_16x16x32_bf16 a[32:35], v[128:131], a[216:219], a[32:35]
    v_mfma_f32_16x16x32_bf16 a[32:35], v[132:135], a[220:223], a[32:35]
    v_mfma_f32_16x16x32_bf16 a[64:67], v[132:135], a[224:227], a[64:67]
    v_mfma_f32_16x16x32_bf16 a[64:67], v[128:131], a[228:231], a[64:67]
    global_load_dword v3, v254, s[8:9] sc1
    global_load_dword v254, v255, s[8:9] offset:512 sc1
    v_mfma_f32_16x16x32_bf16 a[64:67], v[240:243], a[232:235], a[64:67]
    buffer_load_dwordx4 v[148:151], v2, s[56:59], s67 offen offset:0 sc1
    v_mfma_f32_16x16x32_bf16 a[64:67], v[112:115], a[236:239], a[64:67]
    s_waitcnt vmcnt(20)
    v_mfma_f32_16x16x32_bf16 a[28:31], v[140:143], a[240:243], a[28:31]
    v_mfma_f32_16x16x32_bf16 a[28:31], v[76:79], a[244:247], a[28:31]
    v_mfma_f32_16x16x32_bf16 a[28:31], v[80:83], a[248:251], a[28:31]
    v_mfma_f32_16x16x32_bf16 a[60:63], v[80:83], a[252:255], a[60:63]
    buffer_load_dwordx4 v[152:155], v247, s[40:43], s68 offen offset:3072 sc1
    v_mfma_f32_16x16x32_bf16 a[60:63], v[76:79], a[100:103], a[60:63]
    s_waitcnt vmcnt(20)
    v_mfma_f32_16x16x32_bf16 a[60:63], v[140:143], a[96:99], a[60:63]
    v_mov_b32_dpp v140, v140 row_shr:1 row_mask:0xf bank_mask:0xf
    v_mfma_f32_16x16x32_bf16 a[60:63], v[72:75], a[240:243], a[60:63]
    v_mov_b32_dpp v141, v141 row_shr:1 row_mask:0xf bank_mask:0xf
    v_mfma_f32_16x16x32_bf16 a[60:63], v[84:87], a[244:247], a[60:63]
    v_mov_b32_dpp v142, v142 row_shr:1 row_mask:0xf bank_mask:0xf
    v_mfma_f32_16x16x32_bf16 a[60:63], v[92:95], a[248:251], a[60:63]
    buffer_load_dwordx4 a[132:135], v1, s[48:51], s66 offen offset:1024 sc1
    v_mfma_f32_16x16x32_bf16 a[92:95], v[92:95], a[252:255], a[92:95]
    v_mov_b32_dpp v143, v143 row_shr:1 row_mask:0xf bank_mask:0xf
    v_mfma_f32_16x16x32_bf16 a[92:95], v[84:87], a[100:103], a[92:95]
    v_cndmask_b32_dpp v140, v216, v140, vcc row_shl:1 row_mask:0xf bank_mask:0xf
    v_mfma_f32_16x16x32_bf16 a[92:95], v[72:75], a[96:99], a[92:95]
    v_cndmask_b32_dpp v141, v217, v141, vcc row_shl:1 row_mask:0xf bank_mask:0xf
    v_mfma_f32_16x16x32_bf16 a[24:27], v[76:79], a[240:243], a[24:27]
    v_cndmask_b32_dpp v142, v218, v142, vcc row_shl:1 row_mask:0xf bank_mask:0xf
    v_mfma_f32_16x16x32_bf16 a[24:27], v[80:83], a[244:247], a[24:27]
    buffer_load_dwordx4 v[156:159], v247, s[40:43], s68 offen offset:2048 sc1
    v_mfma_f32_16x16x32_bf16 a[24:27], v[88:91], a[248:251], a[24:27]
    v_cndmask_b32_dpp v143, v219, v143, vcc row_shl:1 row_mask:0xf bank_mask:0xf
    v_mfma_f32_16x16x32_bf16 a[56:59], v[88:91], a[252:255], a[56:59]
    v_mov_b32_dpp v72, v72 row_shr:1 row_mask:0xf bank_mask:0xf
    v_mfma_f32_16x16x32_bf16 a[56:59], v[80:83], a[100:103], a[56:59]
    v_mov_b32_dpp v73, v73 row_shr:1 row_mask:0xf bank_mask:0xf
    v_mfma_f32_16x16x32_bf16 a[56:59], v[76:79], a[96:99], a[56:59]
    v_mov_b32_dpp v74, v74 row_shr:1 row_mask:0xf bank_mask:0xf
    v_mfma_f32_16x16x32_bf16 a[56:59], v[84:87], a[240:243], a[56:59]
    buffer_load_dwordx4 a[136:139], v1, s[48:51], s66 offen offset:2048 sc1
    v_mfma_f32_16x16x32_bf16 a[56:59], v[92:95], a[244:247], a[56:59]
    v_mov_b32_dpp v75, v75 row_shr:1 row_mask:0xf bank_mask:0xf
    v_mfma_f32_16x16x32_bf16 a[56:59], v[112:115], a[248:251], a[56:59]
    v_cndmask_b32_dpp v72, v220, v72, vcc row_shl:1 row_mask:0xf bank_mask:0xf
    v_mfma_f32_16x16x32_bf16 a[88:91], v[112:115], a[252:255], a[88:91]
    v_cndmask_b32_dpp v73, v221, v73, vcc row_shl:1 row_mask:0xf bank_mask:0xf
    v_mfma_f32_16x16x32_bf16 a[88:91], v[92:95], a[100:103], a[88:91]
    v_cndmask_b32_dpp v74, v222, v74, vcc row_shl:1 row_mask:0xf bank_mask:0xf
    v_mfma_f32_16x16x32_bf16 a[88:91], v[84:87], a[96:99], a[88:91]
    buffer_load_dwordx4 v[160:163], v247, s[40:43], s68 offen offset:1024 sc1
    v_mfma_f32_16x16x32_bf16 a[20:23], v[80:83], a[240:243], a[20:23]
    v_cndmask_b32_dpp v75, v223, v75, vcc row_shl:1 row_mask:0xf bank_mask:0xf
    v_mfma_f32_16x16x32_bf16 a[20:23], v[88:91], a[244:247], a[20:23]
    v_mov_b32_dpp v76, v76 row_shr:1 row_mask:0xf bank_mask:0xf
    v_mfma_f32_16x16x32_bf16 a[20:23], v[224:227], a[248:251], a[20:23]
    v_mov_b32_dpp v77, v77 row_shr:1 row_mask:0xf bank_mask:0xf
    v_mfma_f32_16x16x32_bf16 a[52:55], v[224:227], a[252:255], a[52:55]
    v_mov_b32_dpp v78, v78 row_shr:1 row_mask:0xf bank_mask:0xf
    v_mfma_f32_16x16x32_bf16 a[52:55], v[88:91], a[100:103], a[52:55]
    buffer_load_dwordx4 a[140:143], v1, s[48:51], s66 offen offset:3072 sc1
    v_mfma_f32_16x16x32_bf16 a[52:55], v[80:83], a[96:99], a[52:55]
    v_mov_b32_dpp v79, v79 row_shr:1 row_mask:0xf bank_mask:0xf
    v_mfma_f32_16x16x32_bf16 a[52:55], v[92:95], a[240:243], a[52:55]
    v_cndmask_b32 v76, v216, v76, vcc
    v_mfma_f32_16x16x32_bf16 a[52:55], v[112:115], a[244:247], a[52:55]
    v_cndmask_b32 v77, v217, v77, vcc
    v_mfma_f32_16x16x32_bf16 a[52:55], v[240:243], a[248:251], a[52:55]
    v_cndmask_b32 v78, v218, v78, vcc
    v_mfma_f32_16x16x32_bf16 a[84:87], v[240:243], a[252:255], a[84:87]
    buffer_load_dwordx4 v[164:167], v247, s[40:43], s68 offen offset:0 sc1
    v_mfma_f32_16x16x32_bf16 a[84:87], v[112:115], a[100:103], a[84:87]
    v_cndmask_b32 v79, v219, v79, vcc
    v_mfma_f32_16x16x32_bf16 a[84:87], v[92:95], a[96:99], a[84:87]
    v_mov_b32_dpp v84, v84 row_shr:1 row_mask:0xf bank_mask:0xf
    v_mfma_f32_16x16x32_bf16 a[16:19], v[88:91], a[240:243], a[16:19]
    v_mov_b32_dpp v85, v85 row_shr:1 row_mask:0xf bank_mask:0xf
    v_mfma_f32_16x16x32_bf16 a[16:19], v[224:227], a[244:247], a[16:19]
    v_mov_b32_dpp v86, v86 row_shr:1 row_mask:0xf bank_mask:0xf
    v_mfma_f32_16x16x32_bf16 a[16:19], v[228:231], a[248:251], a[16:19]
    buffer_load_dwordx4 a[144:147], v1, s[48:51], s67 offen offset:0 sc1
    v_mfma_f32_16x16x32_bf16 a[48:51], v[228:231], a[252:255], a[48:51]
    v_mov_b32_dpp v87, v87 row_shr:1 row_mask:0xf bank_mask:0xf
    v_mfma_f32_16x16x32_bf16 a[48:51], v[224:227], a[100:103], a[48:51]
    v_cndmask_b32 v84, v220, v84, vcc
    v_mfma_f32_16x16x32_bf16 a[48:51], v[88:91], a[96:99], a[48:51]
    v_cndmask_b32 v85, v221, v85, vcc
    v_mfma_f32_16x16x32_bf16 a[48:51], v[112:115], a[240:243], a[48:51]
    v_cndmask_b32 v86, v222, v86, vcc
    v_mfma_f32_16x16x32_bf16 a[48:51], v[240:243], a[244:247], a[48:51]
    buffer_load_dwordx4 v[144:147], v247, s[40:43], s67 offen offset:3072 sc1
    v_mfma_f32_16x16x32_bf16 a[48:51], v[128:131], a[248:251], a[48:51]
    v_cndmask_b32 v87, v223, v87, vcc
    v_mfma_f32_16x16x32_bf16 a[80:83], v[128:131], a[252:255], a[80:83]
    v_mfma_f32_16x16x32_bf16 a[80:83], v[240:243], a[100:103], a[80:83]
    v_mfma_f32_16x16x32_bf16 a[80:83], v[112:115], a[96:99], a[80:83]
    v_mfma_f32_16x16x32_bf16 a[12:15], v[224:227], a[240:243], a[12:15]
    buffer_load_dwordx4 a[148:151], v1, s[48:51], s67 offen offset:1024 sc1
    v_mfma_f32_16x16x32_bf16 a[12:15], v[228:231], a[244:247], a[12:15]
    v_mfma_f32_16x16x32_bf16 a[12:15], v[232:235], a[248:251], a[12:15]
    v_mfma_f32_16x16x32_bf16 a[44:47], v[232:235], a[252:255], a[44:47]
    v_mfma_f32_16x16x32_bf16 a[44:47], v[228:231], a[100:103], a[44:47]
    v_mfma_f32_16x16x32_bf16 a[44:47], v[224:227], a[96:99], a[44:47]
    buffer_load_dwordx4 v[168:171], v247, s[40:43], s67 offen offset:2048 sc1
    v_mfma_f32_16x16x32_bf16 a[44:47], v[240:243], a[240:243], a[44:47]
    v_mfma_f32_16x16x32_bf16 a[44:47], v[128:131], a[244:247], a[44:47]
    v_mfma_f32_16x16x32_bf16 a[44:47], v[132:135], a[248:251], a[44:47]
    v_mfma_f32_16x16x32_bf16 a[76:79], v[132:135], a[252:255], a[76:79]
    v_mfma_f32_16x16x32_bf16 a[76:79], v[128:131], a[100:103], a[76:79]
    buffer_load_dwordx4 a[152:155], v1, s[48:51], s67 offen offset:2048 sc1
    v_mfma_f32_16x16x32_bf16 a[76:79], v[240:243], a[96:99], a[76:79]
    v_mfma_f32_16x16x32_bf16 a[8:11], v[228:231], a[240:243], a[8:11]
    v_mfma_f32_16x16x32_bf16 a[8:11], v[232:235], a[244:247], a[8:11]
    v_mfma_f32_16x16x32_bf16 a[8:11], v[236:239], a[248:251], a[8:11]
    v_mfma_f32_16x16x32_bf16 a[40:43], v[236:239], a[252:255], a[40:43]
    buffer_load_dwordx4 v[208:211], v247, s[40:43], s67 offen offset:1024 sc1
    v_mfma_f32_16x16x32_bf16 a[40:43], v[232:235], a[100:103], a[40:43]
    v_mfma_f32_16x16x32_bf16 a[40:43], v[228:231], a[96:99], a[40:43]
    v_mfma_f32_16x16x32_bf16 a[40:43], v[128:131], a[240:243], a[40:43]
    v_mfma_f32_16x16x32_bf16 a[40:43], v[132:135], a[244:247], a[40:43]
    v_mfma_f32_16x16x32_bf16 a[40:43], v[136:139], a[248:251], a[40:43]
    buffer_load_dwordx4 a[156:159], v1, s[48:51], s67 offen offset:3072 sc1
    v_mfma_f32_16x16x32_bf16 a[72:75], v[136:139], a[252:255], a[72:75]
    v_mfma_f32_16x16x32_bf16 a[72:75], v[132:135], a[100:103], a[72:75]
    v_mfma_f32_16x16x32_bf16 a[72:75], v[128:131], a[96:99], a[72:75]
    v_mfma_f32_16x16x32_bf16 a[4:7], v[232:235], a[240:243], a[4:7]
    v_mfma_f32_16x16x32_bf16 a[4:7], v[236:239], a[244:247], a[4:7]
    buffer_load_dwordx4 v[212:215], v247, s[40:43], s67 offen offset:0 sc1
    v_mfma_f32_16x16x32_bf16 a[4:7], v[140:143], a[248:251], a[4:7]
    v_mfma_f32_16x16x32_bf16 a[36:39], v[140:143], a[252:255], a[36:39]
    v_mfma_f32_16x16x32_bf16 a[36:39], v[236:239], a[100:103], a[36:39]
    v_mfma_f32_16x16x32_bf16 a[36:39], v[232:235], a[96:99], a[36:39]
    s_waitcnt vmcnt(16)
    v_cmp_ne_u32 s[72:73], s82, v3
    v_cmp_ne_u32 s[74:75], s82, v254
    s_nop 4
    s_or_b64 s[72:73], s[72:73], s[74:75]
    s_cmp_lg_u64 s[72:73], 0
    s_cbranch_scc1 FU_poll2_again
FU_poll2_ok:
    s_barrier
    v_mfma_f32_16x16x32_bf16 a[36:39], v[132:135], a[240:243], a[36:39]
    buffer_load_dwordx4 v[184:187], v2, s[60:63], 0 offen offset:0 sc1
    v_mfma_f32_16x16x32_bf16 a[36:39], v[136:139], a[244:247], a[36:39]
    v_mfma_f32_16x16x32_bf16 a[36:39], v[72:75], a[248:251], a[36:39]
    v_mfma_f32_16x16x32_bf16 a[68:71], v[72:75], a[252:255], a[68:71]
    v_mfma_f32_16x16x32_bf16 a[68:71], v[136:139], a[100:103], a[68:71]
    v_mfma_f32_16x16x32_bf16 a[68:71], v[132:135], a[96:99], a[68:71]
    buffer_load_dwordx4 v[188:191], v2, s[60:63], s26 offen offset:0 sc1
    v_mfma_f32_16x16x32_bf16 a[0:3], v[236:239], a[240:243], a[0:3]
    v_mfma_f32_16x16x32_bf16 a[0:3], v[140:143], a[244:247], a[0:3]
    v_mfma_f32_16x16x32_bf16 a[0:3], v[76:79], a[248:251], a[0:3]
    v_mfma_f32_16x16x32_bf16 a[32:35], v[76:79], a[252:255], a[32:35]
    v_mfma_f32_16x16x32_bf16 a[32:35], v[140:143], a[100:103], a[32:35]
    buffer_load_dwordx4 v[192:195], v247, s[44:47], s25 offen offset:3072 sc1
    v_mfma_f32_16x16x32_bf16 a[32:35], v[236:239], a[96:99], a[32:35]
    v_mfma_f32_16x16x32_bf16 a[32:35], v[136:139], a[240:243], a[32:35]
    v_mfma_f32_16x16x32_bf16 a[32:35], v[72:75], a[244:247], a[32:35]
    v_mfma_f32_16x16x32_bf16 a[32:35], v[84:87], a[248:251], a[32:35]
    v_mfma_f32_16x16x32_bf16 a[64:67], v[84:87], a[252:255], a[64:67]
    buffer_load_dwordx4 a[160:163], v1, s[52:55], 0 offen offset:0 sc1
    v_mfma_f32_16x16x32_bf16 a[64:67], v[72:75], a[100:103], a[64:67]
    v_mfma_f32_16x16x32_bf16 a[64:67], v[136:139], a[96:99], a[64:67]
    v_mfma_f32_16x16x32_bf16 v[36:39], v[104:107], a[108:111], v[36:39]
    v_mov_b32_dpp v104, v104 row_shr:1 row_mask:0xf bank_mask:0xf
    v_mov_b32_dpp v105, v105 row_shr:1 row_mask:0xf bank_mask:0xf
    v_mfma_f32_16x16x32_bf16 v[36:39], v[96:99], a[104:107], v[36:39]
    v_mov_b32_dpp v106, v106 row_shr:1 row_mask:0xf bank_mask:0xf
    v_mov_b32_dpp v107, v107 row_shr:1 row_mask:0xf bank_mask:0xf
    v_mfma_f32_16x16x32_bf16 v[36:39], v[116:119], a[116:119], v[36:39]
    buffer_load_dwordx4 v[196:199], v247, s[44:47], s25 offen offset:2048 sc1
    v_cndmask_b32_dpp v104, v120, v104, vcc row_shl:5 row_mask:0xf bank_mask:0xf
    v_mfma_f32_16x16x32_bf16 v[36:39], v[124:127], a[112:115], v[36:39]
    v_cndmask_b32_dpp v105, v121, v105, vcc row_shl:5 row_mask:0xf bank_mask:0xf
    v_cndmask_b32_dpp v106, v122, v106, vcc row_shl:5 row_mask:0xf bank_mask:0xf
    v_mfma_f32_16x16x32_bf16 v[36:39], v[108:111], a[124:127], v[36:39]
    v_cndmask_b32_dpp v107, v123, v107, vcc row_shl:5 row_mask:0xf bank_mask:0xf
    v_mfma_f32_16x16x32_bf16 v[36:39], v[100:103], a[120:123], v[36:39]
    v_mfma_f32_16x16x32_bf16 v[36:39], v[172:175], a[128:131], v[36:39]
    v_mfma_f32_16x16x32_bf16 v[32:35], v[96:99], a[108:111], v[32:35]
    buffer_load_dwordx4 a[164:167], v1, s[52:55], 0 offen offset:1024 sc1
    v_mov_b32_dpp v96, v96 row_shr:1 row_mask:0xf bank_mask:0xf
    v_mfma_f32_16x16x32_bf16 v[32:35], v[116:119], a[104:107], v[32:35]
    v_mov_b32_dpp v97, v97 row_shr:1 row_mask:0xf bank_mask:0xf
    v_mov_b32_dpp v98, v98 row_shr:1 row_mask:0xf bank_mask:0xf
    v_mfma_f32_16x16x32_bf16 v[32:35], v[124:127], a[116:119], v[32:35]
    v_mov_b32_dpp v99, v99 row_shr:1 row_mask:0xf bank_mask:0xf
    v_cndmask_b32_dpp v96, v120, v96, vcc row_shl:4 row_mask:0xf bank_mask:0xf
    v_mfma_f32_16x16x32_bf16 v[32:35], v[108:111], a[112:115], v[32:35]
    v_cndmask_b32_dpp v97, v121, v97, vcc row_shl:4 row_mask:0xf bank_mask:0xf
    v_cndmask_b32_dpp v98, v122, v98, vcc row_shl:4 row_mask:0xf bank_mask:0xf
    v_mfma_f32_16x16x32_bf16 v[32:35], v[100:103], a[124:127], v[32:35]
    v_cndmask_b32_dpp v99, v123, v99, vcc row_shl:4 row_mask:0xf bank_mask:0xf
    v_mfma_f32_16x16x32_bf16 v[32:35], v[172:175], a[120:123], v[32:35]
    buffer_load_dwordx4 v[200:203], v247, s[44:47], s25 offen offset:1024 sc1
    v_mfma_f32_16x16x32_bf16 v[32:35], v[176:179], a[128:131], v[32:35]
    v_mfma_f32_16x16x32_bf16 v[28:31], v[116:119], a[108:111], v[28:31]
    v_mov_b32_dpp v116, v116 row_shr:1 row_mask:0xf bank_mask:0xf
    v_mov_b32_dpp v117, v117 row_shr:1 row_mask:0xf bank_mask:0xf
    v_mfma_f32_16x16x32_bf16 v[28:31], v[124:127], a[104:107], v[28:31]
    v_mov_b32_dpp v118, v118 row_shr:1 row_mask:0xf bank_mask:0xf
    v_mov_b32_dpp v119, v119 row_shr:1 row_mask:0xf bank_mask:0xf
    v_mfma_f32_16x16x32_bf16 v[28:31], v[108:111], a[116:119], v[28:31]
    v_cndmask_b32_dpp v116, v120, v116, vcc row_shl:3 row_mask:0xf bank_mask:0xf
    v_cndmask_b32_dpp v117, v121, v117, vcc row_shl:3 row_mask:0xf bank_mask:0xf
    v_mfma_f32_16x16x32_bf16 v[28:31], v[100:103], a[112:115], v[28:31]
    buffer_load_dwordx4 a[168:171], v1, s[52:55], 0 offen offset:2048 sc1
    v_mfma_f32_16x16x32_bf16 v[28:31], v[172:175], a[124:127], v[28:31]
    v_cndmask_b32_dpp v118, v122, v118, vcc row_shl:3 row_mask:0xf bank_mask:0xf
    v_mfma_f32_16x16x32_bf16 v[28:31], v[176:179], a[120:123], v[28:31]
    v_cndmask_b32_dpp v119, v123, v119, vcc row_shl:3 row_mask:0xf bank_mask:0xf
    v_mfma_f32_16x16x32_bf16 v[28:31], v[104:107], a[128:131], v[28:31]
    v_mfma_f32_16x16x32_bf16 v[24:27], v[124:127], a[108:111], v[24:27]
    v_mov_b32_dpp v124, v124 row_shr:1 row_mask:0xf bank_mask:0xf
    v_mov_b32_dpp v125, v125 row_shr:1 row_mask:0xf bank_mask:0xf
    v_mfma_f32_16x16x32_bf16 v[24:27], v[108:111], a[104:107], v[24:27]
    buffer_load_dwordx4 v[180:183], v247, s[44:47], s25 offen offset:0 sc1
    v_mfma_f32_16x16x32_bf16 v[24:27], v[100:103], a[116:119], v[24:27]
    v_mov_b32_dpp v126, v126 row_shr:1 row_mask:0xf bank_mask:0xf
    v_mfma_f32_16x16x32_bf16 v[24:27], v[172:175], a[112:115], v[24:27]
    v_mov_b32_dpp v127, v127 row_shr:1 row_mask:0xf bank_mask:0xf
    v_mfma_f32_16x16x32_bf16 v[24:27], v[176:179], a[124:127], v[24:27]
    v_cndmask_b32_dpp v124, v120, v124, vcc row_shl:2 row_mask:0xf bank_mask:0xf
    v_mfma_f32_16x16x32_bf16 v[24:27], v[104:107], a[120:123], v[24:27]
    v_cndmask_b32_dpp v125, v121, v125, vcc row_shl:2 row_mask:0xf bank_mask:0xf
    v_mfma_f32_16x16x32_bf16 v[24:27], v[96:99], a[128:131], v[24:27]
    buffer_load_dwordx4 a[172:175], v1, s[52:55], 0 offen offset:3072 sc1
    v_mfma_f32_16x16x32_bf16 v[20:23], v[108:111], a[108:111], v[20:23]
    v_cndmask_b32_dpp v126, v122, v126, vcc row_shl:2 row_mask:0xf bank_mask:0xf
    v_mfma_f32_16x16x32_bf16 v[20:23], v[100:103], a[104:107], v[20:23]
    v_cndmask_b32_dpp v127, v123, v127, vcc row_shl:2 row_mask:0xf bank_mask:0xf
    v_mfma_f32_16x16x32_bf16 v[20:23], v[172:175], a[116:119], v[20:23]
    v_mov_b32_dpp v108, v108 row_shr:1 row_mask:0xf bank_mask:0xf
    v_mov_b32_dpp v109, v109 row_shr:1 row_mask:0xf bank_mask:0xf
    v_mfma_f32_16x16x32_bf16 v[20:23], v[176:179], a[112:115], v[20:23]
    v_mov_b32_dpp v110, v110 row_shr:1 row_mask:0xf bank_mask:0xf
    v_mfma_f32_16x16x32_bf16 v[20:23], v[104:107], a[124:127], v[20:23]
    buffer_load_dwordx4 a[176:179], v1, s[52:55], s26 offen offset:2048 sc1
    v_mfma_f32_16x16x32_bf16 v[20:23], v[96:99], a[120:123], v[20:23]
    v_mov_b32_dpp v111, v111 row_shr:1 row_mask:0xf bank_mask:0xf
    v_mfma_f32_16x16x32_bf16 v[20:23], v[116:119], a[128:131], v[20:23]
    v_cndmask_b32_dpp v108, v120, v108, vcc row_shl:1 row_mask:0xf bank_mask:0xf
    v_mfma_f32_16x16x32_bf16 v[16:19], v[100:103], a[108:111], v[16:19]
    v_cndmask_b32_dpp v109, v121, v109, vcc row_shl:1 row_mask:0xf bank_mask:0xf
    v_mfma_f32_16x16x32_bf16 v[16:19], v[172:175], a[104:107], v[16:19]
    v_cndmask_b32_dpp v110, v122, v110, vcc row_shl:1 row_mask:0xf bank_mask:0xf
    v_mfma_f32_16x16x32_bf16 v[16:19], v[176:179], a[116:119], v[16:19]
    buffer_load_dwordx4 a[180:183], v1, s[52:55], s26 offen offset:1024 sc1
    v_cndmask_b32_dpp v111, v123, v111, vcc row_shl:1 row_mask:0xf bank_mask:0xf
    v_mfma_f32_16x16x32_bf16 v[16:19], v[104:107], a[112:115], v[16:19]
    v_mov_b32_dpp v100, v100 row_shr:1 row_mask:0xf bank_mask:0xf
    v_mov_b32_dpp v101, v101 row_shr:1 row_mask:0xf bank_mask:0xf
    v_mfma_f32_16x16x32_bf16 v[16:19], v[96:99], a[124:127], v[16:19]
    v_mov_b32_dpp v102, v102 row_shr:1 row_mask:0xf bank_mask:0xf
    v_mfma_f32_16x16x32_bf16 v[16:19], v[116:119], a[120:123], v[16:19]
    v_mov_b32_dpp v103, v103 row_shr:1 row_mask:0xf bank_mask:0xf
    v_mfma_f32_16x16x32_bf16 v[16:19], v[124:127], a[128:131], v[16:19]
    v_cndmask_b32 v100, v120, v100, vcc
    v_mfma_f32_16x16x32_bf16 v[12:15], v[172:175], a[108:111], v[12:15]
    buffer_load_dwordx4 a[184:187], v1, s[52:55], s26 offen offset:0 sc1
    v_mfma_f32_16x16x32_bf16 v[12:15], v[176:179], a[104:107], v[12:15]
    v_cndmask_b32 v101, v121, v101, vcc
    v_mfma_f32_16x16x32_bf16 v[12:15], v[104:107], a[116:119], v[12:15]
    v_cndmask_b32 v102, v122, v102, vcc
    v_cndmask_b32 v103, v123, v103, vcc
    v_mfma_f32_16x16x32_bf16 v[12:15], v[96:99], a[112:115], v[12:15]
    v_mfma_f32_16x16x32_bf16 v[12:15], v[116:119], a[124:127], v[12:15]
    v_mfma_f32_16x16x32_bf16 v[12:15], v[124:127], a[120:123], v[12:15]
    buffer_load_dwordx4 a[188:191], v1, s[52:55], s25 offen offset:3072 sc1
    v_mfma_f32_16x16x32_bf16 v[12:15], v[108:111], a[128:131], v[12:15]
    v_mfma_f32_16x16x32_bf16 v[8:11], v[176:179], a[108:111], v[8:11]
    v_mfma_f32_16x16x32_bf16 v[8:11], v[104:107], a[104:107], v[8:11]
    v_mfma_f32_16x16x32_bf16 v[8:11], v[96:99], a[116:119], v[8:11]
    v_mfma_f32_16x16x32_bf16 v[8:11], v[116:119], a[112:115], v[8:11]
    buffer_load_dwordx4 v[204:207], v247, s[44:47], s64 offen offset:3072 sc1
    v_mfma_f32_16x16x32_bf16 v[8:11], v[124:127], a[124:127], v[8:11]
    v_mfma_f32_16x16x32_bf16 v[8:11], v[108:111], a[120:123], v[8:11]
    v_mfma_f32_16x16x32_bf16 v[8:11], v[100:103], a[128:131], v[8:11]
    s_waitcnt vmcnt(18)
    v_mfma_f32_16x16x32_bf16 v[68:71], v[152:155], a[132:135], v[68:71]
    v_mov_b32_dpp v152, v152 row_shr:1 row_mask:0xf bank_mask:0xf
    v_mov_b32_dpp v153, v153 row_shr:1 row_mask:0xf bank_mask:0xf
    v_mfma_f32_16x16x32_bf16 v[68:71], v[156:159], a[136:139], v[68:71]
    buffer_load_dwordx4 v[80:83], v247, s[44:47], s64 offen offset:2048 sc1
    v_mov_b32_dpp v154, v154 row_shr:1 row_mask:0xf bank_mask:0xf
    v_mfma_f32_16x16x32_bf16 v[68:71], v[160:163], a[140:143], v[68:71]
    v_mov_b32_dpp v155, v155 row_shr:1 row_mask:0xf bank_mask:0xf
    v_cndmask_b32_dpp v152, v148, v152, vcc row_shl:5 row_mask:0xf bank_mask:0xf
    v_mfma_f32_16x16x32_bf16 v[68:71], v[164:167], a[144:147], v[68:71]
    v_cndmask_b32_dpp v153, v149, v153, vcc row_shl:5 row_mask:0xf bank_mask:0xf
    v_cndmask_b32_dpp v154, v150, v154, vcc row_shl:5 row_mask:0xf bank_mask:0xf
    v_mfma_f32_16x16x32_bf16 v[68:71], v[144:147], a[148:151], v[68:71]
    v_cndmask_b32_dpp v155, v151, v155, vcc row_shl:5 row_mask:0xf bank_mask:0xf
    v_mfma_f32_16x16x32_bf16 v[68:71], v[168:171], a[152:155], v[68:71]
    s_waitcnt vmcnt(17)
    v_mfma_f32_16x16x32_bf16 v[68:71], v[208:211], a[156:159], v[68:71]
    buffer_load_dwordx4 v[92:95], v247, s[44:47], s64 offen offset:1024 sc1
    v_mfma_f32_16x16x32_bf16 v[64:67], v[156:159], a[132:135], v[64:67]
    v_mov_b32_dpp v156, v156 row_shr:1 row_mask:0xf bank_mask:0xf
    v_mov_b32_dpp v157, v157 row_shr:1 row_mask:0xf bank_mask:0xf
    v_mfma_f32_16x16x32_bf16 v[64:67], v[160:163], a[136:139], v[64:67]
    v_mov_b32_dpp v158, v158 row_shr:1 row_mask:0xf bank_mask:0xf
    v_mov_b32_dpp v159, v159 row_shr:1 row_mask:0xf bank_mask:0xf
    v_mfma_f32_16x16x32_bf16 v[64:67], v[164:167], a[140:143], v[64:67]
    v_cndmask_b32_dpp v156, v148, v156, vcc row_shl:4 row_mask:0xf bank_mask:0xf
    v_cndmask_b32_dpp v157, v149, v157, vcc row_shl:4 row_mask:0xf bank_mask:0xf
    v_mfma_f32_16x16x32_bf16 v[64:67], v[144:147], a[144:147], v[64:67]
    v_cndmask_b32_dpp v158, v150, v158, vcc row_shl:4 row_mask:0xf bank_mask:0xf
    v_cndmask_b32_dpp v159, v151, v159, vcc row_shl:4 row_mask:0xf bank_mask:0xf
    v_mfma_f32_16x16x32_bf16 v[64:67], v[168:171], a[148:151], v[64:67]
    buffer_load_dwordx4 v[88:91], v247, s[44:47], s64 offen offset:0 sc1
    v_mfma_f32_16x16x32_bf16 v[64:67], v[208:211], a[152:155], v[64:67]
    s_waitcnt vmcnt(18)
    v_mfma_f32_16x16x32_bf16 v[64:67], v[212:215], a[156:159], v[64:67]
    v_mfma_f32_16x16x32_bf16 v[60:63], v[160:163], a[132:135], v[60:63]
    v_mov_b32_dpp v160, v160 row_shr:1 row_mask:0xf bank_mask:0xf
    v_mov_b32_dpp v161, v161 row_shr:1 row_mask:0xf bank_mask:0xf
    v_mfma_f32_16x16x32_bf16 v[60:63], v[164:167], a[136:139], v[60:63]
    v_mov_b32_dpp v162, v162 row_shr:1 row_mask:0xf bank_mask:0xf
    v_mov_b32_dpp v163, v163 row_shr:1 row_mask:0xf bank_mask:0xf
    v_mfma_f32_16x16x32_bf16 v[60:63], v[144:147], a[140:143], v[60:63]
    buffer_load_dwordx4 v[112:115], v247, s[44:47], 0 offen offset:3072 sc1
    v_cndmask_b32_dpp v160, v148, v160, vcc row_shl:3 row_mask:0xf bank_mask:0xf
    v_mfma_f32_16x16x32_bf16 v[60:63], v[168:171], a[144:147], v[60:63]
    v_cndmask_b32_dpp v161, v149, v161, vcc row_shl:3 row_mask:0xf bank_mask:0xf
    v_cndmask_b32_dpp v162, v150, v162, vcc row_shl:3 row_mask:0xf bank_mask:0xf
    v_mfma_f32_16x16x32_bf16 v[60:63], v[208:211], a[148:151], v[60:63]
    v_cndmask_b32_dpp v163, v151, v163, vcc row_shl:3 row_mask:0xf bank_mask:0xf
    v_mfma_f32_16x16x32_bf16 v[60:63], v[212:215], a[152:155], v[60:63]
    v_mfma_f32_16x16x32_bf16 v[60:63], v[152:155], a[156:159], v[60:63]
    v_mfma_f32_16x16x32_bf16 v[56:59], v[164:167], a[132:135], v[56:59]
    buffer_load_dwordx4 v[224:227], v247, s[44:47], s26 offen offset:3072 sc1
    v_mov_b32_dpp v164, v164 row_shr:1 row_mask:0xf bank_mask:0xf
    v_mfma_f32_16x16x32_bf16 v[56:59], v[144:147], a[136:139], v[56:59]
    v_mov_b32_dpp v165, v165 row_shr:1 row_mask:0xf bank_mask:0xf
    v_mov_b32_dpp v166, v166 row_shr:1 row_mask:0xf bank_mask:0xf
    v_mfma_f32_16x16x32_bf16 v[56:59], v[168:171], a[140:143], v[56:59]
    v_mov_b32_dpp v167, v167 row_shr:1 row_mask:0xf bank_mask:0xf
    v_mfma_f32_16x16x32_bf16 v[56:59], v[208:211], a[144:147], v[56:59]
    v_cndmask_b32_dpp v164, v148, v164, vcc row_shl:2 row_mask:0xf bank_mask:0xf
    v_mfma_f32_16x16x32_bf16 v[56:59], v[212:215], a[148:151], v[56:59]
    v_cndmask_b32_dpp v165, v149, v165, vcc row_shl:2 row_mask:0xf bank_mask:0xf
    v_mfma_f32_16x16x32_bf16 v[56:59], v[152:155], a[152:155], v[56:59]
    buffer_load_dwordx4 v[128:131], v247, s[44:47], 0 offen offset:2048 sc1
    v_mfma_f32_16x16x32_bf16 v[56:59], v[156:159], a[156:159], v[56:59]
    v_cndmask_b32_dpp v166, v150, v166, vcc row_shl:2 row_mask:0xf bank_mask:0xf
    v_mfma_f32_16x16x32_bf16 v[52:55], v[144:147], a[132:135], v[52:55]
    v_cndmask_b32_dpp v167, v151, v167, vcc row_shl:2 row_mask:0xf bank_mask:0xf
    v_mfma_f32_16x16x32_bf16 v[52:55], v[168:171], a[136:139], v[52:55]
    v_mov_b32_dpp v144, v144 row_shr:1 row_mask:0xf bank_mask:0xf
    v_mfma_f32_16x16x32_bf16 v[52:55], v[208:211], a[140:143], v[52:55]
    v_mov_b32_dpp v145, v145 row_shr:1 row_mask:0xf bank_mask:0xf
    v_mfma_f32_16x16x32_bf16 v[52:55], v[212:215], a[144:147], v[52:55]
    buffer_load_dwordx4 v[132:135], v247, s[44:47], s26 offen offset:2048 sc1
    v_mfma_f32_16x16x32_bf16 v[52:55], v[152:155], a[148:151], v[52:55]
    v_mov_b32_dpp v146, v146 row_shr:1 row_mask:0xf bank_mask:0xf
    v_mfma_f32_16x16x32_bf16 v[52:55], v[156:159], a[152:155], v[52:55]
    v_mov_b32_dpp v147, v147 row_shr:1 row_mask:0xf bank_mask:0xf
    v_mfma_f32_16x16x32_bf16 v[52:55], v[160:163], a[156:159], v[52:55]
    v_cndmask_b32_dpp v144, v148, v144, vcc row_shl:1 row_mask:0xf bank_mask:0xf
    v_mfma_f32_16x16x32_bf16 v[48:51], v[168:171], a[132:135], v[48:51]
    v_cndmask_b32_dpp v145, v149, v145, vcc row_shl:1 row_mask:0xf bank_mask:0xf
    v_mfma_f32_16x16x32_bf16 v[48:51], v[208:211], a[136:139], v[48:51]
    buffer_load_dwordx4 v[216:219], v247, s[44:47], 0 offen offset:1024 sc1
    v_mfma_f32_16x16x32_bf16 v[48:51], v[212:215], a[140:143], v[48:51]
    v_cndmask_b32_dpp v146, v150, v146, vcc row_shl:1 row_mask:0xf bank_mask:0xf
    v_mfma_f32_16x16x32_bf16 v[48:51], v[152:155], a[144:147], v[48:51]
    v_cndmask_b32_dpp v147, v151, v147, vcc row_shl:1 row_mask:0xf bank_mask:0xf
    v_mfma_f32_16x16x32_bf16 v[48:51], v[156:159], a[148:151], v[48:51]
    v_mov_b32_dpp v168, v168 row_shr:1 row_mask:0xf bank_mask:0xf
    v_mfma_f32_16x16x32_bf16 v[48:51], v[160:163], a[152:155], v[48:51]
    v_mov_b32_dpp v169, v169 row_shr:1 row_mask:0xf bank_mask:0xf
    v_mfma_f32_16x16x32_bf16 v[48:51], v[164:167], a[156:159], v[48:51]
    buffer_load_dwordx4 v[76:79], v247, s[44:47], s26 offen offset:1024 sc1
    v_mfma_f32_16x16x32_bf16 v[44:47], v[208:211], a[132:135], v[44:47]
    v_mov_b32_dpp v170, v170 row_shr:1 row_mask:0xf bank_mask:0xf
    v_mfma_f32_16x16x32_bf16 v[44:47], v[212:215], a[136:139], v[44:47]
    v_mov_b32_dpp v171, v171 row_shr:1 row_mask:0xf bank_mask:0xf
    v_mfma_f32_16x16x32_bf16 v[44:47], v[152:155], a[140:143], v[44:47]
    v_cndmask_b32 v168, v148, v168, vcc
    v_mfma_f32_16x16x32_bf16 v[44:47], v[156:159], a[144:147], v[44:47]
    v_cndmask_b32 v169, v149, v169, vcc
    v_mfma_f32_16x16x32_bf16 v[44:47], v[160:163], a[148:151], v[44:47]
    buffer_load_dwordx4 v[140:143], v247, s[44:47], 0 offen offset:0 sc1
    v_mfma_f32_16x16x32_bf16 v[44:47], v[164:167], a[152:155], v[44:47]
    v_cndmask_b32 v170, v150, v170, vcc
    v_mfma_f32_16x16x32_bf16 v[44:47], v[144:147], a[156:159], v[44:47]
    v_cndmask_b32 v171, v151, v171, vcc
    v_mfma_f32_16x16x32_bf16 v[40:43], v[212:215], a[132:135], v[40:43]
    v_mfma_f32_16x16x32_bf16 v[40:43], v[152:155], a[136:139], v[40:43]
    v_mfma_f32_16x16x32_bf16 v[40:43], v[156:159], a[140:143], v[40:43]
    buffer_load_dwordx4 v[220:223], v247, s[44:47], s26 offen offset:0 sc1
    v_mfma_f32_16x16x32_bf16 v[40:43], v[160:163], a[144:147], v[40:43]
    v_mfma_f32_16x16x32_bf16 v[40:43], v[164:167], a[148:151], v[40:43]
    v_mfma_f32_16x16x32_bf16 v[40:43], v[144:147], a[152:155], v[40:43]
    v_mfma_f32_16x16x32_bf16 v[40:43], v[168:171], a[156:159], v[40:43]
    s_waitcnt vmcnt(18)
    v_mfma_f32_16x16x32_bf16 a[28:31], v[192:195], a[160:163], a[28:31]
    buffer_load_dwordx4 a[192:195], v1, s[52:55], s25 offen offset:0 sc1
    v_mfma_f32_16x16x32_bf16 a[28:31], v[196:199], a[164:167], a[28:31]
    v_mfma_f32_16x16x32_bf16 a[28:31], v[200:203], a[168:171], a[28:31]
    s_waitcnt vmcnt(17)
    v_mfma_f32_16x16x32_bf16 a[28:31], v[180:183], a[172:175], a[28:31]
    s_waitcnt vmcnt(16)
    v_mfma_f32_16x16x32_bf16 a[60:63], v[180:183], a[176:179], a[60:63]
    s_waitcnt vmcnt(15)
    v_mfma_f32_16x16x32_bf16 a[60:63], v[200:203], a[180:183], a[60:63]
    buffer_load_dwordx4 a[196:199], v1, s[52:55], s25 offen offset:1024 sc1
    s_waitcnt vmcnt(15)
    v_mfma_f32_16x16x32_bf16 a[60:63], v[196:199], a[184:187], a[60:63]
    s_waitcnt vmcnt(14)
    v_mfma_f32_16x16x32_bf16 a[60:63], v[192:195], a[188:191], a[60:63]
    s_waitcnt vmcnt(13)
    v_mfma_f32_16x16x32_bf16 a[60:63], v[204:207], a[160:163], a[60:63]
    s_waitcnt vmcnt(12)
    v_mfma_f32_16x16x32_bf16 a[60:63], v[80:83], a[164:167], a[60:63]
    s_waitcnt vmcnt(11)
    v_mfma_f32_16x16x32_bf16 a[60:63], v[92:95], a[168:171], a[60:63]
    buffer_load_dwordx4 a[200:203], v1, s[52:55], s25 offen offset:2048 sc1
    s_waitcnt vmcnt(11)
    v_mfma_f32_16x16x32_bf16 a[60:63], v[88:91], a[172:175], a[60:63]
    v_mov_b32_dpp v192, v192 row_shr:1 row_mask:0xf bank_mask:0xf
    v_mfma_f32_16x16x32_bf16 a[92:95], v[88:91], a[176:179], a[92:95]
    v_mov_b32_dpp v193, v193 row_shr:1 row_mask:0xf bank_mask:0xf
    v_mfma_f32_16x16x32_bf16 a[92:95], v[92:95], a[180:183], a[92:95]
    v_mov_b32_dpp v194, v194 row_shr:1 row_mask:0xf bank_mask:0xf
    v_mfma_f32_16x16x32_bf16 a[92:95], v[80:83], a[184:187], a[92:95]
    v_mov_b32_dpp v195, v195 row_shr:1 row_mask:0xf bank_mask:0xf
    v_mfma_f32_16x16x32_bf16 a[92:95], v[204:207], a[188:191], a[92:95]
    buffer_load_dwordx4 a[204:207], v1, s[52:55], s64 offen offset:1024 sc1
    v_mfma_f32_16x16x32_bf16 a[24:27], v[196:199], a[160:163], a[24:27]
    v_cndmask_b32_dpp v192, v184, v192, vcc row_shl:5 row_mask:0xf bank_mask:0xf
    v_mfma_f32_16x16x32_bf16 a[24:27], v[200:203], a[164:167], a[24:27]
    v_cndmask_b32_dpp v193, v185, v193, vcc row_shl:5 row_mask:0xf bank_mask:0xf
    v_mfma_f32_16x16x32_bf16 a[24:27], v[180:183], a[168:171], a[24:27]
    s_waitcnt vmcnt(11)
    v_mfma_f32_16x16x32_bf16 a[24:27], v[112:115], a[172:175], a[24:27]
    v_cndmask_b32_dpp v194, v186, v194, vcc row_shl:5 row_mask:0xf bank_mask:0xf
    v_mfma_f32_16x16x32_bf16 a[56:59], v[112:115], a[176:179], a[56:59]
    buffer_load_dwordx4 a[208:211], v1, s[52:55], s64 offen offset:0 sc1
    v_mfma_f32_16x16x32_bf16 a[56:59], v[180:183], a[180:183], a[56:59]
    v_cndmask_b32_dpp v195, v187, v195, vcc row_shl:5 row_mask:0xf bank_mask:0xf
    v_mfma_f32_16x16x32_bf16 a[56:59], v[200:203], a[184:187], a[56:59]
    v_mov_b32_dpp v204, v204 row_shr:1 row_mask:0xf bank_mask:0xf
    v_mfma_f32_16x16x32_bf16 a[56:59], v[196:199], a[188:191], a[56:59]
    v_mov_b32_dpp v205, v205 row_shr:1 row_mask:0xf bank_mask:0xf
    v_mfma_f32_16x16x32_bf16 a[56:59], v[80:83], a[160:163], a[56:59]
    v_mov_b32_dpp v206, v206 row_shr:1 row_mask:0xf bank_mask:0xf
    v_mfma_f32_16x16x32_bf16 a[56:59], v[92:95], a[164:167], a[56:59]
    buffer_load_dwordx4 a[212:215], v1, s[52:55], s26 offen offset:3072 sc1
    v_mfma_f32_16x16x32_bf16 a[56:59], v[88:91], a[168:171], a[56:59]
    s_waitcnt vmcnt(12)
    v_mfma_f32_16x16x32_bf16 a[56:59], v[224:227], a[172:175], a[56:59]
    v_mov_b32_dpp v207, v207 row_shr:1 row_mask:0xf bank_mask:0xf
    v_mfma_f32_16x16x32_bf16 a[88:91], v[224:227], a[176:179], a[88:91]
    v_cndmask_b32_dpp v204, v188, v204, vcc row_shl:5 row_mask:0xf bank_mask:0xf
    v_mfma_f32_16x16x32_bf16 a[88:91], v[88:91], a[180:183], a[88:91]
    v_cndmask_b32_dpp v205, v189, v205, vcc row_shl:5 row_mask:0xf bank_mask:0xf
    v_mfma_f32_16x16x32_bf16 a[88:91], v[92:95], a[184:187], a[88:91]
    buffer_load_dwordx4 v[84:87], v247, s[44:47], s66 offen offset:3072 sc1
    v_mfma_f32_16x16x32_bf16 a[88:91], v[80:83], a[188:191], a[88:91]
    v_cndmask_b32_dpp v206, v190, v206, vcc row_shl:5 row_mask:0xf bank_mask:0xf
    v_mfma_f32_16x16x32_bf16 a[20:23], v[200:203], a[160:163], a[20:23]
    v_cndmask_b32_dpp v207, v191, v207, vcc row_shl:5 row_mask:0xf bank_mask:0xf
    v_mfma_f32_16x16x32_bf16 a[20:23], v[180:183], a[164:167], a[20:23]
    v_mov_b32_dpp v196, v196 row_shr:1 row_mask:0xf bank_mask:0xf
    v_mfma_f32_16x16x32_bf16 a[20:23], v[112:115], a[168:171], a[20:23]
    s_waitcnt vmcnt(12)
    v_mfma_f32_16x16x32_bf16 a[20:23], v[128:131], a[172:175], a[20:23]
    buffer_load_dwordx4 a[216:219], v1, s[52:55], s64 offen offset:2048 sc1
    v_mfma_f32_16x16x32_bf16 a[52:55], v[128:131], a[176:179], a[52:55]
    v_mov_b32_dpp v197, v197 row_shr:1 row_mask:0xf bank_mask:0xf
    v_mfma_f32_16x16x32_bf16 a[52:55], v[112:115], a[180:183], a[52:55]
    v_mov_b32_dpp v198, v198 row_shr:1 row_mask:0xf bank_mask:0xf
    v_mfma_f32_16x16x32_bf16 a[52:55], v[180:183], a[184:187], a[52:55]
    v_mov_b32_dpp v199, v199 row_shr:1 row_mask:0xf bank_mask:0xf
    v_mfma_f32_16x16x32_bf16 a[52:55], v[200:203], a[188:191], a[52:55]
    v_cndmask_b32_dpp v196, v184, v196, vcc row_shl:4 row_mask:0xf bank_mask:0xf
    v_mfma_f32_16x16x32_bf16 a[52:55], v[92:95], a[160:163], a[52:55]
    buffer_load_dwordx4 v[72:75], v247, s[44:47], s66 offen offset:2048 sc1
    v_mfma_f32_16x16x32_bf16 a[52:55], v[88:91], a[164:167], a[52:55]
    v_cndmask_b32_dpp v197, v185, v197, vcc row_shl:4 row_mask:0xf bank_mask:0xf
    v_mfma_f32_16x16x32_bf16 a[52:55], v[224:227], a[168:171], a[52:55]
    s_waitcnt vmcnt(13)
    v_mfma_f32_16x16x32_bf16 a[52:55], v[132:135], a[172:175], a[52:55]
    v_cndmask_b32_dpp v198, v186, v198, vcc row_shl:4 row_mask:0xf bank_mask:0xf
    v_mfma_f32_16x16x32_bf16 a[84:87], v[132:135], a[176:179], a[84:87]
    v_cndmask_b32_dpp v199, v187, v199, vcc row_shl:4 row_mask:0xf bank_mask:0xf
    v_mfma_f32_16x16x32_bf16 a[84:87], v[224:227], a[180:183], a[84:87]
    buffer_load_dwordx4 a[220:223], v1, s[52:55], s64 offen offset:3072 sc1
    v_mfma_f32_16x16x32_bf16 a[84:87], v[88:91], a[184:187], a[84:87]
    v_mov_b32_dpp v80, v80 row_shr:1 row_mask:0xf bank_mask:0xf
    v_mfma_f32_16x16x32_bf16 a[84:87], v[92:95], a[188:191], a[84:87]
    v_mov_b32_dpp v81, v81 row_shr:1 row_mask:0xf bank_mask:0xf
    v_mfma_f32_16x16x32_bf16 a[16:19], v[180:183], a[160:163], a[16:19]
    v_mov_b32_dpp v82, v82 row_shr:1 row_mask:0xf bank_mask:0xf
    v_mfma_f32_16x16x32_bf16 a[16:19], v[112:115], a[164:167], a[16:19]
    v_mov_b32_dpp v83, v83 row_shr:1 row_mask:0xf bank_mask:0xf
    v_mfma_f32_16x16x32_bf16 a[16:19], v[128:131], a[168:171], a[16:19]
    buffer_load_dwordx4 v[136:139], v247, s[44:47], s66 offen offset:1024 sc1
    s_waitcnt vmcnt(14)
    v_mfma_f32_16x16x32_bf16 a[16:19], v[216:219], a[172:175], a[16:19]
    v_cndmask_b32_dpp v80, v188, v80, vcc row_shl:4 row_mask:0xf bank_mask:0xf
    v_mfma_f32_16x16x32_bf16 a[48:51], v[216:219], a[176:179], a[48:51]
    v_cndmask_b32_dpp v81, v189, v81, vcc row_shl:4 row_mask:0xf bank_mask:0xf
    v_mfma_f32_16x16x32_bf16 a[48:51], v[128:131], a[180:183], a[48:51]
    v_cndmask_b32_dpp v82, v190, v82, vcc row_shl:4 row_mask:0xf bank_mask:0xf
    v_mfma_f32_16x16x32_bf16 a[48:51], v[112:115], a[184:187], a[48:51]
    v_cndmask_b32_dpp v83, v191, v83, vcc row_shl:4 row_mask:0xf bank_mask:0xf
    v_mfma_f32_16x16x32_bf16 a[48:51], v[180:183], a[188:191], a[48:51]
    buffer_load_dwordx4 a[224:227], v1, s[52:55], s65 offen offset:0 sc1
    v_mfma_f32_16x16x32_bf16 a[48:51], v[88:91], a[160:163], a[48:51]
    v_mov_b32_dpp v200, v200 row_shr:1 row_mask:0xf bank_mask:0xf
    v_mfma_f32_16x16x32_bf16 a[48:51], v[224:227], a[164:167], a[48:51]
    v_mov_b32_dpp v201, v201 row_shr:1 row_mask:0xf bank_mask:0xf
    v_mfma_f32_16x16x32_bf16 a[48:51], v[132:135], a[168:171], a[48:51]
    s_waitcnt vmcnt(14)
    v_mfma_f32_16x16x32_bf16 a[48:51], v[76:79], a[172:175], a[48:51]
    v_mov_b32_dpp v202, v202 row_shr:1 row_mask:0xf bank_mask:0xf
    v_mfma_f32_16x16x32_bf16 a[80:83], v[76:79], a[176:179], a[80:83]
    buffer_load_dwordx4 v[172:175], v247, s[44:47], s66 offen offset:0 sc1
    v_mfma_f32_16x16x32_bf16 a[80:83], v[132:135], a[180:183], a[80:83]
    v_mov_b32_dpp v203, v203 row_shr:1 row_mask:0xf bank_mask:0xf
    v_mfma_f32_16x16x32_bf16 a[80:83], v[224:227], a[184:187], a[80:83]
    v_cndmask_b32_dpp v200, v184, v200, vcc row_shl:3 row_mask:0xf bank_mask:0xf
    v_mfma_f32_16x16x32_bf16 a[80:83], v[88:91], a[188:191], a[80:83]
    v_cndmask_b32_dpp v201, v185, v201, vcc row_shl:3 row_mask:0xf bank_mask:0xf
    v_mfma_f32_16x16x32_bf16 a[12:15], v[112:115], a[160:163], a[12:15]
    v_cndmask_b32_dpp v202, v186, v202, vcc row_shl:3 row_mask:0xf bank_mask:0xf
    v_mfma_f32_16x16x32_bf16 a[12:15], v[128:131], a[164:167], a[12:15]
    buffer_load_dwordx4 a[228:231], v1, s[52:55], s65 offen offset:1024 sc1
    v_mfma_f32_16x16x32_bf16 a[12:15], v[216:219], a[168:171], a[12:15]
    s_waitcnt vmcnt(15)
    v_mfma_f32_16x16x32_bf16 a[12:15], v[140:143], a[172:175], a[12:15]
    v_cndmask_b32_dpp v203, v187, v203, vcc row_shl:3 row_mask:0xf bank_mask:0xf
    v_mov_b32_dpp v92, v92 row_shr:1 row_mask:0xf bank_mask:0xf
    v_mfma_f32_16x16x32_bf16 a[44:47], v[140:143], a[176:179], a[44:47]
    v_mov_b32_dpp v93, v93 row_shr:1 row_mask:0xf bank_mask:0xf
    v_mov_b32_dpp v94, v94 row_shr:1 row_mask:0xf bank_mask:0xf
    v_mfma_f32_16x16x32_bf16 a[44:47], v[216:219], a[180:183], a[44:47]
    v_mov_b32_dpp v95, v95 row_shr:1 row_mask:0xf bank_mask:0xf
    v_cndmask_b32_dpp v92, v188, v92, vcc row_shl:3 row_mask:0xf bank_mask:0xf
    v_mfma_f32_16x16x32_bf16 a[44:47], v[128:131], a[184:187], a[44:47]
    buffer_load_dwordx4 v[176:179], v247, s[44:47], s65 offen offset:3072 sc1
    v_cndmask_b32_dpp v93, v189, v93, vcc row_shl:3 row_mask:0xf bank_mask:0xf
    v_mfma_f32_16x16x32_bf16 a[44:47], v[112:115], a[188:191], a[44:47]
    v_cndmask_b32_dpp v94, v190, v94, vcc row_shl:3 row_mask:0xf bank_mask:0xf
    v_cndmask_b32_dpp v95, v191, v95, vcc row_shl:3 row_mask:0xf bank_mask:0xf
    v_mfma_f32_16x16x32_bf16 a[44:47], v[224:227], a[160:163], a[44:47]
    v_mov_b32_dpp v180, v180 row_shr:1 row_mask:0xf bank_mask:0xf
    v_mov_b32_dpp v181, v181 row_shr:1 row_mask:0xf bank_mask:0xf
    v_mfma_f32_16x16x32_bf16 a[44:47], v[132:135], a[164:167], a[44:47]
    v_mov_b32_dpp v182, v182 row_shr:1 row_mask:0xf bank_mask:0xf
    v_mov_b32_dpp v183, v183 row_shr:1 row_mask:0xf bank_mask:0xf
    v_mfma_f32_16x16x32_bf16 a[44:47], v[76:79], a[168:171], a[44:47]
    v_cndmask_b32_dpp v180, v184, v180, vcc row_shl:2 row_mask:0xf bank_mask:0xf
    s_waitcnt vmcnt(15)
    v_mfma_f32_16x16x32_bf16 a[44:47], v[220:223], a[172:175], a[44:47]
    buffer_load_dwordx4 a[232:235], v1, s[52:55], s65 offen offset:2048 sc1
    v_cndmask_b32_dpp v181, v185, v181, vcc row_shl:2 row_mask:0xf bank_mask:0xf
    v_mfma_f32_16x16x32_bf16 a[76:79], v[220:223], a[176:179], a[76:79]
    v_cndmask_b32_dpp v182, v186, v182, vcc row_shl:2 row_mask:0xf bank_mask:0xf
    v_cndmask_b32_dpp v183, v187, v183, vcc row_shl:2 row_mask:0xf bank_mask:0xf
    v_mfma_f32_16x16x32_bf16 a[76:79], v[76:79], a[180:183], a[76:79]
    v_mov_b32_dpp v88, v88 row_shr:1 row_mask:0xf bank_mask:0xf
    v_mov_b32_dpp v89, v89 row_shr:1 row_mask:0xf bank_mask:0xf
    v_mfma_f32_16x16x32_bf16 a[76:79], v[132:135], a[184:187], a[76:79]
    v_mov_b32_dpp v90, v90 row_shr:1 row_mask:0xf bank_mask:0xf
    v_mov_b32_dpp v91, v91 row_shr:1 row_mask:0xf bank_mask:0xf
    v_mfma_f32_16x16x32_bf16 a[76:79], v[224:227], a[188:191], a[76:79]
    v_cndmask_b32_dpp v88, v188, v88, vcc row_shl:2 row_mask:0xf bank_mask:0xf
    v_cndmask_b32_dpp v89, v189, v89, vcc row_shl:2 row_mask:0xf bank_mask:0xf
    v_mfma_f32_16x16x32_bf16 a[8:11], v[128:131], a[160:163], a[8:11]
    buffer_load_dwordx4 a[236:239], v251, s[60:63], s66 offen offset:3072 sc1
    v_cndmask_b32_dpp v90, v190, v90, vcc row_shl:2 row_mask:0xf bank_mask:0xf
    v_mfma_f32_16x16x32_bf16 a[8:11], v[216:219], a[164:167], a[8:11]
    v_cndmask_b32_dpp v91, v191, v91, vcc row_shl:2 row_mask:0xf bank_mask:0xf
    v_mfma_f32_16x16x32_bf16 a[8:11], v[140:143], a[168:171], a[8:11]
    v_mfma_f32_16x16x32_bf16 a[8:11], v[192:195], a[172:175], a[8:11]
    v_mfma_f32_16x16x32_bf16 a[40:43], v[192:195], a[176:179], a[40:43]
    v_mfma_f32_16x16x32_bf16 a[40:43], v[140:143], a[180:183], a[40:43]
    buffer_load_dwordx4 v[104:107], v247, s[44:47], s65 offen offset:2048 sc1
    v_mfma_f32_16x16x32_bf16 a[40:43], v[216:219], a[184:187], a[40:43]
    v_mfma_f32_16x16x32_bf16 a[40:43], v[128:131], a[188:191], a[40:43]
    v_mfma_f32_16x16x32_bf16 a[40:43], v[132:135], a[160:163], a[40:43]
    v_mfma_f32_16x16x32_bf16 a[40:43], v[76:79], a[164:167], a[40:43]
    v_mfma_f32_16x16x32_bf16 a[40:43], v[220:223], a[168:171], a[40:43]
    buffer_load_dwordx4 a[240:243], v1, s[52:55], s65 offen offset:3072 sc1
    v_mfma_f32_16x16x32_bf16 a[40:43], v[204:207], a[172:175], a[40:43]
    v_mfma_f32_16x16x32_bf16 a[72:75], v[204:207], a[176:179], a[72:75]
    v_mfma_f32_16x16x32_bf16 a[72:75], v[220:223], a[180:183], a[72:75]
    v_mfma_f32_16x16x32_bf16 a[72:75], v[76:79], a[184:187], a[72:75]
    v_mfma_f32_16x16x32_bf16 a[72:75], v[132:135], a[188:191], a[72:75]
    buffer_load_dwordx4 a[244:247], v251, s[60:63], s68 offen offset:3072 sc1
    v_mfma_f32_16x16x32_bf16 a[4:7], v[216:219], a[160:163], a[4:7]
    v_mfma_f32_16x16x32_bf16 a[4:7], v[140:143], a[164:167], a[4:7]
    v_mfma_f32_16x16x32_bf16 a[4:7], v[192:195], a[168:171], a[4:7]
    v_mfma_f32_16x16x32_bf16 a[4:7], v[196:199], a[172:175], a[4:7]
    v_mfma_f32_16x16x32_bf16 a[36:39], v[196:199], a[176:179], a[36:39]
    buffer_load_dwordx4 v[96:99], v247, s[44:47], s65 offen offset:1024 sc1
    v_mfma_f32_16x16x32_bf16 a[36:39], v[192:195], a[180:183], a[36:39]
    v_mfma_f32_16x16x32_bf16 a[36:39], v[140:143], a[184:187], a[36:39]
    v_mfma_f32_16x16x32_bf16 a[36:39], v[216:219], a[188:191], a[36:39]
    v_mfma_f32_16x16x32_bf16 a[36:39], v[76:79], a[160:163], a[36:39]
    v_mfma_f32_16x16x32_bf16 a[36:39], v[220:223], a[164:167], a[36:39]
    buffer_load_dwordx4 a[248:251], v1, s[52:55], s66 offen offset:0 sc1
    v_mfma_f32_16x16x32_bf16 a[36:39], v[204:207], a[168:171], a[36:39]
    v_mfma_f32_16x16x32_bf16 a[36:39], v[80:83], a[172:175], a[36:39]
    v_mfma_f32_16x16x32_bf16 a[68:71], v[80:83], a[176:179], a[68:71]
    v_mfma_f32_16x16x32_bf16 a[68:71], v[204:207], a[180:183], a[68:71]
    v_mfma_f32_16x16x32_bf16 a[68:71], v[220:223], a[184:187], a[68:71]
    buffer_load_dwordx4 v[116:119], v247, s[44:47], s67 offen offset:1024 sc1
    v_mfma_f32_16x16x32_bf16 a[68:71], v[76:79], a[188:191], a[68:71]
    v_mfma_f32_16x16x32_bf16 a[0:3], v[140:143], a[160:163], a[0:3]
    v_mfma_f32_16x16x32_bf16 a[0:3], v[192:195], a[164:167], a[0:3]
    v_mfma_f32_16x16x32_bf16 a[0:3], v[196:199], a[168:171], a[0:3]
    v_mfma_f32_16x16x32_bf16 a[0:3], v[200:203], a[172:175], a[0:3]
    buffer_load_dwordx4 a[252:255], v1, s[52:55], s67 offen offset:3072 sc1
    v_mfma_f32_16x16x32_bf16 a[32:35], v[200:203], a[176:179], a[32:35]
    v_mfma_f32_16x16x32_bf16 a[32:35], v[196:199], a[180:183], a[32:35]
    v_mfma_f32_16x16x32_bf16 a[32:35], v[192:195], a[184:187], a[32:35]
    v_mfma_f32_16x16x32_bf16 a[32:35], v[140:143], a[188:191], a[32:35]
    v_mfma_f32_16x16x32_bf16 a[32:35], v[220:223], a[160:163], a[32:35]
    buffer_load_dwordx4 v[124:127], v247, s[44:47], s67 offen offset:2048 sc1
    v_mfma_f32_16x16x32_bf16 a[32:35], v[204:207], a[164:167], a[32:35]
    v_mfma_f32_16x16x32_bf16 a[32:35], v[80:83], a[168:171], a[32:35]
    v_mfma_f32_16x16x32_bf16 a[32:35], v[92:95], a[172:175], a[32:35]
    v_mfma_f32_16x16x32_bf16 a[64:67], v[92:95], a[176:179], a[64:67]
    v_mfma_f32_16x16x32_bf16 a[64:67], v[80:83], a[180:183], a[64:67]
    buffer_load_dwordx4 a[100:103], v1, s[52:55], s67 offen offset:2048 sc1
    v_mfma_f32_16x16x32_bf16 a[64:67], v[204:207], a[184:187], a[64:67]
    v_mfma_f32_16x16x32_bf16 a[64:67], v[220:223], a[188:191], a[64:67]
    s_waitcnt vmcnt(18)
    v_mfma_f32_16x16x32_bf16 a[28:31], v[112:115], a[192:195], a[28:31]
    v_mfma_f32_16x16x32_bf16 a[28:31], v[128:131], a[196:199], a[28:31]
    v_mfma_f32_16x16x32_bf16 a[28:31], v[216:219], a[200:203], a[28:31]
    buffer_load_dwordx4 v[108:111], v247, s[44:47], s67 offen offset:3072 sc1
    v_mfma_f32_16x16x32_bf16 a[60:63], v[216:219], a[204:207], a[60:63]
    v_mfma_f32_16x16x32_bf16 a[60:63], v[128:131], a[208:211], a[60:63]
    v_mfma_f32_16x16x32_bf16 a[60:63], v[112:115], a[212:215], a[60:63]
    v_mov_b32_dpp v112, v112 row_shr:1 row_mask:0xf bank_mask:0xf
    v_mov_b32_dpp v113, v113 row_shr:1 row_mask:0xf bank_mask:0xf
    v_mfma_f32_16x16x32_bf16 a[60:63], v[224:227], a[192:195], a[60:63]
    v_mov_b32_dpp v114, v114 row_shr:1 row_mask:0xf bank_mask:0xf
    v_mov_b32_dpp v115, v115 row_shr:1 row_mask:0xf bank_mask:0xf
    v_mfma_f32_16x16x32_bf16 a[60:63], v[132:135], a[196:199], a[60:63]
    buffer_load_dwordx4 a[96:99], v1, s[52:55], s67 offen offset:1024 sc1
    v_cndmask_b32_dpp v112, v184, v112, vcc row_shl:1 row_mask:0xf bank_mask:0xf
    v_mfma_f32_16x16x32_bf16 a[60:63], v[76:79], a[200:203], a[60:63]
    v_cndmask_b32_dpp v113, v185, v113, vcc row_shl:1 row_mask:0xf bank_mask:0xf
    v_cndmask_b32_dpp v114, v186, v114, vcc row_shl:1 row_mask:0xf bank_mask:0xf
    v_mfma_f32_16x16x32_bf16 a[92:95], v[76:79], a[204:207], a[92:95]
    v_cndmask_b32_dpp v115, v187, v115, vcc row_shl:1 row_mask:0xf bank_mask:0xf
    v_mfma_f32_16x16x32_bf16 a[92:95], v[132:135], a[208:211], a[92:95]
    v_mfma_f32_16x16x32_bf16 a[92:95], v[224:227], a[212:215], a[92:95]
    v_mov_b32_dpp v224, v224 row_shr:1 row_mask:0xf bank_mask:0xf
    v_mov_b32_dpp v225, v225 row_shr:1 row_mask:0xf bank_mask:0xf
    v_mfma_f32_16x16x32_bf16 a[24:27], v[128:131], a[192:195], a[24:27]
    buffer_load_dwordx4 v[120:123], v247, s[44:47], s68 offen offset:0 sc1
    v_mov_b32_dpp v226, v226 row_shr:1 row_mask:0xf bank_mask:0xf
    v_mfma_f32_16x16x32_bf16 a[24:27], v[216:219], a[196:199], a[24:27]
    v_mov_b32_dpp v227, v227 row_shr:1 row_mask:0xf bank_mask:0xf
    v_cndmask_b32_dpp v224, v188, v224, vcc row_shl:1 row_mask:0xf bank_mask:0xf
    v_mfma_f32_16x16x32_bf16 a[24:27], v[140:143], a[200:203], a[24:27]
    v_cndmask_b32_dpp v225, v189, v225, vcc row_shl:1 row_mask:0xf bank_mask:0xf
    v_cndmask_b32_dpp v226, v190, v226, vcc row_shl:1 row_mask:0xf bank_mask:0xf
    v_mfma_f32_16x16x32_bf16 a[56:59], v[140:143], a[204:207], a[56:59]
    v_cndmask_b32_dpp v227, v191, v227, vcc row_shl:1 row_mask:0xf bank_mask:0xf
    v_mfma_f32_16x16x32_bf16 a[56:59], v[216:219], a[208:211], a[56:59]
    v_accvgpr_read_b32 v228, a28
    v_accvgpr_read_b32 v229, a60
    v_mfma_f32_16x16x32_bf16 a[56:59], v[128:131], a[212:215], a[56:59]
    buffer_load_dwordx4 a[108:111], v1, s[52:55], s67 offen offset:0 sc1
    v_mov_b32_dpp v128, v128 row_shr:1 row_mask:0xf bank_mask:0xf
    v_mfma_f32_16x16x32_bf16 a[56:59], v[132:135], a[192:195], a[56:59]
    v_mov_b32_dpp v129, v129 row_shr:1 row_mask:0xf bank_mask:0xf
    v_mov_b32_dpp v130, v130 row_shr:1 row_mask:0xf bank_mask:0xf
    v_mfma_f32_16x16x32_bf16 a[56:59], v[76:79], a[196:199], a[56:59]
    v_mov_b32_dpp v131, v131 row_shr:1 row_mask:0xf bank_mask:0xf
    v_cndmask_b32 v128, v184, v128, vcc
    v_mfma_f32_16x16x32_bf16 a[56:59], v[220:223], a[200:203], a[56:59]
    v_cndmask_b32 v129, v185, v129, vcc
    v_cndmask_b32 v130, v186, v130, vcc
    v_mfma_f32_16x16x32_bf16 a[88:91], v[220:223], a[204:207], a[88:91]
    v_cndmask_b32 v131, v187, v131, vcc
    v_accvgpr_read_b32 v230, a92
    v_mfma_f32_16x16x32_bf16 a[88:91], v[76:79], a[208:211], a[88:91]
    buffer_load_dwordx4 v[100:103], v247, s[44:47], s68 offen offset:1024 sc1
    v_accvgpr_read_b32 v232, a29
    v_mfma_f32_16x16x32_bf16 a[88:91], v[132:135], a[212:215], a[88:91]
    v_mov_b32_dpp v132, v132 row_shr:1 row_mask:0xf bank_mask:0xf
    v_mov_b32_dpp v133, v133 row_shr:1 row_mask:0xf bank_mask:0xf
    v_mfma_f32_16x16x32_bf16 a[20:23], v[216:219], a[192:195], a[20:23]
    v_mov_b32_dpp v134, v134 row_shr:1 row_mask:0xf bank_mask:0xf
    v_mov_b32_dpp v135, v135 row_shr:1 row_mask:0xf bank_mask:0xf
    v_mfma_f32_16x16x32_bf16 a[20:23], v[140:143], a[196:199], a[20:23]
    v_cndmask_b32 v132, v188, v132, vcc
    v_cndmask_b32 v133, v189, v133, vcc
    v_mfma_f32_16x16x32_bf16 a[20:23], v[192:195], a[200:203], a[20:23]
    v_cndmask_b32 v134, v190, v134, vcc
    v_cndmask_b32 v135, v191, v135, vcc
    v_mfma_f32_16x16x32_bf16 a[52:55], v[192:195], a[204:207], a[52:55]
    buffer_load_dwordx4 a[104:107], v1, s[52:55], s66 offen offset:3072 sc1
    v_accvgpr_read_b32 v233, a61
    v_mfma_f32_16x16x32_bf16 a[52:55], v[140:143], a[208:211], a[52:55]
    v_accvgpr_read_b32 v234, a93
    v_cvt_pk_bf16_f32 v228, v228, v229
    v_mfma_f32_16x16x32_bf16 a[52:55], v[216:219], a[212:215], a[52:55]
    v_cvt_pk_bf16_f32 v229, v230, 0
    v_accvgpr_read_b32 v236, a30
    v_mfma_f32_16x16x32_bf16 a[52:55], v[76:79], a[192:195], a[52:55]
    v_accvgpr_read_b32 v237, a62
    v_accvgpr_read_b32 v238, a94
    v_mfma_f32_16x16x32_bf16 a[52:55], v[220:223], a[196:199], a[52:55]
    ds_write_b64 v244, v[228:229] offset:28672
    v_cvt_pk_bf16_f32 v232, v232, v233
    v_mfma_f32_16x16x32_bf16 a[52:55], v[204:207], a[200:203], a[52:55]
    buffer_load_dwordx4 v[208:211], v247, s[44:47], s68 offen offset:2048 sc1
    v_cvt_pk_bf16_f32 v233, v234, 0
    v_mfma_f32_16x16x32_bf16 a[84:87], v[204:207], a[204:207], a[84:87]
    v_accvgpr_read_b32 v240, a31
    v_accvgpr_read_b32 v241, a63
    v_mfma_f32_16x16x32_bf16 a[84:87], v[220:223], a[208:211], a[84:87]
    v_accvgpr_read_b32 v242, a95
    ds_write_b64 v244, v[232:233] offset:28928
    v_mfma_f32_16x16x32_bf16 a[84:87], v[76:79], a[212:215], a[84:87]
    v_cvt_pk_bf16_f32 v236, v236, v237
    v_cvt_pk_bf16_f32 v237, v238, 0
    v_mfma_f32_16x16x32_bf16 a[16:19], v[140:143], a[192:195], a[16:19]
    v_cvt_pk_bf16_f32 v240, v240, v241
    v_cvt_pk_bf16_f32 v241, v242, 0
    v_mfma_f32_16x16x32_bf16 a[16:19], v[192:195], a[196:199], a[16:19]
    buffer_load_dwordx4 a[116:119], v1, s[52:55], s66 offen offset:2048 sc1
    ds_write_b64 v244, v[236:237] offset:29184
    v_mfma_f32_16x16x32_bf16 a[16:19], v[196:199], a[200:203], a[16:19]
    ds_write_b64 v244, v[240:241] offset:29440
    v_accvgpr_read_b32 v228, a24
    v_mfma_f32_16x16x32_bf16 a[48:51], v[196:199], a[204:207], a[48:51]
    v_accvgpr_read_b32 v229, a56
    v_accvgpr_read_b32 v230, a88
    v_mfma_f32_16x16x32_bf16 a[48:51], v[192:195], a[208:211], a[48:51]
    v_accvgpr_read_b32 v232, a25
    v_accvgpr_read_b32 v233, a57
    v_mfma_f32_16x16x32_bf16 a[48:51], v[140:143], a[212:215], a[48:51]
    v_accvgpr_read_b32 v234, a89
    v_cvt_pk_bf16_f32 v228, v228, v229
    v_mfma_f32_16x16x32_bf16 a[48:51], v[220:223], a[192:195], a[48:51]
    buffer_load_dwordx4 v[212:215], v247, s[44:47], s68 offen offset:3072 sc1
    v_cvt_pk_bf16_f32 v229, v230, 0
    v_mfma_f32_16x16x32_bf16 a[48:51], v[204:207], a[196:199], a[48:51]
    v_accvgpr_read_b32 v236, a26
    v_accvgpr_read_b32 v237, a58
    v_mfma_f32_16x16x32_bf16 a[48:51], v[80:83], a[200:203], a[48:51]
    v_accvgpr_read_b32 v238, a90
    ds_write_b64 v244, v[228:229] offset:24576
    v_mfma_f32_16x16x32_bf16 a[80:83], v[80:83], a[204:207], a[80:83]
    v_cvt_pk_bf16_f32 v232, v232, v233
    v_cvt_pk_bf16_f32 v233, v234, 0
    v_mfma_f32_16x16x32_bf16 a[80:83], v[204:207], a[208:211], a[80:83]
    v_accvgpr_read_b32 v240, a27
    v_accvgpr_read_b32 v241, a59
    v_mfma_f32_16x16x32_bf16 a[80:83], v[220:223], a[212:215], a[80:83]
    buffer_load_dwordx4 a[112:115], v1, s[52:55], s66 offen offset:1024 sc1
    v_accvgpr_read_b32 v242, a91
    v_mfma_f32_16x16x32_bf16 a[12:15], v[192:195], a[192:195], a[12:15]
    ds_write_b64 v244, v[232:233] offset:24832
    v_cvt_pk_bf16_f32 v236, v236, v237
    v_mfma_f32_16x16x32_bf16 a[12:15], v[196:199], a[196:199], a[12:15]
    v_cvt_pk_bf16_f32 v237, v238, 0
    v_cvt_pk_bf16_f32 v240, v240, v241
    v_mfma_f32_16x16x32_bf16 a[12:15], v[200:203], a[200:203], a[12:15]
    v_cvt_pk_bf16_f32 v241, v242, 0
    ds_write_b64 v244, v[236:237] offset:25088
    v_mfma_f32_16x16x32_bf16 a[44:47], v[200:203], a[204:207], a[44:47]
    ds_write_b64 v244, v[240:241] offset:25344
    v_accvgpr_read_b32 v228, a20
    v_mfma_f32_16x16x32_bf16 a[44:47], v[196:199], a[208:211], a[44:47]
    buffer_load_dwordx4 a[124:127], v251, s[60:63], s66 offen offset:2048 sc1
    v_accvgpr_read_b32 v229, a52
    v_mfma_f32_16x16x32_bf16 a[44:47], v[192:195], a[212:215], a[44:47]
    v_accvgpr_read_b32 v230, a84
    v_accvgpr_read_b32 v232, a21
    v_mfma_f32_16x16x32_bf16 a[44:47], v[204:207], a[192:195], a[44:47]
    v_accvgpr_read_b32 v233, a53
    v_accvgpr_read_b32 v234, a85
    v_mfma_f32_16x16x32_bf16 a[44:47], v[80:83], a[196:199], a[44:47]
    v_cvt_pk_bf16_f32 v228, v228, v229
    v_cvt_pk_bf16_f32 v229, v230, 0
    v_mfma_f32_16x16x32_bf16 a[44:47], v[92:95], a[200:203], a[44:47]
    v_accvgpr_read_b32 v236, a22
    v_accvgpr_read_b32 v237, a54
    v_mfma_f32_16x16x32_bf16 a[76:79], v[92:95], a[204:207], a[76:79]
    buffer_load_dwordx4 a[120:123], v251, s[60:63], s68 offen offset:2048 sc1
    v_accvgpr_read_b32 v238, a86
    v_mfma_f32_16x16x32_bf16 a[76:79], v[80:83], a[208:211], a[76:79]
    ds_write_b64 v244, v[228:229] offset:20480
    v_cvt_pk_bf16_f32 v232, v232, v233
    v_mfma_f32_16x16x32_bf16 a[76:79], v[204:207], a[212:215], a[76:79]
    v_cvt_pk_bf16_f32 v233, v234, 0
    v_accvgpr_read_b32 v240, a23
    v_mfma_f32_16x16x32_bf16 a[8:11], v[196:199], a[192:195], a[8:11]
    v_accvgpr_read_b32 v241, a55
    v_accvgpr_read_b32 v242, a87
    v_mfma_f32_16x16x32_bf16 a[8:11], v[200:203], a[196:199], a[8:11]
    ds_write_b64 v244, v[232:233] offset:20736
    v_cvt_pk_bf16_f32 v236, v236, v237
    v_mfma_f32_16x16x32_bf16 a[8:11], v[180:183], a[200:203], a[8:11]
    buffer_load_dwordx4 v[152:155], v247, s[44:47], s65 offen offset:0 sc1
    v_cvt_pk_bf16_f32 v237, v238, 0
    v_mfma_f32_16x16x32_bf16 a[40:43], v[180:183], a[204:207], a[40:43]
    v_cvt_pk_bf16_f32 v240, v240, v241
    v_cvt_pk_bf16_f32 v241, v242, 0
    v_mfma_f32_16x16x32_bf16 a[40:43], v[200:203], a[208:211], a[40:43]
    ds_write_b64 v244, v[236:237] offset:20992
    ds_write_b64 v244, v[240:241] offset:21248
    v_mfma_f32_16x16x32_bf16 a[40:43], v[196:199], a[212:215], a[40:43]
    v_accvgpr_read_b32 v228, a16
    v_accvgpr_read_b32 v229, a48
    v_mfma_f32_16x16x32_bf16 a[40:43], v[80:83], a[192:195], a[40:43]
    v_accvgpr_read_b32 v230, a80
    v_accvgpr_read_b32 v232, a17
    v_mfma_f32_16x16x32_bf16 a[40:43], v[92:95], a[196:199], a[40:43]
    buffer_load_dwordx4 v[156:159], v247, s[44:47], s67 offen offset:0 sc1
    v_accvgpr_read_b32 v233, a49
    v_mfma_f32_16x16x32_bf16 a[40:43], v[88:91], a[200:203], a[40:43]
    v_accvgpr_read_b32 v234, a81
    v_cvt_pk_bf16_f32 v228, v228, v229
    v_mfma_f32_16x16x32_bf16 a[72:75], v[88:91], a[204:207], a[72:75]
    v_cvt_pk_bf16_f32 v229, v230, 0
    v_accvgpr_read_b32 v236, a18
    v_mfma_f32_16x16x32_bf16 a[72:75], v[92:95], a[208:211], a[72:75]
    v_accvgpr_read_b32 v237, a50
    v_accvgpr_read_b32 v238, a82
    v_mfma_f32_16x16x32_bf16 a[72:75], v[80:83], a[212:215], a[72:75]
    ds_write_b64 v244, v[228:229] offset:16384
    v_cvt_pk_bf16_f32 v232, v232, v233
    v_mfma_f32_16x16x32_bf16 a[4:7], v[200:203], a[192:195], a[4:7]
    buffer_load_dwordx4 a[128:131], v251, s[60:63], s66 offen offset:1024 sc1
    v_cvt_pk_bf16_f32 v233, v234, 0
    v_mfma_f32_16x16x32_bf16 a[4:7], v[180:183], a[196:199], a[4:7]
    v_accvgpr_read_b32 v240, a19
    v_accvgpr_read_b32 v241, a51
    v_mfma_f32_16x16x32_bf16 a[4:7], v[112:115], a[200:203], a[4:7]
    v_accvgpr_read_b32 v242, a83
    ds_write_b64 v244, v[232:233] offset:16640
    v_mfma_f32_16x16x32_bf16 a[36:39], v[112:115], a[204:207], a[36:39]
    v_cvt_pk_bf16_f32 v236, v236, v237
    v_cvt_pk_bf16_f32 v237, v238, 0
    v_mfma_f32_16x16x32_bf16 a[36:39], v[180:183], a[208:211], a[36:39]
    v_cvt_pk_bf16_f32 v240, v240, v241
    v_cvt_pk_bf16_f32 v241, v242, 0
    v_mfma_f32_16x16x32_bf16 a[36:39], v[200:203], a[212:215], a[36:39]
    buffer_load_dwordx4 a[132:135], v251, s[60:63], s68 offen offset:1024 sc1
    ds_write_b64 v244, v[236:237] offset:16896
    v_mfma_f32_16x16x32_bf16 a[36:39], v[92:95], a[192:195], a[36:39]
    ds_write_b64 v244, v[240:241] offset:17152
    v_accvgpr_read_b32 v228, a12
    v_mfma_f32_16x16x32_bf16 a[36:39], v[88:91], a[196:199], a[36:39]
    v_accvgpr_read_b32 v229, a44
    v_accvgpr_read_b32 v230, a76
    v_mfma_f32_16x16x32_bf16 a[36:39], v[224:227], a[200:203], a[36:39]
    v_accvgpr_read_b32 v232, a13
    v_accvgpr_read_b32 v233, a45
    v_mfma_f32_16x16x32_bf16 a[68:71], v[224:227], a[204:207], a[68:71]
    v_accvgpr_read_b32 v234, a77
    v_cvt_pk_bf16_f32 v228, v228, v229
    v_mfma_f32_16x16x32_bf16 a[68:71], v[88:91], a[208:211], a[68:71]
    buffer_load_dwordx4 a[136:139], v251, s[60:63], s66 offen offset:0 sc1
    v_cvt_pk_bf16_f32 v229, v230, 0
    v_mfma_f32_16x16x32_bf16 a[68:71], v[92:95], a[212:215], a[68:71]
    v_accvgpr_read_b32 v236, a14
    v_accvgpr_read_b32 v237, a46
    v_mfma_f32_16x16x32_bf16 a[0:3], v[180:183], a[192:195], a[0:3]
    v_accvgpr_read_b32 v238, a78
    ds_write_b64 v244, v[228:229] offset:12288
    v_mfma_f32_16x16x32_bf16 a[0:3], v[112:115], a[196:199], a[0:3]
    v_cvt_pk_bf16_f32 v232, v232, v233
    v_cvt_pk_bf16_f32 v233, v234, 0
    v_mfma_f32_16x16x32_bf16 a[0:3], v[128:131], a[200:203], a[0:3]
    v_accvgpr_read_b32 v240, a15
    v_accvgpr_read_b32 v241, a47
    v_mfma_f32_16x16x32_bf16 a[32:35], v[128:131], a[204:207], a[32:35]
    buffer_load_dwordx4 a[140:143], v251, s[60:63], s68 offen offset:0 sc1
    v_accvgpr_read_b32 v242, a79
    v_mfma_f32_16x16x32_bf16 a[32:35], v[112:115], a[208:211], a[32:35]
    ds_write_b64 v244, v[232:233] offset:12544
    v_cvt_pk_bf16_f32 v236, v236, v237
    v_mfma_f32_16x16x32_bf16 a[32:35], v[180:183], a[212:215], a[32:35]
    v_cvt_pk_bf16_f32 v237, v238, 0
    v_cvt_pk_bf16_f32 v240, v240, v241
    v_mfma_f32_16x16x32_bf16 a[32:35], v[88:91], a[192:195], a[32:35]
    v_cvt_pk_bf16_f32 v241, v242, 0
    ds_write_b64 v244, v[236:237] offset:12800
    v_mfma_f32_16x16x32_bf16 a[32:35], v[224:227], a[196:199], a[32:35]
    ds_write_b64 v244, v[240:241] offset:13056
    v_accvgpr_read_b32 v228, a8
    v_mfma_f32_16x16x32_bf16 a[32:35], v[132:135], a[200:203], a[32:35]
    buffer_load_dwordx4 a[144:147], v251, s[60:63], s65 offen offset:3072 sc1
    v_accvgpr_read_b32 v229, a40
    v_mfma_f32_16x16x32_bf16 a[64:67], v[132:135], a[204:207], a[64:67]
    v_accvgpr_read_b32 v230, a72
    v_accvgpr_read_b32 v232, a9
    v_mfma_f32_16x16x32_bf16 a[64:67], v[224:227], a[208:211], a[64:67]
    v_accvgpr_read_b32 v233, a41
    v_accvgpr_read_b32 v234, a73
    v_mfma_f32_16x16x32_bf16 a[64:67], v[88:91], a[212:215], a[64:67]
    v_cvt_pk_bf16_f32 v228, v228, v229
    v_cvt_pk_bf16_f32 v229, v230, 0
    v_accvgpr_read_b32 v236, a10
    v_mfma_f32_16x16x32_bf16 v[36:39], v[84:87], a[216:219], v[36:39]
    v_accvgpr_read_b32 v237, a42
    v_accvgpr_read_b32 v238, a74
    s_waitcnt vmcnt(18)
    v_mfma_f32_16x16x32_bf16 v[36:39], v[72:75], a[220:223], v[36:39]
    buffer_load_dwordx4 a[148:151], v251, s[60:63], s67 offen offset:3072 sc1
    ds_write_b64 v244, v[228:229] offset:8192
    v_cvt_pk_bf16_f32 v232, v232, v233
    v_mfma_f32_16x16x32_bf16 v[36:39], v[136:139], a[224:227], v[36:39]
    v_cvt_pk_bf16_f32 v233, v234, 0
    v_accvgpr_read_b32 v240, a11
    v_accvgpr_read_b32 v241, a43
    v_mfma_f32_16x16x32_bf16 v[36:39], v[172:175], a[228:231], v[36:39]
    v_accvgpr_read_b32 v242, a75
    ds_write_b64 v244, v[232:233] offset:8448
    v_cvt_pk_bf16_f32 v236, v236, v237
    v_mfma_f32_16x16x32_bf16 v[36:39], v[176:179], a[232:235], v[36:39]
    v_cvt_pk_bf16_f32 v237, v238, 0
    v_cvt_pk_bf16_f32 v240, v240, v241
    v_cvt_pk_bf16_f32 v241, v242, 0
    v_mfma_f32_16x16x32_bf16 v[36:39], v[104:107], a[240:243], v[36:39]
    ds_write_b64 v244, v[236:237] offset:8704
    ds_write_b64 v244, v[240:241] offset:8960
    v_accvgpr_read_b32 v228, a4
    v_mfma_f32_16x16x32_bf16 v[36:39], v[96:99], a[248:251], v[36:39]
    buffer_load_dwordx4 a[152:155], v251, s[60:63], s65 offen offset:2048 sc1
    v_accvgpr_read_b32 v229, a36
    v_accvgpr_read_b32 v230, a68
    v_mfma_f32_16x16x32_bf16 v[68:71], v[116:119], a[252:255], v[68:71]
    v_accvgpr_read_b32 v232, a5
    v_accvgpr_read_b32 v233, a37
    v_accvgpr_read_b32 v234, a69
    v_mfma_f32_16x16x32_bf16 v[68:71], v[124:127], a[100:103], v[68:71]
    v_cvt_pk_bf16_f32 v228, v228, v229
    v_cvt_pk_bf16_f32 v229, v230, 0
    s_waitcnt vmcnt(18)
    v_mfma_f32_16x16x32_bf16 v[68:71], v[108:111], a[96:99], v[68:71]
    v_accvgpr_read_b32 v236, a6
    v_accvgpr_read_b32 v237, a38
    s_waitcnt vmcnt(17)
    v_mfma_f32_16x16x32_bf16 v[68:71], v[120:123], a[108:111], v[68:71]
    v_accvgpr_read_b32 v238, a70
    ds_write_b64 v244, v[228:229] offset:4096
    s_waitcnt vmcnt(15)
    v_mfma_f32_16x16x32_bf16 v[68:71], v[100:103], a[104:107], v[68:71]
    buffer_load_dwordx4 a[156:159], v251, s[60:63], s67 offen offset:2048 sc1
    v_cvt_pk_bf16_f32 v232, v232, v233
    s_waitcnt vmcnt(14)
    v_mfma_f32_16x16x32_bf16 v[68:71], v[208:211], a[116:119], v[68:71]
    v_cvt_pk_bf16_f32 v233, v234, 0
    v_accvgpr_read_b32 v240, a7
    s_waitcnt vmcnt(12)
    v_mfma_f32_16x16x32_bf16 v[68:71], v[212:215], a[112:115], v[68:71]
    v_accvgpr_read_b32 v241, a39
    v_accvgpr_read_b32 v242, a71
    ds_write_b64 v244, v[232:233] offset:4352
    v_mfma_f32_16x16x32_bf16 v[32:35], v[72:75], a[216:219], v[32:35]
    v_cvt_pk_bf16_f32 v236, v236, v237
    v_cvt_pk_bf16_f32 v237, v238, 0
    v_cvt_pk_bf16_f32 v240, v240, v241
    v_mfma_f32_16x16x32_bf16 v[32:35], v[136:139], a[220:223], v[32:35]
    v_cvt_pk_bf16_f32 v241, v242, 0
    ds_write_b64 v244, v[236:237] offset:4608
    ds_write_b64 v244, v[240:241] offset:4864
    v_mfma_f32_16x16x32_bf16 v[32:35], v[172:175], a[224:227], v[32:35]
    v_cvt_pk_bf16_f32 v76, v36, v68
    v_cvt_pk_bf16_f32 v77, v37, v69
    v_cvt_pk_bf16_f32 v78, v38, v70
    v_mfma_f32_16x16x32_bf16 v[32:35], v[176:179], a[228:231], v[32:35]
    v_cvt_pk_bf16_f32 v79, v39, v71
    ds_write_b32 v245, v76 offset:28672
    ds_write_b32 v245, v77 offset:28928
    v_mfma_f32_16x16x32_bf16 v[32:35], v[104:107], a[232:235], v[32:35]
    ds_write_b32 v245, v78 offset:29184
    ds_write_b32 v245, v79 offset:29440
    v_accvgpr_read_b32 v228, a0
    v_mfma_f32_16x16x32_bf16 v[32:35], v[96:99], a[240:243], v[32:35]
    v_accvgpr_read_b32 v229, a32
    v_accvgpr_read_b32 v230, a64
    s_waitcnt vmcnt(9)
    v_mfma_f32_16x16x32_bf16 v[32:35], v[152:155], a[248:251], v[32:35]
    v_accvgpr_read_b32 v232, a1
    v_accvgpr_read_b32 v233, a33
    s_waitcnt vmcnt(8)
    v_mfma_f32_16x16x32_bf16 v[64:67], v[156:159], a[252:255], v[64:67]
    v_accvgpr_read_b32 v234, a65
    v_cvt_pk_bf16_f32 v228, v228, v229
    v_cvt_pk_bf16_f32 v229, v230, 0
    v_mfma_f32_16x16x32_bf16 v[64:67], v[116:119], a[100:103], v[64:67]
    s_waitcnt lgkmcnt(0)
    s_barrier
    ds_read_b128 v[84:87], v246 offset:28672
    ds_read_b128 v[88:91], v246 offset:28928
    v_mfma_f32_16x16x32_bf16 v[64:67], v[124:127], a[96:99], v[64:67]
    ds_read_b128 v[92:95], v246 offset:29184
    ds_read_b128 v[112:115], v246 offset:29440
    v_accvgpr_read_b32 v236, a2
    v_mfma_f32_16x16x32_bf16 v[64:67], v[108:111], a[108:111], v[64:67]
    v_accvgpr_read_b32 v237, a34
    v_accvgpr_read_b32 v238, a66
    ds_write_b64 v244, v[228:229] offset:0
    v_mfma_f32_16x16x32_bf16 v[64:67], v[120:123], a[104:107], v[64:67]
    v_cvt_pk_bf16_f32 v232, v232, v233
    v_cvt_pk_bf16_f32 v233, v234, 0
    v_accvgpr_read_b32 v240, a3
    v_mfma_f32_16x16x32_bf16 v[64:67], v[100:103], a[116:119], v[64:67]
    v_accvgpr_read_b32 v241, a35
    v_accvgpr_read_b32 v242, a67
    ds_write_b64 v244, v[232:233] offset:256
    v_mfma_f32_16x16x32_bf16 v[64:67], v[208:211], a[112:115], v[64:67]
    v_cvt_pk_bf16_f32 v236, v236, v237
    v_cvt_pk_bf16_f32 v237, v238, 0
    v_cvt_pk_bf16_f32 v240, v240, v241
    v_mfma_f32_16x16x32_bf16 v[28:31], v[136:139], a[216:219], v[28:31]
    v_cvt_pk_bf16_f32 v241, v242, 0
    ds_write_b64 v244, v[236:237] offset:512
    ds_write_b64 v244, v[240:241] offset:768
    v_mfma_f32_16x16x32_bf16 v[28:31], v[172:175], a[220:223], v[28:31]
    v_mfma_f32_16x16x32_bf16 v[28:31], v[176:179], a[224:227], v[28:31]
    v_cvt_pk_bf16_f32 v80, v32, v64
    v_cvt_pk_bf16_f32 v81, v33, v65
    v_cvt_pk_bf16_f32 v82, v34, v66
    v_mfma_f32_16x16x32_bf16 v[28:31], v[104:107], a[228:231], v[28:31]
    v_cvt_pk_bf16_f32 v83, v35, v67
    ds_write_b32 v245, v80 offset:24576
    ds_write_b32 v245, v81 offset:24832
    v_mfma_f32_16x16x32_bf16 v[28:31], v[96:99], a[232:235], v[28:31]
    ds_write_b32 v245, v82 offset:25088
    ds_write_b32 v245, v83 offset:25344
    s_waitcnt lgkmcnt(11)
    v_mfma_f32_16x16x32_bf16 v[148:151], v[84:87], v[4:7], 0
    v_mfma_f32_16x16x32_bf16 v[28:31], v[152:155], a[240:243], v[28:31]
    s_waitcnt lgkmcnt(10)
    v_mfma_f32_16x16x32_bf16 v[160:163], v[88:91], v[4:7], 0
    s_waitcnt lgkmcnt(9)
    v_mfma_f32_16x16x32_bf16 v[164:167], v[92:95], v[4:7], 0
    s_waitcnt lgkmcnt(8)
    v_mfma_f32_16x16x32_bf16 v[168:171], v[112:115], v[4:7], 0
    v_mfma_f32_16x16x32_bf16 v[28:31], a[236:239], a[248:251], v[28:31]
    v_mfma_f32_16x16x32_bf16 v[60:63], a[244:247], a[252:255], v[60:63]
    v_mfma_f32_16x16x32_bf16 v[60:63], v[156:159], a[100:103], v[60:63]
    s_waitcnt lgkmcnt(0)
    s_barrier
    ds_read_b128 v[128:131], v246 offset:24576
    ds_read_b128 v[132:135], v246 offset:24832
    v_mfma_f32_16x16x32_bf16 v[60:63], v[116:119], a[96:99], v[60:63]
    ds_read_b128 v[140:143], v246 offset:25088
    ds_read_b128 v[144:147], v246 offset:25344
    v_cvt_pk_bf16_f32 v148, v148, v149
    v_mfma_f32_16x16x32_bf16 v[60:63], v[124:127], a[108:111], v[60:63]
    v_cvt_pk_bf16_f32 v149, v150, v151
    v_cvt_pk_bf16_f32 v164, v164, v165
    v_cvt_pk_bf16_f32 v165, v166, v167
    v_mfma_f32_16x16x32_bf16 v[60:63], v[108:111], a[104:107], v[60:63]
    v_cvt_pk_bf16_f32 v150, v160, v161
    v_cvt_pk_bf16_f32 v151, v162, v163
    v_cvt_pk_bf16_f32 v166, v168, v169
    v_mfma_f32_16x16x32_bf16 v[60:63], v[120:123], a[116:119], v[60:63]
    v_cvt_pk_bf16_f32 v167, v170, v171
    v_permlane16_swap_b32 v148, v150
    v_permlane16_swap_b32 v149, v151
    v_mfma_f32_16x16x32_bf16 v[60:63], v[100:103], a[112:115], v[60:63]
    v_permlane16_swap_b32 v164, v166
    v_permlane16_swap_b32 v165, v167
    s_mov_b32 s33, 301056
    s_mov_b64 exec, s[94:95]
    buffer_store_dwordx4 v[148:151], v249, s[4:7], s33 offen
    buffer_store_dwordx4 v[164:167], v250, s[4:7], s33 offen
    s_mov_b64 exec, -1
    v_mfma_f32_16x16x32_bf16 v[24:27], v[172:175], a[216:219], v[24:27]
    v_mfma_f32_16x16x32_bf16 v[24:27], v[176:179], a[220:223], v[24:27]
    v_mfma_f32_16x16x32_bf16 v[24:27], v[104:107], a[224:227], v[24:27]
    v_cvt_pk_bf16_f32 v76, v28, v60
    v_cvt_pk_bf16_f32 v77, v29, v61
    v_cvt_pk_bf16_f32 v78, v30, v62
    v_mfma_f32_16x16x32_bf16 v[24:27], v[96:99], a[228:231], v[24:27]
    v_cvt_pk_bf16_f32 v79, v31, v63
    ds_write_b32 v245, v76 offset:20480
    ds_write_b32 v245, v77 offset:20736
    v_mfma_f32_16x16x32_bf16 v[24:27], v[152:155], a[232:235], v[24:27]
    ds_write_b32 v245, v78 offset:20992
    ds_write_b32 v245, v79 offset:21248
    s_waitcnt lgkmcnt(7)
    v_mfma_f32_16x16x32_bf16 v[180:183], v[128:131], v[4:7], 0
    v_mfma_f32_16x16x32_bf16 v[24:27], a[236:239], a[240:243], v[24:27]
    s_waitcnt lgkmcnt(6)
    v_mfma_f32_16x16x32_bf16 v[184:187], v[132:135], v[4:7], 0
    s_waitcnt lgkmcnt(5)
    v_mfma_f32_16x16x32_bf16 v[188:191], v[140:143], v[4:7], 0
    s_waitcnt lgkmcnt(4)
    v_mfma_f32_16x16x32_bf16 v[192:195], v[144:147], v[4:7], 0
    v_mfma_f32_16x16x32_bf16 v[24:27], a[124:127], a[248:251], v[24:27]
    v_mfma_f32_16x16x32_bf16 v[56:59], a[120:123], a[252:255], v[56:59]
    v_mfma_f32_16x16x32_bf16 v[56:59], a[244:247], a[100:103], v[56:59]
    s_waitcnt lgkmcnt(0)
    s_barrier
    ds_read_b128 v[84:87], v246 offset:20480
    ds_read_b128 v[88:91], v246 offset:20736
    v_mfma_f32_16x16x32_bf16 v[56:59], v[156:159], a[96:99], v[56:59]
    ds_read_b128 v[92:95], v246 offset:20992
    ds_read_b128 v[112:115], v246 offset:21248
    v_cvt_pk_bf16_f32 v180, v180, v181
    v_mfma_f32_16x16x32_bf16 v[56:59], v[116:119], a[108:111], v[56:59]
    v_cvt_pk_bf16_f32 v181, v182, v183
    v_cvt_pk_bf16_f32 v188, v188, v189
    v_cvt_pk_bf16_f32 v189, v190, v191
    v_mfma_f32_16x16x32_bf16 v[56:59], v[124:127], a[104:107], v[56:59]
    v_cvt_pk_bf16_f32 v182, v184, v185
    v_cvt_pk_bf16_f32 v183, v186, v187
    v_cvt_pk_bf16_f32 v190, v192, v193
    v_mfma_f32_16x16x32_bf16 v[56:59], v[108:111], a[116:119], v[56:59]
    v_cvt_pk_bf16_f32 v191, v194, v195
    v_permlane16_swap_b32 v180, v182
    v_permlane16_swap_b32 v181, v183
    v_mfma_f32_16x16x32_bf16 v[56:59], v[120:123], a[112:115], v[56:59]
    v_permlane16_swap_b32 v188, v190
    v_permlane16_swap_b32 v189, v191
    s_mov_b32 s33, 258048
    s_mov_b64 exec, s[94:95]
    buffer_store_dwordx4 v[180:183], v249, s[4:7], s33 offen
    buffer_store_dwordx4 v[188:191], v250, s[4:7], s33 offen
    s_mov_b64 exec, -1
    v_mfma_f32_16x16x32_bf16 v[20:23], v[176:179], a[216:219], v[20:23]
    v_mfma_f32_16x16x32_bf16 v[20:23], v[104:107], a[220:223], v[20:23]
    v_mfma_f32_16x16x32_bf16 v[20:23], v[96:99], a[224:227], v[20:23]
    v_cvt_pk_bf16_f32 v80, v24, v56
    v_cvt_pk_bf16_f32 v81, v25, v57
    v_cvt_pk_bf16_f32 v82, v26, v58
    v_mfma_f32_16x16x32_bf16 v[20:23], v[152:155], a[228:231], v[20:23]
    v_cvt_pk_bf16_f32 v83, v27, v59
    ds_write_b32 v245, v80 offset:16384
    ds_write_b32 v245, v81 offset:16640
    v_mfma_f32_16x16x32_bf16 v[20:23], a[236:239], a[232:235], v[20:23]
    ds_write_b32 v245, v82 offset:16896
    ds_write_b32 v245, v83 offset:17152
    s_waitcnt lgkmcnt(7)
    v_mfma_f32_16x16x32_bf16 v[148:151], v[84:87], v[4:7], 0
    v_mfma_f32_16x16x32_bf16 v[20:23], a[124:127], a[240:243], v[20:23]
    s_waitcnt lgkmcnt(6)
    v_mfma_f32_16x16x32_bf16 v[160:163], v[88:91], v[4:7], 0
    s_waitcnt lgkmcnt(5)
    v_mfma_f32_16x16x32_bf16 v[164:167], v[92:95], v[4:7], 0
    s_waitcnt vmcnt(11)
    v_mfma_f32_16x16x32_bf16 v[20:23], a[128:131], a[248:251], v[20:23]
    s_waitcnt lgkmcnt(4)
    v_mfma_f32_16x16x32_bf16 v[168:171], v[112:115], v[4:7], 0
    s_waitcnt vmcnt(10)
    v_mfma_f32_16x16x32_bf16 v[52:55], a[132:135], a[252:255], v[52:55]
    v_mfma_f32_16x16x32_bf16 v[52:55], a[120:123], a[100:103], v[52:55]
    s_waitcnt lgkmcnt(0)
    s_barrier
    ds_read_b128 v[128:131], v246 offset:16384
    ds_read_b128 v[132:135], v246 offset:16640
    v_mfma_f32_16x16x32_bf16 v[52:55], a[244:247], a[96:99], v[52:55]
    ds_read_b128 v[140:143], v246 offset:16896
    ds_read_b128 v[144:147], v246 offset:17152
    v_cvt_pk_bf16_f32 v148, v148, v149
    v_mfma_f32_16x16x32_bf16 v[52:55], v[156:159], a[108:111], v[52:55]
    v_cvt_pk_bf16_f32 v149, v150, v151
    v_cvt_pk_bf16_f32 v164, v164, v165
    v_cvt_pk_bf16_f32 v165, v166, v167
    v_mfma_f32_16x16x32_bf16 v[52:55], v[116:119], a[104:107], v[52:55]
    v_cvt_pk_bf16_f32 v150, v160, v161
    v_cvt_pk_bf16_f32 v151, v162, v163
    v_cvt_pk_bf16_f32 v166, v168, v169
    v_mfma_f32_16x16x32_bf16 v[52:55], v[124:127], a[116:119], v[52:55]
    v_cvt_pk_bf16_f32 v167, v170, v171
    v_permlane16_swap_b32 v148, v150
    v_permlane16_swap_b32 v149, v151
    v_mfma_f32_16x16x32_bf16 v[52:55], v[108:111], a[112:115], v[52:55]
    v_permlane16_swap_b32 v164, v166
    v_permlane16_swap_b32 v165, v167
    s_mov_b32 s33, 215040
    s_mov_b64 exec, s[94:95]
    buffer_store_dwordx4 v[148:151], v249, s[4:7], s33 offen
    buffer_store_dwordx4 v[164:167], v250, s[4:7], s33 offen
    s_mov_b64 exec, -1
    v_mfma_f32_16x16x32_bf16 v[16:19], v[104:107], a[216:219], v[16:19]
    v_mfma_f32_16x16x32_bf16 v[16:19], v[96:99], a[220:223], v[16:19]
    v_mfma_f32_16x16x32_bf16 v[16:19], v[152:155], a[224:227], v[16:19]
    v_cvt_pk_bf16_f32 v76, v20, v52
    v_cvt_pk_bf16_f32 v77, v21, v53
    v_cvt_pk_bf16_f32 v78, v22, v54
    v_mfma_f32_16x16x32_bf16 v[16:19], a[236:239], a[228:231], v[16:19]
    v_cvt_pk_bf16_f32 v79, v23, v55
    ds_write_b32 v245, v76 offset:12288
    ds_write_b32 v245, v77 offset:12544
    v_mfma_f32_16x16x32_bf16 v[16:19], a[124:127], a[232:235], v[16:19]
    ds_write_b32 v245, v78 offset:12800
    ds_write_b32 v245, v79 offset:13056
    s_waitcnt lgkmcnt(7)
    v_mfma_f32_16x16x32_bf16 v[180:183], v[128:131], v[4:7], 0
    v_mfma_f32_16x16x32_bf16 v[16:19], a[128:131], a[240:243], v[16:19]
    s_waitcnt lgkmcnt(6)
    v_mfma_f32_16x16x32_bf16 v[184:187], v[132:135], v[4:7], 0
    s_waitcnt lgkmcnt(5)
    v_mfma_f32_16x16x32_bf16 v[188:191], v[140:143], v[4:7], 0
    s_waitcnt vmcnt(11)
    v_mfma_f32_16x16x32_bf16 v[16:19], a[136:139], a[248:251], v[16:19]
    s_waitcnt lgkmcnt(4)
    v_mfma_f32_16x16x32_bf16 v[192:195], v[144:147], v[4:7], 0
    s_waitcnt vmcnt(10)
    v_mfma_f32_16x16x32_bf16 v[48:51], a[140:143], a[252:255], v[48:51]
    v_mfma_f32_16x16x32_bf16 v[48:51], a[132:135], a[100:103], v[48:51]
    s_waitcnt lgkmcnt(0)
    s_barrier
    ds_read_b128 v[84:87], v246 offset:12288
    ds_read_b128 v[88:91], v246 offset:12544
    v_mfma_f32_16x16x32_bf16 v[48:51], a[120:123], a[96:99], v[48:51]
    ds_read_b128 v[92:95], v246 offset:12800
    ds_read_b128 v[112:115], v246 offset:13056
    v_cvt_pk_bf16_f32 v180, v180, v181
    v_mfma_f32_16x16x32_bf16 v[48:51], a[244:247], a[108:111], v[48:51]
    v_cvt_pk_bf16_f32 v181, v182, v183
    v_cvt_pk_bf16_f32 v188, v188, v189
    v_cvt_pk_bf16_f32 v189, v190, v191
    v_mfma_f32_16x16x32_bf16 v[48:51], v[156:159], a[104:107], v[48:51]
    v_cvt_pk_bf16_f32 v182, v184, v185
    v_cvt_pk_bf16_f32 v183, v186, v187
    v_cvt_pk_bf16_f32 v190, v192, v193
    v_mfma_f32_16x16x32_bf16 v[48:51], v[116:119], a[116:119], v[48:51]
    v_cvt_pk_bf16_f32 v191, v194, v195
    v_permlane16_swap_b32 v180, v182
    v_permlane16_swap_b32 v181, v183
    v_mfma_f32_16x16x32_bf16 v[48:51], v[124:127], a[112:115], v[48:51]
    v_permlane16_swap_b32 v188, v190
    v_permlane16_swap_b32 v189, v191
    s_mov_b32 s33, 172032
    s_mov_b64 exec, s[94:95]
    buffer_store_dwordx4 v[180:183], v249, s[4:7], s33 offen
    buffer_store_dwordx4 v[188:191], v250, s[4:7], s33 offen
    s_mov_b64 exec, -1
    v_mfma_f32_16x16x32_bf16 v[12:15], v[96:99], a[216:219], v[12:15]
    v_mfma_f32_16x16x32_bf16 v[12:15], v[152:155], a[220:223], v[12:15]
    v_mfma_f32_16x16x32_bf16 v[12:15], a[236:239], a[224:227], v[12:15]
    v_cvt_pk_bf16_f32 v80, v16, v48
    v_cvt_pk_bf16_f32 v81, v17, v49
    v_cvt_pk_bf16_f32 v82, v18, v50
    v_mfma_f32_16x16x32_bf16 v[12:15], a[124:127], a[228:231], v[12:15]
    v_cvt_pk_bf16_f32 v83, v19, v51
    ds_write_b32 v245, v80 offset:8192
    ds_write_b32 v245, v81 offset:8448
    v_mfma_f32_16x16x32_bf16 v[12:15], a[128:131], a[232:235], v[12:15]
    ds_write_b32 v245, v82 offset:8704
    ds_write_b32 v245, v83 offset:8960
    s_waitcnt lgkmcnt(7)
    v_mfma_f32_16x16x32_bf16 v[148:151], v[84:87], v[4:7], 0
    v_mfma_f32_16x16x32_bf16 v[12:15], a[136:139], a[240:243], v[12:15]
    s_waitcnt lgkmcnt(6)
    v_mfma_f32_16x16x32_bf16 v[160:163], v[88:91], v[4:7], 0
    s_waitcnt lgkmcnt(5)
    v_mfma_f32_16x16x32_bf16 v[164:167], v[92:95], v[4:7], 0
    s_waitcnt vmcnt(11)
    v_mfma_f32_16x16x32_bf16 v[12:15], a[144:147], a[248:251], v[12:15]
    s_waitcnt lgkmcnt(4)
    v_mfma_f32_16x16x32_bf16 v[168:171], v[112:115], v[4:7], 0
    s_waitcnt vmcnt(10)
    v_mfma_f32_16x16x32_bf16 v[44:47], a[148:151], a[252:255], v[44:47]
    v_mfma_f32_16x16x32_bf16 v[44:47], a[140:143], a[100:103], v[44:47]
    s_waitcnt lgkmcnt(0)
    s_barrier
    ds_read_b128 v[128:131], v246 offset:8192
    ds_read_b128 v[132:135], v246 offset:8448
    v_mfma_f32_16x16x32_bf16 v[44:47], a[132:135], a[96:99], v[44:47]
    ds_read_b128 v[140:143], v246 offset:8704
    ds_read_b128 v[144:147], v246 offset:8960
    v_cvt_pk_bf16_f32 v148, v148, v149
    v_mfma_f32_16x16x32_bf16 v[44:47], a[120:123], a[108:111], v[44:47]
    v_cvt_pk_bf16_f32 v149, v150, v151
    v_cvt_pk_bf16_f32 v164, v164, v165
    v_cvt_pk_bf16_f32 v165, v166, v167
    v_mfma_f32_16x16x32_bf16 v[44:47], a[244:247], a[104:107], v[44:47]
    v_cvt_pk_bf16_f32 v150, v160, v161
    v_cvt_pk_bf16_f32 v151, v162, v163
    v_cvt_pk_bf16_f32 v166, v168, v169
    v_mfma_f32_16x16x32_bf16 v[44:47], v[156:159], a[116:119], v[44:47]
    v_cvt_pk_bf16_f32 v167, v170, v171
    v_permlane16_swap_b32 v148, v150
    v_permlane16_swap_b32 v149, v151
    v_mfma_f32_16x16x32_bf16 v[44:47], v[116:119], a[112:115], v[44:47]
    v_permlane16_swap_b32 v164, v166
    v_permlane16_swap_b32 v165, v167
    s_mov_b32 s33, 129024
    s_mov_b64 exec, s[94:95]
    buffer_store_dwordx4 v[148:151], v249, s[4:7], s33 offen
    buffer_store_dwordx4 v[164:167], v250, s[4:7], s33 offen
    s_mov_b64 exec, -1
    v_mfma_f32_16x16x32_bf16 v[8:11], v[152:155], a[216:219], v[8:11]
    v_mfma_f32_16x16x32_bf16 v[8:11], a[236:239], a[220:223], v[8:11]
    v_mfma_f32_16x16x32_bf16 v[8:11], a[124:127], a[224:227], v[8:11]
    v_cvt_pk_bf16_f32 v76, v12, v44
    v_cvt_pk_bf16_f32 v77, v13, v45
    v_cvt_pk_bf16_f32 v78, v14, v46
    v_mfma_f32_16x16x32_bf16 v[8:11], a[128:131], a[228:231], v[8:11]
    v_cvt_pk_bf16_f32 v79, v15, v47
    ds_write_b32 v245, v76 offset:4096
    ds_write_b32 v245, v77 offset:4352
    v_mfma_f32_16x16x32_bf16 v[8:11], a[136:139], a[232:235], v[8:11]
    ds_write_b32 v245, v78 offset:4608
    ds_write_b32 v245, v79 offset:4864
    s_waitcnt lgkmcnt(7)
    v_mfma_f32_16x16x32_bf16 v[180:183], v[128:131], v[4:7], 0
    v_mfma_f32_16x16x32_bf16 v[8:11], a[144:147], a[240:243], v[8:11]
    s_waitcnt lgkmcnt(6)
    v_mfma_f32_16x16x32_bf16 v[184:187], v[132:135], v[4:7], 0
    s_waitcnt lgkmcnt(5)
    v_mfma_f32_16x16x32_bf16 v[188:191], v[140:143], v[4:7], 0
    s_waitcnt vmcnt(10)
    v_mfma_f32_16x16x32_bf16 v[8:11], a[152:155], a[248:251], v[8:11]
    s_waitcnt lgkmcnt(4)
    v_mfma_f32_16x16x32_bf16 v[192:195], v[144:147], v[4:7], 0
    v_mfma_f32_16x16x32_bf16 v[40:43], a[156:159], a[252:255], v[40:43]
    v_mfma_f32_16x16x32_bf16 v[40:43], a[148:151], a[100:103], v[40:43]
    s_waitcnt lgkmcnt(0)
    s_barrier
    ds_read_b128 v[84:87], v246 offset:4096
    ds_read_b128 v[88:91], v246 offset:4352
    v_mfma_f32_16x16x32_bf16 v[40:43], a[140:143], a[96:99], v[40:43]
    ds_read_b128 v[92:95], v246 offset:4608
    ds_read_b128 v[112:115], v246 offset:4864
    v_cvt_pk_bf16_f32 v180, v180, v181
    v_mfma_f32_16x16x32_bf16 v[40:43], a[132:135], a[108:111], v[40:43]
    v_cvt_pk_bf16_f32 v181, v182, v183
    v_cvt_pk_bf16_f32 v188, v188, v189
    v_cvt_pk_bf16_f32 v189, v190, v191
    v_mfma_f32_16x16x32_bf16 v[40:43], a[120:123], a[104:107], v[40:43]
    v_cvt_pk_bf16_f32 v182, v184, v185
    v_cvt_pk_bf16_f32 v183, v186, v187
    v_cvt_pk_bf16_f32 v190, v192, v193
    v_mfma_f32_16x16x32_bf16 v[40:43], a[244:247], a[116:119], v[40:43]
    v_cvt_pk_bf16_f32 v191, v194, v195
    v_permlane16_swap_b32 v180, v182
    v_permlane16_swap_b32 v181, v183
    v_mfma_f32_16x16x32_bf16 v[40:43], v[156:159], a[112:115], v[40:43]
    s_nop 7
    v_cvt_pk_bf16_f32 v80, v8, v40
    v_cvt_pk_bf16_f32 v81, v9, v41
    v_cvt_pk_bf16_f32 v82, v10, v42
    v_cvt_pk_bf16_f32 v83, v11, v43
    ds_write_b32 v245, v80 offset:0
    ds_write_b32 v245, v81 offset:256
    ds_write_b32 v245, v82 offset:512
    ds_write_b32 v245, v83 offset:768
    s_waitcnt lgkmcnt(0)
    s_barrier
    ds_read_b128 v[12:15], v246 offset:0
    ds_read_b128 v[16:19], v246 offset:256
    ds_read_b128 v[20:23], v246 offset:512
    ds_read_b128 v[24:27], v246 offset:768
    v_permlane16_swap_b32 v188, v190
    v_permlane16_swap_b32 v189, v191
    s_mov_b32 s33, 86016
    s_mov_b64 exec, s[94:95]
    buffer_store_dwordx4 v[180:183], v249, s[4:7], s33 offen
    buffer_store_dwordx4 v[188:191], v250, s[4:7], s33 offen
    s_mov_b64 exec, -1
    v_mfma_f32_16x16x32_bf16 v[148:151], v[84:87], v[4:7], 0
    v_mfma_f32_16x16x32_bf16 v[160:163], v[88:91], v[4:7], 0
    v_mfma_f32_16x16x32_bf16 v[164:167], v[92:95], v[4:7], 0
    v_mfma_f32_16x16x32_bf16 v[168:171], v[112:115], v[4:7], 0
    s_nop 4
    v_cvt_pk_bf16_f32 v148, v148, v149
    v_cvt_pk_bf16_f32 v149, v150, v151
    v_cvt_pk_bf16_f32 v164, v164, v165
    v_cvt_pk_bf16_f32 v165, v166, v167
    v_cvt_pk_bf16_f32 v150, v160, v161
    v_cvt_pk_bf16_f32 v151, v162, v163
    v_cvt_pk_bf16_f32 v166, v168, v169
    v_cvt_pk_bf16_f32 v167, v170, v171
    v_permlane16_swap_b32 v148, v150
    v_permlane16_swap_b32 v149, v151
    v_permlane16_swap_b32 v164, v166
    v_permlane16_swap_b32 v165, v167
    s_mov_b32 s33, 43008
    s_mov_b64 exec, s[94:95]
    buffer_store_dwordx4 v[148:151], v249, s[4:7], s33 offen
    buffer_store_dwordx4 v[164:167], v250, s[4:7], s33 offen
    s_mov_b64 exec, -1
    s_waitcnt lgkmcnt(3)
    v_mfma_f32_16x16x32_bf16 v[100:103], v[12:15], v[4:7], 0
    s_waitcnt lgkmcnt(2)
    v_mfma_f32_16x16x32_bf16 v[104:107], v[16:19], v[4:7], 0
    s_waitcnt lgkmcnt(1)
    v_mfma_f32_16x16x32_bf16 v[108:111], v[20:23], v[4:7], 0
    s_waitcnt lgkmcnt(0)
    v_mfma_f32_16x16x32_bf16 v[116:119], v[24:27], v[4:7], 0
    s_nop 1
    v_cvt_pk_bf16_f32 v100, v100, v101
    v_cvt_pk_bf16_f32 v101, v102, v103
    s_nop 1
    v_cvt_pk_bf16_f32 v108, v108, v109
    v_cvt_pk_bf16_f32 v109, v110, v111
    v_cvt_pk_bf16_f32 v102, v104, v105
    v_cvt_pk_bf16_f32 v103, v106, v107
    v_cvt_pk_bf16_f32 v110, v116, v117
    v_cvt_pk_bf16_f32 v111, v118, v119
    v_permlane16_swap_b32 v100, v102
    v_permlane16_swap_b32 v101, v103
    v_permlane16_swap_b32 v108, v110
    v_permlane16_swap_b32 v109, v111
    s_mov_b32 s33, 0
    s_mov_b64 exec, s[94:95]
    buffer_store_dwordx4 v[100:103], v249, s[4:7], s33 offen
    buffer_store_dwordx4 v[108:111], v250, s[4:7], s33 offen
    s_mov_b64 exec, -1
K2_end:
    s_endpgm
FU_idle:
    ds_read_b128 v[72:75], v16 offset:128
    ds_read_b128 v[76:79], v17 offset:896
    ds_read_b128 v[80:83], v18 offset:1664
    ds_read_b128 v[84:87], v19 offset:2432
    ds_read_b128 v[88:91], v16 offset:12480
    ds_read_b128 v[92:95], v17 offset:13248
    ds_read_b128 v[96:99], v18 offset:14016
    ds_read_b128 v[100:103], v19 offset:14784
    s_waitcnt lgkmcnt(0)
    s_add_u32 s33, s88, 65536
    buffer_store_dwordx4 v[72:75], v11, s[84:87], s33 offen sc1
    s_add_u32 s33, s88, 163840
    buffer_store_dwordx4 v[76:79], v11, s[84:87], s33 offen sc1
    s_add_u32 s33, s88, 262144
    buffer_store_dwordx4 v[80:83], v11, s[84:87], s33 offen sc1
    s_add_u32 s33, s88, 360448
    buffer_store_dwordx4 v[84:87], v11, s[84:87], s33 offen sc1
    s_add_u32 s33, s89, 65536
    buffer_store_dwordx4 v[88:91], v11, s[84:87], s33 offen sc1
    s_add_u32 s33, s89, 163840
    buffer_store_dwordx4 v[92:95], v11, s[84:87], s33 offen sc1
    s_add_u32 s33, s89, 262144
    buffer_store_dwordx4 v[96:99], v11, s[84:87], s33 offen sc1
    s_add_u32 s33, s89, 360448
    buffer_store_dwordx4 v[100:103], v11, s[84:87], s33 offen sc1
    s_waitcnt vmcnt(0)
    s_cmp_eq_u32 s80, 3
    s_cselect_b32 s80, 0, s78
    s_cmp_eq_u32 s80, 0
    s_cbranch_scc1 FU_nosig2_80
    s_add_u32 s33, s80, 6144
    v_mov_b32 v12, s33
    v_mov_b32 v13, s82
    s_mov_b64 exec, 1
    global_atomic_swap v12, v13, s[8:9] sc1
    s_mov_b64 exec, -1
FU_nosig2_80:
    s_cmp_eq_u32 s81, 0
    s_cbranch_scc1 FU_nosig2_81
    s_add_u32 s33, s81, 6144
    v_mov_b32 v12, s33
    v_mov_b32 v13, s82
    s_mov_b64 exec, 1
    global_atomic_swap v12, v13, s[8:9] sc1
    s_mov_b64 exec, -1
FU_nosig2_81:
    s_cmp_eq_u32 s78, 0
    s_cbranch_scc1 FU_nosig3_78
    s_add_u32 s33, s78, 20480
    v_mov_b32 v10, s33
    v_mov_b32 v11, s82
    s_mov_b64 exec, 1
    global_atomic_swap v10, v11, s[8:9] sc1
    s_mov_b64 exec, -1
FU_nosig3_78:
    s_cmp_eq_u32 s79, 0
    s_cbranch_scc1 FU_nosig3_79
    s_add_u32 s33, s79, 20480
    v_mov_b32 v10, s33
    v_mov_b32 v11, s82
    s_mov_b64 exec, 1
    global_atomic_swap v10, v11, s[8:9] sc1
    s_mov_b64 exec, -1
FU_nosig3_79:
    s_endpgm
FU_poll0_again:
    s_mov_b32 s34, 0
FU_poll0_loop:
    s_add_u32 s34, s34, 1
    s_cmp_ge_u32 s34, 400000
    s_cbranch_scc1 FU_poll0_ok
    s_sleep 16
    global_load_dword v3, v252, s[8:9] sc1
    global_load_dword v8, v255, s[8:9] sc1
    s_waitcnt vmcnt(0)
    v_cmp_ne_u32 s[72:73], s82, v3
    v_cmp_ne_u32 s[74:75], s82, v8
    s_nop 4
    s_or_b64 s[72:73], s[72:73], s[74:75]
    s_cmp_lg_u64 s[72:73], 0
    s_cbranch_scc1 FU_poll0_loop
    s_branch FU_poll0_ok
FU_poll1_again:
    s_mov_b32 s34, 0
FU_poll1_loop:
    s_add_u32 s34, s34, 1
    s_cmp_ge_u32 s34, 400000
    s_cbranch_scc1 FU_poll1_ok
    s_sleep 16
    v_add_u32 v253, 6144, v252
    global_load_dword v3, v253, s[8:9] sc1
    global_load_dword v253, v255, s[8:9] offset:256 sc1
    s_waitcnt vmcnt(0)
    v_cmp_ne_u32 s[72:73], s82, v3
    v_cmp_ne_u32 s[74:75], s82, v253
    s_nop 4
    s_or_b64 s[72:73], s[72:73], s[74:75]
    s_cmp_lg_u64 s[72:73], 0
    s_cbranch_scc1 FU_poll1_loop
    s_branch FU_poll1_ok
FU_poll2_again:
    s_mov_b32 s34, 0
FU_poll2_loop:
    s_add_u32 s34, s34, 1
    s_cmp_ge_u32 s34, 400000
    s_cbranch_scc1 FU_poll2_ok
    s_sleep 16
    v_add_u32 v254, 20480, v252
    global_load_dword v3, v254, s[8:9] sc1
    global_load_dword v254, v255, s[8:9] offset:512 sc1
    s_waitcnt vmcnt(0)
    v_cmp_ne_u32 s[72:73], s82, v3
    v_cmp_ne_u32 s[74:75], s82, v254
    s_nop 4
    s_or_b64 s[72:73], s[72:73], s[74:75]
    s_cmp_lg_u64 s[72:73], 0
    s_cbranch_scc1 FU_poll2_loop
    s_branch FU_poll2_ok
.p2align 8
FU_bt:
    .long 0x3e3f0000, 0xbeb53dec, 0xbcab0000, 0xbe19be18, 0x00003ea6, 0x0000bf12, 0xbea60000, 0x3f120000
    .long 0x3d9f0000, 0xbe91be10, 0xbe290000, 0x3ecbbdee, 0xbe5b0000, 0x3e25be5b, 0x3e5b0000, 0xbe25be5b
    .long 0xbd9f0000, 0x3e91be10, 0xbe290000, 0x3ecb3dee, 0x3e840000, 0xbea83e37, 0xbe840000, 0x3ea83e37
    .long 0xbe3f0000, 0x3eb53dec, 0xbcab0000, 0xbe193e18, 0x3ebe0000, 0x3dfa3f09, 0xbebe0000, 0xbdfa3f09
    .long 0xbe92beb5, 0x3eae3d8e, 0x3ebf3e19, 0x3e8f3eee, 0x0000be82, 0x0000bd94, 0x3e820000, 0x3d940000
    .long 0x3ec23ea1, 0xbec73c76, 0xbda83ebf, 0xbd98bec6, 0x3ea83e25, 0x3ec03ea8, 0xbea83e25, 0xbec03ea8
    .long 0xbec23ea1, 0x3ec73c76, 0xbda8bebf, 0xbd983ec6, 0xbeb8be69, 0xbe6bbe7e, 0x3eb8be69, 0x3e6bbe7e
    .long 0x3e92beb5, 0xbeae3d8e, 0x3ebfbe19, 0x3e8fbeee, 0xbd163e34, 0xbe23bd59, 0x3d163e34, 0x3e23bd59
    .long 0x3e9f3ee0, 0xbe5cbd12, 0xbeb4bd49, 0xbea3bef0, 0x00003d94, 0x00003e82, 0xbd940000, 0xbe820000
    .long 0x3ea5be2d, 0xbdf13e94, 0x3e5d3eb7, 0xbef2be84, 0x3ea83ec0, 0x3e253ea8, 0xbea83ec0, 0xbe253ea8
    .long 0xbea5be2d, 0x3df13e94, 0x3e5dbeb7, 0xbef23e84, 0xbd59be23, 0x3e34bd16, 0x3d59be23, 0xbe34bd16
    .long 0xbe9f3ee0, 0x3e5cbd12, 0xbeb43d49, 0xbea33ef0, 0xbe7ebe6b, 0xbe69beb8, 0x3e7ebe6b, 0x3e69beb8
    .long 0x3c81bec1, 0x00003e15, 0x3e40bd8a, 0x00003df4, 0x00003f12, 0x0000bea6, 0xbf120000, 0x3ea60000
    .long 0x3c3cbefa, 0x00003e37, 0x3e3abb6b, 0x00003d0c, 0xbe5b3e25, 0x0000be5b, 0x3e5b3e25, 0x0000be5b
    .long 0xbc3cbefa, 0x00003e37, 0x3e3a3b6b, 0x0000bd0c, 0x3f093dfa, 0x00003ebe, 0xbf093dfa, 0x00003ebe
    .long 0xbc81bec1, 0x00003e15, 0x3e403d8a, 0x0000bdf4, 0x3e37bea8, 0x00003e84, 0xbe37bea8, 0x00003e84

FU_gt:
    .long 0xbeb43d37, 0xbec9bf09, 0xbecfbf08, 0x3eb9bcf4, 0x00000000, 0x00000000, 0x00003f80, 0x00000000
    .long 0x3f02bd09, 0xbebb3e93, 0x3e293f09, 0xbec8bee7, 0x3ec23ec2, 0x3ec23ec2, 0xbec23ec2, 0xbec23ec2
    .long 0xbf02bd09, 0x3ebb3e93, 0x3e29bf09, 0xbec83ee7, 0x3f003f39, 0x3e763eb2, 0xbf003f39, 0xbe763eb2
    .long 0x3eb43d37, 0x3ec9bf09, 0xbecf3f08, 0x3eb93cf4, 0x3ded3da4, 0x3e763e2b, 0xbded3da4, 0xbe763e2b
    .long 0x3ebfbc75, 0x00003f09, 0x3ec43f09, 0x00000000, 0x00000000, 0x00003f80, 0x00000000, 0x00000000
    .long 0x3e08bef0, 0x00003f09, 0x3f053e84, 0x00000000, 0x3ec23ec2, 0x00003ec2, 0xbec23ec2, 0x00003ec2
    .long 0xbe08bef0, 0x00003f09, 0x3f05be84, 0x00000000, 0x3ded3e2b, 0x00003da4, 0xbded3e2b, 0x00003da4
    .long 0xbebfbc75, 0x00003f09, 0x3ec4bf09, 0x00000000, 0x3f003eb2, 0x00003f39, 0xbf003eb2, 0x00003f39
    .long 0x3a683852, 0xba673ac0, 0x3a69bab7, 0x39fab85d, 0x00000000, 0x00000000, 0x00000000, 0x00000000
    .long 0x3a10b8f3, 0xba30ba37, 0x3910badd, 0x3a80b913, 0xba77ba77, 0xba77ba77, 0x3a77ba77, 0x3a77ba77
    .long 0xba10b8f3, 0x3a30ba37, 0x39103add, 0x3a803913, 0x3a8f39d9, 0x39d9b9d3, 0xba8f39d9, 0xb9d9b9d3
    .long 0xba683852, 0x3a673ac0, 0x3a693ab7, 0x39fa385d, 0xb91f3754, 0x39d9b96a, 0x391f3754, 0xb9d9b96a
    .long 0xb9d037f2, 0x0000ba26, 0x39ceba5d, 0x00000000, 0x00000000, 0x00000000, 0x00000000, 0x00000000
    .long 0x38f739b5, 0x0000ba26, 0xbaecb9a0, 0x00000000, 0xba77ba77, 0x0000ba77, 0x3a77ba77, 0x0000ba77
    .long 0xb8f739b5, 0x0000ba26, 0xbaec39a0, 0x00000000, 0xb91fb96a, 0x00003754, 0x391fb96a, 0x00003754
    .long 0x39d037f2, 0x0000ba26, 0x39ce3a5d, 0x00000000, 0x3a8fb9d3, 0x000039d9, 0xba8fb9d3, 0x000039d9

.p2align 8
K2_at:
    .long 0x00003f48, 0x0000bf48, 0x00003f40, 0x0000bf40, 0xbf103f0c, 0x0000bf0c, 0xbf3a3e3f, 0x0000be3f
    .long 0xbf48bcb3, 0x00003cb3, 0xbeb9bf28, 0x00003f28, 0xbf08bf13, 0x00003f13, 0x3f0cbf04, 0x00003f04
    .long 0x3d33bf48, 0x00003f48, 0x3f223ece, 0x0000bece, 0x3f17bf03, 0x00003f03, 0xbe6d3f37, 0x0000bf37
    .long 0x3f483d86, 0x0000bd86, 0xbf40bd41, 0x00003d41, 0x3efe3f1b, 0x0000bf1b, 0xbe10bf3d, 0x00003f3d
    .long 0xbdb33f47, 0x0000bf47, 0x3f2ebea4, 0x00003ea4, 0xbf1e3ef6, 0x0000bef6, 0x3ef53f14, 0x0000bf14
    .long 0x00000000, 0x00000000, 0x00000000, 0x00000000, 0x00000000, 0x00000000, 0x00000000, 0x00000000
    .long 0x00000000, 0x00000000, 0x00000000, 0x00000000, 0x00000000, 0x00000000, 0x00000000, 0x00000000
    .long 0x00000000, 0x00000000, 0x00000000, 0x00000000, 0x00000000, 0x00000000, 0x00000000, 0x00000000
    .long 0x00003f40, 0x0000bf40, 0x00003f48, 0x0000bf48, 0xbf3abe3f, 0x00003e3f, 0xbf10bf0c, 0x00003f0c
    .long 0x3eb9bf28, 0x00003f28, 0x3f48bcb3, 0x00003cb3, 0x3f0c3f04, 0x0000bf04, 0xbf083f13, 0x0000bf13
    .long 0xbf223ece, 0x0000bece, 0xbd33bf48, 0x00003f48, 0xbe6dbf37, 0x00003f37, 0x3f173f03, 0x0000bf03
    .long 0x3f40bd41, 0x00003d41, 0xbf483d86, 0x0000bd86, 0xbe103f3d, 0x0000bf3d, 0x3efebf1b, 0x00003f1b
    .long 0xbf2ebea4, 0x00003ea4, 0x3db33f47, 0x0000bf47, 0x3ef5bf14, 0x00003f14, 0xbf1ebef6, 0x00003ef6
    .long 0x00000000, 0x00000000, 0x00000000, 0x00000000, 0x00000000, 0x00000000, 0x00000000, 0x00000000
    .long 0x00000000, 0x00000000, 0x00000000, 0x00000000, 0x00000000, 0x00000000, 0x00000000, 0x00000000
    .long 0x00000000, 0x00000000, 0x00000000, 0x00000000, 0x00000000, 0x00000000, 0x00000000, 0x00000000
    .long 0x00004045, 0x3fb73fb7, 0x3dc33dc3, 0x40254025, 0x00000000, 0xbfb73fb7, 0xbe0d3e0d, 0xbfe53fe5
    .long 0x00000000, 0x3fb73fb7, 0x3e4b3e4b, 0x3f9f3f9f, 0x00000000, 0xbfb73fb7, 0xbe923e92, 0xbf5c3f5c
    .long 0x00000000, 0x3fb73fb7, 0x3ed33ed3, 0x3f183f18, 0x00000000, 0xbfb73fb7, 0xbf183f18, 0xbed33ed3
    .long 0x00000000, 0x3fb73fb7, 0x3f5c3f5c, 0x3e923e92, 0x00000000, 0xbfb73fb7, 0xbf9f3f9f, 0xbe4b3e4b
    .long 0x00000000, 0x3fb73fb7, 0x3fe53fe5, 0x3e0d3e0d, 0x40450000, 0xbfb73fb7, 0xc0254025, 0xbdc33dc3
    .long 0x00000000, 0x00000000, 0x00000000, 0x00000000, 0x00000000, 0x00000000, 0x00000000, 0x00000000
    .long 0x00000000, 0x00000000, 0x00000000, 0x00000000, 0x00000000, 0x00000000, 0x00000000, 0x00000000
    .long 0x00000000, 0x00000000, 0x00000000, 0x00000000, 0x00000000, 0x00000000, 0x00000000, 0x00000000
    .long 0x00000000, 0x00000000, 0x00000000, 0x00000000, 0x00000000, 0x00000000, 0x00000000, 0x00000000
    .long 0x00000000, 0x00000000, 0x00000000, 0x00000000, 0x00000000, 0x00000000, 0x00000000, 0x00000000
    .long 0x00000000, 0x00000000, 0x00000000, 0x00000000, 0x00000000, 0x00000000, 0x00000000, 0x00000000
    .long 0x00000000, 0x00000000, 0x00000000, 0x00000000, 0x00000000, 0x00000000, 0x00000000, 0x00000000
    .long 0x00000000, 0x00000000, 0x00000000, 0x00000000, 0x00000000, 0x00000000, 0x00000000, 0x00000000
    .long 0x00000000, 0x00000000, 0x00000000, 0x00000000, 0x00000000, 0x00000000, 0x00000000, 0x00000000
    .long 0x00000000, 0x00000000, 0x00000000, 0x00000000, 0x00000000, 0x00000000, 0x00000000, 0x00000000
    .long 0x00000000, 0x00000000, 0x00000000, 0x00000000, 0x00000000, 0x00000000, 0x00000000, 0x00000000
    .long 0x00003f48, 0x0000bf48, 0x00003f40, 0x0000bf40, 0xbf103f0c, 0x0000bf0c, 0xbf3a3e3f, 0x0000be3f
    .long 0xbf48bcb3, 0x00003cb3, 0xbeb9bf28, 0x00003f28, 0xbf08bf13, 0x00003f13, 0x3f0cbf04, 0x00003f04
    .long 0x3d33bf48, 0x00003f48, 0x3f223ece, 0x0000bece, 0x3f17bf03, 0x00003f03, 0xbe6d3f37, 0x0000bf37
    .long 0x3f483d86, 0x0000bd86, 0xbf40bd41, 0x00003d41, 0x3efe3f1b, 0x0000bf1b, 0xbe10bf3d, 0x00003f3d
    .long 0xbdb33f47, 0x0000bf47, 0x3f2ebea4, 0x00003ea4, 0xbf1e3ef6, 0x0000bef6, 0x3ef53f14, 0x0000bf14
    .long 0x00000000, 0x00000000, 0x00000000, 0x00000000, 0x00000000, 0x00000000, 0x00000000, 0x00000000
    .long 0x00000000, 0x00000000, 0x00000000, 0x00000000, 0x00000000, 0x00000000, 0x00000000, 0x00000000
    .long 0x00000000, 0x00000000, 0x00000000, 0x00000000, 0x00000000, 0x00000000, 0x00000000, 0x00000000
    .long 0x00003f40, 0x0000bf40, 0x00003f48, 0x0000bf48, 0xbf3abe3f, 0x00003e3f, 0xbf10bf0c, 0x00003f0c
    .long 0x3eb9bf28, 0x00003f28, 0x3f48bcb3, 0x00003cb3, 0x3f0c3f04, 0x0000bf04, 0xbf083f13, 0x0000bf13
    .long 0xbf223ece, 0x0000bece, 0xbd33bf48, 0x00003f48, 0xbe6dbf37, 0x00003f37, 0x3f173f03, 0x0000bf03
    .long 0x3f40bd41, 0x00003d41, 0xbf483d86, 0x0000bd86, 0xbe103f3d, 0x0000bf3d, 0x3efebf1b, 0x00003f1b
    .long 0xbf2ebea4, 0x00003ea4, 0x3db33f47, 0x0000bf47, 0x3ef5bf14, 0x00003f14, 0xbf1ebef6, 0x00003ef6
    .long 0x00000000, 0x00000000, 0x00000000, 0x00000000, 0x00000000, 0x00000000, 0x00000000, 0x00000000
    .long 0x00000000, 0x00000000, 0x00000000, 0x00000000, 0x00000000, 0x00000000, 0x00000000, 0x00000000
    .long 0x00000000, 0x00000000, 0x00000000, 0x00000000, 0x00000000, 0x00000000, 0x00000000, 0x00000000
    .long 0x3fb73fb7, 0x00004045, 0x40254025, 0x3dc33dc3, 0xbfb73fb7, 0x00000000, 0xbfe53fe5, 0xbe0d3e0d
    .long 0x3fb73fb7, 0x00000000, 0x3f9f3f9f, 0x3e4b3e4b, 0xbfb73fb7, 0x00000000, 0xbf5c3f5c, 0xbe923e92
    .long 0x3fb73fb7, 0x00000000, 0x3f183f18, 0x3ed33ed3, 0xbfb73fb7, 0x00000000, 0xbed33ed3, 0xbf183f18
    .long 0x3fb73fb7, 0x00000000, 0x3e923e92, 0x3f5c3f5c, 0xbfb73fb7, 0x00000000, 0xbe4b3e4b, 0xbf9f3f9f
    .long 0x3fb73fb7, 0x00000000, 0x3e0d3e0d, 0x3fe53fe5, 0xbfb73fb7, 0x40450000, 0xbdc33dc3, 0xc0254025
    .long 0x00000000, 0x00000000, 0x00000000, 0x00000000, 0x00000000, 0x00000000, 0x00000000, 0x00000000
    .long 0x00000000, 0x00000000, 0x00000000, 0x00000000, 0x00000000, 0x00000000, 0x00000000, 0x00000000
    .long 0x00000000, 0x00000000, 0x00000000, 0x00000000, 0x00000000, 0x00000000, 0x00000000, 0x00000000
    .long 0x00000000, 0x00000000, 0x00000000, 0x00000000, 0x00000000, 0x00000000, 0x00000000, 0x00000000
    .long 0x00000000, 0x00000000, 0x00000000, 0x00000000, 0x00000000, 0x00000000, 0x00000000, 0x00000000
    .long 0x00000000, 0x00000000, 0x00000000, 0x00000000, 0x00000000, 0x00000000, 0x00000000, 0x00000000
    .long 0x00000000, 0x00000000, 0x00000000, 0x00000000, 0x00000000, 0x00000000, 0x00000000, 0x00000000
    .long 0x00000000, 0x00000000, 0x00000000, 0x00000000, 0x00000000, 0x00000000, 0x00000000, 0x00000000
    .long 0x00000000, 0x00000000, 0x00000000, 0x00000000, 0x00000000, 0x00000000, 0x00000000, 0x00000000
    .long 0x00000000, 0x00000000, 0x00000000, 0x00000000, 0x00000000, 0x00000000, 0x00000000, 0x00000000
    .long 0x00000000, 0x00000000, 0x00000000, 0x00000000, 0x00000000, 0x00000000, 0x00000000, 0x00000000
    .long 0x00003f48, 0x0000bf48, 0x00003f40, 0x0000bf40, 0xbf103f0c, 0x0000bf0c, 0xbf3a3e3f, 0x0000be3f
    .long 0xbf48bcb3, 0x00003cb3, 0xbeb9bf28, 0x00003f28, 0xbf08bf13, 0x00003f13, 0x3f0cbf04, 0x00003f04
    .long 0x3d33bf48, 0x00003f48, 0x3f223ece, 0x0000bece, 0x3f17bf03, 0x00003f03, 0xbe6d3f37, 0x0000bf37
    .long 0x3f483d86, 0x0000bd86, 0xbf40bd41, 0x00003d41, 0x3efe3f1b, 0x0000bf1b, 0xbe10bf3d, 0x00003f3d
    .long 0xbdb33f47, 0x0000bf47, 0x3f2ebea4, 0x00003ea4, 0xbf1e3ef6, 0x0000bef6, 0x3ef53f14, 0x0000bf14
    .long 0x00000000, 0x00000000, 0x00000000, 0x00000000, 0x00000000, 0x00000000, 0x00000000, 0x00000000
    .long 0x00000000, 0x00000000, 0x00000000, 0x00000000, 0x00000000, 0x00000000, 0x00000000, 0x00000000
    .long 0x00000000, 0x00000000, 0x00000000, 0x00000000, 0x00000000, 0x00000000, 0x00000000, 0x00000000
    .long 0x00003f40, 0x0000bf40, 0x00003f48, 0x0000bf48, 0xbf3abe3f, 0x00003e3f, 0xbf10bf0c, 0x00003f0c
    .long 0x3eb9bf28, 0x00003f28, 0x3f48bcb3, 0x00003cb3, 0x3f0c3f04, 0x0000bf04, 0xbf083f13, 0x0000bf13
    .long 0xbf223ece, 0x0000bece, 0xbd33bf48, 0x00003f48, 0xbe6dbf37, 0x00003f37, 0x3f173f03, 0x0000bf03
    .long 0x3f40bd41, 0x00003d41, 0xbf483d86, 0x0000bd86, 0xbe103f3d, 0x0000bf3d, 0x3efebf1b, 0x00003f1b
    .long 0xbf2ebea4, 0x00003ea4, 0x3db33f47, 0x0000bf47, 0x3ef5bf14, 0x00003f14, 0xbf1ebef6, 0x00003ef6
    .long 0x00000000, 0x00000000, 0x00000000, 0x00000000, 0x00000000, 0x00000000, 0x00000000, 0x00000000
    .long 0x00000000, 0x00000000, 0x00000000, 0x00000000, 0x00000000, 0x00000000, 0x00000000, 0x00000000
    .long 0x00000000, 0x00000000, 0x00000000, 0x00000000, 0x00000000, 0x00000000, 0x00000000, 0x00000000
    .long 0x3dc33dc3, 0x40254025, 0x00004045, 0x3fb73fb7, 0xbe0d3e0d, 0xbfe53fe5, 0x00000000, 0xbfb73fb7
    .long 0x3e4b3e4b, 0x3f9f3f9f, 0x00000000, 0x3fb73fb7, 0xbe923e92, 0xbf5c3f5c, 0x00000000, 0xbfb73fb7
    .long 0x3ed33ed3, 0x3f183f18, 0x00000000, 0x3fb73fb7, 0xbf183f18, 0xbed33ed3, 0x00000000, 0xbfb73fb7
    .long 0x3f5c3f5c, 0x3e923e92, 0x00000000, 0x3fb73fb7, 0xbf9f3f9f, 0xbe4b3e4b, 0x00000000, 0xbfb73fb7
    .long 0x3fe53fe5, 0x3e0d3e0d, 0x00000000, 0x3fb73fb7, 0xc0254025, 0xbdc33dc3, 0x40450000, 0xbfb73fb7
    .long 0x00000000, 0x00000000, 0x00000000, 0x00000000, 0x00000000, 0x00000000, 0x00000000, 0x00000000
    .long 0x00000000, 0x00000000, 0x00000000, 0x00000000, 0x00000000, 0x00000000, 0x00000000, 0x00000000
    .long 0x00000000, 0x00000000, 0x00000000, 0x00000000, 0x00000000, 0x00000000, 0x00000000, 0x00000000
    .long 0x00000000, 0x00000000, 0x00000000, 0x00000000, 0x00000000, 0x00000000, 0x00000000, 0x00000000
    .long 0x00000000, 0x00000000, 0x00000000, 0x00000000, 0x00000000, 0x00000000, 0x00000000, 0x00000000
    .long 0x00000000, 0x00000000, 0x00000000, 0x00000000, 0x00000000, 0x00000000, 0x00000000, 0x00000000
    .long 0x00000000, 0x00000000, 0x00000000, 0x00000000, 0x00000000, 0x00000000, 0x00000000, 0x00000000
    .long 0x00000000, 0x00000000, 0x00000000, 0x00000000, 0x00000000, 0x00000000, 0x00000000, 0x00000000
    .long 0x00000000, 0x00000000, 0x00000000, 0x00000000, 0x00000000, 0x00000000, 0x00000000, 0x00000000
    .long 0x00000000, 0x00000000, 0x00000000, 0x00000000, 0x00000000, 0x00000000, 0x00000000, 0x00000000
    .long 0x00000000, 0x00000000, 0x00000000, 0x00000000, 0x00000000, 0x00000000, 0x00000000, 0x00000000
    .long 0x00003f48, 0x0000bf48, 0x00003f40, 0x0000bf40, 0xbf103f0c, 0x0000bf0c, 0xbf3a3e3f, 0x0000be3f
    .long 0xbf48bcb3, 0x00003cb3, 0xbeb9bf28, 0x00003f28, 0xbf08bf13, 0x00003f13, 0x3f0cbf04, 0x00003f04
    .long 0x3d33bf48, 0x00003f48, 0x3f223ece, 0x0000bece, 0x3f17bf03, 0x00003f03, 0xbe6d3f37, 0x0000bf37
    .long 0x3f483d86, 0x0000bd86, 0xbf40bd41, 0x00003d41, 0x3efe3f1b, 0x0000bf1b, 0xbe10bf3d, 0x00003f3d
    .long 0xbdb33f47, 0x0000bf47, 0x3f2ebea4, 0x00003ea4, 0xbf1e3ef6, 0x0000bef6, 0x3ef53f14, 0x0000bf14
    .long 0x00000000, 0x00000000, 0x00000000, 0x00000000, 0x00000000, 0x00000000, 0x00000000, 0x00000000
    .long 0x00000000, 0x00000000, 0x00000000, 0x00000000, 0x00000000, 0x00000000, 0x00000000, 0x00000000
    .long 0x00000000, 0x00000000, 0x00000000, 0x00000000, 0x00000000, 0x00000000, 0x00000000, 0x00000000
    .long 0x00003f40, 0x0000bf40, 0x00003f48, 0x0000bf48, 0xbf3abe3f, 0x00003e3f, 0xbf10bf0c, 0x00003f0c
    .long 0x3eb9bf28, 0x00003f28, 0x3f48bcb3, 0x00003cb3, 0x3f0c3f04, 0x0000bf04, 0xbf083f13, 0x0000bf13
    .long 0xbf223ece, 0x0000bece, 0xbd33bf48, 0x00003f48, 0xbe6dbf37, 0x00003f37, 0x3f173f03, 0x0000bf03
    .long 0x3f40bd41, 0x00003d41, 0xbf483d86, 0x0000bd86, 0xbe103f3d, 0x0000bf3d, 0x3efebf1b, 0x00003f1b
    .long 0xbf2ebea4, 0x00003ea4, 0x3db33f47, 0x0000bf47, 0x3ef5bf14, 0x00003f14, 0xbf1ebef6, 0x00003ef6
    .long 0x00000000, 0x00000000, 0x00000000, 0x00000000, 0x00000000, 0x00000000, 0x00000000, 0x00000000
    .long 0x00000000, 0x00000000, 0x00000000, 0x00000000, 0x00000000, 0x00000000, 0x00000000, 0x00000000
    .long 0x00000000, 0x00000000, 0x00000000, 0x00000000, 0x00000000, 0x00000000, 0x00000000, 0x00000000
    .long 0x40254025, 0x3dc33dc3, 0x3fb73fb7, 0x00004045, 0xbfe53fe5, 0xbe0d3e0d, 0xbfb73fb7, 0x00000000
    .long 0x3f9f3f9f, 0x3e4b3e4b, 0x3fb73fb7, 0x00000000, 0xbf5c3f5c, 0xbe923e92, 0xbfb73fb7, 0x00000000
    .long 0x3f183f18, 0x3ed33ed3, 0x3fb73fb7, 0x00000000, 0xbed33ed3, 0xbf183f18, 0xbfb73fb7, 0x00000000
    .long 0x3e923e92, 0x3f5c3f5c, 0x3fb73fb7, 0x00000000, 0xbe4b3e4b, 0xbf9f3f9f, 0xbfb73fb7, 0x00000000
    .long 0x3e0d3e0d, 0x3fe53fe5, 0x3fb73fb7, 0x00000000, 0xbdc33dc3, 0xc0254025, 0xbfb73fb7, 0x40450000
    .long 0x00000000, 0x00000000, 0x00000000, 0x00000000, 0x00000000, 0x00000000, 0x00000000, 0x00000000
    .long 0x00000000, 0x00000000, 0x00000000, 0x00000000, 0x00000000, 0x00000000, 0x00000000, 0x00000000
    .long 0x00000000, 0x00000000, 0x00000000, 0x00000000, 0x00000000, 0x00000000, 0x00000000, 0x00000000
    .long 0x00000000, 0x00000000, 0x00000000, 0x00000000, 0x00000000, 0x00000000, 0x00000000, 0x00000000
    .long 0x00000000, 0x00000000, 0x00000000, 0x00000000, 0x00000000, 0x00000000, 0x00000000, 0x00000000
    .long 0x00000000, 0x00000000, 0x00000000, 0x00000000, 0x00000000, 0x00000000, 0x00000000, 0x00000000
    .long 0x00000000, 0x00000000, 0x00000000, 0x00000000, 0x00000000, 0x00000000, 0x00000000, 0x00000000
    .long 0x00000000, 0x00000000, 0x00000000, 0x00000000, 0x00000000, 0x00000000, 0x00000000, 0x00000000
    .long 0x00000000, 0x00000000, 0x00000000, 0x00000000, 0x00000000, 0x00000000, 0x00000000, 0x00000000
    .long 0x00000000, 0x00000000, 0x00000000, 0x00000000, 0x00000000, 0x00000000, 0x00000000, 0x00000000
    .long 0x00000000, 0x00000000, 0x00000000, 0x00000000, 0x00000000, 0x00000000, 0x00000000, 0x00000000

K2_code_end:
.section .rodata,"a"
.p2align 6
.amdhsa_kernel standalone__fft_conv__vision_kernel
  .amdhsa_next_free_vgpr 512
  .amdhsa_next_free_sgpr 102
  .amdhsa_accum_offset 256
  .amdhsa_group_segment_fixed_size 0
  .amdhsa_kernarg_size 40
  .amdhsa_user_sgpr_count 2
  .amdhsa_user_sgpr_kernarg_segment_ptr 1
  .amdhsa_system_sgpr_workgroup_id_x 1
.end_amdhsa_kernel
```

```asm
; @launch grid=(256,1,1) block=(256,1,1) lds=163840
.amdgcn_target "amdgcn-amd-amdhsa--gfx950"
.text
.globl standalone__fft_conv__vision_kernel
.p2align 8
.type standalone__fft_conv__vision_kernel,@function
standalone__fft_conv__vision_kernel:
    s_load_dwordx4 s[84:87], s[0:1], 0
    s_load_dwordx4 s[4:7], s[0:1], 16
    s_load_dwordx2 s[8:9], s[0:1], 32
    s_getpc_b64 s[10:11]
FU_pc:
    s_cmp_ge_u32 s2, 256
    s_cbranch_scc1 K2_end
    v_lshrrev_b32 v3, 6, v0
    v_and_b32 v0, 63, v0
    s_nop 0
    v_readfirstlane_b32 s24, v3
    s_and_b32 s20, s2, 7
    s_lshr_b32 s21, s2, 3
    s_lshl_b32 s21, s21, 2
    s_add_u32 s21, s21, s24
    s_lshr_b32 s83, s2, 3
    s_lshl_b32 s83, s83, 1
    s_add_u32 s83, s83, s24
    s_cmp_lt_u32 s24, 2
    s_cselect_b32 s83, s83, 64
    s_add_u32 s22, s83, 128
    s_min_u32 s22, s22, 167
    s_mov_b32 s80, 0
    s_cmp_lt_u32 s24, 2
    s_cbranch_scc1 FA_noas
    s_lshr_b32 s57, s2, 3
    s_lshl_b32 s58, s57, 1
    s_add_u32 s58, s58, s24
    s_sub_u32 s58, s58, 2
    s_cmp_ge_u32 s58, 61
    s_cbranch_scc1 FA_noas
    s_mov_b32 s80, 1
    s_add_u32 s22, s58, 128
    s_mov_b32 s81, -41664
    s_cmp_lt_u32 s58, 40
    s_cbranch_scc1 FA_noas
    s_sub_u32 s22, s21, 2
    s_mov_b32 s81, -54016
FA_noas:
    v_and_b32 v1, 3, v0
    v_bfe_u32 v5, v0, 2, 1
    s_sub_u32 s23, s22, s21
    v_mul_u32_u24 v5, s23, v5
    v_add_u32 v5, s21, v5
    v_lshl_add_u32 v1, v5, 2, v1
    v_mul_u32_u24 v2, 2260, v1
    v_lshrrev_b32 v2, 16, v2
    v_mul_u32_u24 v3, 29, v2
    v_sub_u32 v3, v1, v3
    v_min_u32 v2, 22, v2
    v_lshlrev_b32 v4, 3, v3
    v_add_u32 v4, 216, v4
    v_subrev_u32 v5, 224, v4
    v_min_u32 v4, v4, v5
    v_add_u32 v4, s20, v4
    v_mul_u32_u24 v4, 43008, v4
    v_mul_u32_u24 v6, 1920, v2
    v_add_u32 v7, v4, v6
    v_cmp_eq_u32 vcc, 0, v2
    v_mov_b32 v5, 43008
    v_mov_b32 v6, 0
    v_cndmask_b32 v3, v6, v5, vcc
    s_nop 0
    v_readlane_b32 s40, v7, 0
    v_readlane_b32 s41, v7, 1
    v_readlane_b32 s42, v7, 2
    v_readlane_b32 s43, v7, 3
    v_readlane_b32 s44, v7, 4
    v_readlane_b32 s45, v7, 5
    v_readlane_b32 s46, v7, 6
    v_readlane_b32 s47, v7, 7
    v_readlane_b32 s48, v3, 0
    v_readlane_b32 s49, v3, 1
    v_readlane_b32 s50, v3, 2
    v_readlane_b32 s51, v3, 3
    v_readlane_b32 s52, v3, 4
    v_readlane_b32 s53, v3, 5
    v_readlane_b32 s54, v3, 6
    v_readlane_b32 s55, v3, 7
    v_add_u32 v8, 0, v0
    v_mul_u32_u24 v9, 5462, v8
    v_bfe_u32 v10, v9, 18, 2
    v_xor_b32 v8, v8, v10
    v_lshlrev_b32 v12, 4, v8
    v_lshrrev_b32 v9, 16, v9
    v_cmp_gt_u32 vcc, 6, v9
    s_nop 1
    v_cndmask_b32 v16, 0, 1, vcc
    v_add_u32 v8, 64, v0
    v_mul_u32_u24 v9, 5462, v8
    v_bfe_u32 v10, v9, 18, 2
    v_xor_b32 v8, v8, v10
    v_lshlrev_b32 v13, 4, v8
    v_lshrrev_b32 v9, 16, v9
    v_cmp_gt_u32 vcc, 6, v9
    s_nop 1
    v_cndmask_b32 v17, 0, 1, vcc
    v_add_u32 v8, 128, v0
    v_mul_u32_u24 v9, 5462, v8
    v_bfe_u32 v10, v9, 18, 2
    v_xor_b32 v8, v8, v10
    v_lshlrev_b32 v14, 4, v8
    s_mul_i32 s56, s24, 27008
    s_waitcnt lgkmcnt(0)
    s_mov_b64 s[76:77], s[6:7]
    s_sub_u32 s12, s84, 1152
    s_subb_u32 s13, s85, 0
    s_and_b32 s13, s13, 0xffff
    s_mov_b32 s14, 9634944
    s_mov_b32 s15, 0x00020000
    s_or_b32 s57, s2, s24
    s_cmp_lg_u32 s57, 0
    s_cbranch_scc1 FA_nononce
    s_memrealtime s[58:59]
    s_waitcnt lgkmcnt(0)
    s_or_b32 s58, s58, 1
    v_mov_b32 v8, 0
    v_mov_b32 v9, s58
    s_mov_b64 exec, 1
    global_store_dword v8, v9, s[76:77] sc1
    s_mov_b64 exec, -1
FA_nononce:
    s_cmp_lt_u32 s83, 40
    s_cbranch_scc1 FA_xx
    s_cmp_lt_u32 s83, 61
    s_cbranch_scc1 FA_xw
    s_add_u32 m0, s56, 0
    v_mad_i32_i24 v8, v16, s48, v12
    buffer_load_dwordx4 v8, s[12:15], s40 offen lds
    s_add_u32 m0, s56, 1024
    v_mad_i32_i24 v9, v17, s48, v13
    buffer_load_dwordx4 v9, s[12:15], s40 offen lds
    s_add_u32 m0, s56, 2048
    s_nop 0
    buffer_load_dwordx4 v14, s[12:15], s40 offen lds
    s_add_u32 m0, s56, 3088
    v_mad_i32_i24 v9, v16, s49, v12
    buffer_load_dwordx4 v9, s[12:15], s41 offen lds
    s_add_u32 m0, s56, 4112
    v_mad_i32_i24 v8, v17, s49, v13
    buffer_load_dwordx4 v8, s[12:15], s41 offen lds
    s_add_u32 m0, s56, 5136
    s_nop 0
    buffer_load_dwordx4 v14, s[12:15], s41 offen lds
    s_add_u32 m0, s56, 6176
    v_mad_i32_i24 v8, v16, s50, v12
    buffer_load_dwordx4 v8, s[12:15], s42 offen lds
    s_add_u32 m0, s56, 7200
    v_mad_i32_i24 v9, v17, s50, v13
    buffer_load_dwordx4 v9, s[12:15], s42 offen lds
    s_add_u32 m0, s56, 8224
    s_nop 0
    buffer_load_dwordx4 v14, s[12:15], s42 offen lds
    s_add_u32 m0, s56, 9264
    v_mad_i32_i24 v9, v16, s51, v12
    buffer_load_dwordx4 v9, s[12:15], s43 offen lds
    s_add_u32 m0, s56, 10288
    v_mad_i32_i24 v8, v17, s51, v13
    buffer_load_dwordx4 v8, s[12:15], s43 offen lds
    s_add_u32 m0, s56, 11312
    s_nop 0
    buffer_load_dwordx4 v14, s[12:15], s43 offen lds
    v_mov_b32 v30, 0
    global_load_dword v31, v30, s[76:77] sc1
    v_lshlrev_b32 v1, 3, v0
    s_add_u32 s58, s10, FU_bt-FU_pc
    s_addc_u32 s59, s11, 0
    global_load_dwordx2 v[20:21], v1, s[58:59]
    v_lshrrev_b32 v2, 4, v0
    v_and_b32 v3, 15, v0
    v_lshrrev_b32 v4, 2, v3
    v_and_b32 v5, 3, v0
    v_lshl_add_u32 v6, v2, 2, v4
    v_mul_u32_u24 v7, 193, v5
    v_mul_u32_u24 v8, 12, v6
    v_add_u32 v7, v7, v8
    v_mov_b32 v10, s56
    v_xor_b32 v9, 0, v2
    v_add_u32 v9, v7, v9
    v_lshl_add_u32 v24, v9, 4, v10
    v_xor_b32 v9, 1, v2
    v_add_u32 v9, v7, v9
    v_lshl_add_u32 v25, v9, 4, v10
    v_xor_b32 v9, 2, v2
    v_add_u32 v9, v7, v9
    v_lshl_add_u32 v26, v9, 4, v10
    v_xor_b32 v9, 3, v2
    v_add_u32 v9, v7, v9
    v_lshl_add_u32 v27, v9, 4, v10
    v_mul_u32_u24 v7, 193, v2
    v_mul_u32_u24 v8, 12, v3
    v_add_u32 v7, v7, v8
    v_lshrrev_b32 v8, 2, v3
    v_xor_b32 v9, 0, v8
    v_add_u32 v9, v7, v9
    v_lshl_add_u32 v244, v9, 4, v10
    v_xor_b32 v9, 1, v8
    v_add_u32 v9, v7, v9
    v_lshl_add_u32 v245, v9, 4, v10
    v_xor_b32 v9, 2, v8
    v_add_u32 v9, v7, v9
    v_lshl_add_u32 v246, v9, 4, v10
    v_xor_b32 v9, 3, v8
    v_add_u32 v9, v7, v9
    v_lshl_add_u32 v247, v9, 4, v10
    v_lshrrev_b32 v2, 4, v0
    v_bfe_u32 v3, v0, 2, 2
    v_and_b32 v4, 3, v0
    v_mul_u32_u24 v7, 193, v4
    v_mul_u32_u24 v8, 12, v2
    v_add_u32 v7, v7, v8
    v_xor_b32 v9, 0, v3
    v_add_u32 v9, v7, v9
    v_lshl_add_u32 v16, v9, 4, v10
    v_xor_b32 v9, 1, v3
    v_add_u32 v9, v7, v9
    v_lshl_add_u32 v17, v9, 4, v10
    v_xor_b32 v9, 2, v3
    v_add_u32 v9, v7, v9
    v_lshl_add_u32 v18, v9, 4, v10
    v_xor_b32 v9, 3, v3
    v_add_u32 v9, v7, v9
    v_lshl_add_u32 v19, v9, 4, v10
    v_lshlrev_b32 v7, 13, v2
    v_lshl_add_u32 v7, v3, 6, v7
    v_lshl_add_u32 v11, v4, 4, v7
    s_lshr_b32 s62, s21, 2
    s_lshl_b32 s78, s62, 7
    s_mul_i32 s60, s62, 393216
    s_lshl_b32 s62, s20, 2
    s_and_b32 s57, s21, 3
    s_add_u32 s62, s62, s57
    s_lshl_b32 s62, s62, 2
    s_add_u32 s78, s78, s62
    s_add_u32 s78, s78, 18579456
    s_lshl_b32 s62, s20, 10
    s_add_u32 s60, s60, s62
    s_and_b32 s62, s21, 3
    s_lshl_b32 s62, s62, 8
    s_add_u32 s60, s60, s62
    s_lshr_b32 s62, s22, 2
    s_lshl_b32 s79, s62, 7
    s_mul_i32 s61, s62, 393216
    s_lshl_b32 s62, s20, 2
    s_and_b32 s57, s22, 3
    s_add_u32 s62, s62, s57
    s_lshl_b32 s62, s62, 2
    s_add_u32 s79, s79, s62
    s_add_u32 s79, s79, 18579456
    s_lshl_b32 s62, s20, 10
    s_add_u32 s61, s61, s62
    s_and_b32 s62, s22, 3
    s_lshl_b32 s62, s62, 8
    s_add_u32 s61, s61, s62
    s_mov_b32 s16, s8
    s_and_b32 s17, s9, 0xffff
    s_mov_b32 s18, 16515072
    s_mov_b32 s19, 0x00020000
    s_waitcnt vmcnt(2)
    ds_read_b64_tr_b16 v[32:33], v24 offset:0
    ds_read_b64_tr_b16 v[34:35], v24 offset:8
    ds_read_b64_tr_b16 v[36:37], v25 offset:0
    ds_read_b64_tr_b16 v[38:39], v25 offset:8
    ds_read_b64_tr_b16 v[40:41], v26 offset:0
    ds_read_b64_tr_b16 v[42:43], v26 offset:8
    ds_read_b64_tr_b16 v[44:45], v27 offset:0
    ds_read_b64_tr_b16 v[46:47], v27 offset:8
    ds_read_b64_tr_b16 v[48:49], v24 offset:64
    ds_read_b64_tr_b16 v[50:51], v24 offset:72
    ds_read_b64_tr_b16 v[52:53], v25 offset:64
    ds_read_b64_tr_b16 v[54:55], v25 offset:72
    ds_read_b64_tr_b16 v[56:57], v26 offset:64
    ds_read_b64_tr_b16 v[58:59], v26 offset:72
    ds_read_b64_tr_b16 v[60:61], v27 offset:64
    ds_read_b64_tr_b16 v[62:63], v27 offset:72
    ds_read_b64_tr_b16 v[64:65], v24 offset:128
    ds_read_b64_tr_b16 v[66:67], v24 offset:136
    ds_read_b64_tr_b16 v[68:69], v25 offset:128
    ds_read_b64_tr_b16 v[70:71], v25 offset:136
    ds_read_b64_tr_b16 v[72:73], v26 offset:128
    ds_read_b64_tr_b16 v[74:75], v26 offset:136
    ds_read_b64_tr_b16 v[76:77], v27 offset:128
    ds_read_b64_tr_b16 v[78:79], v27 offset:136
    s_waitcnt vmcnt(0) lgkmcnt(15)
    v_mfma_f32_16x16x16_bf16 v[80:83], v[32:33], v[20:21], 0
    v_mfma_f32_16x16x16_bf16 v[84:87], v[34:35], v[20:21], 0
    v_mfma_f32_16x16x16_bf16 v[88:91], v[36:37], v[20:21], 0
    v_mfma_f32_16x16x16_bf16 v[92:95], v[38:39], v[20:21], 0
    v_mfma_f32_16x16x16_bf16 v[96:99], v[40:41], v[20:21], 0
    v_mfma_f32_16x16x16_bf16 v[100:103], v[42:43], v[20:21], 0
    v_mfma_f32_16x16x16_bf16 v[104:107], v[44:45], v[20:21], 0
    v_mfma_f32_16x16x16_bf16 v[108:111], v[46:47], v[20:21], 0
    v_mfma_f32_16x16x16_bf16 v[112:115], v[48:49], v[20:21], 0
    s_waitcnt lgkmcnt(14)
    v_mfma_f32_16x16x16_bf16 v[116:119], v[50:51], v[20:21], 0
    s_waitcnt lgkmcnt(13)
    v_mfma_f32_16x16x16_bf16 v[120:123], v[52:53], v[20:21], 0
    s_waitcnt lgkmcnt(12)
    v_mfma_f32_16x16x16_bf16 v[124:127], v[54:55], v[20:21], 0
    s_waitcnt lgkmcnt(11)
    v_mfma_f32_16x16x16_bf16 v[128:131], v[56:57], v[20:21], 0
    s_waitcnt lgkmcnt(10)
    v_mfma_f32_16x16x16_bf16 v[132:135], v[58:59], v[20:21], 0
    s_waitcnt lgkmcnt(9)
    v_mfma_f32_16x16x16_bf16 v[136:139], v[60:61], v[20:21], 0
    s_waitcnt lgkmcnt(8)
    v_mfma_f32_16x16x16_bf16 v[140:143], v[62:63], v[20:21], 0
    v_cvt_pk_bf16_f32 v80, v80, v81
    v_cvt_pk_bf16_f32 v81, v82, v83
    v_cvt_pk_bf16_f32 v82, v84, v85
    v_cvt_pk_bf16_f32 v83, v86, v87
    ds_write_b128 v244, v[80:83] offset:0
    v_cvt_pk_bf16_f32 v88, v88, v89
    v_cvt_pk_bf16_f32 v89, v90, v91
    v_cvt_pk_bf16_f32 v90, v92, v93
    v_cvt_pk_bf16_f32 v91, v94, v95
    ds_write_b128 v245, v[88:91] offset:0
    v_cvt_pk_bf16_f32 v96, v96, v97
    v_cvt_pk_bf16_f32 v97, v98, v99
    v_cvt_pk_bf16_f32 v98, v100, v101
    v_cvt_pk_bf16_f32 v99, v102, v103
    ds_write_b128 v246, v[96:99] offset:0
    v_cvt_pk_bf16_f32 v104, v104, v105
    v_cvt_pk_bf16_f32 v105, v106, v107
    v_cvt_pk_bf16_f32 v106, v108, v109
    v_cvt_pk_bf16_f32 v107, v110, v111
    ds_write_b128 v247, v[104:107] offset:0
    ds_read_b128 v[144:147], v16 offset:0
    ds_read_b128 v[148:151], v17 offset:768
    ds_read_b128 v[152:155], v18 offset:1536
    ds_read_b128 v[156:159], v19 offset:2304
    s_add_u32 s62, s60, 0
    s_waitcnt lgkmcnt(3)
    buffer_store_dwordx4 v[144:147], v11, s[16:19], s62 offen sc1
    s_add_u32 s62, s60, 98304
    s_waitcnt lgkmcnt(2)
    buffer_store_dwordx4 v[148:151], v11, s[16:19], s62 offen sc1
    s_add_u32 s62, s60, 196608
    s_waitcnt lgkmcnt(1)
    buffer_store_dwordx4 v[152:155], v11, s[16:19], s62 offen sc1
    s_add_u32 s62, s60, 294912
    s_waitcnt lgkmcnt(0)
    buffer_store_dwordx4 v[156:159], v11, s[16:19], s62 offen sc1
    v_mfma_f32_16x16x16_bf16 v[80:83], v[64:65], v[20:21], 0
    v_mfma_f32_16x16x16_bf16 v[84:87], v[66:67], v[20:21], 0
    v_mfma_f32_16x16x16_bf16 v[88:91], v[68:69], v[20:21], 0
    v_mfma_f32_16x16x16_bf16 v[92:95], v[70:71], v[20:21], 0
    v_mfma_f32_16x16x16_bf16 v[96:99], v[72:73], v[20:21], 0
    v_mfma_f32_16x16x16_bf16 v[100:103], v[74:75], v[20:21], 0
    v_mfma_f32_16x16x16_bf16 v[104:107], v[76:77], v[20:21], 0
    v_mfma_f32_16x16x16_bf16 v[108:111], v[78:79], v[20:21], 0
    v_cvt_pk_bf16_f32 v112, v112, v113
    v_cvt_pk_bf16_f32 v113, v114, v115
    v_cvt_pk_bf16_f32 v114, v116, v117
    v_cvt_pk_bf16_f32 v115, v118, v119
    ds_write_b128 v244, v[112:115] offset:64
    v_cvt_pk_bf16_f32 v120, v120, v121
    v_cvt_pk_bf16_f32 v121, v122, v123
    v_cvt_pk_bf16_f32 v122, v124, v125
    v_cvt_pk_bf16_f32 v123, v126, v127
    ds_write_b128 v245, v[120:123] offset:64
    v_cvt_pk_bf16_f32 v128, v128, v129
    v_cvt_pk_bf16_f32 v129, v130, v131
    v_cvt_pk_bf16_f32 v130, v132, v133
    v_cvt_pk_bf16_f32 v131, v134, v135
    ds_write_b128 v246, v[128:131] offset:64
    v_cvt_pk_bf16_f32 v136, v136, v137
    v_cvt_pk_bf16_f32 v137, v138, v139
    v_cvt_pk_bf16_f32 v138, v140, v141
    v_cvt_pk_bf16_f32 v139, v142, v143
    ds_write_b128 v247, v[136:139] offset:64
    v_cvt_pk_bf16_f32 v80, v80, v81
    v_cvt_pk_bf16_f32 v81, v82, v83
    v_cvt_pk_bf16_f32 v82, v84, v85
    v_cvt_pk_bf16_f32 v83, v86, v87
    ds_write_b128 v244, v[80:83] offset:128
    v_cvt_pk_bf16_f32 v88, v88, v89
    v_cvt_pk_bf16_f32 v89, v90, v91
    v_cvt_pk_bf16_f32 v90, v92, v93
    v_cvt_pk_bf16_f32 v91, v94, v95
    ds_write_b128 v245, v[88:91] offset:128
    v_cvt_pk_bf16_f32 v96, v96, v97
    v_cvt_pk_bf16_f32 v97, v98, v99
    v_cvt_pk_bf16_f32 v98, v100, v101
    v_cvt_pk_bf16_f32 v99, v102, v103
    ds_write_b128 v246, v[96:99] offset:128
    v_cvt_pk_bf16_f32 v104, v104, v105
    v_cvt_pk_bf16_f32 v105, v106, v107
    v_cvt_pk_bf16_f32 v106, v108, v109
    v_cvt_pk_bf16_f32 v107, v110, v111
    ds_write_b128 v247, v[104:107] offset:128
    ds_read_b128 v[208:211], v16 offset:64
    ds_read_b128 v[212:215], v17 offset:832
    ds_read_b128 v[216:219], v18 offset:1600
    ds_read_b128 v[220:223], v19 offset:2368
    s_add_u32 s62, s60, 32768
    s_waitcnt lgkmcnt(3)
    buffer_store_dwordx4 v[208:211], v11, s[16:19], s62 offen sc1
    s_add_u32 s62, s60, 131072
    s_waitcnt lgkmcnt(2)
    buffer_store_dwordx4 v[212:215], v11, s[16:19], s62 offen sc1
    s_add_u32 s62, s60, 229376
    s_waitcnt lgkmcnt(1)
    buffer_store_dwordx4 v[216:219], v11, s[16:19], s62 offen sc1
    s_add_u32 s62, s60, 327680
    s_waitcnt lgkmcnt(0)
    buffer_store_dwordx4 v[220:223], v11, s[16:19], s62 offen sc1
    s_nop 0
    v_readfirstlane_b32 s82, v31
    s_mov_b32 s57, 0
FA_na:
    s_cmp_lg_u32 s82, 0
    s_cbranch_scc1 FA_noka
    s_add_u32 s57, s57, 1
    s_cmp_ge_u32 s57, 400000
    s_cbranch_scc1 FA_noka
    s_sleep 4
    v_mov_b32 v30, 0
    global_load_dword v31, v30, s[76:77] sc1
    s_waitcnt vmcnt(0)
    v_readfirstlane_b32 s82, v31
    s_branch FA_na
FA_noka:
    s_waitcnt vmcnt(4)
    v_mov_b32 v1, s78
    v_mov_b32 v2, s82
    s_mov_b64 exec, 1
    global_atomic_swap v1, v2, s[8:9] sc1
    s_mov_b64 exec, -1
    s_barrier
    s_nop 0
    s_cmp_eq_u32 s80, 0
    s_cbranch_scc1 FA_noassist
    v_add_u32 v200, s81, v16
    v_add_u32 v201, s81, v17
    v_add_u32 v202, s81, v18
    v_add_u32 v203, s81, v19
    ds_read_b128 v[160:163], v200 offset:64
    ds_read_b128 v[164:167], v201 offset:832
    ds_read_b128 v[168:171], v202 offset:1600
    ds_read_b128 v[172:175], v203 offset:2368
    s_add_u32 s62, s61, 32768
    s_waitcnt lgkmcnt(3)
    buffer_store_dwordx4 v[160:163], v11, s[16:19], s62 offen sc1
    s_add_u32 s62, s61, 131072
    s_waitcnt lgkmcnt(2)
    buffer_store_dwordx4 v[164:167], v11, s[16:19], s62 offen sc1
    s_add_u32 s62, s61, 229376
    s_waitcnt lgkmcnt(1)
    buffer_store_dwordx4 v[168:171], v11, s[16:19], s62 offen sc1
    s_add_u32 s62, s61, 327680
    s_waitcnt lgkmcnt(0)
    buffer_store_dwordx4 v[172:175], v11, s[16:19], s62 offen sc1
    s_mov_b32 s81, s79
    s_mov_b32 s79, 0
    s_mov_b32 s61, 0x40000000
    s_branch FU_pb
FA_noassist:
    s_mov_b32 s81, 0
    s_mov_b32 s79, 0
    s_mov_b32 s61, 0x40000000
    s_branch FU_pb
FA_xx:
    s_add_u32 m0, s56, 0
    v_mad_i32_i24 v8, v16, s48, v12
    buffer_load_dwordx4 v8, s[12:15], s40 offen lds
    s_add_u32 m0, s56, 1024
    v_mad_i32_i24 v9, v17, s48, v13
    buffer_load_dwordx4 v9, s[12:15], s40 offen lds
    s_add_u32 m0, s56, 2048
    s_nop 0
    buffer_load_dwordx4 v14, s[12:15], s40 offen lds
    s_add_u32 m0, s56, 3088
    v_mad_i32_i24 v9, v16, s49, v12
    buffer_load_dwordx4 v9, s[12:15], s41 offen lds
    s_add_u32 m0, s56, 4112
    v_mad_i32_i24 v8, v17, s49, v13
    buffer_load_dwordx4 v8, s[12:15], s41 offen lds
    s_add_u32 m0, s56, 5136
    s_nop 0
    buffer_load_dwordx4 v14, s[12:15], s41 offen lds
    s_add_u32 m0, s56, 6176
    v_mad_i32_i24 v8, v16, s50, v12
    buffer_load_dwordx4 v8, s[12:15], s42 offen lds
    s_add_u32 m0, s56, 7200
    v_mad_i32_i24 v9, v17, s50, v13
    buffer_load_dwordx4 v9, s[12:15], s42 offen lds
    s_add_u32 m0, s56, 8224
    s_nop 0
    buffer_load_dwordx4 v14, s[12:15], s42 offen lds
    s_add_u32 m0, s56, 9264
    v_mad_i32_i24 v9, v16, s51, v12
    buffer_load_dwordx4 v9, s[12:15], s43 offen lds
    s_add_u32 m0, s56, 10288
    v_mad_i32_i24 v8, v17, s51, v13
    buffer_load_dwordx4 v8, s[12:15], s43 offen lds
    s_add_u32 m0, s56, 11312
    s_nop 0
    buffer_load_dwordx4 v14, s[12:15], s43 offen lds
    v_mov_b32 v30, 0
    global_load_dword v31, v30, s[76:77] sc1
    s_add_u32 m0, s56, 12352
    v_mad_i32_i24 v8, v16, s52, v12
    buffer_load_dwordx4 v8, s[12:15], s44 offen lds
    s_add_u32 m0, s56, 13376
    v_mad_i32_i24 v9, v17, s52, v13
    buffer_load_dwordx4 v9, s[12:15], s44 offen lds
    s_add_u32 m0, s56, 14400
    s_nop 0
    buffer_load_dwordx4 v14, s[12:15], s44 offen lds
    s_add_u32 m0, s56, 15440
    v_mad_i32_i24 v9, v16, s53, v12
    buffer_load_dwordx4 v9, s[12:15], s45 offen lds
    s_add_u32 m0, s56, 16464
    v_mad_i32_i24 v8, v17, s53, v13
    buffer_load_dwordx4 v8, s[12:15], s45 offen lds
    s_add_u32 m0, s56, 17488
    s_nop 0
    buffer_load_dwordx4 v14, s[12:15], s45 offen lds
    s_add_u32 m0, s56, 18528
    v_mad_i32_i24 v8, v16, s54, v12
    buffer_load_dwordx4 v8, s[12:15], s46 offen lds
    s_add_u32 m0, s56, 19552
    v_mad_i32_i24 v9, v17, s54, v13
    buffer_load_dwordx4 v9, s[12:15], s46 offen lds
    s_add_u32 m0, s56, 20576
    s_nop 0
    buffer_load_dwordx4 v14, s[12:15], s46 offen lds
    s_add_u32 m0, s56, 21616
    v_mad_i32_i24 v9, v16, s55, v12
    buffer_load_dwordx4 v9, s[12:15], s47 offen lds
    s_add_u32 m0, s56, 22640
    v_mad_i32_i24 v8, v17, s55, v13
    buffer_load_dwordx4 v8, s[12:15], s47 offen lds
    s_add_u32 m0, s56, 23664
    s_nop 0
    buffer_load_dwordx4 v14, s[12:15], s47 offen lds
    v_lshlrev_b32 v1, 3, v0
    s_add_u32 s58, s10, FU_bt-FU_pc
    s_addc_u32 s59, s11, 0
    global_load_dwordx2 v[20:21], v1, s[58:59]
    v_lshrrev_b32 v2, 4, v0
    v_and_b32 v3, 15, v0
    v_lshrrev_b32 v4, 2, v3
    v_and_b32 v5, 3, v0
    v_lshl_add_u32 v6, v2, 2, v4
    v_mul_u32_u24 v7, 193, v5
    v_mul_u32_u24 v8, 12, v6
    v_add_u32 v7, v7, v8
    v_mov_b32 v10, s56
    v_xor_b32 v9, 0, v2
    v_add_u32 v9, v7, v9
    v_lshl_add_u32 v24, v9, 4, v10
    v_xor_b32 v9, 1, v2
    v_add_u32 v9, v7, v9
    v_lshl_add_u32 v25, v9, 4, v10
    v_xor_b32 v9, 2, v2
    v_add_u32 v9, v7, v9
    v_lshl_add_u32 v26, v9, 4, v10
    v_xor_b32 v9, 3, v2
    v_add_u32 v9, v7, v9
    v_lshl_add_u32 v27, v9, 4, v10
    v_mul_u32_u24 v7, 193, v2
    v_mul_u32_u24 v8, 12, v3
    v_add_u32 v7, v7, v8
    v_lshrrev_b32 v8, 2, v3
    v_xor_b32 v9, 0, v8
    v_add_u32 v9, v7, v9
    v_lshl_add_u32 v244, v9, 4, v10
    v_xor_b32 v9, 1, v8
    v_add_u32 v9, v7, v9
    v_lshl_add_u32 v245, v9, 4, v10
    v_xor_b32 v9, 2, v8
    v_add_u32 v9, v7, v9
    v_lshl_add_u32 v246, v9, 4, v10
    v_xor_b32 v9, 3, v8
    v_add_u32 v9, v7, v9
    v_lshl_add_u32 v247, v9, 4, v10
    v_lshrrev_b32 v2, 4, v0
    v_bfe_u32 v3, v0, 2, 2
    v_and_b32 v4, 3, v0
    v_mul_u32_u24 v7, 193, v4
    v_mul_u32_u24 v8, 12, v2
    v_add_u32 v7, v7, v8
    v_xor_b32 v9, 0, v3
    v_add_u32 v9, v7, v9
    v_lshl_add_u32 v16, v9, 4, v10
    v_xor_b32 v9, 1, v3
    v_add_u32 v9, v7, v9
    v_lshl_add_u32 v17, v9, 4, v10
    v_xor_b32 v9, 2, v3
    v_add_u32 v9, v7, v9
    v_lshl_add_u32 v18, v9, 4, v10
    v_xor_b32 v9, 3, v3
    v_add_u32 v9, v7, v9
    v_lshl_add_u32 v19, v9, 4, v10
    v_lshlrev_b32 v7, 13, v2
    v_lshl_add_u32 v7, v3, 6, v7
    v_lshl_add_u32 v11, v4, 4, v7
    s_lshr_b32 s62, s21, 2
    s_lshl_b32 s78, s62, 7
    s_mul_i32 s60, s62, 393216
    s_lshl_b32 s62, s20, 2
    s_and_b32 s57, s21, 3
    s_add_u32 s62, s62, s57
    s_lshl_b32 s62, s62, 2
    s_add_u32 s78, s78, s62
    s_add_u32 s78, s78, 18579456
    s_lshl_b32 s62, s20, 10
    s_add_u32 s60, s60, s62
    s_and_b32 s62, s21, 3
    s_lshl_b32 s62, s62, 8
    s_add_u32 s60, s60, s62
    s_lshr_b32 s62, s22, 2
    s_lshl_b32 s79, s62, 7
    s_mul_i32 s61, s62, 393216
    s_lshl_b32 s62, s20, 2
    s_and_b32 s57, s22, 3
    s_add_u32 s62, s62, s57
    s_lshl_b32 s62, s62, 2
    s_add_u32 s79, s79, s62
    s_add_u32 s79, s79, 18579456
    s_lshl_b32 s62, s20, 10
    s_add_u32 s61, s61, s62
    s_and_b32 s62, s22, 3
    s_lshl_b32 s62, s62, 8
    s_add_u32 s61, s61, s62
    s_mov_b32 s16, s8
    s_and_b32 s17, s9, 0xffff
    s_mov_b32 s18, 16515072
    s_mov_b32 s19, 0x00020000
    s_waitcnt vmcnt(14)
    ds_read_b64_tr_b16 v[32:33], v24 offset:0
    ds_read_b64_tr_b16 v[34:35], v24 offset:8
    ds_read_b64_tr_b16 v[36:37], v25 offset:0
    ds_read_b64_tr_b16 v[38:39], v25 offset:8
    ds_read_b64_tr_b16 v[40:41], v26 offset:0
    ds_read_b64_tr_b16 v[42:43], v26 offset:8
    ds_read_b64_tr_b16 v[44:45], v27 offset:0
    ds_read_b64_tr_b16 v[46:47], v27 offset:8
    ds_read_b64_tr_b16 v[48:49], v24 offset:64
    ds_read_b64_tr_b16 v[50:51], v24 offset:72
    ds_read_b64_tr_b16 v[52:53], v25 offset:64
    ds_read_b64_tr_b16 v[54:55], v25 offset:72
    ds_read_b64_tr_b16 v[56:57], v26 offset:64
    ds_read_b64_tr_b16 v[58:59], v26 offset:72
    ds_read_b64_tr_b16 v[60:61], v27 offset:64
    ds_read_b64_tr_b16 v[62:63], v27 offset:72
    ds_read_b64_tr_b16 v[64:65], v24 offset:128
    ds_read_b64_tr_b16 v[66:67], v24 offset:136
    ds_read_b64_tr_b16 v[68:69], v25 offset:128
    ds_read_b64_tr_b16 v[70:71], v25 offset:136
    ds_read_b64_tr_b16 v[72:73], v26 offset:128
    ds_read_b64_tr_b16 v[74:75], v26 offset:136
    ds_read_b64_tr_b16 v[76:77], v27 offset:128
    ds_read_b64_tr_b16 v[78:79], v27 offset:136
    s_waitcnt vmcnt(0) lgkmcnt(15)
    v_mfma_f32_16x16x16_bf16 v[80:83], v[32:33], v[20:21], 0
    v_mfma_f32_16x16x16_bf16 v[84:87], v[34:35], v[20:21], 0
    v_mfma_f32_16x16x16_bf16 v[88:91], v[36:37], v[20:21], 0
    v_mfma_f32_16x16x16_bf16 v[92:95], v[38:39], v[20:21], 0
    v_mfma_f32_16x16x16_bf16 v[96:99], v[40:41], v[20:21], 0
    v_mfma_f32_16x16x16_bf16 v[100:103], v[42:43], v[20:21], 0
    v_mfma_f32_16x16x16_bf16 v[104:107], v[44:45], v[20:21], 0
    v_mfma_f32_16x16x16_bf16 v[108:111], v[46:47], v[20:21], 0
    v_mfma_f32_16x16x16_bf16 v[112:115], v[48:49], v[20:21], 0
    s_waitcnt lgkmcnt(14)
    v_mfma_f32_16x16x16_bf16 v[116:119], v[50:51], v[20:21], 0
    s_waitcnt lgkmcnt(13)
    v_mfma_f32_16x16x16_bf16 v[120:123], v[52:53], v[20:21], 0
    s_waitcnt lgkmcnt(12)
    v_mfma_f32_16x16x16_bf16 v[124:127], v[54:55], v[20:21], 0
    s_waitcnt lgkmcnt(11)
    v_mfma_f32_16x16x16_bf16 v[128:131], v[56:57], v[20:21], 0
    s_waitcnt lgkmcnt(10)
    v_mfma_f32_16x16x16_bf16 v[132:135], v[58:59], v[20:21], 0
    s_waitcnt lgkmcnt(9)
    v_mfma_f32_16x16x16_bf16 v[136:139], v[60:61], v[20:21], 0
    s_waitcnt lgkmcnt(8)
    v_mfma_f32_16x16x16_bf16 v[140:143], v[62:63], v[20:21], 0
    v_cvt_pk_bf16_f32 v80, v80, v81
    v_cvt_pk_bf16_f32 v81, v82, v83
    v_cvt_pk_bf16_f32 v82, v84, v85
    v_cvt_pk_bf16_f32 v83, v86, v87
    ds_write_b128 v244, v[80:83] offset:0
    v_cvt_pk_bf16_f32 v88, v88, v89
    v_cvt_pk_bf16_f32 v89, v90, v91
    v_cvt_pk_bf16_f32 v90, v92, v93
    v_cvt_pk_bf16_f32 v91, v94, v95
    ds_write_b128 v245, v[88:91] offset:0
    v_cvt_pk_bf16_f32 v96, v96, v97
    v_cvt_pk_bf16_f32 v97, v98, v99
    v_cvt_pk_bf16_f32 v98, v100, v101
    v_cvt_pk_bf16_f32 v99, v102, v103
    ds_write_b128 v246, v[96:99] offset:0
    v_cvt_pk_bf16_f32 v104, v104, v105
    v_cvt_pk_bf16_f32 v105, v106, v107
    v_cvt_pk_bf16_f32 v106, v108, v109
    v_cvt_pk_bf16_f32 v107, v110, v111
    ds_write_b128 v247, v[104:107] offset:0
    ds_read_b128 v[144:147], v16 offset:0
    ds_read_b128 v[148:151], v17 offset:768
    ds_read_b128 v[152:155], v18 offset:1536
    ds_read_b128 v[156:159], v19 offset:2304
    s_add_u32 s62, s60, 0
    s_waitcnt lgkmcnt(3)
    buffer_store_dwordx4 v[144:147], v11, s[16:19], s62 offen sc1
    s_add_u32 s62, s60, 98304
    s_waitcnt lgkmcnt(2)
    buffer_store_dwordx4 v[148:151], v11, s[16:19], s62 offen sc1
    s_add_u32 s62, s60, 196608
    s_waitcnt lgkmcnt(1)
    buffer_store_dwordx4 v[152:155], v11, s[16:19], s62 offen sc1
    s_add_u32 s62, s60, 294912
    s_waitcnt lgkmcnt(0)
    buffer_store_dwordx4 v[156:159], v11, s[16:19], s62 offen sc1
    ds_read_b64_tr_b16 v[160:161], v24 offset:12352
    ds_read_b64_tr_b16 v[162:163], v24 offset:12360
    ds_read_b64_tr_b16 v[164:165], v25 offset:12352
    ds_read_b64_tr_b16 v[166:167], v25 offset:12360
    ds_read_b64_tr_b16 v[168:169], v26 offset:12352
    ds_read_b64_tr_b16 v[170:171], v26 offset:12360
    ds_read_b64_tr_b16 v[172:173], v27 offset:12352
    ds_read_b64_tr_b16 v[174:175], v27 offset:12360
    ds_read_b64_tr_b16 v[176:177], v24 offset:12416
    ds_read_b64_tr_b16 v[178:179], v24 offset:12424
    ds_read_b64_tr_b16 v[180:181], v25 offset:12416
    ds_read_b64_tr_b16 v[182:183], v25 offset:12424
    ds_read_b64_tr_b16 v[184:185], v26 offset:12416
    ds_read_b64_tr_b16 v[186:187], v26 offset:12424
    ds_read_b64_tr_b16 v[188:189], v27 offset:12416
    ds_read_b64_tr_b16 v[190:191], v27 offset:12424
    ds_read_b64_tr_b16 v[192:193], v24 offset:12480
    ds_read_b64_tr_b16 v[194:195], v24 offset:12488
    ds_read_b64_tr_b16 v[196:197], v25 offset:12480
    ds_read_b64_tr_b16 v[198:199], v25 offset:12488
    ds_read_b64_tr_b16 v[200:201], v26 offset:12480
    ds_read_b64_tr_b16 v[202:203], v26 offset:12488
    ds_read_b64_tr_b16 v[204:205], v27 offset:12480
    ds_read_b64_tr_b16 v[206:207], v27 offset:12488
    s_waitcnt lgkmcnt(15)
    v_mfma_f32_16x16x16_bf16 v[80:83], v[160:161], v[20:21], 0
    v_mfma_f32_16x16x16_bf16 v[84:87], v[162:163], v[20:21], 0
    v_mfma_f32_16x16x16_bf16 v[88:91], v[164:165], v[20:21], 0
    v_mfma_f32_16x16x16_bf16 v[92:95], v[166:167], v[20:21], 0
    v_mfma_f32_16x16x16_bf16 v[96:99], v[168:169], v[20:21], 0
    v_mfma_f32_16x16x16_bf16 v[100:103], v[170:171], v[20:21], 0
    v_mfma_f32_16x16x16_bf16 v[104:107], v[172:173], v[20:21], 0
    v_mfma_f32_16x16x16_bf16 v[108:111], v[174:175], v[20:21], 0
    v_cvt_pk_bf16_f32 v112, v112, v113
    v_cvt_pk_bf16_f32 v113, v114, v115
    v_cvt_pk_bf16_f32 v114, v116, v117
    v_cvt_pk_bf16_f32 v115, v118, v119
    ds_write_b128 v244, v[112:115] offset:64
    v_cvt_pk_bf16_f32 v120, v120, v121
    v_cvt_pk_bf16_f32 v121, v122, v123
    v_cvt_pk_bf16_f32 v122, v124, v125
    v_cvt_pk_bf16_f32 v123, v126, v127
    ds_write_b128 v245, v[120:123] offset:64
    v_cvt_pk_bf16_f32 v128, v128, v129
    v_cvt_pk_bf16_f32 v129, v130, v131
    v_cvt_pk_bf16_f32 v130, v132, v133
    v_cvt_pk_bf16_f32 v131, v134, v135
    ds_write_b128 v246, v[128:131] offset:64
    v_cvt_pk_bf16_f32 v136, v136, v137
    v_cvt_pk_bf16_f32 v137, v138, v139
    v_cvt_pk_bf16_f32 v138, v140, v141
    v_cvt_pk_bf16_f32 v139, v142, v143
    ds_write_b128 v247, v[136:139] offset:64
    v_cvt_pk_bf16_f32 v80, v80, v81
    v_cvt_pk_bf16_f32 v81, v82, v83
    v_cvt_pk_bf16_f32 v82, v84, v85
    v_cvt_pk_bf16_f32 v83, v86, v87
    ds_write_b128 v244, v[80:83] offset:12352
    v_cvt_pk_bf16_f32 v88, v88, v89
    v_cvt_pk_bf16_f32 v89, v90, v91
    v_cvt_pk_bf16_f32 v90, v92, v93
    v_cvt_pk_bf16_f32 v91, v94, v95
    ds_write_b128 v245, v[88:91] offset:12352
    v_cvt_pk_bf16_f32 v96, v96, v97
    v_cvt_pk_bf16_f32 v97, v98, v99
    v_cvt_pk_bf16_f32 v98, v100, v101
    v_cvt_pk_bf16_f32 v99, v102, v103
    ds_write_b128 v246, v[96:99] offset:12352
    v_cvt_pk_bf16_f32 v104, v104, v105
    v_cvt_pk_bf16_f32 v105, v106, v107
    v_cvt_pk_bf16_f32 v106, v108, v109
    v_cvt_pk_bf16_f32 v107, v110, v111
    ds_write_b128 v247, v[104:107] offset:12352
    ds_read_b128 v[208:211], v16 offset:12352
    ds_read_b128 v[212:215], v17 offset:13120
    ds_read_b128 v[216:219], v18 offset:13888
    ds_read_b128 v[220:223], v19 offset:14656
    s_add_u32 s62, s61, 0
    s_waitcnt lgkmcnt(3)
    buffer_store_dwordx4 v[208:211], v11, s[16:19], s62 offen sc1
    s_add_u32 s62, s61, 98304
    s_waitcnt lgkmcnt(2)
    buffer_store_dwordx4 v[212:215], v11, s[16:19], s62 offen sc1
    s_add_u32 s62, s61, 196608
    s_waitcnt lgkmcnt(1)
    buffer_store_dwordx4 v[216:219], v11, s[16:19], s62 offen sc1
    s_add_u32 s62, s61, 294912
    s_waitcnt lgkmcnt(0)
    buffer_store_dwordx4 v[220:223], v11, s[16:19], s62 offen sc1
    v_mfma_f32_16x16x16_bf16 v[112:115], v[176:177], v[20:21], 0
    v_mfma_f32_16x16x16_bf16 v[116:119], v[178:179], v[20:21], 0
    v_mfma_f32_16x16x16_bf16 v[120:123], v[180:181], v[20:21], 0
    v_mfma_f32_16x16x16_bf16 v[124:127], v[182:183], v[20:21], 0
    v_mfma_f32_16x16x16_bf16 v[128:131], v[184:185], v[20:21], 0
    v_mfma_f32_16x16x16_bf16 v[132:135], v[186:187], v[20:21], 0
    v_mfma_f32_16x16x16_bf16 v[136:139], v[188:189], v[20:21], 0
    v_mfma_f32_16x16x16_bf16 v[140:143], v[190:191], v[20:21], 0
    v_mfma_f32_16x16x16_bf16 v[80:83], v[64:65], v[20:21], 0
    v_mfma_f32_16x16x16_bf16 v[84:87], v[66:67], v[20:21], 0
    v_mfma_f32_16x16x16_bf16 v[88:91], v[68:69], v[20:21], 0
    v_mfma_f32_16x16x16_bf16 v[92:95], v[70:71], v[20:21], 0
    v_mfma_f32_16x16x16_bf16 v[96:99], v[72:73], v[20:21], 0
    v_mfma_f32_16x16x16_bf16 v[100:103], v[74:75], v[20:21], 0
    v_mfma_f32_16x16x16_bf16 v[104:107], v[76:77], v[20:21], 0
    v_mfma_f32_16x16x16_bf16 v[108:111], v[78:79], v[20:21], 0
    v_cvt_pk_bf16_f32 v112, v112, v113
    v_cvt_pk_bf16_f32 v113, v114, v115
    v_cvt_pk_bf16_f32 v114, v116, v117
    v_cvt_pk_bf16_f32 v115, v118, v119
    ds_write_b128 v244, v[112:115] offset:12416
    v_cvt_pk_bf16_f32 v120, v120, v121
    v_cvt_pk_bf16_f32 v121, v122, v123
    v_cvt_pk_bf16_f32 v122, v124, v125
    v_cvt_pk_bf16_f32 v123, v126, v127
    ds_write_b128 v245, v[120:123] offset:12416
    v_cvt_pk_bf16_f32 v128, v128, v129
    v_cvt_pk_bf16_f32 v129, v130, v131
    v_cvt_pk_bf16_f32 v130, v132, v133
    v_cvt_pk_bf16_f32 v131, v134, v135
    ds_write_b128 v246, v[128:131] offset:12416
    v_cvt_pk_bf16_f32 v136, v136, v137
    v_cvt_pk_bf16_f32 v137, v138, v139
    v_cvt_pk_bf16_f32 v138, v140, v141
    v_cvt_pk_bf16_f32 v139, v142, v143
    ds_write_b128 v247, v[136:139] offset:12416
    s_waitcnt lgkmcnt(0)
    s_barrier
    ds_read_b128 v[144:147], v16 offset:64
    ds_read_b128 v[148:151], v17 offset:832
    ds_read_b128 v[152:155], v18 offset:1600
    ds_read_b128 v[156:159], v19 offset:2368
    s_add_u32 s62, s60, 32768
    s_waitcnt lgkmcnt(3)
    buffer_store_dwordx4 v[144:147], v11, s[16:19], s62 offen sc1
    s_add_u32 s62, s60, 131072
    s_waitcnt lgkmcnt(2)
    buffer_store_dwordx4 v[148:151], v11, s[16:19], s62 offen sc1
    s_add_u32 s62, s60, 229376
    s_waitcnt lgkmcnt(1)
    buffer_store_dwordx4 v[152:155], v11, s[16:19], s62 offen sc1
    s_add_u32 s62, s60, 327680
    s_waitcnt lgkmcnt(0)
    buffer_store_dwordx4 v[156:159], v11, s[16:19], s62 offen sc1
    s_nop 0
    v_readfirstlane_b32 s82, v31
    s_mov_b32 s57, 0
FA_nb:
    s_cmp_lg_u32 s82, 0
    s_cbranch_scc1 FA_nokb
    s_add_u32 s57, s57, 1
    s_cmp_ge_u32 s57, 400000
    s_cbranch_scc1 FA_nokb
    s_sleep 4
    v_mov_b32 v30, 0
    global_load_dword v31, v30, s[76:77] sc1
    s_waitcnt vmcnt(0)
    v_readfirstlane_b32 s82, v31
    s_branch FA_nb
FA_nokb:
    s_waitcnt vmcnt(8)
    v_mov_b32 v1, s78
    v_mov_b32 v2, s82
    s_mov_b64 exec, 1
    global_atomic_swap v1, v2, s[8:9] sc1
    s_mov_b64 exec, -1
    v_cvt_pk_bf16_f32 v80, v80, v81
    v_cvt_pk_bf16_f32 v81, v82, v83
    v_cvt_pk_bf16_f32 v82, v84, v85
    v_cvt_pk_bf16_f32 v83, v86, v87
    ds_write_b128 v244, v[80:83] offset:128
    v_cvt_pk_bf16_f32 v88, v88, v89
    v_cvt_pk_bf16_f32 v89, v90, v91
    v_cvt_pk_bf16_f32 v90, v92, v93
    v_cvt_pk_bf16_f32 v91, v94, v95
    ds_write_b128 v245, v[88:91] offset:128
    v_cvt_pk_bf16_f32 v96, v96, v97
    v_cvt_pk_bf16_f32 v97, v98, v99
    v_cvt_pk_bf16_f32 v98, v100, v101
    v_cvt_pk_bf16_f32 v99, v102, v103
    ds_write_b128 v246, v[96:99] offset:128
    v_cvt_pk_bf16_f32 v104, v104, v105
    v_cvt_pk_bf16_f32 v105, v106, v107
    v_cvt_pk_bf16_f32 v106, v108, v109
    v_cvt_pk_bf16_f32 v107, v110, v111
    ds_write_b128 v247, v[104:107] offset:128
    v_mfma_f32_16x16x16_bf16 v[112:115], v[192:193], v[20:21], 0
    v_mfma_f32_16x16x16_bf16 v[116:119], v[194:195], v[20:21], 0
    v_mfma_f32_16x16x16_bf16 v[120:123], v[196:197], v[20:21], 0
    v_mfma_f32_16x16x16_bf16 v[124:127], v[198:199], v[20:21], 0
    v_mfma_f32_16x16x16_bf16 v[128:131], v[200:201], v[20:21], 0
    v_mfma_f32_16x16x16_bf16 v[132:135], v[202:203], v[20:21], 0
    v_mfma_f32_16x16x16_bf16 v[136:139], v[204:205], v[20:21], 0
    v_mfma_f32_16x16x16_bf16 v[140:143], v[206:207], v[20:21], 0
    s_nop 0
    v_cvt_pk_bf16_f32 v112, v112, v113
    v_cvt_pk_bf16_f32 v113, v114, v115
    v_cvt_pk_bf16_f32 v114, v116, v117
    v_cvt_pk_bf16_f32 v115, v118, v119
    ds_write_b128 v244, v[112:115] offset:12480
    v_cvt_pk_bf16_f32 v120, v120, v121
    v_cvt_pk_bf16_f32 v121, v122, v123
    v_cvt_pk_bf16_f32 v122, v124, v125
    v_cvt_pk_bf16_f32 v123, v126, v127
    ds_write_b128 v245, v[120:123] offset:12480
    v_cvt_pk_bf16_f32 v128, v128, v129
    v_cvt_pk_bf16_f32 v129, v130, v131
    v_cvt_pk_bf16_f32 v130, v132, v133
    v_cvt_pk_bf16_f32 v131, v134, v135
    ds_write_b128 v246, v[128:131] offset:12480
    v_cvt_pk_bf16_f32 v136, v136, v137
    v_cvt_pk_bf16_f32 v137, v138, v139
    v_cvt_pk_bf16_f32 v138, v140, v141
    v_cvt_pk_bf16_f32 v139, v142, v143
    ds_write_b128 v247, v[136:139] offset:12480
    s_waitcnt vmcnt(5)
    v_mov_b32 v1, s79
    v_mov_b32 v2, s82
    s_mov_b64 exec, 1
    global_atomic_swap v1, v2, s[8:9] sc1
    s_mov_b64 exec, -1
    s_mov_b32 s80, 2
    s_mov_b32 s81, 0
    s_branch FU_pb
FA_xw:
    s_mul_i32 s63, s20, 21
    s_add_u32 s63, s63, s83
    s_sub_u32 s63, s63, 40
    s_and_b32 s64, s63, 1
    s_lshr_b32 s63, s63, 1
    s_and_b32 s65, s63, 3
    s_lshr_b32 s63, s63, 2
    s_mul_i32 s66, s63, 86
    s_lshr_b32 s66, s66, 8
    s_mul_i32 s67, s66, 3
    s_sub_u32 s67, s63, s67
    v_lshlrev_b32 v22, 4, v0
    v_add_u32 v23, 1024, v22
    s_mul_i32 s68, s66, 129024
    s_mul_i32 s69, s67, 6144
    s_add_u32 s68, s68, s69
    s_mul_i32 s69, s65, 1536
    s_add_u32 s68, s68, s69
    s_mov_b32 s72, s86
    s_and_b32 s73, s87, 0xffff
    s_mov_b32 s74, 903168
    s_mov_b32 s75, 0x00020000
    s_add_u32 m0, s56, 12352
    s_add_u32 s69, s68, 0
    buffer_load_dwordx4 v22, s[72:75], s69 offen lds
    s_add_u32 m0, s56, 13376
    s_add_u32 s69, s68, 0
    buffer_load_dwordx4 v23, s[72:75], s69 offen lds
    s_add_u32 m0, s56, 14432
    s_add_u32 s69, s68, 18432
    buffer_load_dwordx4 v22, s[72:75], s69 offen lds
    s_add_u32 m0, s56, 15456
    s_add_u32 s69, s68, 18432
    buffer_load_dwordx4 v23, s[72:75], s69 offen lds
    s_add_u32 m0, s56, 16512
    s_add_u32 s69, s68, 36864
    buffer_load_dwordx4 v22, s[72:75], s69 offen lds
    s_add_u32 m0, s56, 17536
    s_add_u32 s69, s68, 36864
    buffer_load_dwordx4 v23, s[72:75], s69 offen lds
    s_add_u32 m0, s56, 18592
    s_add_u32 s69, s68, 55296
    buffer_load_dwordx4 v22, s[72:75], s69 offen lds
    s_add_u32 m0, s56, 19616
    s_add_u32 s69, s68, 55296
    buffer_load_dwordx4 v23, s[72:75], s69 offen lds
    s_add_u32 m0, s56, 20672
    s_add_u32 s69, s68, 73728
    buffer_load_dwordx4 v22, s[72:75], s69 offen lds
    s_add_u32 m0, s56, 21696
    s_add_u32 s69, s68, 73728
    buffer_load_dwordx4 v23, s[72:75], s69 offen lds
    s_add_u32 m0, s56, 22752
    s_add_u32 s69, s68, 92160
    buffer_load_dwordx4 v22, s[72:75], s69 offen lds
    s_add_u32 m0, s56, 23776
    s_add_u32 s69, s68, 92160
    buffer_load_dwordx4 v23, s[72:75], s69 offen lds
    s_add_u32 m0, s56, 24832
    s_add_u32 s69, s68, 110592
    buffer_load_dwordx4 v22, s[72:75], s69 offen lds
    s_add_u32 m0, s56, 25856
    s_add_u32 s69, s68, 110592
    buffer_load_dwordx4 v23, s[72:75], s69 offen lds
    v_lshlrev_b32 v2, 3, v0
    s_add_u32 s58, s10, FU_gt-FU_pc
    s_addc_u32 s59, s11, 0
    global_load_dwordx2 v[22:23], v2, s[58:59]
    s_add_u32 m0, s56, 0
    v_mad_i32_i24 v8, v16, s48, v12
    buffer_load_dwordx4 v8, s[12:15], s40 offen lds
    s_add_u32 m0, s56, 1024
    v_mad_i32_i24 v9, v17, s48, v13
    buffer_load_dwordx4 v9, s[12:15], s40 offen lds
    s_add_u32 m0, s56, 2048
    s_nop 0
    buffer_load_dwordx4 v14, s[12:15], s40 offen lds
    s_add_u32 m0, s56, 3088
    v_mad_i32_i24 v9, v16, s49, v12
    buffer_load_dwordx4 v9, s[12:15], s41 offen lds
    s_add_u32 m0, s56, 4112
    v_mad_i32_i24 v8, v17, s49, v13
    buffer_load_dwordx4 v8, s[12:15], s41 offen lds
    s_add_u32 m0, s56, 5136
    s_nop 0
    buffer_load_dwordx4 v14, s[12:15], s41 offen lds
    s_add_u32 m0, s56, 6176
    v_mad_i32_i24 v8, v16, s50, v12
    buffer_load_dwordx4 v8, s[12:15], s42 offen lds
    s_add_u32 m0, s56, 7200
    v_mad_i32_i24 v9, v17, s50, v13
    buffer_load_dwordx4 v9, s[12:15], s42 offen lds
    s_add_u32 m0, s56, 8224
    s_nop 0
    buffer_load_dwordx4 v14, s[12:15], s42 offen lds
    s_add_u32 m0, s56, 9264
    v_mad_i32_i24 v9, v16, s51, v12
    buffer_load_dwordx4 v9, s[12:15], s43 offen lds
    s_add_u32 m0, s56, 10288
    v_mad_i32_i24 v8, v17, s51, v13
    buffer_load_dwordx4 v8, s[12:15], s43 offen lds
    s_add_u32 m0, s56, 11312
    s_nop 0
    buffer_load_dwordx4 v14, s[12:15], s43 offen lds
    v_mov_b32 v30, 0
    global_load_dword v31, v30, s[76:77] sc1
    v_lshlrev_b32 v1, 3, v0
    s_add_u32 s58, s10, FU_bt-FU_pc
    s_addc_u32 s59, s11, 0
    global_load_dwordx2 v[20:21], v1, s[58:59]
    v_lshrrev_b32 v2, 4, v0
    v_and_b32 v3, 15, v0
    v_lshrrev_b32 v4, 2, v3
    v_and_b32 v5, 3, v0
    v_lshl_add_u32 v6, v2, 2, v4
    v_mul_u32_u24 v7, 193, v5
    v_mul_u32_u24 v8, 12, v6
    v_add_u32 v7, v7, v8
    v_mov_b32 v10, s56
    v_xor_b32 v9, 0, v2
    v_add_u32 v9, v7, v9
    v_lshl_add_u32 v24, v9, 4, v10
    v_xor_b32 v9, 1, v2
    v_add_u32 v9, v7, v9
    v_lshl_add_u32 v25, v9, 4, v10
    v_xor_b32 v9, 2, v2
    v_add_u32 v9, v7, v9
    v_lshl_add_u32 v26, v9, 4, v10
    v_xor_b32 v9, 3, v2
    v_add_u32 v9, v7, v9
    v_lshl_add_u32 v27, v9, 4, v10
    v_mul_u32_u24 v7, 193, v2
    v_mul_u32_u24 v8, 12, v3
    v_add_u32 v7, v7, v8
    v_lshrrev_b32 v8, 2, v3
    v_xor_b32 v9, 0, v8
    v_add_u32 v9, v7, v9
    v_lshl_add_u32 v244, v9, 4, v10
    v_xor_b32 v9, 1, v8
    v_add_u32 v9, v7, v9
    v_lshl_add_u32 v245, v9, 4, v10
    v_xor_b32 v9, 2, v8
    v_add_u32 v9, v7, v9
    v_lshl_add_u32 v246, v9, 4, v10
    v_xor_b32 v9, 3, v8
    v_add_u32 v9, v7, v9
    v_lshl_add_u32 v247, v9, 4, v10
    v_lshrrev_b32 v2, 4, v0
    v_bfe_u32 v3, v0, 2, 2
    v_and_b32 v4, 3, v0
    v_mul_u32_u24 v7, 193, v4
    v_mul_u32_u24 v8, 12, v2
    v_add_u32 v7, v7, v8
    v_xor_b32 v9, 0, v3
    v_add_u32 v9, v7, v9
    v_lshl_add_u32 v16, v9, 4, v10
    v_xor_b32 v9, 1, v3
    v_add_u32 v9, v7, v9
    v_lshl_add_u32 v17, v9, 4, v10
    v_xor_b32 v9, 2, v3
    v_add_u32 v9, v7, v9
    v_lshl_add_u32 v18, v9, 4, v10
    v_xor_b32 v9, 3, v3
    v_add_u32 v9, v7, v9
    v_lshl_add_u32 v19, v9, 4, v10
    v_lshlrev_b32 v7, 13, v2
    v_lshl_add_u32 v7, v3, 6, v7
    v_lshl_add_u32 v11, v4, 4, v7
    s_lshr_b32 s62, s21, 2
    s_lshl_b32 s78, s62, 7
    s_mul_i32 s60, s62, 393216
    s_lshl_b32 s62, s20, 2
    s_and_b32 s57, s21, 3
    s_add_u32 s62, s62, s57
    s_lshl_b32 s62, s62, 2
    s_add_u32 s78, s78, s62
    s_add_u32 s78, s78, 18579456
    s_lshl_b32 s62, s20, 10
    s_add_u32 s60, s60, s62
    s_and_b32 s62, s21, 3
    s_lshl_b32 s62, s62, 8
    s_add_u32 s60, s60, s62
    s_lshr_b32 s62, s22, 2
    s_lshl_b32 s79, s62, 7
    s_mul_i32 s61, s62, 393216
    s_lshl_b32 s62, s20, 2
    s_and_b32 s57, s22, 3
    s_add_u32 s62, s62, s57
    s_lshl_b32 s62, s62, 2
    s_add_u32 s79, s79, s62
    s_add_u32 s79, s79, 18579456
    s_lshl_b32 s62, s20, 10
    s_add_u32 s61, s61, s62
    s_and_b32 s62, s22, 3
    s_lshl_b32 s62, s62, 8
    s_add_u32 s61, s61, s62
    s_mov_b32 s16, s8
    s_and_b32 s17, s9, 0xffff
    s_mov_b32 s18, 16515072
    s_mov_b32 s19, 0x00020000
    v_bfe_u32 v3, v0, 4, 1
    v_bfe_u32 v4, v0, 2, 2
    v_lshl_add_u32 v3, v3, 2, v4
    v_min_u32 v3, 6, v3
    v_mul_u32_u24 v3, 2080, v3
    v_and_b32 v4, 3, v0
    v_lshl_add_u32 v3, v4, 3, v3
    s_mul_i32 s69, s64, 96
    s_add_u32 s69, s69, s56
    v_add_u32 v240, s69, v3
    v_lshrrev_b32 v4, 4, v0
    v_mul_u32_u24 v241, 86016, v4
    v_and_b32 v4, 15, v0
    v_lshl_add_u32 v241, v4, 4, v241
    s_mul_i32 s68, s64, 1032192
    s_mul_i32 s69, s67, 28672
    s_add_u32 s68, s68, s69
    s_lshl_b32 s69, s66, 10
    s_add_u32 s68, s68, s69
    s_lshl_b32 s69, s65, 8
    s_add_u32 s68, s68, s69
    s_add_u32 s72, s8, 16515072
    s_addc_u32 s73, s9, 0
    s_and_b32 s73, s73, 0xffff
    s_mov_b32 s74, 2064384
    s_waitcnt vmcnt(15)
    ds_read_b64_tr_b16 v[160:161], v240 offset:12352
    ds_read_b64_tr_b16 v[162:163], v240 offset:12544
    ds_read_b64_tr_b16 v[164:165], v240 offset:12736
    ds_read_b64_tr_b16 v[166:167], v240 offset:12928
    ds_read_b64_tr_b16 v[168:169], v240 offset:13120
    ds_read_b64_tr_b16 v[170:171], v240 offset:13312
    ds_read_b64_tr_b16 v[172:173], v240 offset:13504
    ds_read_b64_tr_b16 v[174:175], v240 offset:13696
    ds_read_b64_tr_b16 v[176:177], v240 offset:12384
    ds_read_b64_tr_b16 v[178:179], v240 offset:12576
    ds_read_b64_tr_b16 v[180:181], v240 offset:12768
    ds_read_b64_tr_b16 v[182:183], v240 offset:12960
    ds_read_b64_tr_b16 v[184:185], v240 offset:13152
    ds_read_b64_tr_b16 v[186:187], v240 offset:13344
    ds_read_b64_tr_b16 v[188:189], v240 offset:13536
    ds_read_b64_tr_b16 v[190:191], v240 offset:13728
    ds_read_b64_tr_b16 v[192:193], v240 offset:12416
    ds_read_b64_tr_b16 v[194:195], v240 offset:12608
    ds_read_b64_tr_b16 v[196:197], v240 offset:12800
    ds_read_b64_tr_b16 v[198:199], v240 offset:12992
    ds_read_b64_tr_b16 v[200:201], v240 offset:13184
    ds_read_b64_tr_b16 v[202:203], v240 offset:13376
    ds_read_b64_tr_b16 v[204:205], v240 offset:13568
    ds_read_b64_tr_b16 v[206:207], v240 offset:13760
    s_waitcnt vmcnt(14) lgkmcnt(15)
    v_mfma_f32_16x16x16_bf16 v[80:83], v[22:23], v[160:161], 0
    v_mfma_f32_16x16x16_bf16 v[84:87], v[22:23], v[162:163], 0
    v_mfma_f32_16x16x16_bf16 v[88:91], v[22:23], v[164:165], 0
    v_mfma_f32_16x16x16_bf16 v[92:95], v[22:23], v[166:167], 0
    v_mfma_f32_16x16x16_bf16 v[96:99], v[22:23], v[168:169], 0
    v_mfma_f32_16x16x16_bf16 v[100:103], v[22:23], v[170:171], 0
    v_mfma_f32_16x16x16_bf16 v[104:107], v[22:23], v[172:173], 0
    v_mfma_f32_16x16x16_bf16 v[108:111], v[22:23], v[174:175], 0
    s_nop 1
    v_cvt_pk_bf16_f32 v224, v80, v84
    s_nop 0
    v_cvt_pk_bf16_f32 v225, v88, v92
    s_nop 0
    v_cvt_pk_bf16_f32 v226, v96, v100
    s_nop 0
    v_cvt_pk_bf16_f32 v227, v104, v108
    s_add_u32 s69, s68, 0
    buffer_store_dwordx4 v[224:227], v241, s[72:75], s69 offen sc1
    v_cvt_pk_bf16_f32 v228, v81, v85
    v_cvt_pk_bf16_f32 v229, v89, v93
    v_cvt_pk_bf16_f32 v230, v97, v101
    v_cvt_pk_bf16_f32 v231, v105, v109
    s_add_u32 s69, s68, 7168
    buffer_store_dwordx4 v[228:231], v241, s[72:75], s69 offen sc1
    v_cvt_pk_bf16_f32 v232, v82, v86
    v_cvt_pk_bf16_f32 v233, v90, v94
    v_cvt_pk_bf16_f32 v234, v98, v102
    v_cvt_pk_bf16_f32 v235, v106, v110
    s_add_u32 s69, s68, 14336
    buffer_store_dwordx4 v[232:235], v241, s[72:75], s69 offen sc1
    v_cvt_pk_bf16_f32 v236, v83, v87
    v_cvt_pk_bf16_f32 v237, v91, v95
    v_cvt_pk_bf16_f32 v238, v99, v103
    v_cvt_pk_bf16_f32 v239, v107, v111
    s_add_u32 s69, s68, 21504
    buffer_store_dwordx4 v[236:239], v241, s[72:75], s69 offen sc1
    v_mfma_f32_16x16x16_bf16 v[112:115], v[22:23], v[176:177], 0
    s_waitcnt lgkmcnt(14)
    v_mfma_f32_16x16x16_bf16 v[116:119], v[22:23], v[178:179], 0
    s_waitcnt lgkmcnt(13)
    v_mfma_f32_16x16x16_bf16 v[120:123], v[22:23], v[180:181], 0
    s_waitcnt lgkmcnt(12)
    v_mfma_f32_16x16x16_bf16 v[124:127], v[22:23], v[182:183], 0
    s_waitcnt lgkmcnt(11)
    v_mfma_f32_16x16x16_bf16 v[128:131], v[22:23], v[184:185], 0
    s_waitcnt lgkmcnt(10)
    v_mfma_f32_16x16x16_bf16 v[132:135], v[22:23], v[186:187], 0
    s_waitcnt lgkmcnt(9)
    v_mfma_f32_16x16x16_bf16 v[136:139], v[22:23], v[188:189], 0
    s_waitcnt lgkmcnt(8)
    v_mfma_f32_16x16x16_bf16 v[140:143], v[22:23], v[190:191], 0
    v_cvt_pk_bf16_f32 v224, v112, v116
    v_cvt_pk_bf16_f32 v225, v120, v124
    s_nop 1
    v_cvt_pk_bf16_f32 v226, v128, v132
    s_nop 2
    v_cvt_pk_bf16_f32 v227, v136, v140
    s_add_u32 s69, s68, 344064
    buffer_store_dwordx4 v[224:227], v241, s[72:75], s69 offen sc1
    v_cvt_pk_bf16_f32 v228, v113, v117
    v_cvt_pk_bf16_f32 v229, v121, v125
    v_cvt_pk_bf16_f32 v230, v129, v133
    v_cvt_pk_bf16_f32 v231, v137, v141
    s_add_u32 s69, s68, 351232
    buffer_store_dwordx4 v[228:231], v241, s[72:75], s69 offen sc1
    v_cvt_pk_bf16_f32 v232, v114, v118
    v_cvt_pk_bf16_f32 v233, v122, v126
    v_cvt_pk_bf16_f32 v234, v130, v134
    v_cvt_pk_bf16_f32 v235, v138, v142
    s_add_u32 s69, s68, 358400
    buffer_store_dwordx4 v[232:235], v241, s[72:75], s69 offen sc1
    v_cvt_pk_bf16_f32 v236, v115, v119
    v_cvt_pk_bf16_f32 v237, v123, v127
    v_cvt_pk_bf16_f32 v238, v131, v135
    v_cvt_pk_bf16_f32 v239, v139, v143
    s_add_u32 s69, s68, 365568
    buffer_store_dwordx4 v[236:239], v241, s[72:75], s69 offen sc1
    s_waitcnt lgkmcnt(7)
    v_mfma_f32_16x16x16_bf16 v[80:83], v[22:23], v[192:193], 0
    s_waitcnt lgkmcnt(6)
    v_mfma_f32_16x16x16_bf16 v[84:87], v[22:23], v[194:195], 0
    s_waitcnt lgkmcnt(5)
    v_mfma_f32_16x16x16_bf16 v[88:91], v[22:23], v[196:197], 0
    s_waitcnt lgkmcnt(4)
    v_mfma_f32_16x16x16_bf16 v[92:95], v[22:23], v[198:199], 0
    s_waitcnt lgkmcnt(3)
    v_mfma_f32_16x16x16_bf16 v[96:99], v[22:23], v[200:201], 0
    s_waitcnt lgkmcnt(2)
    v_mfma_f32_16x16x16_bf16 v[100:103], v[22:23], v[202:203], 0
    s_waitcnt lgkmcnt(1)
    v_mfma_f32_16x16x16_bf16 v[104:107], v[22:23], v[204:205], 0
    s_waitcnt lgkmcnt(0)
    v_mfma_f32_16x16x16_bf16 v[108:111], v[22:23], v[206:207], 0
    v_cvt_pk_bf16_f32 v224, v80, v84
    v_cvt_pk_bf16_f32 v225, v88, v92
    s_nop 1
    v_cvt_pk_bf16_f32 v226, v96, v100
    s_nop 2
    v_cvt_pk_bf16_f32 v227, v104, v108
    s_add_u32 s69, s68, 688128
    buffer_store_dwordx4 v[224:227], v241, s[72:75], s69 offen sc1
    v_cvt_pk_bf16_f32 v228, v81, v85
    v_cvt_pk_bf16_f32 v229, v89, v93
    v_cvt_pk_bf16_f32 v230, v97, v101
    v_cvt_pk_bf16_f32 v231, v105, v109
    s_add_u32 s69, s68, 695296
    buffer_store_dwordx4 v[228:231], v241, s[72:75], s69 offen sc1
    v_cvt_pk_bf16_f32 v232, v82, v86
    v_cvt_pk_bf16_f32 v233, v90, v94
    v_cvt_pk_bf16_f32 v234, v98, v102
    v_cvt_pk_bf16_f32 v235, v106, v110
    s_add_u32 s69, s68, 702464
    buffer_store_dwordx4 v[232:235], v241, s[72:75], s69 offen sc1
    v_cvt_pk_bf16_f32 v236, v83, v87
    v_cvt_pk_bf16_f32 v237, v91, v95
    v_cvt_pk_bf16_f32 v238, v99, v103
    v_cvt_pk_bf16_f32 v239, v107, v111
    s_add_u32 s69, s68, 709632
    buffer_store_dwordx4 v[236:239], v241, s[72:75], s69 offen sc1
    s_waitcnt vmcnt(14)
    ds_read_b64_tr_b16 v[32:33], v24 offset:0
    ds_read_b64_tr_b16 v[34:35], v24 offset:8
    ds_read_b64_tr_b16 v[36:37], v25 offset:0
    ds_read_b64_tr_b16 v[38:39], v25 offset:8
    ds_read_b64_tr_b16 v[40:41], v26 offset:0
    ds_read_b64_tr_b16 v[42:43], v26 offset:8
    ds_read_b64_tr_b16 v[44:45], v27 offset:0
    ds_read_b64_tr_b16 v[46:47], v27 offset:8
    ds_read_b64_tr_b16 v[48:49], v24 offset:64
    ds_read_b64_tr_b16 v[50:51], v24 offset:72
    ds_read_b64_tr_b16 v[52:53], v25 offset:64
    ds_read_b64_tr_b16 v[54:55], v25 offset:72
    ds_read_b64_tr_b16 v[56:57], v26 offset:64
    ds_read_b64_tr_b16 v[58:59], v26 offset:72
    ds_read_b64_tr_b16 v[60:61], v27 offset:64
    ds_read_b64_tr_b16 v[62:63], v27 offset:72
    ds_read_b64_tr_b16 v[64:65], v24 offset:128
    ds_read_b64_tr_b16 v[66:67], v24 offset:136
    ds_read_b64_tr_b16 v[68:69], v25 offset:128
    ds_read_b64_tr_b16 v[70:71], v25 offset:136
    ds_read_b64_tr_b16 v[72:73], v26 offset:128
    ds_read_b64_tr_b16 v[74:75], v26 offset:136
    ds_read_b64_tr_b16 v[76:77], v27 offset:128
    ds_read_b64_tr_b16 v[78:79], v27 offset:136
    s_waitcnt vmcnt(12) lgkmcnt(15)
    v_mfma_f32_16x16x16_bf16 v[80:83], v[32:33], v[20:21], 0
    v_mfma_f32_16x16x16_bf16 v[84:87], v[34:35], v[20:21], 0
    v_mfma_f32_16x16x16_bf16 v[88:91], v[36:37], v[20:21], 0
    v_mfma_f32_16x16x16_bf16 v[92:95], v[38:39], v[20:21], 0
    v_mfma_f32_16x16x16_bf16 v[96:99], v[40:41], v[20:21], 0
    v_mfma_f32_16x16x16_bf16 v[100:103], v[42:43], v[20:21], 0
    v_mfma_f32_16x16x16_bf16 v[104:107], v[44:45], v[20:21], 0
    v_mfma_f32_16x16x16_bf16 v[108:111], v[46:47], v[20:21], 0
    v_mfma_f32_16x16x16_bf16 v[112:115], v[48:49], v[20:21], 0
    s_waitcnt lgkmcnt(14)
    v_mfma_f32_16x16x16_bf16 v[116:119], v[50:51], v[20:21], 0
    s_waitcnt lgkmcnt(13)
    v_mfma_f32_16x16x16_bf16 v[120:123], v[52:53], v[20:21], 0
    s_waitcnt lgkmcnt(12)
    v_mfma_f32_16x16x16_bf16 v[124:127], v[54:55], v[20:21], 0
    s_waitcnt lgkmcnt(11)
    v_mfma_f32_16x16x16_bf16 v[128:131], v[56:57], v[20:21], 0
    s_waitcnt lgkmcnt(10)
    v_mfma_f32_16x16x16_bf16 v[132:135], v[58:59], v[20:21], 0
    s_waitcnt lgkmcnt(9)
    v_mfma_f32_16x16x16_bf16 v[136:139], v[60:61], v[20:21], 0
    s_waitcnt lgkmcnt(8)
    v_mfma_f32_16x16x16_bf16 v[140:143], v[62:63], v[20:21], 0
    v_cvt_pk_bf16_f32 v80, v80, v81
    v_cvt_pk_bf16_f32 v81, v82, v83
    v_cvt_pk_bf16_f32 v82, v84, v85
    v_cvt_pk_bf16_f32 v83, v86, v87
    ds_write_b128 v244, v[80:83] offset:0
    v_cvt_pk_bf16_f32 v88, v88, v89
    v_cvt_pk_bf16_f32 v89, v90, v91
    v_cvt_pk_bf16_f32 v90, v92, v93
    v_cvt_pk_bf16_f32 v91, v94, v95
    ds_write_b128 v245, v[88:91] offset:0
    v_cvt_pk_bf16_f32 v96, v96, v97
    v_cvt_pk_bf16_f32 v97, v98, v99
    v_cvt_pk_bf16_f32 v98, v100, v101
    v_cvt_pk_bf16_f32 v99, v102, v103
    ds_write_b128 v246, v[96:99] offset:0
    v_cvt_pk_bf16_f32 v104, v104, v105
    v_cvt_pk_bf16_f32 v105, v106, v107
    v_cvt_pk_bf16_f32 v106, v108, v109
    v_cvt_pk_bf16_f32 v107, v110, v111
    ds_write_b128 v247, v[104:107] offset:0
    ds_read_b128 v[144:147], v16 offset:0
    ds_read_b128 v[148:151], v17 offset:768
    ds_read_b128 v[152:155], v18 offset:1536
    ds_read_b128 v[156:159], v19 offset:2304
    s_add_u32 s62, s60, 0
    s_waitcnt lgkmcnt(3)
    buffer_store_dwordx4 v[144:147], v11, s[16:19], s62 offen sc1
    s_add_u32 s62, s60, 98304
    s_waitcnt lgkmcnt(2)
    buffer_store_dwordx4 v[148:151], v11, s[16:19], s62 offen sc1
    s_add_u32 s62, s60, 196608
    s_waitcnt lgkmcnt(1)
    buffer_store_dwordx4 v[152:155], v11, s[16:19], s62 offen sc1
    s_add_u32 s62, s60, 294912
    s_waitcnt lgkmcnt(0)
    buffer_store_dwordx4 v[156:159], v11, s[16:19], s62 offen sc1
    v_mfma_f32_16x16x16_bf16 v[80:83], v[64:65], v[20:21], 0
    v_mfma_f32_16x16x16_bf16 v[84:87], v[66:67], v[20:21], 0
    v_mfma_f32_16x16x16_bf16 v[88:91], v[68:69], v[20:21], 0
    v_mfma_f32_16x16x16_bf16 v[92:95], v[70:71], v[20:21], 0
    v_mfma_f32_16x16x16_bf16 v[96:99], v[72:73], v[20:21], 0
    v_mfma_f32_16x16x16_bf16 v[100:103], v[74:75], v[20:21], 0
    v_mfma_f32_16x16x16_bf16 v[104:107], v[76:77], v[20:21], 0
    v_mfma_f32_16x16x16_bf16 v[108:111], v[78:79], v[20:21], 0
    v_cvt_pk_bf16_f32 v112, v112, v113
    v_cvt_pk_bf16_f32 v113, v114, v115
    v_cvt_pk_bf16_f32 v114, v116, v117
    v_cvt_pk_bf16_f32 v115, v118, v119
    ds_write_b128 v244, v[112:115] offset:64
    v_cvt_pk_bf16_f32 v120, v120, v121
    v_cvt_pk_bf16_f32 v121, v122, v123
    v_cvt_pk_bf16_f32 v122, v124, v125
    v_cvt_pk_bf16_f32 v123, v126, v127
    ds_write_b128 v245, v[120:123] offset:64
    v_cvt_pk_bf16_f32 v128, v128, v129
    v_cvt_pk_bf16_f32 v129, v130, v131
    v_cvt_pk_bf16_f32 v130, v132, v133
    v_cvt_pk_bf16_f32 v131, v134, v135
    ds_write_b128 v246, v[128:131] offset:64
    v_cvt_pk_bf16_f32 v136, v136, v137
    v_cvt_pk_bf16_f32 v137, v138, v139
    v_cvt_pk_bf16_f32 v138, v140, v141
    v_cvt_pk_bf16_f32 v139, v142, v143
    ds_write_b128 v247, v[136:139] offset:64
    s_waitcnt lgkmcnt(0)
    s_barrier
    v_cvt_pk_bf16_f32 v80, v80, v81
    v_cvt_pk_bf16_f32 v81, v82, v83
    v_cvt_pk_bf16_f32 v82, v84, v85
    v_cvt_pk_bf16_f32 v83, v86, v87
    ds_write_b128 v244, v[80:83] offset:128
    v_cvt_pk_bf16_f32 v88, v88, v89
    v_cvt_pk_bf16_f32 v89, v90, v91
    v_cvt_pk_bf16_f32 v90, v92, v93
    v_cvt_pk_bf16_f32 v91, v94, v95
    ds_write_b128 v245, v[88:91] offset:128
    v_cvt_pk_bf16_f32 v96, v96, v97
    v_cvt_pk_bf16_f32 v97, v98, v99
    v_cvt_pk_bf16_f32 v98, v100, v101
    v_cvt_pk_bf16_f32 v99, v102, v103
    ds_write_b128 v246, v[96:99] offset:128
    v_cvt_pk_bf16_f32 v104, v104, v105
    v_cvt_pk_bf16_f32 v105, v106, v107
    v_cvt_pk_bf16_f32 v106, v108, v109
    v_cvt_pk_bf16_f32 v107, v110, v111
    ds_write_b128 v247, v[104:107] offset:128
    s_nop 0
    v_readfirstlane_b32 s82, v31
    s_mov_b32 s57, 0
FA_nc:
    s_cmp_lg_u32 s82, 0
    s_cbranch_scc1 FA_nokc
    s_add_u32 s57, s57, 1
    s_cmp_ge_u32 s57, 400000
    s_cbranch_scc1 FA_nokc
    s_sleep 4
    v_mov_b32 v30, 0
    global_load_dword v31, v30, s[76:77] sc1
    s_waitcnt vmcnt(0)
    v_readfirstlane_b32 s82, v31
    s_branch FA_nc
FA_nokc:
    s_waitcnt vmcnt(4)
    s_lshl_b32 s79, s66, 2
    s_add_u32 s79, s79, s65
    s_lshl_b32 s79, s79, 1
    s_add_u32 s79, s79, s64
    s_lshl_b32 s79, s79, 2
    s_lshl_b32 s69, s67, 8
    s_add_u32 s79, s79, s69
    s_add_u32 s79, s79, 18591744
    v_lshlrev_b32 v1, 10, v0
    v_add_u32 v1, s79, v1
    v_mov_b32 v2, s82
    s_mov_b64 exec, 0xff
    global_atomic_swap v1, v2, s[8:9] sc1
    s_mov_b64 exec, -1
    s_waitcnt vmcnt(1)
    v_mov_b32 v1, s78
    v_mov_b32 v2, s82
    s_mov_b64 exec, 1
    global_atomic_swap v1, v2, s[8:9] sc1
    s_mov_b64 exec, -1
    s_mov_b32 s79, 0
    s_mov_b32 s61, 0x40000000
    s_mov_b32 s80, 3
    s_mov_b32 s81, 0
    s_branch FU_pb
FU_pb:
    s_waitcnt lgkmcnt(0)
    s_mov_b32 s88, s60
    s_mov_b32 s89, s61
    s_mov_b64 s[92:93], s[10:11]
    s_lshr_b32 s90, s2, 3
    s_lshl_b32 s90, s90, 2
    s_add_u32 s90, s90, s24
    s_lshl_b32 s90, s90, 7
    s_mov_b32 s84, s8
    s_and_b32 s85, s9, 0xffff
    s_mov_b32 s86, 16515072
    s_mov_b32 s87, 0x00020000
    s_cmp_ge_u32 s2, 8
    s_cbranch_scc1 K2_nocpf
    s_lshl_b32 s33, s24, 13
    v_lshlrev_b32 v4, 7, v0
    v_add_u32 v4, s33, v4
    v_min_u32 v4, K2_code_end-FU_pc-4, v4
    global_load_dword v72, v4, s[10:11]
K2_nocpf:
    s_and_b32 s25, s2, 7
    s_lshr_b32 s26, s2, 3
    s_mul_i32 s27, s26, 43
    s_lshr_b32 s27, s27, 8
    s_mul_i32 s28, s27, 6
    s_sub_u32 s28, s26, s28
    s_lshl_b32 s27, s27, 3
    s_add_u32 s27, s27, s25
    s_cmp_lt_u32 s26, 30
    s_cbranch_scc1 K2_map
    s_lshl_b32 s29, s25, 1
    s_add_u32 s29, s29, s26
    s_sub_u32 s29, s29, 30
    s_mul_i32 s27, s29, 43
    s_lshr_b32 s27, s27, 8
    s_mul_i32 s28, s27, 6
    s_sub_u32 s28, s29, s28
    s_add_u32 s27, s27, 40
K2_map:
    s_cmp_ge_u32 s27, 42
    s_cbranch_scc1 FU_idle
    v_lshlrev_b32 v1, 4, v0
    v_and_b32 v3, 15, v0
    v_cmp_ne_u32 vcc, 0, v3
    v_lshrrev_b32 v4, 4, v0
    v_lshlrev_b32 v4, 6, v4
    v_lshrrev_b32 v5, 2, v3
    v_lshl_add_u32 v5, v5, 8, v4
    v_and_b32 v6, 3, v0
    v_lshl_add_u32 v247, v6, 4, v5
    v_min_u32 v3, 5, v3
    v_add_u32 v3, 2, v3
    v_lshlrev_b32 v3, 10, v3
    v_add_u32 v3, v3, v4
    v_add_u32 v2, 816, v3
    s_lshl_b32 s29, s27, 2
    s_add_u32 s29, s29, s24
    s_mul_i32 s29, s29, 98304
    s_max_u32 s30, s27, 1
    s_sub_u32 s30, s30, 1
    s_lshl_b32 s30, s30, 2
    s_add_u32 s30, s30, s24
    s_mul_i32 s30, s30, 98304
    s_lshl_b32 s31, s28, 2
    s_add_u32 s31, s31, s24
    s_mul_i32 s31, s31, 86016
    s_add_u32 s31, s31, 16515072
    s_mov_b32 s32, 0
    s_mov_b32 s36, 1
    s_mov_b32 s39, 2
    s_mul_i32 s14, s32, 32768
    s_add_u32 s14, s14, s29
    s_mul_i32 s18, s32, 28672
    s_add_u32 s18, s18, s31
    s_add_u32 s12, s8, s14
    s_addc_u32 s13, s9, 0
    s_and_b32 s13, s13, 0xffff
    s_mov_b32 s14, 32768
    s_mov_b32 s15, 0x00020000
    s_add_u32 s16, s8, s18
    s_addc_u32 s17, s9, 0
    s_and_b32 s17, s17, 0xffff
    s_mov_b32 s18, 28672
    s_mov_b32 s19, 0x00020000
    s_mov_b32 s25, 4096
    s_mov_b32 s26, 8192
    s_mov_b32 s64, 12288
    s_add_u32 s10, s10, K2_at-FU_pc
    s_addc_u32 s11, s11, 0
    s_lshl_b32 s33, s24, 10
    v_add_u32 v3, s33, v1
    global_load_dwordx4 v[4:7], v3, s[10:11]
    s_mov_b32 s65, 16384
    s_mov_b32 s66, 20480
    s_mov_b32 s67, 24576
    s_mov_b32 s68, 28672
    s_mul_i32 s22, s32, 32768
    s_add_u32 s22, s22, s30
    s_add_u32 s20, s8, s22
    s_addc_u32 s21, s9, 0
    s_and_b32 s21, s21, 0xffff
    s_mov_b32 s22, 425984
    s_mov_b32 s23, 0x00020000
    s_mul_i32 s42, s36, 32768
    s_add_u32 s42, s42, s29
    s_add_u32 s40, s8, s42
    s_addc_u32 s41, s9, 0
    s_and_b32 s41, s41, 0xffff
    s_mov_b32 s42, 32768
    s_mov_b32 s43, 0x00020000
    s_mul_i32 s50, s36, 28672
    s_add_u32 s50, s50, s31
    s_add_u32 s48, s8, s50
    s_addc_u32 s49, s9, 0
    s_and_b32 s49, s49, 0xffff
    s_mov_b32 s50, 28672
    s_mov_b32 s51, 0x00020000
    s_mul_i32 s58, s36, 32768
    s_add_u32 s58, s58, s30
    s_add_u32 s56, s8, s58
    s_addc_u32 s57, s9, 0
    s_and_b32 s57, s57, 0xffff
    s_mov_b32 s58, 425984
    s_mov_b32 s59, 0x00020000
    s_mul_i32 s46, s39, 32768
    s_add_u32 s46, s46, s29
    s_add_u32 s44, s8, s46
    s_addc_u32 s45, s9, 0
    s_and_b32 s45, s45, 0xffff
    s_mov_b32 s46, 32768
    s_mov_b32 s47, 0x00020000
    s_mul_i32 s54, s39, 28672
    s_add_u32 s54, s54, s31
    s_add_u32 s52, s8, s54
    s_addc_u32 s53, s9, 0
    s_and_b32 s53, s53, 0xffff
    s_mov_b32 s54, 28672
    s_mov_b32 s55, 0x00020000
    s_mul_i32 s62, s39, 32768
    s_add_u32 s62, s62, s30
    s_add_u32 s60, s8, s62
    s_addc_u32 s61, s9, 0
    s_and_b32 s61, s61, 0xffff
    s_mov_b32 s62, 425984
    s_mov_b32 s63, 0x00020000
    v_and_b32 v237, 15, v0
    v_lshrrev_b32 v238, 4, v0
    v_lshlrev_b32 v239, 10, v238
    v_lshl_add_u32 v239, v237, 4, v239
    s_lshr_b32 s33, s24, 1
    s_mul_i32 s33, s33, 32768
    s_and_b32 s34, s24, 1
    s_lshl_b32 s34, s34, 3
    s_add_u32 s33, s33, s34
    v_add_u32 v244, s33, v239
    v_xor_b32 v240, s24, v238
    v_lshl_add_u32 v240, v240, 2, v239
    v_add_u32 v245, 65536, v240
    v_min_u32 v239, 2, v238
    v_lshlrev_b32 v239, 15, v239
    v_lshl_add_u32 v239, v237, 4, v239
    s_lshl_b32 s33, s24, 10
    v_add_u32 v246, s33, v239
    s_lshl_b32 s33, s24, 14
    s_add_u32 s33, s33, 98304
    v_and_b32 v237, 15, v0
    v_lshrrev_b32 v239, 1, v238
    v_lshl_add_u32 v239, v237, 1, v239
    v_bfe_u32 v240, v237, 2, 1
    v_xor_b32 v239, v239, v240
    v_and_b32 v240, 1, v238
    v_lshlrev_b32 v240, 9, v240
    v_lshl_add_u32 v239, v239, 4, v240
    v_add_u32 v240, s33, v239
    v_bfe_u32 v240, v0, 3, 1
    v_xor_b32 v240, v0, v240
    v_lshl_add_u32 v241, v240, 4, s33
    v_bfe_u32 v236, v0, 4, 1
    v_and_b32 v237, 15, v0
    v_lshrrev_b32 v238, 5, v0
    s_mov_b32 s38, 224
    s_mov_b32 s35, 2260
    s_mov_b32 s37, 192
    s_lshl_b32 s33, s27, 4
    s_lshl_b32 s34, s24, 2
    s_add_u32 s33, s33, s34
    s_add_u32 s33, s33, 0
    v_add_u32 v239, s33, v236
    v_mul_u32_u24 v240, s35, v239
    v_lshrrev_b32 v240, 16, v240
    v_mul_u32_u24 v241, 29, v240
    v_sub_u32 v241, v239, v241
    v_mul_u32_u24 v242, 10, v240
    v_add_u32 v242, v242, v237
    v_subrev_u32 v243, 1, v241
    v_mul_u32_u24 v243, 1792, v243
    v_add_u32 v243, v243, v242
    v_mul_lo_u32 v243, v243, s37
    v_lshl_add_u32 v243, v238, 4, v243
    s_lshl_b32 s34, s28, 5
    v_add_u32 v243, s34, v243
    v_cmp_ne_u32 s[70:71], 0, v241
    v_cmp_gt_u32 s[72:73], 10, v237
    v_cmp_gt_u32 s[74:75], s38, v242
    v_mov_b32 v239, 0x7fffffff
    s_nop 2
    s_and_b64 s[70:71], s[70:71], s[72:73]
    s_and_b64 s[70:71], s[70:71], s[74:75]
    s_nop 0
    v_cndmask_b32 v249, v239, v243, s[70:71]
    s_lshl_b32 s33, s27, 4
    s_lshl_b32 s34, s24, 2
    s_add_u32 s33, s33, s34
    s_add_u32 s33, s33, 2
    v_add_u32 v239, s33, v236
    v_mul_u32_u24 v240, s35, v239
    v_lshrrev_b32 v240, 16, v240
    v_mul_u32_u24 v241, 29, v240
    v_sub_u32 v241, v239, v241
    v_mul_u32_u24 v242, 10, v240
    v_add_u32 v242, v242, v237
    v_subrev_u32 v243, 1, v241
    v_mul_u32_u24 v243, 1792, v243
    v_add_u32 v243, v243, v242
    v_mul_lo_u32 v243, v243, s37
    v_lshl_add_u32 v243, v238, 4, v243
    s_lshl_b32 s34, s28, 5
    v_add_u32 v243, s34, v243
    v_cmp_ne_u32 s[70:71], 0, v241
    v_cmp_gt_u32 s[72:73], 10, v237
    v_cmp_gt_u32 s[74:75], s38, v242
    v_mov_b32 v239, 0x7fffffff
    s_nop 2
    s_and_b64 s[70:71], s[70:71], s[72:73]
    s_and_b64 s[70:71], s[70:71], s[74:75]
    s_nop 0
    v_cndmask_b32 v250, v239, v243, s[70:71]
    s_cmp_eq_u32 s27, 0
    s_cselect_b32 s33, 0, 393216
    v_and_b32 v239, 15, v0
    v_add_u32 v239, -1, v239
    v_lshrrev_b32 v240, 2, v239
    v_lshlrev_b32 v240, 8, v240
    v_and_b32 v239, 3, v239
    v_lshl_add_u32 v239, v239, 4, v240
    v_lshrrev_b32 v240, 4, v0
    v_lshlrev_b32 v240, 6, v240
    v_add3_u32 v239, v239, v240, s33
    v_add_u32 v240, 816, v240
    v_cndmask_b32 v251, v240, v239, vcc
    s_mov_b32 s6, 9633792
    s_mov_b32 s7, 0x00020000
    s_and_b32 s5, s5, 0xffff
    s_mov_b32 s94, 0x03ff03ff
    s_mov_b32 s95, 0x03ff03ff
    s_lshl_b32 s33, s27, 7
    s_max_u32 s34, s27, 1
    s_sub_u32 s34, s34, 1
    s_lshl_b32 s34, s34, 7
    v_mov_b32 v252, s33
    v_mov_b32 v253, s34
    v_cmp_gt_u32 s[72:73], 32, v0
    s_nop 1
    v_cndmask_b32 v252, v253, v252, s[72:73]
    v_and_b32 v253, 31, v0
    v_lshl_add_u32 v252, v253, 2, v252
    v_add_u32 v252, 18579456, v252
    v_add_u32 v253, 6144, v252
    v_add_u32 v254, 20480, v252
    v_min_u32 v255, 55, v0
    v_lshlrev_b32 v255, 2, v255
    s_and_b32 s33, s2, 7
    s_lshl_b32 s33, s33, 10
    s_add_u32 s33, s33, 18591744
    v_add_u32 v255, s33, v255
    s_mov_b32 s33, 0
    s_waitcnt vmcnt(0)
    s_cmp_lg_u32 s24, 3
    s_cbranch_scc1 FU_sig
    global_load_dword v3, v252, s[8:9] sc1
    global_load_dword v8, v255, s[8:9] sc1
    s_waitcnt vmcnt(0)
    v_cmp_ne_u32 s[72:73], s82, v3
    v_cmp_ne_u32 s[74:75], s82, v8
    s_nop 4
    s_or_b64 s[72:73], s[72:73], s[74:75]
    s_cmp_lg_u64 s[72:73], 0
    s_cbranch_scc1 FU_poll0_again
FU_poll0_ok:
FU_sig:
    s_cmp_eq_u32 s80, 3
    s_cselect_b32 s80, 0, s78
    s_cmp_eq_u32 s80, 0
    s_cbranch_scc1 FU_nosig0_80
    s_add_u32 s33, s80, 6144
    v_mov_b32 v12, s33
    v_mov_b32 v13, s82
    s_mov_b64 exec, 1
    global_atomic_swap v12, v13, s[8:9] sc1
    s_mov_b64 exec, -1
FU_nosig0_80:
    s_cmp_eq_u32 s81, 0
    s_cbranch_scc1 FU_nosig0_81
    s_add_u32 s33, s81, 6144
    v_mov_b32 v12, s33
    v_mov_b32 v13, s82
    s_mov_b64 exec, 1
    global_atomic_swap v12, v13, s[8:9] sc1
    s_mov_b64 exec, -1
FU_nosig0_81:
    s_barrier
    buffer_load_dwordx4 v[72:75], v247, s[12:15], s25 offen offset:3072 sc1
    buffer_load_dwordx4 a[96:99], v1, s[16:19], 0 offen offset:0 sc1
    buffer_load_dwordx4 a[100:103], v1, s[16:19], s25 offen offset:3072 sc1
    buffer_load_dwordx4 v[76:79], v247, s[12:15], s64 offen offset:3072 sc1
    buffer_load_dwordx4 v[80:83], v247, s[12:15], s64 offen offset:2048 sc1
    buffer_load_dwordx4 a[104:107], v1, s[16:19], s26 offen offset:0 sc1
    buffer_load_dwordx4 a[108:111], v1, s[16:19], 0 offen offset:1024 sc1
    buffer_load_dwordx4 v[84:87], v247, s[12:15], s25 offen offset:2048 sc1
    buffer_load_dwordx4 v[88:91], v247, s[12:15], s64 offen offset:1024 sc1
    buffer_load_dwordx4 a[112:115], v1, s[16:19], s26 offen offset:1024 sc1
    buffer_load_dwordx4 a[116:119], v1, s[16:19], 0 offen offset:2048 sc1
    buffer_load_dwordx4 v[92:95], v247, s[12:15], s25 offen offset:1024 sc1
    buffer_load_dwordx4 v[96:99], v247, s[12:15], s25 offen offset:0 sc1
    buffer_load_dwordx4 a[120:123], v1, s[16:19], 0 offen offset:3072 sc1
    buffer_load_dwordx4 a[124:127], v1, s[16:19], s26 offen offset:2048 sc1
    buffer_load_dwordx4 v[100:103], v247, s[12:15], s64 offen offset:0 sc1
    s_waitcnt vmcnt(14)
    v_mfma_f32_16x16x32_bf16 a[28:31], v[72:75], a[96:99], 0
    buffer_load_dwordx4 v[104:107], v247, s[12:15], 0 offen offset:3072 sc1
    s_waitcnt vmcnt(14)
    v_mfma_f32_16x16x32_bf16 a[60:63], v[72:75], a[100:103], 0
    s_waitcnt vmcnt(13)
    v_mfma_f32_16x16x32_bf16 a[60:63], v[76:79], a[96:99], a[60:63]
    buffer_load_dwordx4 v[108:111], v247, s[12:15], s26 offen offset:3072 sc1
    v_mfma_f32_16x16x32_bf16 a[92:95], v[76:79], a[100:103], 0
    s_waitcnt vmcnt(12)
    v_mfma_f32_16x16x32_bf16 a[92:95], v[80:83], a[104:107], a[92:95]
    s_waitcnt vmcnt(11)
    v_mfma_f32_16x16x32_bf16 a[60:63], v[80:83], a[108:111], a[60:63]
    s_waitcnt vmcnt(10)
    v_mfma_f32_16x16x32_bf16 a[60:63], v[84:87], a[104:107], a[60:63]
    v_mfma_f32_16x16x32_bf16 a[28:31], v[84:87], a[108:111], a[28:31]
    buffer_load_dwordx4 v[112:115], v2, s[20:23], 0 offen offset:0 sc1
    v_mfma_f32_16x16x32_bf16 a[24:27], v[84:87], a[96:99], 0
    v_mfma_f32_16x16x32_bf16 a[56:59], v[84:87], a[100:103], 0
    v_mfma_f32_16x16x32_bf16 a[56:59], v[80:83], a[96:99], a[56:59]
    buffer_load_dwordx4 v[116:119], v2, s[20:23], s26 offen offset:0 sc1
    v_mfma_f32_16x16x32_bf16 a[88:91], v[80:83], a[100:103], 0
    s_waitcnt vmcnt(10)
    v_mfma_f32_16x16x32_bf16 a[92:95], v[88:91], a[112:115], a[92:95]
    s_waitcnt vmcnt(9)
    v_mfma_f32_16x16x32_bf16 a[60:63], v[88:91], a[116:119], a[60:63]
    s_waitcnt vmcnt(8)
    v_mfma_f32_16x16x32_bf16 a[60:63], v[92:95], a[112:115], a[60:63]
    v_mfma_f32_16x16x32_bf16 a[28:31], v[92:95], a[116:119], a[28:31]
    buffer_load_dwordx4 v[120:123], v247, s[12:15], 0 offen offset:2048 sc1
    v_mfma_f32_16x16x32_bf16 a[24:27], v[92:95], a[108:111], a[24:27]
    v_mfma_f32_16x16x32_bf16 a[56:59], v[92:95], a[104:107], a[56:59]
    v_mfma_f32_16x16x32_bf16 a[56:59], v[88:91], a[108:111], a[56:59]
    buffer_load_dwordx4 v[124:127], v247, s[12:15], s26 offen offset:2048 sc1
    v_mfma_f32_16x16x32_bf16 a[88:91], v[88:91], a[104:107], a[88:91]
    v_mfma_f32_16x16x32_bf16 a[84:87], v[88:91], a[100:103], 0
    v_mfma_f32_16x16x32_bf16 a[52:55], v[88:91], a[96:99], 0
    v_mfma_f32_16x16x32_bf16 a[52:55], v[92:95], a[100:103], a[52:55]
    v_mfma_f32_16x16x32_bf16 a[20:23], v[92:95], a[96:99], 0
    buffer_load_dwordx4 v[128:131], v247, s[12:15], 0 offen offset:1024 sc1
    s_waitcnt vmcnt(9)
    v_mfma_f32_16x16x32_bf16 a[28:31], v[96:99], a[120:123], a[28:31]
    s_waitcnt vmcnt(8)
    v_mfma_f32_16x16x32_bf16 a[60:63], v[96:99], a[124:127], a[60:63]
    s_waitcnt vmcnt(7)
    v_mfma_f32_16x16x32_bf16 a[60:63], v[100:103], a[120:123], a[60:63]
    v_mfma_f32_16x16x32_bf16 a[92:95], v[100:103], a[124:127], a[92:95]
    v_mfma_f32_16x16x32_bf16 a[88:91], v[100:103], a[112:115], a[88:91]
    buffer_load_dwordx4 v[132:135], v247, s[12:15], s26 offen offset:1024 sc1
    v_mfma_f32_16x16x32_bf16 a[56:59], v[100:103], a[116:119], a[56:59]
    v_mfma_f32_16x16x32_bf16 a[56:59], v[96:99], a[112:115], a[56:59]
    v_mfma_f32_16x16x32_bf16 a[24:27], v[96:99], a[116:119], a[24:27]
    v_mfma_f32_16x16x32_bf16 a[20:23], v[96:99], a[108:111], a[20:23]
    v_mfma_f32_16x16x32_bf16 a[52:55], v[96:99], a[104:107], a[52:55]
    buffer_load_dwordx4 v[136:139], v247, s[12:15], 0 offen offset:0 sc1
    v_mfma_f32_16x16x32_bf16 a[52:55], v[100:103], a[108:111], a[52:55]
    v_mfma_f32_16x16x32_bf16 a[84:87], v[100:103], a[104:107], a[84:87]
    v_mfma_f32_16x16x32_bf16 a[80:83], v[100:103], a[100:103], 0
    v_mfma_f32_16x16x32_bf16 a[48:51], v[100:103], a[96:99], 0
    v_mfma_f32_16x16x32_bf16 a[48:51], v[96:99], a[100:103], a[48:51]
    buffer_load_dwordx4 v[140:143], v247, s[12:15], s26 offen offset:0 sc1
    v_mfma_f32_16x16x32_bf16 a[16:19], v[96:99], a[96:99], 0
    s_waitcnt vmcnt(9)
    v_mfma_f32_16x16x32_bf16 a[24:27], v[104:107], a[120:123], a[24:27]
    v_mfma_f32_16x16x32_bf16 a[56:59], v[104:107], a[124:127], a[56:59]
    s_waitcnt vmcnt(8)
    v_mfma_f32_16x16x32_bf16 a[56:59], v[108:111], a[120:123], a[56:59]
    v_mfma_f32_16x16x32_bf16 a[88:91], v[108:111], a[124:127], a[88:91]
    buffer_load_dwordx4 a[128:131], v1, s[16:19], s25 offen offset:0 sc1
    v_mfma_f32_16x16x32_bf16 a[84:87], v[108:111], a[112:115], a[84:87]
    v_mfma_f32_16x16x32_bf16 a[52:55], v[108:111], a[116:119], a[52:55]
    v_mfma_f32_16x16x32_bf16 a[52:55], v[104:107], a[112:115], a[52:55]
    v_mfma_f32_16x16x32_bf16 a[20:23], v[104:107], a[116:119], a[20:23]
    v_mfma_f32_16x16x32_bf16 a[16:19], v[104:107], a[108:111], a[16:19]
    buffer_load_dwordx4 a[132:135], v1, s[16:19], s25 offen offset:1024 sc1
    v_mfma_f32_16x16x32_bf16 a[48:51], v[104:107], a[104:107], a[48:51]
    v_mfma_f32_16x16x32_bf16 a[48:51], v[108:111], a[108:111], a[48:51]
    v_mfma_f32_16x16x32_bf16 a[80:83], v[108:111], a[104:107], a[80:83]
    v_mfma_f32_16x16x32_bf16 a[76:79], v[108:111], a[100:103], 0
    v_mfma_f32_16x16x32_bf16 a[44:47], v[108:111], a[96:99], 0
    buffer_load_dwordx4 a[136:139], v1, s[16:19], s25 offen offset:2048 sc1
    v_mfma_f32_16x16x32_bf16 a[44:47], v[104:107], a[100:103], a[44:47]
    v_mfma_f32_16x16x32_bf16 a[12:15], v[104:107], a[96:99], 0
    s_waitcnt vmcnt(8)
    v_mfma_f32_16x16x32_bf16 a[20:23], v[120:123], a[120:123], a[20:23]
    v_mfma_f32_16x16x32_bf16 a[52:55], v[120:123], a[124:127], a[52:55]
    s_waitcnt vmcnt(7)
    v_mfma_f32_16x16x32_bf16 a[52:55], v[124:127], a[120:123], a[52:55]
    buffer_load_dwordx4 a[140:143], v1, s[16:19], s64 offen offset:1024 sc1
    v_mfma_f32_16x16x32_bf16 a[84:87], v[124:127], a[124:127], a[84:87]
    v_mfma_f32_16x16x32_bf16 a[80:83], v[124:127], a[112:115], a[80:83]
    v_mfma_f32_16x16x32_bf16 a[48:51], v[124:127], a[116:119], a[48:51]
    v_mfma_f32_16x16x32_bf16 a[48:51], v[120:123], a[112:115], a[48:51]
    v_mfma_f32_16x16x32_bf16 a[16:19], v[120:123], a[116:119], a[16:19]
    buffer_load_dwordx4 a[144:147], v1, s[16:19], s64 offen offset:0 sc1
    v_mfma_f32_16x16x32_bf16 a[12:15], v[120:123], a[108:111], a[12:15]
    v_mfma_f32_16x16x32_bf16 a[44:47], v[120:123], a[104:107], a[44:47]
    v_mfma_f32_16x16x32_bf16 a[44:47], v[124:127], a[108:111], a[44:47]
    v_mfma_f32_16x16x32_bf16 a[76:79], v[124:127], a[104:107], a[76:79]
    v_mov_b32_dpp v72, v72 row_shr:1 row_mask:0xf bank_mask:0xf
    v_mov_b32_dpp v73, v73 row_shr:1 row_mask:0xf bank_mask:0xf
    v_mfma_f32_16x16x32_bf16 a[72:75], v[124:127], a[100:103], 0
    buffer_load_dwordx4 a[148:151], v1, s[16:19], s26 offen offset:3072 sc1
    v_mov_b32_dpp v74, v74 row_shr:1 row_mask:0xf bank_mask:0xf
    v_mfma_f32_16x16x32_bf16 a[40:43], v[124:127], a[96:99], 0
    v_mov_b32_dpp v75, v75 row_shr:1 row_mask:0xf bank_mask:0xf
    v_cndmask_b32_dpp v72, v112, v72, vcc row_shl:5 row_mask:0xf bank_mask:0xf
    v_mfma_f32_16x16x32_bf16 a[40:43], v[120:123], a[100:103], a[40:43]
    v_cndmask_b32_dpp v73, v113, v73, vcc row_shl:5 row_mask:0xf bank_mask:0xf
    v_cndmask_b32_dpp v74, v114, v74, vcc row_shl:5 row_mask:0xf bank_mask:0xf
    v_mfma_f32_16x16x32_bf16 a[8:11], v[120:123], a[96:99], 0
    v_cndmask_b32_dpp v75, v115, v75, vcc row_shl:5 row_mask:0xf bank_mask:0xf
    s_waitcnt vmcnt(9)
    v_mfma_f32_16x16x32_bf16 a[16:19], v[128:131], a[120:123], a[16:19]
    v_mov_b32_dpp v76, v76 row_shr:1 row_mask:0xf bank_mask:0xf
    v_mov_b32_dpp v77, v77 row_shr:1 row_mask:0xf bank_mask:0xf
    v_mfma_f32_16x16x32_bf16 a[48:51], v[128:131], a[124:127], a[48:51]
    buffer_load_dwordx4 v[144:147], v2, s[20:23], s65 offen offset:0 sc1
    s_waitcnt vmcnt(9)
    v_mfma_f32_16x16x32_bf16 a[48:51], v[132:135], a[120:123], a[48:51]
    v_mov_b32_dpp v78, v78 row_shr:1 row_mask:0xf bank_mask:0xf
    v_mov_b32_dpp v79, v79 row_shr:1 row_mask:0xf bank_mask:0xf
    v_mfma_f32_16x16x32_bf16 a[80:83], v[132:135], a[124:127], a[80:83]
    v_cndmask_b32_dpp v76, v116, v76, vcc row_shl:5 row_mask:0xf bank_mask:0xf
    v_cndmask_b32_dpp v77, v117, v77, vcc row_shl:5 row_mask:0xf bank_mask:0xf
    v_mfma_f32_16x16x32_bf16 a[76:79], v[132:135], a[112:115], a[76:79]
    v_cndmask_b32_dpp v78, v118, v78, vcc row_shl:5 row_mask:0xf bank_mask:0xf
    v_cndmask_b32_dpp v79, v119, v79, vcc row_shl:5 row_mask:0xf bank_mask:0xf
    v_mfma_f32_16x16x32_bf16 a[44:47], v[132:135], a[116:119], a[44:47]
    v_mov_b32_dpp v80, v80 row_shr:1 row_mask:0xf bank_mask:0xf
    v_mfma_f32_16x16x32_bf16 a[44:47], v[128:131], a[112:115], a[44:47]
    buffer_load_dwordx4 v[148:151], v247, s[12:15], s66 offen offset:3072 sc1
    v_mfma_f32_16x16x32_bf16 a[12:15], v[128:131], a[116:119], a[12:15]
    v_mov_b32_dpp v81, v81 row_shr:1 row_mask:0xf bank_mask:0xf
    v_mfma_f32_16x16x32_bf16 a[8:11], v[128:131], a[108:111], a[8:11]
    v_mov_b32_dpp v82, v82 row_shr:1 row_mask:0xf bank_mask:0xf
    v_mfma_f32_16x16x32_bf16 a[40:43], v[128:131], a[104:107], a[40:43]
    v_mov_b32_dpp v83, v83 row_shr:1 row_mask:0xf bank_mask:0xf
    v_mfma_f32_16x16x32_bf16 a[40:43], v[132:135], a[108:111], a[40:43]
    v_cndmask_b32_dpp v80, v116, v80, vcc row_shl:4 row_mask:0xf bank_mask:0xf
    v_mfma_f32_16x16x32_bf16 a[72:75], v[132:135], a[104:107], a[72:75]
    buffer_load_dwordx4 a[152:155], v1, s[16:19], s64 offen offset:2048 sc1
    v_mfma_f32_16x16x32_bf16 a[68:71], v[132:135], a[100:103], 0
    v_cndmask_b32_dpp v81, v117, v81, vcc row_shl:4 row_mask:0xf bank_mask:0xf
    v_mfma_f32_16x16x32_bf16 a[36:39], v[132:135], a[96:99], 0
    v_cndmask_b32_dpp v82, v118, v82, vcc row_shl:4 row_mask:0xf bank_mask:0xf
    v_mfma_f32_16x16x32_bf16 a[36:39], v[128:131], a[100:103], a[36:39]
    v_cndmask_b32_dpp v83, v119, v83, vcc row_shl:4 row_mask:0xf bank_mask:0xf
    v_mfma_f32_16x16x32_bf16 a[4:7], v[128:131], a[96:99], 0
    s_waitcnt vmcnt(10)
    v_mfma_f32_16x16x32_bf16 a[12:15], v[136:139], a[120:123], a[12:15]
    buffer_load_dwordx4 v[152:155], v247, s[12:15], s66 offen offset:2048 sc1
    v_mfma_f32_16x16x32_bf16 a[44:47], v[136:139], a[124:127], a[44:47]
    s_waitcnt vmcnt(10)
    v_mfma_f32_16x16x32_bf16 a[44:47], v[140:143], a[120:123], a[44:47]
    v_mov_b32_dpp v84, v84 row_shr:1 row_mask:0xf bank_mask:0xf
    v_mfma_f32_16x16x32_bf16 a[76:79], v[140:143], a[124:127], a[76:79]
    v_mov_b32_dpp v85, v85 row_shr:1 row_mask:0xf bank_mask:0xf
    v_mfma_f32_16x16x32_bf16 a[72:75], v[140:143], a[112:115], a[72:75]
    v_mov_b32_dpp v86, v86 row_shr:1 row_mask:0xf bank_mask:0xf
    v_mfma_f32_16x16x32_bf16 a[40:43], v[140:143], a[116:119], a[40:43]
    buffer_load_dwordx4 a[156:159], v1, s[16:19], s64 offen offset:3072 sc1
    v_mfma_f32_16x16x32_bf16 a[40:43], v[136:139], a[112:115], a[40:43]
    v_mov_b32_dpp v87, v87 row_shr:1 row_mask:0xf bank_mask:0xf
    v_mfma_f32_16x16x32_bf16 a[8:11], v[136:139], a[116:119], a[8:11]
    v_cndmask_b32_dpp v84, v112, v84, vcc row_shl:4 row_mask:0xf bank_mask:0xf
    v_mfma_f32_16x16x32_bf16 a[4:7], v[136:139], a[108:111], a[4:7]
    v_cndmask_b32_dpp v85, v113, v85, vcc row_shl:4 row_mask:0xf bank_mask:0xf
    v_mfma_f32_16x16x32_bf16 a[36:39], v[136:139], a[104:107], a[36:39]
    v_cndmask_b32_dpp v86, v114, v86, vcc row_shl:4 row_mask:0xf bank_mask:0xf
    v_mfma_f32_16x16x32_bf16 a[36:39], v[140:143], a[108:111], a[36:39]
    buffer_load_dwordx4 v[156:159], v247, s[12:15], s66 offen offset:1024 sc1
    v_mfma_f32_16x16x32_bf16 a[68:71], v[140:143], a[104:107], a[68:71]
    v_cndmask_b32_dpp v87, v115, v87, vcc row_shl:4 row_mask:0xf bank_mask:0xf
    v_mfma_f32_16x16x32_bf16 a[64:67], v[140:143], a[100:103], 0
    v_mov_b32_dpp v88, v88 row_shr:1 row_mask:0xf bank_mask:0xf
    v_mfma_f32_16x16x32_bf16 a[32:35], v[140:143], a[96:99], 0
    v_mov_b32_dpp v89, v89 row_shr:1 row_mask:0xf bank_mask:0xf
    v_mfma_f32_16x16x32_bf16 a[32:35], v[136:139], a[100:103], a[32:35]
    v_mov_b32_dpp v90, v90 row_shr:1 row_mask:0xf bank_mask:0xf
    v_mfma_f32_16x16x32_bf16 a[0:3], v[136:139], a[96:99], 0
    buffer_load_dwordx4 a[160:163], v1, s[16:19], s65 offen offset:0 sc1
    v_mfma_f32_16x16x32_bf16 a[8:11], v[72:75], a[120:123], a[8:11]
    v_mov_b32_dpp v91, v91 row_shr:1 row_mask:0xf bank_mask:0xf
    v_mfma_f32_16x16x32_bf16 a[40:43], v[72:75], a[124:127], a[40:43]
    v_cndmask_b32_dpp v88, v116, v88, vcc row_shl:3 row_mask:0xf bank_mask:0xf
    v_mfma_f32_16x16x32_bf16 a[40:43], v[76:79], a[120:123], a[40:43]
    v_cndmask_b32_dpp v89, v117, v89, vcc row_shl:3 row_mask:0xf bank_mask:0xf
    v_mfma_f32_16x16x32_bf16 a[72:75], v[76:79], a[124:127], a[72:75]
    v_cndmask_b32_dpp v90, v118, v90, vcc row_shl:3 row_mask:0xf bank_mask:0xf
    v_mfma_f32_16x16x32_bf16 a[68:71], v[76:79], a[112:115], a[68:71]
    buffer_load_dwordx4 v[160:163], v247, s[12:15], s66 offen offset:0 sc1
    v_mfma_f32_16x16x32_bf16 a[36:39], v[76:79], a[116:119], a[36:39]
    v_cndmask_b32_dpp v91, v119, v91, vcc row_shl:3 row_mask:0xf bank_mask:0xf
    ds_read_b128 v[40:43], v16 offset:128
    v_mfma_f32_16x16x32_bf16 a[36:39], v[72:75], a[112:115], a[36:39]
    v_mov_b32_dpp v92, v92 row_shr:1 row_mask:0xf bank_mask:0xf
    v_mfma_f32_16x16x32_bf16 a[4:7], v[72:75], a[116:119], a[4:7]
    v_mov_b32_dpp v93, v93 row_shr:1 row_mask:0xf bank_mask:0xf
    v_mfma_f32_16x16x32_bf16 a[0:3], v[72:75], a[108:111], a[0:3]
    v_mov_b32_dpp v94, v94 row_shr:1 row_mask:0xf bank_mask:0xf
    v_mfma_f32_16x16x32_bf16 a[32:35], v[72:75], a[104:107], a[32:35]
    buffer_load_dwordx4 a[164:167], v1, s[16:19], s65 offen offset:1024 sc1
    ds_read_b128 v[44:47], v17 offset:896
    v_mfma_f32_16x16x32_bf16 a[32:35], v[76:79], a[108:111], a[32:35]
    v_mov_b32_dpp v95, v95 row_shr:1 row_mask:0xf bank_mask:0xf
    v_mfma_f32_16x16x32_bf16 a[64:67], v[76:79], a[104:107], a[64:67]
    v_cndmask_b32_dpp v92, v112, v92, vcc row_shl:3 row_mask:0xf bank_mask:0xf
    v_mfma_f32_16x16x32_bf16 a[68:71], v[80:83], a[124:127], a[68:71]
    v_cndmask_b32_dpp v93, v113, v93, vcc row_shl:3 row_mask:0xf bank_mask:0xf
    v_mfma_f32_16x16x32_bf16 a[36:39], v[80:83], a[120:123], a[36:39]
    v_cndmask_b32_dpp v94, v114, v94, vcc row_shl:3 row_mask:0xf bank_mask:0xf
    ds_read_b128 v[48:51], v18 offset:1664
    v_mfma_f32_16x16x32_bf16 a[36:39], v[84:87], a[124:127], a[36:39]
    buffer_load_dwordx4 v[164:167], v247, s[12:15], s65 offen offset:3072 sc1
    v_mfma_f32_16x16x32_bf16 a[4:7], v[84:87], a[120:123], a[4:7]
    v_cndmask_b32_dpp v95, v115, v95, vcc row_shl:3 row_mask:0xf bank_mask:0xf
    s_add_u32 s33, s88, 65536
    s_waitcnt lgkmcnt(2)
    buffer_store_dwordx4 v[40:43], v11, s[84:87], s33 offen sc1
    v_mfma_f32_16x16x32_bf16 a[0:3], v[84:87], a[116:119], a[0:3]
    v_mov_b32_dpp v96, v96 row_shr:1 row_mask:0xf bank_mask:0xf
    v_mfma_f32_16x16x32_bf16 a[32:35], v[84:87], a[112:115], a[32:35]
    v_mov_b32_dpp v97, v97 row_shr:1 row_mask:0xf bank_mask:0xf
    ds_read_b128 v[52:55], v19 offset:2432
    v_mfma_f32_16x16x32_bf16 a[32:35], v[80:83], a[116:119], a[32:35]
    v_mov_b32_dpp v98, v98 row_shr:1 row_mask:0xf bank_mask:0xf
    v_mfma_f32_16x16x32_bf16 a[64:67], v[80:83], a[112:115], a[64:67]
    buffer_load_dwordx4 a[168:171], v1, s[16:19], s65 offen offset:2048 sc1
    s_add_u32 s33, s88, 163840
    s_waitcnt lgkmcnt(2)
    buffer_store_dwordx4 v[44:47], v11, s[84:87], s33 offen sc1
    v_mfma_f32_16x16x32_bf16 a[64:67], v[88:91], a[124:127], a[64:67]
    v_mov_b32_dpp v99, v99 row_shr:1 row_mask:0xf bank_mask:0xf
    v_mfma_f32_16x16x32_bf16 a[32:35], v[88:91], a[120:123], a[32:35]
    v_cndmask_b32_dpp v96, v112, v96, vcc row_shl:2 row_mask:0xf bank_mask:0xf
    ds_read_b128 v[40:43], v16 offset:12480
    v_mfma_f32_16x16x32_bf16 a[32:35], v[92:95], a[124:127], a[32:35]
    v_cndmask_b32_dpp v97, v113, v97, vcc row_shl:2 row_mask:0xf bank_mask:0xf
    v_mfma_f32_16x16x32_bf16 a[0:3], v[92:95], a[120:123], a[0:3]
    s_add_u32 s33, s88, 262144
    s_waitcnt lgkmcnt(2)
    buffer_store_dwordx4 v[48:51], v11, s[84:87], s33 offen sc1
    s_waitcnt vmcnt(19)
    v_mfma_f32_16x16x32_bf16 a[28:31], v[104:107], a[128:131], a[28:31]
    buffer_load_dwordx4 v[168:171], v247, s[12:15], s65 offen offset:2048 sc1
    s_waitcnt vmcnt(19)
    v_mfma_f32_16x16x32_bf16 a[28:31], v[120:123], a[132:135], a[28:31]
    ds_read_b128 v[44:47], v17 offset:13248
    s_waitcnt vmcnt(18)
    v_mfma_f32_16x16x32_bf16 a[28:31], v[128:131], a[136:139], a[28:31]
    s_waitcnt vmcnt(17)
    v_mfma_f32_16x16x32_bf16 a[60:63], v[128:131], a[140:143], a[60:63]
    s_add_u32 s33, s88, 360448
    s_waitcnt lgkmcnt(2)
    buffer_store_dwordx4 v[52:55], v11, s[84:87], s33 offen sc1
    s_waitcnt vmcnt(17)
    v_mfma_f32_16x16x32_bf16 a[60:63], v[120:123], a[144:147], a[60:63]
    s_waitcnt vmcnt(16)
    v_mfma_f32_16x16x32_bf16 a[60:63], v[104:107], a[148:151], a[60:63]
    buffer_load_dwordx4 a[172:175], v1, s[16:19], s65 offen offset:3072 sc1
    ds_read_b128 v[48:51], v18 offset:14016
    v_mfma_f32_16x16x32_bf16 a[60:63], v[108:111], a[128:131], a[60:63]
    v_cndmask_b32_dpp v98, v114, v98, vcc row_shl:2 row_mask:0xf bank_mask:0xf
    v_mfma_f32_16x16x32_bf16 a[60:63], v[124:127], a[132:135], a[60:63]
    v_cndmask_b32_dpp v99, v115, v99, vcc row_shl:2 row_mask:0xf bank_mask:0xf
    s_add_u32 s33, s89, 65536
    s_waitcnt lgkmcnt(2)
    buffer_store_dwordx4 v[40:43], v11, s[84:87], s33 offen sc1
    v_mfma_f32_16x16x32_bf16 a[60:63], v[132:135], a[136:139], a[60:63]
    v_mov_b32_dpp v100, v100 row_shr:1 row_mask:0xf bank_mask:0xf
    v_mfma_f32_16x16x32_bf16 a[92:95], v[132:135], a[140:143], a[92:95]
    v_mov_b32_dpp v101, v101 row_shr:1 row_mask:0xf bank_mask:0xf
    ds_read_b128 v[52:55], v19 offset:14784
    v_mfma_f32_16x16x32_bf16 a[92:95], v[124:127], a[144:147], a[92:95]
    buffer_load_dwordx4 v[172:175], v247, s[12:15], s65 offen offset:1024 sc1
    v_mfma_f32_16x16x32_bf16 a[92:95], v[108:111], a[148:151], a[92:95]
    v_mov_b32_dpp v102, v102 row_shr:1 row_mask:0xf bank_mask:0xf
    s_add_u32 s33, s89, 163840
    s_waitcnt lgkmcnt(2)
    buffer_store_dwordx4 v[44:47], v11, s[84:87], s33 offen sc1
    v_mfma_f32_16x16x32_bf16 a[24:27], v[120:123], a[128:131], a[24:27]
    v_mov_b32_dpp v103, v103 row_shr:1 row_mask:0xf bank_mask:0xf
    v_mfma_f32_16x16x32_bf16 a[24:27], v[128:131], a[132:135], a[24:27]
    v_cndmask_b32_dpp v100, v116, v100, vcc row_shl:2 row_mask:0xf bank_mask:0xf
    v_mfma_f32_16x16x32_bf16 a[24:27], v[136:139], a[136:139], a[24:27]
    v_cndmask_b32_dpp v101, v117, v101, vcc row_shl:2 row_mask:0xf bank_mask:0xf
    v_mfma_f32_16x16x32_bf16 a[56:59], v[136:139], a[140:143], a[56:59]
    buffer_load_dwordx4 a[176:179], v1, s[16:19], s66 offen offset:0 sc1
    s_add_u32 s33, s89, 262144
    s_waitcnt lgkmcnt(1)
    buffer_store_dwordx4 v[48:51], v11, s[84:87], s33 offen sc1
    v_mfma_f32_16x16x32_bf16 a[56:59], v[128:131], a[144:147], a[56:59]
    v_cndmask_b32_dpp v102, v118, v102, vcc row_shl:2 row_mask:0xf bank_mask:0xf
    v_mfma_f32_16x16x32_bf16 a[56:59], v[120:123], a[148:151], a[56:59]
    v_cndmask_b32_dpp v103, v119, v103, vcc row_shl:2 row_mask:0xf bank_mask:0xf
    v_mfma_f32_16x16x32_bf16 a[56:59], v[124:127], a[128:131], a[56:59]
    v_mov_b32_dpp v104, v104 row_shr:1 row_mask:0xf bank_mask:0xf
    v_mfma_f32_16x16x32_bf16 a[56:59], v[132:135], a[132:135], a[56:59]
    v_mov_b32_dpp v105, v105 row_shr:1 row_mask:0xf bank_mask:0xf
    s_add_u32 s33, s89, 360448
    s_waitcnt lgkmcnt(0)
    buffer_store_dwordx4 v[52:55], v11, s[84:87], s33 offen sc1
    v_mfma_f32_16x16x32_bf16 a[56:59], v[140:143], a[136:139], a[56:59]
    buffer_load_dwordx4 v[176:179], v247, s[12:15], s65 offen offset:0 sc1
    v_mfma_f32_16x16x32_bf16 a[88:91], v[140:143], a[140:143], a[88:91]
    v_mov_b32_dpp v106, v106 row_shr:1 row_mask:0xf bank_mask:0xf
    v_mfma_f32_16x16x32_bf16 a[88:91], v[132:135], a[144:147], a[88:91]
    v_mov_b32_dpp v107, v107 row_shr:1 row_mask:0xf bank_mask:0xf
    v_mfma_f32_16x16x32_bf16 a[88:91], v[124:127], a[148:151], a[88:91]
    v_cndmask_b32_dpp v104, v112, v104, vcc row_shl:1 row_mask:0xf bank_mask:0xf
    v_mfma_f32_16x16x32_bf16 a[20:23], v[128:131], a[128:131], a[20:23]
    v_cndmask_b32_dpp v105, v113, v105, vcc row_shl:1 row_mask:0xf bank_mask:0xf
    global_load_dword v3, v253, s[8:9] sc1
    global_load_dword v253, v255, s[8:9] offset:256 sc1
    v_mfma_f32_16x16x32_bf16 a[20:23], v[136:139], a[132:135], a[20:23]
    buffer_load_dwordx4 v[180:183], v2, s[20:23], s67 offen offset:0 sc1
    v_mfma_f32_16x16x32_bf16 a[20:23], v[72:75], a[136:139], a[20:23]
    v_cndmask_b32_dpp v106, v114, v106, vcc row_shl:1 row_mask:0xf bank_mask:0xf
    v_mfma_f32_16x16x32_bf16 a[52:55], v[72:75], a[140:143], a[52:55]
    v_cndmask_b32_dpp v107, v115, v107, vcc row_shl:1 row_mask:0xf bank_mask:0xf
    v_mfma_f32_16x16x32_bf16 a[52:55], v[136:139], a[144:147], a[52:55]
    v_mov_b32_dpp v108, v108 row_shr:1 row_mask:0xf bank_mask:0xf
    v_mfma_f32_16x16x32_bf16 a[52:55], v[128:131], a[148:151], a[52:55]
    v_mov_b32_dpp v109, v109 row_shr:1 row_mask:0xf bank_mask:0xf
    v_mfma_f32_16x16x32_bf16 a[52:55], v[132:135], a[128:131], a[52:55]
    buffer_load_dwordx4 v[184:187], v247, s[12:15], s68 offen offset:3072 sc1
    v_mfma_f32_16x16x32_bf16 a[52:55], v[140:143], a[132:135], a[52:55]
    v_mov_b32_dpp v110, v110 row_shr:1 row_mask:0xf bank_mask:0xf
    v_mfma_f32_16x16x32_bf16 a[52:55], v[76:79], a[136:139], a[52:55]
    v_mov_b32_dpp v111, v111 row_shr:1 row_mask:0xf bank_mask:0xf
    v_mfma_f32_16x16x32_bf16 a[84:87], v[76:79], a[140:143], a[84:87]
    v_cndmask_b32_dpp v108, v116, v108, vcc row_shl:1 row_mask:0xf bank_mask:0xf
    v_mfma_f32_16x16x32_bf16 a[84:87], v[140:143], a[144:147], a[84:87]
    v_cndmask_b32_dpp v109, v117, v109, vcc row_shl:1 row_mask:0xf bank_mask:0xf
    v_mfma_f32_16x16x32_bf16 a[84:87], v[132:135], a[148:151], a[84:87]
    buffer_load_dwordx4 a[180:183], v1, s[16:19], s66 offen offset:1024 sc1
    v_mfma_f32_16x16x32_bf16 a[16:19], v[136:139], a[128:131], a[16:19]
    v_cndmask_b32_dpp v110, v118, v110, vcc row_shl:1 row_mask:0xf bank_mask:0xf
    v_mfma_f32_16x16x32_bf16 a[16:19], v[72:75], a[132:135], a[16:19]
    v_cndmask_b32_dpp v111, v119, v111, vcc row_shl:1 row_mask:0xf bank_mask:0xf
    v_mfma_f32_16x16x32_bf16 a[16:19], v[84:87], a[136:139], a[16:19]
    v_mov_b32_dpp v120, v120 row_shr:1 row_mask:0xf bank_mask:0xf
    v_mfma_f32_16x16x32_bf16 a[48:51], v[84:87], a[140:143], a[48:51]
    v_mov_b32_dpp v121, v121 row_shr:1 row_mask:0xf bank_mask:0xf
    v_mfma_f32_16x16x32_bf16 a[48:51], v[72:75], a[144:147], a[48:51]
    buffer_load_dwordx4 v[188:191], v247, s[12:15], s68 offen offset:2048 sc1
    v_mfma_f32_16x16x32_bf16 a[48:51], v[136:139], a[148:151], a[48:51]
    v_mov_b32_dpp v122, v122 row_shr:1 row_mask:0xf bank_mask:0xf
    v_mfma_f32_16x16x32_bf16 a[48:51], v[140:143], a[128:131], a[48:51]
    v_mov_b32_dpp v123, v123 row_shr:1 row_mask:0xf bank_mask:0xf
    v_mfma_f32_16x16x32_bf16 a[48:51], v[76:79], a[132:135], a[48:51]
    v_cndmask_b32 v120, v112, v120, vcc
    v_mfma_f32_16x16x32_bf16 a[48:51], v[80:83], a[136:139], a[48:51]
    v_cndmask_b32 v121, v113, v121, vcc
    v_mfma_f32_16x16x32_bf16 a[80:83], v[80:83], a[140:143], a[80:83]
    buffer_load_dwordx4 a[184:187], v1, s[16:19], s66 offen offset:2048 sc1
    v_mfma_f32_16x16x32_bf16 a[80:83], v[76:79], a[144:147], a[80:83]
    v_cndmask_b32 v122, v114, v122, vcc
    v_mfma_f32_16x16x32_bf16 a[80:83], v[140:143], a[148:151], a[80:83]
    v_cndmask_b32 v123, v115, v123, vcc
    v_mfma_f32_16x16x32_bf16 a[12:15], v[72:75], a[128:131], a[12:15]
    v_mov_b32_dpp v124, v124 row_shr:1 row_mask:0xf bank_mask:0xf
    v_mfma_f32_16x16x32_bf16 a[12:15], v[84:87], a[132:135], a[12:15]
    v_mov_b32_dpp v125, v125 row_shr:1 row_mask:0xf bank_mask:0xf
    v_mfma_f32_16x16x32_bf16 a[12:15], v[92:95], a[136:139], a[12:15]
    buffer_load_dwordx4 v[192:195], v247, s[12:15], s68 offen offset:1024 sc1
    v_mfma_f32_16x16x32_bf16 a[44:47], v[92:95], a[140:143], a[44:47]
    v_mov_b32_dpp v126, v126 row_shr:1 row_mask:0xf bank_mask:0xf
    v_mfma_f32_16x16x32_bf16 a[44:47], v[84:87], a[144:147], a[44:47]
    v_mov_b32_dpp v127, v127 row_shr:1 row_mask:0xf bank_mask:0xf
    v_mfma_f32_16x16x32_bf16 a[44:47], v[72:75], a[148:151], a[44:47]
    v_cndmask_b32 v124, v116, v124, vcc
    v_mfma_f32_16x16x32_bf16 a[44:47], v[76:79], a[128:131], a[44:47]
    v_cndmask_b32 v125, v117, v125, vcc
    v_mfma_f32_16x16x32_bf16 a[44:47], v[80:83], a[132:135], a[44:47]
    buffer_load_dwordx4 a[188:191], v1, s[16:19], s66 offen offset:3072 sc1
    v_mfma_f32_16x16x32_bf16 a[44:47], v[88:91], a[136:139], a[44:47]
    v_cndmask_b32 v126, v118, v126, vcc
    v_mfma_f32_16x16x32_bf16 a[76:79], v[88:91], a[140:143], a[76:79]
    v_cndmask_b32 v127, v119, v127, vcc
    v_mfma_f32_16x16x32_bf16 a[76:79], v[80:83], a[144:147], a[76:79]
    v_mfma_f32_16x16x32_bf16 a[76:79], v[76:79], a[148:151], a[76:79]
    v_mfma_f32_16x16x32_bf16 a[8:11], v[84:87], a[128:131], a[8:11]
    buffer_load_dwordx4 v[196:199], v247, s[12:15], s68 offen offset:0 sc1
    v_mfma_f32_16x16x32_bf16 a[8:11], v[92:95], a[132:135], a[8:11]
    v_mfma_f32_16x16x32_bf16 a[8:11], v[96:99], a[136:139], a[8:11]
    v_mfma_f32_16x16x32_bf16 a[40:43], v[96:99], a[140:143], a[40:43]
    v_mfma_f32_16x16x32_bf16 a[40:43], v[92:95], a[144:147], a[40:43]
    v_mfma_f32_16x16x32_bf16 a[40:43], v[84:87], a[148:151], a[40:43]
    buffer_load_dwordx4 a[192:195], v1, s[16:19], s67 offen offset:0 sc1
    v_mfma_f32_16x16x32_bf16 a[40:43], v[80:83], a[128:131], a[40:43]
    v_mfma_f32_16x16x32_bf16 a[40:43], v[88:91], a[132:135], a[40:43]
    v_mfma_f32_16x16x32_bf16 a[40:43], v[100:103], a[136:139], a[40:43]
    v_mfma_f32_16x16x32_bf16 a[72:75], v[100:103], a[140:143], a[72:75]
    v_mfma_f32_16x16x32_bf16 a[72:75], v[88:91], a[144:147], a[72:75]
    buffer_load_dwordx4 v[200:203], v247, s[12:15], s67 offen offset:3072 sc1
    v_mfma_f32_16x16x32_bf16 a[72:75], v[80:83], a[148:151], a[72:75]
    v_mfma_f32_16x16x32_bf16 a[4:7], v[92:95], a[128:131], a[4:7]
    v_mfma_f32_16x16x32_bf16 a[4:7], v[96:99], a[132:135], a[4:7]
    v_mfma_f32_16x16x32_bf16 a[4:7], v[104:107], a[136:139], a[4:7]
    v_mfma_f32_16x16x32_bf16 a[36:39], v[104:107], a[140:143], a[36:39]
    buffer_load_dwordx4 a[196:199], v1, s[16:19], s67 offen offset:1024 sc1
    v_mfma_f32_16x16x32_bf16 a[36:39], v[96:99], a[144:147], a[36:39]
    v_mfma_f32_16x16x32_bf16 a[36:39], v[92:95], a[148:151], a[36:39]
    v_mfma_f32_16x16x32_bf16 a[36:39], v[88:91], a[128:131], a[36:39]
    v_mfma_f32_16x16x32_bf16 a[36:39], v[100:103], a[132:135], a[36:39]
    v_mfma_f32_16x16x32_bf16 a[36:39], v[108:111], a[136:139], a[36:39]
    buffer_load_dwordx4 v[204:207], v247, s[12:15], s67 offen offset:2048 sc1
    v_mfma_f32_16x16x32_bf16 a[68:71], v[108:111], a[140:143], a[68:71]
    v_mfma_f32_16x16x32_bf16 a[68:71], v[100:103], a[144:147], a[68:71]
    v_mfma_f32_16x16x32_bf16 a[68:71], v[88:91], a[148:151], a[68:71]
    v_mfma_f32_16x16x32_bf16 a[0:3], v[96:99], a[128:131], a[0:3]
    v_mfma_f32_16x16x32_bf16 a[0:3], v[104:107], a[132:135], a[0:3]
    buffer_load_dwordx4 a[200:203], v1, s[16:19], s67 offen offset:2048 sc1
    v_mfma_f32_16x16x32_bf16 a[0:3], v[120:123], a[136:139], a[0:3]
    v_mfma_f32_16x16x32_bf16 a[32:35], v[120:123], a[140:143], a[32:35]
    v_mfma_f32_16x16x32_bf16 a[32:35], v[104:107], a[144:147], a[32:35]
    v_mfma_f32_16x16x32_bf16 a[32:35], v[96:99], a[148:151], a[32:35]
    v_mfma_f32_16x16x32_bf16 a[32:35], v[100:103], a[128:131], a[32:35]
    buffer_load_dwordx4 v[208:211], v247, s[12:15], s67 offen offset:1024 sc1
    v_mfma_f32_16x16x32_bf16 a[32:35], v[108:111], a[132:135], a[32:35]
    v_mfma_f32_16x16x32_bf16 a[32:35], v[124:127], a[136:139], a[32:35]
    v_mfma_f32_16x16x32_bf16 a[64:67], v[124:127], a[140:143], a[64:67]
    v_mfma_f32_16x16x32_bf16 a[64:67], v[108:111], a[144:147], a[64:67]
    v_mfma_f32_16x16x32_bf16 a[64:67], v[100:103], a[148:151], a[64:67]
    buffer_load_dwordx4 a[204:207], v1, s[16:19], s67 offen offset:3072 sc1
    s_waitcnt vmcnt(31)
    v_mfma_f32_16x16x32_bf16 v[36:39], v[148:151], a[152:155], 0
    v_mov_b32_dpp v148, v148 row_shr:1 row_mask:0xf bank_mask:0xf
    v_mov_b32_dpp v149, v149 row_shr:1 row_mask:0xf bank_mask:0xf
    v_mfma_f32_16x16x32_bf16 v[36:39], v[152:155], a[156:159], v[36:39]
    v_mov_b32_dpp v150, v150 row_shr:1 row_mask:0xf bank_mask:0xf
    v_mov_b32_dpp v151, v151 row_shr:1 row_mask:0xf bank_mask:0xf
    v_mfma_f32_16x16x32_bf16 v[36:39], v[156:159], a[160:163], v[36:39]
    v_cndmask_b32_dpp v148, v144, v148, vcc row_shl:5 row_mask:0xf bank_mask:0xf
    v_cndmask_b32_dpp v149, v145, v149, vcc row_shl:5 row_mask:0xf bank_mask:0xf
    v_mfma_f32_16x16x32_bf16 v[36:39], v[160:163], a[164:167], v[36:39]
    v_cndmask_b32_dpp v150, v146, v150, vcc row_shl:5 row_mask:0xf bank_mask:0xf
    v_cndmask_b32_dpp v151, v147, v151, vcc row_shl:5 row_mask:0xf bank_mask:0xf
    s_waitcnt vmcnt(18)
    s_cmp_eq_u32 s78, 0
    s_cbranch_scc1 FU_nosig1_78
    s_add_u32 s33, s78, 20480
    v_mov_b32 v12, s33
    v_mov_b32 v13, s82
    s_mov_b64 exec, 1
    global_atomic_swap v12, v13, s[8:9] sc1
    s_mov_b64 exec, -1
FU_nosig1_78:
    s_cmp_eq_u32 s79, 0
    s_cbranch_scc1 FU_nosig1_79
    s_add_u32 s33, s79, 20480
    v_mov_b32 v12, s33
    v_mov_b32 v13, s82
    s_mov_b64 exec, 1
    global_atomic_swap v12, v13, s[8:9] sc1
    s_mov_b64 exec, -1
FU_nosig1_79:
    v_mfma_f32_16x16x32_bf16 v[36:39], v[164:167], a[168:171], v[36:39]
    buffer_load_dwordx4 v[212:215], v247, s[12:15], s67 offen offset:0 sc1
    v_mfma_f32_16x16x32_bf16 v[36:39], v[168:171], a[172:175], v[36:39]
    v_mfma_f32_16x16x32_bf16 v[36:39], v[172:175], a[176:179], v[36:39]
    v_mfma_f32_16x16x32_bf16 v[32:35], v[152:155], a[152:155], 0
    v_mov_b32_dpp v152, v152 row_shr:1 row_mask:0xf bank_mask:0xf
    v_mov_b32_dpp v153, v153 row_shr:1 row_mask:0xf bank_mask:0xf
    v_mfma_f32_16x16x32_bf16 v[32:35], v[156:159], a[156:159], v[32:35]
    s_waitcnt vmcnt(16)
    v_cmp_ne_u32 s[72:73], s82, v3
    v_cmp_ne_u32 s[74:75], s82, v253
    s_nop 4
    s_or_b64 s[72:73], s[72:73], s[74:75]
    s_cmp_lg_u64 s[72:73], 0
    s_cbranch_scc1 FU_poll1_again
FU_poll1_ok:
    s_barrier
    v_mov_b32_dpp v154, v154 row_shr:1 row_mask:0xf bank_mask:0xf
    v_mov_b32_dpp v155, v155 row_shr:1 row_mask:0xf bank_mask:0xf
    v_mfma_f32_16x16x32_bf16 v[32:35], v[160:163], a[160:163], v[32:35]
    buffer_load_dwordx4 v[216:219], v2, s[56:59], 0 offen offset:0 sc1
    v_cndmask_b32_dpp v152, v144, v152, vcc row_shl:4 row_mask:0xf bank_mask:0xf
    v_mfma_f32_16x16x32_bf16 v[32:35], v[164:167], a[164:167], v[32:35]
    v_cndmask_b32_dpp v153, v145, v153, vcc row_shl:4 row_mask:0xf bank_mask:0xf
    v_cndmask_b32_dpp v154, v146, v154, vcc row_shl:4 row_mask:0xf bank_mask:0xf
    v_mfma_f32_16x16x32_bf16 v[32:35], v[168:171], a[168:171], v[32:35]
    v_cndmask_b32_dpp v155, v147, v155, vcc row_shl:4 row_mask:0xf bank_mask:0xf
    v_mfma_f32_16x16x32_bf16 v[32:35], v[172:175], a[172:175], v[32:35]
    v_mfma_f32_16x16x32_bf16 v[32:35], v[176:179], a[176:179], v[32:35]
    v_mfma_f32_16x16x32_bf16 v[28:31], v[156:159], a[152:155], 0
    buffer_load_dwordx4 v[220:223], v2, s[56:59], s26 offen offset:0 sc1
    v_mov_b32_dpp v156, v156 row_shr:1 row_mask:0xf bank_mask:0xf
    v_mfma_f32_16x16x32_bf16 v[28:31], v[160:163], a[156:159], v[28:31]
    v_mov_b32_dpp v157, v157 row_shr:1 row_mask:0xf bank_mask:0xf
    v_mov_b32_dpp v158, v158 row_shr:1 row_mask:0xf bank_mask:0xf
    v_mfma_f32_16x16x32_bf16 v[28:31], v[164:167], a[160:163], v[28:31]
    v_mov_b32_dpp v159, v159 row_shr:1 row_mask:0xf bank_mask:0xf
    v_cndmask_b32_dpp v156, v144, v156, vcc row_shl:3 row_mask:0xf bank_mask:0xf
    v_mfma_f32_16x16x32_bf16 v[28:31], v[168:171], a[164:167], v[28:31]
    v_cndmask_b32_dpp v157, v145, v157, vcc row_shl:3 row_mask:0xf bank_mask:0xf
    v_cndmask_b32_dpp v158, v146, v158, vcc row_shl:3 row_mask:0xf bank_mask:0xf
    v_mfma_f32_16x16x32_bf16 v[28:31], v[172:175], a[168:171], v[28:31]
    v_cndmask_b32_dpp v159, v147, v159, vcc row_shl:3 row_mask:0xf bank_mask:0xf
    v_mfma_f32_16x16x32_bf16 v[28:31], v[176:179], a[172:175], v[28:31]
    buffer_load_dwordx4 v[224:227], v247, s[40:43], s25 offen offset:3072 sc1
    v_mfma_f32_16x16x32_bf16 v[28:31], v[148:151], a[176:179], v[28:31]
    v_mfma_f32_16x16x32_bf16 v[24:27], v[160:163], a[152:155], 0
    v_mov_b32_dpp v160, v160 row_shr:1 row_mask:0xf bank_mask:0xf
    v_mov_b32_dpp v161, v161 row_shr:1 row_mask:0xf bank_mask:0xf
    v_mfma_f32_16x16x32_bf16 v[24:27], v[164:167], a[156:159], v[24:27]
    v_mov_b32_dpp v162, v162 row_shr:1 row_mask:0xf bank_mask:0xf
    v_mfma_f32_16x16x32_bf16 v[24:27], v[168:171], a[160:163], v[24:27]
    v_mov_b32_dpp v163, v163 row_shr:1 row_mask:0xf bank_mask:0xf
    v_mfma_f32_16x16x32_bf16 v[24:27], v[172:175], a[164:167], v[24:27]
    buffer_load_dwordx4 a[208:211], v1, s[48:51], 0 offen offset:0 sc1
    v_mfma_f32_16x16x32_bf16 v[24:27], v[176:179], a[168:171], v[24:27]
    v_cndmask_b32_dpp v160, v144, v160, vcc row_shl:2 row_mask:0xf bank_mask:0xf
    v_mfma_f32_16x16x32_bf16 v[24:27], v[148:151], a[172:175], v[24:27]
    v_cndmask_b32_dpp v161, v145, v161, vcc row_shl:2 row_mask:0xf bank_mask:0xf
    v_mfma_f32_16x16x32_bf16 v[24:27], v[152:155], a[176:179], v[24:27]
    v_cndmask_b32_dpp v162, v146, v162, vcc row_shl:2 row_mask:0xf bank_mask:0xf
    v_mfma_f32_16x16x32_bf16 v[20:23], v[164:167], a[152:155], 0
    v_cndmask_b32_dpp v163, v147, v163, vcc row_shl:2 row_mask:0xf bank_mask:0xf
    v_mfma_f32_16x16x32_bf16 v[20:23], v[168:171], a[156:159], v[20:23]
    buffer_load_dwordx4 v[228:231], v247, s[40:43], s25 offen offset:2048 sc1
    v_mfma_f32_16x16x32_bf16 v[20:23], v[172:175], a[160:163], v[20:23]
    v_mov_b32_dpp v164, v164 row_shr:1 row_mask:0xf bank_mask:0xf
    v_mov_b32_dpp v165, v165 row_shr:1 row_mask:0xf bank_mask:0xf
    v_mfma_f32_16x16x32_bf16 v[20:23], v[176:179], a[164:167], v[20:23]
    v_mov_b32_dpp v166, v166 row_shr:1 row_mask:0xf bank_mask:0xf
    v_mov_b32_dpp v167, v167 row_shr:1 row_mask:0xf bank_mask:0xf
    v_mfma_f32_16x16x32_bf16 v[20:23], v[148:151], a[168:171], v[20:23]
    v_cndmask_b32_dpp v164, v144, v164, vcc row_shl:1 row_mask:0xf bank_mask:0xf
    v_cndmask_b32_dpp v165, v145, v165, vcc row_shl:1 row_mask:0xf bank_mask:0xf
    v_mfma_f32_16x16x32_bf16 v[20:23], v[152:155], a[172:175], v[20:23]
    v_cndmask_b32_dpp v166, v146, v166, vcc row_shl:1 row_mask:0xf bank_mask:0xf
    v_cndmask_b32_dpp v167, v147, v167, vcc row_shl:1 row_mask:0xf bank_mask:0xf
    v_mfma_f32_16x16x32_bf16 v[20:23], v[156:159], a[176:179], v[20:23]
    buffer_load_dwordx4 a[212:215], v1, s[48:51], 0 offen offset:1024 sc1
    v_mfma_f32_16x16x32_bf16 v[16:19], v[168:171], a[152:155], 0
    v_mov_b32_dpp v168, v168 row_shr:1 row_mask:0xf bank_mask:0xf
    v_mfma_f32_16x16x32_bf16 v[16:19], v[172:175], a[156:159], v[16:19]
    v_mov_b32_dpp v169, v169 row_shr:1 row_mask:0xf bank_mask:0xf
    v_mfma_f32_16x16x32_bf16 v[16:19], v[176:179], a[160:163], v[16:19]
    v_mov_b32_dpp v170, v170 row_shr:1 row_mask:0xf bank_mask:0xf
    v_mov_b32_dpp v171, v171 row_shr:1 row_mask:0xf bank_mask:0xf
    v_mfma_f32_16x16x32_bf16 v[16:19], v[148:151], a[164:167], v[16:19]
    v_cndmask_b32 v168, v144, v168, vcc
    v_cndmask_b32 v169, v145, v169, vcc
    v_mfma_f32_16x16x32_bf16 v[16:19], v[152:155], a[168:171], v[16:19]
    buffer_load_dwordx4 v[232:235], v247, s[40:43], s25 offen offset:1024 sc1
    v_cndmask_b32 v170, v146, v170, vcc
    v_mfma_f32_16x16x32_bf16 v[16:19], v[156:159], a[172:175], v[16:19]
    v_cndmask_b32 v171, v147, v171, vcc
    v_mfma_f32_16x16x32_bf16 v[16:19], v[160:163], a[176:179], v[16:19]
    v_mfma_f32_16x16x32_bf16 v[12:15], v[172:175], a[152:155], 0
    v_mfma_f32_16x16x32_bf16 v[12:15], v[176:179], a[156:159], v[12:15]
    v_mfma_f32_16x16x32_bf16 v[12:15], v[148:151], a[160:163], v[12:15]
    buffer_load_dwordx4 a[216:219], v1, s[48:51], 0 offen offset:2048 sc1
    v_mfma_f32_16x16x32_bf16 v[12:15], v[152:155], a[164:167], v[12:15]
    v_mfma_f32_16x16x32_bf16 v[12:15], v[156:159], a[168:171], v[12:15]
    v_mfma_f32_16x16x32_bf16 v[12:15], v[160:163], a[172:175], v[12:15]
    v_mfma_f32_16x16x32_bf16 v[12:15], v[164:167], a[176:179], v[12:15]
    v_mfma_f32_16x16x32_bf16 v[8:11], v[176:179], a[152:155], 0
    buffer_load_dwordx4 v[236:239], v247, s[40:43], s25 offen offset:0 sc1
    v_mfma_f32_16x16x32_bf16 v[8:11], v[148:151], a[156:159], v[8:11]
    v_mfma_f32_16x16x32_bf16 v[8:11], v[152:155], a[160:163], v[8:11]
    v_mfma_f32_16x16x32_bf16 v[8:11], v[156:159], a[164:167], v[8:11]
    v_mfma_f32_16x16x32_bf16 v[8:11], v[160:163], a[168:171], v[8:11]
    v_mfma_f32_16x16x32_bf16 v[8:11], v[164:167], a[172:175], v[8:11]
    buffer_load_dwordx4 a[220:223], v1, s[48:51], 0 offen offset:3072 sc1
    v_mfma_f32_16x16x32_bf16 v[8:11], v[168:171], a[176:179], v[8:11]
    s_waitcnt vmcnt(18)
    v_mfma_f32_16x16x32_bf16 v[68:71], v[184:187], a[180:183], 0
    v_mov_b32_dpp v184, v184 row_shr:1 row_mask:0xf bank_mask:0xf
    v_mov_b32_dpp v185, v185 row_shr:1 row_mask:0xf bank_mask:0xf
    v_mfma_f32_16x16x32_bf16 v[68:71], v[188:191], a[184:187], v[68:71]
    v_mov_b32_dpp v186, v186 row_shr:1 row_mask:0xf bank_mask:0xf
    v_mov_b32_dpp v187, v187 row_shr:1 row_mask:0xf bank_mask:0xf
    v_mfma_f32_16x16x32_bf16 v[68:71], v[192:195], a[188:191], v[68:71]
    v_cndmask_b32_dpp v184, v180, v184, vcc row_shl:5 row_mask:0xf bank_mask:0xf
    s_waitcnt vmcnt(17)
    v_mfma_f32_16x16x32_bf16 v[68:71], v[196:199], a[192:195], v[68:71]
    buffer_load_dwordx4 a[224:227], v1, s[48:51], s26 offen offset:2048 sc1
    s_waitcnt vmcnt(16)
    v_mfma_f32_16x16x32_bf16 v[68:71], v[200:203], a[196:199], v[68:71]
    v_cndmask_b32_dpp v185, v181, v185, vcc row_shl:5 row_mask:0xf bank_mask:0xf
    s_waitcnt vmcnt(14)
    v_mfma_f32_16x16x32_bf16 v[68:71], v[204:207], a[200:203], v[68:71]
    v_cndmask_b32_dpp v186, v182, v186, vcc row_shl:5 row_mask:0xf bank_mask:0xf
    s_waitcnt vmcnt(12)
    v_mfma_f32_16x16x32_bf16 v[68:71], v[208:211], a[204:207], v[68:71]
    v_cndmask_b32_dpp v187, v183, v187, vcc row_shl:5 row_mask:0xf bank_mask:0xf
    v_mfma_f32_16x16x32_bf16 v[64:67], v[188:191], a[180:183], 0
    v_mov_b32_dpp v188, v188 row_shr:1 row_mask:0xf bank_mask:0xf
    v_mov_b32_dpp v189, v189 row_shr:1 row_mask:0xf bank_mask:0xf
    v_mfma_f32_16x16x32_bf16 v[64:67], v[192:195], a[184:187], v[64:67]
    buffer_load_dwordx4 a[228:231], v1, s[48:51], s26 offen offset:1024 sc1
    v_mov_b32_dpp v190, v190 row_shr:1 row_mask:0xf bank_mask:0xf
    v_mfma_f32_16x16x32_bf16 v[64:67], v[196:199], a[188:191], v[64:67]
    v_mov_b32_dpp v191, v191 row_shr:1 row_mask:0xf bank_mask:0xf
    v_cndmask_b32_dpp v188, v180, v188, vcc row_shl:4 row_mask:0xf bank_mask:0xf
    v_mfma_f32_16x16x32_bf16 v[64:67], v[200:203], a[192:195], v[64:67]
    v_cndmask_b32_dpp v189, v181, v189, vcc row_shl:4 row_mask:0xf bank_mask:0xf
    v_cndmask_b32_dpp v190, v182, v190, vcc row_shl:4 row_mask:0xf bank_mask:0xf
    v_mfma_f32_16x16x32_bf16 v[64:67], v[204:207], a[196:199], v[64:67]
    v_cndmask_b32_dpp v191, v183, v191, vcc row_shl:4 row_mask:0xf bank_mask:0xf
    v_mfma_f32_16x16x32_bf16 v[64:67], v[208:211], a[200:203], v[64:67]
    s_waitcnt vmcnt(12)
    v_mfma_f32_16x16x32_bf16 v[64:67], v[212:215], a[204:207], v[64:67]
    buffer_load_dwordx4 a[232:235], v1, s[48:51], s26 offen offset:0 sc1
    v_mfma_f32_16x16x32_bf16 v[60:63], v[192:195], a[180:183], 0
    v_mov_b32_dpp v192, v192 row_shr:1 row_mask:0xf bank_mask:0xf
    v_mov_b32_dpp v193, v193 row_shr:1 row_mask:0xf bank_mask:0xf
    v_mfma_f32_16x16x32_bf16 v[60:63], v[196:199], a[184:187], v[60:63]
    v_mov_b32_dpp v194, v194 row_shr:1 row_mask:0xf bank_mask:0xf
    v_mov_b32_dpp v195, v195 row_shr:1 row_mask:0xf bank_mask:0xf
    v_mfma_f32_16x16x32_bf16 v[60:63], v[200:203], a[188:191], v[60:63]
    v_cndmask_b32_dpp v192, v180, v192, vcc row_shl:3 row_mask:0xf bank_mask:0xf
    v_cndmask_b32_dpp v193, v181, v193, vcc row_shl:3 row_mask:0xf bank_mask:0xf
    v_mfma_f32_16x16x32_bf16 v[60:63], v[204:207], a[192:195], v[60:63]
    v_cndmask_b32_dpp v194, v182, v194, vcc row_shl:3 row_mask:0xf bank_mask:0xf
    v_cndmask_b32_dpp v195, v183, v195, vcc row_shl:3 row_mask:0xf bank_mask:0xf
    v_mfma_f32_16x16x32_bf16 v[60:63], v[208:211], a[196:199], v[60:63]
    buffer_load_dwordx4 a[236:239], v1, s[48:51], s25 offen offset:3072 sc1
    v_mfma_f32_16x16x32_bf16 v[60:63], v[212:215], a[200:203], v[60:63]
    v_mfma_f32_16x16x32_bf16 v[60:63], v[184:187], a[204:207], v[60:63]
    v_mfma_f32_16x16x32_bf16 v[56:59], v[196:199], a[180:183], 0
    v_mov_b32_dpp v196, v196 row_shr:1 row_mask:0xf bank_mask:0xf
    v_mov_b32_dpp v197, v197 row_shr:1 row_mask:0xf bank_mask:0xf
    v_mfma_f32_16x16x32_bf16 v[56:59], v[200:203], a[184:187], v[56:59]
    v_mov_b32_dpp v198, v198 row_shr:1 row_mask:0xf bank_mask:0xf
    v_mov_b32_dpp v199, v199 row_shr:1 row_mask:0xf bank_mask:0xf
    v_mfma_f32_16x16x32_bf16 v[56:59], v[204:207], a[188:191], v[56:59]
    buffer_load_dwordx4 v[240:243], v247, s[40:43], s64 offen offset:3072 sc1
    v_cndmask_b32_dpp v196, v180, v196, vcc row_shl:2 row_mask:0xf bank_mask:0xf
    v_mfma_f32_16x16x32_bf16 v[56:59], v[208:211], a[192:195], v[56:59]
    v_cndmask_b32_dpp v197, v181, v197, vcc row_shl:2 row_mask:0xf bank_mask:0xf
    v_mfma_f32_16x16x32_bf16 v[56:59], v[212:215], a[196:199], v[56:59]
    buffer_load_dwordx4 v[128:131], v247, s[40:43], s64 offen offset:2048 sc1
    v_mfma_f32_16x16x32_bf16 v[56:59], v[184:187], a[200:203], v[56:59]
    buffer_load_dwordx4 v[132:135], v247, s[40:43], s64 offen offset:1024 sc1
    v_mfma_f32_16x16x32_bf16 v[56:59], v[188:191], a[204:207], v[56:59]
    buffer_load_dwordx4 v[136:139], v247, s[40:43], s64 offen offset:0 sc1
    v_mfma_f32_16x16x32_bf16 v[52:55], v[200:203], a[180:183], 0
    v_cndmask_b32_dpp v198, v182, v198, vcc row_shl:2 row_mask:0xf bank_mask:0xf
    v_mfma_f32_16x16x32_bf16 v[52:55], v[204:207], a[184:187], v[52:55]
    v_cndmask_b32_dpp v199, v183, v199, vcc row_shl:2 row_mask:0xf bank_mask:0xf
    v_mfma_f32_16x16x32_bf16 v[52:55], v[208:211], a[188:191], v[52:55]
    v_mov_b32_dpp v200, v200 row_shr:1 row_mask:0xf bank_mask:0xf
    v_mfma_f32_16x16x32_bf16 v[52:55], v[212:215], a[192:195], v[52:55]
    v_mov_b32_dpp v201, v201 row_shr:1 row_mask:0xf bank_mask:0xf
    v_mfma_f32_16x16x32_bf16 v[52:55], v[184:187], a[196:199], v[52:55]
    buffer_load_dwordx4 v[140:143], v247, s[40:43], 0 offen offset:3072 sc1
    v_mfma_f32_16x16x32_bf16 v[52:55], v[188:191], a[200:203], v[52:55]
    v_mov_b32_dpp v202, v202 row_shr:1 row_mask:0xf bank_mask:0xf
    v_mfma_f32_16x16x32_bf16 v[52:55], v[192:195], a[204:207], v[52:55]
    v_mov_b32_dpp v203, v203 row_shr:1 row_mask:0xf bank_mask:0xf
    v_mfma_f32_16x16x32_bf16 v[48:51], v[204:207], a[180:183], 0
    v_cndmask_b32_dpp v200, v180, v200, vcc row_shl:1 row_mask:0xf bank_mask:0xf
    v_mfma_f32_16x16x32_bf16 v[48:51], v[208:211], a[184:187], v[48:51]
    v_cndmask_b32_dpp v201, v181, v201, vcc row_shl:1 row_mask:0xf bank_mask:0xf
    v_mfma_f32_16x16x32_bf16 v[48:51], v[212:215], a[188:191], v[48:51]
    buffer_load_dwordx4 v[72:75], v247, s[40:43], s26 offen offset:3072 sc1
    v_mfma_f32_16x16x32_bf16 v[48:51], v[184:187], a[192:195], v[48:51]
    v_cndmask_b32_dpp v202, v182, v202, vcc row_shl:1 row_mask:0xf bank_mask:0xf
    v_mfma_f32_16x16x32_bf16 v[48:51], v[188:191], a[196:199], v[48:51]
    v_cndmask_b32_dpp v203, v183, v203, vcc row_shl:1 row_mask:0xf bank_mask:0xf
    v_mfma_f32_16x16x32_bf16 v[48:51], v[192:195], a[200:203], v[48:51]
    v_mov_b32_dpp v204, v204 row_shr:1 row_mask:0xf bank_mask:0xf
    v_mfma_f32_16x16x32_bf16 v[48:51], v[196:199], a[204:207], v[48:51]
    v_mov_b32_dpp v205, v205 row_shr:1 row_mask:0xf bank_mask:0xf
    v_mfma_f32_16x16x32_bf16 v[44:47], v[208:211], a[180:183], 0
    buffer_load_dwordx4 v[76:79], v247, s[40:43], 0 offen offset:2048 sc1
    v_mfma_f32_16x16x32_bf16 v[44:47], v[212:215], a[184:187], v[44:47]
    v_mov_b32_dpp v206, v206 row_shr:1 row_mask:0xf bank_mask:0xf
    v_mfma_f32_16x16x32_bf16 v[44:47], v[184:187], a[188:191], v[44:47]
    v_mov_b32_dpp v207, v207 row_shr:1 row_mask:0xf bank_mask:0xf
    v_mfma_f32_16x16x32_bf16 v[44:47], v[188:191], a[192:195], v[44:47]
    v_cndmask_b32 v204, v180, v204, vcc
    v_mfma_f32_16x16x32_bf16 v[44:47], v[192:195], a[196:199], v[44:47]
    v_cndmask_b32 v205, v181, v205, vcc
    v_mfma_f32_16x16x32_bf16 v[44:47], v[196:199], a[200:203], v[44:47]
    buffer_load_dwordx4 v[84:87], v247, s[40:43], s26 offen offset:2048 sc1
    v_mfma_f32_16x16x32_bf16 v[44:47], v[200:203], a[204:207], v[44:47]
    v_cndmask_b32 v206, v182, v206, vcc
    v_mfma_f32_16x16x32_bf16 v[40:43], v[212:215], a[180:183], 0
    v_cndmask_b32 v207, v183, v207, vcc
    v_mfma_f32_16x16x32_bf16 v[40:43], v[184:187], a[184:187], v[40:43]
    v_mfma_f32_16x16x32_bf16 v[40:43], v[188:191], a[188:191], v[40:43]
    v_mfma_f32_16x16x32_bf16 v[40:43], v[192:195], a[192:195], v[40:43]
    buffer_load_dwordx4 v[80:83], v247, s[40:43], 0 offen offset:1024 sc1
    v_mfma_f32_16x16x32_bf16 v[40:43], v[196:199], a[196:199], v[40:43]
    v_mfma_f32_16x16x32_bf16 v[40:43], v[200:203], a[200:203], v[40:43]
    v_mfma_f32_16x16x32_bf16 v[40:43], v[204:207], a[204:207], v[40:43]
    s_waitcnt vmcnt(19)
    v_mfma_f32_16x16x32_bf16 a[28:31], v[224:227], a[208:211], a[28:31]
    s_waitcnt vmcnt(17)
    v_mfma_f32_16x16x32_bf16 a[28:31], v[228:231], a[212:215], a[28:31]
    buffer_load_dwordx4 v[92:95], v247, s[40:43], s26 offen offset:1024 sc1
    s_waitcnt vmcnt(16)
    v_mfma_f32_16x16x32_bf16 a[28:31], v[232:235], a[216:219], a[28:31]
    s_waitcnt vmcnt(14)
    v_mfma_f32_16x16x32_bf16 a[28:31], v[236:239], a[220:223], a[28:31]
    s_waitcnt vmcnt(13)
    v_mfma_f32_16x16x32_bf16 a[60:63], v[236:239], a[224:227], a[60:63]
    s_waitcnt vmcnt(12)
    v_mfma_f32_16x16x32_bf16 a[60:63], v[232:235], a[228:231], a[60:63]
    s_waitcnt vmcnt(11)
    v_mfma_f32_16x16x32_bf16 a[60:63], v[228:231], a[232:235], a[60:63]
    buffer_load_dwordx4 v[88:91], v247, s[40:43], 0 offen offset:0 sc1
    s_waitcnt vmcnt(11)
    v_mfma_f32_16x16x32_bf16 a[60:63], v[224:227], a[236:239], a[60:63]
    s_waitcnt vmcnt(10)
    v_mfma_f32_16x16x32_bf16 a[60:63], v[240:243], a[208:211], a[60:63]
    s_waitcnt vmcnt(9)
    v_mfma_f32_16x16x32_bf16 a[60:63], v[128:131], a[212:215], a[60:63]
    s_waitcnt vmcnt(8)
    v_mfma_f32_16x16x32_bf16 a[60:63], v[132:135], a[216:219], a[60:63]
    s_waitcnt vmcnt(7)
    v_mfma_f32_16x16x32_bf16 a[60:63], v[136:139], a[220:223], a[60:63]
    buffer_load_dwordx4 v[112:115], v247, s[40:43], s26 offen offset:0 sc1
    v_mfma_f32_16x16x32_bf16 a[92:95], v[136:139], a[224:227], a[92:95]
    v_mov_b32_dpp v224, v224 row_shr:1 row_mask:0xf bank_mask:0xf
    v_mfma_f32_16x16x32_bf16 a[92:95], v[132:135], a[228:231], a[92:95]
    v_mov_b32_dpp v225, v225 row_shr:1 row_mask:0xf bank_mask:0xf
    v_mfma_f32_16x16x32_bf16 a[92:95], v[128:131], a[232:235], a[92:95]
    v_mov_b32_dpp v226, v226 row_shr:1 row_mask:0xf bank_mask:0xf
    v_mfma_f32_16x16x32_bf16 a[92:95], v[240:243], a[236:239], a[92:95]
    v_mov_b32_dpp v227, v227 row_shr:1 row_mask:0xf bank_mask:0xf
    v_mfma_f32_16x16x32_bf16 a[24:27], v[228:231], a[208:211], a[24:27]
    buffer_load_dwordx4 a[240:243], v1, s[48:51], s25 offen offset:0 sc1
    v_mfma_f32_16x16x32_bf16 a[24:27], v[232:235], a[212:215], a[24:27]
    v_cndmask_b32_dpp v224, v216, v224, vcc row_shl:5 row_mask:0xf bank_mask:0xf
    v_mfma_f32_16x16x32_bf16 a[24:27], v[236:239], a[216:219], a[24:27]
    s_waitcnt vmcnt(8)
    v_mfma_f32_16x16x32_bf16 a[24:27], v[140:143], a[220:223], a[24:27]
    v_cndmask_b32_dpp v225, v217, v225, vcc row_shl:5 row_mask:0xf bank_mask:0xf
    v_mfma_f32_16x16x32_bf16 a[56:59], v[140:143], a[224:227], a[56:59]
    v_cndmask_b32_dpp v226, v218, v226, vcc row_shl:5 row_mask:0xf bank_mask:0xf
    v_mfma_f32_16x16x32_bf16 a[56:59], v[236:239], a[228:231], a[56:59]
    buffer_load_dwordx4 a[244:247], v1, s[48:51], s25 offen offset:1024 sc1
    v_mfma_f32_16x16x32_bf16 a[56:59], v[232:235], a[232:235], a[56:59]
    v_cndmask_b32_dpp v227, v219, v227, vcc row_shl:5 row_mask:0xf bank_mask:0xf
    v_mfma_f32_16x16x32_bf16 a[56:59], v[228:231], a[236:239], a[56:59]
    v_mov_b32_dpp v240, v240 row_shr:1 row_mask:0xf bank_mask:0xf
    v_mfma_f32_16x16x32_bf16 a[56:59], v[128:131], a[208:211], a[56:59]
    v_mov_b32_dpp v241, v241 row_shr:1 row_mask:0xf bank_mask:0xf
    v_mfma_f32_16x16x32_bf16 a[56:59], v[132:135], a[212:215], a[56:59]
    v_mov_b32_dpp v242, v242 row_shr:1 row_mask:0xf bank_mask:0xf
    v_mfma_f32_16x16x32_bf16 a[56:59], v[136:139], a[216:219], a[56:59]
    buffer_load_dwordx4 a[248:251], v1, s[48:51], s25 offen offset:2048 sc1
    s_waitcnt vmcnt(9)
    v_mfma_f32_16x16x32_bf16 a[56:59], v[72:75], a[220:223], a[56:59]
    v_mov_b32_dpp v243, v243 row_shr:1 row_mask:0xf bank_mask:0xf
    v_mfma_f32_16x16x32_bf16 a[88:91], v[72:75], a[224:227], a[88:91]
    v_cndmask_b32_dpp v240, v220, v240, vcc row_shl:5 row_mask:0xf bank_mask:0xf
    v_mfma_f32_16x16x32_bf16 a[88:91], v[136:139], a[228:231], a[88:91]
    v_cndmask_b32_dpp v241, v221, v241, vcc row_shl:5 row_mask:0xf bank_mask:0xf
    v_mfma_f32_16x16x32_bf16 a[88:91], v[132:135], a[232:235], a[88:91]
    v_cndmask_b32_dpp v242, v222, v242, vcc row_shl:5 row_mask:0xf bank_mask:0xf
    v_mfma_f32_16x16x32_bf16 a[88:91], v[128:131], a[236:239], a[88:91]
    buffer_load_dwordx4 a[252:255], v1, s[48:51], s64 offen offset:1024 sc1
    v_mfma_f32_16x16x32_bf16 a[20:23], v[232:235], a[208:211], a[20:23]
    v_cndmask_b32_dpp v243, v223, v243, vcc row_shl:5 row_mask:0xf bank_mask:0xf
    v_mfma_f32_16x16x32_bf16 a[20:23], v[236:239], a[212:215], a[20:23]
    v_mov_b32_dpp v228, v228 row_shr:1 row_mask:0xf bank_mask:0xf
    v_mfma_f32_16x16x32_bf16 a[20:23], v[140:143], a[216:219], a[20:23]
    s_waitcnt vmcnt(9)
    v_mfma_f32_16x16x32_bf16 a[20:23], v[76:79], a[220:223], a[20:23]
    v_mov_b32_dpp v229, v229 row_shr:1 row_mask:0xf bank_mask:0xf
    v_mfma_f32_16x16x32_bf16 a[52:55], v[76:79], a[224:227], a[52:55]
    buffer_load_dwordx4 a[100:103], v1, s[48:51], s64 offen offset:0 sc1
    v_mfma_f32_16x16x32_bf16 a[52:55], v[140:143], a[228:231], a[52:55]
    v_mov_b32_dpp v230, v230 row_shr:1 row_mask:0xf bank_mask:0xf
    v_mfma_f32_16x16x32_bf16 a[52:55], v[236:239], a[232:235], a[52:55]
    v_mov_b32_dpp v231, v231 row_shr:1 row_mask:0xf bank_mask:0xf
    v_mfma_f32_16x16x32_bf16 a[52:55], v[232:235], a[236:239], a[52:55]
    v_cndmask_b32_dpp v228, v216, v228, vcc row_shl:4 row_mask:0xf bank_mask:0xf
    v_mfma_f32_16x16x32_bf16 a[52:55], v[132:135], a[208:211], a[52:55]
    v_cndmask_b32_dpp v229, v217, v229, vcc row_shl:4 row_mask:0xf bank_mask:0xf
    v_mfma_f32_16x16x32_bf16 a[52:55], v[136:139], a[212:215], a[52:55]
    buffer_load_dwordx4 a[96:99], v1, s[48:51], s26 offen offset:3072 sc1
    v_mfma_f32_16x16x32_bf16 a[52:55], v[72:75], a[216:219], a[52:55]
    s_waitcnt vmcnt(10)
    v_mfma_f32_16x16x32_bf16 a[52:55], v[84:87], a[220:223], a[52:55]
    v_cndmask_b32_dpp v230, v218, v230, vcc row_shl:4 row_mask:0xf bank_mask:0xf
    v_mfma_f32_16x16x32_bf16 a[84:87], v[84:87], a[224:227], a[84:87]
    v_cndmask_b32_dpp v231, v219, v231, vcc row_shl:4 row_mask:0xf bank_mask:0xf
    v_mfma_f32_16x16x32_bf16 a[84:87], v[72:75], a[228:231], a[84:87]
    v_mov_b32_dpp v128, v128 row_shr:1 row_mask:0xf bank_mask:0xf
    v_mfma_f32_16x16x32_bf16 a[84:87], v[136:139], a[232:235], a[84:87]
    buffer_load_dwordx4 v[120:123], v2, s[56:59], s65 offen offset:0 sc1
    v_mfma_f32_16x16x32_bf16 a[84:87], v[132:135], a[236:239], a[84:87]
    v_mov_b32_dpp v129, v129 row_shr:1 row_mask:0xf bank_mask:0xf
    v_mfma_f32_16x16x32_bf16 a[16:19], v[236:239], a[208:211], a[16:19]
    v_mov_b32_dpp v130, v130 row_shr:1 row_mask:0xf bank_mask:0xf
    v_mfma_f32_16x16x32_bf16 a[16:19], v[140:143], a[212:215], a[16:19]
    v_mov_b32_dpp v131, v131 row_shr:1 row_mask:0xf bank_mask:0xf
    v_mfma_f32_16x16x32_bf16 a[16:19], v[76:79], a[216:219], a[16:19]
    s_waitcnt vmcnt(10)
    v_mfma_f32_16x16x32_bf16 a[16:19], v[80:83], a[220:223], a[16:19]
    buffer_load_dwordx4 v[104:107], v247, s[40:43], s66 offen offset:3072 sc1
    v_mfma_f32_16x16x32_bf16 a[48:51], v[80:83], a[224:227], a[48:51]
    v_cndmask_b32_dpp v128, v220, v128, vcc row_shl:4 row_mask:0xf bank_mask:0xf
    v_mfma_f32_16x16x32_bf16 a[48:51], v[76:79], a[228:231], a[48:51]
    v_cndmask_b32_dpp v129, v221, v129, vcc row_shl:4 row_mask:0xf bank_mask:0xf
    v_mfma_f32_16x16x32_bf16 a[48:51], v[140:143], a[232:235], a[48:51]
    v_cndmask_b32_dpp v130, v222, v130, vcc row_shl:4 row_mask:0xf bank_mask:0xf
    v_mfma_f32_16x16x32_bf16 a[48:51], v[236:239], a[236:239], a[48:51]
    v_cndmask_b32_dpp v131, v223, v131, vcc row_shl:4 row_mask:0xf bank_mask:0xf
    v_mfma_f32_16x16x32_bf16 a[48:51], v[136:139], a[208:211], a[48:51]
    buffer_load_dwordx4 a[108:111], v1, s[48:51], s64 offen offset:2048 sc1
    v_mfma_f32_16x16x32_bf16 a[48:51], v[72:75], a[212:215], a[48:51]
    v_mov_b32_dpp v232, v232 row_shr:1 row_mask:0xf bank_mask:0xf
    v_mfma_f32_16x16x32_bf16 a[48:51], v[84:87], a[216:219], a[48:51]
    s_waitcnt vmcnt(11)
    v_mfma_f32_16x16x32_bf16 a[48:51], v[92:95], a[220:223], a[48:51]
    v_mov_b32_dpp v233, v233 row_shr:1 row_mask:0xf bank_mask:0xf
    v_mfma_f32_16x16x32_bf16 a[80:83], v[92:95], a[224:227], a[80:83]
    v_mov_b32_dpp v234, v234 row_shr:1 row_mask:0xf bank_mask:0xf
    v_mfma_f32_16x16x32_bf16 a[80:83], v[84:87], a[228:231], a[80:83]
    buffer_load_dwordx4 v[96:99], v247, s[40:43], s66 offen offset:2048 sc1
    v_mfma_f32_16x16x32_bf16 a[80:83], v[72:75], a[232:235], a[80:83]
    v_mov_b32_dpp v235, v235 row_shr:1 row_mask:0xf bank_mask:0xf
    v_mfma_f32_16x16x32_bf16 a[80:83], v[136:139], a[236:239], a[80:83]
    v_cndmask_b32_dpp v232, v216, v232, vcc row_shl:3 row_mask:0xf bank_mask:0xf
    v_mfma_f32_16x16x32_bf16 a[12:15], v[140:143], a[208:211], a[12:15]
    v_cndmask_b32_dpp v233, v217, v233, vcc row_shl:3 row_mask:0xf bank_mask:0xf
    v_mfma_f32_16x16x32_bf16 a[12:15], v[76:79], a[212:215], a[12:15]
    v_cndmask_b32_dpp v234, v218, v234, vcc row_shl:3 row_mask:0xf bank_mask:0xf
    v_mfma_f32_16x16x32_bf16 a[12:15], v[80:83], a[216:219], a[12:15]
    buffer_load_dwordx4 a[104:107], v1, s[48:51], s64 offen offset:3072 sc1
    s_waitcnt vmcnt(12)
    v_mfma_f32_16x16x32_bf16 a[12:15], v[88:91], a[220:223], a[12:15]
    v_cndmask_b32_dpp v235, v219, v235, vcc row_shl:3 row_mask:0xf bank_mask:0xf
    v_mfma_f32_16x16x32_bf16 a[44:47], v[88:91], a[224:227], a[44:47]
    v_mov_b32_dpp v132, v132 row_shr:1 row_mask:0xf bank_mask:0xf
    v_mfma_f32_16x16x32_bf16 a[44:47], v[80:83], a[228:231], a[44:47]
    v_mov_b32_dpp v133, v133 row_shr:1 row_mask:0xf bank_mask:0xf
    v_mfma_f32_16x16x32_bf16 a[44:47], v[76:79], a[232:235], a[44:47]
    v_mov_b32_dpp v134, v134 row_shr:1 row_mask:0xf bank_mask:0xf
    v_mfma_f32_16x16x32_bf16 a[44:47], v[140:143], a[236:239], a[44:47]
    buffer_load_dwordx4 v[116:119], v247, s[40:43], s66 offen offset:1024 sc1
    v_mfma_f32_16x16x32_bf16 a[44:47], v[72:75], a[208:211], a[44:47]
    v_mov_b32_dpp v135, v135 row_shr:1 row_mask:0xf bank_mask:0xf
    v_mfma_f32_16x16x32_bf16 a[44:47], v[84:87], a[212:215], a[44:47]
    v_cndmask_b32_dpp v132, v220, v132, vcc row_shl:3 row_mask:0xf bank_mask:0xf
    v_mfma_f32_16x16x32_bf16 a[44:47], v[92:95], a[216:219], a[44:47]
    s_waitcnt vmcnt(12)
    v_mfma_f32_16x16x32_bf16 a[44:47], v[112:115], a[220:223], a[44:47]
    v_cndmask_b32_dpp v133, v221, v133, vcc row_shl:3 row_mask:0xf bank_mask:0xf
    v_mfma_f32_16x16x32_bf16 a[76:79], v[112:115], a[224:227], a[76:79]
    buffer_load_dwordx4 a[116:119], v1, s[48:51], s65 offen offset:0 sc1
    v_mfma_f32_16x16x32_bf16 a[76:79], v[92:95], a[228:231], a[76:79]
    v_cndmask_b32_dpp v134, v222, v134, vcc row_shl:3 row_mask:0xf bank_mask:0xf
    v_mfma_f32_16x16x32_bf16 a[76:79], v[84:87], a[232:235], a[76:79]
    v_cndmask_b32_dpp v135, v223, v135, vcc row_shl:3 row_mask:0xf bank_mask:0xf
    v_mfma_f32_16x16x32_bf16 a[76:79], v[72:75], a[236:239], a[76:79]
    v_mov_b32_dpp v236, v236 row_shr:1 row_mask:0xf bank_mask:0xf
    v_mfma_f32_16x16x32_bf16 a[8:11], v[76:79], a[208:211], a[8:11]
    v_mov_b32_dpp v237, v237 row_shr:1 row_mask:0xf bank_mask:0xf
    v_mfma_f32_16x16x32_bf16 a[8:11], v[80:83], a[212:215], a[8:11]
    buffer_load_dwordx4 v[124:127], v247, s[40:43], s66 offen offset:0 sc1
    v_mfma_f32_16x16x32_bf16 a[8:11], v[88:91], a[216:219], a[8:11]
    v_mov_b32_dpp v238, v238 row_shr:1 row_mask:0xf bank_mask:0xf
    v_mfma_f32_16x16x32_bf16 a[8:11], v[224:227], a[220:223], a[8:11]
    v_mov_b32_dpp v239, v239 row_shr:1 row_mask:0xf bank_mask:0xf
    v_mfma_f32_16x16x32_bf16 a[40:43], v[224:227], a[224:227], a[40:43]
    v_cndmask_b32_dpp v236, v216, v236, vcc row_shl:2 row_mask:0xf bank_mask:0xf
    v_mfma_f32_16x16x32_bf16 a[40:43], v[88:91], a[228:231], a[40:43]
    v_cndmask_b32_dpp v237, v217, v237, vcc row_shl:2 row_mask:0xf bank_mask:0xf
    v_mfma_f32_16x16x32_bf16 a[40:43], v[80:83], a[232:235], a[40:43]
    buffer_load_dwordx4 a[112:115], v1, s[48:51], s65 offen offset:1024 sc1
    v_mfma_f32_16x16x32_bf16 a[40:43], v[76:79], a[236:239], a[40:43]
    v_cndmask_b32_dpp v238, v218, v238, vcc row_shl:2 row_mask:0xf bank_mask:0xf
    v_mfma_f32_16x16x32_bf16 a[40:43], v[84:87], a[208:211], a[40:43]
    v_cndmask_b32_dpp v239, v219, v239, vcc row_shl:2 row_mask:0xf bank_mask:0xf
    v_mfma_f32_16x16x32_bf16 a[40:43], v[92:95], a[212:215], a[40:43]
    v_mov_b32_dpp v136, v136 row_shr:1 row_mask:0xf bank_mask:0xf
    v_mfma_f32_16x16x32_bf16 a[40:43], v[112:115], a[216:219], a[40:43]
    v_mov_b32_dpp v137, v137 row_shr:1 row_mask:0xf bank_mask:0xf
    v_mfma_f32_16x16x32_bf16 a[40:43], v[240:243], a[220:223], a[40:43]
    buffer_load_dwordx4 v[108:111], v247, s[40:43], s65 offen offset:3072 sc1
    v_mfma_f32_16x16x32_bf16 a[72:75], v[240:243], a[224:227], a[72:75]
    v_mov_b32_dpp v138, v138 row_shr:1 row_mask:0xf bank_mask:0xf
    v_mfma_f32_16x16x32_bf16 a[72:75], v[112:115], a[228:231], a[72:75]
    v_mov_b32_dpp v139, v139 row_shr:1 row_mask:0xf bank_mask:0xf
    v_mfma_f32_16x16x32_bf16 a[72:75], v[92:95], a[232:235], a[72:75]
    v_cndmask_b32_dpp v136, v220, v136, vcc row_shl:2 row_mask:0xf bank_mask:0xf
    v_mfma_f32_16x16x32_bf16 a[72:75], v[84:87], a[236:239], a[72:75]
    v_cndmask_b32_dpp v137, v221, v137, vcc row_shl:2 row_mask:0xf bank_mask:0xf
    v_mfma_f32_16x16x32_bf16 a[4:7], v[80:83], a[208:211], a[4:7]
    buffer_load_dwordx4 a[124:127], v1, s[48:51], s65 offen offset:2048 sc1
    v_mfma_f32_16x16x32_bf16 a[4:7], v[88:91], a[212:215], a[4:7]
    v_cndmask_b32_dpp v138, v222, v138, vcc row_shl:2 row_mask:0xf bank_mask:0xf
    v_mfma_f32_16x16x32_bf16 a[4:7], v[224:227], a[216:219], a[4:7]
    v_cndmask_b32_dpp v139, v223, v139, vcc row_shl:2 row_mask:0xf bank_mask:0xf
    v_mfma_f32_16x16x32_bf16 a[4:7], v[228:231], a[220:223], a[4:7]
    v_mfma_f32_16x16x32_bf16 a[36:39], v[228:231], a[224:227], a[36:39]
    v_mfma_f32_16x16x32_bf16 a[36:39], v[224:227], a[228:231], a[36:39]
    buffer_load_dwordx4 v[100:103], v247, s[40:43], s65 offen offset:2048 sc1
    v_mfma_f32_16x16x32_bf16 a[36:39], v[88:91], a[232:235], a[36:39]
    v_mfma_f32_16x16x32_bf16 a[36:39], v[80:83], a[236:239], a[36:39]
    v_mfma_f32_16x16x32_bf16 a[36:39], v[92:95], a[208:211], a[36:39]
    v_mfma_f32_16x16x32_bf16 a[36:39], v[112:115], a[212:215], a[36:39]
    v_mfma_f32_16x16x32_bf16 a[36:39], v[240:243], a[216:219], a[36:39]
    buffer_load_dwordx4 a[120:123], v1, s[48:51], s65 offen offset:3072 sc1
    v_mfma_f32_16x16x32_bf16 a[36:39], v[128:131], a[220:223], a[36:39]
    v_mfma_f32_16x16x32_bf16 a[68:71], v[128:131], a[224:227], a[68:71]
    v_mfma_f32_16x16x32_bf16 a[68:71], v[240:243], a[228:231], a[68:71]
    v_mfma_f32_16x16x32_bf16 a[68:71], v[112:115], a[232:235], a[68:71]
    v_mfma_f32_16x16x32_bf16 a[68:71], v[92:95], a[236:239], a[68:71]
    buffer_load_dwordx4 v[172:175], v247, s[40:43], s65 offen offset:1024 sc1
    v_mfma_f32_16x16x32_bf16 a[0:3], v[88:91], a[208:211], a[0:3]
    v_mfma_f32_16x16x32_bf16 a[0:3], v[224:227], a[212:215], a[0:3]
K2_t0:
    v_mfma_f32_16x16x32_bf16 a[0:3], v[228:231], a[216:219], a[0:3]
    v_mfma_f32_16x16x32_bf16 a[0:3], v[232:235], a[220:223], a[0:3]
    v_mfma_f32_16x16x32_bf16 a[32:35], v[232:235], a[224:227], a[32:35]
    buffer_load_dwordx4 a[128:131], v1, s[48:51], s66 offen offset:0 sc1
    v_mfma_f32_16x16x32_bf16 a[32:35], v[228:231], a[228:231], a[32:35]
    v_mfma_f32_16x16x32_bf16 a[32:35], v[224:227], a[232:235], a[32:35]
    v_mfma_f32_16x16x32_bf16 a[32:35], v[88:91], a[236:239], a[32:35]
    v_mfma_f32_16x16x32_bf16 a[32:35], v[112:115], a[208:211], a[32:35]
    v_mfma_f32_16x16x32_bf16 a[32:35], v[240:243], a[212:215], a[32:35]
    buffer_load_dwordx4 v[176:179], v247, s[40:43], s65 offen offset:0 sc1
    v_mfma_f32_16x16x32_bf16 a[32:35], v[128:131], a[216:219], a[32:35]
    v_mfma_f32_16x16x32_bf16 a[32:35], v[132:135], a[220:223], a[32:35]
    v_mfma_f32_16x16x32_bf16 a[64:67], v[132:135], a[224:227], a[64:67]
    v_mfma_f32_16x16x32_bf16 a[64:67], v[128:131], a[228:231], a[64:67]
    global_load_dword v3, v254, s[8:9] sc1
    global_load_dword v254, v255, s[8:9] offset:512 sc1
    v_mfma_f32_16x16x32_bf16 a[64:67], v[240:243], a[232:235], a[64:67]
    buffer_load_dwordx4 v[148:151], v2, s[56:59], s67 offen offset:0 sc1
    v_mfma_f32_16x16x32_bf16 a[64:67], v[112:115], a[236:239], a[64:67]
    s_waitcnt vmcnt(20)
    v_mfma_f32_16x16x32_bf16 a[28:31], v[140:143], a[240:243], a[28:31]
    v_mfma_f32_16x16x32_bf16 a[28:31], v[76:79], a[244:247], a[28:31]
    v_mfma_f32_16x16x32_bf16 a[28:31], v[80:83], a[248:251], a[28:31]
    v_mfma_f32_16x16x32_bf16 a[60:63], v[80:83], a[252:255], a[60:63]
    buffer_load_dwordx4 v[152:155], v247, s[40:43], s68 offen offset:3072 sc1
    v_mfma_f32_16x16x32_bf16 a[60:63], v[76:79], a[100:103], a[60:63]
    s_waitcnt vmcnt(20)
    v_mfma_f32_16x16x32_bf16 a[60:63], v[140:143], a[96:99], a[60:63]
    v_mov_b32_dpp v140, v140 row_shr:1 row_mask:0xf bank_mask:0xf
    v_mfma_f32_16x16x32_bf16 a[60:63], v[72:75], a[240:243], a[60:63]
    v_mov_b32_dpp v141, v141 row_shr:1 row_mask:0xf bank_mask:0xf
    v_mfma_f32_16x16x32_bf16 a[60:63], v[84:87], a[244:247], a[60:63]
    v_mov_b32_dpp v142, v142 row_shr:1 row_mask:0xf bank_mask:0xf
    v_mfma_f32_16x16x32_bf16 a[60:63], v[92:95], a[248:251], a[60:63]
    buffer_load_dwordx4 a[132:135], v1, s[48:51], s66 offen offset:1024 sc1
    v_mfma_f32_16x16x32_bf16 a[92:95], v[92:95], a[252:255], a[92:95]
    v_mov_b32_dpp v143, v143 row_shr:1 row_mask:0xf bank_mask:0xf
    v_mfma_f32_16x16x32_bf16 a[92:95], v[84:87], a[100:103], a[92:95]
    v_cndmask_b32_dpp v140, v216, v140, vcc row_shl:1 row_mask:0xf bank_mask:0xf
    v_mfma_f32_16x16x32_bf16 a[92:95], v[72:75], a[96:99], a[92:95]
    v_cndmask_b32_dpp v141, v217, v141, vcc row_shl:1 row_mask:0xf bank_mask:0xf
    v_mfma_f32_16x16x32_bf16 a[24:27], v[76:79], a[240:243], a[24:27]
    v_cndmask_b32_dpp v142, v218, v142, vcc row_shl:1 row_mask:0xf bank_mask:0xf
    v_mfma_f32_16x16x32_bf16 a[24:27], v[80:83], a[244:247], a[24:27]
    buffer_load_dwordx4 v[156:159], v247, s[40:43], s68 offen offset:2048 sc1
    v_mfma_f32_16x16x32_bf16 a[24:27], v[88:91], a[248:251], a[24:27]
    v_cndmask_b32_dpp v143, v219, v143, vcc row_shl:1 row_mask:0xf bank_mask:0xf
    v_mfma_f32_16x16x32_bf16 a[56:59], v[88:91], a[252:255], a[56:59]
    v_mov_b32_dpp v72, v72 row_shr:1 row_mask:0xf bank_mask:0xf
    v_mfma_f32_16x16x32_bf16 a[56:59], v[80:83], a[100:103], a[56:59]
    v_mov_b32_dpp v73, v73 row_shr:1 row_mask:0xf bank_mask:0xf
    v_mfma_f32_16x16x32_bf16 a[56:59], v[76:79], a[96:99], a[56:59]
    v_mov_b32_dpp v74, v74 row_shr:1 row_mask:0xf bank_mask:0xf
    v_mfma_f32_16x16x32_bf16 a[56:59], v[84:87], a[240:243], a[56:59]
    buffer_load_dwordx4 a[136:139], v1, s[48:51], s66 offen offset:2048 sc1
    v_mfma_f32_16x16x32_bf16 a[56:59], v[92:95], a[244:247], a[56:59]
    v_mov_b32_dpp v75, v75 row_shr:1 row_mask:0xf bank_mask:0xf
    v_mfma_f32_16x16x32_bf16 a[56:59], v[112:115], a[248:251], a[56:59]
    v_cndmask_b32_dpp v72, v220, v72, vcc row_shl:1 row_mask:0xf bank_mask:0xf
    v_mfma_f32_16x16x32_bf16 a[88:91], v[112:115], a[252:255], a[88:91]
    v_cndmask_b32_dpp v73, v221, v73, vcc row_shl:1 row_mask:0xf bank_mask:0xf
    v_mfma_f32_16x16x32_bf16 a[88:91], v[92:95], a[100:103], a[88:91]
    v_cndmask_b32_dpp v74, v222, v74, vcc row_shl:1 row_mask:0xf bank_mask:0xf
    v_mfma_f32_16x16x32_bf16 a[88:91], v[84:87], a[96:99], a[88:91]
    buffer_load_dwordx4 v[160:163], v247, s[40:43], s68 offen offset:1024 sc1
    v_mfma_f32_16x16x32_bf16 a[20:23], v[80:83], a[240:243], a[20:23]
    v_cndmask_b32_dpp v75, v223, v75, vcc row_shl:1 row_mask:0xf bank_mask:0xf
    v_mfma_f32_16x16x32_bf16 a[20:23], v[88:91], a[244:247], a[20:23]
    v_mov_b32_dpp v76, v76 row_shr:1 row_mask:0xf bank_mask:0xf
    v_mfma_f32_16x16x32_bf16 a[20:23], v[224:227], a[248:251], a[20:23]
    v_mov_b32_dpp v77, v77 row_shr:1 row_mask:0xf bank_mask:0xf
    v_mfma_f32_16x16x32_bf16 a[52:55], v[224:227], a[252:255], a[52:55]
    v_mov_b32_dpp v78, v78 row_shr:1 row_mask:0xf bank_mask:0xf
    v_mfma_f32_16x16x32_bf16 a[52:55], v[88:91], a[100:103], a[52:55]
    buffer_load_dwordx4 a[140:143], v1, s[48:51], s66 offen offset:3072 sc1
    v_mfma_f32_16x16x32_bf16 a[52:55], v[80:83], a[96:99], a[52:55]
    v_mov_b32_dpp v79, v79 row_shr:1 row_mask:0xf bank_mask:0xf
    v_mfma_f32_16x16x32_bf16 a[52:55], v[92:95], a[240:243], a[52:55]
    v_cndmask_b32 v76, v216, v76, vcc
    v_mfma_f32_16x16x32_bf16 a[52:55], v[112:115], a[244:247], a[52:55]
    v_cndmask_b32 v77, v217, v77, vcc
    v_mfma_f32_16x16x32_bf16 a[52:55], v[240:243], a[248:251], a[52:55]
    v_cndmask_b32 v78, v218, v78, vcc
    v_mfma_f32_16x16x32_bf16 a[84:87], v[240:243], a[252:255], a[84:87]
    buffer_load_dwordx4 v[164:167], v247, s[40:43], s68 offen offset:0 sc1
    v_mfma_f32_16x16x32_bf16 a[84:87], v[112:115], a[100:103], a[84:87]
    v_cndmask_b32 v79, v219, v79, vcc
    v_mfma_f32_16x16x32_bf16 a[84:87], v[92:95], a[96:99], a[84:87]
    v_mov_b32_dpp v84, v84 row_shr:1 row_mask:0xf bank_mask:0xf
    v_mfma_f32_16x16x32_bf16 a[16:19], v[88:91], a[240:243], a[16:19]
    v_mov_b32_dpp v85, v85 row_shr:1 row_mask:0xf bank_mask:0xf
    v_mfma_f32_16x16x32_bf16 a[16:19], v[224:227], a[244:247], a[16:19]
    v_mov_b32_dpp v86, v86 row_shr:1 row_mask:0xf bank_mask:0xf
    v_mfma_f32_16x16x32_bf16 a[16:19], v[228:231], a[248:251], a[16:19]
    buffer_load_dwordx4 a[144:147], v1, s[48:51], s67 offen offset:0 sc1
    v_mfma_f32_16x16x32_bf16 a[48:51], v[228:231], a[252:255], a[48:51]
    v_mov_b32_dpp v87, v87 row_shr:1 row_mask:0xf bank_mask:0xf
    v_mfma_f32_16x16x32_bf16 a[48:51], v[224:227], a[100:103], a[48:51]
    v_cndmask_b32 v84, v220, v84, vcc
    v_mfma_f32_16x16x32_bf16 a[48:51], v[88:91], a[96:99], a[48:51]
    v_cndmask_b32 v85, v221, v85, vcc
    v_mfma_f32_16x16x32_bf16 a[48:51], v[112:115], a[240:243], a[48:51]
    v_cndmask_b32 v86, v222, v86, vcc
    v_mfma_f32_16x16x32_bf16 a[48:51], v[240:243], a[244:247], a[48:51]
    buffer_load_dwordx4 v[144:147], v247, s[40:43], s67 offen offset:3072 sc1
    v_mfma_f32_16x16x32_bf16 a[48:51], v[128:131], a[248:251], a[48:51]
    v_cndmask_b32 v87, v223, v87, vcc
    v_mfma_f32_16x16x32_bf16 a[80:83], v[128:131], a[252:255], a[80:83]
    v_mfma_f32_16x16x32_bf16 a[80:83], v[240:243], a[100:103], a[80:83]
    v_mfma_f32_16x16x32_bf16 a[80:83], v[112:115], a[96:99], a[80:83]
    v_mfma_f32_16x16x32_bf16 a[12:15], v[224:227], a[240:243], a[12:15]
    buffer_load_dwordx4 a[148:151], v1, s[48:51], s67 offen offset:1024 sc1
    v_mfma_f32_16x16x32_bf16 a[12:15], v[228:231], a[244:247], a[12:15]
    v_mfma_f32_16x16x32_bf16 a[12:15], v[232:235], a[248:251], a[12:15]
    v_mfma_f32_16x16x32_bf16 a[44:47], v[232:235], a[252:255], a[44:47]
    v_mfma_f32_16x16x32_bf16 a[44:47], v[228:231], a[100:103], a[44:47]
    v_mfma_f32_16x16x32_bf16 a[44:47], v[224:227], a[96:99], a[44:47]
    buffer_load_dwordx4 v[168:171], v247, s[40:43], s67 offen offset:2048 sc1
    v_mfma_f32_16x16x32_bf16 a[44:47], v[240:243], a[240:243], a[44:47]
    v_mfma_f32_16x16x32_bf16 a[44:47], v[128:131], a[244:247], a[44:47]
    v_mfma_f32_16x16x32_bf16 a[44:47], v[132:135], a[248:251], a[44:47]
    v_mfma_f32_16x16x32_bf16 a[76:79], v[132:135], a[252:255], a[76:79]
    v_mfma_f32_16x16x32_bf16 a[76:79], v[128:131], a[100:103], a[76:79]
    buffer_load_dwordx4 a[152:155], v1, s[48:51], s67 offen offset:2048 sc1
    v_mfma_f32_16x16x32_bf16 a[76:79], v[240:243], a[96:99], a[76:79]
    v_mfma_f32_16x16x32_bf16 a[8:11], v[228:231], a[240:243], a[8:11]
    v_mfma_f32_16x16x32_bf16 a[8:11], v[232:235], a[244:247], a[8:11]
    v_mfma_f32_16x16x32_bf16 a[8:11], v[236:239], a[248:251], a[8:11]
    v_mfma_f32_16x16x32_bf16 a[40:43], v[236:239], a[252:255], a[40:43]
    buffer_load_dwordx4 v[208:211], v247, s[40:43], s67 offen offset:1024 sc1
    v_mfma_f32_16x16x32_bf16 a[40:43], v[232:235], a[100:103], a[40:43]
    v_mfma_f32_16x16x32_bf16 a[40:43], v[228:231], a[96:99], a[40:43]
    v_mfma_f32_16x16x32_bf16 a[40:43], v[128:131], a[240:243], a[40:43]
    v_mfma_f32_16x16x32_bf16 a[40:43], v[132:135], a[244:247], a[40:43]
    v_mfma_f32_16x16x32_bf16 a[40:43], v[136:139], a[248:251], a[40:43]
    buffer_load_dwordx4 a[156:159], v1, s[48:51], s67 offen offset:3072 sc1
    v_mfma_f32_16x16x32_bf16 a[72:75], v[136:139], a[252:255], a[72:75]
    v_mfma_f32_16x16x32_bf16 a[72:75], v[132:135], a[100:103], a[72:75]
    v_mfma_f32_16x16x32_bf16 a[72:75], v[128:131], a[96:99], a[72:75]
    v_mfma_f32_16x16x32_bf16 a[4:7], v[232:235], a[240:243], a[4:7]
    v_mfma_f32_16x16x32_bf16 a[4:7], v[236:239], a[244:247], a[4:7]
    buffer_load_dwordx4 v[212:215], v247, s[40:43], s67 offen offset:0 sc1
    v_mfma_f32_16x16x32_bf16 a[4:7], v[140:143], a[248:251], a[4:7]
    v_mfma_f32_16x16x32_bf16 a[36:39], v[140:143], a[252:255], a[36:39]
    v_mfma_f32_16x16x32_bf16 a[36:39], v[236:239], a[100:103], a[36:39]
    v_mfma_f32_16x16x32_bf16 a[36:39], v[232:235], a[96:99], a[36:39]
    s_waitcnt vmcnt(16)
    v_cmp_ne_u32 s[72:73], s82, v3
    v_cmp_ne_u32 s[74:75], s82, v254
    s_nop 4
    s_or_b64 s[72:73], s[72:73], s[74:75]
    s_cmp_lg_u64 s[72:73], 0
    s_cbranch_scc1 FU_poll2_again
FU_poll2_ok:
    s_barrier
    v_mfma_f32_16x16x32_bf16 a[36:39], v[132:135], a[240:243], a[36:39]
    buffer_load_dwordx4 v[184:187], v2, s[60:63], 0 offen offset:0 sc1
    v_mfma_f32_16x16x32_bf16 a[36:39], v[136:139], a[244:247], a[36:39]
    v_mfma_f32_16x16x32_bf16 a[36:39], v[72:75], a[248:251], a[36:39]
    v_mfma_f32_16x16x32_bf16 a[68:71], v[72:75], a[252:255], a[68:71]
    v_mfma_f32_16x16x32_bf16 a[68:71], v[136:139], a[100:103], a[68:71]
    v_mfma_f32_16x16x32_bf16 a[68:71], v[132:135], a[96:99], a[68:71]
    buffer_load_dwordx4 v[188:191], v2, s[60:63], s26 offen offset:0 sc1
    v_mfma_f32_16x16x32_bf16 a[0:3], v[236:239], a[240:243], a[0:3]
    v_mfma_f32_16x16x32_bf16 a[0:3], v[140:143], a[244:247], a[0:3]
    v_mfma_f32_16x16x32_bf16 a[0:3], v[76:79], a[248:251], a[0:3]
    v_mfma_f32_16x16x32_bf16 a[32:35], v[76:79], a[252:255], a[32:35]
    v_mfma_f32_16x16x32_bf16 a[32:35], v[140:143], a[100:103], a[32:35]
    buffer_load_dwordx4 v[192:195], v247, s[44:47], s25 offen offset:3072 sc1
    v_mfma_f32_16x16x32_bf16 a[32:35], v[236:239], a[96:99], a[32:35]
    v_mfma_f32_16x16x32_bf16 a[32:35], v[136:139], a[240:243], a[32:35]
    v_mfma_f32_16x16x32_bf16 a[32:35], v[72:75], a[244:247], a[32:35]
    v_mfma_f32_16x16x32_bf16 a[32:35], v[84:87], a[248:251], a[32:35]
    v_mfma_f32_16x16x32_bf16 a[64:67], v[84:87], a[252:255], a[64:67]
    buffer_load_dwordx4 a[160:163], v1, s[52:55], 0 offen offset:0 sc1
    v_mfma_f32_16x16x32_bf16 a[64:67], v[72:75], a[100:103], a[64:67]
    v_mfma_f32_16x16x32_bf16 a[64:67], v[136:139], a[96:99], a[64:67]
    v_mfma_f32_16x16x32_bf16 v[36:39], v[104:107], a[108:111], v[36:39]
    v_mov_b32_dpp v104, v104 row_shr:1 row_mask:0xf bank_mask:0xf
    v_mov_b32_dpp v105, v105 row_shr:1 row_mask:0xf bank_mask:0xf
    v_mfma_f32_16x16x32_bf16 v[36:39], v[96:99], a[104:107], v[36:39]
    v_mov_b32_dpp v106, v106 row_shr:1 row_mask:0xf bank_mask:0xf
    v_mov_b32_dpp v107, v107 row_shr:1 row_mask:0xf bank_mask:0xf
    v_mfma_f32_16x16x32_bf16 v[36:39], v[116:119], a[116:119], v[36:39]
    buffer_load_dwordx4 v[196:199], v247, s[44:47], s25 offen offset:2048 sc1
    v_cndmask_b32_dpp v104, v120, v104, vcc row_shl:5 row_mask:0xf bank_mask:0xf
    v_mfma_f32_16x16x32_bf16 v[36:39], v[124:127], a[112:115], v[36:39]
    v_cndmask_b32_dpp v105, v121, v105, vcc row_shl:5 row_mask:0xf bank_mask:0xf
    v_cndmask_b32_dpp v106, v122, v106, vcc row_shl:5 row_mask:0xf bank_mask:0xf
    v_mfma_f32_16x16x32_bf16 v[36:39], v[108:111], a[124:127], v[36:39]
    v_cndmask_b32_dpp v107, v123, v107, vcc row_shl:5 row_mask:0xf bank_mask:0xf
    v_mfma_f32_16x16x32_bf16 v[36:39], v[100:103], a[120:123], v[36:39]
    v_mfma_f32_16x16x32_bf16 v[36:39], v[172:175], a[128:131], v[36:39]
    v_mfma_f32_16x16x32_bf16 v[32:35], v[96:99], a[108:111], v[32:35]
    buffer_load_dwordx4 a[164:167], v1, s[52:55], 0 offen offset:1024 sc1
    v_mov_b32_dpp v96, v96 row_shr:1 row_mask:0xf bank_mask:0xf
    v_mfma_f32_16x16x32_bf16 v[32:35], v[116:119], a[104:107], v[32:35]
    v_mov_b32_dpp v97, v97 row_shr:1 row_mask:0xf bank_mask:0xf
    v_mov_b32_dpp v98, v98 row_shr:1 row_mask:0xf bank_mask:0xf
    v_mfma_f32_16x16x32_bf16 v[32:35], v[124:127], a[116:119], v[32:35]
    v_mov_b32_dpp v99, v99 row_shr:1 row_mask:0xf bank_mask:0xf
    v_cndmask_b32_dpp v96, v120, v96, vcc row_shl:4 row_mask:0xf bank_mask:0xf
    v_mfma_f32_16x16x32_bf16 v[32:35], v[108:111], a[112:115], v[32:35]
    v_cndmask_b32_dpp v97, v121, v97, vcc row_shl:4 row_mask:0xf bank_mask:0xf
    v_cndmask_b32_dpp v98, v122, v98, vcc row_shl:4 row_mask:0xf bank_mask:0xf
    v_mfma_f32_16x16x32_bf16 v[32:35], v[100:103], a[124:127], v[32:35]
    v_cndmask_b32_dpp v99, v123, v99, vcc row_shl:4 row_mask:0xf bank_mask:0xf
    v_mfma_f32_16x16x32_bf16 v[32:35], v[172:175], a[120:123], v[32:35]
    buffer_load_dwordx4 v[200:203], v247, s[44:47], s25 offen offset:1024 sc1
    v_mfma_f32_16x16x32_bf16 v[32:35], v[176:179], a[128:131], v[32:35]
    v_mfma_f32_16x16x32_bf16 v[28:31], v[116:119], a[108:111], v[28:31]
    v_mov_b32_dpp v116, v116 row_shr:1 row_mask:0xf bank_mask:0xf
    v_mov_b32_dpp v117, v117 row_shr:1 row_mask:0xf bank_mask:0xf
    v_mfma_f32_16x16x32_bf16 v[28:31], v[124:127], a[104:107], v[28:31]
    v_mov_b32_dpp v118, v118 row_shr:1 row_mask:0xf bank_mask:0xf
    v_mov_b32_dpp v119, v119 row_shr:1 row_mask:0xf bank_mask:0xf
    v_mfma_f32_16x16x32_bf16 v[28:31], v[108:111], a[116:119], v[28:31]
    v_cndmask_b32_dpp v116, v120, v116, vcc row_shl:3 row_mask:0xf bank_mask:0xf
    v_cndmask_b32_dpp v117, v121, v117, vcc row_shl:3 row_mask:0xf bank_mask:0xf
    v_mfma_f32_16x16x32_bf16 v[28:31], v[100:103], a[112:115], v[28:31]
    buffer_load_dwordx4 a[168:171], v1, s[52:55], 0 offen offset:2048 sc1
    v_mfma_f32_16x16x32_bf16 v[28:31], v[172:175], a[124:127], v[28:31]
    v_cndmask_b32_dpp v118, v122, v118, vcc row_shl:3 row_mask:0xf bank_mask:0xf
    v_mfma_f32_16x16x32_bf16 v[28:31], v[176:179], a[120:123], v[28:31]
    v_cndmask_b32_dpp v119, v123, v119, vcc row_shl:3 row_mask:0xf bank_mask:0xf
    v_mfma_f32_16x16x32_bf16 v[28:31], v[104:107], a[128:131], v[28:31]
    v_mfma_f32_16x16x32_bf16 v[24:27], v[124:127], a[108:111], v[24:27]
    v_mov_b32_dpp v124, v124 row_shr:1 row_mask:0xf bank_mask:0xf
    v_mov_b32_dpp v125, v125 row_shr:1 row_mask:0xf bank_mask:0xf
    v_mfma_f32_16x16x32_bf16 v[24:27], v[108:111], a[104:107], v[24:27]
    buffer_load_dwordx4 v[180:183], v247, s[44:47], s25 offen offset:0 sc1
    v_mfma_f32_16x16x32_bf16 v[24:27], v[100:103], a[116:119], v[24:27]
    v_mov_b32_dpp v126, v126 row_shr:1 row_mask:0xf bank_mask:0xf
    v_mfma_f32_16x16x32_bf16 v[24:27], v[172:175], a[112:115], v[24:27]
    v_mov_b32_dpp v127, v127 row_shr:1 row_mask:0xf bank_mask:0xf
    v_mfma_f32_16x16x32_bf16 v[24:27], v[176:179], a[124:127], v[24:27]
    v_cndmask_b32_dpp v124, v120, v124, vcc row_shl:2 row_mask:0xf bank_mask:0xf
    v_mfma_f32_16x16x32_bf16 v[24:27], v[104:107], a[120:123], v[24:27]
    v_cndmask_b32_dpp v125, v121, v125, vcc row_shl:2 row_mask:0xf bank_mask:0xf
    v_mfma_f32_16x16x32_bf16 v[24:27], v[96:99], a[128:131], v[24:27]
    buffer_load_dwordx4 a[172:175], v1, s[52:55], 0 offen offset:3072 sc1
    v_mfma_f32_16x16x32_bf16 v[20:23], v[108:111], a[108:111], v[20:23]
    v_cndmask_b32_dpp v126, v122, v126, vcc row_shl:2 row_mask:0xf bank_mask:0xf
    v_mfma_f32_16x16x32_bf16 v[20:23], v[100:103], a[104:107], v[20:23]
    v_cndmask_b32_dpp v127, v123, v127, vcc row_shl:2 row_mask:0xf bank_mask:0xf
    v_mfma_f32_16x16x32_bf16 v[20:23], v[172:175], a[116:119], v[20:23]
    v_mov_b32_dpp v108, v108 row_shr:1 row_mask:0xf bank_mask:0xf
    v_mov_b32_dpp v109, v109 row_shr:1 row_mask:0xf bank_mask:0xf
    v_mfma_f32_16x16x32_bf16 v[20:23], v[176:179], a[112:115], v[20:23]
    v_mov_b32_dpp v110, v110 row_shr:1 row_mask:0xf bank_mask:0xf
    v_mfma_f32_16x16x32_bf16 v[20:23], v[104:107], a[124:127], v[20:23]
    buffer_load_dwordx4 a[176:179], v1, s[52:55], s26 offen offset:2048 sc1
    v_mfma_f32_16x16x32_bf16 v[20:23], v[96:99], a[120:123], v[20:23]
    v_mov_b32_dpp v111, v111 row_shr:1 row_mask:0xf bank_mask:0xf
    v_mfma_f32_16x16x32_bf16 v[20:23], v[116:119], a[128:131], v[20:23]
    v_cndmask_b32_dpp v108, v120, v108, vcc row_shl:1 row_mask:0xf bank_mask:0xf
    v_mfma_f32_16x16x32_bf16 v[16:19], v[100:103], a[108:111], v[16:19]
    v_cndmask_b32_dpp v109, v121, v109, vcc row_shl:1 row_mask:0xf bank_mask:0xf
    v_mfma_f32_16x16x32_bf16 v[16:19], v[172:175], a[104:107], v[16:19]
    v_cndmask_b32_dpp v110, v122, v110, vcc row_shl:1 row_mask:0xf bank_mask:0xf
    v_mfma_f32_16x16x32_bf16 v[16:19], v[176:179], a[116:119], v[16:19]
    buffer_load_dwordx4 a[180:183], v1, s[52:55], s26 offen offset:1024 sc1
    v_cndmask_b32_dpp v111, v123, v111, vcc row_shl:1 row_mask:0xf bank_mask:0xf
    v_mfma_f32_16x16x32_bf16 v[16:19], v[104:107], a[112:115], v[16:19]
    v_mov_b32_dpp v100, v100 row_shr:1 row_mask:0xf bank_mask:0xf
    v_mov_b32_dpp v101, v101 row_shr:1 row_mask:0xf bank_mask:0xf
    v_mfma_f32_16x16x32_bf16 v[16:19], v[96:99], a[124:127], v[16:19]
    v_mov_b32_dpp v102, v102 row_shr:1 row_mask:0xf bank_mask:0xf
    v_mfma_f32_16x16x32_bf16 v[16:19], v[116:119], a[120:123], v[16:19]
    v_mov_b32_dpp v103, v103 row_shr:1 row_mask:0xf bank_mask:0xf
    v_mfma_f32_16x16x32_bf16 v[16:19], v[124:127], a[128:131], v[16:19]
    v_cndmask_b32 v100, v120, v100, vcc
    v_mfma_f32_16x16x32_bf16 v[12:15], v[172:175], a[108:111], v[12:15]
    buffer_load_dwordx4 a[184:187], v1, s[52:55], s26 offen offset:0 sc1
    v_mfma_f32_16x16x32_bf16 v[12:15], v[176:179], a[104:107], v[12:15]
    v_cndmask_b32 v101, v121, v101, vcc
    v_mfma_f32_16x16x32_bf16 v[12:15], v[104:107], a[116:119], v[12:15]
    v_cndmask_b32 v102, v122, v102, vcc
    v_cndmask_b32 v103, v123, v103, vcc
    v_mfma_f32_16x16x32_bf16 v[12:15], v[96:99], a[112:115], v[12:15]
    v_mfma_f32_16x16x32_bf16 v[12:15], v[116:119], a[124:127], v[12:15]
    v_mfma_f32_16x16x32_bf16 v[12:15], v[124:127], a[120:123], v[12:15]
    buffer_load_dwordx4 a[188:191], v1, s[52:55], s25 offen offset:3072 sc1
    v_mfma_f32_16x16x32_bf16 v[12:15], v[108:111], a[128:131], v[12:15]
    v_mfma_f32_16x16x32_bf16 v[8:11], v[176:179], a[108:111], v[8:11]
    v_mfma_f32_16x16x32_bf16 v[8:11], v[104:107], a[104:107], v[8:11]
    v_mfma_f32_16x16x32_bf16 v[8:11], v[96:99], a[116:119], v[8:11]
    v_mfma_f32_16x16x32_bf16 v[8:11], v[116:119], a[112:115], v[8:11]
    buffer_load_dwordx4 v[204:207], v247, s[44:47], s64 offen offset:3072 sc1
    v_mfma_f32_16x16x32_bf16 v[8:11], v[124:127], a[124:127], v[8:11]
    v_mfma_f32_16x16x32_bf16 v[8:11], v[108:111], a[120:123], v[8:11]
    v_mfma_f32_16x16x32_bf16 v[8:11], v[100:103], a[128:131], v[8:11]
    s_waitcnt vmcnt(18)
    v_mfma_f32_16x16x32_bf16 v[68:71], v[152:155], a[132:135], v[68:71]
    v_mov_b32_dpp v152, v152 row_shr:1 row_mask:0xf bank_mask:0xf
    v_mov_b32_dpp v153, v153 row_shr:1 row_mask:0xf bank_mask:0xf
    v_mfma_f32_16x16x32_bf16 v[68:71], v[156:159], a[136:139], v[68:71]
    buffer_load_dwordx4 v[80:83], v247, s[44:47], s64 offen offset:2048 sc1
    v_mov_b32_dpp v154, v154 row_shr:1 row_mask:0xf bank_mask:0xf
    v_mfma_f32_16x16x32_bf16 v[68:71], v[160:163], a[140:143], v[68:71]
    v_mov_b32_dpp v155, v155 row_shr:1 row_mask:0xf bank_mask:0xf
    v_cndmask_b32_dpp v152, v148, v152, vcc row_shl:5 row_mask:0xf bank_mask:0xf
    v_mfma_f32_16x16x32_bf16 v[68:71], v[164:167], a[144:147], v[68:71]
    v_cndmask_b32_dpp v153, v149, v153, vcc row_shl:5 row_mask:0xf bank_mask:0xf
    v_cndmask_b32_dpp v154, v150, v154, vcc row_shl:5 row_mask:0xf bank_mask:0xf
    v_mfma_f32_16x16x32_bf16 v[68:71], v[144:147], a[148:151], v[68:71]
    v_cndmask_b32_dpp v155, v151, v155, vcc row_shl:5 row_mask:0xf bank_mask:0xf
    v_mfma_f32_16x16x32_bf16 v[68:71], v[168:171], a[152:155], v[68:71]
    s_waitcnt vmcnt(17)
    v_mfma_f32_16x16x32_bf16 v[68:71], v[208:211], a[156:159], v[68:71]
    buffer_load_dwordx4 v[92:95], v247, s[44:47], s64 offen offset:1024 sc1
    v_mfma_f32_16x16x32_bf16 v[64:67], v[156:159], a[132:135], v[64:67]
    v_mov_b32_dpp v156, v156 row_shr:1 row_mask:0xf bank_mask:0xf
    v_mov_b32_dpp v157, v157 row_shr:1 row_mask:0xf bank_mask:0xf
    v_mfma_f32_16x16x32_bf16 v[64:67], v[160:163], a[136:139], v[64:67]
    v_mov_b32_dpp v158, v158 row_shr:1 row_mask:0xf bank_mask:0xf
    v_mov_b32_dpp v159, v159 row_shr:1 row_mask:0xf bank_mask:0xf
    v_mfma_f32_16x16x32_bf16 v[64:67], v[164:167], a[140:143], v[64:67]
    v_cndmask_b32_dpp v156, v148, v156, vcc row_shl:4 row_mask:0xf bank_mask:0xf
    v_cndmask_b32_dpp v157, v149, v157, vcc row_shl:4 row_mask:0xf bank_mask:0xf
    v_mfma_f32_16x16x32_bf16 v[64:67], v[144:147], a[144:147], v[64:67]
    v_cndmask_b32_dpp v158, v150, v158, vcc row_shl:4 row_mask:0xf bank_mask:0xf
    v_cndmask_b32_dpp v159, v151, v159, vcc row_shl:4 row_mask:0xf bank_mask:0xf
    v_mfma_f32_16x16x32_bf16 v[64:67], v[168:171], a[148:151], v[64:67]
    buffer_load_dwordx4 v[88:91], v247, s[44:47], s64 offen offset:0 sc1
    v_mfma_f32_16x16x32_bf16 v[64:67], v[208:211], a[152:155], v[64:67]
    s_waitcnt vmcnt(18)
    v_mfma_f32_16x16x32_bf16 v[64:67], v[212:215], a[156:159], v[64:67]
    v_mfma_f32_16x16x32_bf16 v[60:63], v[160:163], a[132:135], v[60:63]
    v_mov_b32_dpp v160, v160 row_shr:1 row_mask:0xf bank_mask:0xf
    v_mov_b32_dpp v161, v161 row_shr:1 row_mask:0xf bank_mask:0xf
    v_mfma_f32_16x16x32_bf16 v[60:63], v[164:167], a[136:139], v[60:63]
    v_mov_b32_dpp v162, v162 row_shr:1 row_mask:0xf bank_mask:0xf
    v_mov_b32_dpp v163, v163 row_shr:1 row_mask:0xf bank_mask:0xf
    v_mfma_f32_16x16x32_bf16 v[60:63], v[144:147], a[140:143], v[60:63]
    buffer_load_dwordx4 v[112:115], v247, s[44:47], 0 offen offset:3072 sc1
    v_cndmask_b32_dpp v160, v148, v160, vcc row_shl:3 row_mask:0xf bank_mask:0xf
    v_mfma_f32_16x16x32_bf16 v[60:63], v[168:171], a[144:147], v[60:63]
    v_cndmask_b32_dpp v161, v149, v161, vcc row_shl:3 row_mask:0xf bank_mask:0xf
    v_cndmask_b32_dpp v162, v150, v162, vcc row_shl:3 row_mask:0xf bank_mask:0xf
    v_mfma_f32_16x16x32_bf16 v[60:63], v[208:211], a[148:151], v[60:63]
    v_cndmask_b32_dpp v163, v151, v163, vcc row_shl:3 row_mask:0xf bank_mask:0xf
    v_mfma_f32_16x16x32_bf16 v[60:63], v[212:215], a[152:155], v[60:63]
    v_mfma_f32_16x16x32_bf16 v[60:63], v[152:155], a[156:159], v[60:63]
    v_mfma_f32_16x16x32_bf16 v[56:59], v[164:167], a[132:135], v[56:59]
    buffer_load_dwordx4 v[224:227], v247, s[44:47], s26 offen offset:3072 sc1
    v_mov_b32_dpp v164, v164 row_shr:1 row_mask:0xf bank_mask:0xf
    v_mfma_f32_16x16x32_bf16 v[56:59], v[144:147], a[136:139], v[56:59]
    v_mov_b32_dpp v165, v165 row_shr:1 row_mask:0xf bank_mask:0xf
    v_mov_b32_dpp v166, v166 row_shr:1 row_mask:0xf bank_mask:0xf
    v_mfma_f32_16x16x32_bf16 v[56:59], v[168:171], a[140:143], v[56:59]
    v_mov_b32_dpp v167, v167 row_shr:1 row_mask:0xf bank_mask:0xf
    v_mfma_f32_16x16x32_bf16 v[56:59], v[208:211], a[144:147], v[56:59]
    v_cndmask_b32_dpp v164, v148, v164, vcc row_shl:2 row_mask:0xf bank_mask:0xf
    v_mfma_f32_16x16x32_bf16 v[56:59], v[212:215], a[148:151], v[56:59]
    v_cndmask_b32_dpp v165, v149, v165, vcc row_shl:2 row_mask:0xf bank_mask:0xf
    v_mfma_f32_16x16x32_bf16 v[56:59], v[152:155], a[152:155], v[56:59]
    buffer_load_dwordx4 v[128:131], v247, s[44:47], 0 offen offset:2048 sc1
    v_mfma_f32_16x16x32_bf16 v[56:59], v[156:159], a[156:159], v[56:59]
    v_cndmask_b32_dpp v166, v150, v166, vcc row_shl:2 row_mask:0xf bank_mask:0xf
    v_mfma_f32_16x16x32_bf16 v[52:55], v[144:147], a[132:135], v[52:55]
    v_cndmask_b32_dpp v167, v151, v167, vcc row_shl:2 row_mask:0xf bank_mask:0xf
    v_mfma_f32_16x16x32_bf16 v[52:55], v[168:171], a[136:139], v[52:55]
    v_mov_b32_dpp v144, v144 row_shr:1 row_mask:0xf bank_mask:0xf
    v_mfma_f32_16x16x32_bf16 v[52:55], v[208:211], a[140:143], v[52:55]
    v_mov_b32_dpp v145, v145 row_shr:1 row_mask:0xf bank_mask:0xf
    v_mfma_f32_16x16x32_bf16 v[52:55], v[212:215], a[144:147], v[52:55]
    buffer_load_dwordx4 v[132:135], v247, s[44:47], s26 offen offset:2048 sc1
    v_mfma_f32_16x16x32_bf16 v[52:55], v[152:155], a[148:151], v[52:55]
    v_mov_b32_dpp v146, v146 row_shr:1 row_mask:0xf bank_mask:0xf
    v_mfma_f32_16x16x32_bf16 v[52:55], v[156:159], a[152:155], v[52:55]
    v_mov_b32_dpp v147, v147 row_shr:1 row_mask:0xf bank_mask:0xf
    s_add_u32 s33, s90, K2_t1-FU_pc
    s_min_u32 s33, s33, K2_code_end-FU_pc-4
    s_load_dword s99, s[92:93], s33
    v_mfma_f32_16x16x32_bf16 v[52:55], v[160:163], a[156:159], v[52:55]
    v_cndmask_b32_dpp v144, v148, v144, vcc row_shl:1 row_mask:0xf bank_mask:0xf
    v_mfma_f32_16x16x32_bf16 v[48:51], v[168:171], a[132:135], v[48:51]
    v_cndmask_b32_dpp v145, v149, v145, vcc row_shl:1 row_mask:0xf bank_mask:0xf
    v_mfma_f32_16x16x32_bf16 v[48:51], v[208:211], a[136:139], v[48:51]
    buffer_load_dwordx4 v[216:219], v247, s[44:47], 0 offen offset:1024 sc1
    v_mfma_f32_16x16x32_bf16 v[48:51], v[212:215], a[140:143], v[48:51]
    v_cndmask_b32_dpp v146, v150, v146, vcc row_shl:1 row_mask:0xf bank_mask:0xf
    v_mfma_f32_16x16x32_bf16 v[48:51], v[152:155], a[144:147], v[48:51]
    v_cndmask_b32_dpp v147, v151, v147, vcc row_shl:1 row_mask:0xf bank_mask:0xf
    v_mfma_f32_16x16x32_bf16 v[48:51], v[156:159], a[148:151], v[48:51]
    v_mov_b32_dpp v168, v168 row_shr:1 row_mask:0xf bank_mask:0xf
    v_mfma_f32_16x16x32_bf16 v[48:51], v[160:163], a[152:155], v[48:51]
    v_mov_b32_dpp v169, v169 row_shr:1 row_mask:0xf bank_mask:0xf
    v_mfma_f32_16x16x32_bf16 v[48:51], v[164:167], a[156:159], v[48:51]
    buffer_load_dwordx4 v[76:79], v247, s[44:47], s26 offen offset:1024 sc1
    v_mfma_f32_16x16x32_bf16 v[44:47], v[208:211], a[132:135], v[44:47]
    v_mov_b32_dpp v170, v170 row_shr:1 row_mask:0xf bank_mask:0xf
    v_mfma_f32_16x16x32_bf16 v[44:47], v[212:215], a[136:139], v[44:47]
    v_mov_b32_dpp v171, v171 row_shr:1 row_mask:0xf bank_mask:0xf
    v_mfma_f32_16x16x32_bf16 v[44:47], v[152:155], a[140:143], v[44:47]
    v_cndmask_b32 v168, v148, v168, vcc
    v_mfma_f32_16x16x32_bf16 v[44:47], v[156:159], a[144:147], v[44:47]
    v_cndmask_b32 v169, v149, v169, vcc
    v_mfma_f32_16x16x32_bf16 v[44:47], v[160:163], a[148:151], v[44:47]
    buffer_load_dwordx4 v[140:143], v247, s[44:47], 0 offen offset:0 sc1
    v_mfma_f32_16x16x32_bf16 v[44:47], v[164:167], a[152:155], v[44:47]
    v_cndmask_b32 v170, v150, v170, vcc
    v_mfma_f32_16x16x32_bf16 v[44:47], v[144:147], a[156:159], v[44:47]
    v_cndmask_b32 v171, v151, v171, vcc
    v_mfma_f32_16x16x32_bf16 v[40:43], v[212:215], a[132:135], v[40:43]
    v_mfma_f32_16x16x32_bf16 v[40:43], v[152:155], a[136:139], v[40:43]
    v_mfma_f32_16x16x32_bf16 v[40:43], v[156:159], a[140:143], v[40:43]
    buffer_load_dwordx4 v[220:223], v247, s[44:47], s26 offen offset:0 sc1
    v_mfma_f32_16x16x32_bf16 v[40:43], v[160:163], a[144:147], v[40:43]
    v_mfma_f32_16x16x32_bf16 v[40:43], v[164:167], a[148:151], v[40:43]
    v_mfma_f32_16x16x32_bf16 v[40:43], v[144:147], a[152:155], v[40:43]
    v_mfma_f32_16x16x32_bf16 v[40:43], v[168:171], a[156:159], v[40:43]
    s_waitcnt vmcnt(18)
    v_mfma_f32_16x16x32_bf16 a[28:31], v[192:195], a[160:163], a[28:31]
    buffer_load_dwordx4 a[192:195], v1, s[52:55], s25 offen offset:0 sc1
    v_mfma_f32_16x16x32_bf16 a[28:31], v[196:199], a[164:167], a[28:31]
    v_mfma_f32_16x16x32_bf16 a[28:31], v[200:203], a[168:171], a[28:31]
    s_waitcnt vmcnt(17)
    v_mfma_f32_16x16x32_bf16 a[28:31], v[180:183], a[172:175], a[28:31]
    s_waitcnt vmcnt(16)
    v_mfma_f32_16x16x32_bf16 a[60:63], v[180:183], a[176:179], a[60:63]
    s_waitcnt vmcnt(15)
    v_mfma_f32_16x16x32_bf16 a[60:63], v[200:203], a[180:183], a[60:63]
    buffer_load_dwordx4 a[196:199], v1, s[52:55], s25 offen offset:1024 sc1
    s_waitcnt vmcnt(15)
    v_mfma_f32_16x16x32_bf16 a[60:63], v[196:199], a[184:187], a[60:63]
    s_waitcnt vmcnt(14)
    v_mfma_f32_16x16x32_bf16 a[60:63], v[192:195], a[188:191], a[60:63]
    s_waitcnt vmcnt(13)
    v_mfma_f32_16x16x32_bf16 a[60:63], v[204:207], a[160:163], a[60:63]
    s_waitcnt vmcnt(12)
    v_mfma_f32_16x16x32_bf16 a[60:63], v[80:83], a[164:167], a[60:63]
    s_waitcnt vmcnt(11)
    v_mfma_f32_16x16x32_bf16 a[60:63], v[92:95], a[168:171], a[60:63]
    buffer_load_dwordx4 a[200:203], v1, s[52:55], s25 offen offset:2048 sc1
    s_waitcnt vmcnt(11)
    v_mfma_f32_16x16x32_bf16 a[60:63], v[88:91], a[172:175], a[60:63]
    v_mov_b32_dpp v192, v192 row_shr:1 row_mask:0xf bank_mask:0xf
    v_mfma_f32_16x16x32_bf16 a[92:95], v[88:91], a[176:179], a[92:95]
    v_mov_b32_dpp v193, v193 row_shr:1 row_mask:0xf bank_mask:0xf
    v_mfma_f32_16x16x32_bf16 a[92:95], v[92:95], a[180:183], a[92:95]
    v_mov_b32_dpp v194, v194 row_shr:1 row_mask:0xf bank_mask:0xf
    v_mfma_f32_16x16x32_bf16 a[92:95], v[80:83], a[184:187], a[92:95]
    v_mov_b32_dpp v195, v195 row_shr:1 row_mask:0xf bank_mask:0xf
    v_mfma_f32_16x16x32_bf16 a[92:95], v[204:207], a[188:191], a[92:95]
    buffer_load_dwordx4 a[204:207], v1, s[52:55], s64 offen offset:1024 sc1
    v_mfma_f32_16x16x32_bf16 a[24:27], v[196:199], a[160:163], a[24:27]
    v_cndmask_b32_dpp v192, v184, v192, vcc row_shl:5 row_mask:0xf bank_mask:0xf
    v_mfma_f32_16x16x32_bf16 a[24:27], v[200:203], a[164:167], a[24:27]
    v_cndmask_b32_dpp v193, v185, v193, vcc row_shl:5 row_mask:0xf bank_mask:0xf
    v_mfma_f32_16x16x32_bf16 a[24:27], v[180:183], a[168:171], a[24:27]
    s_waitcnt vmcnt(11)
    v_mfma_f32_16x16x32_bf16 a[24:27], v[112:115], a[172:175], a[24:27]
    v_cndmask_b32_dpp v194, v186, v194, vcc row_shl:5 row_mask:0xf bank_mask:0xf
    v_mfma_f32_16x16x32_bf16 a[56:59], v[112:115], a[176:179], a[56:59]
    buffer_load_dwordx4 a[208:211], v1, s[52:55], s64 offen offset:0 sc1
    v_mfma_f32_16x16x32_bf16 a[56:59], v[180:183], a[180:183], a[56:59]
    v_cndmask_b32_dpp v195, v187, v195, vcc row_shl:5 row_mask:0xf bank_mask:0xf
    v_mfma_f32_16x16x32_bf16 a[56:59], v[200:203], a[184:187], a[56:59]
    v_mov_b32_dpp v204, v204 row_shr:1 row_mask:0xf bank_mask:0xf
    v_mfma_f32_16x16x32_bf16 a[56:59], v[196:199], a[188:191], a[56:59]
    v_mov_b32_dpp v205, v205 row_shr:1 row_mask:0xf bank_mask:0xf
    v_mfma_f32_16x16x32_bf16 a[56:59], v[80:83], a[160:163], a[56:59]
    v_mov_b32_dpp v206, v206 row_shr:1 row_mask:0xf bank_mask:0xf
    v_mfma_f32_16x16x32_bf16 a[56:59], v[92:95], a[164:167], a[56:59]
    buffer_load_dwordx4 a[212:215], v1, s[52:55], s26 offen offset:3072 sc1
    v_mfma_f32_16x16x32_bf16 a[56:59], v[88:91], a[168:171], a[56:59]
    s_waitcnt vmcnt(12)
    v_mfma_f32_16x16x32_bf16 a[56:59], v[224:227], a[172:175], a[56:59]
    v_mov_b32_dpp v207, v207 row_shr:1 row_mask:0xf bank_mask:0xf
    v_mfma_f32_16x16x32_bf16 a[88:91], v[224:227], a[176:179], a[88:91]
    v_cndmask_b32_dpp v204, v188, v204, vcc row_shl:5 row_mask:0xf bank_mask:0xf
    v_mfma_f32_16x16x32_bf16 a[88:91], v[88:91], a[180:183], a[88:91]
    v_cndmask_b32_dpp v205, v189, v205, vcc row_shl:5 row_mask:0xf bank_mask:0xf
    v_mfma_f32_16x16x32_bf16 a[88:91], v[92:95], a[184:187], a[88:91]
    buffer_load_dwordx4 v[84:87], v247, s[44:47], s66 offen offset:3072 sc1
    v_mfma_f32_16x16x32_bf16 a[88:91], v[80:83], a[188:191], a[88:91]
    v_cndmask_b32_dpp v206, v190, v206, vcc row_shl:5 row_mask:0xf bank_mask:0xf
    v_mfma_f32_16x16x32_bf16 a[20:23], v[200:203], a[160:163], a[20:23]
    v_cndmask_b32_dpp v207, v191, v207, vcc row_shl:5 row_mask:0xf bank_mask:0xf
    v_mfma_f32_16x16x32_bf16 a[20:23], v[180:183], a[164:167], a[20:23]
    v_mov_b32_dpp v196, v196 row_shr:1 row_mask:0xf bank_mask:0xf
    v_mfma_f32_16x16x32_bf16 a[20:23], v[112:115], a[168:171], a[20:23]
    s_waitcnt vmcnt(12)
    v_mfma_f32_16x16x32_bf16 a[20:23], v[128:131], a[172:175], a[20:23]
    buffer_load_dwordx4 a[216:219], v1, s[52:55], s64 offen offset:2048 sc1
    v_mfma_f32_16x16x32_bf16 a[52:55], v[128:131], a[176:179], a[52:55]
    v_mov_b32_dpp v197, v197 row_shr:1 row_mask:0xf bank_mask:0xf
    v_mfma_f32_16x16x32_bf16 a[52:55], v[112:115], a[180:183], a[52:55]
    v_mov_b32_dpp v198, v198 row_shr:1 row_mask:0xf bank_mask:0xf
    v_mfma_f32_16x16x32_bf16 a[52:55], v[180:183], a[184:187], a[52:55]
    v_mov_b32_dpp v199, v199 row_shr:1 row_mask:0xf bank_mask:0xf
    v_mfma_f32_16x16x32_bf16 a[52:55], v[200:203], a[188:191], a[52:55]
    v_cndmask_b32_dpp v196, v184, v196, vcc row_shl:4 row_mask:0xf bank_mask:0xf
    v_mfma_f32_16x16x32_bf16 a[52:55], v[92:95], a[160:163], a[52:55]
    buffer_load_dwordx4 v[72:75], v247, s[44:47], s66 offen offset:2048 sc1
    v_mfma_f32_16x16x32_bf16 a[52:55], v[88:91], a[164:167], a[52:55]
    v_cndmask_b32_dpp v197, v185, v197, vcc row_shl:4 row_mask:0xf bank_mask:0xf
    v_mfma_f32_16x16x32_bf16 a[52:55], v[224:227], a[168:171], a[52:55]
    s_waitcnt vmcnt(13)
    v_mfma_f32_16x16x32_bf16 a[52:55], v[132:135], a[172:175], a[52:55]
    v_cndmask_b32_dpp v198, v186, v198, vcc row_shl:4 row_mask:0xf bank_mask:0xf
    v_mfma_f32_16x16x32_bf16 a[84:87], v[132:135], a[176:179], a[84:87]
    v_cndmask_b32_dpp v199, v187, v199, vcc row_shl:4 row_mask:0xf bank_mask:0xf
    v_mfma_f32_16x16x32_bf16 a[84:87], v[224:227], a[180:183], a[84:87]
    buffer_load_dwordx4 a[220:223], v1, s[52:55], s64 offen offset:3072 sc1
    v_mfma_f32_16x16x32_bf16 a[84:87], v[88:91], a[184:187], a[84:87]
    v_mov_b32_dpp v80, v80 row_shr:1 row_mask:0xf bank_mask:0xf
    v_mfma_f32_16x16x32_bf16 a[84:87], v[92:95], a[188:191], a[84:87]
    v_mov_b32_dpp v81, v81 row_shr:1 row_mask:0xf bank_mask:0xf
    v_mfma_f32_16x16x32_bf16 a[16:19], v[180:183], a[160:163], a[16:19]
    v_mov_b32_dpp v82, v82 row_shr:1 row_mask:0xf bank_mask:0xf
    v_mfma_f32_16x16x32_bf16 a[16:19], v[112:115], a[164:167], a[16:19]
    v_mov_b32_dpp v83, v83 row_shr:1 row_mask:0xf bank_mask:0xf
    v_mfma_f32_16x16x32_bf16 a[16:19], v[128:131], a[168:171], a[16:19]
    buffer_load_dwordx4 v[136:139], v247, s[44:47], s66 offen offset:1024 sc1
    s_waitcnt vmcnt(14)
    v_mfma_f32_16x16x32_bf16 a[16:19], v[216:219], a[172:175], a[16:19]
    v_cndmask_b32_dpp v80, v188, v80, vcc row_shl:4 row_mask:0xf bank_mask:0xf
    v_mfma_f32_16x16x32_bf16 a[48:51], v[216:219], a[176:179], a[48:51]
    v_cndmask_b32_dpp v81, v189, v81, vcc row_shl:4 row_mask:0xf bank_mask:0xf
    v_mfma_f32_16x16x32_bf16 a[48:51], v[128:131], a[180:183], a[48:51]
    v_cndmask_b32_dpp v82, v190, v82, vcc row_shl:4 row_mask:0xf bank_mask:0xf
    v_mfma_f32_16x16x32_bf16 a[48:51], v[112:115], a[184:187], a[48:51]
    v_cndmask_b32_dpp v83, v191, v83, vcc row_shl:4 row_mask:0xf bank_mask:0xf
    v_mfma_f32_16x16x32_bf16 a[48:51], v[180:183], a[188:191], a[48:51]
    buffer_load_dwordx4 a[224:227], v1, s[52:55], s65 offen offset:0 sc1
    v_mfma_f32_16x16x32_bf16 a[48:51], v[88:91], a[160:163], a[48:51]
    v_mov_b32_dpp v200, v200 row_shr:1 row_mask:0xf bank_mask:0xf
    v_mfma_f32_16x16x32_bf16 a[48:51], v[224:227], a[164:167], a[48:51]
    v_mov_b32_dpp v201, v201 row_shr:1 row_mask:0xf bank_mask:0xf
    v_mfma_f32_16x16x32_bf16 a[48:51], v[132:135], a[168:171], a[48:51]
    s_waitcnt vmcnt(14)
    v_mfma_f32_16x16x32_bf16 a[48:51], v[76:79], a[172:175], a[48:51]
    v_mov_b32_dpp v202, v202 row_shr:1 row_mask:0xf bank_mask:0xf
    v_mfma_f32_16x16x32_bf16 a[80:83], v[76:79], a[176:179], a[80:83]
    buffer_load_dwordx4 v[172:175], v247, s[44:47], s66 offen offset:0 sc1
    v_mfma_f32_16x16x32_bf16 a[80:83], v[132:135], a[180:183], a[80:83]
    v_mov_b32_dpp v203, v203 row_shr:1 row_mask:0xf bank_mask:0xf
    v_mfma_f32_16x16x32_bf16 a[80:83], v[224:227], a[184:187], a[80:83]
    v_cndmask_b32_dpp v200, v184, v200, vcc row_shl:3 row_mask:0xf bank_mask:0xf
    v_mfma_f32_16x16x32_bf16 a[80:83], v[88:91], a[188:191], a[80:83]
    v_cndmask_b32_dpp v201, v185, v201, vcc row_shl:3 row_mask:0xf bank_mask:0xf
    v_mfma_f32_16x16x32_bf16 a[12:15], v[112:115], a[160:163], a[12:15]
    v_cndmask_b32_dpp v202, v186, v202, vcc row_shl:3 row_mask:0xf bank_mask:0xf
    v_mfma_f32_16x16x32_bf16 a[12:15], v[128:131], a[164:167], a[12:15]
    buffer_load_dwordx4 a[228:231], v1, s[52:55], s65 offen offset:1024 sc1
    v_mfma_f32_16x16x32_bf16 a[12:15], v[216:219], a[168:171], a[12:15]
    s_waitcnt vmcnt(15)
    v_mfma_f32_16x16x32_bf16 a[12:15], v[140:143], a[172:175], a[12:15]
    v_cndmask_b32_dpp v203, v187, v203, vcc row_shl:3 row_mask:0xf bank_mask:0xf
    v_mov_b32_dpp v92, v92 row_shr:1 row_mask:0xf bank_mask:0xf
    v_mfma_f32_16x16x32_bf16 a[44:47], v[140:143], a[176:179], a[44:47]
    v_mov_b32_dpp v93, v93 row_shr:1 row_mask:0xf bank_mask:0xf
    v_mov_b32_dpp v94, v94 row_shr:1 row_mask:0xf bank_mask:0xf
    v_mfma_f32_16x16x32_bf16 a[44:47], v[216:219], a[180:183], a[44:47]
    v_mov_b32_dpp v95, v95 row_shr:1 row_mask:0xf bank_mask:0xf
    v_cndmask_b32_dpp v92, v188, v92, vcc row_shl:3 row_mask:0xf bank_mask:0xf
    v_mfma_f32_16x16x32_bf16 a[44:47], v[128:131], a[184:187], a[44:47]
    buffer_load_dwordx4 v[176:179], v247, s[44:47], s65 offen offset:3072 sc1
    v_cndmask_b32_dpp v93, v189, v93, vcc row_shl:3 row_mask:0xf bank_mask:0xf
    v_mfma_f32_16x16x32_bf16 a[44:47], v[112:115], a[188:191], a[44:47]
    v_cndmask_b32_dpp v94, v190, v94, vcc row_shl:3 row_mask:0xf bank_mask:0xf
    v_cndmask_b32_dpp v95, v191, v95, vcc row_shl:3 row_mask:0xf bank_mask:0xf
    v_mfma_f32_16x16x32_bf16 a[44:47], v[224:227], a[160:163], a[44:47]
    v_mov_b32_dpp v180, v180 row_shr:1 row_mask:0xf bank_mask:0xf
    v_mov_b32_dpp v181, v181 row_shr:1 row_mask:0xf bank_mask:0xf
    v_mfma_f32_16x16x32_bf16 a[44:47], v[132:135], a[164:167], a[44:47]
    v_mov_b32_dpp v182, v182 row_shr:1 row_mask:0xf bank_mask:0xf
    v_mov_b32_dpp v183, v183 row_shr:1 row_mask:0xf bank_mask:0xf
    v_mfma_f32_16x16x32_bf16 a[44:47], v[76:79], a[168:171], a[44:47]
    v_cndmask_b32_dpp v180, v184, v180, vcc row_shl:2 row_mask:0xf bank_mask:0xf
    s_waitcnt vmcnt(15)
    v_mfma_f32_16x16x32_bf16 a[44:47], v[220:223], a[172:175], a[44:47]
    buffer_load_dwordx4 a[232:235], v1, s[52:55], s65 offen offset:2048 sc1
    v_cndmask_b32_dpp v181, v185, v181, vcc row_shl:2 row_mask:0xf bank_mask:0xf
    v_mfma_f32_16x16x32_bf16 a[76:79], v[220:223], a[176:179], a[76:79]
    v_cndmask_b32_dpp v182, v186, v182, vcc row_shl:2 row_mask:0xf bank_mask:0xf
    v_cndmask_b32_dpp v183, v187, v183, vcc row_shl:2 row_mask:0xf bank_mask:0xf
    v_mfma_f32_16x16x32_bf16 a[76:79], v[76:79], a[180:183], a[76:79]
    v_mov_b32_dpp v88, v88 row_shr:1 row_mask:0xf bank_mask:0xf
    v_mov_b32_dpp v89, v89 row_shr:1 row_mask:0xf bank_mask:0xf
    v_mfma_f32_16x16x32_bf16 a[76:79], v[132:135], a[184:187], a[76:79]
    v_mov_b32_dpp v90, v90 row_shr:1 row_mask:0xf bank_mask:0xf
    v_mov_b32_dpp v91, v91 row_shr:1 row_mask:0xf bank_mask:0xf
    v_mfma_f32_16x16x32_bf16 a[76:79], v[224:227], a[188:191], a[76:79]
    v_cndmask_b32_dpp v88, v188, v88, vcc row_shl:2 row_mask:0xf bank_mask:0xf
    v_cndmask_b32_dpp v89, v189, v89, vcc row_shl:2 row_mask:0xf bank_mask:0xf
    v_mfma_f32_16x16x32_bf16 a[8:11], v[128:131], a[160:163], a[8:11]
    buffer_load_dwordx4 a[236:239], v251, s[60:63], s66 offen offset:3072 sc1
    v_cndmask_b32_dpp v90, v190, v90, vcc row_shl:2 row_mask:0xf bank_mask:0xf
    v_mfma_f32_16x16x32_bf16 a[8:11], v[216:219], a[164:167], a[8:11]
    v_cndmask_b32_dpp v91, v191, v91, vcc row_shl:2 row_mask:0xf bank_mask:0xf
    v_mfma_f32_16x16x32_bf16 a[8:11], v[140:143], a[168:171], a[8:11]
    v_mfma_f32_16x16x32_bf16 a[8:11], v[192:195], a[172:175], a[8:11]
    v_mfma_f32_16x16x32_bf16 a[40:43], v[192:195], a[176:179], a[40:43]
    v_mfma_f32_16x16x32_bf16 a[40:43], v[140:143], a[180:183], a[40:43]
    buffer_load_dwordx4 v[104:107], v247, s[44:47], s65 offen offset:2048 sc1
    v_mfma_f32_16x16x32_bf16 a[40:43], v[216:219], a[184:187], a[40:43]
    v_mfma_f32_16x16x32_bf16 a[40:43], v[128:131], a[188:191], a[40:43]
    v_mfma_f32_16x16x32_bf16 a[40:43], v[132:135], a[160:163], a[40:43]
    v_mfma_f32_16x16x32_bf16 a[40:43], v[76:79], a[164:167], a[40:43]
    v_mfma_f32_16x16x32_bf16 a[40:43], v[220:223], a[168:171], a[40:43]
    buffer_load_dwordx4 a[240:243], v1, s[52:55], s65 offen offset:3072 sc1
    v_mfma_f32_16x16x32_bf16 a[40:43], v[204:207], a[172:175], a[40:43]
    v_mfma_f32_16x16x32_bf16 a[72:75], v[204:207], a[176:179], a[72:75]
    v_mfma_f32_16x16x32_bf16 a[72:75], v[220:223], a[180:183], a[72:75]
    v_mfma_f32_16x16x32_bf16 a[72:75], v[76:79], a[184:187], a[72:75]
    v_mfma_f32_16x16x32_bf16 a[72:75], v[132:135], a[188:191], a[72:75]
    buffer_load_dwordx4 a[244:247], v251, s[60:63], s68 offen offset:3072 sc1
    v_mfma_f32_16x16x32_bf16 a[4:7], v[216:219], a[160:163], a[4:7]
    v_mfma_f32_16x16x32_bf16 a[4:7], v[140:143], a[164:167], a[4:7]
    v_mfma_f32_16x16x32_bf16 a[4:7], v[192:195], a[168:171], a[4:7]
    v_mfma_f32_16x16x32_bf16 a[4:7], v[196:199], a[172:175], a[4:7]
    v_mfma_f32_16x16x32_bf16 a[36:39], v[196:199], a[176:179], a[36:39]
    buffer_load_dwordx4 v[96:99], v247, s[44:47], s65 offen offset:1024 sc1
    v_mfma_f32_16x16x32_bf16 a[36:39], v[192:195], a[180:183], a[36:39]
    v_mfma_f32_16x16x32_bf16 a[36:39], v[140:143], a[184:187], a[36:39]
    v_mfma_f32_16x16x32_bf16 a[36:39], v[216:219], a[188:191], a[36:39]
    v_mfma_f32_16x16x32_bf16 a[36:39], v[76:79], a[160:163], a[36:39]
    v_mfma_f32_16x16x32_bf16 a[36:39], v[220:223], a[164:167], a[36:39]
    buffer_load_dwordx4 a[248:251], v1, s[52:55], s66 offen offset:0 sc1
    v_mfma_f32_16x16x32_bf16 a[36:39], v[204:207], a[168:171], a[36:39]
    v_mfma_f32_16x16x32_bf16 a[36:39], v[80:83], a[172:175], a[36:39]
K2_t1:
    v_mfma_f32_16x16x32_bf16 a[68:71], v[80:83], a[176:179], a[68:71]
    v_mfma_f32_16x16x32_bf16 a[68:71], v[204:207], a[180:183], a[68:71]
    v_mfma_f32_16x16x32_bf16 a[68:71], v[220:223], a[184:187], a[68:71]
    buffer_load_dwordx4 v[116:119], v247, s[44:47], s67 offen offset:1024 sc1
    v_mfma_f32_16x16x32_bf16 a[68:71], v[76:79], a[188:191], a[68:71]
    v_mfma_f32_16x16x32_bf16 a[0:3], v[140:143], a[160:163], a[0:3]
    v_mfma_f32_16x16x32_bf16 a[0:3], v[192:195], a[164:167], a[0:3]
    v_mfma_f32_16x16x32_bf16 a[0:3], v[196:199], a[168:171], a[0:3]
    v_mfma_f32_16x16x32_bf16 a[0:3], v[200:203], a[172:175], a[0:3]
    buffer_load_dwordx4 a[252:255], v1, s[52:55], s67 offen offset:3072 sc1
    v_mfma_f32_16x16x32_bf16 a[32:35], v[200:203], a[176:179], a[32:35]
    v_mfma_f32_16x16x32_bf16 a[32:35], v[196:199], a[180:183], a[32:35]
    v_mfma_f32_16x16x32_bf16 a[32:35], v[192:195], a[184:187], a[32:35]
    v_mfma_f32_16x16x32_bf16 a[32:35], v[140:143], a[188:191], a[32:35]
    v_mfma_f32_16x16x32_bf16 a[32:35], v[220:223], a[160:163], a[32:35]
    buffer_load_dwordx4 v[124:127], v247, s[44:47], s67 offen offset:2048 sc1
    v_mfma_f32_16x16x32_bf16 a[32:35], v[204:207], a[164:167], a[32:35]
    v_mfma_f32_16x16x32_bf16 a[32:35], v[80:83], a[168:171], a[32:35]
    v_mfma_f32_16x16x32_bf16 a[32:35], v[92:95], a[172:175], a[32:35]
    v_mfma_f32_16x16x32_bf16 a[64:67], v[92:95], a[176:179], a[64:67]
    v_mfma_f32_16x16x32_bf16 a[64:67], v[80:83], a[180:183], a[64:67]
    buffer_load_dwordx4 a[100:103], v1, s[52:55], s67 offen offset:2048 sc1
    v_mfma_f32_16x16x32_bf16 a[64:67], v[204:207], a[184:187], a[64:67]
    v_mfma_f32_16x16x32_bf16 a[64:67], v[220:223], a[188:191], a[64:67]
    s_waitcnt vmcnt(18)
    v_mfma_f32_16x16x32_bf16 a[28:31], v[112:115], a[192:195], a[28:31]
    v_mfma_f32_16x16x32_bf16 a[28:31], v[128:131], a[196:199], a[28:31]
    v_mfma_f32_16x16x32_bf16 a[28:31], v[216:219], a[200:203], a[28:31]
    buffer_load_dwordx4 v[108:111], v247, s[44:47], s67 offen offset:3072 sc1
    v_mfma_f32_16x16x32_bf16 a[60:63], v[216:219], a[204:207], a[60:63]
    v_mfma_f32_16x16x32_bf16 a[60:63], v[128:131], a[208:211], a[60:63]
    v_mfma_f32_16x16x32_bf16 a[60:63], v[112:115], a[212:215], a[60:63]
    v_mov_b32_dpp v112, v112 row_shr:1 row_mask:0xf bank_mask:0xf
    v_mov_b32_dpp v113, v113 row_shr:1 row_mask:0xf bank_mask:0xf
    v_mfma_f32_16x16x32_bf16 a[60:63], v[224:227], a[192:195], a[60:63]
    v_mov_b32_dpp v114, v114 row_shr:1 row_mask:0xf bank_mask:0xf
    v_mov_b32_dpp v115, v115 row_shr:1 row_mask:0xf bank_mask:0xf
    v_mfma_f32_16x16x32_bf16 a[60:63], v[132:135], a[196:199], a[60:63]
    buffer_load_dwordx4 a[96:99], v1, s[52:55], s67 offen offset:1024 sc1
    v_cndmask_b32_dpp v112, v184, v112, vcc row_shl:1 row_mask:0xf bank_mask:0xf
    v_mfma_f32_16x16x32_bf16 a[60:63], v[76:79], a[200:203], a[60:63]
    v_cndmask_b32_dpp v113, v185, v113, vcc row_shl:1 row_mask:0xf bank_mask:0xf
    v_cndmask_b32_dpp v114, v186, v114, vcc row_shl:1 row_mask:0xf bank_mask:0xf
    v_mfma_f32_16x16x32_bf16 a[92:95], v[76:79], a[204:207], a[92:95]
    v_cndmask_b32_dpp v115, v187, v115, vcc row_shl:1 row_mask:0xf bank_mask:0xf
    v_mfma_f32_16x16x32_bf16 a[92:95], v[132:135], a[208:211], a[92:95]
    v_mfma_f32_16x16x32_bf16 a[92:95], v[224:227], a[212:215], a[92:95]
    v_mov_b32_dpp v224, v224 row_shr:1 row_mask:0xf bank_mask:0xf
    v_mov_b32_dpp v225, v225 row_shr:1 row_mask:0xf bank_mask:0xf
    v_mfma_f32_16x16x32_bf16 a[24:27], v[128:131], a[192:195], a[24:27]
    buffer_load_dwordx4 v[120:123], v247, s[44:47], s68 offen offset:0 sc1
    v_mov_b32_dpp v226, v226 row_shr:1 row_mask:0xf bank_mask:0xf
    v_mfma_f32_16x16x32_bf16 a[24:27], v[216:219], a[196:199], a[24:27]
    v_mov_b32_dpp v227, v227 row_shr:1 row_mask:0xf bank_mask:0xf
    v_cndmask_b32_dpp v224, v188, v224, vcc row_shl:1 row_mask:0xf bank_mask:0xf
    v_mfma_f32_16x16x32_bf16 a[24:27], v[140:143], a[200:203], a[24:27]
    v_cndmask_b32_dpp v225, v189, v225, vcc row_shl:1 row_mask:0xf bank_mask:0xf
    v_cndmask_b32_dpp v226, v190, v226, vcc row_shl:1 row_mask:0xf bank_mask:0xf
    v_mfma_f32_16x16x32_bf16 a[56:59], v[140:143], a[204:207], a[56:59]
    v_cndmask_b32_dpp v227, v191, v227, vcc row_shl:1 row_mask:0xf bank_mask:0xf
    v_mfma_f32_16x16x32_bf16 a[56:59], v[216:219], a[208:211], a[56:59]
    v_accvgpr_read_b32 v228, a28
    v_accvgpr_read_b32 v229, a60
    v_mfma_f32_16x16x32_bf16 a[56:59], v[128:131], a[212:215], a[56:59]
    buffer_load_dwordx4 a[108:111], v1, s[52:55], s67 offen offset:0 sc1
    v_mov_b32_dpp v128, v128 row_shr:1 row_mask:0xf bank_mask:0xf
    v_mfma_f32_16x16x32_bf16 a[56:59], v[132:135], a[192:195], a[56:59]
    v_mov_b32_dpp v129, v129 row_shr:1 row_mask:0xf bank_mask:0xf
    v_mov_b32_dpp v130, v130 row_shr:1 row_mask:0xf bank_mask:0xf
    v_mfma_f32_16x16x32_bf16 a[56:59], v[76:79], a[196:199], a[56:59]
    v_mov_b32_dpp v131, v131 row_shr:1 row_mask:0xf bank_mask:0xf
    v_cndmask_b32 v128, v184, v128, vcc
    v_mfma_f32_16x16x32_bf16 a[56:59], v[220:223], a[200:203], a[56:59]
    v_cndmask_b32 v129, v185, v129, vcc
    v_cndmask_b32 v130, v186, v130, vcc
    v_mfma_f32_16x16x32_bf16 a[88:91], v[220:223], a[204:207], a[88:91]
    v_cndmask_b32 v131, v187, v131, vcc
    v_accvgpr_read_b32 v230, a92
    v_mfma_f32_16x16x32_bf16 a[88:91], v[76:79], a[208:211], a[88:91]
    buffer_load_dwordx4 v[100:103], v247, s[44:47], s68 offen offset:1024 sc1
    v_accvgpr_read_b32 v232, a29
    v_mfma_f32_16x16x32_bf16 a[88:91], v[132:135], a[212:215], a[88:91]
    v_mov_b32_dpp v132, v132 row_shr:1 row_mask:0xf bank_mask:0xf
    v_mov_b32_dpp v133, v133 row_shr:1 row_mask:0xf bank_mask:0xf
    v_mfma_f32_16x16x32_bf16 a[20:23], v[216:219], a[192:195], a[20:23]
    v_mov_b32_dpp v134, v134 row_shr:1 row_mask:0xf bank_mask:0xf
    v_mov_b32_dpp v135, v135 row_shr:1 row_mask:0xf bank_mask:0xf
    v_mfma_f32_16x16x32_bf16 a[20:23], v[140:143], a[196:199], a[20:23]
    v_cndmask_b32 v132, v188, v132, vcc
    v_cndmask_b32 v133, v189, v133, vcc
    v_mfma_f32_16x16x32_bf16 a[20:23], v[192:195], a[200:203], a[20:23]
    v_cndmask_b32 v134, v190, v134, vcc
    v_cndmask_b32 v135, v191, v135, vcc
    v_mfma_f32_16x16x32_bf16 a[52:55], v[192:195], a[204:207], a[52:55]
    buffer_load_dwordx4 a[104:107], v1, s[52:55], s66 offen offset:3072 sc1
    v_accvgpr_read_b32 v233, a61
    v_mfma_f32_16x16x32_bf16 a[52:55], v[140:143], a[208:211], a[52:55]
    v_accvgpr_read_b32 v234, a93
    v_cvt_pk_bf16_f32 v228, v228, v229
    v_mfma_f32_16x16x32_bf16 a[52:55], v[216:219], a[212:215], a[52:55]
    v_cvt_pk_bf16_f32 v229, v230, 0
    v_accvgpr_read_b32 v236, a30
    v_mfma_f32_16x16x32_bf16 a[52:55], v[76:79], a[192:195], a[52:55]
    v_accvgpr_read_b32 v237, a62
    v_accvgpr_read_b32 v238, a94
    v_mfma_f32_16x16x32_bf16 a[52:55], v[220:223], a[196:199], a[52:55]
    ds_write_b64 v244, v[228:229] offset:28672
    v_cvt_pk_bf16_f32 v232, v232, v233
    v_mfma_f32_16x16x32_bf16 a[52:55], v[204:207], a[200:203], a[52:55]
    buffer_load_dwordx4 v[208:211], v247, s[44:47], s68 offen offset:2048 sc1
    v_cvt_pk_bf16_f32 v233, v234, 0
    v_mfma_f32_16x16x32_bf16 a[84:87], v[204:207], a[204:207], a[84:87]
    v_accvgpr_read_b32 v240, a31
    v_accvgpr_read_b32 v241, a63
    v_mfma_f32_16x16x32_bf16 a[84:87], v[220:223], a[208:211], a[84:87]
    v_accvgpr_read_b32 v242, a95
    ds_write_b64 v244, v[232:233] offset:28928
    v_mfma_f32_16x16x32_bf16 a[84:87], v[76:79], a[212:215], a[84:87]
    v_cvt_pk_bf16_f32 v236, v236, v237
    v_cvt_pk_bf16_f32 v237, v238, 0
    v_mfma_f32_16x16x32_bf16 a[16:19], v[140:143], a[192:195], a[16:19]
    v_cvt_pk_bf16_f32 v240, v240, v241
    v_cvt_pk_bf16_f32 v241, v242, 0
    v_mfma_f32_16x16x32_bf16 a[16:19], v[192:195], a[196:199], a[16:19]
    buffer_load_dwordx4 a[116:119], v1, s[52:55], s66 offen offset:2048 sc1
    ds_write_b64 v244, v[236:237] offset:29184
    v_mfma_f32_16x16x32_bf16 a[16:19], v[196:199], a[200:203], a[16:19]
    ds_write_b64 v244, v[240:241] offset:29440
    v_accvgpr_read_b32 v228, a24
    v_mfma_f32_16x16x32_bf16 a[48:51], v[196:199], a[204:207], a[48:51]
    v_accvgpr_read_b32 v229, a56
    v_accvgpr_read_b32 v230, a88
    v_mfma_f32_16x16x32_bf16 a[48:51], v[192:195], a[208:211], a[48:51]
    v_accvgpr_read_b32 v232, a25
    v_accvgpr_read_b32 v233, a57
    v_mfma_f32_16x16x32_bf16 a[48:51], v[140:143], a[212:215], a[48:51]
    v_accvgpr_read_b32 v234, a89
    v_cvt_pk_bf16_f32 v228, v228, v229
    v_mfma_f32_16x16x32_bf16 a[48:51], v[220:223], a[192:195], a[48:51]
    buffer_load_dwordx4 v[212:215], v247, s[44:47], s68 offen offset:3072 sc1
    v_cvt_pk_bf16_f32 v229, v230, 0
    v_mfma_f32_16x16x32_bf16 a[48:51], v[204:207], a[196:199], a[48:51]
    v_accvgpr_read_b32 v236, a26
    v_accvgpr_read_b32 v237, a58
    v_mfma_f32_16x16x32_bf16 a[48:51], v[80:83], a[200:203], a[48:51]
    v_accvgpr_read_b32 v238, a90
    ds_write_b64 v244, v[228:229] offset:24576
    v_mfma_f32_16x16x32_bf16 a[80:83], v[80:83], a[204:207], a[80:83]
    v_cvt_pk_bf16_f32 v232, v232, v233
    v_cvt_pk_bf16_f32 v233, v234, 0
    v_mfma_f32_16x16x32_bf16 a[80:83], v[204:207], a[208:211], a[80:83]
    v_accvgpr_read_b32 v240, a27
    v_accvgpr_read_b32 v241, a59
    v_mfma_f32_16x16x32_bf16 a[80:83], v[220:223], a[212:215], a[80:83]
    buffer_load_dwordx4 a[112:115], v1, s[52:55], s66 offen offset:1024 sc1
    v_accvgpr_read_b32 v242, a91
    v_mfma_f32_16x16x32_bf16 a[12:15], v[192:195], a[192:195], a[12:15]
    ds_write_b64 v244, v[232:233] offset:24832
    v_cvt_pk_bf16_f32 v236, v236, v237
    v_mfma_f32_16x16x32_bf16 a[12:15], v[196:199], a[196:199], a[12:15]
    v_cvt_pk_bf16_f32 v237, v238, 0
    v_cvt_pk_bf16_f32 v240, v240, v241
    v_mfma_f32_16x16x32_bf16 a[12:15], v[200:203], a[200:203], a[12:15]
    v_cvt_pk_bf16_f32 v241, v242, 0
    ds_write_b64 v244, v[236:237] offset:25088
    v_mfma_f32_16x16x32_bf16 a[44:47], v[200:203], a[204:207], a[44:47]
    ds_write_b64 v244, v[240:241] offset:25344
    v_accvgpr_read_b32 v228, a20
    v_mfma_f32_16x16x32_bf16 a[44:47], v[196:199], a[208:211], a[44:47]
    buffer_load_dwordx4 a[124:127], v251, s[60:63], s66 offen offset:2048 sc1
    v_accvgpr_read_b32 v229, a52
    v_mfma_f32_16x16x32_bf16 a[44:47], v[192:195], a[212:215], a[44:47]
    v_accvgpr_read_b32 v230, a84
    v_accvgpr_read_b32 v232, a21
    v_mfma_f32_16x16x32_bf16 a[44:47], v[204:207], a[192:195], a[44:47]
    v_accvgpr_read_b32 v233, a53
    v_accvgpr_read_b32 v234, a85
    v_mfma_f32_16x16x32_bf16 a[44:47], v[80:83], a[196:199], a[44:47]
    v_cvt_pk_bf16_f32 v228, v228, v229
    v_cvt_pk_bf16_f32 v229, v230, 0
    v_mfma_f32_16x16x32_bf16 a[44:47], v[92:95], a[200:203], a[44:47]
    v_accvgpr_read_b32 v236, a22
    v_accvgpr_read_b32 v237, a54
    v_mfma_f32_16x16x32_bf16 a[76:79], v[92:95], a[204:207], a[76:79]
    buffer_load_dwordx4 a[120:123], v251, s[60:63], s68 offen offset:2048 sc1
    v_accvgpr_read_b32 v238, a86
    v_mfma_f32_16x16x32_bf16 a[76:79], v[80:83], a[208:211], a[76:79]
    ds_write_b64 v244, v[228:229] offset:20480
    v_cvt_pk_bf16_f32 v232, v232, v233
    v_mfma_f32_16x16x32_bf16 a[76:79], v[204:207], a[212:215], a[76:79]
    v_cvt_pk_bf16_f32 v233, v234, 0
    v_accvgpr_read_b32 v240, a23
    v_mfma_f32_16x16x32_bf16 a[8:11], v[196:199], a[192:195], a[8:11]
    v_accvgpr_read_b32 v241, a55
    v_accvgpr_read_b32 v242, a87
    v_mfma_f32_16x16x32_bf16 a[8:11], v[200:203], a[196:199], a[8:11]
    ds_write_b64 v244, v[232:233] offset:20736
    v_cvt_pk_bf16_f32 v236, v236, v237
    v_mfma_f32_16x16x32_bf16 a[8:11], v[180:183], a[200:203], a[8:11]
    buffer_load_dwordx4 v[152:155], v247, s[44:47], s65 offen offset:0 sc1
    v_cvt_pk_bf16_f32 v237, v238, 0
    v_mfma_f32_16x16x32_bf16 a[40:43], v[180:183], a[204:207], a[40:43]
    v_cvt_pk_bf16_f32 v240, v240, v241
    v_cvt_pk_bf16_f32 v241, v242, 0
    v_mfma_f32_16x16x32_bf16 a[40:43], v[200:203], a[208:211], a[40:43]
    ds_write_b64 v244, v[236:237] offset:20992
    ds_write_b64 v244, v[240:241] offset:21248
    v_mfma_f32_16x16x32_bf16 a[40:43], v[196:199], a[212:215], a[40:43]
    v_accvgpr_read_b32 v228, a16
    v_accvgpr_read_b32 v229, a48
    v_mfma_f32_16x16x32_bf16 a[40:43], v[80:83], a[192:195], a[40:43]
    v_accvgpr_read_b32 v230, a80
    v_accvgpr_read_b32 v232, a17
    v_mfma_f32_16x16x32_bf16 a[40:43], v[92:95], a[196:199], a[40:43]
    buffer_load_dwordx4 v[156:159], v247, s[44:47], s67 offen offset:0 sc1
    v_accvgpr_read_b32 v233, a49
    v_mfma_f32_16x16x32_bf16 a[40:43], v[88:91], a[200:203], a[40:43]
    v_accvgpr_read_b32 v234, a81
    v_cvt_pk_bf16_f32 v228, v228, v229
    v_mfma_f32_16x16x32_bf16 a[72:75], v[88:91], a[204:207], a[72:75]
    v_cvt_pk_bf16_f32 v229, v230, 0
    v_accvgpr_read_b32 v236, a18
    v_mfma_f32_16x16x32_bf16 a[72:75], v[92:95], a[208:211], a[72:75]
    v_accvgpr_read_b32 v237, a50
    v_accvgpr_read_b32 v238, a82
    v_mfma_f32_16x16x32_bf16 a[72:75], v[80:83], a[212:215], a[72:75]
    ds_write_b64 v244, v[228:229] offset:16384
    v_cvt_pk_bf16_f32 v232, v232, v233
    v_mfma_f32_16x16x32_bf16 a[4:7], v[200:203], a[192:195], a[4:7]
    buffer_load_dwordx4 a[128:131], v251, s[60:63], s66 offen offset:1024 sc1
    v_cvt_pk_bf16_f32 v233, v234, 0
    v_mfma_f32_16x16x32_bf16 a[4:7], v[180:183], a[196:199], a[4:7]
    v_accvgpr_read_b32 v240, a19
    v_accvgpr_read_b32 v241, a51
    v_mfma_f32_16x16x32_bf16 a[4:7], v[112:115], a[200:203], a[4:7]
    v_accvgpr_read_b32 v242, a83
    ds_write_b64 v244, v[232:233] offset:16640
    v_mfma_f32_16x16x32_bf16 a[36:39], v[112:115], a[204:207], a[36:39]
    v_cvt_pk_bf16_f32 v236, v236, v237
    v_cvt_pk_bf16_f32 v237, v238, 0
    v_mfma_f32_16x16x32_bf16 a[36:39], v[180:183], a[208:211], a[36:39]
    v_cvt_pk_bf16_f32 v240, v240, v241
    v_cvt_pk_bf16_f32 v241, v242, 0
    v_mfma_f32_16x16x32_bf16 a[36:39], v[200:203], a[212:215], a[36:39]
    buffer_load_dwordx4 a[132:135], v251, s[60:63], s68 offen offset:1024 sc1
    ds_write_b64 v244, v[236:237] offset:16896
    v_mfma_f32_16x16x32_bf16 a[36:39], v[92:95], a[192:195], a[36:39]
    ds_write_b64 v244, v[240:241] offset:17152
    v_accvgpr_read_b32 v228, a12
    v_mfma_f32_16x16x32_bf16 a[36:39], v[88:91], a[196:199], a[36:39]
    v_accvgpr_read_b32 v229, a44
    v_accvgpr_read_b32 v230, a76
    v_mfma_f32_16x16x32_bf16 a[36:39], v[224:227], a[200:203], a[36:39]
    v_accvgpr_read_b32 v232, a13
    v_accvgpr_read_b32 v233, a45
    v_mfma_f32_16x16x32_bf16 a[68:71], v[224:227], a[204:207], a[68:71]
    v_accvgpr_read_b32 v234, a77
    v_cvt_pk_bf16_f32 v228, v228, v229
    v_mfma_f32_16x16x32_bf16 a[68:71], v[88:91], a[208:211], a[68:71]
    buffer_load_dwordx4 a[136:139], v251, s[60:63], s66 offen offset:0 sc1
    v_cvt_pk_bf16_f32 v229, v230, 0
    v_mfma_f32_16x16x32_bf16 a[68:71], v[92:95], a[212:215], a[68:71]
    v_accvgpr_read_b32 v236, a14
    v_accvgpr_read_b32 v237, a46
    v_mfma_f32_16x16x32_bf16 a[0:3], v[180:183], a[192:195], a[0:3]
    v_accvgpr_read_b32 v238, a78
    ds_write_b64 v244, v[228:229] offset:12288
    v_mfma_f32_16x16x32_bf16 a[0:3], v[112:115], a[196:199], a[0:3]
    v_cvt_pk_bf16_f32 v232, v232, v233
    v_cvt_pk_bf16_f32 v233, v234, 0
    v_mfma_f32_16x16x32_bf16 a[0:3], v[128:131], a[200:203], a[0:3]
    v_accvgpr_read_b32 v240, a15
    v_accvgpr_read_b32 v241, a47
    v_mfma_f32_16x16x32_bf16 a[32:35], v[128:131], a[204:207], a[32:35]
    buffer_load_dwordx4 a[140:143], v251, s[60:63], s68 offen offset:0 sc1
    v_accvgpr_read_b32 v242, a79
    v_mfma_f32_16x16x32_bf16 a[32:35], v[112:115], a[208:211], a[32:35]
    ds_write_b64 v244, v[232:233] offset:12544
    v_cvt_pk_bf16_f32 v236, v236, v237
    v_mfma_f32_16x16x32_bf16 a[32:35], v[180:183], a[212:215], a[32:35]
    v_cvt_pk_bf16_f32 v237, v238, 0
    v_cvt_pk_bf16_f32 v240, v240, v241
    v_mfma_f32_16x16x32_bf16 a[32:35], v[88:91], a[192:195], a[32:35]
    v_cvt_pk_bf16_f32 v241, v242, 0
    ds_write_b64 v244, v[236:237] offset:12800
    v_mfma_f32_16x16x32_bf16 a[32:35], v[224:227], a[196:199], a[32:35]
    ds_write_b64 v244, v[240:241] offset:13056
    v_accvgpr_read_b32 v228, a8
    v_mfma_f32_16x16x32_bf16 a[32:35], v[132:135], a[200:203], a[32:35]
    buffer_load_dwordx4 a[144:147], v251, s[60:63], s65 offen offset:3072 sc1
    v_accvgpr_read_b32 v229, a40
    v_mfma_f32_16x16x32_bf16 a[64:67], v[132:135], a[204:207], a[64:67]
    v_accvgpr_read_b32 v230, a72
    v_accvgpr_read_b32 v232, a9
    v_mfma_f32_16x16x32_bf16 a[64:67], v[224:227], a[208:211], a[64:67]
    v_accvgpr_read_b32 v233, a41
    v_accvgpr_read_b32 v234, a73
    v_mfma_f32_16x16x32_bf16 a[64:67], v[88:91], a[212:215], a[64:67]
    v_cvt_pk_bf16_f32 v228, v228, v229
    v_cvt_pk_bf16_f32 v229, v230, 0
    v_accvgpr_read_b32 v236, a10
    v_mfma_f32_16x16x32_bf16 v[36:39], v[84:87], a[216:219], v[36:39]
    v_accvgpr_read_b32 v237, a42
    v_accvgpr_read_b32 v238, a74
    s_waitcnt vmcnt(18)
    v_mfma_f32_16x16x32_bf16 v[36:39], v[72:75], a[220:223], v[36:39]
    buffer_load_dwordx4 a[148:151], v251, s[60:63], s67 offen offset:3072 sc1
    ds_write_b64 v244, v[228:229] offset:8192
    v_cvt_pk_bf16_f32 v232, v232, v233
    v_mfma_f32_16x16x32_bf16 v[36:39], v[136:139], a[224:227], v[36:39]
    v_cvt_pk_bf16_f32 v233, v234, 0
    v_accvgpr_read_b32 v240, a11
    v_accvgpr_read_b32 v241, a43
    v_mfma_f32_16x16x32_bf16 v[36:39], v[172:175], a[228:231], v[36:39]
    v_accvgpr_read_b32 v242, a75
    ds_write_b64 v244, v[232:233] offset:8448
    v_cvt_pk_bf16_f32 v236, v236, v237
    v_mfma_f32_16x16x32_bf16 v[36:39], v[176:179], a[232:235], v[36:39]
    v_cvt_pk_bf16_f32 v237, v238, 0
    v_cvt_pk_bf16_f32 v240, v240, v241
    v_cvt_pk_bf16_f32 v241, v242, 0
    v_mfma_f32_16x16x32_bf16 v[36:39], v[104:107], a[240:243], v[36:39]
    ds_write_b64 v244, v[236:237] offset:8704
    ds_write_b64 v244, v[240:241] offset:8960
    v_accvgpr_read_b32 v228, a4
    v_mfma_f32_16x16x32_bf16 v[36:39], v[96:99], a[248:251], v[36:39]
    buffer_load_dwordx4 a[152:155], v251, s[60:63], s65 offen offset:2048 sc1
    v_accvgpr_read_b32 v229, a36
    v_accvgpr_read_b32 v230, a68
    v_mfma_f32_16x16x32_bf16 v[68:71], v[116:119], a[252:255], v[68:71]
    v_accvgpr_read_b32 v232, a5
    v_accvgpr_read_b32 v233, a37
    v_accvgpr_read_b32 v234, a69
    v_mfma_f32_16x16x32_bf16 v[68:71], v[124:127], a[100:103], v[68:71]
    v_cvt_pk_bf16_f32 v228, v228, v229
    v_cvt_pk_bf16_f32 v229, v230, 0
    s_waitcnt vmcnt(18)
    v_mfma_f32_16x16x32_bf16 v[68:71], v[108:111], a[96:99], v[68:71]
    v_accvgpr_read_b32 v236, a6
    v_accvgpr_read_b32 v237, a38
    s_waitcnt vmcnt(17)
    v_mfma_f32_16x16x32_bf16 v[68:71], v[120:123], a[108:111], v[68:71]
    v_accvgpr_read_b32 v238, a70
    ds_write_b64 v244, v[228:229] offset:4096
    s_waitcnt vmcnt(15)
    v_mfma_f32_16x16x32_bf16 v[68:71], v[100:103], a[104:107], v[68:71]
    buffer_load_dwordx4 a[156:159], v251, s[60:63], s67 offen offset:2048 sc1
    v_cvt_pk_bf16_f32 v232, v232, v233
    s_waitcnt vmcnt(14)
    v_mfma_f32_16x16x32_bf16 v[68:71], v[208:211], a[116:119], v[68:71]
    v_cvt_pk_bf16_f32 v233, v234, 0
    v_accvgpr_read_b32 v240, a7
    s_waitcnt vmcnt(12)
    v_mfma_f32_16x16x32_bf16 v[68:71], v[212:215], a[112:115], v[68:71]
    v_accvgpr_read_b32 v241, a39
    v_accvgpr_read_b32 v242, a71
    ds_write_b64 v244, v[232:233] offset:4352
    v_mfma_f32_16x16x32_bf16 v[32:35], v[72:75], a[216:219], v[32:35]
    v_cvt_pk_bf16_f32 v236, v236, v237
    v_cvt_pk_bf16_f32 v237, v238, 0
    v_cvt_pk_bf16_f32 v240, v240, v241
    v_mfma_f32_16x16x32_bf16 v[32:35], v[136:139], a[220:223], v[32:35]
    v_cvt_pk_bf16_f32 v241, v242, 0
    ds_write_b64 v244, v[236:237] offset:4608
    ds_write_b64 v244, v[240:241] offset:4864
    v_mfma_f32_16x16x32_bf16 v[32:35], v[172:175], a[224:227], v[32:35]
    v_cvt_pk_bf16_f32 v76, v36, v68
    v_cvt_pk_bf16_f32 v77, v37, v69
    v_cvt_pk_bf16_f32 v78, v38, v70
    v_mfma_f32_16x16x32_bf16 v[32:35], v[176:179], a[228:231], v[32:35]
    v_cvt_pk_bf16_f32 v79, v39, v71
    ds_write_b32 v245, v76 offset:28672
    ds_write_b32 v245, v77 offset:28928
    v_mfma_f32_16x16x32_bf16 v[32:35], v[104:107], a[232:235], v[32:35]
    ds_write_b32 v245, v78 offset:29184
    ds_write_b32 v245, v79 offset:29440
    v_accvgpr_read_b32 v228, a0
    v_mfma_f32_16x16x32_bf16 v[32:35], v[96:99], a[240:243], v[32:35]
    v_accvgpr_read_b32 v229, a32
    v_accvgpr_read_b32 v230, a64
    s_waitcnt vmcnt(9)
    v_mfma_f32_16x16x32_bf16 v[32:35], v[152:155], a[248:251], v[32:35]
    v_accvgpr_read_b32 v232, a1
    v_accvgpr_read_b32 v233, a33
    s_waitcnt vmcnt(8)
    v_mfma_f32_16x16x32_bf16 v[64:67], v[156:159], a[252:255], v[64:67]
    v_accvgpr_read_b32 v234, a65
    v_cvt_pk_bf16_f32 v228, v228, v229
    v_cvt_pk_bf16_f32 v229, v230, 0
    v_mfma_f32_16x16x32_bf16 v[64:67], v[116:119], a[100:103], v[64:67]
    s_waitcnt lgkmcnt(0)
    s_barrier
    ds_read_b128 v[84:87], v246 offset:28672
    ds_read_b128 v[88:91], v246 offset:28928
    v_mfma_f32_16x16x32_bf16 v[64:67], v[124:127], a[96:99], v[64:67]
    ds_read_b128 v[92:95], v246 offset:29184
    ds_read_b128 v[112:115], v246 offset:29440
    v_accvgpr_read_b32 v236, a2
    v_mfma_f32_16x16x32_bf16 v[64:67], v[108:111], a[108:111], v[64:67]
    v_accvgpr_read_b32 v237, a34
    v_accvgpr_read_b32 v238, a66
    ds_write_b64 v244, v[228:229] offset:0
    v_mfma_f32_16x16x32_bf16 v[64:67], v[120:123], a[104:107], v[64:67]
    v_cvt_pk_bf16_f32 v232, v232, v233
    v_cvt_pk_bf16_f32 v233, v234, 0
    v_accvgpr_read_b32 v240, a3
    v_mfma_f32_16x16x32_bf16 v[64:67], v[100:103], a[116:119], v[64:67]
    v_accvgpr_read_b32 v241, a35
    v_accvgpr_read_b32 v242, a67
    ds_write_b64 v244, v[232:233] offset:256
    v_mfma_f32_16x16x32_bf16 v[64:67], v[208:211], a[112:115], v[64:67]
    v_cvt_pk_bf16_f32 v236, v236, v237
    v_cvt_pk_bf16_f32 v237, v238, 0
    v_cvt_pk_bf16_f32 v240, v240, v241
    v_mfma_f32_16x16x32_bf16 v[28:31], v[136:139], a[216:219], v[28:31]
    v_cvt_pk_bf16_f32 v241, v242, 0
    ds_write_b64 v244, v[236:237] offset:512
    ds_write_b64 v244, v[240:241] offset:768
    v_mfma_f32_16x16x32_bf16 v[28:31], v[172:175], a[220:223], v[28:31]
    v_mfma_f32_16x16x32_bf16 v[28:31], v[176:179], a[224:227], v[28:31]
    v_cvt_pk_bf16_f32 v80, v32, v64
    v_cvt_pk_bf16_f32 v81, v33, v65
    v_cvt_pk_bf16_f32 v82, v34, v66
    v_mfma_f32_16x16x32_bf16 v[28:31], v[104:107], a[228:231], v[28:31]
    v_cvt_pk_bf16_f32 v83, v35, v67
    ds_write_b32 v245, v80 offset:24576
    ds_write_b32 v245, v81 offset:24832
    v_mfma_f32_16x16x32_bf16 v[28:31], v[96:99], a[232:235], v[28:31]
    ds_write_b32 v245, v82 offset:25088
    ds_write_b32 v245, v83 offset:25344
    s_waitcnt lgkmcnt(11)
    v_mfma_f32_16x16x32_bf16 v[148:151], v[84:87], v[4:7], 0
    v_mfma_f32_16x16x32_bf16 v[28:31], v[152:155], a[240:243], v[28:31]
    s_waitcnt lgkmcnt(10)
    v_mfma_f32_16x16x32_bf16 v[160:163], v[88:91], v[4:7], 0
    s_waitcnt lgkmcnt(9)
    v_mfma_f32_16x16x32_bf16 v[164:167], v[92:95], v[4:7], 0
    s_waitcnt lgkmcnt(8)
    v_mfma_f32_16x16x32_bf16 v[168:171], v[112:115], v[4:7], 0
    v_mfma_f32_16x16x32_bf16 v[28:31], a[236:239], a[248:251], v[28:31]
    v_mfma_f32_16x16x32_bf16 v[60:63], a[244:247], a[252:255], v[60:63]
    v_mfma_f32_16x16x32_bf16 v[60:63], v[156:159], a[100:103], v[60:63]
    s_waitcnt lgkmcnt(0)
    s_barrier
    ds_read_b128 v[128:131], v246 offset:24576
    ds_read_b128 v[132:135], v246 offset:24832
    v_mfma_f32_16x16x32_bf16 v[60:63], v[116:119], a[96:99], v[60:63]
    ds_read_b128 v[140:143], v246 offset:25088
    ds_read_b128 v[144:147], v246 offset:25344
    v_cvt_pk_bf16_f32 v148, v148, v149
    v_mfma_f32_16x16x32_bf16 v[60:63], v[124:127], a[108:111], v[60:63]
    v_cvt_pk_bf16_f32 v149, v150, v151
    v_cvt_pk_bf16_f32 v164, v164, v165
    v_cvt_pk_bf16_f32 v165, v166, v167
    v_mfma_f32_16x16x32_bf16 v[60:63], v[108:111], a[104:107], v[60:63]
    v_cvt_pk_bf16_f32 v150, v160, v161
    v_cvt_pk_bf16_f32 v151, v162, v163
    v_cvt_pk_bf16_f32 v166, v168, v169
    v_mfma_f32_16x16x32_bf16 v[60:63], v[120:123], a[116:119], v[60:63]
    v_cvt_pk_bf16_f32 v167, v170, v171
    v_permlane16_swap_b32 v148, v150
    v_permlane16_swap_b32 v149, v151
    v_mfma_f32_16x16x32_bf16 v[60:63], v[100:103], a[112:115], v[60:63]
    v_permlane16_swap_b32 v164, v166
    v_permlane16_swap_b32 v165, v167
    s_mov_b32 s33, 301056
    s_mov_b64 exec, s[94:95]
    buffer_store_dwordx4 v[148:151], v249, s[4:7], s33 offen
    buffer_store_dwordx4 v[164:167], v250, s[4:7], s33 offen
    s_mov_b64 exec, -1
    v_mfma_f32_16x16x32_bf16 v[24:27], v[172:175], a[216:219], v[24:27]
    v_mfma_f32_16x16x32_bf16 v[24:27], v[176:179], a[220:223], v[24:27]
    v_mfma_f32_16x16x32_bf16 v[24:27], v[104:107], a[224:227], v[24:27]
    v_cvt_pk_bf16_f32 v76, v28, v60
    v_cvt_pk_bf16_f32 v77, v29, v61
    v_cvt_pk_bf16_f32 v78, v30, v62
    v_mfma_f32_16x16x32_bf16 v[24:27], v[96:99], a[228:231], v[24:27]
    v_cvt_pk_bf16_f32 v79, v31, v63
    ds_write_b32 v245, v76 offset:20480
    ds_write_b32 v245, v77 offset:20736
    v_mfma_f32_16x16x32_bf16 v[24:27], v[152:155], a[232:235], v[24:27]
    ds_write_b32 v245, v78 offset:20992
    ds_write_b32 v245, v79 offset:21248
    s_waitcnt lgkmcnt(7)
    v_mfma_f32_16x16x32_bf16 v[180:183], v[128:131], v[4:7], 0
    v_mfma_f32_16x16x32_bf16 v[24:27], a[236:239], a[240:243], v[24:27]
    s_waitcnt lgkmcnt(6)
    v_mfma_f32_16x16x32_bf16 v[184:187], v[132:135], v[4:7], 0
    s_waitcnt lgkmcnt(5)
    v_mfma_f32_16x16x32_bf16 v[188:191], v[140:143], v[4:7], 0
    s_waitcnt lgkmcnt(4)
    v_mfma_f32_16x16x32_bf16 v[192:195], v[144:147], v[4:7], 0
    v_mfma_f32_16x16x32_bf16 v[24:27], a[124:127], a[248:251], v[24:27]
    v_mfma_f32_16x16x32_bf16 v[56:59], a[120:123], a[252:255], v[56:59]
    v_mfma_f32_16x16x32_bf16 v[56:59], a[244:247], a[100:103], v[56:59]
    s_waitcnt lgkmcnt(0)
    s_barrier
    ds_read_b128 v[84:87], v246 offset:20480
    ds_read_b128 v[88:91], v246 offset:20736
    v_mfma_f32_16x16x32_bf16 v[56:59], v[156:159], a[96:99], v[56:59]
    ds_read_b128 v[92:95], v246 offset:20992
    ds_read_b128 v[112:115], v246 offset:21248
    v_cvt_pk_bf16_f32 v180, v180, v181
    v_mfma_f32_16x16x32_bf16 v[56:59], v[116:119], a[108:111], v[56:59]
    v_cvt_pk_bf16_f32 v181, v182, v183
    v_cvt_pk_bf16_f32 v188, v188, v189
    v_cvt_pk_bf16_f32 v189, v190, v191
    v_mfma_f32_16x16x32_bf16 v[56:59], v[124:127], a[104:107], v[56:59]
    v_cvt_pk_bf16_f32 v182, v184, v185
    v_cvt_pk_bf16_f32 v183, v186, v187
    v_cvt_pk_bf16_f32 v190, v192, v193
    v_mfma_f32_16x16x32_bf16 v[56:59], v[108:111], a[116:119], v[56:59]
    v_cvt_pk_bf16_f32 v191, v194, v195
    v_permlane16_swap_b32 v180, v182
    v_permlane16_swap_b32 v181, v183
    v_mfma_f32_16x16x32_bf16 v[56:59], v[120:123], a[112:115], v[56:59]
    v_permlane16_swap_b32 v188, v190
    v_permlane16_swap_b32 v189, v191
    s_mov_b32 s33, 258048
    s_mov_b64 exec, s[94:95]
    buffer_store_dwordx4 v[180:183], v249, s[4:7], s33 offen
    buffer_store_dwordx4 v[188:191], v250, s[4:7], s33 offen
    s_mov_b64 exec, -1
    v_mfma_f32_16x16x32_bf16 v[20:23], v[176:179], a[216:219], v[20:23]
    v_mfma_f32_16x16x32_bf16 v[20:23], v[104:107], a[220:223], v[20:23]
    v_mfma_f32_16x16x32_bf16 v[20:23], v[96:99], a[224:227], v[20:23]
    v_cvt_pk_bf16_f32 v80, v24, v56
    v_cvt_pk_bf16_f32 v81, v25, v57
    v_cvt_pk_bf16_f32 v82, v26, v58
    v_mfma_f32_16x16x32_bf16 v[20:23], v[152:155], a[228:231], v[20:23]
    v_cvt_pk_bf16_f32 v83, v27, v59
    ds_write_b32 v245, v80 offset:16384
    ds_write_b32 v245, v81 offset:16640
    v_mfma_f32_16x16x32_bf16 v[20:23], a[236:239], a[232:235], v[20:23]
    ds_write_b32 v245, v82 offset:16896
    ds_write_b32 v245, v83 offset:17152
    s_waitcnt lgkmcnt(7)
    v_mfma_f32_16x16x32_bf16 v[148:151], v[84:87], v[4:7], 0
    v_mfma_f32_16x16x32_bf16 v[20:23], a[124:127], a[240:243], v[20:23]
    s_waitcnt lgkmcnt(6)
    v_mfma_f32_16x16x32_bf16 v[160:163], v[88:91], v[4:7], 0
    s_waitcnt lgkmcnt(5)
    v_mfma_f32_16x16x32_bf16 v[164:167], v[92:95], v[4:7], 0
    s_waitcnt vmcnt(11)
    v_mfma_f32_16x16x32_bf16 v[20:23], a[128:131], a[248:251], v[20:23]
    s_waitcnt lgkmcnt(4)
    v_mfma_f32_16x16x32_bf16 v[168:171], v[112:115], v[4:7], 0
    s_waitcnt vmcnt(10)
    v_mfma_f32_16x16x32_bf16 v[52:55], a[132:135], a[252:255], v[52:55]
    v_mfma_f32_16x16x32_bf16 v[52:55], a[120:123], a[100:103], v[52:55]
    s_waitcnt lgkmcnt(0)
    s_barrier
    ds_read_b128 v[128:131], v246 offset:16384
    ds_read_b128 v[132:135], v246 offset:16640
    v_mfma_f32_16x16x32_bf16 v[52:55], a[244:247], a[96:99], v[52:55]
    ds_read_b128 v[140:143], v246 offset:16896
    ds_read_b128 v[144:147], v246 offset:17152
    v_cvt_pk_bf16_f32 v148, v148, v149
    v_mfma_f32_16x16x32_bf16 v[52:55], v[156:159], a[108:111], v[52:55]
    v_cvt_pk_bf16_f32 v149, v150, v151
    v_cvt_pk_bf16_f32 v164, v164, v165
    v_cvt_pk_bf16_f32 v165, v166, v167
    v_mfma_f32_16x16x32_bf16 v[52:55], v[116:119], a[104:107], v[52:55]
    v_cvt_pk_bf16_f32 v150, v160, v161
    v_cvt_pk_bf16_f32 v151, v162, v163
    v_cvt_pk_bf16_f32 v166, v168, v169
    v_mfma_f32_16x16x32_bf16 v[52:55], v[124:127], a[116:119], v[52:55]
    v_cvt_pk_bf16_f32 v167, v170, v171
    v_permlane16_swap_b32 v148, v150
    v_permlane16_swap_b32 v149, v151
    v_mfma_f32_16x16x32_bf16 v[52:55], v[108:111], a[112:115], v[52:55]
    v_permlane16_swap_b32 v164, v166
    v_permlane16_swap_b32 v165, v167
    s_mov_b32 s33, 215040
    s_mov_b64 exec, s[94:95]
    buffer_store_dwordx4 v[148:151], v249, s[4:7], s33 offen
    buffer_store_dwordx4 v[164:167], v250, s[4:7], s33 offen
    s_mov_b64 exec, -1
    v_mfma_f32_16x16x32_bf16 v[16:19], v[104:107], a[216:219], v[16:19]
    v_mfma_f32_16x16x32_bf16 v[16:19], v[96:99], a[220:223], v[16:19]
    v_mfma_f32_16x16x32_bf16 v[16:19], v[152:155], a[224:227], v[16:19]
    v_cvt_pk_bf16_f32 v76, v20, v52
    v_cvt_pk_bf16_f32 v77, v21, v53
    v_cvt_pk_bf16_f32 v78, v22, v54
    v_mfma_f32_16x16x32_bf16 v[16:19], a[236:239], a[228:231], v[16:19]
    v_cvt_pk_bf16_f32 v79, v23, v55
    ds_write_b32 v245, v76 offset:12288
    ds_write_b32 v245, v77 offset:12544
    v_mfma_f32_16x16x32_bf16 v[16:19], a[124:127], a[232:235], v[16:19]
    ds_write_b32 v245, v78 offset:12800
    ds_write_b32 v245, v79 offset:13056
    s_waitcnt lgkmcnt(7)
    v_mfma_f32_16x16x32_bf16 v[180:183], v[128:131], v[4:7], 0
    v_mfma_f32_16x16x32_bf16 v[16:19], a[128:131], a[240:243], v[16:19]
    s_waitcnt lgkmcnt(6)
    v_mfma_f32_16x16x32_bf16 v[184:187], v[132:135], v[4:7], 0
    s_waitcnt lgkmcnt(5)
    v_mfma_f32_16x16x32_bf16 v[188:191], v[140:143], v[4:7], 0
    s_waitcnt vmcnt(11)
    v_mfma_f32_16x16x32_bf16 v[16:19], a[136:139], a[248:251], v[16:19]
    s_waitcnt lgkmcnt(4)
    v_mfma_f32_16x16x32_bf16 v[192:195], v[144:147], v[4:7], 0
    s_waitcnt vmcnt(10)
    v_mfma_f32_16x16x32_bf16 v[48:51], a[140:143], a[252:255], v[48:51]
    v_mfma_f32_16x16x32_bf16 v[48:51], a[132:135], a[100:103], v[48:51]
    s_waitcnt lgkmcnt(0)
    s_barrier
    ds_read_b128 v[84:87], v246 offset:12288
    ds_read_b128 v[88:91], v246 offset:12544
    v_mfma_f32_16x16x32_bf16 v[48:51], a[120:123], a[96:99], v[48:51]
    ds_read_b128 v[92:95], v246 offset:12800
    ds_read_b128 v[112:115], v246 offset:13056
    v_cvt_pk_bf16_f32 v180, v180, v181
    v_mfma_f32_16x16x32_bf16 v[48:51], a[244:247], a[108:111], v[48:51]
    v_cvt_pk_bf16_f32 v181, v182, v183
    v_cvt_pk_bf16_f32 v188, v188, v189
    v_cvt_pk_bf16_f32 v189, v190, v191
    v_mfma_f32_16x16x32_bf16 v[48:51], v[156:159], a[104:107], v[48:51]
    v_cvt_pk_bf16_f32 v182, v184, v185
    v_cvt_pk_bf16_f32 v183, v186, v187
    v_cvt_pk_bf16_f32 v190, v192, v193
    v_mfma_f32_16x16x32_bf16 v[48:51], v[116:119], a[116:119], v[48:51]
    v_cvt_pk_bf16_f32 v191, v194, v195
    v_permlane16_swap_b32 v180, v182
    v_permlane16_swap_b32 v181, v183
    v_mfma_f32_16x16x32_bf16 v[48:51], v[124:127], a[112:115], v[48:51]
    v_permlane16_swap_b32 v188, v190
    v_permlane16_swap_b32 v189, v191
    s_mov_b32 s33, 172032
    s_mov_b64 exec, s[94:95]
    buffer_store_dwordx4 v[180:183], v249, s[4:7], s33 offen
    buffer_store_dwordx4 v[188:191], v250, s[4:7], s33 offen
    s_mov_b64 exec, -1
    v_mfma_f32_16x16x32_bf16 v[12:15], v[96:99], a[216:219], v[12:15]
    v_mfma_f32_16x16x32_bf16 v[12:15], v[152:155], a[220:223], v[12:15]
    v_mfma_f32_16x16x32_bf16 v[12:15], a[236:239], a[224:227], v[12:15]
    v_cvt_pk_bf16_f32 v80, v16, v48
    v_cvt_pk_bf16_f32 v81, v17, v49
    v_cvt_pk_bf16_f32 v82, v18, v50
    v_mfma_f32_16x16x32_bf16 v[12:15], a[124:127], a[228:231], v[12:15]
    v_cvt_pk_bf16_f32 v83, v19, v51
    ds_write_b32 v245, v80 offset:8192
    ds_write_b32 v245, v81 offset:8448
    v_mfma_f32_16x16x32_bf16 v[12:15], a[128:131], a[232:235], v[12:15]
    ds_write_b32 v245, v82 offset:8704
    ds_write_b32 v245, v83 offset:8960
    s_waitcnt lgkmcnt(7)
    v_mfma_f32_16x16x32_bf16 v[148:151], v[84:87], v[4:7], 0
    v_mfma_f32_16x16x32_bf16 v[12:15], a[136:139], a[240:243], v[12:15]
    s_waitcnt lgkmcnt(6)
    v_mfma_f32_16x16x32_bf16 v[160:163], v[88:91], v[4:7], 0
    s_waitcnt lgkmcnt(5)
    v_mfma_f32_16x16x32_bf16 v[164:167], v[92:95], v[4:7], 0
    s_waitcnt vmcnt(11)
    v_mfma_f32_16x16x32_bf16 v[12:15], a[144:147], a[248:251], v[12:15]
    s_waitcnt lgkmcnt(4)
    v_mfma_f32_16x16x32_bf16 v[168:171], v[112:115], v[4:7], 0
    s_waitcnt vmcnt(10)
    v_mfma_f32_16x16x32_bf16 v[44:47], a[148:151], a[252:255], v[44:47]
    v_mfma_f32_16x16x32_bf16 v[44:47], a[140:143], a[100:103], v[44:47]
    s_waitcnt lgkmcnt(0)
    s_barrier
    ds_read_b128 v[128:131], v246 offset:8192
    ds_read_b128 v[132:135], v246 offset:8448
    v_mfma_f32_16x16x32_bf16 v[44:47], a[132:135], a[96:99], v[44:47]
    ds_read_b128 v[140:143], v246 offset:8704
    ds_read_b128 v[144:147], v246 offset:8960
    v_cvt_pk_bf16_f32 v148, v148, v149
    v_mfma_f32_16x16x32_bf16 v[44:47], a[120:123], a[108:111], v[44:47]
    v_cvt_pk_bf16_f32 v149, v150, v151
    v_cvt_pk_bf16_f32 v164, v164, v165
    v_cvt_pk_bf16_f32 v165, v166, v167
    v_mfma_f32_16x16x32_bf16 v[44:47], a[244:247], a[104:107], v[44:47]
    v_cvt_pk_bf16_f32 v150, v160, v161
    v_cvt_pk_bf16_f32 v151, v162, v163
    v_cvt_pk_bf16_f32 v166, v168, v169
    v_mfma_f32_16x16x32_bf16 v[44:47], v[156:159], a[116:119], v[44:47]
    v_cvt_pk_bf16_f32 v167, v170, v171
    v_permlane16_swap_b32 v148, v150
    v_permlane16_swap_b32 v149, v151
    v_mfma_f32_16x16x32_bf16 v[44:47], v[116:119], a[112:115], v[44:47]
    v_permlane16_swap_b32 v164, v166
    v_permlane16_swap_b32 v165, v167
    s_mov_b32 s33, 129024
    s_mov_b64 exec, s[94:95]
    buffer_store_dwordx4 v[148:151], v249, s[4:7], s33 offen
    buffer_store_dwordx4 v[164:167], v250, s[4:7], s33 offen
    s_mov_b64 exec, -1
    v_mfma_f32_16x16x32_bf16 v[8:11], v[152:155], a[216:219], v[8:11]
    v_mfma_f32_16x16x32_bf16 v[8:11], a[236:239], a[220:223], v[8:11]
    v_mfma_f32_16x16x32_bf16 v[8:11], a[124:127], a[224:227], v[8:11]
    v_cvt_pk_bf16_f32 v76, v12, v44
    v_cvt_pk_bf16_f32 v77, v13, v45
    v_cvt_pk_bf16_f32 v78, v14, v46
    v_mfma_f32_16x16x32_bf16 v[8:11], a[128:131], a[228:231], v[8:11]
    v_cvt_pk_bf16_f32 v79, v15, v47
    ds_write_b32 v245, v76 offset:4096
    ds_write_b32 v245, v77 offset:4352
    v_mfma_f32_16x16x32_bf16 v[8:11], a[136:139], a[232:235], v[8:11]
    ds_write_b32 v245, v78 offset:4608
    ds_write_b32 v245, v79 offset:4864
    s_waitcnt lgkmcnt(7)
    v_mfma_f32_16x16x32_bf16 v[180:183], v[128:131], v[4:7], 0
    v_mfma_f32_16x16x32_bf16 v[8:11], a[144:147], a[240:243], v[8:11]
    s_waitcnt lgkmcnt(6)
    v_mfma_f32_16x16x32_bf16 v[184:187], v[132:135], v[4:7], 0
    s_waitcnt lgkmcnt(5)
    v_mfma_f32_16x16x32_bf16 v[188:191], v[140:143], v[4:7], 0
    s_waitcnt vmcnt(10)
    v_mfma_f32_16x16x32_bf16 v[8:11], a[152:155], a[248:251], v[8:11]
    s_waitcnt lgkmcnt(4)
    v_mfma_f32_16x16x32_bf16 v[192:195], v[144:147], v[4:7], 0
    v_mfma_f32_16x16x32_bf16 v[40:43], a[156:159], a[252:255], v[40:43]
    v_mfma_f32_16x16x32_bf16 v[40:43], a[148:151], a[100:103], v[40:43]
    s_waitcnt lgkmcnt(0)
    s_barrier
    ds_read_b128 v[84:87], v246 offset:4096
    ds_read_b128 v[88:91], v246 offset:4352
    v_mfma_f32_16x16x32_bf16 v[40:43], a[140:143], a[96:99], v[40:43]
    ds_read_b128 v[92:95], v246 offset:4608
    ds_read_b128 v[112:115], v246 offset:4864
    v_cvt_pk_bf16_f32 v180, v180, v181
    v_mfma_f32_16x16x32_bf16 v[40:43], a[132:135], a[108:111], v[40:43]
    v_cvt_pk_bf16_f32 v181, v182, v183
    v_cvt_pk_bf16_f32 v188, v188, v189
    v_cvt_pk_bf16_f32 v189, v190, v191
    v_mfma_f32_16x16x32_bf16 v[40:43], a[120:123], a[104:107], v[40:43]
    v_cvt_pk_bf16_f32 v182, v184, v185
    v_cvt_pk_bf16_f32 v183, v186, v187
    v_cvt_pk_bf16_f32 v190, v192, v193
    v_mfma_f32_16x16x32_bf16 v[40:43], a[244:247], a[116:119], v[40:43]
    v_cvt_pk_bf16_f32 v191, v194, v195
    v_permlane16_swap_b32 v180, v182
    v_permlane16_swap_b32 v181, v183
    v_mfma_f32_16x16x32_bf16 v[40:43], v[156:159], a[112:115], v[40:43]
    s_nop 7
    v_cvt_pk_bf16_f32 v80, v8, v40
    v_cvt_pk_bf16_f32 v81, v9, v41
    v_cvt_pk_bf16_f32 v82, v10, v42
    v_cvt_pk_bf16_f32 v83, v11, v43
    ds_write_b32 v245, v80 offset:0
    ds_write_b32 v245, v81 offset:256
    ds_write_b32 v245, v82 offset:512
    ds_write_b32 v245, v83 offset:768
    s_waitcnt lgkmcnt(0)
    s_barrier
    ds_read_b128 v[12:15], v246 offset:0
    ds_read_b128 v[16:19], v246 offset:256
    ds_read_b128 v[20:23], v246 offset:512
    ds_read_b128 v[24:27], v246 offset:768
    v_permlane16_swap_b32 v188, v190
    v_permlane16_swap_b32 v189, v191
    s_mov_b32 s33, 86016
    s_mov_b64 exec, s[94:95]
    buffer_store_dwordx4 v[180:183], v249, s[4:7], s33 offen
    buffer_store_dwordx4 v[188:191], v250, s[4:7], s33 offen
    s_mov_b64 exec, -1
    v_mfma_f32_16x16x32_bf16 v[148:151], v[84:87], v[4:7], 0
    v_mfma_f32_16x16x32_bf16 v[160:163], v[88:91], v[4:7], 0
    v_mfma_f32_16x16x32_bf16 v[164:167], v[92:95], v[4:7], 0
    v_mfma_f32_16x16x32_bf16 v[168:171], v[112:115], v[4:7], 0
    s_nop 4
    v_cvt_pk_bf16_f32 v148, v148, v149
    v_cvt_pk_bf16_f32 v149, v150, v151
    v_cvt_pk_bf16_f32 v164, v164, v165
    v_cvt_pk_bf16_f32 v165, v166, v167
    v_cvt_pk_bf16_f32 v150, v160, v161
    v_cvt_pk_bf16_f32 v151, v162, v163
    v_cvt_pk_bf16_f32 v166, v168, v169
    v_cvt_pk_bf16_f32 v167, v170, v171
    v_permlane16_swap_b32 v148, v150
    v_permlane16_swap_b32 v149, v151
    v_permlane16_swap_b32 v164, v166
    v_permlane16_swap_b32 v165, v167
    s_mov_b32 s33, 43008
    s_mov_b64 exec, s[94:95]
    buffer_store_dwordx4 v[148:151], v249, s[4:7], s33 offen
    buffer_store_dwordx4 v[164:167], v250, s[4:7], s33 offen
    s_mov_b64 exec, -1
    s_waitcnt lgkmcnt(3)
    v_mfma_f32_16x16x32_bf16 v[100:103], v[12:15], v[4:7], 0
    s_waitcnt lgkmcnt(2)
    v_mfma_f32_16x16x32_bf16 v[104:107], v[16:19], v[4:7], 0
    s_waitcnt lgkmcnt(1)
    v_mfma_f32_16x16x32_bf16 v[108:111], v[20:23], v[4:7], 0
    s_waitcnt lgkmcnt(0)
    v_mfma_f32_16x16x32_bf16 v[116:119], v[24:27], v[4:7], 0
    s_nop 1
    v_cvt_pk_bf16_f32 v100, v100, v101
    v_cvt_pk_bf16_f32 v101, v102, v103
    s_nop 1
    v_cvt_pk_bf16_f32 v108, v108, v109
    v_cvt_pk_bf16_f32 v109, v110, v111
    v_cvt_pk_bf16_f32 v102, v104, v105
    v_cvt_pk_bf16_f32 v103, v106, v107
    v_cvt_pk_bf16_f32 v110, v116, v117
    v_cvt_pk_bf16_f32 v111, v118, v119
    v_permlane16_swap_b32 v100, v102
    v_permlane16_swap_b32 v101, v103
    v_permlane16_swap_b32 v108, v110
    v_permlane16_swap_b32 v109, v111
    s_mov_b32 s33, 0
    s_mov_b64 exec, s[94:95]
    buffer_store_dwordx4 v[100:103], v249, s[4:7], s33 offen
    buffer_store_dwordx4 v[108:111], v250, s[4:7], s33 offen
    s_mov_b64 exec, -1
K2_end:
    s_endpgm
FU_idle:
    ds_read_b128 v[72:75], v16 offset:128
    ds_read_b128 v[76:79], v17 offset:896
    ds_read_b128 v[80:83], v18 offset:1664
    ds_read_b128 v[84:87], v19 offset:2432
    ds_read_b128 v[88:91], v16 offset:12480
    ds_read_b128 v[92:95], v17 offset:13248
    ds_read_b128 v[96:99], v18 offset:14016
    ds_read_b128 v[100:103], v19 offset:14784
    s_waitcnt lgkmcnt(0)
    s_add_u32 s33, s88, 65536
    buffer_store_dwordx4 v[72:75], v11, s[84:87], s33 offen sc1
    s_add_u32 s33, s88, 163840
    buffer_store_dwordx4 v[76:79], v11, s[84:87], s33 offen sc1
    s_add_u32 s33, s88, 262144
    buffer_store_dwordx4 v[80:83], v11, s[84:87], s33 offen sc1
    s_add_u32 s33, s88, 360448
    buffer_store_dwordx4 v[84:87], v11, s[84:87], s33 offen sc1
    s_add_u32 s33, s89, 65536
    buffer_store_dwordx4 v[88:91], v11, s[84:87], s33 offen sc1
    s_add_u32 s33, s89, 163840
    buffer_store_dwordx4 v[92:95], v11, s[84:87], s33 offen sc1
    s_add_u32 s33, s89, 262144
    buffer_store_dwordx4 v[96:99], v11, s[84:87], s33 offen sc1
    s_add_u32 s33, s89, 360448
    buffer_store_dwordx4 v[100:103], v11, s[84:87], s33 offen sc1
    s_waitcnt vmcnt(0)
    s_cmp_eq_u32 s80, 3
    s_cselect_b32 s80, 0, s78
    s_cmp_eq_u32 s80, 0
    s_cbranch_scc1 FU_nosig2_80
    s_add_u32 s33, s80, 6144
    v_mov_b32 v12, s33
    v_mov_b32 v13, s82
    s_mov_b64 exec, 1
    global_atomic_swap v12, v13, s[8:9] sc1
    s_mov_b64 exec, -1
FU_nosig2_80:
    s_cmp_eq_u32 s81, 0
    s_cbranch_scc1 FU_nosig2_81
    s_add_u32 s33, s81, 6144
    v_mov_b32 v12, s33
    v_mov_b32 v13, s82
    s_mov_b64 exec, 1
    global_atomic_swap v12, v13, s[8:9] sc1
    s_mov_b64 exec, -1
FU_nosig2_81:
    s_cmp_eq_u32 s78, 0
    s_cbranch_scc1 FU_nosig3_78
    s_add_u32 s33, s78, 20480
    v_mov_b32 v10, s33
    v_mov_b32 v11, s82
    s_mov_b64 exec, 1
    global_atomic_swap v10, v11, s[8:9] sc1
    s_mov_b64 exec, -1
FU_nosig3_78:
    s_cmp_eq_u32 s79, 0
    s_cbranch_scc1 FU_nosig3_79
    s_add_u32 s33, s79, 20480
    v_mov_b32 v10, s33
    v_mov_b32 v11, s82
    s_mov_b64 exec, 1
    global_atomic_swap v10, v11, s[8:9] sc1
    s_mov_b64 exec, -1
FU_nosig3_79:
    s_endpgm
FU_poll0_again:
    s_mov_b32 s34, 0
FU_poll0_loop:
    s_add_u32 s34, s34, 1
    s_cmp_ge_u32 s34, 400000
    s_cbranch_scc1 FU_poll0_ok
    s_sleep 16
    global_load_dword v3, v252, s[8:9] sc1
    global_load_dword v8, v255, s[8:9] sc1
    s_waitcnt vmcnt(0)
    v_cmp_ne_u32 s[72:73], s82, v3
    v_cmp_ne_u32 s[74:75], s82, v8
    s_nop 4
    s_or_b64 s[72:73], s[72:73], s[74:75]
    s_cmp_lg_u64 s[72:73], 0
    s_cbranch_scc1 FU_poll0_loop
    s_branch FU_poll0_ok
FU_poll1_again:
    s_mov_b32 s34, 0
FU_poll1_loop:
    s_add_u32 s34, s34, 1
    s_cmp_ge_u32 s34, 400000
    s_cbranch_scc1 FU_poll1_ok
    s_sleep 16
    v_add_u32 v253, 6144, v252
    global_load_dword v3, v253, s[8:9] sc1
    global_load_dword v253, v255, s[8:9] offset:256 sc1
    s_waitcnt vmcnt(0)
    v_cmp_ne_u32 s[72:73], s82, v3
    v_cmp_ne_u32 s[74:75], s82, v253
    s_nop 4
    s_or_b64 s[72:73], s[72:73], s[74:75]
    s_cmp_lg_u64 s[72:73], 0
    s_cbranch_scc1 FU_poll1_loop
    s_branch FU_poll1_ok
FU_poll2_again:
    s_mov_b32 s34, 0
FU_poll2_loop:
    s_add_u32 s34, s34, 1
    s_cmp_ge_u32 s34, 400000
    s_cbranch_scc1 FU_poll2_ok
    s_sleep 16
    v_add_u32 v254, 20480, v252
    global_load_dword v3, v254, s[8:9] sc1
    global_load_dword v254, v255, s[8:9] offset:512 sc1
    s_waitcnt vmcnt(0)
    v_cmp_ne_u32 s[72:73], s82, v3
    v_cmp_ne_u32 s[74:75], s82, v254
    s_nop 4
    s_or_b64 s[72:73], s[72:73], s[74:75]
    s_cmp_lg_u64 s[72:73], 0
    s_cbranch_scc1 FU_poll2_loop
    s_branch FU_poll2_ok
.p2align 8
FU_bt:
    .long 0x3e3f0000, 0xbeb53dec, 0xbcab0000, 0xbe19be18, 0x00003ea6, 0x0000bf12, 0xbea60000, 0x3f120000
    .long 0x3d9f0000, 0xbe91be10, 0xbe290000, 0x3ecbbdee, 0xbe5b0000, 0x3e25be5b, 0x3e5b0000, 0xbe25be5b
    .long 0xbd9f0000, 0x3e91be10, 0xbe290000, 0x3ecb3dee, 0x3e840000, 0xbea83e37, 0xbe840000, 0x3ea83e37
    .long 0xbe3f0000, 0x3eb53dec, 0xbcab0000, 0xbe193e18, 0x3ebe0000, 0x3dfa3f09, 0xbebe0000, 0xbdfa3f09
    .long 0xbe92beb5, 0x3eae3d8e, 0x3ebf3e19, 0x3e8f3eee, 0x0000be82, 0x0000bd94, 0x3e820000, 0x3d940000
    .long 0x3ec23ea1, 0xbec73c76, 0xbda83ebf, 0xbd98bec6, 0x3ea83e25, 0x3ec03ea8, 0xbea83e25, 0xbec03ea8
    .long 0xbec23ea1, 0x3ec73c76, 0xbda8bebf, 0xbd983ec6, 0xbeb8be69, 0xbe6bbe7e, 0x3eb8be69, 0x3e6bbe7e
    .long 0x3e92beb5, 0xbeae3d8e, 0x3ebfbe19, 0x3e8fbeee, 0xbd163e34, 0xbe23bd59, 0x3d163e34, 0x3e23bd59
    .long 0x3e9f3ee0, 0xbe5cbd12, 0xbeb4bd49, 0xbea3bef0, 0x00003d94, 0x00003e82, 0xbd940000, 0xbe820000
    .long 0x3ea5be2d, 0xbdf13e94, 0x3e5d3eb7, 0xbef2be84, 0x3ea83ec0, 0x3e253ea8, 0xbea83ec0, 0xbe253ea8
    .long 0xbea5be2d, 0x3df13e94, 0x3e5dbeb7, 0xbef23e84, 0xbd59be23, 0x3e34bd16, 0x3d59be23, 0xbe34bd16
    .long 0xbe9f3ee0, 0x3e5cbd12, 0xbeb43d49, 0xbea33ef0, 0xbe7ebe6b, 0xbe69beb8, 0x3e7ebe6b, 0x3e69beb8
    .long 0x3c81bec1, 0x00003e15, 0x3e40bd8a, 0x00003df4, 0x00003f12, 0x0000bea6, 0xbf120000, 0x3ea60000
    .long 0x3c3cbefa, 0x00003e37, 0x3e3abb6b, 0x00003d0c, 0xbe5b3e25, 0x0000be5b, 0x3e5b3e25, 0x0000be5b
    .long 0xbc3cbefa, 0x00003e37, 0x3e3a3b6b, 0x0000bd0c, 0x3f093dfa, 0x00003ebe, 0xbf093dfa, 0x00003ebe
    .long 0xbc81bec1, 0x00003e15, 0x3e403d8a, 0x0000bdf4, 0x3e37bea8, 0x00003e84, 0xbe37bea8, 0x00003e84

FU_gt:
    .long 0xbeb43d37, 0xbec9bf09, 0xbecfbf08, 0x3eb9bcf4, 0x00000000, 0x00000000, 0x00003f80, 0x00000000
    .long 0x3f02bd09, 0xbebb3e93, 0x3e293f09, 0xbec8bee7, 0x3ec23ec2, 0x3ec23ec2, 0xbec23ec2, 0xbec23ec2
    .long 0xbf02bd09, 0x3ebb3e93, 0x3e29bf09, 0xbec83ee7, 0x3f003f39, 0x3e763eb2, 0xbf003f39, 0xbe763eb2
    .long 0x3eb43d37, 0x3ec9bf09, 0xbecf3f08, 0x3eb93cf4, 0x3ded3da4, 0x3e763e2b, 0xbded3da4, 0xbe763e2b
    .long 0x3ebfbc75, 0x00003f09, 0x3ec43f09, 0x00000000, 0x00000000, 0x00003f80, 0x00000000, 0x00000000
    .long 0x3e08bef0, 0x00003f09, 0x3f053e84, 0x00000000, 0x3ec23ec2, 0x00003ec2, 0xbec23ec2, 0x00003ec2
    .long 0xbe08bef0, 0x00003f09, 0x3f05be84, 0x00000000, 0x3ded3e2b, 0x00003da4, 0xbded3e2b, 0x00003da4
    .long 0xbebfbc75, 0x00003f09, 0x3ec4bf09, 0x00000000, 0x3f003eb2, 0x00003f39, 0xbf003eb2, 0x00003f39
    .long 0x3a683852, 0xba673ac0, 0x3a69bab7, 0x39fab85d, 0x00000000, 0x00000000, 0x00000000, 0x00000000
    .long 0x3a10b8f3, 0xba30ba37, 0x3910badd, 0x3a80b913, 0xba77ba77, 0xba77ba77, 0x3a77ba77, 0x3a77ba77
    .long 0xba10b8f3, 0x3a30ba37, 0x39103add, 0x3a803913, 0x3a8f39d9, 0x39d9b9d3, 0xba8f39d9, 0xb9d9b9d3
    .long 0xba683852, 0x3a673ac0, 0x3a693ab7, 0x39fa385d, 0xb91f3754, 0x39d9b96a, 0x391f3754, 0xb9d9b96a
    .long 0xb9d037f2, 0x0000ba26, 0x39ceba5d, 0x00000000, 0x00000000, 0x00000000, 0x00000000, 0x00000000
    .long 0x38f739b5, 0x0000ba26, 0xbaecb9a0, 0x00000000, 0xba77ba77, 0x0000ba77, 0x3a77ba77, 0x0000ba77
    .long 0xb8f739b5, 0x0000ba26, 0xbaec39a0, 0x00000000, 0xb91fb96a, 0x00003754, 0x391fb96a, 0x00003754
    .long 0x39d037f2, 0x0000ba26, 0x39ce3a5d, 0x00000000, 0x3a8fb9d3, 0x000039d9, 0xba8fb9d3, 0x000039d9

.p2align 8
K2_at:
    .long 0x00003f48, 0x0000bf48, 0x00003f40, 0x0000bf40, 0xbf103f0c, 0x0000bf0c, 0xbf3a3e3f, 0x0000be3f
    .long 0xbf48bcb3, 0x00003cb3, 0xbeb9bf28, 0x00003f28, 0xbf08bf13, 0x00003f13, 0x3f0cbf04, 0x00003f04
    .long 0x3d33bf48, 0x00003f48, 0x3f223ece, 0x0000bece, 0x3f17bf03, 0x00003f03, 0xbe6d3f37, 0x0000bf37
    .long 0x3f483d86, 0x0000bd86, 0xbf40bd41, 0x00003d41, 0x3efe3f1b, 0x0000bf1b, 0xbe10bf3d, 0x00003f3d
    .long 0xbdb33f47, 0x0000bf47, 0x3f2ebea4, 0x00003ea4, 0xbf1e3ef6, 0x0000bef6, 0x3ef53f14, 0x0000bf14
    .long 0x00000000, 0x00000000, 0x00000000, 0x00000000, 0x00000000, 0x00000000, 0x00000000, 0x00000000
    .long 0x00000000, 0x00000000, 0x00000000, 0x00000000, 0x00000000, 0x00000000, 0x00000000, 0x00000000
    .long 0x00000000, 0x00000000, 0x00000000, 0x00000000, 0x00000000, 0x00000000, 0x00000000, 0x00000000
    .long 0x00003f40, 0x0000bf40, 0x00003f48, 0x0000bf48, 0xbf3abe3f, 0x00003e3f, 0xbf10bf0c, 0x00003f0c
    .long 0x3eb9bf28, 0x00003f28, 0x3f48bcb3, 0x00003cb3, 0x3f0c3f04, 0x0000bf04, 0xbf083f13, 0x0000bf13
    .long 0xbf223ece, 0x0000bece, 0xbd33bf48, 0x00003f48, 0xbe6dbf37, 0x00003f37, 0x3f173f03, 0x0000bf03
    .long 0x3f40bd41, 0x00003d41, 0xbf483d86, 0x0000bd86, 0xbe103f3d, 0x0000bf3d, 0x3efebf1b, 0x00003f1b
    .long 0xbf2ebea4, 0x00003ea4, 0x3db33f47, 0x0000bf47, 0x3ef5bf14, 0x00003f14, 0xbf1ebef6, 0x00003ef6
    .long 0x00000000, 0x00000000, 0x00000000, 0x00000000, 0x00000000, 0x00000000, 0x00000000, 0x00000000
    .long 0x00000000, 0x00000000, 0x00000000, 0x00000000, 0x00000000, 0x00000000, 0x00000000, 0x00000000
    .long 0x00000000, 0x00000000, 0x00000000, 0x00000000, 0x00000000, 0x00000000, 0x00000000, 0x00000000
    .long 0x00004045, 0x3fb73fb7, 0x3dc33dc3, 0x40254025, 0x00000000, 0xbfb73fb7, 0xbe0d3e0d, 0xbfe53fe5
    .long 0x00000000, 0x3fb73fb7, 0x3e4b3e4b, 0x3f9f3f9f, 0x00000000, 0xbfb73fb7, 0xbe923e92, 0xbf5c3f5c
    .long 0x00000000, 0x3fb73fb7, 0x3ed33ed3, 0x3f183f18, 0x00000000, 0xbfb73fb7, 0xbf183f18, 0xbed33ed3
    .long 0x00000000, 0x3fb73fb7, 0x3f5c3f5c, 0x3e923e92, 0x00000000, 0xbfb73fb7, 0xbf9f3f9f, 0xbe4b3e4b
    .long 0x00000000, 0x3fb73fb7, 0x3fe53fe5, 0x3e0d3e0d, 0x40450000, 0xbfb73fb7, 0xc0254025, 0xbdc33dc3
    .long 0x00000000, 0x00000000, 0x00000000, 0x00000000, 0x00000000, 0x00000000, 0x00000000, 0x00000000
    .long 0x00000000, 0x00000000, 0x00000000, 0x00000000, 0x00000000, 0x00000000, 0x00000000, 0x00000000
    .long 0x00000000, 0x00000000, 0x00000000, 0x00000000, 0x00000000, 0x00000000, 0x00000000, 0x00000000
    .long 0x00000000, 0x00000000, 0x00000000, 0x00000000, 0x00000000, 0x00000000, 0x00000000, 0x00000000
    .long 0x00000000, 0x00000000, 0x00000000, 0x00000000, 0x00000000, 0x00000000, 0x00000000, 0x00000000
    .long 0x00000000, 0x00000000, 0x00000000, 0x00000000, 0x00000000, 0x00000000, 0x00000000, 0x00000000
    .long 0x00000000, 0x00000000, 0x00000000, 0x00000000, 0x00000000, 0x00000000, 0x00000000, 0x00000000
    .long 0x00000000, 0x00000000, 0x00000000, 0x00000000, 0x00000000, 0x00000000, 0x00000000, 0x00000000
    .long 0x00000000, 0x00000000, 0x00000000, 0x00000000, 0x00000000, 0x00000000, 0x00000000, 0x00000000
    .long 0x00000000, 0x00000000, 0x00000000, 0x00000000, 0x00000000, 0x00000000, 0x00000000, 0x00000000
    .long 0x00000000, 0x00000000, 0x00000000, 0x00000000, 0x00000000, 0x00000000, 0x00000000, 0x00000000
    .long 0x00003f48, 0x0000bf48, 0x00003f40, 0x0000bf40, 0xbf103f0c, 0x0000bf0c, 0xbf3a3e3f, 0x0000be3f
    .long 0xbf48bcb3, 0x00003cb3, 0xbeb9bf28, 0x00003f28, 0xbf08bf13, 0x00003f13, 0x3f0cbf04, 0x00003f04
    .long 0x3d33bf48, 0x00003f48, 0x3f223ece, 0x0000bece, 0x3f17bf03, 0x00003f03, 0xbe6d3f37, 0x0000bf37
    .long 0x3f483d86, 0x0000bd86, 0xbf40bd41, 0x00003d41, 0x3efe3f1b, 0x0000bf1b, 0xbe10bf3d, 0x00003f3d
    .long 0xbdb33f47, 0x0000bf47, 0x3f2ebea4, 0x00003ea4, 0xbf1e3ef6, 0x0000bef6, 0x3ef53f14, 0x0000bf14
    .long 0x00000000, 0x00000000, 0x00000000, 0x00000000, 0x00000000, 0x00000000, 0x00000000, 0x00000000
    .long 0x00000000, 0x00000000, 0x00000000, 0x00000000, 0x00000000, 0x00000000, 0x00000000, 0x00000000
    .long 0x00000000, 0x00000000, 0x00000000, 0x00000000, 0x00000000, 0x00000000, 0x00000000, 0x00000000
    .long 0x00003f40, 0x0000bf40, 0x00003f48, 0x0000bf48, 0xbf3abe3f, 0x00003e3f, 0xbf10bf0c, 0x00003f0c
    .long 0x3eb9bf28, 0x00003f28, 0x3f48bcb3, 0x00003cb3, 0x3f0c3f04, 0x0000bf04, 0xbf083f13, 0x0000bf13
    .long 0xbf223ece, 0x0000bece, 0xbd33bf48, 0x00003f48, 0xbe6dbf37, 0x00003f37, 0x3f173f03, 0x0000bf03
    .long 0x3f40bd41, 0x00003d41, 0xbf483d86, 0x0000bd86, 0xbe103f3d, 0x0000bf3d, 0x3efebf1b, 0x00003f1b
    .long 0xbf2ebea4, 0x00003ea4, 0x3db33f47, 0x0000bf47, 0x3ef5bf14, 0x00003f14, 0xbf1ebef6, 0x00003ef6
    .long 0x00000000, 0x00000000, 0x00000000, 0x00000000, 0x00000000, 0x00000000, 0x00000000, 0x00000000
    .long 0x00000000, 0x00000000, 0x00000000, 0x00000000, 0x00000000, 0x00000000, 0x00000000, 0x00000000
    .long 0x00000000, 0x00000000, 0x00000000, 0x00000000, 0x00000000, 0x00000000, 0x00000000, 0x00000000
    .long 0x3fb73fb7, 0x00004045, 0x40254025, 0x3dc33dc3, 0xbfb73fb7, 0x00000000, 0xbfe53fe5, 0xbe0d3e0d
    .long 0x3fb73fb7, 0x00000000, 0x3f9f3f9f, 0x3e4b3e4b, 0xbfb73fb7, 0x00000000, 0xbf5c3f5c, 0xbe923e92
    .long 0x3fb73fb7, 0x00000000, 0x3f183f18, 0x3ed33ed3, 0xbfb73fb7, 0x00000000, 0xbed33ed3, 0xbf183f18
    .long 0x3fb73fb7, 0x00000000, 0x3e923e92, 0x3f5c3f5c, 0xbfb73fb7, 0x00000000, 0xbe4b3e4b, 0xbf9f3f9f
    .long 0x3fb73fb7, 0x00000000, 0x3e0d3e0d, 0x3fe53fe5, 0xbfb73fb7, 0x40450000, 0xbdc33dc3, 0xc0254025
    .long 0x00000000, 0x00000000, 0x00000000, 0x00000000, 0x00000000, 0x00000000, 0x00000000, 0x00000000
    .long 0x00000000, 0x00000000, 0x00000000, 0x00000000, 0x00000000, 0x00000000, 0x00000000, 0x00000000
    .long 0x00000000, 0x00000000, 0x00000000, 0x00000000, 0x00000000, 0x00000000, 0x00000000, 0x00000000
    .long 0x00000000, 0x00000000, 0x00000000, 0x00000000, 0x00000000, 0x00000000, 0x00000000, 0x00000000
    .long 0x00000000, 0x00000000, 0x00000000, 0x00000000, 0x00000000, 0x00000000, 0x00000000, 0x00000000
    .long 0x00000000, 0x00000000, 0x00000000, 0x00000000, 0x00000000, 0x00000000, 0x00000000, 0x00000000
    .long 0x00000000, 0x00000000, 0x00000000, 0x00000000, 0x00000000, 0x00000000, 0x00000000, 0x00000000
    .long 0x00000000, 0x00000000, 0x00000000, 0x00000000, 0x00000000, 0x00000000, 0x00000000, 0x00000000
    .long 0x00000000, 0x00000000, 0x00000000, 0x00000000, 0x00000000, 0x00000000, 0x00000000, 0x00000000
    .long 0x00000000, 0x00000000, 0x00000000, 0x00000000, 0x00000000, 0x00000000, 0x00000000, 0x00000000
    .long 0x00000000, 0x00000000, 0x00000000, 0x00000000, 0x00000000, 0x00000000, 0x00000000, 0x00000000
    .long 0x00003f48, 0x0000bf48, 0x00003f40, 0x0000bf40, 0xbf103f0c, 0x0000bf0c, 0xbf3a3e3f, 0x0000be3f
    .long 0xbf48bcb3, 0x00003cb3, 0xbeb9bf28, 0x00003f28, 0xbf08bf13, 0x00003f13, 0x3f0cbf04, 0x00003f04
    .long 0x3d33bf48, 0x00003f48, 0x3f223ece, 0x0000bece, 0x3f17bf03, 0x00003f03, 0xbe6d3f37, 0x0000bf37
    .long 0x3f483d86, 0x0000bd86, 0xbf40bd41, 0x00003d41, 0x3efe3f1b, 0x0000bf1b, 0xbe10bf3d, 0x00003f3d
    .long 0xbdb33f47, 0x0000bf47, 0x3f2ebea4, 0x00003ea4, 0xbf1e3ef6, 0x0000bef6, 0x3ef53f14, 0x0000bf14
    .long 0x00000000, 0x00000000, 0x00000000, 0x00000000, 0x00000000, 0x00000000, 0x00000000, 0x00000000
    .long 0x00000000, 0x00000000, 0x00000000, 0x00000000, 0x00000000, 0x00000000, 0x00000000, 0x00000000
    .long 0x00000000, 0x00000000, 0x00000000, 0x00000000, 0x00000000, 0x00000000, 0x00000000, 0x00000000
    .long 0x00003f40, 0x0000bf40, 0x00003f48, 0x0000bf48, 0xbf3abe3f, 0x00003e3f, 0xbf10bf0c, 0x00003f0c
    .long 0x3eb9bf28, 0x00003f28, 0x3f48bcb3, 0x00003cb3, 0x3f0c3f04, 0x0000bf04, 0xbf083f13, 0x0000bf13
    .long 0xbf223ece, 0x0000bece, 0xbd33bf48, 0x00003f48, 0xbe6dbf37, 0x00003f37, 0x3f173f03, 0x0000bf03
    .long 0x3f40bd41, 0x00003d41, 0xbf483d86, 0x0000bd86, 0xbe103f3d, 0x0000bf3d, 0x3efebf1b, 0x00003f1b
    .long 0xbf2ebea4, 0x00003ea4, 0x3db33f47, 0x0000bf47, 0x3ef5bf14, 0x00003f14, 0xbf1ebef6, 0x00003ef6
    .long 0x00000000, 0x00000000, 0x00000000, 0x00000000, 0x00000000, 0x00000000, 0x00000000, 0x00000000
    .long 0x00000000, 0x00000000, 0x00000000, 0x00000000, 0x00000000, 0x00000000, 0x00000000, 0x00000000
    .long 0x00000000, 0x00000000, 0x00000000, 0x00000000, 0x00000000, 0x00000000, 0x00000000, 0x00000000
    .long 0x3dc33dc3, 0x40254025, 0x00004045, 0x3fb73fb7, 0xbe0d3e0d, 0xbfe53fe5, 0x00000000, 0xbfb73fb7
    .long 0x3e4b3e4b, 0x3f9f3f9f, 0x00000000, 0x3fb73fb7, 0xbe923e92, 0xbf5c3f5c, 0x00000000, 0xbfb73fb7
    .long 0x3ed33ed3, 0x3f183f18, 0x00000000, 0x3fb73fb7, 0xbf183f18, 0xbed33ed3, 0x00000000, 0xbfb73fb7
    .long 0x3f5c3f5c, 0x3e923e92, 0x00000000, 0x3fb73fb7, 0xbf9f3f9f, 0xbe4b3e4b, 0x00000000, 0xbfb73fb7
    .long 0x3fe53fe5, 0x3e0d3e0d, 0x00000000, 0x3fb73fb7, 0xc0254025, 0xbdc33dc3, 0x40450000, 0xbfb73fb7
    .long 0x00000000, 0x00000000, 0x00000000, 0x00000000, 0x00000000, 0x00000000, 0x00000000, 0x00000000
    .long 0x00000000, 0x00000000, 0x00000000, 0x00000000, 0x00000000, 0x00000000, 0x00000000, 0x00000000
    .long 0x00000000, 0x00000000, 0x00000000, 0x00000000, 0x00000000, 0x00000000, 0x00000000, 0x00000000
    .long 0x00000000, 0x00000000, 0x00000000, 0x00000000, 0x00000000, 0x00000000, 0x00000000, 0x00000000
    .long 0x00000000, 0x00000000, 0x00000000, 0x00000000, 0x00000000, 0x00000000, 0x00000000, 0x00000000
    .long 0x00000000, 0x00000000, 0x00000000, 0x00000000, 0x00000000, 0x00000000, 0x00000000, 0x00000000
    .long 0x00000000, 0x00000000, 0x00000000, 0x00000000, 0x00000000, 0x00000000, 0x00000000, 0x00000000
    .long 0x00000000, 0x00000000, 0x00000000, 0x00000000, 0x00000000, 0x00000000, 0x00000000, 0x00000000
    .long 0x00000000, 0x00000000, 0x00000000, 0x00000000, 0x00000000, 0x00000000, 0x00000000, 0x00000000
    .long 0x00000000, 0x00000000, 0x00000000, 0x00000000, 0x00000000, 0x00000000, 0x00000000, 0x00000000
    .long 0x00000000, 0x00000000, 0x00000000, 0x00000000, 0x00000000, 0x00000000, 0x00000000, 0x00000000
    .long 0x00003f48, 0x0000bf48, 0x00003f40, 0x0000bf40, 0xbf103f0c, 0x0000bf0c, 0xbf3a3e3f, 0x0000be3f
    .long 0xbf48bcb3, 0x00003cb3, 0xbeb9bf28, 0x00003f28, 0xbf08bf13, 0x00003f13, 0x3f0cbf04, 0x00003f04
    .long 0x3d33bf48, 0x00003f48, 0x3f223ece, 0x0000bece, 0x3f17bf03, 0x00003f03, 0xbe6d3f37, 0x0000bf37
    .long 0x3f483d86, 0x0000bd86, 0xbf40bd41, 0x00003d41, 0x3efe3f1b, 0x0000bf1b, 0xbe10bf3d, 0x00003f3d
    .long 0xbdb33f47, 0x0000bf47, 0x3f2ebea4, 0x00003ea4, 0xbf1e3ef6, 0x0000bef6, 0x3ef53f14, 0x0000bf14
    .long 0x00000000, 0x00000000, 0x00000000, 0x00000000, 0x00000000, 0x00000000, 0x00000000, 0x00000000
    .long 0x00000000, 0x00000000, 0x00000000, 0x00000000, 0x00000000, 0x00000000, 0x00000000, 0x00000000
    .long 0x00000000, 0x00000000, 0x00000000, 0x00000000, 0x00000000, 0x00000000, 0x00000000, 0x00000000
    .long 0x00003f40, 0x0000bf40, 0x00003f48, 0x0000bf48, 0xbf3abe3f, 0x00003e3f, 0xbf10bf0c, 0x00003f0c
    .long 0x3eb9bf28, 0x00003f28, 0x3f48bcb3, 0x00003cb3, 0x3f0c3f04, 0x0000bf04, 0xbf083f13, 0x0000bf13
    .long 0xbf223ece, 0x0000bece, 0xbd33bf48, 0x00003f48, 0xbe6dbf37, 0x00003f37, 0x3f173f03, 0x0000bf03
    .long 0x3f40bd41, 0x00003d41, 0xbf483d86, 0x0000bd86, 0xbe103f3d, 0x0000bf3d, 0x3efebf1b, 0x00003f1b
    .long 0xbf2ebea4, 0x00003ea4, 0x3db33f47, 0x0000bf47, 0x3ef5bf14, 0x00003f14, 0xbf1ebef6, 0x00003ef6
    .long 0x00000000, 0x00000000, 0x00000000, 0x00000000, 0x00000000, 0x00000000, 0x00000000, 0x00000000
    .long 0x00000000, 0x00000000, 0x00000000, 0x00000000, 0x00000000, 0x00000000, 0x00000000, 0x00000000
    .long 0x00000000, 0x00000000, 0x00000000, 0x00000000, 0x00000000, 0x00000000, 0x00000000, 0x00000000
    .long 0x40254025, 0x3dc33dc3, 0x3fb73fb7, 0x00004045, 0xbfe53fe5, 0xbe0d3e0d, 0xbfb73fb7, 0x00000000
    .long 0x3f9f3f9f, 0x3e4b3e4b, 0x3fb73fb7, 0x00000000, 0xbf5c3f5c, 0xbe923e92, 0xbfb73fb7, 0x00000000
    .long 0x3f183f18, 0x3ed33ed3, 0x3fb73fb7, 0x00000000, 0xbed33ed3, 0xbf183f18, 0xbfb73fb7, 0x00000000
    .long 0x3e923e92, 0x3f5c3f5c, 0x3fb73fb7, 0x00000000, 0xbe4b3e4b, 0xbf9f3f9f, 0xbfb73fb7, 0x00000000
    .long 0x3e0d3e0d, 0x3fe53fe5, 0x3fb73fb7, 0x00000000, 0xbdc33dc3, 0xc0254025, 0xbfb73fb7, 0x40450000
    .long 0x00000000, 0x00000000, 0x00000000, 0x00000000, 0x00000000, 0x00000000, 0x00000000, 0x00000000
    .long 0x00000000, 0x00000000, 0x00000000, 0x00000000, 0x00000000, 0x00000000, 0x00000000, 0x00000000
    .long 0x00000000, 0x00000000, 0x00000000, 0x00000000, 0x00000000, 0x00000000, 0x00000000, 0x00000000
    .long 0x00000000, 0x00000000, 0x00000000, 0x00000000, 0x00000000, 0x00000000, 0x00000000, 0x00000000
    .long 0x00000000, 0x00000000, 0x00000000, 0x00000000, 0x00000000, 0x00000000, 0x00000000, 0x00000000
    .long 0x00000000, 0x00000000, 0x00000000, 0x00000000, 0x00000000, 0x00000000, 0x00000000, 0x00000000
    .long 0x00000000, 0x00000000, 0x00000000, 0x00000000, 0x00000000, 0x00000000, 0x00000000, 0x00000000
    .long 0x00000000, 0x00000000, 0x00000000, 0x00000000, 0x00000000, 0x00000000, 0x00000000, 0x00000000
    .long 0x00000000, 0x00000000, 0x00000000, 0x00000000, 0x00000000, 0x00000000, 0x00000000, 0x00000000
    .long 0x00000000, 0x00000000, 0x00000000, 0x00000000, 0x00000000, 0x00000000, 0x00000000, 0x00000000
    .long 0x00000000, 0x00000000, 0x00000000, 0x00000000, 0x00000000, 0x00000000, 0x00000000, 0x00000000

K2_code_end:
.section .rodata,"a"
.p2align 6
.amdhsa_kernel standalone__fft_conv__vision_kernel
  .amdhsa_next_free_vgpr 512
  .amdhsa_next_free_sgpr 102
  .amdhsa_accum_offset 256
  .amdhsa_group_segment_fixed_size 0
  .amdhsa_kernarg_size 40
  .amdhsa_user_sgpr_count 2
  .amdhsa_user_sgpr_kernarg_segment_ptr 1
  .amdhsa_system_sgpr_workgroup_id_x 1
.end_amdhsa_kernel
```
